```python
import torch

def _softmax(x, axis=-1):
    return torch.softmax(x, dim=axis)
def _gelu(x):
    return torch.nn.functional.gelu(x, approximate="tanh")
def _silu(x):
    return torch.nn.functional.silu(x)
def _sigmoid(x):
    return torch.sigmoid(x)
def _layernorm(x, axis=-1, eps=1e-5):
    m = x.mean(dim=axis, keepdim=True)
    v = x.var(dim=axis, keepdim=True, unbiased=False)
    return (x - m) / torch.sqrt(v + eps)
def _scatter_add(tgt, idx, src, axis=0):
    return tgt.clone().index_add_(axis, idx, src)
def _segment_sum(src, seg, n):
    out = torch.zeros((n,) + src.shape[1:], dtype=src.dtype)
    return out.index_add_(0, seg, src)
def _pad(x, pw):
    flat = tuple(v for pair in reversed(pw) for v in pair)
    return torch.nn.functional.pad(x, flat)

kernel_name = 'concat_heads__gqa_block_cached__mha_block_cached__near_ridge'

def setup_inputs():

    _w = (lambda a: (lambda t: t.to(torch.bfloat16) if t.is_floating_point() else t)(torch.as_tensor(a)))
    def _A_setup():
        B, Sq, D = 8, 96, 640
        Hq, Hkv, Sk, Dh = 32, 32, 512, 192
        assert Hq % Hkv == 0, (Hq, Hkv)
        return {
            "x": _w((lambda *s: torch.randn(*s, dtype=torch.bfloat16) * 0.8)(B, Sq, D)),
            "k_cache": _w((lambda *s: torch.randn(*s, dtype=torch.bfloat16) * 0.8)(B, Hkv, Sk, Dh)),
            "v_cache": _w((lambda *s: torch.randn(*s, dtype=torch.bfloat16) * 0.05)(B, Hkv, Sk, Dh)),
            "wq": _w((lambda *s: torch.randn(*s, dtype=torch.bfloat16) * 0.8)(D, Hq * Dh) * (D ** -0.5)),
            "wo": _w((lambda *s: torch.randn(*s, dtype=torch.bfloat16) * 0.05)(Hq * Dh, D) * ((Hq * Dh) ** -0.5)),
        }
    _A_in = _A_setup()

    def _B_setup():
        B, Sq, D = 8, 96, 640
        H, Sk, Dh = 32, 512, 192
        return {
            "x": _w((lambda *s: torch.randn(*s, dtype=torch.bfloat16) * 0.8)(B, Sq, D)),
            "k_cache": _w((lambda *s: torch.randn(*s, dtype=torch.bfloat16) * 0.8)(B, H, Sk, Dh)),
            "v_cache": _w((lambda *s: torch.randn(*s, dtype=torch.bfloat16) * 0.05)(B, H, Sk, Dh)),
            "wq": _w((lambda *s: torch.randn(*s, dtype=torch.bfloat16) * 0.8)(D, H * Dh) * (D ** -0.5)),
            "wo": _w((lambda *s: torch.randn(*s, dtype=torch.bfloat16) * 0.05)(H * Dh, D) * ((H * Dh) ** -0.5)),
        }
    _B_in = _B_setup()

    return {
        "A_x": _A_in["x"],
        "A_k_cache": _A_in["k_cache"],
        "A_v_cache": _A_in["v_cache"],
        "A_wq": _A_in["wq"],
        "A_wo": _A_in["wo"],
        "B_x": _B_in["x"],
        "B_k_cache": _B_in["k_cache"],
        "B_v_cache": _B_in["v_cache"],
        "B_wq": _B_in["wq"],
        "B_wo": _B_in["wo"],
    }

def reference(A_x, A_k_cache, A_v_cache, A_wq, A_wo, B_x, B_k_cache, B_v_cache, B_wq, B_wo):
    def _A_ref(x, k_cache, v_cache, wq, wo):
        B, Sq, D = x.shape
        Hq, Dh = 32, 192
        Hkv = k_cache.shape[1]
        rep = Hq // Hkv
        q = (lambda x, *d: x.permute(*d))((x @ wq).reshape(B, Sq, Hq, Dh), 0, 2, 1, 3)
        k = (lambda x, n, axis: torch.repeat_interleave(x, n, dim=axis))(k_cache, rep, axis=1)
        v = (lambda x, n, axis: torch.repeat_interleave(x, n, dim=axis))(v_cache, rep, axis=1)
        scores = torch.einsum("bhqd,bhkd->bhqk", q, k) * (Dh ** -0.5)
        p = _softmax(scores, axis=-1)
        o = torch.einsum("bhqk,bhkd->bhqd", p, v)
        return (lambda x, *d: x.permute(*d))(o, 0, 2, 1, 3).reshape(B, Sq, Hq * Dh) @ wo

    def _B_ref(x, k_cache, v_cache, wq, wo):
        B, Sq, D = x.shape
        H, Dh = 32, 192
        q = (lambda x, *d: x.permute(*d))((x @ wq).reshape(B, Sq, H, Dh), 0, 2, 1, 3)
        scores = torch.einsum("bhqd,bhkd->bhqk", q, k_cache) * (Dh ** -0.5)
        p = _softmax(scores, axis=-1)
        o = torch.einsum("bhqk,bhkd->bhqd", p, v_cache)
        return (lambda x, *d: x.permute(*d))(o, 0, 2, 1, 3).reshape(B, Sq, H * Dh) @ wo

    a = _A_ref(A_x, A_k_cache, A_v_cache, A_wq, A_wo)
    b = _B_ref(B_x, B_k_cache, B_v_cache, B_wq, B_wo)
    return torch.concatenate([a, b], axis=-1)
```

```asm
; @launch grid=(256,1,1) block=(256,1,1) lds=163840
.amdgcn_target "amdgcn-amd-amdhsa--gfx950"
.text
.globl concat_heads__gqa_block_cached__mha_block_cached__near_ridge_kernel
.p2align 8
.type concat_heads__gqa_block_cached__mha_block_cached__near_ridge_kernel,@function
concat_heads__gqa_block_cached__mha_block_cached__near_ridge_kernel:
    s_cmp_lt_u32 s2, 256
    s_cbranch_scc1 1f
    s_endpgm
1:
    s_load_dwordx16 s[64:79], s[0:1], 0
    s_load_dwordx8 s[80:87], s[0:1], 64
    s_load_dwordx2 s[88:89], s[0:1], 96
    s_bfe_u32 s3, s2, 196611
    s_lshr_b32 s3, 170, s3
    s_bitcmp1_b32 s3, 0
    s_cbranch_scc0 L_second
    v_lshrrev_b32 v48, 6, v0
    v_and_b32 v34, 63, v0
    v_readfirstlane_b32 s48, v48
    s_getpc_b64 s[4:5]
    s_bfe_u32 s58, s2, 196611
    s_lshl_b32 s58, 1, s58
    s_sub_u32 s58, s58, 1
    s_and_b32 s58, s58, 170
    s_bcnt1_i32_b32 s58, s58
    s_lshr_b32 s59, s2, 6
    s_mul_i32 s59, s59, 4
    s_add_u32 s58, s58, s59
    s_lshl_b32 s58, s58, 2
    s_add_u32 s58, s58, s48
    s_mul_i32 s58, s58, 4
    v_min_u32 v62, 3, v34
    v_add_u32 v62, s58, v62
    v_min_u32 v62, 499, v62
    v_lshlrev_b32 v62, 7, v62
    v_mov_b32 v63, s5
    v_add_co_u32 v62, vcc, s4, v62
    v_addc_co_u32 v63, vcc, 0, v63, vcc
    global_load_dword v36, v[62:63], off
    s_and_b32 s57, s2, 7
    s_lshr_b32 s58, s2, 3
    s_lshr_b32 s53, s57, 2
    s_and_b32 s54, s57, 3
    s_and_b32 s55, s58, 7
    s_lshr_b32 s56, s58, 3
    s_lshr_b32 s49, s48, 1
    s_and_b32 s50, s48, 1
    s_mul_i32 s51, s48, 3072
    v_lshlrev_b32 v1, 4, v34
    s_mov_b32 s52, 0x3dd53b95
    v_lshrrev_b32 v48, 3, v34
    v_and_b32 v49, 7, v34
    v_and_b32 v53, 6, v48
    v_xor_b32 v53, v53, v49
    v_lshlrev_b32 v53, 4, v53
    v_mul_u32_u24 v8, 1280, v48
    s_mul_i32 s58, s48, 30720
    v_add3_u32 v8, v8, v53, s58
    v_add_u32 v9, 9216, v8
    v_add_u32 v10, 18432, v8
    v_add_u32 v50, 0, v48
    v_mul_u32_u24 v51, 43, v50
    v_lshrrev_b32 v51, 7, v51
    v_mul_u32_u24 v52, 3, v51
    v_sub_u32 v52, v50, v52
    s_lshl_b32 s58, s50, 2
    v_and_b32 v53, 2, v51
    v_or_b32 v53, s58, v53
    v_xor_b32 v53, v53, v49
    v_lshlrev_b32 v53, 4, v53
    v_lshl_add_u32 v53, v52, 7, v53
    v_mul_u32_u24 v5, 12288, v51
    s_mul_i32 s58, s48, 98304
    s_sub_u32 s58, s58, 0
    v_add3_u32 v5, v5, v53, s58
    v_add_u32 v50, 8, v48
    v_mul_u32_u24 v51, 43, v50
    v_lshrrev_b32 v51, 7, v51
    v_mul_u32_u24 v52, 3, v51
    v_sub_u32 v52, v50, v52
    s_lshl_b32 s58, s50, 2
    v_and_b32 v53, 2, v51
    v_or_b32 v53, s58, v53
    v_xor_b32 v53, v53, v49
    v_lshlrev_b32 v53, 4, v53
    v_lshl_add_u32 v53, v52, 7, v53
    v_mul_u32_u24 v6, 12288, v51
    s_mul_i32 s58, s48, 98304
    s_sub_u32 s58, s58, 1024
    v_add3_u32 v6, v6, v53, s58
    v_add_u32 v50, 16, v48
    v_mul_u32_u24 v51, 43, v50
    v_lshrrev_b32 v51, 7, v51
    v_mul_u32_u24 v52, 3, v51
    v_sub_u32 v52, v50, v52
    s_lshl_b32 s58, s50, 2
    v_and_b32 v53, 2, v51
    v_or_b32 v53, s58, v53
    v_xor_b32 v53, v53, v49
    v_lshlrev_b32 v53, 4, v53
    v_lshl_add_u32 v53, v52, 7, v53
    v_mul_u32_u24 v7, 12288, v51
    s_mul_i32 s58, s48, 98304
    s_sub_u32 s58, s58, 2048
    v_add3_u32 v7, v7, v53, s58
    s_mul_i32 s59, s54, 4
    s_mul_i32 s63, s56, 1
    s_add_u32 s63, s59, s63
    s_mul_i32 s61, s56, 3
    s_lshr_b32 s59, s55, 1
    s_mul_i32 s59, s59, 5
    s_lshr_b32 s59, s59, 1
    s_add_u32 s61, s61, s59
    s_mul_i32 s59, s61, 26
    s_lshr_b32 s59, s59, 8
    s_mul_i32 s59, s59, 10
    s_sub_u32 s61, s61, s59
    s_lshl_b32 s61, s61, 7
    s_waitcnt lgkmcnt(0)
    s_mul_i32 s58, s55, 122880
    s_cmp_eq_u32 s53, 0
    s_cselect_b64 s[8:9], s[64:65], s[74:75]
    s_add_u32 s8, s8, s58
    s_addc_u32 s9, s9, 0
    s_mov_b32 s10, 122880
    s_mov_b32 s11, 0x00020000
    s_mul_i32 s58, s63, 384
    s_cmp_eq_u32 s53, 0
    s_cselect_b64 s[20:21], s[70:71], s[80:81]
    s_add_u32 s20, s20, s58
    s_addc_u32 s21, s21, 0
    s_sub_u32 s22, 7864320, s58
    s_mov_b32 s23, 0x00020000
    v_lshrrev_b32 v56, 4, v34
    v_and_b32 v57, 15, v34
    v_and_b32 v58, 1, v56
    v_lshlrev_b32 v58, 1, v58
    v_lshrrev_b32 v60, 3, v57
    v_or_b32 v58, v58, v60
    v_lshlrev_b32 v58, 5, v58
    v_and_b32 v60, 3, v57
    s_mul_i32 s58, s48, 3
    v_lshl_add_u32 v58, v60, 3, v58
    s_add_u32 s60, s58, 0
    v_lshrrev_b32 v60, 2, v57
    s_and_b32 s60, s60, 3
    v_lshl_add_u32 v59, v56, 3, v60
    s_lshl_b32 s60, s60, 5
    v_xor_b32 v60, s60, v58
    s_add_u32 s60, s58, 0
    s_lshr_b32 s60, s60, 2
    s_mov_b32 s59, 0
    s_lshl_b32 s60, s60, 7
    v_mul_u32_u24 v59, 384, v59
    s_add_u32 s60, s60, s59
    v_add3_u32 v24, v60, v59, s60
    s_add_u32 s60, s58, 1
    s_and_b32 s60, s60, 3
    s_lshl_b32 s60, s60, 5
    v_xor_b32 v60, s60, v58
    s_add_u32 s60, s58, 1
    s_lshr_b32 s60, s60, 2
    s_lshl_b32 s60, s60, 7
    s_add_u32 s60, s60, s59
    v_add3_u32 v37, v60, v59, s60
    s_add_u32 s60, s58, 2
    s_and_b32 s60, s60, 3
    s_lshl_b32 s60, s60, 5
    v_xor_b32 v60, s60, v58
    s_add_u32 s60, s58, 2
    s_lshr_b32 s60, s60, 2
    s_lshl_b32 s60, s60, 7
    s_add_u32 s60, s60, s59
    s_lshl_b32 s59, s55, 5
    s_add_u32 s59, s59, s63
    s_cmp_eq_u32 s53, 0
    s_cselect_b64 s[12:13], s[66:67], s[76:77]
    s_cmp_eq_u32 s53, 0
    s_cselect_b64 s[16:17], s[68:69], s[78:79]
    s_mul_i32 s58, s59, 196608
    s_add_u32 s12, s12, s58
    s_addc_u32 s13, s13, 0
    s_add_u32 s16, s16, s58
    s_addc_u32 s17, s17, 0
    s_cmp_eq_u32 s53, 0
    s_cselect_b64 s[24:25], s[72:73], s[82:83]
    s_mul_i32 s58, s63, 245760
    s_add_u32 s24, s24, s58
    s_addc_u32 s25, s25, 0
    s_lshl_b32 s59, s53, 3
    s_add_u32 s59, s59, s55
    s_mul_i32 s58, s59, 1982464
    s_add_u32 s32, s88, s58
    s_addc_u32 s33, s89, 0
    v_add3_u32 v38, v60, v59, s60
    v_and_b32 v60, 6, v57
    s_lshl_b32 s58, s59, 4
    v_xor_b32 v60, v60, v56
    s_add_u32 s40, s86, s58
    s_addc_u32 s41, s87, 0
    v_lshlrev_b32 v60, 4, v60
    v_lshl_add_u32 v60, v57, 7, v60
    s_mul_i32 s58, s55, 245760
    s_mul_i32 s59, s53, 1280
    v_lshrrev_b32 v56, 4, v34
    v_add_u32 v25, 98304, v60
    s_add_u32 s58, s58, s59
    v_and_b32 v57, 15, v34
    v_and_b32 v58, 1, v56
    s_add_u32 s36, s84, s58
    s_addc_u32 s37, s85, 0
    v_lshlrev_b32 v58, 1, v58
    v_lshrrev_b32 v60, 3, v57
    v_or_b32 v58, v58, v60
    v_lshlrev_b32 v58, 5, v58
    v_and_b32 v60, 3, v57
    s_mul_i32 s58, s50, 6
    s_add_u32 m0, s51, 147456
    v_lshl_add_u32 v58, v60, 3, v58
    s_add_u32 s60, s58, 0
    v_lshrrev_b32 v60, 2, v57
    s_and_b32 s60, s60, 3
    v_lshl_add_u32 v59, v56, 2, v60
    s_lshl_b32 s60, s60, 5
    v_xor_b32 v60, s60, v58
    s_add_u32 s60, s58, 0
    s_lshr_b32 s60, s60, 2
    buffer_load_dwordx4 v8, s[8:11], s61 offen lds
    s_mul_i32 s59, s50, 12288
    s_lshl_b32 s60, s60, 7
    buffer_load_dwordx4 v9, s[8:11], s61 offen offset:1024 lds
    s_mul_i32 s62, s61, 6144
    v_mul_u32_u24 v59, 384, v59
    s_add_u32 s60, s60, s59
    s_add_u32 s57, s62, 0
    buffer_load_dwordx4 v10, s[8:11], s61 offen offset:2048 lds
    s_add_u32 m0, s51, 73728
    v_add3_u32 v13, v60, v59, s60
    s_add_u32 s60, s58, 1
    s_and_b32 s60, s60, 3
    buffer_load_dwordx4 v5, s[20:23], s57 offen lds
    s_lshl_b32 s60, s60, 5
    v_xor_b32 v60, s60, v58
    s_add_u32 s60, s58, 1
    s_lshr_b32 s60, s60, 2
    buffer_load_dwordx4 v6, s[20:23], s57 offen offset:1024 lds
    s_lshl_b32 s60, s60, 7
    s_add_u32 s60, s60, s59
    buffer_load_dwordx4 v7, s[20:23], s57 offen offset:2048 lds
    s_add_u32 s57, s62, 393216
    s_add_u32 m0, s51, 86016
    v_add3_u32 v14, v60, v59, s60
    s_add_u32 s60, s58, 2
    s_and_b32 s60, s60, 3
    buffer_load_dwordx4 v5, s[20:23], s57 offen lds
    s_lshl_b32 s60, s60, 5
    v_xor_b32 v60, s60, v58
    s_add_u32 s60, s58, 2
    s_lshr_b32 s60, s60, 2
    buffer_load_dwordx4 v6, s[20:23], s57 offen offset:1024 lds
    s_lshl_b32 s60, s60, 7
    s_add_u32 s60, s60, s59
    buffer_load_dwordx4 v7, s[20:23], s57 offen offset:2048 lds
    v_add3_u32 v15, v60, v59, s60
    s_add_u32 s60, s58, 3
    s_and_b32 s60, s60, 3
    s_lshl_b32 s60, s60, 5
    v_xor_b32 v60, s60, v58
    s_add_u32 s60, s58, 3
    s_lshr_b32 s60, s60, 2
    s_lshl_b32 s60, s60, 7
    s_add_u32 s60, s60, s59
    v_add3_u32 v16, v60, v59, s60
    s_mul_i32 s58, s50, 4294942720
    v_and_b32 v60, 6, v57
    s_add_u32 s58, s58, 12288
    v_xor_b32 v60, v60, v56
    v_add_u32 v17, s58, v13
    v_add_u32 v18, s58, v14
    v_add_u32 v19, s58, v15
    v_add_u32 v20, s58, v16
    v_lshlrev_b32 v60, 4, v60
    v_mul_u32_u24 v11, 384, v57
    v_add3_u32 v11, v11, v60, s59
    s_add_u32 s58, s51, 135168
    v_add_u32 v27, s58, v1
    s_xor_b32 s59, s48, 1
    s_mul_i32 s58, s59, 3072
    v_lshrrev_b32 v48, 3, v34
    s_add_u32 s58, s58, 135168
    v_add_u32 v50, 0, v48
    v_add_u32 v28, s58, v1
    v_mul_u32_u24 v51, 43, v50
    s_lshl_b32 s58, s48, 10
    v_lshrrev_b32 v51, 7, v51
    s_add_u32 s58, s58, 159744
    v_mul_u32_u24 v52, 3, v51
    v_add_u32 v31, s58, v1
    v_sub_u32 v52, v50, v52
    v_lshrrev_b32 v60, 1, v56
    s_mul_i32 s58, s49, 18432
    v_and_b32 v49, 7, v34
    v_and_b32 v53, 6, v51
    v_add_u32 v50, 8, v48
    v_lshlrev_b32 v60, 8, v60
    s_add_u32 s58, s58, 73728
    v_xor_b32 v53, v53, v49
    v_mul_u32_u24 v51, 43, v50
    v_lshl_add_u32 v60, v57, 4, v60
    v_and_b32 v29, 1, v56
    v_add_u32 v30, s58, v1
    s_mul_i32 s59, s50, 3072
    v_lshlrev_b32 v53, 4, v53
    v_lshrrev_b32 v51, 7, v51
    v_lshl_add_u32 v29, v29, 3, v60
    s_add_u32 s58, s58, s59
    v_lshl_add_u32 v2, v48, 7, v53
    v_mul_u32_u24 v52, 3, v51
    v_add_u32 v29, s58, v29
    v_sub_u32 v52, v50, v52
    v_and_b32 v53, 6, v51
    s_mul_i32 s58, s50, 18432
    s_mul_i32 s59, s49, 3072
    v_xor_b32 v53, v53, v49
    v_add_u32 v50, 16, v48
    s_add_u32 s58, s58, s59
    v_lshlrev_b32 v53, 4, v53
    v_mul_u32_u24 v51, 43, v50
    v_add_u32 v33, s58, v1
    v_lshl_add_u32 v3, v48, 7, v53
    v_lshrrev_b32 v51, 7, v51
    s_mul_i32 s58, s49, 4294951936
    s_mul_i32 s59, s50, 4294965760
    v_and_b32 v53, 6, v51
    s_add_u32 s58, s58, s59
    v_xor_b32 v53, v53, v49
    v_add_u32 v29, s58, v29
    v_lshlrev_b32 v53, 4, v53
    s_mul_i32 s58, s49, 3072
    s_lshl_b32 s46, s54, 2
    v_mul_u32_u24 v52, 3, v51
    v_lshl_add_u32 v4, v48, 7, v53
    v_cmp_eq_u32 vcc, 0, v34
    v_bfrev_b32 v47, 1
    v_mov_b32 v60, 0x3f803f80
    s_add_u32 s58, s58, 98304
    v_add_u32 v21, 73728, v24
    v_add_u32 v22, 73728, v37
    v_add_u32 v23, 73728, v38
    v_xor_b32 v26, 64, v25
    s_mov_b32 s14, 3342336
    s_mov_b32 s15, 0x00020000
    s_mov_b32 s18, 3342336
    s_mov_b32 s19, 0x00020000
    s_mov_b32 s26, 4177920
    s_mov_b32 s27, 0x00020000
    s_mov_b32 s34, 1982464
    s_mov_b32 s35, 0x00020000
    s_mov_b32 s42, 16
    s_mov_b32 s43, 0x00020000
    s_mov_b32 s38, 244480
    s_mov_b32 s39, 0x00020000
    s_add_u32 s46, s46, s56
    s_mul_i32 s44, s55, 128
    v_add_u32 v2, s51, v2
    v_add_u32 v3, s51, v3
    v_sub_u32 v52, v50, v52
    v_add_u32 v4, s51, v4
    v_cndmask_b32 v47, v47, v34, vcc
    v_xor_b32 v12, 64, v11
    v_xor_b32 v32, 1024, v31
    v_mov_b32 v39, 0
    v_accvgpr_write_b32 a156, v60
    v_accvgpr_write_b32 a157, v60
    v_accvgpr_write_b32 a158, v60
    v_accvgpr_write_b32 a159, v60
    v_add_u32 v33, 98304, v33
    v_add_u32 v35, s58, v1
    s_waitcnt vmcnt(3)
    s_barrier
    ds_read_b128 a[208:211], v25 offset:49152
    s_add_u32 s61, s61, 128
    ds_read_b64_tr_b16 a[184:185], v21 offset:0
    s_cmp_eq_u32 s61, 1280
    s_cselect_b32 s61, 0, s61
    ds_read_b64_tr_b16 a[186:187], v21 offset:1536
    ds_read_b128 a[212:215], v25 offset:51200
    s_add_u32 m0, s51, 135168
    s_mul_i32 s62, s61, 6144
    buffer_load_dwordx4 v8, s[8:11], s61 offen lds
    ds_read_b128 a[216:219], v25 offset:53248
    s_add_u32 s57, s62, 0
    s_lshl_b32 s58, s48, 6
    ds_read_b128 a[220:223], v25 offset:55296
    s_lshl_b32 s59, s46, 2
    s_add_u32 s58, s58, s59
    s_add_u32 s65, s58, 1966080
    ds_read_b128 a[224:227], v25 offset:57344
    buffer_load_dwordx4 v9, s[8:11], s61 offen offset:1024 lds
    s_cmp_eq_u32 s58, 0
    s_cselect_b32 s58, 0, 0x40000000
    ds_read_b128 a[228:231], v25 offset:59392
    v_lshlrev_b32 v44, 4, v34
    v_add_u32 v44, s58, v44
    v_mov_b32 v40, 0
    v_mov_b32 v41, 0
    v_mov_b32 v42, 0
    s_waitcnt lgkmcnt(5)
    v_mfma_f32_16x16x32_bf16 a[0:3], a[184:187], a[208:211], 0
    s_add_u32 s45, s44, 1024
    buffer_load_dwordx4 v10, s[8:11], s61 offen offset:2048 lds
    s_waitcnt lgkmcnt(4)
    v_mfma_f32_16x16x32_bf16 a[4:7], a[184:187], a[212:215], 0
    s_add_u32 m0, s51, 98304
    ds_read_b64_tr_b16 a[188:189], v22 offset:0
    ds_read_b64_tr_b16 a[190:191], v22 offset:1536
    s_waitcnt lgkmcnt(5)
    v_mfma_f32_16x16x32_bf16 a[8:11], a[184:187], a[216:219], 0
    s_add_u32 s61, s61, 128
    ds_read_b64_tr_b16 a[192:193], v23 offset:0
    ds_read_b64_tr_b16 a[194:195], v23 offset:1536
    s_waitcnt lgkmcnt(6)
    v_mfma_f32_16x16x32_bf16 a[12:15], a[184:187], a[220:223], 0
    s_lshr_b32 s59, s2, 6
    buffer_load_dwordx4 v5, s[20:23], s57 offen lds
    s_waitcnt lgkmcnt(5)
    v_mfma_f32_16x16x32_bf16 a[16:19], a[184:187], a[224:227], 0
    s_mul_i32 s59, s59, 4
    ds_read_b128 a[232:235], v26 offset:49152
    v_mov_b32 v43, 0
    s_waitcnt lgkmcnt(5)
    v_mfma_f32_16x16x32_bf16 a[20:23], a[184:187], a[228:231], 0
    ds_read_b128 a[236:239], v26 offset:51200
    buffer_load_dwordx4 v6, s[20:23], s57 offen offset:1024 lds
    ds_read_b128 a[240:243], v26 offset:53248
    s_cmp_eq_u32 s61, 1280
    s_cselect_b32 s61, 0, s61
    ds_read_b128 a[244:247], v26 offset:55296
    v_add_u32 v45, s58, v47
    v_lshrrev_b32 v56, 4, v34
    s_waitcnt lgkmcnt(6)
    v_mfma_f32_16x16x32_bf16 a[24:27], a[188:191], a[208:211], 0
    s_lshl_b32 s58, s50, 1
    buffer_load_dwordx4 v7, s[20:23], s57 offen offset:2048 lds
    v_mfma_f32_16x16x32_bf16 a[28:31], a[188:191], a[212:215], 0
    s_add_u32 s57, s62, 393216
    ds_read_b128 a[248:251], v26 offset:57344
    s_add_u32 m0, s51, 73728
    v_mfma_f32_16x16x32_bf16 a[32:35], a[188:191], a[216:219], 0
    s_mul_i32 s62, s61, 6144
    ds_read_b128 a[252:255], v26 offset:59392
    v_bfe_u32 v57, v34, 2, 2
    v_mfma_f32_16x16x32_bf16 a[36:39], a[188:191], a[220:223], 0
    s_waitcnt vmcnt(6) lgkmcnt(5)
    s_barrier
    ds_read_b64_tr_b16 a[196:197], v21 offset:12288
    v_mfma_f32_16x16x32_bf16 a[40:43], a[188:191], a[224:227], 0
    ds_read_b64_tr_b16 a[198:199], v21 offset:13824
    ds_read_b64_tr_b16 a[200:201], v22 offset:12288
    v_mfma_f32_16x16x32_bf16 a[44:47], a[188:191], a[228:231], 0
    buffer_load_dwordx4 v5, s[20:23], s57 offen lds
    v_mfma_f32_16x16x32_bf16 a[48:51], a[192:195], a[208:211], 0
    ds_read_b64_tr_b16 a[202:203], v22 offset:13824
    ds_read_b64_tr_b16 a[204:205], v23 offset:12288
    v_mfma_f32_16x16x32_bf16 a[52:55], a[192:195], a[212:215], 0
    ds_read_b64_tr_b16 a[206:207], v23 offset:13824
    v_lshl_add_u32 v57, v56, 2, v57
    v_mfma_f32_16x16x32_bf16 a[56:59], a[192:195], a[216:219], 0
    buffer_load_dwordx4 v6, s[20:23], s57 offen offset:1024 lds
    v_mfma_f32_16x16x32_bf16 a[60:63], a[192:195], a[220:223], 0
    buffer_store_dwordx4 v[40:43], v44, s[32:35], s65 offen sc1
    v_mfma_f32_16x16x32_bf16 a[64:67], a[192:195], a[224:227], 0
    buffer_load_dwordx4 v7, s[20:23], s57 offen offset:2048 lds
    v_mfma_f32_16x16x32_bf16 a[68:71], a[192:195], a[228:231], 0
    s_add_u32 m0, s51, 122880
    s_add_u32 s57, s62, 0
    v_mov_b32 v40, 1
    s_waitcnt lgkmcnt(2)
    v_mfma_f32_16x16x32_bf16 a[0:3], a[196:199], a[232:235], a[0:3]
    v_mov_b32 v41, 1
    v_mov_b32 v42, 1
    v_mfma_f32_16x16x32_bf16 a[4:7], a[196:199], a[236:239], a[4:7]
    buffer_load_dwordx4 v8, s[8:11], s61 offen lds
    v_mfma_f32_16x16x32_bf16 a[8:11], a[196:199], a[240:243], a[8:11]
    v_mov_b32 v43, 1
    v_bfe_u32 v58, v57, 1, 2
    v_mfma_f32_16x16x32_bf16 a[12:15], a[196:199], a[244:247], a[12:15]
    v_xor_b32 v58, s58, v58
    s_bfe_u32 s58, s2, 196611
    v_mfma_f32_16x16x32_bf16 a[16:19], a[196:199], a[248:251], a[16:19]
    s_lshl_b32 s58, 1, s58
    buffer_load_dwordx4 v9, s[8:11], s61 offen offset:1024 lds
    v_mfma_f32_16x16x32_bf16 a[20:23], a[196:199], a[252:255], a[20:23]
    s_sub_u32 s58, s58, 1
    s_and_b32 s58, s58, 170
    s_bcnt1_i32_b32 s58, s58
    v_mfma_f32_16x16x32_bf16 a[24:27], a[200:203], a[232:235], a[24:27]
    s_add_u32 s58, s58, s59
    s_lshl_b32 s58, s58, 2
    s_add_u32 s58, s58, s48
    v_mfma_f32_16x16x32_bf16 a[28:31], a[200:203], a[236:239], a[28:31]
    s_mul_i32 s58, s58, 4
    buffer_load_dwordx4 v10, s[8:11], s61 offen offset:2048 lds
    v_mfma_f32_16x16x32_bf16 a[32:35], a[200:203], a[240:243], a[32:35]
    s_add_u32 m0, s51, 86016
    s_waitcnt vmcnt(7) lgkmcnt(0)
    s_barrier
    v_mfma_f32_16x16x32_bf16 a[36:39], a[200:203], a[244:247], a[36:39]
    s_add_u32 s61, s61, 128
    ds_read_b128 a[208:211], v25 offset:36864
    v_lshlrev_b32 v58, 5, v58
    v_mfma_f32_16x16x32_bf16 a[40:43], a[200:203], a[248:251], a[40:43]
    s_add_u32 s58, s58, 8
    ds_read_b64_tr_b16 a[184:185], v21 offset:24576
    ds_read_b64_tr_b16 a[186:187], v21 offset:26112
    v_mfma_f32_16x16x32_bf16 a[44:47], a[200:203], a[252:255], a[44:47]
    s_lshl_b32 s59, s49, 3
    buffer_load_dwordx4 v5, s[20:23], s57 offen lds
    v_mfma_f32_16x16x32_bf16 a[48:51], a[204:207], a[232:235], a[48:51]
    s_add_u32 s59, s59, s46
    ds_read_b128 a[212:215], v25 offset:38912
    v_lshl_add_u32 v58, v57, 7, v58
    v_mfma_f32_16x16x32_bf16 a[52:55], a[204:207], a[236:239], a[52:55]
    s_and_b32 s64, s59, 15
    buffer_load_dwordx4 v6, s[20:23], s57 offen offset:1024 lds
    v_mfma_f32_16x16x32_bf16 a[56:59], a[204:207], a[240:243], a[56:59]
    ds_read_b128 a[216:219], v25 offset:40960
    v_min_u32 v62, 3, v34
    v_mfma_f32_16x16x32_bf16 a[60:63], a[204:207], a[244:247], a[60:63]
    buffer_load_dwordx4 v7, s[20:23], s57 offen offset:2048 lds
    v_mfma_f32_16x16x32_bf16 a[64:67], a[204:207], a[248:251], a[64:67]
    s_add_u32 s57, s62, 393216
    ds_read_b128 a[220:223], v25 offset:43008
    s_add_u32 m0, s51, 110592
    v_mfma_f32_16x16x32_bf16 a[68:71], a[204:207], a[252:255], a[68:71]
    s_waitcnt lgkmcnt(3)
    buffer_load_dwordx4 v5, s[20:23], s57 offen lds
    v_mfma_f32_16x16x32_bf16 a[0:3], a[184:187], a[208:211], a[0:3]
    s_waitcnt lgkmcnt(2)
    ds_read_b128 a[224:227], v25 offset:45056
    v_and_b32 v57, 3, v34
    v_mfma_f32_16x16x32_bf16 a[4:7], a[184:187], a[212:215], a[4:7]
    s_waitcnt lgkmcnt(2)
    buffer_load_dwordx4 v6, s[20:23], s57 offen offset:1024 lds
    ds_read_b128 a[228:231], v25 offset:47104
    v_mfma_f32_16x16x32_bf16 a[8:11], a[184:187], a[216:219], a[8:11]
    buffer_load_dwordx4 v7, s[20:23], s57 offen offset:2048 lds
    ds_read_b64_tr_b16 a[188:189], v22 offset:24576
    ds_read_b64_tr_b16 a[190:191], v22 offset:26112
    ds_read_b64_tr_b16 a[192:193], v23 offset:24576
    s_cmp_eq_u32 s61, 1280
    s_cselect_b32 s61, 0, s61
    s_waitcnt lgkmcnt(5)
    v_mfma_f32_16x16x32_bf16 a[12:15], a[184:187], a[220:223], a[12:15]
    s_add_u32 m0, s51, 147456
    ds_read_b64_tr_b16 a[194:195], v23 offset:26112
    buffer_load_dwordx4 v8, s[8:11], s61 offen lds
    ds_read_b128 a[232:235], v26 offset:36864
    s_mul_i32 s62, s61, 6144
    s_waitcnt lgkmcnt(6)
    v_mfma_f32_16x16x32_bf16 a[16:19], a[184:187], a[224:227], a[16:19]
    s_add_u32 s57, s62, 0
    buffer_load_dwordx4 v9, s[8:11], s61 offen offset:1024 lds
    ds_read_b128 a[236:239], v26 offset:38912
    v_add_u32 v62, s58, v62
    s_waitcnt lgkmcnt(6)
    v_mfma_f32_16x16x32_bf16 a[20:23], a[184:187], a[228:231], a[20:23]
    s_waitcnt lgkmcnt(5)
    buffer_load_dwordx4 v10, s[8:11], s61 offen offset:2048 lds
    s_add_u32 m0, s51, 61440
    ds_read_b128 a[240:243], v26 offset:40960
    s_add_u32 s61, s61, 128
    s_waitcnt lgkmcnt(5)
    v_mfma_f32_16x16x32_bf16 a[24:27], a[188:191], a[208:211], a[24:27]
    buffer_load_dwordx4 v5, s[20:23], s57 offen lds
    v_mfma_f32_16x16x32_bf16 a[28:31], a[188:191], a[212:215], a[28:31]
    ds_read_b128 a[244:247], v26 offset:43008
    v_lshl_add_u32 v58, v57, 3, v58
    v_mfma_f32_16x16x32_bf16 a[32:35], a[188:191], a[216:219], a[32:35]
    buffer_load_dwordx4 v6, s[20:23], s57 offen offset:1024 lds
    v_mfma_f32_16x16x32_bf16 a[36:39], a[188:191], a[220:223], a[36:39]
    ds_read_b128 a[248:251], v26 offset:45056
    v_lshlrev_b32 v62, 7, v62
    v_mfma_f32_16x16x32_bf16 a[40:43], a[188:191], a[224:227], a[40:43]
    buffer_load_dwordx4 v7, s[20:23], s57 offen offset:2048 lds
    v_mfma_f32_16x16x32_bf16 a[44:47], a[188:191], a[228:231], a[44:47]
    s_add_u32 s57, s62, 393216
    ds_read_b128 a[252:255], v26 offset:47104
    s_add_u32 m0, s51, 98304
    s_waitcnt lgkmcnt(3)
    v_mfma_f32_16x16x32_bf16 a[48:51], a[192:195], a[208:211], a[48:51]
    s_waitcnt vmcnt(15)
    s_barrier
    ds_read_b64_tr_b16 a[196:197], v21 offset:0
    v_mfma_f32_16x16x32_bf16 a[52:55], a[192:195], a[212:215], a[52:55]
    ds_read_b64_tr_b16 a[198:199], v21 offset:1536
    ds_read_b64_tr_b16 a[200:201], v22 offset:0
    v_mfma_f32_16x16x32_bf16 a[56:59], a[192:195], a[216:219], a[56:59]
    ds_read_b64_tr_b16 a[202:203], v22 offset:1536
    ds_read_b64_tr_b16 a[204:205], v23 offset:0
    v_mfma_f32_16x16x32_bf16 a[60:63], a[192:195], a[220:223], a[60:63]
    buffer_load_dwordx4 v5, s[20:23], s57 offen lds
    v_mfma_f32_16x16x32_bf16 a[64:67], a[192:195], a[224:227], a[64:67]
    ds_read_b64_tr_b16 a[206:207], v23 offset:1536
    v_mov_b32 v60, 0
    v_mfma_f32_16x16x32_bf16 a[68:71], a[192:195], a[228:231], a[68:71]
    s_cmp_eq_u32 s61, 1280
    s_cselect_b32 s61, 0, s61
    s_mul_i32 s62, s61, 6144
    v_mov_b32 v61, 0
    s_waitcnt lgkmcnt(4)
    v_mfma_f32_16x16x32_bf16 a[0:3], a[196:199], a[232:235], a[0:3]
    buffer_load_dwordx4 v6, s[20:23], s57 offen offset:1024 lds
    v_mfma_f32_16x16x32_bf16 a[4:7], a[196:199], a[236:239], a[4:7]
    v_mfma_f32_16x16x32_bf16 a[8:11], a[196:199], a[240:243], a[8:11]
    v_mfma_f32_16x16x32_bf16 a[12:15], a[196:199], a[244:247], a[12:15]
    v_mfma_f32_16x16x32_bf16 a[16:19], a[196:199], a[248:251], a[16:19]
    v_mfma_f32_16x16x32_bf16 a[20:23], a[196:199], a[252:255], a[20:23]
    s_waitcnt lgkmcnt(0)
    buffer_load_dwordx4 v7, s[20:23], s57 offen offset:2048 lds
    v_mfma_f32_16x16x32_bf16 a[24:27], a[200:203], a[232:235], a[24:27]
    s_add_u32 m0, s51, 135168
    s_waitcnt vmcnt(12)
    s_barrier
    v_mfma_f32_16x16x32_bf16 a[28:31], a[200:203], a[236:239], a[28:31]
    s_add_u32 s57, s62, 0
    ds_read_b128 a[208:211], v25 offset:24576
    buffer_load_dwordx4 v8, s[8:11], s61 offen lds
    v_mfma_f32_16x16x32_bf16 a[32:35], a[200:203], a[240:243], a[32:35]
    ds_read_b64_tr_b16 a[184:185], v21 offset:12288
    ds_read_b64_tr_b16 a[186:187], v21 offset:13824
    v_mfma_f32_16x16x32_bf16 a[36:39], a[200:203], a[244:247], a[36:39]
    ds_read_b128 a[212:215], v25 offset:26624
    buffer_load_dwordx4 v9, s[8:11], s61 offen offset:1024 lds
    v_mfma_f32_16x16x32_bf16 a[40:43], a[200:203], a[248:251], a[40:43]
    ds_read_b128 a[216:219], v25 offset:28672
    v_mfma_f32_16x16x32_bf16 a[44:47], a[200:203], a[252:255], a[44:47]
    ds_read_b128 a[220:223], v25 offset:30720
    buffer_load_dwordx4 v10, s[8:11], s61 offen offset:2048 lds
    v_mfma_f32_16x16x32_bf16 a[48:51], a[204:207], a[232:235], a[48:51]
    s_add_u32 m0, s51, 73728
    ds_read_b128 a[224:227], v25 offset:32768
    s_add_u32 s61, s61, 128
    v_mfma_f32_16x16x32_bf16 a[52:55], a[204:207], a[236:239], a[52:55]
    ds_read_b128 a[228:231], v25 offset:34816
    buffer_load_dwordx4 v5, s[20:23], s57 offen lds
    v_mfma_f32_16x16x32_bf16 a[56:59], a[204:207], a[240:243], a[56:59]
    ds_read_b64_tr_b16 a[188:189], v22 offset:12288
    ds_read_b64_tr_b16 a[190:191], v22 offset:13824
    v_mfma_f32_16x16x32_bf16 a[60:63], a[204:207], a[244:247], a[60:63]
    ds_read_b64_tr_b16 a[192:193], v23 offset:12288
    ds_read_b64_tr_b16 a[194:195], v23 offset:13824
    v_mfma_f32_16x16x32_bf16 a[64:67], a[204:207], a[248:251], a[64:67]
    buffer_load_dwordx4 v6, s[20:23], s57 offen offset:1024 lds
    v_mfma_f32_16x16x32_bf16 a[68:71], a[204:207], a[252:255], a[68:71]
    s_waitcnt lgkmcnt(6)
    ds_read_b128 a[232:235], v26 offset:24576
    s_cmp_eq_u32 s61, 1280
    s_cselect_b32 s61, 0, s61
    v_mfma_f32_16x16x32_bf16 a[0:3], a[184:187], a[208:211], a[0:3]
    buffer_load_dwordx4 v7, s[20:23], s57 offen offset:2048 lds
    v_mfma_f32_16x16x32_bf16 a[4:7], a[184:187], a[212:215], a[4:7]
    s_add_u32 s57, s62, 393216
    ds_read_b128 a[236:239], v26 offset:26624
    s_add_u32 m0, s51, 86016
    v_mfma_f32_16x16x32_bf16 a[8:11], a[184:187], a[216:219], a[8:11]
    s_mul_i32 s62, s61, 6144
    ds_read_b128 a[240:243], v26 offset:28672
    v_mfma_f32_16x16x32_bf16 a[12:15], a[184:187], a[220:223], a[12:15]
    ds_read_b128 a[244:247], v26 offset:30720
    s_waitcnt vmcnt(15) lgkmcnt(4)
    s_barrier
    v_mfma_f32_16x16x32_bf16 a[16:19], a[184:187], a[224:227], a[16:19]
    ds_read_b64_tr_b16 a[196:197], v21 offset:36864
    ds_read_b64_tr_b16 a[198:199], v21 offset:38400
    v_mfma_f32_16x16x32_bf16 a[20:23], a[184:187], a[228:231], a[20:23]
    ds_read_b128 a[248:251], v26 offset:32768
    buffer_load_dwordx4 v5, s[20:23], s57 offen lds
    v_mfma_f32_16x16x32_bf16 a[24:27], a[188:191], a[208:211], a[24:27]
    ds_read_b128 a[252:255], v26 offset:34816
    v_mfma_f32_16x16x32_bf16 a[28:31], a[188:191], a[212:215], a[28:31]
    ds_read_b64_tr_b16 a[200:201], v22 offset:36864
    ds_read_b64_tr_b16 a[202:203], v22 offset:38400
    v_mfma_f32_16x16x32_bf16 a[32:35], a[188:191], a[216:219], a[32:35]
    ds_read_b64_tr_b16 a[204:205], v23 offset:36864
    ds_read_b64_tr_b16 a[206:207], v23 offset:38400
    v_mfma_f32_16x16x32_bf16 a[36:39], a[188:191], a[220:223], a[36:39]
    v_mfma_f32_16x16x32_bf16 a[40:43], a[188:191], a[224:227], a[40:43]
    buffer_load_dwordx4 v6, s[20:23], s57 offen offset:1024 lds
    v_mfma_f32_16x16x32_bf16 a[44:47], a[188:191], a[228:231], a[44:47]
    v_mfma_f32_16x16x32_bf16 a[48:51], a[192:195], a[208:211], a[48:51]
    v_mfma_f32_16x16x32_bf16 a[52:55], a[192:195], a[212:215], a[52:55]
    v_mfma_f32_16x16x32_bf16 a[56:59], a[192:195], a[216:219], a[56:59]
    v_mfma_f32_16x16x32_bf16 a[60:63], a[192:195], a[220:223], a[60:63]
    buffer_load_dwordx4 v7, s[20:23], s57 offen offset:2048 lds
    v_mfma_f32_16x16x32_bf16 a[64:67], a[192:195], a[224:227], a[64:67]
    s_add_u32 m0, s51, 122880
    s_waitcnt vmcnt(12) lgkmcnt(0)
    s_barrier
    v_mfma_f32_16x16x32_bf16 a[68:71], a[192:195], a[228:231], a[68:71]
    s_add_u32 s57, s62, 0
    ds_read_b128 a[208:211], v25 offset:49152
    buffer_load_dwordx4 v8, s[8:11], s61 offen lds
    v_mfma_f32_16x16x32_bf16 a[0:3], a[196:199], a[232:235], a[0:3]
    ds_read_b64_tr_b16 a[184:185], v24 offset:61440
    ds_read_b64_tr_b16 a[186:187], v24 offset:62976
    v_mfma_f32_16x16x32_bf16 a[4:7], a[196:199], a[236:239], a[4:7]
    ds_read_b128 a[212:215], v25 offset:51200
    buffer_load_dwordx4 v9, s[8:11], s61 offen offset:1024 lds
    v_mfma_f32_16x16x32_bf16 a[8:11], a[196:199], a[240:243], a[8:11]
    ds_read_b128 a[216:219], v25 offset:53248
    buffer_store_dwordx4 v[40:43], v45, s[40:43], 0 offen sc1
    v_mfma_f32_16x16x32_bf16 a[12:15], a[196:199], a[244:247], a[12:15]
    ds_read_b128 a[220:223], v25 offset:55296
    buffer_load_dwordx4 v10, s[8:11], s61 offen offset:2048 lds
    v_mfma_f32_16x16x32_bf16 a[16:19], a[196:199], a[248:251], a[16:19]
    s_add_u32 m0, s51, 110592
    ds_read_b128 a[224:227], v25 offset:57344
    s_add_u32 s61, s61, 128
    v_mfma_f32_16x16x32_bf16 a[20:23], a[196:199], a[252:255], a[20:23]
    ds_read_b128 a[228:231], v25 offset:59392
    buffer_load_dwordx4 v5, s[20:23], s57 offen lds
    v_mfma_f32_16x16x32_bf16 a[24:27], a[200:203], a[232:235], a[24:27]
    ds_read_b64_tr_b16 a[188:189], v37 offset:61440
    ds_read_b64_tr_b16 a[190:191], v37 offset:62976
    v_mfma_f32_16x16x32_bf16 a[28:31], a[200:203], a[236:239], a[28:31]
    ds_read_b64_tr_b16 a[192:193], v38 offset:61440
    ds_read_b64_tr_b16 a[194:195], v38 offset:62976
    v_mfma_f32_16x16x32_bf16 a[32:35], a[200:203], a[240:243], a[32:35]
    buffer_load_dwordx4 v6, s[20:23], s57 offen offset:1024 lds
    v_mfma_f32_16x16x32_bf16 a[36:39], a[200:203], a[244:247], a[36:39]
    s_cmp_eq_u32 s61, 1280
    s_cselect_b32 s61, 0, s61
    v_mfma_f32_16x16x32_bf16 a[40:43], a[200:203], a[248:251], a[40:43]
    buffer_load_dwordx4 v7, s[20:23], s57 offen offset:2048 lds
    v_mfma_f32_16x16x32_bf16 a[44:47], a[200:203], a[252:255], a[44:47]
    s_add_u32 s57, s62, 393216
    s_add_u32 m0, s51, 61440
    s_mul_i32 s62, s61, 6144
    v_mfma_f32_16x16x32_bf16 a[48:51], a[204:207], a[232:235], a[48:51]
    ds_read_b128 a[232:235], v26 offset:49152
    v_mfma_f32_16x16x32_bf16 a[52:55], a[204:207], a[236:239], a[52:55]
    ds_read_b128 a[236:239], v26 offset:51200
    s_waitcnt vmcnt(16) lgkmcnt(2)
    s_barrier
    v_mfma_f32_16x16x32_bf16 a[56:59], a[204:207], a[240:243], a[56:59]
    ds_read_b64_tr_b16 a[196:197], v21 offset:24576
    ds_read_b64_tr_b16 a[198:199], v21 offset:26112
    v_mfma_f32_16x16x32_bf16 a[60:63], a[204:207], a[244:247], a[60:63]
    ds_read_b128 a[240:243], v26 offset:53248
    buffer_load_dwordx4 v5, s[20:23], s57 offen lds
    v_mfma_f32_16x16x32_bf16 a[64:67], a[204:207], a[248:251], a[64:67]
    ds_read_b128 a[244:247], v26 offset:55296
    v_mfma_f32_16x16x32_bf16 a[68:71], a[204:207], a[252:255], a[68:71]
    ds_read_b128 a[248:251], v26 offset:57344
    v_mfma_f32_16x16x32_bf16 a[0:3], a[184:187], a[208:211], a[0:3]
    ds_read_b128 a[252:255], v26 offset:59392
    v_mfma_f32_16x16x32_bf16 a[4:7], a[184:187], a[212:215], a[4:7]
    ds_read_b64_tr_b16 a[200:201], v22 offset:24576
    ds_read_b64_tr_b16 a[202:203], v22 offset:26112
    v_mfma_f32_16x16x32_bf16 a[8:11], a[184:187], a[216:219], a[8:11]
    buffer_load_dwordx4 v6, s[20:23], s57 offen offset:1024 lds
    v_mfma_f32_16x16x32_bf16 a[12:15], a[184:187], a[220:223], a[12:15]
    ds_read_b64_tr_b16 a[204:205], v23 offset:24576
    ds_read_b64_tr_b16 a[206:207], v23 offset:26112
    v_mfma_f32_16x16x32_bf16 a[16:19], a[184:187], a[224:227], a[16:19]
    v_mfma_f32_16x16x32_bf16 a[20:23], a[184:187], a[228:231], a[20:23]
    v_mfma_f32_16x16x32_bf16 a[24:27], a[188:191], a[208:211], a[24:27]
    v_mfma_f32_16x16x32_bf16 a[28:31], a[188:191], a[212:215], a[28:31]
    buffer_load_dwordx4 v7, s[20:23], s57 offen offset:2048 lds
    v_mfma_f32_16x16x32_bf16 a[32:35], a[188:191], a[216:219], a[32:35]
    s_add_u32 m0, s51, 147456
    s_add_u32 s57, s62, 0
    v_mfma_f32_16x16x32_bf16 a[36:39], a[188:191], a[220:223], a[36:39]
    s_waitcnt vmcnt(13) lgkmcnt(0)
    s_barrier
    v_mfma_f32_16x16x32_bf16 a[40:43], a[188:191], a[224:227], a[40:43]
    ds_read_b64_tr_b16 a[184:185], v21 offset:0
    ds_read_b64_tr_b16 a[186:187], v21 offset:1536
    v_mfma_f32_16x16x32_bf16 a[44:47], a[188:191], a[228:231], a[44:47]
    buffer_load_dwordx4 v8, s[8:11], s61 offen lds
    v_mfma_f32_16x16x32_bf16 a[48:51], a[192:195], a[208:211], a[48:51]
    ds_read_b128 a[208:211], v25 offset:36864
    v_mfma_f32_16x16x32_bf16 a[52:55], a[192:195], a[212:215], a[52:55]
    ds_read_b128 a[212:215], v25 offset:38912
    buffer_load_dwordx4 v9, s[8:11], s61 offen offset:1024 lds
    v_mfma_f32_16x16x32_bf16 a[56:59], a[192:195], a[216:219], a[56:59]
    ds_read_b128 a[216:219], v25 offset:40960
    v_mfma_f32_16x16x32_bf16 a[60:63], a[192:195], a[220:223], a[60:63]
    ds_read_b128 a[220:223], v25 offset:43008
    buffer_load_dwordx4 v10, s[8:11], s61 offen offset:2048 lds
    v_mfma_f32_16x16x32_bf16 a[64:67], a[192:195], a[224:227], a[64:67]
    s_add_u32 m0, s51, 98304
    ds_read_b128 a[224:227], v25 offset:45056
    s_add_u32 s61, s61, 128
    v_mfma_f32_16x16x32_bf16 a[68:71], a[192:195], a[228:231], a[68:71]
    ds_read_b128 a[228:231], v25 offset:47104
    buffer_load_dwordx4 v5, s[20:23], s57 offen lds
    v_mfma_f32_16x16x32_bf16 a[0:3], a[196:199], a[232:235], a[0:3]
    ds_read_b64_tr_b16 a[188:189], v22 offset:0
    ds_read_b64_tr_b16 a[190:191], v22 offset:1536
    v_mfma_f32_16x16x32_bf16 a[4:7], a[196:199], a[236:239], a[4:7]
    ds_read_b64_tr_b16 a[192:193], v23 offset:0
    ds_read_b64_tr_b16 a[194:195], v23 offset:1536
    v_mfma_f32_16x16x32_bf16 a[8:11], a[196:199], a[240:243], a[8:11]
    buffer_load_dwordx4 v6, s[20:23], s57 offen offset:1024 lds
    v_mfma_f32_16x16x32_bf16 a[12:15], a[196:199], a[244:247], a[12:15]
    s_cmp_eq_u32 s61, 1280
    s_cselect_b32 s61, 0, s61
    v_mfma_f32_16x16x32_bf16 a[16:19], a[196:199], a[248:251], a[16:19]
    buffer_load_dwordx4 v7, s[20:23], s57 offen offset:2048 lds
    v_mfma_f32_16x16x32_bf16 a[20:23], a[196:199], a[252:255], a[20:23]
    s_add_u32 s57, s62, 393216
    s_add_u32 m0, s51, 73728
    s_mul_i32 s62, s61, 6144
    v_mfma_f32_16x16x32_bf16 a[24:27], a[200:203], a[232:235], a[24:27]
    v_mfma_f32_16x16x32_bf16 a[28:31], a[200:203], a[236:239], a[28:31]
    s_waitcnt vmcnt(16) lgkmcnt(0)
    s_barrier
    v_mfma_f32_16x16x32_bf16 a[32:35], a[200:203], a[240:243], a[32:35]
    ds_read_b64_tr_b16 a[196:197], v21 offset:12288
    ds_read_b64_tr_b16 a[198:199], v21 offset:13824
    v_mfma_f32_16x16x32_bf16 a[36:39], a[200:203], a[244:247], a[36:39]
    buffer_load_dwordx4 v5, s[20:23], s57 offen lds
    v_mfma_f32_16x16x32_bf16 a[40:43], a[200:203], a[248:251], a[40:43]
    v_mfma_f32_16x16x32_bf16 a[44:47], a[200:203], a[252:255], a[44:47]
    ds_read_b64_tr_b16 a[200:201], v22 offset:12288
    ds_read_b64_tr_b16 a[202:203], v22 offset:13824
    v_mfma_f32_16x16x32_bf16 a[48:51], a[204:207], a[232:235], a[48:51]
    ds_read_b128 a[232:235], v26 offset:36864
    v_mfma_f32_16x16x32_bf16 a[52:55], a[204:207], a[236:239], a[52:55]
    ds_read_b128 a[236:239], v26 offset:38912
    v_mfma_f32_16x16x32_bf16 a[56:59], a[204:207], a[240:243], a[56:59]
    ds_read_b128 a[240:243], v26 offset:40960
    buffer_load_dwordx4 v6, s[20:23], s57 offen offset:1024 lds
    v_mfma_f32_16x16x32_bf16 a[60:63], a[204:207], a[244:247], a[60:63]
    ds_read_b128 a[244:247], v26 offset:43008
    v_mfma_f32_16x16x32_bf16 a[64:67], a[204:207], a[248:251], a[64:67]
    ds_read_b128 a[248:251], v26 offset:45056
    v_mfma_f32_16x16x32_bf16 a[68:71], a[204:207], a[252:255], a[68:71]
    ds_read_b128 a[252:255], v26 offset:47104
    v_mfma_f32_16x16x32_bf16 a[0:3], a[184:187], a[208:211], a[0:3]
    ds_read_b64_tr_b16 a[204:205], v23 offset:12288
    ds_read_b64_tr_b16 a[206:207], v23 offset:13824
    v_mfma_f32_16x16x32_bf16 a[4:7], a[184:187], a[212:215], a[4:7]
    buffer_load_dwordx4 v7, s[20:23], s57 offen offset:2048 lds
    v_mfma_f32_16x16x32_bf16 a[8:11], a[184:187], a[216:219], a[8:11]
    s_add_u32 m0, s51, 135168
    s_add_u32 s57, s62, 0
    v_mfma_f32_16x16x32_bf16 a[12:15], a[184:187], a[220:223], a[12:15]
    v_mfma_f32_16x16x32_bf16 a[16:19], a[184:187], a[224:227], a[16:19]
    v_mfma_f32_16x16x32_bf16 a[20:23], a[184:187], a[228:231], a[20:23]
    v_mfma_f32_16x16x32_bf16 a[24:27], a[188:191], a[208:211], a[24:27]
    s_waitcnt vmcnt(12) lgkmcnt(0)
    s_barrier
    v_mfma_f32_16x16x32_bf16 a[28:31], a[188:191], a[212:215], a[28:31]
    ds_read_b64_tr_b16 a[184:185], v21 offset:36864
    ds_read_b64_tr_b16 a[186:187], v21 offset:38400
    v_mfma_f32_16x16x32_bf16 a[32:35], a[188:191], a[216:219], a[32:35]
    buffer_load_dwordx4 v8, s[8:11], s61 offen lds
    v_mfma_f32_16x16x32_bf16 a[36:39], a[188:191], a[220:223], a[36:39]
    v_mfma_f32_16x16x32_bf16 a[40:43], a[188:191], a[224:227], a[40:43]
    buffer_load_dwordx4 v9, s[8:11], s61 offen offset:1024 lds
    v_mfma_f32_16x16x32_bf16 a[44:47], a[188:191], a[228:231], a[44:47]
    ds_read_b64_tr_b16 a[188:189], v22 offset:36864
    ds_read_b64_tr_b16 a[190:191], v22 offset:38400
    v_mfma_f32_16x16x32_bf16 a[48:51], a[192:195], a[208:211], a[48:51]
    ds_read_b128 a[208:211], v25 offset:24576
    buffer_load_dwordx4 v10, s[8:11], s61 offen offset:2048 lds
    v_mfma_f32_16x16x32_bf16 a[52:55], a[192:195], a[212:215], a[52:55]
    s_add_u32 m0, s51, 86016
    ds_read_b128 a[212:215], v25 offset:26624
    s_add_u32 s61, s61, 128
    v_mfma_f32_16x16x32_bf16 a[56:59], a[192:195], a[216:219], a[56:59]
    ds_read_b128 a[216:219], v25 offset:28672
    buffer_load_dwordx4 v5, s[20:23], s57 offen lds
    v_mfma_f32_16x16x32_bf16 a[60:63], a[192:195], a[220:223], a[60:63]
    ds_read_b128 a[220:223], v25 offset:30720
    s_cmp_eq_u32 s61, 1280
    s_cselect_b32 s61, 0, s61
    v_mfma_f32_16x16x32_bf16 a[64:67], a[192:195], a[224:227], a[64:67]
    ds_read_b128 a[224:227], v25 offset:32768
    buffer_load_dwordx4 v6, s[20:23], s57 offen offset:1024 lds
    v_mfma_f32_16x16x32_bf16 a[68:71], a[192:195], a[228:231], a[68:71]
    ds_read_b128 a[228:231], v25 offset:34816
    v_mfma_f32_16x16x32_bf16 a[0:3], a[196:199], a[232:235], a[0:3]
    ds_read_b64_tr_b16 a[192:193], v23 offset:36864
    ds_read_b64_tr_b16 a[194:195], v23 offset:38400
    v_mfma_f32_16x16x32_bf16 a[4:7], a[196:199], a[236:239], a[4:7]
    buffer_load_dwordx4 v7, s[20:23], s57 offen offset:2048 lds
    v_mfma_f32_16x16x32_bf16 a[8:11], a[196:199], a[240:243], a[8:11]
    s_add_u32 s57, s62, 393216
    s_add_u32 m0, s51, 110592
    s_mul_i32 s62, s61, 6144
    v_mfma_f32_16x16x32_bf16 a[12:15], a[196:199], a[244:247], a[12:15]
    v_mfma_f32_16x16x32_bf16 a[16:19], a[196:199], a[248:251], a[16:19]
    v_mfma_f32_16x16x32_bf16 a[20:23], a[196:199], a[252:255], a[20:23]
    v_mfma_f32_16x16x32_bf16 a[24:27], a[200:203], a[232:235], a[24:27]
    s_waitcnt vmcnt(15) lgkmcnt(0)
    s_barrier
    v_mfma_f32_16x16x32_bf16 a[28:31], a[200:203], a[236:239], a[28:31]
    ds_read_b64_tr_b16 a[196:197], v24 offset:61440
    ds_read_b64_tr_b16 a[198:199], v24 offset:62976
    v_mfma_f32_16x16x32_bf16 a[32:35], a[200:203], a[240:243], a[32:35]
    buffer_load_dwordx4 v5, s[20:23], s57 offen lds
    v_mfma_f32_16x16x32_bf16 a[36:39], a[200:203], a[244:247], a[36:39]
    v_mfma_f32_16x16x32_bf16 a[40:43], a[200:203], a[248:251], a[40:43]
    v_mfma_f32_16x16x32_bf16 a[44:47], a[200:203], a[252:255], a[44:47]
    ds_read_b64_tr_b16 a[200:201], v37 offset:61440
    ds_read_b64_tr_b16 a[202:203], v37 offset:62976
    v_mfma_f32_16x16x32_bf16 a[48:51], a[204:207], a[232:235], a[48:51]
    ds_read_b128 a[232:235], v26 offset:24576
    v_mfma_f32_16x16x32_bf16 a[52:55], a[204:207], a[236:239], a[52:55]
    ds_read_b128 a[236:239], v26 offset:26624
    buffer_load_dwordx4 v6, s[20:23], s57 offen offset:1024 lds
    v_mfma_f32_16x16x32_bf16 a[56:59], a[204:207], a[240:243], a[56:59]
    ds_read_b128 a[240:243], v26 offset:28672
    v_mfma_f32_16x16x32_bf16 a[60:63], a[204:207], a[244:247], a[60:63]
    ds_read_b128 a[244:247], v26 offset:30720
    v_mfma_f32_16x16x32_bf16 a[64:67], a[204:207], a[248:251], a[64:67]
    ds_read_b128 a[248:251], v26 offset:32768
    v_mfma_f32_16x16x32_bf16 a[68:71], a[204:207], a[252:255], a[68:71]
    ds_read_b128 a[252:255], v26 offset:34816
    v_mfma_f32_16x16x32_bf16 a[0:3], a[184:187], a[208:211], a[0:3]
    buffer_load_dwordx4 v7, s[20:23], s57 offen offset:2048 lds
    v_mfma_f32_16x16x32_bf16 a[4:7], a[184:187], a[212:215], a[4:7]
    s_add_u32 m0, s51, 122880
    ds_read_b64_tr_b16 a[204:205], v38 offset:61440
    ds_read_b64_tr_b16 a[206:207], v38 offset:62976
    v_mfma_f32_16x16x32_bf16 a[8:11], a[184:187], a[216:219], a[8:11]
    s_add_u32 s57, s62, 0
    v_mfma_f32_16x16x32_bf16 a[12:15], a[184:187], a[220:223], a[12:15]
    v_mfma_f32_16x16x32_bf16 a[16:19], a[184:187], a[224:227], a[16:19]
    v_mfma_f32_16x16x32_bf16 a[20:23], a[184:187], a[228:231], a[20:23]
    v_mfma_f32_16x16x32_bf16 a[24:27], a[188:191], a[208:211], a[24:27]
    v_mfma_f32_16x16x32_bf16 a[28:31], a[188:191], a[212:215], a[28:31]
    s_waitcnt vmcnt(12) lgkmcnt(0)
    s_barrier
    v_mfma_f32_16x16x32_bf16 a[32:35], a[188:191], a[216:219], a[32:35]
    ds_read_b64_tr_b16 a[184:185], v21 offset:24576
    ds_read_b64_tr_b16 a[186:187], v21 offset:26112
    v_mfma_f32_16x16x32_bf16 a[36:39], a[188:191], a[220:223], a[36:39]
    buffer_load_dwordx4 v8, s[8:11], s61 offen lds
    v_mfma_f32_16x16x32_bf16 a[40:43], a[188:191], a[224:227], a[40:43]
    v_mfma_f32_16x16x32_bf16 a[44:47], a[188:191], a[228:231], a[44:47]
    ds_read_b64_tr_b16 a[188:189], v22 offset:24576
    ds_read_b64_tr_b16 a[190:191], v22 offset:26112
    v_mfma_f32_16x16x32_bf16 a[48:51], a[192:195], a[208:211], a[48:51]
    ds_read_b128 a[208:211], v25 offset:49152
    buffer_load_dwordx4 v9, s[8:11], s61 offen offset:1024 lds
    v_mfma_f32_16x16x32_bf16 a[52:55], a[192:195], a[212:215], a[52:55]
    ds_read_b128 a[212:215], v25 offset:51200
    v_mfma_f32_16x16x32_bf16 a[56:59], a[192:195], a[216:219], a[56:59]
    ds_read_b128 a[216:219], v25 offset:53248
    buffer_load_dwordx4 v10, s[8:11], s61 offen offset:2048 lds
    v_mfma_f32_16x16x32_bf16 a[60:63], a[192:195], a[220:223], a[60:63]
    s_add_u32 m0, s51, 61440
    ds_read_b128 a[220:223], v25 offset:55296
    s_add_u32 s61, s61, 128
    v_mfma_f32_16x16x32_bf16 a[64:67], a[192:195], a[224:227], a[64:67]
    ds_read_b128 a[224:227], v25 offset:57344
    buffer_load_dwordx4 v5, s[20:23], s57 offen lds
    v_mfma_f32_16x16x32_bf16 a[68:71], a[192:195], a[228:231], a[68:71]
    ds_read_b128 a[228:231], v25 offset:59392
    s_cmp_eq_u32 s61, 1280
    s_cselect_b32 s61, 0, s61
    v_mfma_f32_16x16x32_bf16 a[0:3], a[196:199], a[232:235], a[0:3]
    buffer_load_dwordx4 v6, s[20:23], s57 offen offset:1024 lds
    v_mfma_f32_16x16x32_bf16 a[4:7], a[196:199], a[236:239], a[4:7]
    ds_read_b64_tr_b16 a[192:193], v23 offset:24576
    ds_read_b64_tr_b16 a[194:195], v23 offset:26112
    v_mfma_f32_16x16x32_bf16 a[8:11], a[196:199], a[240:243], a[8:11]
    buffer_load_dwordx4 v7, s[20:23], s57 offen offset:2048 lds
    v_mfma_f32_16x16x32_bf16 a[12:15], a[196:199], a[244:247], a[12:15]
    s_add_u32 s57, s62, 393216
    s_add_u32 m0, s51, 98304
    s_mul_i32 s62, s61, 6144
    v_mfma_f32_16x16x32_bf16 a[16:19], a[196:199], a[248:251], a[16:19]
    v_mfma_f32_16x16x32_bf16 a[20:23], a[196:199], a[252:255], a[20:23]
    v_mfma_f32_16x16x32_bf16 a[24:27], a[200:203], a[232:235], a[24:27]
    v_mfma_f32_16x16x32_bf16 a[28:31], a[200:203], a[236:239], a[28:31]
    s_waitcnt vmcnt(15) lgkmcnt(0)
    s_barrier
    v_mfma_f32_16x16x32_bf16 a[32:35], a[200:203], a[240:243], a[32:35]
    ds_read_b64_tr_b16 a[196:197], v21 offset:0
    ds_read_b64_tr_b16 a[198:199], v21 offset:1536
    v_mfma_f32_16x16x32_bf16 a[36:39], a[200:203], a[244:247], a[36:39]
    buffer_load_dwordx4 v5, s[20:23], s57 offen lds
    v_mfma_f32_16x16x32_bf16 a[40:43], a[200:203], a[248:251], a[40:43]
    v_mfma_f32_16x16x32_bf16 a[44:47], a[200:203], a[252:255], a[44:47]
    ds_read_b64_tr_b16 a[200:201], v22 offset:0
    ds_read_b64_tr_b16 a[202:203], v22 offset:1536
    v_mfma_f32_16x16x32_bf16 a[48:51], a[204:207], a[232:235], a[48:51]
    ds_read_b128 a[232:235], v26 offset:49152
    v_mfma_f32_16x16x32_bf16 a[52:55], a[204:207], a[236:239], a[52:55]
    ds_read_b128 a[236:239], v26 offset:51200
    v_mfma_f32_16x16x32_bf16 a[56:59], a[204:207], a[240:243], a[56:59]
    ds_read_b128 a[240:243], v26 offset:53248
    buffer_load_dwordx4 v6, s[20:23], s57 offen offset:1024 lds
    v_mfma_f32_16x16x32_bf16 a[60:63], a[204:207], a[244:247], a[60:63]
    ds_read_b128 a[244:247], v26 offset:55296
    v_mfma_f32_16x16x32_bf16 a[64:67], a[204:207], a[248:251], a[64:67]
    ds_read_b128 a[248:251], v26 offset:57344
    v_mfma_f32_16x16x32_bf16 a[68:71], a[204:207], a[252:255], a[68:71]
    ds_read_b128 a[252:255], v26 offset:59392
    v_mfma_f32_16x16x32_bf16 a[0:3], a[184:187], a[208:211], a[0:3]
    ds_read_b64_tr_b16 a[204:205], v23 offset:0
    ds_read_b64_tr_b16 a[206:207], v23 offset:1536
    v_mfma_f32_16x16x32_bf16 a[4:7], a[184:187], a[212:215], a[4:7]
    buffer_load_dwordx4 v7, s[20:23], s57 offen offset:2048 lds
    v_mfma_f32_16x16x32_bf16 a[8:11], a[184:187], a[216:219], a[8:11]
    s_add_u32 m0, s51, 147456
    s_add_u32 s57, s62, 0
    v_mfma_f32_16x16x32_bf16 a[12:15], a[184:187], a[220:223], a[12:15]
    v_mfma_f32_16x16x32_bf16 a[16:19], a[184:187], a[224:227], a[16:19]
    v_mfma_f32_16x16x32_bf16 a[20:23], a[184:187], a[228:231], a[20:23]
    v_mfma_f32_16x16x32_bf16 a[24:27], a[188:191], a[208:211], a[24:27]
    s_waitcnt vmcnt(12) lgkmcnt(0)
    s_barrier
    v_mfma_f32_16x16x32_bf16 a[28:31], a[188:191], a[212:215], a[28:31]
    ds_read_b64_tr_b16 a[184:185], v21 offset:12288
    ds_read_b64_tr_b16 a[186:187], v21 offset:13824
    v_mfma_f32_16x16x32_bf16 a[32:35], a[188:191], a[216:219], a[32:35]
    buffer_load_dwordx4 v8, s[8:11], s61 offen lds
    v_mfma_f32_16x16x32_bf16 a[36:39], a[188:191], a[220:223], a[36:39]
    v_mfma_f32_16x16x32_bf16 a[40:43], a[188:191], a[224:227], a[40:43]
    buffer_load_dwordx4 v9, s[8:11], s61 offen offset:1024 lds
    v_mfma_f32_16x16x32_bf16 a[44:47], a[188:191], a[228:231], a[44:47]
    ds_read_b64_tr_b16 a[188:189], v22 offset:12288
    ds_read_b64_tr_b16 a[190:191], v22 offset:13824
    v_mfma_f32_16x16x32_bf16 a[48:51], a[192:195], a[208:211], a[48:51]
    ds_read_b128 a[208:211], v25 offset:36864
    buffer_load_dwordx4 v10, s[8:11], s61 offen offset:2048 lds
    v_mfma_f32_16x16x32_bf16 a[52:55], a[192:195], a[212:215], a[52:55]
    s_add_u32 m0, s51, 73728
    ds_read_b128 a[212:215], v25 offset:38912
    s_add_u32 s61, s61, 128
    v_mfma_f32_16x16x32_bf16 a[56:59], a[192:195], a[216:219], a[56:59]
    ds_read_b128 a[216:219], v25 offset:40960
    buffer_load_dwordx4 v5, s[20:23], s57 offen lds
    v_mfma_f32_16x16x32_bf16 a[60:63], a[192:195], a[220:223], a[60:63]
    ds_read_b128 a[220:223], v25 offset:43008
    s_cmp_eq_u32 s61, 1280
    s_cselect_b32 s61, 0, s61
    v_mfma_f32_16x16x32_bf16 a[64:67], a[192:195], a[224:227], a[64:67]
    ds_read_b128 a[224:227], v25 offset:45056
    buffer_load_dwordx4 v6, s[20:23], s57 offen offset:1024 lds
    v_mfma_f32_16x16x32_bf16 a[68:71], a[192:195], a[228:231], a[68:71]
    ds_read_b128 a[228:231], v25 offset:47104
    v_mfma_f32_16x16x32_bf16 a[0:3], a[196:199], a[232:235], a[0:3]
    ds_read_b64_tr_b16 a[192:193], v23 offset:12288
    ds_read_b64_tr_b16 a[194:195], v23 offset:13824
    v_mfma_f32_16x16x32_bf16 a[4:7], a[196:199], a[236:239], a[4:7]
    buffer_load_dwordx4 v7, s[20:23], s57 offen offset:2048 lds
    v_mfma_f32_16x16x32_bf16 a[8:11], a[196:199], a[240:243], a[8:11]
    s_add_u32 s57, s62, 393216
    s_add_u32 m0, s51, 86016
    s_mul_i32 s62, s61, 6144
    v_mfma_f32_16x16x32_bf16 a[12:15], a[196:199], a[244:247], a[12:15]
    v_mfma_f32_16x16x32_bf16 a[16:19], a[196:199], a[248:251], a[16:19]
    v_mfma_f32_16x16x32_bf16 a[20:23], a[196:199], a[252:255], a[20:23]
    v_mfma_f32_16x16x32_bf16 a[24:27], a[200:203], a[232:235], a[24:27]
    s_waitcnt vmcnt(15) lgkmcnt(0)
    s_barrier
    v_mfma_f32_16x16x32_bf16 a[28:31], a[200:203], a[236:239], a[28:31]
    ds_read_b64_tr_b16 a[196:197], v21 offset:36864
    ds_read_b64_tr_b16 a[198:199], v21 offset:38400
    v_mfma_f32_16x16x32_bf16 a[32:35], a[200:203], a[240:243], a[32:35]
    buffer_load_dwordx4 v5, s[20:23], s57 offen lds
    v_mfma_f32_16x16x32_bf16 a[36:39], a[200:203], a[244:247], a[36:39]
    v_mfma_f32_16x16x32_bf16 a[40:43], a[200:203], a[248:251], a[40:43]
    v_mfma_f32_16x16x32_bf16 a[44:47], a[200:203], a[252:255], a[44:47]
    ds_read_b64_tr_b16 a[200:201], v22 offset:36864
    ds_read_b64_tr_b16 a[202:203], v22 offset:38400
    v_mfma_f32_16x16x32_bf16 a[48:51], a[204:207], a[232:235], a[48:51]
    ds_read_b128 a[232:235], v26 offset:36864
    v_mfma_f32_16x16x32_bf16 a[52:55], a[204:207], a[236:239], a[52:55]
    ds_read_b128 a[236:239], v26 offset:38912
    buffer_load_dwordx4 v6, s[20:23], s57 offen offset:1024 lds
    v_mfma_f32_16x16x32_bf16 a[56:59], a[204:207], a[240:243], a[56:59]
    ds_read_b128 a[240:243], v26 offset:40960
    v_mfma_f32_16x16x32_bf16 a[60:63], a[204:207], a[244:247], a[60:63]
    ds_read_b128 a[244:247], v26 offset:43008
    v_mfma_f32_16x16x32_bf16 a[64:67], a[204:207], a[248:251], a[64:67]
    ds_read_b128 a[248:251], v26 offset:45056
    v_mfma_f32_16x16x32_bf16 a[68:71], a[204:207], a[252:255], a[68:71]
    ds_read_b128 a[252:255], v26 offset:47104
    v_mfma_f32_16x16x32_bf16 a[0:3], a[184:187], a[208:211], a[0:3]
    buffer_load_dwordx4 v7, s[20:23], s57 offen offset:2048 lds
    v_mfma_f32_16x16x32_bf16 a[4:7], a[184:187], a[212:215], a[4:7]
    s_mov_b32 s57, 0
    ds_read_b64_tr_b16 a[204:205], v23 offset:36864
    ds_read_b64_tr_b16 a[206:207], v23 offset:38400
    v_mfma_f32_16x16x32_bf16 a[8:11], a[184:187], a[216:219], a[8:11]
    s_add_u32 m0, s51, 0
    v_mfma_f32_16x16x32_bf16 a[12:15], a[184:187], a[220:223], a[12:15]
    v_mfma_f32_16x16x32_bf16 a[16:19], a[184:187], a[224:227], a[16:19]
    v_mfma_f32_16x16x32_bf16 a[20:23], a[184:187], a[228:231], a[20:23]
    v_mfma_f32_16x16x32_bf16 a[24:27], a[188:191], a[208:211], a[24:27]
    v_mfma_f32_16x16x32_bf16 a[28:31], a[188:191], a[212:215], a[28:31]
    s_waitcnt vmcnt(12) lgkmcnt(0)
    s_barrier
    v_mfma_f32_16x16x32_bf16 a[32:35], a[188:191], a[216:219], a[32:35]
    ds_read_b64_tr_b16 a[184:185], v24 offset:61440
    ds_read_b64_tr_b16 a[186:187], v24 offset:62976
    v_mfma_f32_16x16x32_bf16 a[36:39], a[188:191], a[220:223], a[36:39]
    buffer_load_dwordx4 v2, s[12:15], s57 offen nt lds
    v_mfma_f32_16x16x32_bf16 a[40:43], a[188:191], a[224:227], a[40:43]
    v_mfma_f32_16x16x32_bf16 a[44:47], a[188:191], a[228:231], a[44:47]
    ds_read_b64_tr_b16 a[188:189], v37 offset:61440
    ds_read_b64_tr_b16 a[190:191], v37 offset:62976
    v_mfma_f32_16x16x32_bf16 a[48:51], a[192:195], a[208:211], a[48:51]
    ds_read_b128 a[208:211], v25 offset:24576
    buffer_load_dwordx4 v3, s[12:15], s57 offen offset:1024 nt lds
    v_mfma_f32_16x16x32_bf16 a[52:55], a[192:195], a[212:215], a[52:55]
    ds_read_b128 a[212:215], v25 offset:26624
    v_mfma_f32_16x16x32_bf16 a[56:59], a[192:195], a[216:219], a[56:59]
    ds_read_b128 a[216:219], v25 offset:28672
    buffer_load_dwordx4 v4, s[12:15], s57 offen offset:2048 nt lds
    v_mfma_f32_16x16x32_bf16 a[60:63], a[192:195], a[220:223], a[60:63]
    s_mov_b32 s57, 12288
    ds_read_b128 a[220:223], v25 offset:30720
    s_add_u32 m0, s51, 12288
    v_mfma_f32_16x16x32_bf16 a[64:67], a[192:195], a[224:227], a[64:67]
    ds_read_b128 a[224:227], v25 offset:32768
    buffer_load_dwordx4 v2, s[12:15], s57 offen nt lds
    v_mfma_f32_16x16x32_bf16 a[68:71], a[192:195], a[228:231], a[68:71]
    ds_read_b128 a[228:231], v25 offset:34816
    v_mfma_f32_16x16x32_bf16 a[0:3], a[196:199], a[232:235], a[0:3]
    ds_read_b64_tr_b16 a[192:193], v38 offset:61440
    ds_read_b64_tr_b16 a[194:195], v38 offset:62976
    v_mfma_f32_16x16x32_bf16 a[4:7], a[196:199], a[236:239], a[4:7]
    buffer_load_dwordx4 v3, s[12:15], s57 offen offset:1024 nt lds
    v_mfma_f32_16x16x32_bf16 a[8:11], a[196:199], a[240:243], a[8:11]
    v_mfma_f32_16x16x32_bf16 a[12:15], a[196:199], a[244:247], a[12:15]
    buffer_load_dwordx4 v4, s[12:15], s57 offen offset:2048 nt lds
    v_mfma_f32_16x16x32_bf16 a[16:19], a[196:199], a[248:251], a[16:19]
    s_mov_b32 s57, 24576
    s_add_u32 m0, s51, 24576
    v_mfma_f32_16x16x32_bf16 a[20:23], a[196:199], a[252:255], a[20:23]
    v_mfma_f32_16x16x32_bf16 a[24:27], a[200:203], a[232:235], a[24:27]
    s_waitcnt vmcnt(15) lgkmcnt(0)
    s_barrier
    v_mfma_f32_16x16x32_bf16 a[28:31], a[200:203], a[236:239], a[28:31]
    ds_read_b64_tr_b16 a[196:197], v21 offset:24576
    ds_read_b64_tr_b16 a[198:199], v21 offset:26112
    v_mfma_f32_16x16x32_bf16 a[32:35], a[200:203], a[240:243], a[32:35]
    v_mfma_f32_16x16x32_bf16 a[36:39], a[200:203], a[244:247], a[36:39]
    v_mfma_f32_16x16x32_bf16 a[40:43], a[200:203], a[248:251], a[40:43]
    v_mfma_f32_16x16x32_bf16 a[44:47], a[200:203], a[252:255], a[44:47]
    ds_read_b64_tr_b16 a[200:201], v22 offset:24576
    ds_read_b64_tr_b16 a[202:203], v22 offset:26112
    v_mfma_f32_16x16x32_bf16 a[48:51], a[204:207], a[232:235], a[48:51]
    ds_read_b128 a[232:235], v26 offset:24576
    v_mfma_f32_16x16x32_bf16 a[52:55], a[204:207], a[236:239], a[52:55]
    ds_read_b128 a[236:239], v26 offset:26624
    v_mfma_f32_16x16x32_bf16 a[56:59], a[204:207], a[240:243], a[56:59]
    ds_read_b128 a[240:243], v26 offset:28672
    v_mfma_f32_16x16x32_bf16 a[60:63], a[204:207], a[244:247], a[60:63]
    ds_read_b128 a[244:247], v26 offset:30720
    v_mfma_f32_16x16x32_bf16 a[64:67], a[204:207], a[248:251], a[64:67]
    ds_read_b128 a[248:251], v26 offset:32768
    v_mfma_f32_16x16x32_bf16 a[68:71], a[204:207], a[252:255], a[68:71]
    ds_read_b128 a[252:255], v26 offset:34816
    v_mfma_f32_16x16x32_bf16 a[0:3], a[184:187], a[208:211], a[0:3]
    ds_read_b64_tr_b16 a[204:205], v23 offset:24576
    ds_read_b64_tr_b16 a[206:207], v23 offset:26112
    v_mfma_f32_16x16x32_bf16 a[4:7], a[184:187], a[212:215], a[4:7]
    v_mfma_f32_16x16x32_bf16 a[8:11], a[184:187], a[216:219], a[8:11]
    v_mfma_f32_16x16x32_bf16 a[12:15], a[184:187], a[220:223], a[12:15]
    v_mfma_f32_16x16x32_bf16 a[16:19], a[184:187], a[224:227], a[16:19]
    v_mfma_f32_16x16x32_bf16 a[20:23], a[184:187], a[228:231], a[20:23]
    v_mfma_f32_16x16x32_bf16 a[24:27], a[188:191], a[208:211], a[24:27]
    s_waitcnt vmcnt(9) lgkmcnt(0)
    s_barrier
    v_mfma_f32_16x16x32_bf16 a[28:31], a[188:191], a[212:215], a[28:31]
    ds_read_b64_tr_b16 a[184:185], v21 offset:0
    ds_read_b64_tr_b16 a[186:187], v21 offset:1536
    v_mfma_f32_16x16x32_bf16 a[32:35], a[188:191], a[216:219], a[32:35]
    buffer_load_dwordx4 v2, s[12:15], s57 offen nt lds
    v_mfma_f32_16x16x32_bf16 a[36:39], a[188:191], a[220:223], a[36:39]
    v_mfma_f32_16x16x32_bf16 a[40:43], a[188:191], a[224:227], a[40:43]
    buffer_load_dwordx4 v3, s[12:15], s57 offen offset:1024 nt lds
    v_mfma_f32_16x16x32_bf16 a[44:47], a[188:191], a[228:231], a[44:47]
    ds_read_b64_tr_b16 a[188:189], v22 offset:0
    ds_read_b64_tr_b16 a[190:191], v22 offset:1536
    v_mfma_f32_16x16x32_bf16 a[48:51], a[192:195], a[208:211], a[48:51]
    ds_read_b128 a[208:211], v25 offset:49152
    buffer_load_dwordx4 v4, s[12:15], s57 offen offset:2048 nt lds
    v_mfma_f32_16x16x32_bf16 a[52:55], a[192:195], a[212:215], a[52:55]
    s_mov_b32 s57, 36864
    ds_read_b128 a[212:215], v25 offset:51200
    s_add_u32 m0, s51, 36864
    v_mfma_f32_16x16x32_bf16 a[56:59], a[192:195], a[216:219], a[56:59]
    ds_read_b128 a[216:219], v25 offset:53248
    buffer_load_dwordx4 v2, s[12:15], s57 offen nt lds
    v_mfma_f32_16x16x32_bf16 a[60:63], a[192:195], a[220:223], a[60:63]
    ds_read_b128 a[220:223], v25 offset:55296
    v_mfma_f32_16x16x32_bf16 a[64:67], a[192:195], a[224:227], a[64:67]
    ds_read_b128 a[224:227], v25 offset:57344
    buffer_load_dwordx4 v3, s[12:15], s57 offen offset:1024 nt lds
    v_mfma_f32_16x16x32_bf16 a[68:71], a[192:195], a[228:231], a[68:71]
    ds_read_b128 a[228:231], v25 offset:59392
    v_mfma_f32_16x16x32_bf16 a[0:3], a[196:199], a[232:235], a[0:3]
    ds_read_b64_tr_b16 a[192:193], v23 offset:0
    ds_read_b64_tr_b16 a[194:195], v23 offset:1536
    v_mfma_f32_16x16x32_bf16 a[4:7], a[196:199], a[236:239], a[4:7]
    buffer_load_dwordx4 v4, s[12:15], s57 offen offset:2048 nt lds
    v_mfma_f32_16x16x32_bf16 a[8:11], a[196:199], a[240:243], a[8:11]
    s_mov_b32 s57, 49152
    s_add_u32 m0, s51, 49152
    v_mfma_f32_16x16x32_bf16 a[12:15], a[196:199], a[244:247], a[12:15]
    v_mfma_f32_16x16x32_bf16 a[16:19], a[196:199], a[248:251], a[16:19]
    v_mfma_f32_16x16x32_bf16 a[20:23], a[196:199], a[252:255], a[20:23]
    v_mfma_f32_16x16x32_bf16 a[24:27], a[200:203], a[232:235], a[24:27]
    s_waitcnt vmcnt(12) lgkmcnt(0)
    s_barrier
    v_mfma_f32_16x16x32_bf16 a[28:31], a[200:203], a[236:239], a[28:31]
    ds_read_b64_tr_b16 a[196:197], v21 offset:12288
    ds_read_b64_tr_b16 a[198:199], v21 offset:13824
    v_mfma_f32_16x16x32_bf16 a[32:35], a[200:203], a[240:243], a[32:35]
    buffer_load_dwordx4 v2, s[12:15], s57 offen nt lds
    v_mfma_f32_16x16x32_bf16 a[36:39], a[200:203], a[244:247], a[36:39]
    v_mfma_f32_16x16x32_bf16 a[40:43], a[200:203], a[248:251], a[40:43]
    buffer_load_dwordx4 v3, s[12:15], s57 offen offset:1024 nt lds
    v_mfma_f32_16x16x32_bf16 a[44:47], a[200:203], a[252:255], a[44:47]
    ds_read_b64_tr_b16 a[200:201], v22 offset:12288
    ds_read_b64_tr_b16 a[202:203], v22 offset:13824
    v_mfma_f32_16x16x32_bf16 a[48:51], a[204:207], a[232:235], a[48:51]
    ds_read_b128 a[232:235], v26 offset:49152
    buffer_load_dwordx4 v4, s[12:15], s57 offen offset:2048 nt lds
    v_mfma_f32_16x16x32_bf16 a[52:55], a[204:207], a[236:239], a[52:55]
    s_mov_b32 s57, 61440
    ds_read_b128 a[236:239], v26 offset:51200
    s_add_u32 m0, s51, 61440
    v_mfma_f32_16x16x32_bf16 a[56:59], a[204:207], a[240:243], a[56:59]
    ds_read_b128 a[240:243], v26 offset:53248
    buffer_load_dwordx4 v2, s[12:15], s57 offen nt lds
    v_mfma_f32_16x16x32_bf16 a[60:63], a[204:207], a[244:247], a[60:63]
    ds_read_b128 a[244:247], v26 offset:55296
    v_mfma_f32_16x16x32_bf16 a[64:67], a[204:207], a[248:251], a[64:67]
    ds_read_b128 a[248:251], v26 offset:57344
    buffer_load_dwordx4 v3, s[12:15], s57 offen offset:1024 nt lds
    v_mfma_f32_16x16x32_bf16 a[68:71], a[204:207], a[252:255], a[68:71]
    ds_read_b128 a[252:255], v26 offset:59392
    v_mfma_f32_16x16x32_bf16 a[0:3], a[184:187], a[208:211], a[0:3]
    ds_read_b64_tr_b16 a[204:205], v23 offset:12288
    ds_read_b64_tr_b16 a[206:207], v23 offset:13824
    v_mfma_f32_16x16x32_bf16 a[4:7], a[184:187], a[212:215], a[4:7]
    buffer_load_dwordx4 v4, s[12:15], s57 offen offset:2048 nt lds
    v_mfma_f32_16x16x32_bf16 a[8:11], a[184:187], a[216:219], a[8:11]
    s_add_u32 m0, s51, 122880
    s_add_u32 s57, s62, 6144
    v_mfma_f32_16x16x32_bf16 a[12:15], a[184:187], a[220:223], a[12:15]
    v_mfma_f32_16x16x32_bf16 a[16:19], a[184:187], a[224:227], a[16:19]
    v_mfma_f32_16x16x32_bf16 a[20:23], a[184:187], a[228:231], a[20:23]
    v_mfma_f32_16x16x32_bf16 a[24:27], a[188:191], a[208:211], a[24:27]
    s_waitcnt lgkmcnt(0)
    s_barrier
    v_mfma_f32_16x16x32_bf16 a[28:31], a[188:191], a[212:215], a[28:31]
    v_mfma_f32_16x16x32_bf16 a[32:35], a[188:191], a[216:219], a[32:35]
    v_mfma_f32_16x16x32_bf16 a[36:39], a[188:191], a[220:223], a[36:39]
    v_mfma_f32_16x16x32_bf16 a[40:43], a[188:191], a[224:227], a[40:43]
    v_mfma_f32_16x16x32_bf16 a[44:47], a[188:191], a[228:231], a[44:47]
    v_mfma_f32_16x16x32_bf16 a[48:51], a[192:195], a[208:211], a[48:51]
    v_mfma_f32_16x16x32_bf16 a[52:55], a[192:195], a[212:215], a[52:55]
    v_mfma_f32_16x16x32_bf16 a[56:59], a[192:195], a[216:219], a[56:59]
    v_mfma_f32_16x16x32_bf16 a[60:63], a[192:195], a[220:223], a[60:63]
    v_mfma_f32_16x16x32_bf16 a[64:67], a[192:195], a[224:227], a[64:67]
    v_mfma_f32_16x16x32_bf16 a[68:71], a[192:195], a[228:231], a[68:71]
    v_mfma_f32_16x16x32_bf16 a[0:3], a[196:199], a[232:235], a[0:3]
    v_mfma_f32_16x16x32_bf16 a[4:7], a[196:199], a[236:239], a[4:7]
    v_mfma_f32_16x16x32_bf16 a[8:11], a[196:199], a[240:243], a[8:11]
    v_mfma_f32_16x16x32_bf16 a[12:15], a[196:199], a[244:247], a[12:15]
    s_nop 4
    v_accvgpr_read_b32 v64, a0
    v_accvgpr_read_b32 v65, a1
    v_mfma_f32_16x16x32_bf16 a[16:19], a[196:199], a[248:251], a[16:19]
    v_accvgpr_read_b32 v68, a4
    v_accvgpr_read_b32 v69, a5
    v_mfma_f32_16x16x32_bf16 a[20:23], a[196:199], a[252:255], a[20:23]
    v_accvgpr_read_b32 v72, a8
    v_accvgpr_read_b32 v73, a9
    v_mfma_f32_16x16x32_bf16 a[24:27], a[200:203], a[232:235], a[24:27]
    v_accvgpr_read_b32 v76, a12
    v_accvgpr_read_b32 v77, a13
    v_mfma_f32_16x16x32_bf16 a[28:31], a[200:203], a[236:239], a[28:31]
    v_accvgpr_read_b32 v80, a16
    v_accvgpr_read_b32 v81, a17
    v_mfma_f32_16x16x32_bf16 a[32:35], a[200:203], a[240:243], a[32:35]
    v_accvgpr_read_b32 v84, a20
    v_accvgpr_read_b32 v85, a21
    v_mfma_f32_16x16x32_bf16 a[36:39], a[200:203], a[244:247], a[36:39]
    v_accvgpr_read_b32 v88, a24
    v_accvgpr_read_b32 v89, a25
    v_mfma_f32_16x16x32_bf16 a[40:43], a[200:203], a[248:251], a[40:43]
    v_accvgpr_read_b32 v92, a28
    v_accvgpr_read_b32 v93, a29
    v_mfma_f32_16x16x32_bf16 a[44:47], a[200:203], a[252:255], a[44:47]
    v_accvgpr_read_b32 v96, a32
    v_accvgpr_read_b32 v97, a33
    v_mfma_f32_16x16x32_bf16 a[48:51], a[204:207], a[232:235], a[48:51]
    v_accvgpr_read_b32 v100, a36
    v_accvgpr_read_b32 v101, a37
    v_mfma_f32_16x16x32_bf16 a[52:55], a[204:207], a[236:239], a[52:55]
    v_accvgpr_read_b32 v104, a40
    v_accvgpr_read_b32 v105, a41
    v_mfma_f32_16x16x32_bf16 a[56:59], a[204:207], a[240:243], a[56:59]
    v_accvgpr_read_b32 v108, a44
    v_accvgpr_read_b32 v109, a45
    v_mfma_f32_16x16x32_bf16 a[60:63], a[204:207], a[244:247], a[60:63]
    v_accvgpr_read_b32 v112, a48
    v_accvgpr_read_b32 v113, a49
    v_mfma_f32_16x16x32_bf16 a[64:67], a[204:207], a[248:251], a[64:67]
    v_accvgpr_read_b32 v116, a52
    v_accvgpr_read_b32 v117, a53
    v_mfma_f32_16x16x32_bf16 a[68:71], a[204:207], a[252:255], a[68:71]
    v_accvgpr_read_b32 v120, a56
    v_accvgpr_read_b32 v121, a57
    v_accvgpr_read_b32 v124, a60
    v_accvgpr_read_b32 v125, a61
    v_accvgpr_read_b32 v66, a2
    v_accvgpr_read_b32 v67, a3
    v_accvgpr_read_b32 v128, a64
    v_accvgpr_read_b32 v129, a65
    v_cvt_pk_bf16_f32 v64, v64, v65
    v_accvgpr_read_b32 v70, a6
    v_accvgpr_read_b32 v132, a68
    v_accvgpr_read_b32 v133, a69
    v_accvgpr_read_b32 v71, a7
    v_cvt_pk_bf16_f32 v68, v68, v69
    v_accvgpr_read_b32 v74, a10
    v_accvgpr_read_b32 v75, a11
    v_cvt_pk_bf16_f32 v72, v72, v73
    v_accvgpr_read_b32 v78, a14
    v_accvgpr_read_b32 v79, a15
    v_cvt_pk_bf16_f32 v76, v76, v77
    v_accvgpr_read_b32 v82, a18
    v_accvgpr_read_b32 v83, a19
    v_cvt_pk_bf16_f32 v80, v80, v81
    v_accvgpr_read_b32 v86, a22
    v_accvgpr_read_b32 v87, a23
    v_cvt_pk_bf16_f32 v84, v84, v85
    v_accvgpr_read_b32 v90, a26
    v_accvgpr_read_b32 v91, a27
    v_cvt_pk_bf16_f32 v88, v88, v89
    v_accvgpr_read_b32 v94, a30
    v_accvgpr_read_b32 v95, a31
    v_cvt_pk_bf16_f32 v92, v92, v93
    v_accvgpr_read_b32 v98, a34
    v_accvgpr_read_b32 v99, a35
    v_cvt_pk_bf16_f32 v96, v96, v97
    v_accvgpr_read_b32 v102, a38
    v_accvgpr_read_b32 v103, a39
    v_cvt_pk_bf16_f32 v100, v100, v101
    v_accvgpr_read_b32 v106, a42
    v_accvgpr_read_b32 v107, a43
    v_cvt_pk_bf16_f32 v104, v104, v105
    v_accvgpr_read_b32 v110, a46
    v_accvgpr_read_b32 v111, a47
    v_cvt_pk_bf16_f32 v108, v108, v109
    v_accvgpr_read_b32 v114, a50
    v_accvgpr_read_b32 v115, a51
    v_cvt_pk_bf16_f32 v112, v112, v113
    v_accvgpr_read_b32 v118, a54
    v_accvgpr_read_b32 v119, a55
    v_cvt_pk_bf16_f32 v116, v116, v117
    v_accvgpr_read_b32 v122, a58
    v_accvgpr_read_b32 v123, a59
    v_cvt_pk_bf16_f32 v120, v120, v121
    v_accvgpr_read_b32 v126, a62
    v_accvgpr_read_b32 v127, a63
    v_cvt_pk_bf16_f32 v124, v124, v125
    v_accvgpr_read_b32 v130, a66
    v_accvgpr_read_b32 v131, a67
    v_cvt_pk_bf16_f32 v128, v128, v129
    v_accvgpr_read_b32 v134, a70
    v_accvgpr_read_b32 v135, a71
    v_cvt_pk_bf16_f32 v132, v132, v133
    v_cvt_pk_bf16_f32 v65, v66, v67
    v_cvt_pk_bf16_f32 v69, v70, v71
    v_cvt_pk_bf16_f32 v73, v74, v75
    v_cvt_pk_bf16_f32 v77, v78, v79
    v_cvt_pk_bf16_f32 v81, v82, v83
    v_cvt_pk_bf16_f32 v85, v86, v87
    v_cvt_pk_bf16_f32 v89, v90, v91
    v_cvt_pk_bf16_f32 v93, v94, v95
    v_cvt_pk_bf16_f32 v97, v98, v99
    v_cvt_pk_bf16_f32 v101, v102, v103
    v_cvt_pk_bf16_f32 v105, v106, v107
    v_cvt_pk_bf16_f32 v109, v110, v111
    v_cvt_pk_bf16_f32 v113, v114, v115
    v_cvt_pk_bf16_f32 v117, v118, v119
    v_cvt_pk_bf16_f32 v121, v122, v123
    v_cvt_pk_bf16_f32 v125, v126, v127
    v_cvt_pk_bf16_f32 v129, v130, v131
    v_cvt_pk_bf16_f32 v133, v134, v135
    ds_write_b64 v29, v[64:65] offset:0
    ds_write_b64 v29, v[68:69] offset:6144
    ds_write_b64 v29, v[72:73] offset:12288
    ds_write_b64 v29, v[76:77] offset:18432
    ds_write_b64 v29, v[80:81] offset:24576
    ds_write_b64 v29, v[84:85] offset:30720
    ds_write_b64 v29, v[88:89] offset:512
    ds_write_b64 v29, v[92:93] offset:6656
    ds_write_b64 v29, v[96:97] offset:12800
    ds_write_b64 v29, v[100:101] offset:18944
    ds_write_b64 v29, v[104:105] offset:25088
    ds_write_b64 v29, v[108:109] offset:31232
    ds_write_b64 v29, v[112:113] offset:1024
    ds_write_b64 v29, v[116:117] offset:7168
    ds_write_b64 v29, v[120:121] offset:13312
    ds_write_b64 v29, v[124:125] offset:19456
    ds_write_b64 v29, v[128:129] offset:25600
    ds_write_b64 v29, v[132:133] offset:31744
    s_waitcnt vmcnt(12) lgkmcnt(0)
    s_barrier
    ds_read_b128 a[0:3], v30 offset:0
    buffer_load_dwordx4 v8, s[8:11], s61 offen lds
    ds_read_b128 a[160:163], v11 offset:0
    ds_read_b128 a[4:7], v30 offset:6144
    ds_read_b128 a[8:11], v30 offset:12288
    ds_read_b128 a[12:15], v30 offset:1024
    ds_read_b128 a[164:167], v12 offset:0
    buffer_load_dwordx4 v9, s[8:11], s61 offen offset:1024 lds
    ds_read_b128 a[16:19], v30 offset:7168
    ds_read_b128 a[20:23], v30 offset:13312
    s_waitcnt lgkmcnt(6)
    v_mfma_f32_16x16x32_bf16 v[64:67], a[160:163], a[0:3], 0
    s_waitcnt lgkmcnt(5)
    ds_read_b128 a[24:27], v30 offset:2048
    v_mfma_f32_16x16x32_bf16 v[72:75], a[160:163], a[4:7], 0
    s_waitcnt lgkmcnt(5)
    ds_read_b128 a[168:171], v11 offset:128
    v_mfma_f32_16x16x32_bf16 v[80:83], a[160:163], a[8:11], 0
    s_waitcnt lgkmcnt(5)
    buffer_load_dwordx4 v10, s[8:11], s61 offen offset:2048 lds
    ds_read_b128 a[28:31], v30 offset:8192
    s_add_u32 m0, s51, 110592
    s_add_u32 s61, s61, 128
    ds_read_b128 a[32:35], v30 offset:14336
    s_waitcnt lgkmcnt(6)
    v_mfma_f32_16x16x32_bf16 v[64:67], a[164:167], a[12:15], v[64:67]
    s_cmp_eq_u32 s61, 1280
    s_cselect_b32 s61, 0, s61
    ds_read_b128 a[36:39], v30 offset:3072
    s_waitcnt lgkmcnt(6)
    v_mfma_f32_16x16x32_bf16 v[72:75], a[164:167], a[16:19], v[72:75]
    s_waitcnt lgkmcnt(5)
    ds_read_b128 a[172:175], v12 offset:128
    v_mfma_f32_16x16x32_bf16 v[80:83], a[164:167], a[20:23], v[80:83]
    s_waitcnt lgkmcnt(5)
    ds_read_b128 a[40:43], v30 offset:9216
    buffer_load_dwordx4 v5, s[20:23], s57 offen lds
    ds_read_b128 a[44:47], v30 offset:15360
    s_waitcnt lgkmcnt(6)
    v_mfma_f32_16x16x32_bf16 v[64:67], a[168:171], a[24:27], v[64:67]
    s_waitcnt lgkmcnt(5)
    ds_read_b128 a[48:51], v30 offset:4096
    v_mfma_f32_16x16x32_bf16 v[72:75], a[168:171], a[28:31], v[72:75]
    s_waitcnt lgkmcnt(5)
    ds_read_b128 a[176:179], v11 offset:256
    v_mfma_f32_16x16x32_bf16 v[80:83], a[168:171], a[32:35], v[80:83]
    s_waitcnt lgkmcnt(5)
    ds_read_b128 a[52:55], v30 offset:10240
    buffer_load_dwordx4 v6, s[20:23], s57 offen offset:1024 lds
    s_waitcnt lgkmcnt(5)
    v_mfma_f32_16x16x32_bf16 v[64:67], a[172:175], a[36:39], v[64:67]
    s_waitcnt lgkmcnt(4)
    ds_read_b128 a[56:59], v30 offset:16384
    v_mfma_f32_16x16x32_bf16 v[72:75], a[172:175], a[40:43], v[72:75]
    s_waitcnt lgkmcnt(4)
    ds_read_b128 a[60:63], v30 offset:5120
    v_mfma_f32_16x16x32_bf16 v[80:83], a[172:175], a[44:47], v[80:83]
    s_waitcnt lgkmcnt(4)
    ds_read_b128 a[180:183], v12 offset:256
    ds_read_b128 a[64:67], v30 offset:11264
    s_waitcnt lgkmcnt(5)
    v_mfma_f32_16x16x32_bf16 v[64:67], a[176:179], a[48:51], v[64:67]
    s_waitcnt lgkmcnt(4)
    ds_read_b128 a[68:71], v30 offset:17408
    buffer_load_dwordx4 v7, s[20:23], s57 offen offset:2048 lds
    v_mfma_f32_16x16x32_bf16 v[72:75], a[176:179], a[52:55], v[72:75]
    s_add_u32 s57, s62, 399360
    ds_read_b128 a[160:163], v11 offset:6144
    s_add_u32 m0, s51, 73728
    s_waitcnt lgkmcnt(5)
    v_mfma_f32_16x16x32_bf16 v[80:83], a[176:179], a[56:59], v[80:83]
    s_mul_i32 s62, s61, 6144
    ds_read_b128 a[164:167], v12 offset:6144
    ds_read_b128 a[168:171], v11 offset:6272
    s_waitcnt lgkmcnt(5)
    v_mfma_f32_16x16x32_bf16 v[64:67], a[180:183], a[60:63], v[64:67]
    s_waitcnt lgkmcnt(4)
    ds_read_b128 a[172:175], v12 offset:6272
    v_mfma_f32_16x16x32_bf16 v[72:75], a[180:183], a[64:67], v[72:75]
    s_waitcnt lgkmcnt(4)
    ds_read_b128 a[176:179], v11 offset:6400
    v_mfma_f32_16x16x32_bf16 v[80:83], a[180:183], a[68:71], v[80:83]
    s_waitcnt lgkmcnt(4)
    ds_read_b128 a[180:183], v12 offset:6400
    v_max3_f32 v36, v64, v65, v66
    v_mfma_f32_16x16x32_bf16 v[68:71], a[160:163], a[0:3], 0
    v_max_f32 v36, v36, v67
    v_max3_f32 v37, v72, v73, v74
    v_mfma_f32_16x16x32_bf16 v[76:79], a[160:163], a[4:7], 0
    v_max_f32 v37, v37, v75
    v_max3_f32 v38, v80, v81, v82
    v_mfma_f32_16x16x32_bf16 v[84:87], a[160:163], a[8:11], 0
    s_waitcnt lgkmcnt(3)
    v_max_f32 v38, v38, v83
    v_mfma_f32_16x16x32_bf16 v[68:71], a[164:167], a[12:15], v[68:71]
    v_mfma_f32_16x16x32_bf16 v[76:79], a[164:167], a[16:19], v[76:79]
    s_waitcnt vmcnt(12) lgkmcnt(0)
    s_barrier
    v_mfma_f32_16x16x32_bf16 v[84:87], a[164:167], a[20:23], v[84:87]
    ds_read_b128 a[160:163], v11 offset:24576
    buffer_load_dwordx4 v5, s[20:23], s57 offen lds
    v_mfma_f32_16x16x32_bf16 v[68:71], a[168:171], a[24:27], v[68:71]
    ds_read_b128 a[164:167], v12 offset:24576
    v_mfma_f32_16x16x32_bf16 v[76:79], a[168:171], a[28:31], v[76:79]
    v_mfma_f32_16x16x32_bf16 v[84:87], a[168:171], a[32:35], v[84:87]
    ds_read_b128 a[168:171], v11 offset:24704
    buffer_load_dwordx4 v6, s[20:23], s57 offen offset:1024 lds
    v_mfma_f32_16x16x32_bf16 v[68:71], a[172:175], a[36:39], v[68:71]
    v_mfma_f32_16x16x32_bf16 v[76:79], a[172:175], a[40:43], v[76:79]
    v_mfma_f32_16x16x32_bf16 v[84:87], a[172:175], a[44:47], v[84:87]
    ds_read_b128 a[172:175], v12 offset:24704
    buffer_load_dwordx4 v7, s[20:23], s57 offen offset:2048 lds
    v_mfma_f32_16x16x32_bf16 v[68:71], a[176:179], a[48:51], v[68:71]
    s_mov_b32 s57, 73728
    s_add_u32 m0, s51, 0
    v_mfma_f32_16x16x32_bf16 v[76:79], a[176:179], a[52:55], v[76:79]
    v_mfma_f32_16x16x32_bf16 v[84:87], a[176:179], a[56:59], v[84:87]
    ds_read_b128 a[176:179], v11 offset:24832
    buffer_load_dwordx4 v2, s[12:15], s57 offen nt lds
    v_mfma_f32_16x16x32_bf16 v[68:71], a[180:183], a[60:63], v[68:71]
    v_mfma_f32_16x16x32_bf16 v[76:79], a[180:183], a[64:67], v[76:79]
    v_mfma_f32_16x16x32_bf16 v[84:87], a[180:183], a[68:71], v[84:87]
    s_waitcnt lgkmcnt(1)
    ds_read_b128 a[180:183], v12 offset:24832
    buffer_load_dwordx4 v3, s[12:15], s57 offen offset:1024 nt lds
    v_mfma_f32_16x16x32_bf16 v[88:91], a[160:163], a[0:3], 0
    s_nop 1
    v_max3_f32 v36, v36, v68, v69
    v_max3_f32 v37, v37, v76, v77
    v_mfma_f32_16x16x32_bf16 v[96:99], a[160:163], a[4:7], 0
    v_max3_f32 v36, v36, v70, v71
    v_max3_f32 v38, v38, v84, v85
    v_mfma_f32_16x16x32_bf16 v[104:107], a[160:163], a[8:11], 0
    ds_read_b128 a[160:163], v11 offset:30720
    v_max3_f32 v37, v37, v78, v79
    v_mfma_f32_16x16x32_bf16 v[88:91], a[164:167], a[12:15], v[88:91]
    buffer_load_dwordx4 v4, s[12:15], s57 offen offset:2048 nt lds
    v_mfma_f32_16x16x32_bf16 v[96:99], a[164:167], a[16:19], v[96:99]
    s_mov_b32 s57, 86016
    s_add_u32 m0, s51, 12288
    v_max3_f32 v38, v38, v86, v87
    v_mfma_f32_16x16x32_bf16 v[104:107], a[164:167], a[20:23], v[104:107]
    ds_read_b128 a[164:167], v12 offset:30720
    v_mfma_f32_16x16x32_bf16 v[88:91], a[168:171], a[24:27], v[88:91]
    buffer_load_dwordx4 v2, s[12:15], s57 offen nt lds
    v_mfma_f32_16x16x32_bf16 v[96:99], a[168:171], a[28:31], v[96:99]
    v_mfma_f32_16x16x32_bf16 v[104:107], a[168:171], a[32:35], v[104:107]
    ds_read_b128 a[168:171], v11 offset:30848
    v_mfma_f32_16x16x32_bf16 v[88:91], a[172:175], a[36:39], v[88:91]
    buffer_load_dwordx4 v3, s[12:15], s57 offen offset:1024 nt lds
    v_mfma_f32_16x16x32_bf16 v[96:99], a[172:175], a[40:43], v[96:99]
    v_mfma_f32_16x16x32_bf16 v[104:107], a[172:175], a[44:47], v[104:107]
    s_waitcnt lgkmcnt(2)
    ds_read_b128 a[172:175], v12 offset:30848
    v_mfma_f32_16x16x32_bf16 v[88:91], a[176:179], a[48:51], v[88:91]
    buffer_load_dwordx4 v4, s[12:15], s57 offen offset:2048 nt lds
    v_mfma_f32_16x16x32_bf16 v[96:99], a[176:179], a[52:55], v[96:99]
    s_add_u32 m0, s51, 147456
    s_add_u32 s57, s62, 6144
    v_mfma_f32_16x16x32_bf16 v[104:107], a[176:179], a[56:59], v[104:107]
    ds_read_b128 a[176:179], v11 offset:30976
    v_mfma_f32_16x16x32_bf16 v[88:91], a[180:183], a[60:63], v[88:91]
    v_mfma_f32_16x16x32_bf16 v[96:99], a[180:183], a[64:67], v[96:99]
    v_mfma_f32_16x16x32_bf16 v[104:107], a[180:183], a[68:71], v[104:107]
    ds_read_b128 a[180:183], v12 offset:30976
    v_mfma_f32_16x16x32_bf16 v[92:95], a[160:163], a[0:3], 0
    s_nop 3
    v_max3_f32 v36, v36, v88, v89
    v_max3_f32 v36, v36, v90, v91
    v_mfma_f32_16x16x32_bf16 v[100:103], a[160:163], a[4:7], 0
    v_max3_f32 v37, v37, v96, v97
    v_max3_f32 v37, v37, v98, v99
    v_mfma_f32_16x16x32_bf16 v[108:111], a[160:163], a[8:11], 0
    s_waitcnt lgkmcnt(2)
    v_max3_f32 v38, v38, v104, v105
    v_max3_f32 v38, v38, v106, v107
    v_mfma_f32_16x16x32_bf16 v[92:95], a[164:167], a[12:15], v[92:95]
    v_mfma_f32_16x16x32_bf16 v[100:103], a[164:167], a[16:19], v[100:103]
    v_mfma_f32_16x16x32_bf16 v[108:111], a[164:167], a[20:23], v[108:111]
    s_waitcnt vmcnt(9) lgkmcnt(0)
    s_barrier
    ds_read_b128 a[160:163], v11 offset:49152
    v_mfma_f32_16x16x32_bf16 v[92:95], a[168:171], a[24:27], v[92:95]
    ds_read_b128 a[164:167], v12 offset:49152
    buffer_load_dwordx4 v8, s[8:11], s61 offen lds
    v_mfma_f32_16x16x32_bf16 v[100:103], a[168:171], a[28:31], v[100:103]
    ds_read_b128 a[208:211], v25 offset:24576
    v_mfma_f32_16x16x32_bf16 v[108:111], a[168:171], a[32:35], v[108:111]
    ds_read_b128 a[168:171], v11 offset:49280
    v_mfma_f32_16x16x32_bf16 v[92:95], a[172:175], a[36:39], v[92:95]
    ds_read_b64_tr_b16 a[184:185], v21 offset:36864
    ds_read_b64_tr_b16 a[186:187], v21 offset:38400
    v_mfma_f32_16x16x32_bf16 v[100:103], a[172:175], a[40:43], v[100:103]
    buffer_load_dwordx4 v9, s[8:11], s61 offen offset:1024 lds
    v_mfma_f32_16x16x32_bf16 v[108:111], a[172:175], a[44:47], v[108:111]
    ds_read_b128 a[172:175], v12 offset:49280
    v_mfma_f32_16x16x32_bf16 v[92:95], a[176:179], a[48:51], v[92:95]
    ds_read_b128 a[212:215], v25 offset:26624
    v_mfma_f32_16x16x32_bf16 v[100:103], a[176:179], a[52:55], v[100:103]
    ds_read_b128 a[216:219], v25 offset:28672
    buffer_load_dwordx4 v10, s[8:11], s61 offen offset:2048 lds
    v_mfma_f32_16x16x32_bf16 v[108:111], a[176:179], a[56:59], v[108:111]
    s_add_u32 m0, s51, 86016
    ds_read_b128 a[176:179], v11 offset:49408
    s_add_u32 s61, s61, 128
    v_mfma_f32_16x16x32_bf16 v[92:95], a[180:183], a[60:63], v[92:95]
    ds_read_b128 a[220:223], v25 offset:30720
    s_cmp_eq_u32 s61, 1280
    s_cselect_b32 s61, 0, s61
    v_mfma_f32_16x16x32_bf16 v[100:103], a[180:183], a[64:67], v[100:103]
    ds_read_b128 a[224:227], v25 offset:32768
    buffer_load_dwordx4 v5, s[20:23], s57 offen lds
    v_mfma_f32_16x16x32_bf16 v[108:111], a[180:183], a[68:71], v[108:111]
    s_waitcnt lgkmcnt(5)
    ds_read_b128 a[180:183], v12 offset:49408
    v_max3_f32 v36, v36, v92, v93
    v_mfma_f32_16x16x32_bf16 v[112:115], a[160:163], a[0:3], 0
    ds_read_b128 a[228:231], v25 offset:34816
    v_max3_f32 v37, v37, v100, v101
    v_mfma_f32_16x16x32_bf16 v[120:123], a[160:163], a[4:7], 0
    ds_read_b64_tr_b16 a[188:189], v22 offset:36864
    ds_read_b64_tr_b16 a[190:191], v22 offset:38400
    v_mfma_f32_16x16x32_bf16 v[128:131], a[160:163], a[8:11], 0
    buffer_load_dwordx4 v6, s[20:23], s57 offen offset:1024 lds
    v_mfma_f32_16x16x32_bf16 v[112:115], a[164:167], a[12:15], v[112:115]
    ds_read_b128 a[160:163], v11 offset:55296
    v_max3_f32 v38, v38, v108, v109
    v_mfma_f32_16x16x32_bf16 v[120:123], a[164:167], a[16:19], v[120:123]
    v_max3_f32 v36, v36, v94, v95
    v_max3_f32 v37, v37, v102, v103
    v_mfma_f32_16x16x32_bf16 v[128:131], a[164:167], a[20:23], v[128:131]
    ds_read_b128 a[164:167], v12 offset:55296
    v_max3_f32 v38, v38, v110, v111
    v_mfma_f32_16x16x32_bf16 v[112:115], a[168:171], a[24:27], v[112:115]
    buffer_load_dwordx4 v7, s[20:23], s57 offen offset:2048 lds
    v_mfma_f32_16x16x32_bf16 v[120:123], a[168:171], a[28:31], v[120:123]
    s_mov_b32 s57, 98304
    s_add_u32 m0, s51, 24576
    ds_read_b64_tr_b16 a[192:193], v23 offset:36864
    v_mfma_f32_16x16x32_bf16 v[128:131], a[168:171], a[32:35], v[128:131]
    ds_read_b128 a[168:171], v11 offset:55424
    v_mfma_f32_16x16x32_bf16 v[112:115], a[172:175], a[36:39], v[112:115]
    ds_read_b64_tr_b16 a[194:195], v23 offset:38400
    ds_read_b128 a[232:235], v26 offset:24576
    v_mfma_f32_16x16x32_bf16 v[120:123], a[172:175], a[40:43], v[120:123]
    buffer_load_dwordx4 v2, s[12:15], s57 offen nt lds
    v_mfma_f32_16x16x32_bf16 v[128:131], a[172:175], a[44:47], v[128:131]
    s_waitcnt lgkmcnt(5)
    ds_read_b128 a[172:175], v12 offset:55424
    v_mfma_f32_16x16x32_bf16 v[112:115], a[176:179], a[48:51], v[112:115]
    ds_read_b128 a[236:239], v26 offset:26624
    v_mfma_f32_16x16x32_bf16 v[120:123], a[176:179], a[52:55], v[120:123]
    ds_read_b128 a[240:243], v26 offset:28672
    buffer_load_dwordx4 v3, s[12:15], s57 offen offset:1024 nt lds
    v_mfma_f32_16x16x32_bf16 v[128:131], a[176:179], a[56:59], v[128:131]
    ds_read_b128 a[176:179], v11 offset:55552
    v_mfma_f32_16x16x32_bf16 v[112:115], a[180:183], a[60:63], v[112:115]
    ds_read_b128 a[244:247], v26 offset:30720
    v_mfma_f32_16x16x32_bf16 v[120:123], a[180:183], a[64:67], v[120:123]
    ds_read_b128 a[248:251], v26 offset:32768
    buffer_load_dwordx4 v4, s[12:15], s57 offen offset:2048 nt lds
    v_mfma_f32_16x16x32_bf16 v[128:131], a[180:183], a[68:71], v[128:131]
    s_mov_b32 s57, 110592
    s_add_u32 m0, s51, 36864
    ds_read_b128 a[180:183], v12 offset:55552
    v_mfma_f32_16x16x32_bf16 v[116:119], a[160:163], a[0:3], 0
    v_max3_f32 v36, v36, v112, v113
    v_max3_f32 v37, v37, v120, v121
    v_mfma_f32_16x16x32_bf16 v[124:127], a[160:163], a[4:7], 0
    v_max3_f32 v36, v36, v114, v115
    v_max3_f32 v37, v37, v122, v123
    v_mfma_f32_16x16x32_bf16 v[132:135], a[160:163], a[8:11], 0
    s_waitcnt lgkmcnt(3)
    buffer_load_dwordx4 v2, s[12:15], s57 offen nt lds
    v_mfma_f32_16x16x32_bf16 v[116:119], a[164:167], a[12:15], v[116:119]
    v_max3_f32 v38, v38, v128, v129
    v_max3_f32 v38, v38, v130, v131
    v_mfma_f32_16x16x32_bf16 v[124:127], a[164:167], a[16:19], v[124:127]
    ds_read_b128 a[252:255], v26 offset:34816
    v_mfma_f32_16x16x32_bf16 v[132:135], a[164:167], a[20:23], v[132:135]
    buffer_load_dwordx4 v3, s[12:15], s57 offen offset:1024 nt lds
    v_mfma_f32_16x16x32_bf16 v[116:119], a[168:171], a[24:27], v[116:119]
    v_mfma_f32_16x16x32_bf16 v[124:127], a[168:171], a[28:31], v[124:127]
    v_mfma_f32_16x16x32_bf16 v[132:135], a[168:171], a[32:35], v[132:135]
    buffer_load_dwordx4 v4, s[12:15], s57 offen offset:2048 nt lds
    v_mfma_f32_16x16x32_bf16 v[116:119], a[172:175], a[36:39], v[116:119]
    s_add_u32 s57, s62, 399360
    s_waitcnt vmcnt(12) lgkmcnt(0)
    s_barrier
    v_mfma_f32_16x16x32_bf16 v[124:127], a[172:175], a[40:43], v[124:127]
    s_add_u32 m0, s51, 98304
    ds_read_b128 a[160:163], v11 offset:0
    s_mul_i32 s62, s61, 6144
    v_mfma_f32_16x16x32_bf16 v[132:135], a[172:175], a[44:47], v[132:135]
    ds_read_b128 a[164:167], v12 offset:0
    v_mfma_f32_16x16x32_bf16 v[116:119], a[176:179], a[48:51], v[116:119]
    ds_read_b128 a[168:171], v11 offset:128
    v_mfma_f32_16x16x32_bf16 v[124:127], a[176:179], a[52:55], v[124:127]
    ds_read_b128 a[172:175], v12 offset:128
    buffer_load_dwordx4 v5, s[20:23], s57 offen lds
    v_mfma_f32_16x16x32_bf16 v[132:135], a[176:179], a[56:59], v[132:135]
    ds_read_b128 a[176:179], v11 offset:256
    v_mfma_f32_16x16x32_bf16 v[116:119], a[180:183], a[60:63], v[116:119]
    ds_read_b64_tr_b16 a[196:197], v21 offset:0
    ds_read_b64_tr_b16 a[198:199], v21 offset:1536
    v_mfma_f32_16x16x32_bf16 v[124:127], a[180:183], a[64:67], v[124:127]
    ds_read_b64_tr_b16 a[200:201], v22 offset:0
    ds_read_b64_tr_b16 a[202:203], v22 offset:1536
    v_mfma_f32_16x16x32_bf16 v[132:135], a[180:183], a[68:71], v[132:135]
    ds_read_b128 a[180:183], v12 offset:256
    v_mfma_f32_16x16x32_bf16 a[72:75], a[184:187], a[208:211], 0
    buffer_load_dwordx4 v6, s[20:23], s57 offen offset:1024 lds
    v_mfma_f32_16x16x32_bf16 a[76:79], a[184:187], a[212:215], 0
    v_max3_f32 v36, v36, v116, v117
    v_max3_f32 v37, v37, v124, v125
    v_mfma_f32_16x16x32_bf16 a[80:83], a[184:187], a[216:219], 0
    s_nop 0
    v_max3_f32 v38, v38, v132, v133
    v_max3_f32 v36, v36, v118, v119
    v_mfma_f32_16x16x32_bf16 a[84:87], a[184:187], a[220:223], 0
    v_max3_f32 v37, v37, v126, v127
    v_max3_f32 v38, v38, v134, v135
    v_mfma_f32_16x16x32_bf16 a[88:91], a[184:187], a[224:227], 0
    ds_read_b64_tr_b16 a[204:205], v23 offset:0
    ds_read_b64_tr_b16 a[206:207], v23 offset:1536
    v_mfma_f32_16x16x32_bf16 a[92:95], a[184:187], a[228:231], 0
    buffer_load_dwordx4 v7, s[20:23], s57 offen offset:2048 lds
    v_mfma_f32_16x16x32_bf16 a[96:99], a[188:191], a[208:211], 0
    s_mov_b32 s57, 122880
    s_add_u32 m0, s51, 49152
    v_mfma_f32_16x16x32_bf16 a[100:103], a[188:191], a[212:215], 0
    v_mfma_f32_16x16x32_bf16 a[104:107], a[188:191], a[216:219], 0
    v_mfma_f32_16x16x32_bf16 a[108:111], a[188:191], a[220:223], 0
    v_mfma_f32_16x16x32_bf16 a[112:115], a[188:191], a[224:227], 0
    buffer_load_dwordx4 v2, s[12:15], s57 offen nt lds
    v_mfma_f32_16x16x32_bf16 a[116:119], a[188:191], a[228:231], 0
    v_mfma_f32_16x16x32_bf16 a[120:123], a[192:195], a[208:211], 0
    v_mfma_f32_16x16x32_bf16 a[124:127], a[192:195], a[212:215], 0
    v_mfma_f32_16x16x32_bf16 a[128:131], a[192:195], a[216:219], 0
    v_mfma_f32_16x16x32_bf16 a[132:135], a[192:195], a[220:223], 0
    buffer_load_dwordx4 v3, s[12:15], s57 offen offset:1024 nt lds
    v_mfma_f32_16x16x32_bf16 a[136:139], a[192:195], a[224:227], 0
    v_mfma_f32_16x16x32_bf16 a[140:143], a[192:195], a[228:231], 0
    s_waitcnt lgkmcnt(0)
    v_mfma_f32_16x16x32_bf16 v[136:139], a[160:163], a[0:3], 0
    v_mfma_f32_16x16x32_bf16 v[144:147], a[160:163], a[4:7], 0
    v_mfma_f32_16x16x32_bf16 v[152:155], a[160:163], a[8:11], 0
    ds_read_b128 a[160:163], v11 offset:6144
    buffer_load_dwordx4 v4, s[12:15], s57 offen offset:2048 nt lds
    v_mfma_f32_16x16x32_bf16 v[136:139], a[164:167], a[12:15], v[136:139]
    s_mov_b32 s57, 135168
    s_add_u32 m0, s51, 61440
    v_mfma_f32_16x16x32_bf16 v[144:147], a[164:167], a[16:19], v[144:147]
    v_mfma_f32_16x16x32_bf16 v[152:155], a[164:167], a[20:23], v[152:155]
    ds_read_b128 a[164:167], v12 offset:6144
    v_mfma_f32_16x16x32_bf16 v[136:139], a[168:171], a[24:27], v[136:139]
    v_mfma_f32_16x16x32_bf16 v[144:147], a[168:171], a[28:31], v[144:147]
    buffer_load_dwordx4 v2, s[12:15], s57 offen nt lds
    v_mfma_f32_16x16x32_bf16 v[152:155], a[168:171], a[32:35], v[152:155]
    ds_read_b128 a[168:171], v11 offset:6272
    v_mfma_f32_16x16x32_bf16 v[136:139], a[172:175], a[36:39], v[136:139]
    v_mfma_f32_16x16x32_bf16 v[144:147], a[172:175], a[40:43], v[144:147]
    v_mfma_f32_16x16x32_bf16 v[152:155], a[172:175], a[44:47], v[152:155]
    ds_read_b128 a[172:175], v12 offset:6272
    v_mfma_f32_16x16x32_bf16 v[136:139], a[176:179], a[48:51], v[136:139]
    buffer_load_dwordx4 v3, s[12:15], s57 offen offset:1024 nt lds
    v_mfma_f32_16x16x32_bf16 v[144:147], a[176:179], a[52:55], v[144:147]
    v_mfma_f32_16x16x32_bf16 v[152:155], a[176:179], a[56:59], v[152:155]
    ds_read_b128 a[176:179], v11 offset:6400
    v_mfma_f32_16x16x32_bf16 v[136:139], a[180:183], a[60:63], v[136:139]
    v_mfma_f32_16x16x32_bf16 v[144:147], a[180:183], a[64:67], v[144:147]
    v_mfma_f32_16x16x32_bf16 v[152:155], a[180:183], a[68:71], v[152:155]
    s_waitcnt lgkmcnt(2)
    buffer_load_dwordx4 v4, s[12:15], s57 offen offset:2048 nt lds
    v_mfma_f32_16x16x32_bf16 v[140:143], a[160:163], a[0:3], 0
    s_add_u32 m0, s51, 122880
    ds_read_b128 a[180:183], v12 offset:6400
    s_nop 0
    v_max3_f32 v36, v36, v136, v137
    v_mfma_f32_16x16x32_bf16 v[148:151], a[160:163], a[4:7], 0
    s_add_u32 s57, s62, 6144
    v_max3_f32 v37, v37, v144, v145
    v_max3_f32 v36, v36, v138, v139
    v_mfma_f32_16x16x32_bf16 v[156:159], a[160:163], a[8:11], 0
    v_max3_f32 v38, v38, v152, v153
    v_max3_f32 v37, v37, v146, v147
    v_mfma_f32_16x16x32_bf16 v[140:143], a[164:167], a[12:15], v[140:143]
    v_max3_f32 v38, v38, v154, v155
    v_mfma_f32_16x16x32_bf16 v[148:151], a[164:167], a[16:19], v[148:151]
    v_mfma_f32_16x16x32_bf16 v[156:159], a[164:167], a[20:23], v[156:159]
    v_mfma_f32_16x16x32_bf16 v[140:143], a[168:171], a[24:27], v[140:143]
    s_waitcnt vmcnt(9) lgkmcnt(0)
    s_barrier
    ds_read_b128 a[160:163], v11 offset:24576
    v_mfma_f32_16x16x32_bf16 v[148:151], a[168:171], a[28:31], v[148:151]
    ds_read_b128 a[164:167], v12 offset:24576
    buffer_load_dwordx4 v8, s[8:11], s61 offen lds
    v_mfma_f32_16x16x32_bf16 v[156:159], a[168:171], a[32:35], v[156:159]
    ds_read_b128 a[168:171], v11 offset:24704
    v_mfma_f32_16x16x32_bf16 v[140:143], a[172:175], a[36:39], v[140:143]
    ds_read_b128 a[208:211], v25 offset:49152
    v_mfma_f32_16x16x32_bf16 v[148:151], a[172:175], a[40:43], v[148:151]
    ds_read_b64_tr_b16 a[184:185], v21 offset:12288
    ds_read_b64_tr_b16 a[186:187], v21 offset:13824
    v_mfma_f32_16x16x32_bf16 v[156:159], a[172:175], a[44:47], v[156:159]
    ds_read_b128 a[172:175], v12 offset:24704
    buffer_load_dwordx4 v9, s[8:11], s61 offen offset:1024 lds
    v_mfma_f32_16x16x32_bf16 v[140:143], a[176:179], a[48:51], v[140:143]
    ds_read_b128 a[212:215], v25 offset:51200
    v_mfma_f32_16x16x32_bf16 v[148:151], a[176:179], a[52:55], v[148:151]
    ds_read_b128 a[216:219], v25 offset:53248
    v_mfma_f32_16x16x32_bf16 v[156:159], a[176:179], a[56:59], v[156:159]
    ds_read_b128 a[176:179], v11 offset:24832
    buffer_load_dwordx4 v10, s[8:11], s61 offen offset:2048 lds
    v_mfma_f32_16x16x32_bf16 v[140:143], a[180:183], a[60:63], v[140:143]
    s_add_u32 m0, s51, 73728
    ds_read_b128 a[220:223], v25 offset:55296
    s_add_u32 s61, s61, 128
    v_mfma_f32_16x16x32_bf16 v[148:151], a[180:183], a[64:67], v[148:151]
    ds_read_b128 a[224:227], v25 offset:57344
    s_cmp_eq_u32 s61, 1280
    s_cselect_b32 s61, 0, s61
    v_mfma_f32_16x16x32_bf16 v[156:159], a[180:183], a[68:71], v[156:159]
    ds_read_b128 a[180:183], v12 offset:24832
    v_max3_f32 v36, v36, v140, v141
    v_mfma_f32_16x16x32_bf16 a[72:75], a[196:199], a[232:235], a[72:75]
    buffer_load_dwordx4 v5, s[20:23], s57 offen lds
    v_mfma_f32_16x16x32_bf16 a[76:79], a[196:199], a[236:239], a[76:79]
    v_max3_f32 v37, v37, v148, v149
    v_max3_f32 v36, v36, v142, v143
    v_mfma_f32_16x16x32_bf16 a[80:83], a[196:199], a[240:243], a[80:83]
    v_max3_f32 v38, v38, v156, v157
    v_max3_f32 v37, v37, v150, v151
    v_mfma_f32_16x16x32_bf16 a[84:87], a[196:199], a[244:247], a[84:87]
    v_max3_f32 v38, v38, v158, v159
    v_mfma_f32_16x16x32_bf16 a[88:91], a[196:199], a[248:251], a[88:91]
    buffer_load_dwordx4 v6, s[20:23], s57 offen offset:1024 lds
    v_mfma_f32_16x16x32_bf16 a[92:95], a[196:199], a[252:255], a[92:95]
    ds_read_b128 a[228:231], v25 offset:59392
    v_mfma_f32_16x16x32_bf16 a[96:99], a[200:203], a[232:235], a[96:99]
    ds_read_b64_tr_b16 a[188:189], v22 offset:12288
    ds_read_b64_tr_b16 a[190:191], v22 offset:13824
    v_mfma_f32_16x16x32_bf16 a[100:103], a[200:203], a[236:239], a[100:103]
    ds_read_b64_tr_b16 a[192:193], v23 offset:12288
    ds_read_b64_tr_b16 a[194:195], v23 offset:13824
    v_mfma_f32_16x16x32_bf16 a[104:107], a[200:203], a[240:243], a[104:107]
    buffer_load_dwordx4 v7, s[20:23], s57 offen offset:2048 lds
    v_mfma_f32_16x16x32_bf16 a[108:111], a[200:203], a[244:247], a[108:111]
    s_mov_b32 s57, 147456
    s_add_u32 m0, s51, 0
    v_mfma_f32_16x16x32_bf16 a[112:115], a[200:203], a[248:251], a[112:115]
    v_mfma_f32_16x16x32_bf16 a[116:119], a[200:203], a[252:255], a[116:119]
    buffer_load_dwordx4 v2, s[12:15], s57 offen nt lds
    v_mfma_f32_16x16x32_bf16 a[120:123], a[204:207], a[232:235], a[120:123]
    ds_read_b128 a[232:235], v26 offset:49152
    v_mfma_f32_16x16x32_bf16 a[124:127], a[204:207], a[236:239], a[124:127]
    ds_read_b128 a[236:239], v26 offset:51200
    v_mfma_f32_16x16x32_bf16 a[128:131], a[204:207], a[240:243], a[128:131]
    ds_read_b128 a[240:243], v26 offset:53248
    buffer_load_dwordx4 v3, s[12:15], s57 offen offset:1024 nt lds
    v_mfma_f32_16x16x32_bf16 a[132:135], a[204:207], a[244:247], a[132:135]
    ds_read_b128 a[244:247], v26 offset:55296
    v_mfma_f32_16x16x32_bf16 a[136:139], a[204:207], a[248:251], a[136:139]
    ds_read_b128 a[248:251], v26 offset:57344
    v_mfma_f32_16x16x32_bf16 a[140:143], a[204:207], a[252:255], a[140:143]
    s_waitcnt lgkmcnt(5)
    ds_read_b128 a[252:255], v26 offset:59392
    buffer_load_dwordx4 v4, s[12:15], s57 offen offset:2048 nt lds
    v_mfma_f32_16x16x32_bf16 v[160:163], a[160:163], a[0:3], 0
    s_mov_b32 s57, 159744
    s_add_u32 m0, s51, 12288
    v_mfma_f32_16x16x32_bf16 v[168:171], a[160:163], a[4:7], 0
    v_mfma_f32_16x16x32_bf16 v[176:179], a[160:163], a[8:11], 0
    ds_read_b128 a[160:163], v11 offset:30720
    buffer_load_dwordx4 v2, s[12:15], s57 offen nt lds
    v_mfma_f32_16x16x32_bf16 v[160:163], a[164:167], a[12:15], v[160:163]
    v_mfma_f32_16x16x32_bf16 v[168:171], a[164:167], a[16:19], v[168:171]
    v_mfma_f32_16x16x32_bf16 v[176:179], a[164:167], a[20:23], v[176:179]
    ds_read_b128 a[164:167], v12 offset:30720
    buffer_load_dwordx4 v3, s[12:15], s57 offen offset:1024 nt lds
    v_mfma_f32_16x16x32_bf16 v[160:163], a[168:171], a[24:27], v[160:163]
    v_mfma_f32_16x16x32_bf16 v[168:171], a[168:171], a[28:31], v[168:171]
    v_mfma_f32_16x16x32_bf16 v[176:179], a[168:171], a[32:35], v[176:179]
    ds_read_b128 a[168:171], v11 offset:30848
    buffer_load_dwordx4 v4, s[12:15], s57 offen offset:2048 nt lds
    v_mfma_f32_16x16x32_bf16 v[160:163], a[172:175], a[36:39], v[160:163]
    s_add_u32 s57, s62, 399360
    s_add_u32 m0, s51, 86016
    s_mul_i32 s62, s61, 6144
    v_mfma_f32_16x16x32_bf16 v[168:171], a[172:175], a[40:43], v[168:171]
    v_mfma_f32_16x16x32_bf16 v[176:179], a[172:175], a[44:47], v[176:179]
    ds_read_b128 a[172:175], v12 offset:30848
    v_mfma_f32_16x16x32_bf16 v[160:163], a[176:179], a[48:51], v[160:163]
    v_mfma_f32_16x16x32_bf16 v[168:171], a[176:179], a[52:55], v[168:171]
    v_mfma_f32_16x16x32_bf16 v[176:179], a[176:179], a[56:59], v[176:179]
    ds_read_b128 a[176:179], v11 offset:30976
    v_mfma_f32_16x16x32_bf16 v[160:163], a[180:183], a[60:63], v[160:163]
    v_mfma_f32_16x16x32_bf16 v[168:171], a[180:183], a[64:67], v[168:171]
    v_mfma_f32_16x16x32_bf16 v[176:179], a[180:183], a[68:71], v[176:179]
    s_waitcnt lgkmcnt(2)
    ds_read_b128 a[180:183], v12 offset:30976
    v_mfma_f32_16x16x32_bf16 v[164:167], a[160:163], a[0:3], 0
    s_nop 2
    v_max3_f32 v36, v36, v160, v161
    v_max3_f32 v36, v36, v162, v163
    v_mfma_f32_16x16x32_bf16 v[172:175], a[160:163], a[4:7], 0
    v_max3_f32 v37, v37, v168, v169
    v_max3_f32 v37, v37, v170, v171
    v_mfma_f32_16x16x32_bf16 v[180:183], a[160:163], a[8:11], 0
    v_max3_f32 v38, v38, v176, v177
    v_max3_f32 v38, v38, v178, v179
    v_mfma_f32_16x16x32_bf16 v[164:167], a[164:167], a[12:15], v[164:167]
    v_mfma_f32_16x16x32_bf16 v[172:175], a[164:167], a[16:19], v[172:175]
    v_mfma_f32_16x16x32_bf16 v[180:183], a[164:167], a[20:23], v[180:183]
    s_waitcnt vmcnt(12) lgkmcnt(0)
    s_barrier
    ds_read_b128 a[160:163], v11 offset:49152
    v_mfma_f32_16x16x32_bf16 v[164:167], a[168:171], a[24:27], v[164:167]
    ds_read_b128 a[164:167], v12 offset:49152
    buffer_load_dwordx4 v5, s[20:23], s57 offen lds
    v_mfma_f32_16x16x32_bf16 v[172:175], a[168:171], a[28:31], v[172:175]
    ds_read_b64_tr_b16 a[196:197], v21 offset:24576
    ds_read_b64_tr_b16 a[198:199], v21 offset:26112
    v_mfma_f32_16x16x32_bf16 v[180:183], a[168:171], a[32:35], v[180:183]
    ds_read_b128 a[168:171], v11 offset:49280
    v_mfma_f32_16x16x32_bf16 v[164:167], a[172:175], a[36:39], v[164:167]
    ds_read_b64_tr_b16 a[200:201], v22 offset:24576
    ds_read_b64_tr_b16 a[202:203], v22 offset:26112
    v_mfma_f32_16x16x32_bf16 v[172:175], a[172:175], a[40:43], v[172:175]
    ds_read_b64_tr_b16 a[204:205], v23 offset:24576
    ds_read_b64_tr_b16 a[206:207], v23 offset:26112
    v_mfma_f32_16x16x32_bf16 v[180:183], a[172:175], a[44:47], v[180:183]
    ds_read_b128 a[172:175], v12 offset:49280
    buffer_load_dwordx4 v6, s[20:23], s57 offen offset:1024 lds
    v_mfma_f32_16x16x32_bf16 v[164:167], a[176:179], a[48:51], v[164:167]
    v_mfma_f32_16x16x32_bf16 v[172:175], a[176:179], a[52:55], v[172:175]
    v_mfma_f32_16x16x32_bf16 v[180:183], a[176:179], a[56:59], v[180:183]
    ds_read_b128 a[176:179], v11 offset:49408
    v_mfma_f32_16x16x32_bf16 v[164:167], a[180:183], a[60:63], v[164:167]
    v_mfma_f32_16x16x32_bf16 v[172:175], a[180:183], a[64:67], v[172:175]
    buffer_load_dwordx4 v7, s[20:23], s57 offen offset:2048 lds
    v_mfma_f32_16x16x32_bf16 v[180:183], a[180:183], a[68:71], v[180:183]
    s_mov_b32 s57, 172032
    ds_read_b128 a[180:183], v12 offset:49408
    s_add_u32 m0, s51, 24576
    v_mfma_f32_16x16x32_bf16 a[72:75], a[184:187], a[208:211], a[72:75]
    s_nop 0
    v_max3_f32 v36, v36, v164, v165
    v_max3_f32 v36, v36, v166, v167
    v_mfma_f32_16x16x32_bf16 a[76:79], a[184:187], a[212:215], a[76:79]
    v_max3_f32 v37, v37, v172, v173
    v_max3_f32 v37, v37, v174, v175
    v_mfma_f32_16x16x32_bf16 a[80:83], a[184:187], a[216:219], a[80:83]
    v_max3_f32 v38, v38, v180, v181
    v_max3_f32 v38, v38, v182, v183
    v_mfma_f32_16x16x32_bf16 a[84:87], a[184:187], a[220:223], a[84:87]
    buffer_load_dwordx4 v2, s[12:15], s57 offen nt lds
    v_mfma_f32_16x16x32_bf16 a[88:91], a[184:187], a[224:227], a[88:91]
    v_mfma_f32_16x16x32_bf16 a[92:95], a[184:187], a[228:231], a[92:95]
    v_mfma_f32_16x16x32_bf16 a[96:99], a[188:191], a[208:211], a[96:99]
    v_mfma_f32_16x16x32_bf16 a[100:103], a[188:191], a[212:215], a[100:103]
    v_mfma_f32_16x16x32_bf16 a[104:107], a[188:191], a[216:219], a[104:107]
    buffer_load_dwordx4 v3, s[12:15], s57 offen offset:1024 nt lds
    v_mfma_f32_16x16x32_bf16 a[108:111], a[188:191], a[220:223], a[108:111]
    v_mfma_f32_16x16x32_bf16 a[112:115], a[188:191], a[224:227], a[112:115]
    v_mfma_f32_16x16x32_bf16 a[116:119], a[188:191], a[228:231], a[116:119]
    v_mfma_f32_16x16x32_bf16 a[120:123], a[192:195], a[208:211], a[120:123]
    v_mfma_f32_16x16x32_bf16 a[124:127], a[192:195], a[212:215], a[124:127]
    buffer_load_dwordx4 v4, s[12:15], s57 offen offset:2048 nt lds
    v_mfma_f32_16x16x32_bf16 a[128:131], a[192:195], a[216:219], a[128:131]
    s_mov_b32 s57, 184320
    s_add_u32 m0, s51, 36864
    v_mfma_f32_16x16x32_bf16 a[132:135], a[192:195], a[220:223], a[132:135]
    v_mfma_f32_16x16x32_bf16 a[136:139], a[192:195], a[224:227], a[136:139]
    v_mfma_f32_16x16x32_bf16 a[140:143], a[192:195], a[228:231], a[140:143]
    s_waitcnt lgkmcnt(0)
    v_mfma_f32_16x16x32_bf16 v[184:187], a[160:163], a[0:3], 0
    buffer_load_dwordx4 v2, s[12:15], s57 offen nt lds
    v_mfma_f32_16x16x32_bf16 v[192:195], a[160:163], a[4:7], 0
    v_mfma_f32_16x16x32_bf16 v[200:203], a[160:163], a[8:11], 0
    ds_read_b128 a[160:163], v11 offset:55296
    v_mfma_f32_16x16x32_bf16 v[184:187], a[164:167], a[12:15], v[184:187]
    v_mfma_f32_16x16x32_bf16 v[192:195], a[164:167], a[16:19], v[192:195]
    v_mfma_f32_16x16x32_bf16 v[200:203], a[164:167], a[20:23], v[200:203]
    buffer_load_dwordx4 v3, s[12:15], s57 offen offset:1024 nt lds
    v_mfma_f32_16x16x32_bf16 v[184:187], a[168:171], a[24:27], v[184:187]
    ds_read_b128 a[164:167], v12 offset:55296
    v_mfma_f32_16x16x32_bf16 v[192:195], a[168:171], a[28:31], v[192:195]
    v_mfma_f32_16x16x32_bf16 v[200:203], a[168:171], a[32:35], v[200:203]
    ds_read_b128 a[168:171], v11 offset:55424
    v_mfma_f32_16x16x32_bf16 v[184:187], a[172:175], a[36:39], v[184:187]
    v_mfma_f32_16x16x32_bf16 v[192:195], a[172:175], a[40:43], v[192:195]
    buffer_load_dwordx4 v4, s[12:15], s57 offen offset:2048 nt lds
    v_mfma_f32_16x16x32_bf16 v[200:203], a[172:175], a[44:47], v[200:203]
    s_add_u32 m0, s51, 110592
    ds_read_b128 a[172:175], v12 offset:55424
    s_add_u32 s57, s62, 6144
    v_mfma_f32_16x16x32_bf16 v[184:187], a[176:179], a[48:51], v[184:187]
    v_mfma_f32_16x16x32_bf16 v[192:195], a[176:179], a[52:55], v[192:195]
    v_mfma_f32_16x16x32_bf16 v[200:203], a[176:179], a[56:59], v[200:203]
    ds_read_b128 a[176:179], v11 offset:55552
    v_mfma_f32_16x16x32_bf16 v[184:187], a[180:183], a[60:63], v[184:187]
    v_mfma_f32_16x16x32_bf16 v[192:195], a[180:183], a[64:67], v[192:195]
    v_mfma_f32_16x16x32_bf16 v[200:203], a[180:183], a[68:71], v[200:203]
    s_waitcnt lgkmcnt(2)
    ds_read_b128 a[180:183], v12 offset:55552
    v_mfma_f32_16x16x32_bf16 v[188:191], a[160:163], a[0:3], 0
    s_nop 2
    v_max3_f32 v36, v36, v184, v185
    v_max3_f32 v36, v36, v186, v187
    v_mfma_f32_16x16x32_bf16 v[196:199], a[160:163], a[4:7], 0
    v_max3_f32 v37, v37, v192, v193
    v_max3_f32 v37, v37, v194, v195
    v_mfma_f32_16x16x32_bf16 v[204:207], a[160:163], a[8:11], 0
    v_max3_f32 v38, v38, v200, v201
    v_max3_f32 v38, v38, v202, v203
    v_mfma_f32_16x16x32_bf16 v[188:191], a[164:167], a[12:15], v[188:191]
    v_mfma_f32_16x16x32_bf16 v[196:199], a[164:167], a[16:19], v[196:199]
    v_mfma_f32_16x16x32_bf16 v[204:207], a[164:167], a[20:23], v[204:207]
    s_waitcnt vmcnt(9) lgkmcnt(0)
    s_barrier
    ds_read_b128 a[160:163], v11 offset:0
    v_mfma_f32_16x16x32_bf16 v[188:191], a[168:171], a[24:27], v[188:191]
    ds_read_b128 a[164:167], v12 offset:0
    buffer_load_dwordx4 v8, s[8:11], s61 offen lds
    v_mfma_f32_16x16x32_bf16 v[196:199], a[168:171], a[28:31], v[196:199]
    ds_read_b128 a[208:211], v25 offset:24576
    v_mfma_f32_16x16x32_bf16 v[204:207], a[168:171], a[32:35], v[204:207]
    ds_read_b128 a[168:171], v11 offset:128
    v_mfma_f32_16x16x32_bf16 v[188:191], a[172:175], a[36:39], v[188:191]
    ds_read_b64_tr_b16 a[184:185], v21 offset:0
    ds_read_b64_tr_b16 a[186:187], v21 offset:1536
    v_mfma_f32_16x16x32_bf16 v[196:199], a[172:175], a[40:43], v[196:199]
    buffer_load_dwordx4 v9, s[8:11], s61 offen offset:1024 lds
    v_mfma_f32_16x16x32_bf16 v[204:207], a[172:175], a[44:47], v[204:207]
    ds_read_b128 a[172:175], v12 offset:128
    v_mfma_f32_16x16x32_bf16 v[188:191], a[176:179], a[48:51], v[188:191]
    ds_read_b128 a[212:215], v25 offset:26624
    v_mfma_f32_16x16x32_bf16 v[196:199], a[176:179], a[52:55], v[196:199]
    ds_read_b128 a[216:219], v25 offset:28672
    buffer_load_dwordx4 v10, s[8:11], s61 offen offset:2048 lds
    v_mfma_f32_16x16x32_bf16 v[204:207], a[176:179], a[56:59], v[204:207]
    s_add_u32 m0, s51, 98304
    ds_read_b128 a[176:179], v11 offset:256
    s_add_u32 s61, s61, 128
    v_mfma_f32_16x16x32_bf16 v[188:191], a[180:183], a[60:63], v[188:191]
    ds_read_b128 a[220:223], v25 offset:30720
    s_cmp_eq_u32 s61, 1280
    s_cselect_b32 s61, 0, s61
    v_mfma_f32_16x16x32_bf16 v[196:199], a[180:183], a[64:67], v[196:199]
    ds_read_b128 a[224:227], v25 offset:32768
    buffer_load_dwordx4 v5, s[20:23], s57 offen lds
    v_mfma_f32_16x16x32_bf16 v[204:207], a[180:183], a[68:71], v[204:207]
    ds_read_b128 a[180:183], v12 offset:256
    v_max3_f32 v36, v36, v188, v189
    v_mfma_f32_16x16x32_bf16 a[72:75], a[196:199], a[232:235], a[72:75]
    v_max3_f32 v36, v36, v190, v191
    s_nop 0
    v_max3_f32 v37, v37, v196, v197
    v_mfma_f32_16x16x32_bf16 a[76:79], a[196:199], a[236:239], a[76:79]
    v_max3_f32 v37, v37, v198, v199
    v_mfma_f32_16x16x32_bf16 a[80:83], a[196:199], a[240:243], a[80:83]
    buffer_load_dwordx4 v6, s[20:23], s57 offen offset:1024 lds
    v_mfma_f32_16x16x32_bf16 a[84:87], a[196:199], a[244:247], a[84:87]
    v_max3_f32 v38, v38, v204, v205
    v_max3_f32 v38, v38, v206, v207
    v_mfma_f32_16x16x32_bf16 a[88:91], a[196:199], a[248:251], a[88:91]
    ds_read_b128 a[228:231], v25 offset:34816
    v_mfma_f32_16x16x32_bf16 a[92:95], a[196:199], a[252:255], a[92:95]
    ds_read_b64_tr_b16 a[188:189], v22 offset:0
    ds_read_b64_tr_b16 a[190:191], v22 offset:1536
    v_mfma_f32_16x16x32_bf16 a[96:99], a[200:203], a[232:235], a[96:99]
    buffer_load_dwordx4 v7, s[20:23], s57 offen offset:2048 lds
    v_mfma_f32_16x16x32_bf16 a[100:103], a[200:203], a[236:239], a[100:103]
    s_mov_b32 s57, 0
    s_add_u32 m0, s51, 49152
    ds_read_b64_tr_b16 a[192:193], v23 offset:0
    v_mfma_f32_16x16x32_bf16 a[104:107], a[200:203], a[240:243], a[104:107]
    ds_read_b64_tr_b16 a[194:195], v23 offset:1536
    v_mfma_f32_16x16x32_bf16 a[108:111], a[200:203], a[244:247], a[108:111]
    buffer_load_dwordx4 v2, s[16:19], s57 offen nt lds
    v_mfma_f32_16x16x32_bf16 a[112:115], a[200:203], a[248:251], a[112:115]
    v_mfma_f32_16x16x32_bf16 a[116:119], a[200:203], a[252:255], a[116:119]
    v_mfma_f32_16x16x32_bf16 a[120:123], a[204:207], a[232:235], a[120:123]
    ds_read_b128 a[232:235], v26 offset:24576
    buffer_load_dwordx4 v3, s[16:19], s57 offen offset:1024 nt lds
    v_mfma_f32_16x16x32_bf16 a[124:127], a[204:207], a[236:239], a[124:127]
    ds_read_b128 a[236:239], v26 offset:26624
    v_mfma_f32_16x16x32_bf16 a[128:131], a[204:207], a[240:243], a[128:131]
    ds_read_b128 a[240:243], v26 offset:28672
    v_mfma_f32_16x16x32_bf16 a[132:135], a[204:207], a[244:247], a[132:135]
    ds_read_b128 a[244:247], v26 offset:30720
    buffer_load_dwordx4 v4, s[16:19], s57 offen offset:2048 nt lds
    v_mfma_f32_16x16x32_bf16 a[136:139], a[204:207], a[248:251], a[136:139]
    s_mov_b32 s57, 12288
    s_add_u32 m0, s51, 61440
    ds_read_b128 a[248:251], v26 offset:32768
    v_mfma_f32_16x16x32_bf16 a[140:143], a[204:207], a[252:255], a[140:143]
    s_waitcnt lgkmcnt(5)
    ds_read_b128 a[252:255], v26 offset:34816
    v_mfma_f32_16x16x32_bf16 v[208:211], a[160:163], a[0:3], 0
    buffer_load_dwordx4 v2, s[16:19], s57 offen nt lds
    v_mfma_f32_16x16x32_bf16 v[216:219], a[160:163], a[4:7], 0
    v_mfma_f32_16x16x32_bf16 v[224:227], a[160:163], a[8:11], 0
    ds_read_b128 a[160:163], v11 offset:6144
    v_mfma_f32_16x16x32_bf16 v[208:211], a[164:167], a[12:15], v[208:211]
    buffer_load_dwordx4 v3, s[16:19], s57 offen offset:1024 nt lds
    v_mfma_f32_16x16x32_bf16 v[216:219], a[164:167], a[16:19], v[216:219]
    v_mfma_f32_16x16x32_bf16 v[224:227], a[164:167], a[20:23], v[224:227]
    ds_read_b128 a[164:167], v12 offset:6144
    v_mfma_f32_16x16x32_bf16 v[208:211], a[168:171], a[24:27], v[208:211]
    buffer_load_dwordx4 v4, s[16:19], s57 offen offset:2048 nt lds
    v_mfma_f32_16x16x32_bf16 v[216:219], a[168:171], a[28:31], v[216:219]
    s_add_u32 s57, s62, 399360
    s_add_u32 m0, s51, 73728
    s_mul_i32 s62, s61, 6144
    v_mfma_f32_16x16x32_bf16 v[224:227], a[168:171], a[32:35], v[224:227]
    ds_read_b128 a[168:171], v11 offset:6272
    v_mfma_f32_16x16x32_bf16 v[208:211], a[172:175], a[36:39], v[208:211]
    v_mfma_f32_16x16x32_bf16 v[216:219], a[172:175], a[40:43], v[216:219]
    v_mfma_f32_16x16x32_bf16 v[224:227], a[172:175], a[44:47], v[224:227]
    ds_read_b128 a[172:175], v12 offset:6272
    v_mfma_f32_16x16x32_bf16 v[208:211], a[176:179], a[48:51], v[208:211]
    v_mfma_f32_16x16x32_bf16 v[216:219], a[176:179], a[52:55], v[216:219]
    v_mfma_f32_16x16x32_bf16 v[224:227], a[176:179], a[56:59], v[224:227]
    ds_read_b128 a[176:179], v11 offset:6400
    v_mfma_f32_16x16x32_bf16 v[208:211], a[180:183], a[60:63], v[208:211]
    v_mfma_f32_16x16x32_bf16 v[216:219], a[180:183], a[64:67], v[216:219]
    v_mfma_f32_16x16x32_bf16 v[224:227], a[180:183], a[68:71], v[224:227]
    s_waitcnt lgkmcnt(2)
    ds_read_b128 a[180:183], v12 offset:6400
    v_mfma_f32_16x16x32_bf16 v[212:215], a[160:163], a[0:3], 0
    s_nop 2
    v_max3_f32 v36, v36, v208, v209
    v_max3_f32 v36, v36, v210, v211
    v_mfma_f32_16x16x32_bf16 v[220:223], a[160:163], a[4:7], 0
    v_max3_f32 v37, v37, v216, v217
    v_max3_f32 v37, v37, v218, v219
    v_mfma_f32_16x16x32_bf16 v[228:231], a[160:163], a[8:11], 0
    v_max3_f32 v38, v38, v224, v225
    v_max3_f32 v38, v38, v226, v227
    v_mfma_f32_16x16x32_bf16 v[212:215], a[164:167], a[12:15], v[212:215]
    v_mfma_f32_16x16x32_bf16 v[220:223], a[164:167], a[16:19], v[220:223]
    v_mfma_f32_16x16x32_bf16 v[228:231], a[164:167], a[20:23], v[228:231]
    s_waitcnt vmcnt(12) lgkmcnt(0)
    s_barrier
    ds_read_b128 a[160:163], v11 offset:24576
    v_mfma_f32_16x16x32_bf16 v[212:215], a[168:171], a[24:27], v[212:215]
    ds_read_b128 a[164:167], v12 offset:24576
    buffer_load_dwordx4 v5, s[20:23], s57 offen lds
    v_mfma_f32_16x16x32_bf16 v[220:223], a[168:171], a[28:31], v[220:223]
    ds_read_b64_tr_b16 a[196:197], v21 offset:12288
    ds_read_b64_tr_b16 a[198:199], v21 offset:13824
    v_mfma_f32_16x16x32_bf16 v[228:231], a[168:171], a[32:35], v[228:231]
    ds_read_b128 a[168:171], v11 offset:24704
    v_mfma_f32_16x16x32_bf16 v[212:215], a[172:175], a[36:39], v[212:215]
    ds_read_b64_tr_b16 a[200:201], v22 offset:12288
    ds_read_b64_tr_b16 a[202:203], v22 offset:13824
    v_mfma_f32_16x16x32_bf16 v[220:223], a[172:175], a[40:43], v[220:223]
    ds_read_b64_tr_b16 a[204:205], v23 offset:12288
    ds_read_b64_tr_b16 a[206:207], v23 offset:13824
    v_mfma_f32_16x16x32_bf16 v[228:231], a[172:175], a[44:47], v[228:231]
    ds_read_b128 a[172:175], v12 offset:24704
    buffer_load_dwordx4 v6, s[20:23], s57 offen offset:1024 lds
    v_mfma_f32_16x16x32_bf16 v[212:215], a[176:179], a[48:51], v[212:215]
    v_mfma_f32_16x16x32_bf16 v[220:223], a[176:179], a[52:55], v[220:223]
    v_mfma_f32_16x16x32_bf16 v[228:231], a[176:179], a[56:59], v[228:231]
    ds_read_b128 a[176:179], v11 offset:24832
    v_mfma_f32_16x16x32_bf16 v[212:215], a[180:183], a[60:63], v[212:215]
    v_mfma_f32_16x16x32_bf16 v[220:223], a[180:183], a[64:67], v[220:223]
    buffer_load_dwordx4 v7, s[20:23], s57 offen offset:2048 lds
    v_mfma_f32_16x16x32_bf16 v[228:231], a[180:183], a[68:71], v[228:231]
    s_mov_b32 s57, 24576
    ds_read_b128 a[180:183], v12 offset:24832
    s_add_u32 m0, s51, 0
    v_mfma_f32_16x16x32_bf16 a[72:75], a[184:187], a[208:211], a[72:75]
    s_nop 0
    v_max3_f32 v36, v36, v212, v213
    v_max3_f32 v36, v36, v214, v215
    v_mfma_f32_16x16x32_bf16 a[76:79], a[184:187], a[212:215], a[76:79]
    v_max3_f32 v37, v37, v220, v221
    v_max3_f32 v37, v37, v222, v223
    v_mfma_f32_16x16x32_bf16 a[80:83], a[184:187], a[216:219], a[80:83]
    v_max3_f32 v38, v38, v228, v229
    v_max3_f32 v38, v38, v230, v231
    v_mfma_f32_16x16x32_bf16 a[84:87], a[184:187], a[220:223], a[84:87]
    buffer_load_dwordx4 v2, s[16:19], s57 offen nt lds
    v_mfma_f32_16x16x32_bf16 a[88:91], a[184:187], a[224:227], a[88:91]
    v_mfma_f32_16x16x32_bf16 a[92:95], a[184:187], a[228:231], a[92:95]
    v_mfma_f32_16x16x32_bf16 a[96:99], a[188:191], a[208:211], a[96:99]
    v_mfma_f32_16x16x32_bf16 a[100:103], a[188:191], a[212:215], a[100:103]
    v_mfma_f32_16x16x32_bf16 a[104:107], a[188:191], a[216:219], a[104:107]
    buffer_load_dwordx4 v3, s[16:19], s57 offen offset:1024 nt lds
    v_mfma_f32_16x16x32_bf16 a[108:111], a[188:191], a[220:223], a[108:111]
    v_mfma_f32_16x16x32_bf16 a[112:115], a[188:191], a[224:227], a[112:115]
    v_mfma_f32_16x16x32_bf16 a[116:119], a[188:191], a[228:231], a[116:119]
    v_mfma_f32_16x16x32_bf16 a[120:123], a[192:195], a[208:211], a[120:123]
    v_mfma_f32_16x16x32_bf16 a[124:127], a[192:195], a[212:215], a[124:127]
    buffer_load_dwordx4 v4, s[16:19], s57 offen offset:2048 nt lds
    v_mfma_f32_16x16x32_bf16 a[128:131], a[192:195], a[216:219], a[128:131]
    s_mov_b32 s57, 36864
    s_add_u32 m0, s51, 12288
    v_mfma_f32_16x16x32_bf16 a[132:135], a[192:195], a[220:223], a[132:135]
    v_mfma_f32_16x16x32_bf16 a[136:139], a[192:195], a[224:227], a[136:139]
    v_mfma_f32_16x16x32_bf16 a[140:143], a[192:195], a[228:231], a[140:143]
    s_waitcnt lgkmcnt(0)
    v_mfma_f32_16x16x32_bf16 v[232:235], a[160:163], a[0:3], 0
    buffer_load_dwordx4 v2, s[16:19], s57 offen nt lds
    v_mfma_f32_16x16x32_bf16 v[240:243], a[160:163], a[4:7], 0
    v_mfma_f32_16x16x32_bf16 v[248:251], a[160:163], a[8:11], 0
    ds_read_b128 a[160:163], v11 offset:30720
    v_mfma_f32_16x16x32_bf16 v[232:235], a[164:167], a[12:15], v[232:235]
    v_mfma_f32_16x16x32_bf16 v[240:243], a[164:167], a[16:19], v[240:243]
    v_mfma_f32_16x16x32_bf16 v[248:251], a[164:167], a[20:23], v[248:251]
    buffer_load_dwordx4 v3, s[16:19], s57 offen offset:1024 nt lds
    v_mfma_f32_16x16x32_bf16 v[232:235], a[168:171], a[24:27], v[232:235]
    ds_read_b128 a[164:167], v12 offset:30720
    v_mfma_f32_16x16x32_bf16 v[240:243], a[168:171], a[28:31], v[240:243]
    v_mfma_f32_16x16x32_bf16 v[248:251], a[168:171], a[32:35], v[248:251]
    ds_read_b128 a[168:171], v11 offset:30848
    v_mfma_f32_16x16x32_bf16 v[232:235], a[172:175], a[36:39], v[232:235]
    v_mfma_f32_16x16x32_bf16 v[240:243], a[172:175], a[40:43], v[240:243]
    buffer_load_dwordx4 v4, s[16:19], s57 offen offset:2048 nt lds
    v_mfma_f32_16x16x32_bf16 v[248:251], a[172:175], a[44:47], v[248:251]
    s_add_u32 m0, s51, 122880
    ds_read_b128 a[172:175], v12 offset:30848
    s_add_u32 s57, s62, 6144
    v_mfma_f32_16x16x32_bf16 v[232:235], a[176:179], a[48:51], v[232:235]
    v_mfma_f32_16x16x32_bf16 v[240:243], a[176:179], a[52:55], v[240:243]
    v_mfma_f32_16x16x32_bf16 v[248:251], a[176:179], a[56:59], v[248:251]
    ds_read_b128 a[176:179], v11 offset:30976
    v_mfma_f32_16x16x32_bf16 v[232:235], a[180:183], a[60:63], v[232:235]
    v_mfma_f32_16x16x32_bf16 v[240:243], a[180:183], a[64:67], v[240:243]
    v_mfma_f32_16x16x32_bf16 v[248:251], a[180:183], a[68:71], v[248:251]
    s_waitcnt lgkmcnt(2)
    ds_read_b128 a[180:183], v12 offset:30976
    v_mfma_f32_16x16x32_bf16 v[236:239], a[160:163], a[0:3], 0
    s_nop 2
    v_max3_f32 v36, v36, v232, v233
    v_max3_f32 v36, v36, v234, v235
    v_mfma_f32_16x16x32_bf16 v[244:247], a[160:163], a[4:7], 0
    v_max3_f32 v37, v37, v240, v241
    v_max3_f32 v37, v37, v242, v243
    v_mfma_f32_16x16x32_bf16 v[252:255], a[160:163], a[8:11], 0
    v_max3_f32 v38, v38, v248, v249
    v_max3_f32 v38, v38, v250, v251
    v_mfma_f32_16x16x32_bf16 v[236:239], a[164:167], a[12:15], v[236:239]
    v_mfma_f32_16x16x32_bf16 v[244:247], a[164:167], a[16:19], v[244:247]
    v_mfma_f32_16x16x32_bf16 v[252:255], a[164:167], a[20:23], v[252:255]
    v_mfma_f32_16x16x32_bf16 v[236:239], a[168:171], a[24:27], v[236:239]
    v_mfma_f32_16x16x32_bf16 v[244:247], a[168:171], a[28:31], v[244:247]
    v_mfma_f32_16x16x32_bf16 v[252:255], a[168:171], a[32:35], v[252:255]
    s_waitcnt lgkmcnt(0)
    v_mfma_f32_16x16x32_bf16 v[236:239], a[172:175], a[36:39], v[236:239]
    v_mfma_f32_16x16x32_bf16 v[244:247], a[172:175], a[40:43], v[244:247]
    v_mfma_f32_16x16x32_bf16 v[252:255], a[172:175], a[44:47], v[252:255]
    v_mfma_f32_16x16x32_bf16 v[236:239], a[176:179], a[48:51], v[236:239]
    v_mfma_f32_16x16x32_bf16 v[244:247], a[176:179], a[52:55], v[244:247]
    v_mfma_f32_16x16x32_bf16 v[252:255], a[176:179], a[56:59], v[252:255]
    v_mfma_f32_16x16x32_bf16 v[236:239], a[180:183], a[60:63], v[236:239]
    v_mfma_f32_16x16x32_bf16 v[244:247], a[180:183], a[64:67], v[244:247]
    v_mfma_f32_16x16x32_bf16 v[252:255], a[180:183], a[68:71], v[252:255]
    v_mfma_f32_16x16x32_bf16 a[72:75], a[196:199], a[232:235], a[72:75]
    s_nop 4
    v_max3_f32 v36, v36, v236, v237
    v_max3_f32 v36, v36, v238, v239
    v_mfma_f32_16x16x32_bf16 a[76:79], a[196:199], a[236:239], a[76:79]
    v_max3_f32 v37, v37, v244, v245
    v_max3_f32 v37, v37, v246, v247
    v_mfma_f32_16x16x32_bf16 a[80:83], a[196:199], a[240:243], a[80:83]
    v_max3_f32 v38, v38, v252, v253
    v_max3_f32 v38, v38, v254, v255
    v_mfma_f32_16x16x32_bf16 a[84:87], a[196:199], a[244:247], a[84:87]
    v_mov_b32 v48, v36
    v_mov_b32 v49, v37
    v_mfma_f32_16x16x32_bf16 a[88:91], a[196:199], a[248:251], a[88:91]
    v_mov_b32 v50, v38
    v_permlane32_swap_b32 v48, v36
    v_mfma_f32_16x16x32_bf16 a[92:95], a[196:199], a[252:255], a[92:95]
    v_permlane32_swap_b32 v49, v37
    v_permlane32_swap_b32 v50, v38
    v_mfma_f32_16x16x32_bf16 a[96:99], a[200:203], a[232:235], a[96:99]
    v_max_f32 v36, v48, v36
    v_max_f32 v37, v49, v37
    v_mfma_f32_16x16x32_bf16 a[100:103], a[200:203], a[236:239], a[100:103]
    v_max_f32 v38, v50, v38
    v_mov_b32 v48, v36
    v_mfma_f32_16x16x32_bf16 a[104:107], a[200:203], a[240:243], a[104:107]
    v_mov_b32 v49, v37
    v_mov_b32 v50, v38
    v_mfma_f32_16x16x32_bf16 a[108:111], a[200:203], a[244:247], a[108:111]
    v_permlane16_swap_b32 v48, v36
    v_permlane16_swap_b32 v49, v37
    v_mfma_f32_16x16x32_bf16 a[112:115], a[200:203], a[248:251], a[112:115]
    v_permlane16_swap_b32 v50, v38
    v_max_f32 v36, v48, v36
    v_mfma_f32_16x16x32_bf16 a[116:119], a[200:203], a[252:255], a[116:119]
    v_max_f32 v37, v49, v37
    v_max_f32 v38, v50, v38
    v_mfma_f32_16x16x32_bf16 a[120:123], a[204:207], a[232:235], a[120:123]
    ds_write_b128 v31, v[36:39]
    v_mfma_f32_16x16x32_bf16 a[124:127], a[204:207], a[236:239], a[124:127]
    v_and_b32 v48, 15, v34
    v_and_b32 v50, 1, v48
    v_mfma_f32_16x16x32_bf16 a[128:131], a[204:207], a[240:243], a[128:131]
    v_lshlrev_b32 v50, 4, v50
    v_lshrrev_b32 v49, 4, v34
    v_mfma_f32_16x16x32_bf16 a[132:135], a[204:207], a[244:247], a[132:135]
    v_mfma_f32_16x16x32_bf16 a[136:139], a[204:207], a[248:251], a[136:139]
    v_mfma_f32_16x16x32_bf16 a[140:143], a[204:207], a[252:255], a[140:143]
    s_waitcnt vmcnt(15) lgkmcnt(0)
    s_barrier
    ds_read_b128 a[208:211], v25 offset:12288
    buffer_load_dwordx4 v8, s[8:11], s61 offen lds
    ds_read_b64_tr_b16 a[184:185], v21 offset:24576
    ds_read_b64_tr_b16 a[186:187], v21 offset:26112
    buffer_load_dwordx4 v9, s[8:11], s61 offen offset:1024 lds
    ds_read_b128 a[212:215], v25 offset:14336
    buffer_load_dwordx4 v10, s[8:11], s61 offen offset:2048 lds
    ds_read_b128 a[216:219], v25 offset:16384
    s_add_u32 m0, s51, 86016
    ds_read_b128 a[220:223], v25 offset:18432
    buffer_load_dwordx4 v5, s[20:23], s57 offen lds
    s_add_u32 s61, s61, 128
    ds_read_b128 a[224:227], v25 offset:20480
    s_cmp_eq_u32 s61, 1280
    s_cselect_b32 s61, 0, s61
    buffer_load_dwordx4 v6, s[20:23], s57 offen offset:1024 lds
    ds_read_b128 a[228:231], v25 offset:22528
    buffer_load_dwordx4 v7, s[20:23], s57 offen offset:2048 lds
    ds_read_b64_tr_b16 a[188:189], v22 offset:24576
    s_waitcnt lgkmcnt(6)
    v_mfma_f32_16x16x32_bf16 a[72:75], a[184:187], a[208:211], a[72:75]
    s_mov_b32 s57, 49152
    ds_read_b64_tr_b16 a[190:191], v22 offset:26112
    ds_read_b128 v[40:43], v32
    s_waitcnt lgkmcnt(7)
    v_mfma_f32_16x16x32_bf16 a[76:79], a[184:187], a[212:215], a[76:79]
    s_add_u32 m0, s51, 24576
    ds_read_b64_tr_b16 a[192:193], v23 offset:24576
    buffer_load_dwordx4 v2, s[16:19], s57 offen nt lds
    s_waitcnt lgkmcnt(7)
    v_mfma_f32_16x16x32_bf16 a[80:83], a[184:187], a[216:219], a[80:83]
    s_waitcnt lgkmcnt(6)
    ds_read_b64_tr_b16 a[194:195], v23 offset:26112
    ds_read_b128 a[232:235], v26 offset:12288
    v_mfma_f32_16x16x32_bf16 a[84:87], a[184:187], a[220:223], a[84:87]
    s_waitcnt lgkmcnt(7)
    buffer_load_dwordx4 v3, s[16:19], s57 offen offset:1024 nt lds
    v_mfma_f32_16x16x32_bf16 a[88:91], a[184:187], a[224:227], a[88:91]
    s_waitcnt lgkmcnt(6)
    ds_read_b128 a[236:239], v26 offset:14336
    buffer_load_dwordx4 v4, s[16:19], s57 offen offset:2048 nt lds
    v_mfma_f32_16x16x32_bf16 a[92:95], a[184:187], a[228:231], a[92:95]
    s_mov_b32 s57, 61440
    s_add_u32 m0, s51, 36864
    ds_read_b128 a[240:243], v26 offset:16384
    s_waitcnt lgkmcnt(6)
    v_mfma_f32_16x16x32_bf16 a[96:99], a[188:191], a[208:211], a[96:99]
    buffer_load_dwordx4 v2, s[16:19], s57 offen nt lds
    v_mfma_f32_16x16x32_bf16 a[100:103], a[188:191], a[212:215], a[100:103]
    s_waitcnt lgkmcnt(5)
    ds_read_b128 a[244:247], v26 offset:18432
    v_max_f32 v44, v36, v40
    v_mfma_f32_16x16x32_bf16 a[104:107], a[188:191], a[216:219], a[104:107]
    buffer_load_dwordx4 v3, s[16:19], s57 offen offset:1024 nt lds
    v_mfma_f32_16x16x32_bf16 a[108:111], a[188:191], a[220:223], a[108:111]
    ds_read_b128 a[248:251], v26 offset:20480
    v_max_f32 v45, v37, v41
    v_mfma_f32_16x16x32_bf16 a[112:115], a[188:191], a[224:227], a[112:115]
    buffer_load_dwordx4 v4, s[16:19], s57 offen offset:2048 nt lds
    v_mfma_f32_16x16x32_bf16 a[116:119], a[188:191], a[228:231], a[116:119]
    s_add_u32 s57, s62, 399360
    ds_read_b128 a[252:255], v26 offset:22528
    s_add_u32 m0, s51, 98304
    s_waitcnt lgkmcnt(3)
    v_mfma_f32_16x16x32_bf16 a[120:123], a[192:195], a[208:211], a[120:123]
    s_mul_i32 s62, s61, 6144
    s_waitcnt vmcnt(18)
    s_barrier
    v_mfma_f32_16x16x32_bf16 a[124:127], a[192:195], a[212:215], a[124:127]
    ds_read_b64_tr_b16 a[196:197], v21 offset:0
    ds_read_b64_tr_b16 a[198:199], v21 offset:1536
    v_mfma_f32_16x16x32_bf16 a[128:131], a[192:195], a[216:219], a[128:131]
    ds_read_b64_tr_b16 a[200:201], v22 offset:0
    ds_read_b64_tr_b16 a[202:203], v22 offset:1536
    v_mfma_f32_16x16x32_bf16 a[132:135], a[192:195], a[220:223], a[132:135]
    ds_read_b64_tr_b16 a[204:205], v23 offset:0
    v_max_f32 v46, v38, v42
    v_mfma_f32_16x16x32_bf16 a[136:139], a[192:195], a[224:227], a[136:139]
    buffer_load_dwordx4 v5, s[20:23], s57 offen lds
    v_mfma_f32_16x16x32_bf16 a[140:143], a[192:195], a[228:231], a[140:143]
    ds_read_b64_tr_b16 a[206:207], v23 offset:1536
    v_mul_f32 v44, s52, v44
    v_mul_f32 v45, s52, v45
    v_mul_f32 v46, s52, v46
    v_fma_f32 v64, v64, s52, -v44
    v_fma_f32 v65, v65, s52, -v44
    v_fma_f32 v72, v72, s52, -v45
    v_fma_f32 v73, v73, s52, -v45
    v_fma_f32 v80, v80, s52, -v46
    s_waitcnt lgkmcnt(4)
    v_mfma_f32_16x16x32_bf16 a[72:75], a[196:199], a[232:235], a[72:75]
    v_fma_f32 v81, v81, s52, -v46
    v_fma_f32 v66, v66, s52, -v44
    v_mfma_f32_16x16x32_bf16 a[76:79], a[196:199], a[236:239], a[76:79]
    v_exp_f32 v64, v64
    v_mfma_f32_16x16x32_bf16 a[80:83], a[196:199], a[240:243], a[80:83]
    buffer_load_dwordx4 v6, s[20:23], s57 offen offset:1024 lds
    v_mfma_f32_16x16x32_bf16 a[84:87], a[196:199], a[244:247], a[84:87]
    v_exp_f32 v65, v65
    v_mfma_f32_16x16x32_bf16 a[88:91], a[196:199], a[248:251], a[88:91]
    v_fma_f32 v67, v67, s52, -v44
    v_fma_f32 v74, v74, s52, -v45
    v_mfma_f32_16x16x32_bf16 a[92:95], a[196:199], a[252:255], a[92:95]
    s_waitcnt lgkmcnt(0)
    v_exp_f32 v72, v72
    v_mfma_f32_16x16x32_bf16 a[96:99], a[200:203], a[232:235], a[96:99]
    v_exp_f32 v73, v73
    v_mfma_f32_16x16x32_bf16 a[100:103], a[200:203], a[236:239], a[100:103]
    v_fma_f32 v75, v75, s52, -v45
    v_fma_f32 v82, v82, s52, -v46
    v_mfma_f32_16x16x32_bf16 a[104:107], a[200:203], a[240:243], a[104:107]
    buffer_load_dwordx4 v7, s[20:23], s57 offen offset:2048 lds
    v_mfma_f32_16x16x32_bf16 a[108:111], a[200:203], a[244:247], a[108:111]
    s_add_u32 m0, s51, 110592
    v_exp_f32 v80, v80
    v_mfma_f32_16x16x32_bf16 a[112:115], a[200:203], a[248:251], a[112:115]
    s_add_u32 s57, s62, 6144
    v_exp_f32 v81, v81
    v_mfma_f32_16x16x32_bf16 a[116:119], a[200:203], a[252:255], a[116:119]
    v_fma_f32 v83, v83, s52, -v46
    v_fma_f32 v68, v68, s52, -v44
    v_mfma_f32_16x16x32_bf16 a[120:123], a[204:207], a[232:235], a[120:123]
    v_exp_f32 v66, v66
    v_mfma_f32_16x16x32_bf16 a[124:127], a[204:207], a[236:239], a[124:127]
    v_exp_f32 v67, v67
    v_mfma_f32_16x16x32_bf16 a[128:131], a[204:207], a[240:243], a[128:131]
    v_fma_f32 v69, v69, s52, -v44
    v_fma_f32 v70, v70, s52, -v44
    v_mfma_f32_16x16x32_bf16 a[132:135], a[204:207], a[244:247], a[132:135]
    v_fma_f32 v71, v71, s52, -v44
    v_fma_f32 v76, v76, s52, -v45
    v_mfma_f32_16x16x32_bf16 a[136:139], a[204:207], a[248:251], a[136:139]
    v_exp_f32 v74, v74
    v_mfma_f32_16x16x32_bf16 a[140:143], a[204:207], a[252:255], a[140:143]
    v_exp_f32 v75, v75
    v_fma_f32 v77, v77, s52, -v45
    v_fma_f32 v78, v78, s52, -v45
    v_fma_f32 v79, v79, s52, -v45
    v_exp_f32 v82, v82
    v_exp_f32 v83, v83
    v_fma_f32 v84, v84, s52, -v46
    v_fma_f32 v85, v85, s52, -v46
    v_fma_f32 v86, v86, s52, -v46
    v_fma_f32 v87, v87, s52, -v46
    v_exp_f32 v68, v68
    v_exp_f32 v69, v69
    v_exp_f32 v70, v70
    v_exp_f32 v71, v71
    v_exp_f32 v76, v76
    v_exp_f32 v77, v77
    v_exp_f32 v78, v78
    v_exp_f32 v79, v79
    v_exp_f32 v84, v84
    v_exp_f32 v85, v85
    v_exp_f32 v86, v86
    v_exp_f32 v87, v87
    v_cvt_pk_bf16_f32 v64, v64, v65
    v_cvt_pk_bf16_f32 v72, v72, v73
    v_cvt_pk_bf16_f32 v80, v80, v81
    v_cvt_pk_bf16_f32 v65, v66, v67
    v_cvt_pk_bf16_f32 v73, v74, v75
    v_cvt_pk_bf16_f32 v81, v82, v83
    v_cvt_pk_bf16_f32 v66, v68, v69
    v_cvt_pk_bf16_f32 v67, v70, v71
    v_cvt_pk_bf16_f32 v74, v76, v77
    v_cvt_pk_bf16_f32 v75, v78, v79
    v_mfma_f32_16x16x32_bf16 a[144:147], a[156:159], v[64:67], 0
    ds_write_b128 v27, v[64:67] offset:0
    v_mfma_f32_16x16x32_bf16 a[148:151], a[156:159], v[72:75], 0
    v_cvt_pk_bf16_f32 v82, v84, v85
    v_cvt_pk_bf16_f32 v83, v86, v87
    v_fma_f32 v88, v88, s52, -v44
    v_fma_f32 v89, v89, s52, -v44
    v_mfma_f32_16x16x32_bf16 a[152:155], a[156:159], v[80:83], 0
    ds_write_b128 v27, v[72:75] offset:1024
    v_exp_f32 v88, v88
    v_exp_f32 v89, v89
    v_fma_f32 v90, v90, s52, -v44
    v_fma_f32 v91, v91, s52, -v44
    ds_write_b128 v27, v[80:83] offset:2048
    v_exp_f32 v90, v90
    v_exp_f32 v91, v91
    v_fma_f32 v92, v92, s52, -v44
    v_fma_f32 v93, v93, s52, -v44
    v_fma_f32 v94, v94, s52, -v44
    v_fma_f32 v95, v95, s52, -v44
    v_exp_f32 v92, v92
    v_exp_f32 v93, v93
    v_exp_f32 v94, v94
    v_exp_f32 v95, v95
    v_cvt_pk_bf16_f32 v88, v88, v89
    v_fma_f32 v96, v96, s52, -v45
    v_fma_f32 v97, v97, s52, -v45
    v_cvt_pk_bf16_f32 v89, v90, v91
    v_exp_f32 v96, v96
    v_exp_f32 v97, v97
    v_fma_f32 v98, v98, s52, -v45
    s_waitcnt vmcnt(9) lgkmcnt(0)
    s_barrier
    ds_read_b64_tr_b16 a[160:161], v13 offset:49152
    ds_read_b64_tr_b16 a[162:163], v13 offset:55296
    ds_read_b64_tr_b16 a[164:165], v14 offset:49152
    buffer_load_dwordx4 v8, s[8:11], s61 offen lds
    ds_read_b64_tr_b16 a[166:167], v14 offset:55296
    ds_read_b64_tr_b16 a[168:169], v15 offset:49152
    v_fma_f32 v99, v99, s52, -v45
    ds_read_b64_tr_b16 a[170:171], v15 offset:55296
    ds_read_b64_tr_b16 a[172:173], v16 offset:49152
    ds_read_b64_tr_b16 a[174:175], v16 offset:55296
    v_cvt_pk_bf16_f32 v90, v92, v93
    ds_read_b64_tr_b16 a[176:177], v13 offset:49280
    ds_read_b64_tr_b16 a[178:179], v13 offset:55424
    ds_read_b64_tr_b16 a[180:181], v14 offset:49280
    v_cvt_pk_bf16_f32 v91, v94, v95
    ds_read_b64_tr_b16 a[182:183], v14 offset:55424
    ds_read_b128 v[68:71], v28 offset:0
    v_exp_f32 v98, v98
    s_waitcnt lgkmcnt(11)
    v_mfma_f32_16x16x32_bf16 a[0:3], a[160:163], v[64:67], 0
    ds_read_b128 v[76:79], v28 offset:1024
    v_fma_f32 v100, v100, s52, -v45
    v_mfma_f32_16x16x32_bf16 a[4:7], a[160:163], v[72:75], 0
    buffer_load_dwordx4 v9, s[8:11], s61 offen offset:1024 lds
    v_mfma_f32_16x16x32_bf16 a[8:11], a[160:163], v[80:83], 0
    s_waitcnt lgkmcnt(8)
    ds_read_b64_tr_b16 a[160:161], v17 offset:49152
    ds_read_b64_tr_b16 a[162:163], v17 offset:55296
    v_mfma_f32_16x16x32_bf16 a[12:15], a[164:167], v[64:67], 0
    ds_read_b128 v[84:87], v28 offset:2048
    v_fma_f32 v101, v101, s52, -v45
    v_mfma_f32_16x16x32_bf16 a[16:19], a[164:167], v[72:75], 0
    ds_read_b128 a[208:211], v25 offset:24576
    v_fma_f32 v102, v102, s52, -v45
    v_mfma_f32_16x16x32_bf16 a[20:23], a[164:167], v[80:83], 0
    ds_read_b64_tr_b16 a[164:165], v18 offset:49152
    ds_read_b64_tr_b16 a[166:167], v18 offset:55296
    v_mfma_f32_16x16x32_bf16 a[24:27], a[168:171], v[64:67], 0
    ds_read_b64_tr_b16 a[184:185], v21 offset:12288
    ds_read_b64_tr_b16 a[186:187], v21 offset:13824
    v_mfma_f32_16x16x32_bf16 a[28:31], a[168:171], v[72:75], 0
    ds_read_b128 a[212:215], v25 offset:26624
    v_fma_f32 v103, v103, s52, -v45
    v_mfma_f32_16x16x32_bf16 a[32:35], a[168:171], v[80:83], 0
    s_waitcnt lgkmcnt(9)
    ds_read_b64_tr_b16 a[168:169], v19 offset:49152
    ds_read_b64_tr_b16 a[170:171], v19 offset:55296
    v_mfma_f32_16x16x32_bf16 a[36:39], a[172:175], v[64:67], 0
    buffer_load_dwordx4 v10, s[8:11], s61 offen offset:2048 lds
    v_mfma_f32_16x16x32_bf16 a[40:43], a[172:175], v[72:75], 0
    s_add_u32 m0, s51, 73728
    ds_read_b128 a[216:219], v25 offset:28672
    v_cvt_pk_bf16_f32 v96, v96, v97
    v_mfma_f32_16x16x32_bf16 a[44:47], a[172:175], v[80:83], 0
    s_add_u32 s61, s61, 128
    ds_read_b64_tr_b16 a[172:173], v20 offset:49152
    ds_read_b64_tr_b16 a[174:175], v20 offset:55296
    v_mfma_f32_16x16x32_bf16 a[48:51], a[176:179], v[64:67], 0
    ds_read_b128 a[220:223], v25 offset:30720
    v_fma_f32 v104, v104, s52, -v46
    v_mfma_f32_16x16x32_bf16 a[52:55], a[176:179], v[72:75], 0
    ds_read_b128 a[224:227], v25 offset:32768
    v_fma_f32 v105, v105, s52, -v46
    v_mfma_f32_16x16x32_bf16 a[56:59], a[176:179], v[80:83], 0
    ds_read_b64_tr_b16 a[176:177], v17 offset:49280
    ds_read_b64_tr_b16 a[178:179], v17 offset:55424
    v_mfma_f32_16x16x32_bf16 a[60:63], a[180:183], v[64:67], 0
    ds_read_b128 a[228:231], v25 offset:34816
    v_fma_f32 v106, v106, s52, -v46
    v_mfma_f32_16x16x32_bf16 a[64:67], a[180:183], v[72:75], 0
    ds_read_b64_tr_b16 a[188:189], v22 offset:12288
    ds_read_b64_tr_b16 a[190:191], v22 offset:13824
    v_mfma_f32_16x16x32_bf16 a[68:71], a[180:183], v[80:83], 0
    s_waitcnt lgkmcnt(9)
    buffer_load_dwordx4 v5, s[20:23], s57 offen lds
    v_mfma_f32_16x16x32_bf16 a[0:3], a[160:163], v[68:71], a[0:3]
    ds_read_b64_tr_b16 a[180:181], v18 offset:49280
    ds_read_b64_tr_b16 a[182:183], v18 offset:55424
    v_mfma_f32_16x16x32_bf16 a[4:7], a[160:163], v[76:79], a[4:7]
    ds_read_b64_tr_b16 a[192:193], v23 offset:12288
    ds_read_b64_tr_b16 a[194:195], v23 offset:13824
    v_mfma_f32_16x16x32_bf16 a[8:11], a[160:163], v[84:87], a[8:11]
    ds_read_b128 a[232:235], v26 offset:24576
    v_fma_f32 v107, v107, s52, -v46
    v_mfma_f32_16x16x32_bf16 a[12:15], a[164:167], v[68:71], a[12:15]
    ds_read_b128 a[236:239], v26 offset:26624
    v_fma_f32 v108, v108, s52, -v46
    v_mfma_f32_16x16x32_bf16 a[16:19], a[164:167], v[76:79], a[16:19]
    ds_read_b128 a[240:243], v26 offset:28672
    v_fma_f32 v109, v109, s52, -v46
    v_mfma_f32_16x16x32_bf16 a[20:23], a[164:167], v[84:87], a[20:23]
    ds_read_b128 a[244:247], v26 offset:30720
    v_fma_f32 v110, v110, s52, -v46
    v_mfma_f32_16x16x32_bf16 a[24:27], a[168:171], v[68:71], a[24:27]
    ds_read_b128 a[248:251], v26 offset:32768
    v_fma_f32 v111, v111, s52, -v46
    v_mfma_f32_16x16x32_bf16 a[28:31], a[168:171], v[76:79], a[28:31]
    buffer_load_dwordx4 v6, s[20:23], s57 offen offset:1024 lds
    v_mfma_f32_16x16x32_bf16 a[32:35], a[168:171], v[84:87], a[32:35]
    s_waitcnt lgkmcnt(5)
    ds_read_b128 a[252:255], v26 offset:34816
    v_fma_f32 v112, v112, s52, -v44
    v_mfma_f32_16x16x32_bf16 a[36:39], a[172:175], v[68:71], a[36:39]
    ds_write_b128 v27, v[88:91] offset:12288
    v_mfma_f32_16x16x32_bf16 a[40:43], a[172:175], v[76:79], a[40:43]
    v_exp_f32 v99, v99
    v_mfma_f32_16x16x32_bf16 a[44:47], a[172:175], v[84:87], a[44:47]
    v_exp_f32 v100, v100
    v_mfma_f32_16x16x32_bf16 a[48:51], a[176:179], v[68:71], a[48:51]
    v_exp_f32 v101, v101
    v_mfma_f32_16x16x32_bf16 a[52:55], a[176:179], v[76:79], a[52:55]
    v_exp_f32 v102, v102
    v_mfma_f32_16x16x32_bf16 a[56:59], a[176:179], v[84:87], a[56:59]
    buffer_load_dwordx4 v7, s[20:23], s57 offen offset:2048 lds
    v_mfma_f32_16x16x32_bf16 a[60:63], a[180:183], v[68:71], a[60:63]
    s_add_u32 s57, s62, 399360
    s_waitcnt vmcnt(6)
    s_barrier
    v_mfma_f32_16x16x32_bf16 a[64:67], a[180:183], v[76:79], a[64:67]
    s_add_u32 m0, s51, 86016
    ds_read_b64_tr_b16 a[196:197], v21 offset:24576
    ds_read_b64_tr_b16 a[198:199], v21 offset:26112
    v_mfma_f32_16x16x32_bf16 a[68:71], a[180:183], v[84:87], a[68:71]
    buffer_load_dwordx4 v5, s[20:23], s57 offen lds
    v_mfma_f32_16x16x32_bf16 a[72:75], a[184:187], a[208:211], a[72:75]
    ds_read_b64_tr_b16 a[200:201], v22 offset:24576
    ds_read_b64_tr_b16 a[202:203], v22 offset:26112
    v_mfma_f32_16x16x32_bf16 a[76:79], a[184:187], a[212:215], a[76:79]
    buffer_load_dwordx4 v6, s[20:23], s57 offen offset:1024 lds
    v_mfma_f32_16x16x32_bf16 a[80:83], a[184:187], a[216:219], a[80:83]
    ds_read_b64_tr_b16 a[204:205], v23 offset:24576
    ds_read_b64_tr_b16 a[206:207], v23 offset:26112
    v_mfma_f32_16x16x32_bf16 a[84:87], a[184:187], a[220:223], a[84:87]
    buffer_load_dwordx4 v7, s[20:23], s57 offen offset:2048 lds
    v_mfma_f32_16x16x32_bf16 a[88:91], a[184:187], a[224:227], a[88:91]
    s_mov_b32 s57, 73728
    v_exp_f32 v103, v103
    v_mfma_f32_16x16x32_bf16 a[92:95], a[184:187], a[228:231], a[92:95]
    s_add_u32 m0, s51, 49152
    v_cvt_pk_bf16_f32 v97, v98, v99
    v_cvt_pk_bf16_f32 v98, v100, v101
    v_mfma_f32_16x16x32_bf16 a[96:99], a[188:191], a[208:211], a[96:99]
    buffer_load_dwordx4 v2, s[16:19], s57 offen nt lds
    v_mfma_f32_16x16x32_bf16 a[100:103], a[188:191], a[212:215], a[100:103]
    v_exp_f32 v104, v104
    v_mfma_f32_16x16x32_bf16 a[104:107], a[188:191], a[216:219], a[104:107]
    buffer_load_dwordx4 v3, s[16:19], s57 offen offset:1024 nt lds
    v_mfma_f32_16x16x32_bf16 a[108:111], a[188:191], a[220:223], a[108:111]
    v_exp_f32 v105, v105
    v_mfma_f32_16x16x32_bf16 a[112:115], a[188:191], a[224:227], a[112:115]
    buffer_load_dwordx4 v4, s[16:19], s57 offen offset:2048 nt lds
    v_mfma_f32_16x16x32_bf16 a[116:119], a[188:191], a[228:231], a[116:119]
    s_mov_b32 s57, 86016
    v_cvt_pk_bf16_f32 v99, v102, v103
    v_cvt_pk_bf16_f32 v104, v104, v105
    v_mfma_f32_16x16x32_bf16 a[120:123], a[192:195], a[208:211], a[120:123]
    s_add_u32 m0, s51, 61440
    ds_write_b128 v27, v[96:99] offset:13312
    v_mfma_f32_16x16x32_bf16 a[124:127], a[192:195], a[212:215], a[124:127]
    buffer_load_dwordx4 v2, s[16:19], s57 offen nt lds
    v_mfma_f32_16x16x32_bf16 a[128:131], a[192:195], a[216:219], a[128:131]
    v_exp_f32 v106, v106
    v_mfma_f32_16x16x32_bf16 a[132:135], a[192:195], a[220:223], a[132:135]
    buffer_load_dwordx4 v3, s[16:19], s57 offen offset:1024 nt lds
    v_mfma_f32_16x16x32_bf16 a[136:139], a[192:195], a[224:227], a[136:139]
    v_exp_f32 v107, v107
    v_mfma_f32_16x16x32_bf16 a[140:143], a[192:195], a[228:231], a[140:143]
    buffer_load_dwordx4 v4, s[16:19], s57 offen offset:2048 nt lds
    v_mfma_f32_16x16x32_bf16 a[144:147], a[156:159], v[88:91], a[144:147]
    s_add_u32 m0, s51, 122880
    v_exp_f32 v108, v108
    v_mfma_f32_16x16x32_bf16 a[148:151], a[156:159], v[96:99], a[148:151]
    v_exp_f32 v109, v109
    v_exp_f32 v110, v110
    v_exp_f32 v111, v111
    v_cvt_pk_bf16_f32 v105, v106, v107
    v_cvt_pk_bf16_f32 v106, v108, v109
    v_cvt_pk_bf16_f32 v107, v110, v111
    s_cmp_eq_u32 s61, 1280
    s_cselect_b32 s61, 0, s61
    v_mfma_f32_16x16x32_bf16 a[152:155], a[156:159], v[104:107], a[152:155]
    s_mul_i32 s62, s61, 6144
    ds_write_b128 v27, v[104:107] offset:14336
    s_waitcnt lgkmcnt(1)
    v_mfma_f32_16x16x32_bf16 a[72:75], a[196:199], a[232:235], a[72:75]
    s_add_u32 s57, s62, 6144
    v_fma_f32 v113, v113, s52, -v44
    v_fma_f32 v114, v114, s52, -v44
    v_mfma_f32_16x16x32_bf16 a[76:79], a[196:199], a[236:239], a[76:79]
    v_exp_f32 v112, v112
    v_mfma_f32_16x16x32_bf16 a[80:83], a[196:199], a[240:243], a[80:83]
    v_exp_f32 v113, v113
    v_mfma_f32_16x16x32_bf16 a[84:87], a[196:199], a[244:247], a[84:87]
    v_fma_f32 v115, v115, s52, -v44
    v_fma_f32 v116, v116, s52, -v44
    v_mfma_f32_16x16x32_bf16 a[88:91], a[196:199], a[248:251], a[88:91]
    v_exp_f32 v114, v114
    v_mfma_f32_16x16x32_bf16 a[92:95], a[196:199], a[252:255], a[92:95]
    v_exp_f32 v115, v115
    v_mfma_f32_16x16x32_bf16 a[96:99], a[200:203], a[232:235], a[96:99]
    s_waitcnt vmcnt(9) lgkmcnt(0)
    s_barrier
    ds_read_b64_tr_b16 a[160:161], v13 offset:0
    v_mfma_f32_16x16x32_bf16 a[100:103], a[200:203], a[236:239], a[100:103]
    ds_read_b64_tr_b16 a[162:163], v13 offset:6144
    ds_read_b64_tr_b16 a[164:165], v14 offset:0
    v_mfma_f32_16x16x32_bf16 a[104:107], a[200:203], a[240:243], a[104:107]
    ds_read_b64_tr_b16 a[166:167], v14 offset:6144
    ds_read_b64_tr_b16 a[168:169], v15 offset:0
    v_mfma_f32_16x16x32_bf16 a[108:111], a[200:203], a[244:247], a[108:111]
    ds_read_b64_tr_b16 a[170:171], v15 offset:6144
    ds_read_b64_tr_b16 a[172:173], v16 offset:0
    v_mfma_f32_16x16x32_bf16 a[112:115], a[200:203], a[248:251], a[112:115]
    ds_read_b64_tr_b16 a[174:175], v16 offset:6144
    ds_read_b64_tr_b16 a[176:177], v13 offset:128
    v_mfma_f32_16x16x32_bf16 a[116:119], a[200:203], a[252:255], a[116:119]
    ds_read_b64_tr_b16 a[178:179], v13 offset:6272
    ds_read_b64_tr_b16 a[180:181], v14 offset:128
    v_mfma_f32_16x16x32_bf16 a[120:123], a[204:207], a[232:235], a[120:123]
    ds_read_b64_tr_b16 a[182:183], v14 offset:6272
    ds_read_b128 v[92:95], v28 offset:12288
    v_mfma_f32_16x16x32_bf16 a[124:127], a[204:207], a[236:239], a[124:127]
    buffer_load_dwordx4 v8, s[8:11], s61 offen lds
    v_mfma_f32_16x16x32_bf16 a[128:131], a[204:207], a[240:243], a[128:131]
    ds_read_b128 v[100:103], v28 offset:13312
    v_fma_f32 v117, v117, s52, -v44
    v_mfma_f32_16x16x32_bf16 a[132:135], a[204:207], a[244:247], a[132:135]
    ds_read_b128 v[108:111], v28 offset:14336
    v_fma_f32 v118, v118, s52, -v44
    v_mfma_f32_16x16x32_bf16 a[136:139], a[204:207], a[248:251], a[136:139]
    ds_read_b128 a[208:211], v25 offset:12288
    v_fma_f32 v119, v119, s52, -v44
    v_mfma_f32_16x16x32_bf16 a[140:143], a[204:207], a[252:255], a[140:143]
    s_waitcnt lgkmcnt(7)
    ds_read_b64_tr_b16 a[184:185], v21 offset:0
    ds_read_b64_tr_b16 a[186:187], v21 offset:1536
    v_mfma_f32_16x16x32_bf16 a[0:3], a[160:163], v[88:91], a[0:3]
    ds_read_b128 a[212:215], v25 offset:14336
    v_cvt_pk_bf16_f32 v112, v112, v113
    v_mfma_f32_16x16x32_bf16 a[4:7], a[160:163], v[96:99], a[4:7]
    ds_read_b128 a[216:219], v25 offset:16384
    v_fma_f32 v120, v120, s52, -v45
    v_mfma_f32_16x16x32_bf16 a[8:11], a[160:163], v[104:107], a[8:11]
    ds_read_b64_tr_b16 a[160:161], v17 offset:0
    ds_read_b64_tr_b16 a[162:163], v17 offset:6144
    v_mfma_f32_16x16x32_bf16 a[12:15], a[164:167], v[88:91], a[12:15]
    buffer_load_dwordx4 v9, s[8:11], s61 offen offset:1024 lds
    v_mfma_f32_16x16x32_bf16 a[16:19], a[164:167], v[96:99], a[16:19]
    ds_read_b128 a[220:223], v25 offset:18432
    v_fma_f32 v121, v121, s52, -v45
    v_mfma_f32_16x16x32_bf16 a[20:23], a[164:167], v[104:107], a[20:23]
    ds_read_b64_tr_b16 a[164:165], v18 offset:0
    ds_read_b64_tr_b16 a[166:167], v18 offset:6144
    v_mfma_f32_16x16x32_bf16 a[24:27], a[168:171], v[88:91], a[24:27]
    ds_read_b128 a[224:227], v25 offset:20480
    v_cvt_pk_bf16_f32 v113, v114, v115
    v_mfma_f32_16x16x32_bf16 a[28:31], a[168:171], v[96:99], a[28:31]
    ds_read_b128 a[228:231], v25 offset:22528
    v_fma_f32 v122, v122, s52, -v45
    v_mfma_f32_16x16x32_bf16 a[32:35], a[168:171], v[104:107], a[32:35]
    ds_read_b64_tr_b16 a[168:169], v19 offset:0
    ds_read_b64_tr_b16 a[170:171], v19 offset:6144
    v_mfma_f32_16x16x32_bf16 a[36:39], a[172:175], v[88:91], a[36:39]
    ds_read_b64_tr_b16 a[188:189], v22 offset:0
    ds_read_b64_tr_b16 a[190:191], v22 offset:1536
    v_mfma_f32_16x16x32_bf16 a[40:43], a[172:175], v[96:99], a[40:43]
    ds_read_b64_tr_b16 a[192:193], v23 offset:0
    ds_read_b64_tr_b16 a[194:195], v23 offset:1536
    v_mfma_f32_16x16x32_bf16 a[44:47], a[172:175], v[104:107], a[44:47]
    s_waitcnt lgkmcnt(10)
    buffer_load_dwordx4 v10, s[8:11], s61 offen offset:2048 lds
    v_mfma_f32_16x16x32_bf16 a[48:51], a[176:179], v[88:91], a[48:51]
    s_add_u32 m0, s51, 98304
    ds_read_b64_tr_b16 a[172:173], v20 offset:0
    ds_read_b64_tr_b16 a[174:175], v20 offset:6144
    v_mfma_f32_16x16x32_bf16 a[52:55], a[176:179], v[96:99], a[52:55]
    s_add_u32 s61, s61, 128
    ds_read_b128 a[232:235], v26 offset:12288
    v_fma_f32 v123, v123, s52, -v45
    v_mfma_f32_16x16x32_bf16 a[56:59], a[176:179], v[104:107], a[56:59]
    ds_read_b64_tr_b16 a[176:177], v17 offset:128
    ds_read_b64_tr_b16 a[178:179], v17 offset:6272
    v_mfma_f32_16x16x32_bf16 a[60:63], a[180:183], v[88:91], a[60:63]
    ds_read_b128 a[236:239], v26 offset:14336
    v_fma_f32 v124, v124, s52, -v45
    v_mfma_f32_16x16x32_bf16 a[64:67], a[180:183], v[96:99], a[64:67]
    ds_read_b128 a[240:243], v26 offset:16384
    v_fma_f32 v125, v125, s52, -v45
    v_mfma_f32_16x16x32_bf16 a[68:71], a[180:183], v[104:107], a[68:71]
    ds_read_b64_tr_b16 a[180:181], v18 offset:128
    ds_read_b64_tr_b16 a[182:183], v18 offset:6272
    v_mfma_f32_16x16x32_bf16 a[0:3], a[160:163], v[92:95], a[0:3]
    ds_read_b128 a[244:247], v26 offset:18432
    v_fma_f32 v126, v126, s52, -v45
    v_mfma_f32_16x16x32_bf16 a[4:7], a[160:163], v[100:103], a[4:7]
    buffer_load_dwordx4 v5, s[20:23], s57 offen lds
    v_mfma_f32_16x16x32_bf16 a[8:11], a[160:163], v[108:111], a[8:11]
    s_waitcnt lgkmcnt(7)
    ds_read_b128 a[248:251], v26 offset:20480
    v_fma_f32 v127, v127, s52, -v45
    v_mfma_f32_16x16x32_bf16 a[12:15], a[164:167], v[92:95], a[12:15]
    ds_read_b128 a[252:255], v26 offset:22528
    v_fma_f32 v128, v128, s52, -v46
    v_mfma_f32_16x16x32_bf16 a[16:19], a[164:167], v[100:103], a[16:19]
    v_exp_f32 v116, v116
    v_mfma_f32_16x16x32_bf16 a[20:23], a[164:167], v[108:111], a[20:23]
    v_exp_f32 v117, v117
    v_mfma_f32_16x16x32_bf16 a[24:27], a[168:171], v[92:95], a[24:27]
    v_exp_f32 v118, v118
    v_mfma_f32_16x16x32_bf16 a[28:31], a[168:171], v[100:103], a[28:31]
    v_exp_f32 v119, v119
    v_mfma_f32_16x16x32_bf16 a[32:35], a[168:171], v[108:111], a[32:35]
    v_exp_f32 v120, v120
    v_mfma_f32_16x16x32_bf16 a[36:39], a[172:175], v[92:95], a[36:39]
    buffer_load_dwordx4 v6, s[20:23], s57 offen offset:1024 lds
    v_mfma_f32_16x16x32_bf16 a[40:43], a[172:175], v[100:103], a[40:43]
    v_exp_f32 v121, v121
    v_mfma_f32_16x16x32_bf16 a[44:47], a[172:175], v[108:111], a[44:47]
    s_waitcnt lgkmcnt(0)
    v_cvt_pk_bf16_f32 v114, v116, v117
    v_cvt_pk_bf16_f32 v115, v118, v119
    v_mfma_f32_16x16x32_bf16 a[48:51], a[176:179], v[92:95], a[48:51]
    ds_write_b128 v27, v[112:115] offset:0
    v_mfma_f32_16x16x32_bf16 a[52:55], a[176:179], v[100:103], a[52:55]
    v_exp_f32 v122, v122
    v_mfma_f32_16x16x32_bf16 a[56:59], a[176:179], v[108:111], a[56:59]
    v_exp_f32 v123, v123
    v_mfma_f32_16x16x32_bf16 a[60:63], a[180:183], v[92:95], a[60:63]
    v_exp_f32 v124, v124
    v_mfma_f32_16x16x32_bf16 a[64:67], a[180:183], v[100:103], a[64:67]
    buffer_load_dwordx4 v7, s[20:23], s57 offen offset:2048 lds
    v_mfma_f32_16x16x32_bf16 a[68:71], a[180:183], v[108:111], a[68:71]
    s_add_u32 s57, s62, 399360
    s_waitcnt vmcnt(12)
    s_barrier
    v_mfma_f32_16x16x32_bf16 a[72:75], a[184:187], a[208:211], a[72:75]
    s_add_u32 m0, s51, 73728
    ds_read_b64_tr_b16 a[196:197], v21 offset:12288
    ds_read_b64_tr_b16 a[198:199], v21 offset:13824
    v_mfma_f32_16x16x32_bf16 a[76:79], a[184:187], a[212:215], a[76:79]
    buffer_load_dwordx4 v5, s[20:23], s57 offen lds
    v_mfma_f32_16x16x32_bf16 a[80:83], a[184:187], a[216:219], a[80:83]
    ds_read_b64_tr_b16 a[200:201], v22 offset:12288
    ds_read_b64_tr_b16 a[202:203], v22 offset:13824
    v_mfma_f32_16x16x32_bf16 a[84:87], a[184:187], a[220:223], a[84:87]
    buffer_load_dwordx4 v6, s[20:23], s57 offen offset:1024 lds
    v_mfma_f32_16x16x32_bf16 a[88:91], a[184:187], a[224:227], a[88:91]
    ds_read_b64_tr_b16 a[204:205], v23 offset:12288
    ds_read_b64_tr_b16 a[206:207], v23 offset:13824
    v_mfma_f32_16x16x32_bf16 a[92:95], a[184:187], a[228:231], a[92:95]
    buffer_load_dwordx4 v7, s[20:23], s57 offen offset:2048 lds
    v_mfma_f32_16x16x32_bf16 a[96:99], a[188:191], a[208:211], a[96:99]
    s_mov_b32 s57, 98304
    v_exp_f32 v125, v125
    v_mfma_f32_16x16x32_bf16 a[100:103], a[188:191], a[212:215], a[100:103]
    s_add_u32 m0, s51, 0
    v_exp_f32 v126, v126
    v_mfma_f32_16x16x32_bf16 a[104:107], a[188:191], a[216:219], a[104:107]
    buffer_load_dwordx4 v2, s[16:19], s57 offen nt lds
    v_mfma_f32_16x16x32_bf16 a[108:111], a[188:191], a[220:223], a[108:111]
    v_exp_f32 v127, v127
    v_mfma_f32_16x16x32_bf16 a[112:115], a[188:191], a[224:227], a[112:115]
    buffer_load_dwordx4 v3, s[16:19], s57 offen offset:1024 nt lds
    v_mfma_f32_16x16x32_bf16 a[116:119], a[188:191], a[228:231], a[116:119]
    v_cvt_pk_bf16_f32 v120, v120, v121
    v_fma_f32 v129, v129, s52, -v46
    v_mfma_f32_16x16x32_bf16 a[120:123], a[192:195], a[208:211], a[120:123]
    buffer_load_dwordx4 v4, s[16:19], s57 offen offset:2048 nt lds
    v_mfma_f32_16x16x32_bf16 a[124:127], a[192:195], a[212:215], a[124:127]
    s_mov_b32 s57, 110592
    v_cvt_pk_bf16_f32 v121, v122, v123
    v_fma_f32 v130, v130, s52, -v46
    v_mfma_f32_16x16x32_bf16 a[128:131], a[192:195], a[216:219], a[128:131]
    s_add_u32 m0, s51, 12288
    v_exp_f32 v128, v128
    v_mfma_f32_16x16x32_bf16 a[132:135], a[192:195], a[220:223], a[132:135]
    buffer_load_dwordx4 v2, s[16:19], s57 offen nt lds
    v_mfma_f32_16x16x32_bf16 a[136:139], a[192:195], a[224:227], a[136:139]
    v_exp_f32 v129, v129
    v_mfma_f32_16x16x32_bf16 a[140:143], a[192:195], a[228:231], a[140:143]
    buffer_load_dwordx4 v3, s[16:19], s57 offen offset:1024 nt lds
    v_mfma_f32_16x16x32_bf16 a[144:147], a[156:159], v[112:115], a[144:147]
    v_fma_f32 v131, v131, s52, -v46
    v_cvt_pk_bf16_f32 v122, v124, v125
    v_cvt_pk_bf16_f32 v123, v126, v127
    v_exp_f32 v130, v130
    s_nop 0
    v_mfma_f32_16x16x32_bf16 a[148:151], a[156:159], v[120:123], a[148:151]
    buffer_load_dwordx4 v4, s[16:19], s57 offen offset:2048 nt lds
    ds_write_b128 v27, v[120:123] offset:1024
    v_exp_f32 v131, v131
    v_fma_f32 v132, v132, s52, -v46
    v_fma_f32 v133, v133, s52, -v46
    v_fma_f32 v134, v134, s52, -v46
    v_fma_f32 v135, v135, s52, -v46
    v_exp_f32 v132, v132
    v_exp_f32 v133, v133
    v_exp_f32 v134, v134
    v_exp_f32 v135, v135
    v_cvt_pk_bf16_f32 v128, v128, v129
    v_cvt_pk_bf16_f32 v129, v130, v131
    v_cvt_pk_bf16_f32 v130, v132, v133
    v_cvt_pk_bf16_f32 v131, v134, v135
    s_cmp_eq_u32 s61, 1280
    s_cselect_b32 s61, 0, s61
    v_mfma_f32_16x16x32_bf16 a[152:155], a[156:159], v[128:131], a[152:155]
    s_add_u32 m0, s51, 110592
    ds_write_b128 v27, v[128:131] offset:2048
    s_waitcnt lgkmcnt(1)
    v_mfma_f32_16x16x32_bf16 a[72:75], a[196:199], a[232:235], a[72:75]
    s_mul_i32 s62, s61, 6144
    s_add_u32 s57, s62, 6144
    v_fma_f32 v136, v136, s52, -v44
    v_mfma_f32_16x16x32_bf16 a[76:79], a[196:199], a[236:239], a[76:79]
    v_fma_f32 v137, v137, s52, -v44
    v_fma_f32 v138, v138, s52, -v44
    v_mfma_f32_16x16x32_bf16 a[80:83], a[196:199], a[240:243], a[80:83]
    v_exp_f32 v136, v136
    v_mfma_f32_16x16x32_bf16 a[84:87], a[196:199], a[244:247], a[84:87]
    v_exp_f32 v137, v137
    v_mfma_f32_16x16x32_bf16 a[88:91], a[196:199], a[248:251], a[88:91]
    v_fma_f32 v139, v139, s52, -v44
    v_fma_f32 v140, v140, s52, -v44
    v_mfma_f32_16x16x32_bf16 a[92:95], a[196:199], a[252:255], a[92:95]
    v_exp_f32 v138, v138
    v_mfma_f32_16x16x32_bf16 a[96:99], a[200:203], a[232:235], a[96:99]
    s_waitcnt vmcnt(9) lgkmcnt(0)
    s_barrier
    ds_read_b64_tr_b16 a[160:161], v13 offset:24576
    v_mfma_f32_16x16x32_bf16 a[100:103], a[200:203], a[236:239], a[100:103]
    ds_read_b64_tr_b16 a[162:163], v13 offset:30720
    ds_read_b64_tr_b16 a[164:165], v14 offset:24576
    v_mfma_f32_16x16x32_bf16 a[104:107], a[200:203], a[240:243], a[104:107]
    ds_read_b64_tr_b16 a[166:167], v14 offset:30720
    ds_read_b64_tr_b16 a[168:169], v15 offset:24576
    v_mfma_f32_16x16x32_bf16 a[108:111], a[200:203], a[244:247], a[108:111]
    ds_read_b64_tr_b16 a[170:171], v15 offset:30720
    ds_read_b64_tr_b16 a[172:173], v16 offset:24576
    v_mfma_f32_16x16x32_bf16 a[112:115], a[200:203], a[248:251], a[112:115]
    ds_read_b64_tr_b16 a[174:175], v16 offset:30720
    ds_read_b64_tr_b16 a[176:177], v13 offset:24704
    v_mfma_f32_16x16x32_bf16 a[116:119], a[200:203], a[252:255], a[116:119]
    ds_read_b64_tr_b16 a[178:179], v13 offset:30848
    ds_read_b64_tr_b16 a[180:181], v14 offset:24704
    v_mfma_f32_16x16x32_bf16 a[120:123], a[204:207], a[232:235], a[120:123]
    ds_read_b64_tr_b16 a[182:183], v14 offset:30848
    ds_read_b128 v[116:119], v28 offset:0
    v_mfma_f32_16x16x32_bf16 a[124:127], a[204:207], a[236:239], a[124:127]
    buffer_load_dwordx4 v8, s[8:11], s61 offen lds
    v_mfma_f32_16x16x32_bf16 a[128:131], a[204:207], a[240:243], a[128:131]
    ds_read_b128 v[124:127], v28 offset:1024
    v_fma_f32 v141, v141, s52, -v44
    v_mfma_f32_16x16x32_bf16 a[132:135], a[204:207], a[244:247], a[132:135]
    ds_read_b128 v[132:135], v28 offset:2048
    v_fma_f32 v142, v142, s52, -v44
    v_mfma_f32_16x16x32_bf16 a[136:139], a[204:207], a[248:251], a[136:139]
    ds_read_b128 a[208:211], v25 offset:24576
    v_fma_f32 v143, v143, s52, -v44
    v_mfma_f32_16x16x32_bf16 a[140:143], a[204:207], a[252:255], a[140:143]
    s_waitcnt lgkmcnt(7)
    ds_read_b64_tr_b16 a[184:185], v21 offset:24576
    ds_read_b64_tr_b16 a[186:187], v21 offset:26112
    v_mfma_f32_16x16x32_bf16 a[0:3], a[160:163], v[112:115], a[0:3]
    ds_read_b128 a[212:215], v25 offset:26624
    v_cvt_pk_bf16_f32 v136, v136, v137
    v_mfma_f32_16x16x32_bf16 a[4:7], a[160:163], v[120:123], a[4:7]
    ds_read_b128 a[216:219], v25 offset:28672
    v_fma_f32 v144, v144, s52, -v45
    v_mfma_f32_16x16x32_bf16 a[8:11], a[160:163], v[128:131], a[8:11]
    ds_read_b64_tr_b16 a[160:161], v17 offset:24576
    ds_read_b64_tr_b16 a[162:163], v17 offset:30720
    v_mfma_f32_16x16x32_bf16 a[12:15], a[164:167], v[112:115], a[12:15]
    buffer_load_dwordx4 v9, s[8:11], s61 offen offset:1024 lds
    v_mfma_f32_16x16x32_bf16 a[16:19], a[164:167], v[120:123], a[16:19]
    ds_read_b128 a[220:223], v25 offset:30720
    v_fma_f32 v145, v145, s52, -v45
    v_mfma_f32_16x16x32_bf16 a[20:23], a[164:167], v[128:131], a[20:23]
    ds_read_b64_tr_b16 a[164:165], v18 offset:24576
    ds_read_b64_tr_b16 a[166:167], v18 offset:30720
    v_mfma_f32_16x16x32_bf16 a[24:27], a[168:171], v[112:115], a[24:27]
    ds_read_b128 a[224:227], v25 offset:32768
    v_fma_f32 v146, v146, s52, -v45
    v_mfma_f32_16x16x32_bf16 a[28:31], a[168:171], v[120:123], a[28:31]
    ds_read_b128 a[228:231], v25 offset:34816
    v_fma_f32 v147, v147, s52, -v45
    v_mfma_f32_16x16x32_bf16 a[32:35], a[168:171], v[128:131], a[32:35]
    ds_read_b64_tr_b16 a[168:169], v19 offset:24576
    ds_read_b64_tr_b16 a[170:171], v19 offset:30720
    v_mfma_f32_16x16x32_bf16 a[36:39], a[172:175], v[112:115], a[36:39]
    ds_read_b64_tr_b16 a[188:189], v22 offset:24576
    ds_read_b64_tr_b16 a[190:191], v22 offset:26112
    v_mfma_f32_16x16x32_bf16 a[40:43], a[172:175], v[120:123], a[40:43]
    ds_read_b64_tr_b16 a[192:193], v23 offset:24576
    ds_read_b64_tr_b16 a[194:195], v23 offset:26112
    v_mfma_f32_16x16x32_bf16 a[44:47], a[172:175], v[128:131], a[44:47]
    s_waitcnt lgkmcnt(10)
    buffer_load_dwordx4 v10, s[8:11], s61 offen offset:2048 lds
    v_mfma_f32_16x16x32_bf16 a[48:51], a[176:179], v[112:115], a[48:51]
    s_add_u32 m0, s51, 86016
    ds_read_b64_tr_b16 a[172:173], v20 offset:24576
    ds_read_b64_tr_b16 a[174:175], v20 offset:30720
    v_mfma_f32_16x16x32_bf16 a[52:55], a[176:179], v[120:123], a[52:55]
    s_add_u32 s61, s61, 128
    ds_read_b128 a[232:235], v26 offset:24576
    v_fma_f32 v148, v148, s52, -v45
    v_mfma_f32_16x16x32_bf16 a[56:59], a[176:179], v[128:131], a[56:59]
    ds_read_b64_tr_b16 a[176:177], v17 offset:24704
    ds_read_b64_tr_b16 a[178:179], v17 offset:30848
    v_mfma_f32_16x16x32_bf16 a[60:63], a[180:183], v[112:115], a[60:63]
    ds_read_b128 a[236:239], v26 offset:26624
    v_fma_f32 v149, v149, s52, -v45
    v_mfma_f32_16x16x32_bf16 a[64:67], a[180:183], v[120:123], a[64:67]
    ds_read_b128 a[240:243], v26 offset:28672
    v_fma_f32 v150, v150, s52, -v45
    v_mfma_f32_16x16x32_bf16 a[68:71], a[180:183], v[128:131], a[68:71]
    ds_read_b64_tr_b16 a[180:181], v18 offset:24704
    ds_read_b64_tr_b16 a[182:183], v18 offset:30848
    v_mfma_f32_16x16x32_bf16 a[0:3], a[160:163], v[116:119], a[0:3]
    ds_read_b128 a[244:247], v26 offset:30720
    v_fma_f32 v151, v151, s52, -v45
    v_mfma_f32_16x16x32_bf16 a[4:7], a[160:163], v[124:127], a[4:7]
    buffer_load_dwordx4 v5, s[20:23], s57 offen lds
    v_mfma_f32_16x16x32_bf16 a[8:11], a[160:163], v[132:135], a[8:11]
    s_waitcnt lgkmcnt(7)
    ds_read_b128 a[248:251], v26 offset:32768
    v_fma_f32 v152, v152, s52, -v46
    v_mfma_f32_16x16x32_bf16 a[12:15], a[164:167], v[116:119], a[12:15]
    ds_read_b128 a[252:255], v26 offset:34816
    v_fma_f32 v153, v153, s52, -v46
    v_mfma_f32_16x16x32_bf16 a[16:19], a[164:167], v[124:127], a[16:19]
    v_exp_f32 v139, v139
    v_mfma_f32_16x16x32_bf16 a[20:23], a[164:167], v[132:135], a[20:23]
    v_exp_f32 v140, v140
    v_mfma_f32_16x16x32_bf16 a[24:27], a[168:171], v[116:119], a[24:27]
    v_exp_f32 v141, v141
    v_mfma_f32_16x16x32_bf16 a[28:31], a[168:171], v[124:127], a[28:31]
    v_exp_f32 v142, v142
    v_mfma_f32_16x16x32_bf16 a[32:35], a[168:171], v[132:135], a[32:35]
    v_exp_f32 v143, v143
    v_mfma_f32_16x16x32_bf16 a[36:39], a[172:175], v[116:119], a[36:39]
    buffer_load_dwordx4 v6, s[20:23], s57 offen offset:1024 lds
    v_mfma_f32_16x16x32_bf16 a[40:43], a[172:175], v[124:127], a[40:43]
    v_cvt_pk_bf16_f32 v137, v138, v139
    v_cvt_pk_bf16_f32 v138, v140, v141
    v_mfma_f32_16x16x32_bf16 a[44:47], a[172:175], v[132:135], a[44:47]
    s_waitcnt lgkmcnt(0)
    v_exp_f32 v144, v144
    v_mfma_f32_16x16x32_bf16 a[48:51], a[176:179], v[116:119], a[48:51]
    v_exp_f32 v145, v145
    v_mfma_f32_16x16x32_bf16 a[52:55], a[176:179], v[124:127], a[52:55]
    v_cvt_pk_bf16_f32 v139, v142, v143
    v_cvt_pk_bf16_f32 v144, v144, v145
    v_mfma_f32_16x16x32_bf16 a[56:59], a[176:179], v[132:135], a[56:59]
    ds_write_b128 v27, v[136:139] offset:12288
    v_mfma_f32_16x16x32_bf16 a[60:63], a[180:183], v[116:119], a[60:63]
    v_exp_f32 v146, v146
    v_mfma_f32_16x16x32_bf16 a[64:67], a[180:183], v[124:127], a[64:67]
    buffer_load_dwordx4 v7, s[20:23], s57 offen offset:2048 lds
    v_mfma_f32_16x16x32_bf16 a[68:71], a[180:183], v[132:135], a[68:71]
    s_add_u32 s57, s62, 399360
    s_waitcnt vmcnt(12)
    s_barrier
    v_mfma_f32_16x16x32_bf16 a[72:75], a[184:187], a[208:211], a[72:75]
    s_add_u32 m0, s51, 98304
    ds_read_b64_tr_b16 a[196:197], v21 offset:0
    ds_read_b64_tr_b16 a[198:199], v21 offset:1536
    v_mfma_f32_16x16x32_bf16 a[76:79], a[184:187], a[212:215], a[76:79]
    buffer_load_dwordx4 v5, s[20:23], s57 offen lds
    v_mfma_f32_16x16x32_bf16 a[80:83], a[184:187], a[216:219], a[80:83]
    ds_read_b64_tr_b16 a[200:201], v22 offset:0
    ds_read_b64_tr_b16 a[202:203], v22 offset:1536
    v_mfma_f32_16x16x32_bf16 a[84:87], a[184:187], a[220:223], a[84:87]
    buffer_load_dwordx4 v6, s[20:23], s57 offen offset:1024 lds
    v_mfma_f32_16x16x32_bf16 a[88:91], a[184:187], a[224:227], a[88:91]
    ds_read_b64_tr_b16 a[204:205], v23 offset:0
    ds_read_b64_tr_b16 a[206:207], v23 offset:1536
    v_mfma_f32_16x16x32_bf16 a[92:95], a[184:187], a[228:231], a[92:95]
    buffer_load_dwordx4 v7, s[20:23], s57 offen offset:2048 lds
    v_mfma_f32_16x16x32_bf16 a[96:99], a[188:191], a[208:211], a[96:99]
    s_mov_b32 s57, 122880
    v_exp_f32 v147, v147
    v_mfma_f32_16x16x32_bf16 a[100:103], a[188:191], a[212:215], a[100:103]
    s_add_u32 m0, s51, 24576
    v_exp_f32 v148, v148
    v_mfma_f32_16x16x32_bf16 a[104:107], a[188:191], a[216:219], a[104:107]
    buffer_load_dwordx4 v2, s[16:19], s57 offen nt lds
    v_mfma_f32_16x16x32_bf16 a[108:111], a[188:191], a[220:223], a[108:111]
    v_exp_f32 v149, v149
    v_mfma_f32_16x16x32_bf16 a[112:115], a[188:191], a[224:227], a[112:115]
    buffer_load_dwordx4 v3, s[16:19], s57 offen offset:1024 nt lds
    v_mfma_f32_16x16x32_bf16 a[116:119], a[188:191], a[228:231], a[116:119]
    v_exp_f32 v150, v150
    v_mfma_f32_16x16x32_bf16 a[120:123], a[192:195], a[208:211], a[120:123]
    buffer_load_dwordx4 v4, s[16:19], s57 offen offset:2048 nt lds
    v_mfma_f32_16x16x32_bf16 a[124:127], a[192:195], a[212:215], a[124:127]
    s_mov_b32 s57, 135168
    v_exp_f32 v151, v151
    v_mfma_f32_16x16x32_bf16 a[128:131], a[192:195], a[216:219], a[128:131]
    s_add_u32 m0, s51, 36864
    v_cvt_pk_bf16_f32 v145, v146, v147
    v_fma_f32 v154, v154, s52, -v46
    v_mfma_f32_16x16x32_bf16 a[132:135], a[192:195], a[220:223], a[132:135]
    buffer_load_dwordx4 v2, s[16:19], s57 offen nt lds
    v_mfma_f32_16x16x32_bf16 a[136:139], a[192:195], a[224:227], a[136:139]
    v_exp_f32 v152, v152
    v_mfma_f32_16x16x32_bf16 a[140:143], a[192:195], a[228:231], a[140:143]
    buffer_load_dwordx4 v3, s[16:19], s57 offen offset:1024 nt lds
    v_mfma_f32_16x16x32_bf16 a[144:147], a[156:159], v[136:139], a[144:147]
    v_exp_f32 v153, v153
    v_fma_f32 v155, v155, s52, -v46
    v_cvt_pk_bf16_f32 v146, v148, v149
    v_cvt_pk_bf16_f32 v147, v150, v151
    v_exp_f32 v154, v154
    s_nop 0
    v_mfma_f32_16x16x32_bf16 a[148:151], a[156:159], v[144:147], a[148:151]
    buffer_load_dwordx4 v4, s[16:19], s57 offen offset:2048 nt lds
    ds_write_b128 v27, v[144:147] offset:13312
    v_exp_f32 v155, v155
    v_fma_f32 v156, v156, s52, -v46
    v_fma_f32 v157, v157, s52, -v46
    v_fma_f32 v158, v158, s52, -v46
    v_fma_f32 v159, v159, s52, -v46
    v_exp_f32 v156, v156
    v_exp_f32 v157, v157
    v_exp_f32 v158, v158
    v_exp_f32 v159, v159
    v_cvt_pk_bf16_f32 v152, v152, v153
    v_cvt_pk_bf16_f32 v153, v154, v155
    v_cvt_pk_bf16_f32 v154, v156, v157
    v_cvt_pk_bf16_f32 v155, v158, v159
    s_cmp_eq_u32 s61, 1280
    s_cselect_b32 s61, 0, s61
    v_mfma_f32_16x16x32_bf16 a[152:155], a[156:159], v[152:155], a[152:155]
    s_add_u32 m0, s51, 122880
    ds_write_b128 v27, v[152:155] offset:14336
    s_waitcnt lgkmcnt(1)
    v_mfma_f32_16x16x32_bf16 a[72:75], a[196:199], a[232:235], a[72:75]
    s_mul_i32 s62, s61, 6144
    s_add_u32 s57, s62, 6144
    v_fma_f32 v160, v160, s52, -v44
    v_mfma_f32_16x16x32_bf16 a[76:79], a[196:199], a[236:239], a[76:79]
    v_fma_f32 v161, v161, s52, -v44
    v_fma_f32 v162, v162, s52, -v44
    v_mfma_f32_16x16x32_bf16 a[80:83], a[196:199], a[240:243], a[80:83]
    v_exp_f32 v160, v160
    v_mfma_f32_16x16x32_bf16 a[84:87], a[196:199], a[244:247], a[84:87]
    v_exp_f32 v161, v161
    v_mfma_f32_16x16x32_bf16 a[88:91], a[196:199], a[248:251], a[88:91]
    v_fma_f32 v163, v163, s52, -v44
    v_fma_f32 v164, v164, s52, -v44
    v_mfma_f32_16x16x32_bf16 a[92:95], a[196:199], a[252:255], a[92:95]
    v_exp_f32 v162, v162
    v_mfma_f32_16x16x32_bf16 a[96:99], a[200:203], a[232:235], a[96:99]
    s_waitcnt vmcnt(9) lgkmcnt(0)
    s_barrier
    ds_read_b64_tr_b16 a[160:161], v13 offset:49152
    v_mfma_f32_16x16x32_bf16 a[100:103], a[200:203], a[236:239], a[100:103]
    ds_read_b64_tr_b16 a[162:163], v13 offset:55296
    ds_read_b64_tr_b16 a[164:165], v14 offset:49152
    v_mfma_f32_16x16x32_bf16 a[104:107], a[200:203], a[240:243], a[104:107]
    ds_read_b64_tr_b16 a[166:167], v14 offset:55296
    ds_read_b64_tr_b16 a[168:169], v15 offset:49152
    v_mfma_f32_16x16x32_bf16 a[108:111], a[200:203], a[244:247], a[108:111]
    ds_read_b64_tr_b16 a[170:171], v15 offset:55296
    ds_read_b64_tr_b16 a[172:173], v16 offset:49152
    v_mfma_f32_16x16x32_bf16 a[112:115], a[200:203], a[248:251], a[112:115]
    ds_read_b64_tr_b16 a[174:175], v16 offset:55296
    ds_read_b64_tr_b16 a[176:177], v13 offset:49280
    v_mfma_f32_16x16x32_bf16 a[116:119], a[200:203], a[252:255], a[116:119]
    ds_read_b64_tr_b16 a[178:179], v13 offset:55424
    ds_read_b64_tr_b16 a[180:181], v14 offset:49280
    v_mfma_f32_16x16x32_bf16 a[120:123], a[204:207], a[232:235], a[120:123]
    ds_read_b64_tr_b16 a[182:183], v14 offset:55424
    ds_read_b128 v[140:143], v28 offset:12288
    v_mfma_f32_16x16x32_bf16 a[124:127], a[204:207], a[236:239], a[124:127]
    buffer_load_dwordx4 v8, s[8:11], s61 offen lds
    v_mfma_f32_16x16x32_bf16 a[128:131], a[204:207], a[240:243], a[128:131]
    ds_read_b128 v[148:151], v28 offset:13312
    v_fma_f32 v165, v165, s52, -v44
    v_mfma_f32_16x16x32_bf16 a[132:135], a[204:207], a[244:247], a[132:135]
    ds_read_b128 v[156:159], v28 offset:14336
    v_fma_f32 v166, v166, s52, -v44
    v_mfma_f32_16x16x32_bf16 a[136:139], a[204:207], a[248:251], a[136:139]
    ds_read_b128 a[208:211], v25 offset:12288
    v_fma_f32 v167, v167, s52, -v44
    v_mfma_f32_16x16x32_bf16 a[140:143], a[204:207], a[252:255], a[140:143]
    s_waitcnt lgkmcnt(7)
    ds_read_b64_tr_b16 a[184:185], v21 offset:12288
    ds_read_b64_tr_b16 a[186:187], v21 offset:13824
    v_mfma_f32_16x16x32_bf16 a[0:3], a[160:163], v[136:139], a[0:3]
    ds_read_b128 a[212:215], v25 offset:14336
    v_cvt_pk_bf16_f32 v160, v160, v161
    v_mfma_f32_16x16x32_bf16 a[4:7], a[160:163], v[144:147], a[4:7]
    ds_read_b128 a[216:219], v25 offset:16384
    v_fma_f32 v168, v168, s52, -v45
    v_mfma_f32_16x16x32_bf16 a[8:11], a[160:163], v[152:155], a[8:11]
    ds_read_b64_tr_b16 a[160:161], v17 offset:49152
    ds_read_b64_tr_b16 a[162:163], v17 offset:55296
    v_mfma_f32_16x16x32_bf16 a[12:15], a[164:167], v[136:139], a[12:15]
    buffer_load_dwordx4 v9, s[8:11], s61 offen offset:1024 lds
    v_mfma_f32_16x16x32_bf16 a[16:19], a[164:167], v[144:147], a[16:19]
    ds_read_b128 a[220:223], v25 offset:18432
    v_fma_f32 v169, v169, s52, -v45
    v_mfma_f32_16x16x32_bf16 a[20:23], a[164:167], v[152:155], a[20:23]
    ds_read_b64_tr_b16 a[164:165], v18 offset:49152
    ds_read_b64_tr_b16 a[166:167], v18 offset:55296
    v_mfma_f32_16x16x32_bf16 a[24:27], a[168:171], v[136:139], a[24:27]
    ds_read_b128 a[224:227], v25 offset:20480
    v_fma_f32 v170, v170, s52, -v45
    v_mfma_f32_16x16x32_bf16 a[28:31], a[168:171], v[144:147], a[28:31]
    ds_read_b128 a[228:231], v25 offset:22528
    v_fma_f32 v171, v171, s52, -v45
    v_mfma_f32_16x16x32_bf16 a[32:35], a[168:171], v[152:155], a[32:35]
    ds_read_b64_tr_b16 a[168:169], v19 offset:49152
    ds_read_b64_tr_b16 a[170:171], v19 offset:55296
    v_mfma_f32_16x16x32_bf16 a[36:39], a[172:175], v[136:139], a[36:39]
    ds_read_b64_tr_b16 a[188:189], v22 offset:12288
    ds_read_b64_tr_b16 a[190:191], v22 offset:13824
    v_mfma_f32_16x16x32_bf16 a[40:43], a[172:175], v[144:147], a[40:43]
    ds_read_b64_tr_b16 a[192:193], v23 offset:12288
    ds_read_b64_tr_b16 a[194:195], v23 offset:13824
    v_mfma_f32_16x16x32_bf16 a[44:47], a[172:175], v[152:155], a[44:47]
    s_waitcnt lgkmcnt(10)
    buffer_load_dwordx4 v10, s[8:11], s61 offen offset:2048 lds
    v_mfma_f32_16x16x32_bf16 a[48:51], a[176:179], v[136:139], a[48:51]
    s_add_u32 m0, s51, 73728
    ds_read_b64_tr_b16 a[172:173], v20 offset:49152
    ds_read_b64_tr_b16 a[174:175], v20 offset:55296
    v_mfma_f32_16x16x32_bf16 a[52:55], a[176:179], v[144:147], a[52:55]
    s_add_u32 s61, s61, 128
    ds_read_b128 a[232:235], v26 offset:12288
    v_fma_f32 v172, v172, s52, -v45
    v_mfma_f32_16x16x32_bf16 a[56:59], a[176:179], v[152:155], a[56:59]
    ds_read_b64_tr_b16 a[176:177], v17 offset:49280
    ds_read_b64_tr_b16 a[178:179], v17 offset:55424
    v_mfma_f32_16x16x32_bf16 a[60:63], a[180:183], v[136:139], a[60:63]
    ds_read_b128 a[236:239], v26 offset:14336
    v_fma_f32 v173, v173, s52, -v45
    v_mfma_f32_16x16x32_bf16 a[64:67], a[180:183], v[144:147], a[64:67]
    ds_read_b128 a[240:243], v26 offset:16384
    v_fma_f32 v174, v174, s52, -v45
    v_mfma_f32_16x16x32_bf16 a[68:71], a[180:183], v[152:155], a[68:71]
    ds_read_b64_tr_b16 a[180:181], v18 offset:49280
    ds_read_b64_tr_b16 a[182:183], v18 offset:55424
    v_mfma_f32_16x16x32_bf16 a[0:3], a[160:163], v[140:143], a[0:3]
    ds_read_b128 a[244:247], v26 offset:18432
    v_fma_f32 v175, v175, s52, -v45
    v_mfma_f32_16x16x32_bf16 a[4:7], a[160:163], v[148:151], a[4:7]
    buffer_load_dwordx4 v5, s[20:23], s57 offen lds
    v_mfma_f32_16x16x32_bf16 a[8:11], a[160:163], v[156:159], a[8:11]
    s_waitcnt lgkmcnt(7)
    ds_read_b128 a[248:251], v26 offset:20480
    v_fma_f32 v176, v176, s52, -v46
    v_mfma_f32_16x16x32_bf16 a[12:15], a[164:167], v[140:143], a[12:15]
    ds_read_b128 a[252:255], v26 offset:22528
    v_fma_f32 v177, v177, s52, -v46
    v_mfma_f32_16x16x32_bf16 a[16:19], a[164:167], v[148:151], a[16:19]
    v_exp_f32 v163, v163
    v_mfma_f32_16x16x32_bf16 a[20:23], a[164:167], v[156:159], a[20:23]
    v_exp_f32 v164, v164
    v_mfma_f32_16x16x32_bf16 a[24:27], a[168:171], v[140:143], a[24:27]
    v_exp_f32 v165, v165
    v_mfma_f32_16x16x32_bf16 a[28:31], a[168:171], v[148:151], a[28:31]
    v_exp_f32 v166, v166
    v_mfma_f32_16x16x32_bf16 a[32:35], a[168:171], v[156:159], a[32:35]
    v_exp_f32 v167, v167
    v_mfma_f32_16x16x32_bf16 a[36:39], a[172:175], v[140:143], a[36:39]
    buffer_load_dwordx4 v6, s[20:23], s57 offen offset:1024 lds
    v_mfma_f32_16x16x32_bf16 a[40:43], a[172:175], v[148:151], a[40:43]
    v_cvt_pk_bf16_f32 v161, v162, v163
    v_cvt_pk_bf16_f32 v162, v164, v165
    v_mfma_f32_16x16x32_bf16 a[44:47], a[172:175], v[156:159], a[44:47]
    s_waitcnt lgkmcnt(0)
    v_exp_f32 v168, v168
    v_mfma_f32_16x16x32_bf16 a[48:51], a[176:179], v[140:143], a[48:51]
    v_exp_f32 v169, v169
    v_mfma_f32_16x16x32_bf16 a[52:55], a[176:179], v[148:151], a[52:55]
    v_cvt_pk_bf16_f32 v163, v166, v167
    v_cvt_pk_bf16_f32 v168, v168, v169
    v_mfma_f32_16x16x32_bf16 a[56:59], a[176:179], v[156:159], a[56:59]
    ds_write_b128 v27, v[160:163] offset:0
    v_mfma_f32_16x16x32_bf16 a[60:63], a[180:183], v[140:143], a[60:63]
    v_exp_f32 v170, v170
    v_mfma_f32_16x16x32_bf16 a[64:67], a[180:183], v[148:151], a[64:67]
    buffer_load_dwordx4 v7, s[20:23], s57 offen offset:2048 lds
    v_mfma_f32_16x16x32_bf16 a[68:71], a[180:183], v[156:159], a[68:71]
    s_add_u32 s57, s62, 399360
    s_waitcnt vmcnt(12)
    s_barrier
    v_mfma_f32_16x16x32_bf16 a[72:75], a[184:187], a[208:211], a[72:75]
    s_add_u32 m0, s51, 86016
    ds_read_b64_tr_b16 a[196:197], v21 offset:24576
    ds_read_b64_tr_b16 a[198:199], v21 offset:26112
    v_mfma_f32_16x16x32_bf16 a[76:79], a[184:187], a[212:215], a[76:79]
    buffer_load_dwordx4 v5, s[20:23], s57 offen lds
    v_mfma_f32_16x16x32_bf16 a[80:83], a[184:187], a[216:219], a[80:83]
    ds_read_b64_tr_b16 a[200:201], v22 offset:24576
    ds_read_b64_tr_b16 a[202:203], v22 offset:26112
    v_mfma_f32_16x16x32_bf16 a[84:87], a[184:187], a[220:223], a[84:87]
    buffer_load_dwordx4 v6, s[20:23], s57 offen offset:1024 lds
    v_mfma_f32_16x16x32_bf16 a[88:91], a[184:187], a[224:227], a[88:91]
    ds_read_b64_tr_b16 a[204:205], v23 offset:24576
    ds_read_b64_tr_b16 a[206:207], v23 offset:26112
    v_mfma_f32_16x16x32_bf16 a[92:95], a[184:187], a[228:231], a[92:95]
    buffer_load_dwordx4 v7, s[20:23], s57 offen offset:2048 lds
    v_mfma_f32_16x16x32_bf16 a[96:99], a[188:191], a[208:211], a[96:99]
    s_mov_b32 s57, 147456
    v_exp_f32 v171, v171
    v_mfma_f32_16x16x32_bf16 a[100:103], a[188:191], a[212:215], a[100:103]
    s_add_u32 m0, s51, 49152
    v_exp_f32 v172, v172
    v_mfma_f32_16x16x32_bf16 a[104:107], a[188:191], a[216:219], a[104:107]
    buffer_load_dwordx4 v2, s[16:19], s57 offen nt lds
    v_mfma_f32_16x16x32_bf16 a[108:111], a[188:191], a[220:223], a[108:111]
    v_exp_f32 v173, v173
    v_mfma_f32_16x16x32_bf16 a[112:115], a[188:191], a[224:227], a[112:115]
    buffer_load_dwordx4 v3, s[16:19], s57 offen offset:1024 nt lds
    v_mfma_f32_16x16x32_bf16 a[116:119], a[188:191], a[228:231], a[116:119]
    v_exp_f32 v174, v174
    v_mfma_f32_16x16x32_bf16 a[120:123], a[192:195], a[208:211], a[120:123]
    buffer_load_dwordx4 v4, s[16:19], s57 offen offset:2048 nt lds
    v_mfma_f32_16x16x32_bf16 a[124:127], a[192:195], a[212:215], a[124:127]
    s_mov_b32 s57, 159744
    v_exp_f32 v175, v175
    v_mfma_f32_16x16x32_bf16 a[128:131], a[192:195], a[216:219], a[128:131]
    s_add_u32 m0, s51, 61440
    v_cvt_pk_bf16_f32 v169, v170, v171
    v_fma_f32 v178, v178, s52, -v46
    v_mfma_f32_16x16x32_bf16 a[132:135], a[192:195], a[220:223], a[132:135]
    buffer_load_dwordx4 v2, s[16:19], s57 offen nt lds
    v_mfma_f32_16x16x32_bf16 a[136:139], a[192:195], a[224:227], a[136:139]
    v_exp_f32 v176, v176
    v_mfma_f32_16x16x32_bf16 a[140:143], a[192:195], a[228:231], a[140:143]
    buffer_load_dwordx4 v3, s[16:19], s57 offen offset:1024 nt lds
    v_mfma_f32_16x16x32_bf16 a[144:147], a[156:159], v[160:163], a[144:147]
    v_exp_f32 v177, v177
    v_fma_f32 v179, v179, s52, -v46
    v_cvt_pk_bf16_f32 v170, v172, v173
    v_cvt_pk_bf16_f32 v171, v174, v175
    v_exp_f32 v178, v178
    s_nop 0
    v_mfma_f32_16x16x32_bf16 a[148:151], a[156:159], v[168:171], a[148:151]
    buffer_load_dwordx4 v4, s[16:19], s57 offen offset:2048 nt lds
    ds_write_b128 v27, v[168:171] offset:1024
    v_exp_f32 v179, v179
    v_fma_f32 v180, v180, s52, -v46
    v_fma_f32 v181, v181, s52, -v46
    v_fma_f32 v182, v182, s52, -v46
    v_fma_f32 v183, v183, s52, -v46
    v_exp_f32 v180, v180
    v_exp_f32 v181, v181
    v_exp_f32 v182, v182
    v_exp_f32 v183, v183
    v_cvt_pk_bf16_f32 v176, v176, v177
    v_cvt_pk_bf16_f32 v177, v178, v179
    v_cvt_pk_bf16_f32 v178, v180, v181
    v_cvt_pk_bf16_f32 v179, v182, v183
    s_cmp_eq_u32 s61, 1280
    s_cselect_b32 s61, 0, s61
    v_mfma_f32_16x16x32_bf16 a[152:155], a[156:159], v[176:179], a[152:155]
    s_add_u32 m0, s51, 110592
    ds_write_b128 v27, v[176:179] offset:2048
    s_waitcnt lgkmcnt(1)
    v_mfma_f32_16x16x32_bf16 a[72:75], a[196:199], a[232:235], a[72:75]
    s_mul_i32 s62, s61, 6144
    s_add_u32 s57, s62, 6144
    v_fma_f32 v184, v184, s52, -v44
    v_mfma_f32_16x16x32_bf16 a[76:79], a[196:199], a[236:239], a[76:79]
    v_fma_f32 v185, v185, s52, -v44
    v_fma_f32 v186, v186, s52, -v44
    v_mfma_f32_16x16x32_bf16 a[80:83], a[196:199], a[240:243], a[80:83]
    v_exp_f32 v184, v184
    v_mfma_f32_16x16x32_bf16 a[84:87], a[196:199], a[244:247], a[84:87]
    v_exp_f32 v185, v185
    v_mfma_f32_16x16x32_bf16 a[88:91], a[196:199], a[248:251], a[88:91]
    v_fma_f32 v187, v187, s52, -v44
    v_fma_f32 v188, v188, s52, -v44
    v_mfma_f32_16x16x32_bf16 a[92:95], a[196:199], a[252:255], a[92:95]
    v_exp_f32 v186, v186
    v_mfma_f32_16x16x32_bf16 a[96:99], a[200:203], a[232:235], a[96:99]
    s_waitcnt vmcnt(9) lgkmcnt(0)
    s_barrier
    ds_read_b64_tr_b16 a[160:161], v13 offset:0
    v_mfma_f32_16x16x32_bf16 a[100:103], a[200:203], a[236:239], a[100:103]
    ds_read_b64_tr_b16 a[162:163], v13 offset:6144
    ds_read_b64_tr_b16 a[164:165], v14 offset:0
    v_mfma_f32_16x16x32_bf16 a[104:107], a[200:203], a[240:243], a[104:107]
    ds_read_b64_tr_b16 a[166:167], v14 offset:6144
    ds_read_b64_tr_b16 a[168:169], v15 offset:0
    v_mfma_f32_16x16x32_bf16 a[108:111], a[200:203], a[244:247], a[108:111]
    ds_read_b64_tr_b16 a[170:171], v15 offset:6144
    ds_read_b64_tr_b16 a[172:173], v16 offset:0
    v_mfma_f32_16x16x32_bf16 a[112:115], a[200:203], a[248:251], a[112:115]
    ds_read_b64_tr_b16 a[174:175], v16 offset:6144
    ds_read_b64_tr_b16 a[176:177], v13 offset:128
    v_mfma_f32_16x16x32_bf16 a[116:119], a[200:203], a[252:255], a[116:119]
    ds_read_b64_tr_b16 a[178:179], v13 offset:6272
    ds_read_b64_tr_b16 a[180:181], v14 offset:128
    v_mfma_f32_16x16x32_bf16 a[120:123], a[204:207], a[232:235], a[120:123]
    ds_read_b64_tr_b16 a[182:183], v14 offset:6272
    ds_read_b128 v[164:167], v28 offset:0
    v_mfma_f32_16x16x32_bf16 a[124:127], a[204:207], a[236:239], a[124:127]
    buffer_load_dwordx4 v8, s[8:11], s61 offen lds
    v_mfma_f32_16x16x32_bf16 a[128:131], a[204:207], a[240:243], a[128:131]
    ds_read_b128 v[172:175], v28 offset:1024
    v_fma_f32 v189, v189, s52, -v44
    v_mfma_f32_16x16x32_bf16 a[132:135], a[204:207], a[244:247], a[132:135]
    ds_read_b128 v[180:183], v28 offset:2048
    v_fma_f32 v190, v190, s52, -v44
    v_mfma_f32_16x16x32_bf16 a[136:139], a[204:207], a[248:251], a[136:139]
    ds_read_b128 a[208:211], v25 offset:24576
    v_fma_f32 v191, v191, s52, -v44
    v_mfma_f32_16x16x32_bf16 a[140:143], a[204:207], a[252:255], a[140:143]
    s_waitcnt lgkmcnt(7)
    ds_read_b64_tr_b16 a[184:185], v21 offset:0
    ds_read_b64_tr_b16 a[186:187], v21 offset:1536
    v_mfma_f32_16x16x32_bf16 a[0:3], a[160:163], v[160:163], a[0:3]
    ds_read_b128 a[212:215], v25 offset:26624
    v_cvt_pk_bf16_f32 v184, v184, v185
    v_mfma_f32_16x16x32_bf16 a[4:7], a[160:163], v[168:171], a[4:7]
    ds_read_b128 a[216:219], v25 offset:28672
    v_fma_f32 v192, v192, s52, -v45
    v_mfma_f32_16x16x32_bf16 a[8:11], a[160:163], v[176:179], a[8:11]
    ds_read_b64_tr_b16 a[160:161], v17 offset:0
    ds_read_b64_tr_b16 a[162:163], v17 offset:6144
    v_mfma_f32_16x16x32_bf16 a[12:15], a[164:167], v[160:163], a[12:15]
    buffer_load_dwordx4 v9, s[8:11], s61 offen offset:1024 lds
    v_mfma_f32_16x16x32_bf16 a[16:19], a[164:167], v[168:171], a[16:19]
    ds_read_b128 a[220:223], v25 offset:30720
    v_fma_f32 v193, v193, s52, -v45
    v_mfma_f32_16x16x32_bf16 a[20:23], a[164:167], v[176:179], a[20:23]
    ds_read_b64_tr_b16 a[164:165], v18 offset:0
    ds_read_b64_tr_b16 a[166:167], v18 offset:6144
    v_mfma_f32_16x16x32_bf16 a[24:27], a[168:171], v[160:163], a[24:27]
    ds_read_b128 a[224:227], v25 offset:32768
    v_fma_f32 v194, v194, s52, -v45
    v_mfma_f32_16x16x32_bf16 a[28:31], a[168:171], v[168:171], a[28:31]
    ds_read_b128 a[228:231], v25 offset:34816
    v_fma_f32 v195, v195, s52, -v45
    v_mfma_f32_16x16x32_bf16 a[32:35], a[168:171], v[176:179], a[32:35]
    ds_read_b64_tr_b16 a[168:169], v19 offset:0
    ds_read_b64_tr_b16 a[170:171], v19 offset:6144
    v_mfma_f32_16x16x32_bf16 a[36:39], a[172:175], v[160:163], a[36:39]
    ds_read_b64_tr_b16 a[188:189], v22 offset:0
    ds_read_b64_tr_b16 a[190:191], v22 offset:1536
    v_mfma_f32_16x16x32_bf16 a[40:43], a[172:175], v[168:171], a[40:43]
    ds_read_b64_tr_b16 a[192:193], v23 offset:0
    ds_read_b64_tr_b16 a[194:195], v23 offset:1536
    v_mfma_f32_16x16x32_bf16 a[44:47], a[172:175], v[176:179], a[44:47]
    s_waitcnt lgkmcnt(10)
    buffer_load_dwordx4 v10, s[8:11], s61 offen offset:2048 lds
    v_mfma_f32_16x16x32_bf16 a[48:51], a[176:179], v[160:163], a[48:51]
    s_add_u32 m0, s51, 98304
    ds_read_b64_tr_b16 a[172:173], v20 offset:0
    ds_read_b64_tr_b16 a[174:175], v20 offset:6144
    v_mfma_f32_16x16x32_bf16 a[52:55], a[176:179], v[168:171], a[52:55]
    s_mul_i32 s61, s46, 122880
    ds_read_b128 a[232:235], v26 offset:24576
    v_fma_f32 v196, v196, s52, -v45
    v_mfma_f32_16x16x32_bf16 a[56:59], a[176:179], v[176:179], a[56:59]
    ds_read_b64_tr_b16 a[176:177], v17 offset:128
    ds_read_b64_tr_b16 a[178:179], v17 offset:6272
    v_mfma_f32_16x16x32_bf16 a[60:63], a[180:183], v[160:163], a[60:63]
    ds_read_b128 a[236:239], v26 offset:26624
    v_fma_f32 v197, v197, s52, -v45
    v_mfma_f32_16x16x32_bf16 a[64:67], a[180:183], v[168:171], a[64:67]
    ds_read_b128 a[240:243], v26 offset:28672
    v_fma_f32 v198, v198, s52, -v45
    v_mfma_f32_16x16x32_bf16 a[68:71], a[180:183], v[176:179], a[68:71]
    ds_read_b64_tr_b16 a[180:181], v18 offset:128
    ds_read_b64_tr_b16 a[182:183], v18 offset:6272
    v_mfma_f32_16x16x32_bf16 a[0:3], a[160:163], v[164:167], a[0:3]
    ds_read_b128 a[244:247], v26 offset:30720
    v_fma_f32 v199, v199, s52, -v45
    v_mfma_f32_16x16x32_bf16 a[4:7], a[160:163], v[172:175], a[4:7]
    buffer_load_dwordx4 v5, s[20:23], s57 offen lds
    v_mfma_f32_16x16x32_bf16 a[8:11], a[160:163], v[180:183], a[8:11]
    s_waitcnt lgkmcnt(7)
    ds_read_b128 a[248:251], v26 offset:32768
    v_fma_f32 v200, v200, s52, -v46
    v_mfma_f32_16x16x32_bf16 a[12:15], a[164:167], v[164:167], a[12:15]
    ds_read_b128 a[252:255], v26 offset:34816
    v_fma_f32 v201, v201, s52, -v46
    v_mfma_f32_16x16x32_bf16 a[16:19], a[164:167], v[172:175], a[16:19]
    v_exp_f32 v187, v187
    v_mfma_f32_16x16x32_bf16 a[20:23], a[164:167], v[180:183], a[20:23]
    v_exp_f32 v188, v188
    v_mfma_f32_16x16x32_bf16 a[24:27], a[168:171], v[164:167], a[24:27]
    v_exp_f32 v189, v189
    v_mfma_f32_16x16x32_bf16 a[28:31], a[168:171], v[172:175], a[28:31]
    v_exp_f32 v190, v190
    v_mfma_f32_16x16x32_bf16 a[32:35], a[168:171], v[180:183], a[32:35]
    v_exp_f32 v191, v191
    v_mfma_f32_16x16x32_bf16 a[36:39], a[172:175], v[164:167], a[36:39]
    buffer_load_dwordx4 v6, s[20:23], s57 offen offset:1024 lds
    v_mfma_f32_16x16x32_bf16 a[40:43], a[172:175], v[172:175], a[40:43]
    v_cvt_pk_bf16_f32 v185, v186, v187
    v_cvt_pk_bf16_f32 v186, v188, v189
    v_mfma_f32_16x16x32_bf16 a[44:47], a[172:175], v[180:183], a[44:47]
    s_waitcnt lgkmcnt(0)
    v_exp_f32 v192, v192
    v_mfma_f32_16x16x32_bf16 a[48:51], a[176:179], v[164:167], a[48:51]
    v_exp_f32 v193, v193
    v_mfma_f32_16x16x32_bf16 a[52:55], a[176:179], v[172:175], a[52:55]
    v_cvt_pk_bf16_f32 v187, v190, v191
    v_cvt_pk_bf16_f32 v192, v192, v193
    v_mfma_f32_16x16x32_bf16 a[56:59], a[176:179], v[180:183], a[56:59]
    ds_write_b128 v27, v[184:187] offset:12288
    v_mfma_f32_16x16x32_bf16 a[60:63], a[180:183], v[164:167], a[60:63]
    v_exp_f32 v194, v194
    v_mfma_f32_16x16x32_bf16 a[64:67], a[180:183], v[172:175], a[64:67]
    buffer_load_dwordx4 v7, s[20:23], s57 offen offset:2048 lds
    v_mfma_f32_16x16x32_bf16 a[68:71], a[180:183], v[180:183], a[68:71]
    s_add_u32 s57, s62, 399360
    s_waitcnt vmcnt(12)
    s_barrier
    v_mfma_f32_16x16x32_bf16 a[72:75], a[184:187], a[208:211], a[72:75]
    s_add_u32 m0, s51, 73728
    ds_read_b64_tr_b16 a[196:197], v21 offset:12288
    ds_read_b64_tr_b16 a[198:199], v21 offset:13824
    v_mfma_f32_16x16x32_bf16 a[76:79], a[184:187], a[212:215], a[76:79]
    buffer_load_dwordx4 v5, s[20:23], s57 offen lds
    v_mfma_f32_16x16x32_bf16 a[80:83], a[184:187], a[216:219], a[80:83]
    ds_read_b64_tr_b16 a[200:201], v22 offset:12288
    ds_read_b64_tr_b16 a[202:203], v22 offset:13824
    v_mfma_f32_16x16x32_bf16 a[84:87], a[184:187], a[220:223], a[84:87]
    buffer_load_dwordx4 v6, s[20:23], s57 offen offset:1024 lds
    v_mfma_f32_16x16x32_bf16 a[88:91], a[184:187], a[224:227], a[88:91]
    ds_read_b64_tr_b16 a[204:205], v23 offset:12288
    ds_read_b64_tr_b16 a[206:207], v23 offset:13824
    v_mfma_f32_16x16x32_bf16 a[92:95], a[184:187], a[228:231], a[92:95]
    buffer_load_dwordx4 v7, s[20:23], s57 offen offset:2048 lds
    v_mfma_f32_16x16x32_bf16 a[96:99], a[188:191], a[208:211], a[96:99]
    s_mov_b32 s57, 172032
    v_exp_f32 v195, v195
    v_mfma_f32_16x16x32_bf16 a[100:103], a[188:191], a[212:215], a[100:103]
    s_add_u32 m0, s51, 0
    v_exp_f32 v196, v196
    v_mfma_f32_16x16x32_bf16 a[104:107], a[188:191], a[216:219], a[104:107]
    buffer_load_dwordx4 v2, s[16:19], s57 offen nt lds
    v_mfma_f32_16x16x32_bf16 a[108:111], a[188:191], a[220:223], a[108:111]
    v_exp_f32 v197, v197
    v_mfma_f32_16x16x32_bf16 a[112:115], a[188:191], a[224:227], a[112:115]
    buffer_load_dwordx4 v3, s[16:19], s57 offen offset:1024 nt lds
    v_mfma_f32_16x16x32_bf16 a[116:119], a[188:191], a[228:231], a[116:119]
    v_exp_f32 v198, v198
    v_mfma_f32_16x16x32_bf16 a[120:123], a[192:195], a[208:211], a[120:123]
    buffer_load_dwordx4 v4, s[16:19], s57 offen offset:2048 nt lds
    v_mfma_f32_16x16x32_bf16 a[124:127], a[192:195], a[212:215], a[124:127]
    s_mov_b32 s57, 184320
    v_exp_f32 v199, v199
    v_mfma_f32_16x16x32_bf16 a[128:131], a[192:195], a[216:219], a[128:131]
    s_add_u32 m0, s51, 12288
    v_cvt_pk_bf16_f32 v193, v194, v195
    v_fma_f32 v202, v202, s52, -v46
    v_mfma_f32_16x16x32_bf16 a[132:135], a[192:195], a[220:223], a[132:135]
    buffer_load_dwordx4 v2, s[16:19], s57 offen nt lds
    v_mfma_f32_16x16x32_bf16 a[136:139], a[192:195], a[224:227], a[136:139]
    v_exp_f32 v200, v200
    v_mfma_f32_16x16x32_bf16 a[140:143], a[192:195], a[228:231], a[140:143]
    buffer_load_dwordx4 v3, s[16:19], s57 offen offset:1024 nt lds
    v_mfma_f32_16x16x32_bf16 a[144:147], a[156:159], v[184:187], a[144:147]
    v_exp_f32 v201, v201
    v_fma_f32 v203, v203, s52, -v46
    v_cvt_pk_bf16_f32 v194, v196, v197
    v_cvt_pk_bf16_f32 v195, v198, v199
    v_exp_f32 v202, v202
    s_nop 0
    v_mfma_f32_16x16x32_bf16 a[148:151], a[156:159], v[192:195], a[148:151]
    buffer_load_dwordx4 v4, s[16:19], s57 offen offset:2048 nt lds
    ds_write_b128 v27, v[192:195] offset:13312
    v_exp_f32 v203, v203
    v_fma_f32 v204, v204, s52, -v46
    v_fma_f32 v205, v205, s52, -v46
    v_fma_f32 v206, v206, s52, -v46
    v_fma_f32 v207, v207, s52, -v46
    v_exp_f32 v204, v204
    v_exp_f32 v205, v205
    v_exp_f32 v206, v206
    v_exp_f32 v207, v207
    v_cvt_pk_bf16_f32 v200, v200, v201
    v_cvt_pk_bf16_f32 v201, v202, v203
    v_cvt_pk_bf16_f32 v202, v204, v205
    v_cvt_pk_bf16_f32 v203, v206, v207
    v_fma_f32 v208, v208, s52, -v44
    v_fma_f32 v209, v209, s52, -v44
    v_mfma_f32_16x16x32_bf16 a[152:155], a[156:159], v[200:203], a[152:155]
    s_mov_b32 s57, 3145728
    ds_write_b128 v27, v[200:203] offset:14336
    s_waitcnt lgkmcnt(1)
    v_mfma_f32_16x16x32_bf16 a[72:75], a[196:199], a[232:235], a[72:75]
    s_add_u32 m0, s51, 24576
    v_exp_f32 v208, v208
    v_mfma_f32_16x16x32_bf16 a[76:79], a[196:199], a[236:239], a[76:79]
    v_exp_f32 v209, v209
    v_mfma_f32_16x16x32_bf16 a[80:83], a[196:199], a[240:243], a[80:83]
    v_fma_f32 v210, v210, s52, -v44
    v_fma_f32 v211, v211, s52, -v44
    v_mfma_f32_16x16x32_bf16 a[84:87], a[196:199], a[244:247], a[84:87]
    v_exp_f32 v210, v210
    v_mfma_f32_16x16x32_bf16 a[88:91], a[196:199], a[248:251], a[88:91]
    v_exp_f32 v211, v211
    v_mfma_f32_16x16x32_bf16 a[92:95], a[196:199], a[252:255], a[92:95]
    v_fma_f32 v212, v212, s52, -v44
    v_fma_f32 v213, v213, s52, -v44
    v_mfma_f32_16x16x32_bf16 a[96:99], a[200:203], a[232:235], a[96:99]
    s_waitcnt vmcnt(9) lgkmcnt(0)
    s_barrier
    ds_read_b64_tr_b16 a[160:161], v13 offset:24576
    v_mfma_f32_16x16x32_bf16 a[100:103], a[200:203], a[236:239], a[100:103]
    ds_read_b64_tr_b16 a[162:163], v13 offset:30720
    ds_read_b64_tr_b16 a[164:165], v14 offset:24576
    v_mfma_f32_16x16x32_bf16 a[104:107], a[200:203], a[240:243], a[104:107]
    ds_read_b64_tr_b16 a[166:167], v14 offset:30720
    ds_read_b64_tr_b16 a[168:169], v15 offset:24576
    v_mfma_f32_16x16x32_bf16 a[108:111], a[200:203], a[244:247], a[108:111]
    ds_read_b64_tr_b16 a[170:171], v15 offset:30720
    ds_read_b64_tr_b16 a[172:173], v16 offset:24576
    v_mfma_f32_16x16x32_bf16 a[112:115], a[200:203], a[248:251], a[112:115]
    ds_read_b64_tr_b16 a[174:175], v16 offset:30720
    ds_read_b64_tr_b16 a[176:177], v13 offset:24704
    v_mfma_f32_16x16x32_bf16 a[116:119], a[200:203], a[252:255], a[116:119]
    ds_read_b64_tr_b16 a[178:179], v13 offset:30848
    ds_read_b64_tr_b16 a[180:181], v14 offset:24704
    v_mfma_f32_16x16x32_bf16 a[120:123], a[204:207], a[232:235], a[120:123]
    ds_read_b64_tr_b16 a[182:183], v14 offset:30848
    ds_read_b128 v[188:191], v28 offset:12288
    v_mfma_f32_16x16x32_bf16 a[124:127], a[204:207], a[236:239], a[124:127]
    ds_read_b128 v[196:199], v28 offset:13312
    v_fma_f32 v214, v214, s52, -v44
    v_mfma_f32_16x16x32_bf16 a[128:131], a[204:207], a[240:243], a[128:131]
    ds_read_b128 v[204:207], v28 offset:14336
    v_fma_f32 v215, v215, s52, -v44
    v_mfma_f32_16x16x32_bf16 a[132:135], a[204:207], a[244:247], a[132:135]
    ds_read_b128 a[208:211], v25 offset:12288
    v_cvt_pk_bf16_f32 v208, v208, v209
    v_mfma_f32_16x16x32_bf16 a[136:139], a[204:207], a[248:251], a[136:139]
    ds_read_b64_tr_b16 a[184:185], v21 offset:24576
    v_fma_f32 v216, v216, s52, -v45
    v_mfma_f32_16x16x32_bf16 a[140:143], a[204:207], a[252:255], a[140:143]
    s_waitcnt lgkmcnt(8)
    ds_read_b64_tr_b16 a[186:187], v21 offset:26112
    ds_read_b128 a[212:215], v25 offset:14336
    v_mfma_f32_16x16x32_bf16 a[0:3], a[160:163], v[184:187], a[0:3]
    ds_read_b128 a[216:219], v25 offset:16384
    v_fma_f32 v217, v217, s52, -v45
    v_mfma_f32_16x16x32_bf16 a[4:7], a[160:163], v[192:195], a[4:7]
    ds_read_b128 a[220:223], v25 offset:18432
    v_cvt_pk_bf16_f32 v209, v210, v211
    v_mfma_f32_16x16x32_bf16 a[8:11], a[160:163], v[200:203], a[8:11]
    ds_read_b64_tr_b16 a[160:161], v17 offset:24576
    v_fma_f32 v218, v218, s52, -v45
    v_mfma_f32_16x16x32_bf16 a[12:15], a[164:167], v[184:187], a[12:15]
    ds_read_b64_tr_b16 a[162:163], v17 offset:30720
    ds_read_b128 a[224:227], v25 offset:20480
    v_mfma_f32_16x16x32_bf16 a[16:19], a[164:167], v[192:195], a[16:19]
    ds_read_b128 a[228:231], v25 offset:22528
    v_fma_f32 v219, v219, s52, -v45
    v_mfma_f32_16x16x32_bf16 a[20:23], a[164:167], v[200:203], a[20:23]
    ds_read_b64_tr_b16 a[164:165], v18 offset:24576
    v_fma_f32 v220, v220, s52, -v45
    v_mfma_f32_16x16x32_bf16 a[24:27], a[168:171], v[184:187], a[24:27]
    ds_read_b64_tr_b16 a[166:167], v18 offset:30720
    ds_read_b64_tr_b16 a[188:189], v22 offset:24576
    v_mfma_f32_16x16x32_bf16 a[28:31], a[168:171], v[192:195], a[28:31]
    ds_read_b64_tr_b16 a[190:191], v22 offset:26112
    ds_read_b64_tr_b16 a[192:193], v23 offset:24576
    v_mfma_f32_16x16x32_bf16 a[32:35], a[168:171], v[200:203], a[32:35]
    ds_read_b64_tr_b16 a[168:169], v19 offset:24576
    ds_read_b64_tr_b16 a[170:171], v19 offset:30720
    v_mfma_f32_16x16x32_bf16 a[36:39], a[172:175], v[184:187], a[36:39]
    ds_read_b64_tr_b16 a[194:195], v23 offset:26112
    ds_read_b128 a[232:235], v26 offset:12288
    v_mfma_f32_16x16x32_bf16 a[40:43], a[172:175], v[192:195], a[40:43]
    ds_read_b128 a[236:239], v26 offset:14336
    v_fma_f32 v221, v221, s52, -v45
    v_mfma_f32_16x16x32_bf16 a[44:47], a[172:175], v[200:203], a[44:47]
    s_waitcnt lgkmcnt(10)
    ds_read_b64_tr_b16 a[172:173], v20 offset:24576
    v_fma_f32 v222, v222, s52, -v45
    v_mfma_f32_16x16x32_bf16 a[48:51], a[176:179], v[184:187], a[48:51]
    ds_read_b64_tr_b16 a[174:175], v20 offset:30720
    ds_read_b128 a[240:243], v26 offset:16384
    v_mfma_f32_16x16x32_bf16 a[52:55], a[176:179], v[192:195], a[52:55]
    ds_read_b128 a[244:247], v26 offset:18432
    v_fma_f32 v223, v223, s52, -v45
    v_mfma_f32_16x16x32_bf16 a[56:59], a[176:179], v[200:203], a[56:59]
    ds_read_b64_tr_b16 a[176:177], v17 offset:24704
    v_fma_f32 v224, v224, s52, -v46
    v_mfma_f32_16x16x32_bf16 a[60:63], a[180:183], v[184:187], a[60:63]
    ds_read_b64_tr_b16 a[178:179], v17 offset:30848
    ds_read_b128 a[248:251], v26 offset:20480
    v_mfma_f32_16x16x32_bf16 a[64:67], a[180:183], v[192:195], a[64:67]
    ds_read_b128 a[252:255], v26 offset:22528
    v_fma_f32 v225, v225, s52, -v46
    v_mfma_f32_16x16x32_bf16 a[68:71], a[180:183], v[200:203], a[68:71]
    ds_read_b64_tr_b16 a[180:181], v18 offset:24704
    v_fma_f32 v226, v226, s52, -v46
    v_mfma_f32_16x16x32_bf16 a[0:3], a[160:163], v[188:191], a[0:3]
    ds_read_b64_tr_b16 a[182:183], v18 offset:30848
    v_fma_f32 v227, v227, s52, -v46
    v_mfma_f32_16x16x32_bf16 a[4:7], a[160:163], v[196:199], a[4:7]
    v_exp_f32 v212, v212
    v_mfma_f32_16x16x32_bf16 a[8:11], a[160:163], v[204:207], a[8:11]
    s_waitcnt lgkmcnt(6)
    v_exp_f32 v213, v213
    v_mfma_f32_16x16x32_bf16 a[12:15], a[164:167], v[188:191], a[12:15]
    v_exp_f32 v214, v214
    v_mfma_f32_16x16x32_bf16 a[16:19], a[164:167], v[196:199], a[16:19]
    v_exp_f32 v215, v215
    v_mfma_f32_16x16x32_bf16 a[20:23], a[164:167], v[204:207], a[20:23]
    v_exp_f32 v216, v216
    v_mfma_f32_16x16x32_bf16 a[24:27], a[168:171], v[188:191], a[24:27]
    s_waitcnt vmcnt(6) lgkmcnt(0)
    s_barrier
    ds_read_b64_tr_b16 a[196:197], v21 offset:0
    v_mfma_f32_16x16x32_bf16 a[28:31], a[168:171], v[196:199], a[28:31]
    ds_read_b64_tr_b16 a[198:199], v21 offset:1536
    v_cvt_pk_bf16_f32 v210, v212, v213
    v_mfma_f32_16x16x32_bf16 a[32:35], a[168:171], v[204:207], a[32:35]
    buffer_load_dwordx4 v2, s[12:15], s57 offen nt lds
    v_mfma_f32_16x16x32_bf16 a[36:39], a[172:175], v[188:191], a[36:39]
    ds_read_b64_tr_b16 a[200:201], v22 offset:0
    ds_read_b64_tr_b16 a[202:203], v22 offset:1536
    v_mfma_f32_16x16x32_bf16 a[40:43], a[172:175], v[196:199], a[40:43]
    ds_read_b64_tr_b16 a[204:205], v23 offset:0
    v_cvt_pk_bf16_f32 v211, v214, v215
    v_mfma_f32_16x16x32_bf16 a[44:47], a[172:175], v[204:207], a[44:47]
    buffer_load_dwordx4 v3, s[12:15], s57 offen offset:1024 nt lds
    v_mfma_f32_16x16x32_bf16 a[48:51], a[176:179], v[188:191], a[48:51]
    ds_write_b128 v27, v[208:211] offset:0
    v_mfma_f32_16x16x32_bf16 a[52:55], a[176:179], v[196:199], a[52:55]
    buffer_load_dwordx4 v4, s[12:15], s57 offen offset:2048 nt lds
    v_mfma_f32_16x16x32_bf16 a[56:59], a[176:179], v[204:207], a[56:59]
    s_mov_b32 s57, 3158016
    ds_read_b64_tr_b16 a[206:207], v23 offset:1536
    v_fma_f32 v228, v228, s52, -v46
    v_mfma_f32_16x16x32_bf16 a[60:63], a[180:183], v[188:191], a[60:63]
    s_add_u32 m0, s51, 36864
    v_exp_f32 v217, v217
    v_mfma_f32_16x16x32_bf16 a[64:67], a[180:183], v[196:199], a[64:67]
    buffer_load_dwordx4 v2, s[12:15], s57 offen nt lds
    v_mfma_f32_16x16x32_bf16 a[68:71], a[180:183], v[204:207], a[68:71]
    v_exp_f32 v218, v218
    v_mfma_f32_16x16x32_bf16 a[72:75], a[184:187], a[208:211], a[72:75]
    v_exp_f32 v219, v219
    v_mfma_f32_16x16x32_bf16 a[76:79], a[184:187], a[212:215], a[76:79]
    buffer_load_dwordx4 v3, s[12:15], s57 offen offset:1024 nt lds
    v_mfma_f32_16x16x32_bf16 a[80:83], a[184:187], a[216:219], a[80:83]
    v_exp_f32 v220, v220
    v_mfma_f32_16x16x32_bf16 a[84:87], a[184:187], a[220:223], a[84:87]
    v_exp_f32 v221, v221
    v_mfma_f32_16x16x32_bf16 a[88:91], a[184:187], a[224:227], a[88:91]
    buffer_load_dwordx4 v4, s[12:15], s57 offen offset:2048 nt lds
    v_mfma_f32_16x16x32_bf16 a[92:95], a[184:187], a[228:231], a[92:95]
    s_mov_b32 s57, 3170304
    v_exp_f32 v222, v222
    v_mfma_f32_16x16x32_bf16 a[96:99], a[188:191], a[208:211], a[96:99]
    s_add_u32 m0, s51, 49152
    v_exp_f32 v223, v223
    v_mfma_f32_16x16x32_bf16 a[100:103], a[188:191], a[212:215], a[100:103]
    v_cvt_pk_bf16_f32 v216, v216, v217
    v_cvt_pk_bf16_f32 v217, v218, v219
    v_mfma_f32_16x16x32_bf16 a[104:107], a[188:191], a[216:219], a[104:107]
    v_exp_f32 v224, v224
    v_mfma_f32_16x16x32_bf16 a[108:111], a[188:191], a[220:223], a[108:111]
    v_exp_f32 v225, v225
    v_mfma_f32_16x16x32_bf16 a[112:115], a[188:191], a[224:227], a[112:115]
    v_cvt_pk_bf16_f32 v218, v220, v221
    v_cvt_pk_bf16_f32 v219, v222, v223
    v_mfma_f32_16x16x32_bf16 a[116:119], a[188:191], a[228:231], a[116:119]
    ds_write_b128 v27, v[216:219] offset:1024
    v_mfma_f32_16x16x32_bf16 a[120:123], a[192:195], a[208:211], a[120:123]
    v_exp_f32 v226, v226
    v_mfma_f32_16x16x32_bf16 a[124:127], a[192:195], a[212:215], a[124:127]
    v_exp_f32 v227, v227
    v_mfma_f32_16x16x32_bf16 a[128:131], a[192:195], a[216:219], a[128:131]
    v_fma_f32 v229, v229, s52, -v46
    v_fma_f32 v230, v230, s52, -v46
    v_mfma_f32_16x16x32_bf16 a[132:135], a[192:195], a[220:223], a[132:135]
    v_fma_f32 v231, v231, s52, -v46
    v_cvt_pk_bf16_f32 v224, v224, v225
    v_mfma_f32_16x16x32_bf16 a[136:139], a[192:195], a[224:227], a[136:139]
    v_exp_f32 v228, v228
    v_mfma_f32_16x16x32_bf16 a[140:143], a[192:195], a[228:231], a[140:143]
    v_exp_f32 v229, v229
    v_mfma_f32_16x16x32_bf16 a[144:147], a[156:159], v[208:211], a[144:147]
    v_exp_f32 v230, v230
    v_mfma_f32_16x16x32_bf16 a[148:151], a[156:159], v[216:219], a[148:151]
    v_exp_f32 v231, v231
    v_cvt_pk_bf16_f32 v225, v226, v227
    v_cvt_pk_bf16_f32 v226, v228, v229
    v_cvt_pk_bf16_f32 v227, v230, v231
    v_fma_f32 v232, v232, s52, -v44
    v_fma_f32 v233, v233, s52, -v44
    v_mfma_f32_16x16x32_bf16 a[152:155], a[156:159], v[224:227], a[152:155]
    s_waitcnt lgkmcnt(0)
    ds_write_b128 v27, v[224:227] offset:2048
    v_mfma_f32_16x16x32_bf16 a[72:75], a[196:199], a[232:235], a[72:75]
    v_exp_f32 v232, v232
    v_mfma_f32_16x16x32_bf16 a[76:79], a[196:199], a[236:239], a[76:79]
    v_exp_f32 v233, v233
    v_mfma_f32_16x16x32_bf16 a[80:83], a[196:199], a[240:243], a[80:83]
    v_fma_f32 v234, v234, s52, -v44
    v_fma_f32 v235, v235, s52, -v44
    v_mfma_f32_16x16x32_bf16 a[84:87], a[196:199], a[244:247], a[84:87]
    v_exp_f32 v234, v234
    v_mfma_f32_16x16x32_bf16 a[88:91], a[196:199], a[248:251], a[88:91]
    v_exp_f32 v235, v235
    v_mfma_f32_16x16x32_bf16 a[92:95], a[196:199], a[252:255], a[92:95]
    v_fma_f32 v236, v236, s52, -v44
    v_fma_f32 v237, v237, s52, -v44
    v_mfma_f32_16x16x32_bf16 a[96:99], a[200:203], a[232:235], a[96:99]
    s_waitcnt lgkmcnt(0)
    s_barrier
    ds_read_b64_tr_b16 a[160:161], v13 offset:49152
    v_mfma_f32_16x16x32_bf16 a[100:103], a[200:203], a[236:239], a[100:103]
    ds_read_b64_tr_b16 a[162:163], v13 offset:55296
    ds_read_b64_tr_b16 a[164:165], v14 offset:49152
    v_mfma_f32_16x16x32_bf16 a[104:107], a[200:203], a[240:243], a[104:107]
    ds_read_b64_tr_b16 a[166:167], v14 offset:55296
    ds_read_b64_tr_b16 a[168:169], v15 offset:49152
    v_mfma_f32_16x16x32_bf16 a[108:111], a[200:203], a[244:247], a[108:111]
    ds_read_b64_tr_b16 a[170:171], v15 offset:55296
    ds_read_b64_tr_b16 a[172:173], v16 offset:49152
    v_mfma_f32_16x16x32_bf16 a[112:115], a[200:203], a[248:251], a[112:115]
    ds_read_b64_tr_b16 a[174:175], v16 offset:55296
    ds_read_b64_tr_b16 a[176:177], v13 offset:49280
    v_mfma_f32_16x16x32_bf16 a[116:119], a[200:203], a[252:255], a[116:119]
    ds_read_b64_tr_b16 a[178:179], v13 offset:55424
    ds_read_b64_tr_b16 a[180:181], v14 offset:49280
    v_mfma_f32_16x16x32_bf16 a[120:123], a[204:207], a[232:235], a[120:123]
    ds_read_b64_tr_b16 a[182:183], v14 offset:55424
    ds_read_b128 v[212:215], v28 offset:0
    v_mfma_f32_16x16x32_bf16 a[124:127], a[204:207], a[236:239], a[124:127]
    ds_read_b128 v[220:223], v28 offset:1024
    v_fma_f32 v238, v238, s52, -v44
    v_mfma_f32_16x16x32_bf16 a[128:131], a[204:207], a[240:243], a[128:131]
    ds_read_b128 v[228:231], v28 offset:2048
    v_fma_f32 v239, v239, s52, -v44
    v_mfma_f32_16x16x32_bf16 a[132:135], a[204:207], a[244:247], a[132:135]
    v_exp_f32 v236, v236
    v_mfma_f32_16x16x32_bf16 a[136:139], a[204:207], a[248:251], a[136:139]
    v_exp_f32 v237, v237
    v_mfma_f32_16x16x32_bf16 a[140:143], a[204:207], a[252:255], a[140:143]
    s_waitcnt lgkmcnt(6)
    v_exp_f32 v238, v238
    v_mfma_f32_16x16x32_bf16 a[0:3], a[160:163], v[208:211], a[0:3]
    v_exp_f32 v239, v239
    v_mfma_f32_16x16x32_bf16 a[4:7], a[160:163], v[216:219], a[4:7]
    v_cvt_pk_bf16_f32 v232, v232, v233
    v_fma_f32 v240, v240, s52, -v45
    v_mfma_f32_16x16x32_bf16 a[8:11], a[160:163], v[224:227], a[8:11]
    ds_read_b64_tr_b16 a[160:161], v17 offset:49152
    ds_read_b64_tr_b16 a[162:163], v17 offset:55296
    v_mfma_f32_16x16x32_bf16 a[12:15], a[164:167], v[208:211], a[12:15]
    v_fma_f32 v241, v241, s52, -v45
    v_cvt_pk_bf16_f32 v233, v234, v235
    v_mfma_f32_16x16x32_bf16 a[16:19], a[164:167], v[216:219], a[16:19]
    v_exp_f32 v240, v240
    v_mfma_f32_16x16x32_bf16 a[20:23], a[164:167], v[224:227], a[20:23]
    ds_read_b64_tr_b16 a[164:165], v18 offset:49152
    ds_read_b64_tr_b16 a[166:167], v18 offset:55296
    v_mfma_f32_16x16x32_bf16 a[24:27], a[168:171], v[208:211], a[24:27]
    v_exp_f32 v241, v241
    v_mfma_f32_16x16x32_bf16 a[28:31], a[168:171], v[216:219], a[28:31]
    v_fma_f32 v242, v242, s52, -v45
    v_fma_f32 v243, v243, s52, -v45
    v_mfma_f32_16x16x32_bf16 a[32:35], a[168:171], v[224:227], a[32:35]
    ds_read_b64_tr_b16 a[168:169], v19 offset:49152
    ds_read_b64_tr_b16 a[170:171], v19 offset:55296
    v_mfma_f32_16x16x32_bf16 a[36:39], a[172:175], v[208:211], a[36:39]
    v_cvt_pk_bf16_f32 v234, v236, v237
    v_cvt_pk_bf16_f32 v235, v238, v239
    v_mfma_f32_16x16x32_bf16 a[40:43], a[172:175], v[216:219], a[40:43]
    ds_write_b128 v27, v[232:235] offset:12288
    v_mfma_f32_16x16x32_bf16 a[44:47], a[172:175], v[224:227], a[44:47]
    s_waitcnt lgkmcnt(3)
    v_exp_f32 v242, v242
    v_mfma_f32_16x16x32_bf16 a[48:51], a[176:179], v[208:211], a[48:51]
    ds_read_b64_tr_b16 a[172:173], v20 offset:49152
    v_fma_f32 v244, v244, s52, -v45
    v_mfma_f32_16x16x32_bf16 a[52:55], a[176:179], v[216:219], a[52:55]
    ds_read_b64_tr_b16 a[174:175], v20 offset:55296
    v_fma_f32 v245, v245, s52, -v45
    v_mfma_f32_16x16x32_bf16 a[56:59], a[176:179], v[224:227], a[56:59]
    ds_read_b64_tr_b16 a[176:177], v17 offset:49280
    ds_read_b64_tr_b16 a[178:179], v17 offset:55424
    v_mfma_f32_16x16x32_bf16 a[60:63], a[180:183], v[208:211], a[60:63]
    v_exp_f32 v243, v243
    v_mfma_f32_16x16x32_bf16 a[64:67], a[180:183], v[216:219], a[64:67]
    v_fma_f32 v246, v246, s52, -v45
    v_fma_f32 v247, v247, s52, -v45
    v_mfma_f32_16x16x32_bf16 a[68:71], a[180:183], v[224:227], a[68:71]
    ds_read_b64_tr_b16 a[180:181], v18 offset:49280
    ds_read_b64_tr_b16 a[182:183], v18 offset:55424
    v_mfma_f32_16x16x32_bf16 a[0:3], a[160:163], v[212:215], a[0:3]
    v_exp_f32 v244, v244
    v_mfma_f32_16x16x32_bf16 a[4:7], a[160:163], v[220:223], a[4:7]
    v_exp_f32 v245, v245
    v_mfma_f32_16x16x32_bf16 a[8:11], a[160:163], v[228:231], a[8:11]
    v_exp_f32 v246, v246
    v_mfma_f32_16x16x32_bf16 a[12:15], a[164:167], v[212:215], a[12:15]
    v_exp_f32 v247, v247
    v_mfma_f32_16x16x32_bf16 a[16:19], a[164:167], v[220:223], a[16:19]
    v_cvt_pk_bf16_f32 v240, v240, v241
    v_fma_f32 v248, v248, s52, -v46
    v_mfma_f32_16x16x32_bf16 a[20:23], a[164:167], v[228:231], a[20:23]
    s_waitcnt lgkmcnt(2)
    v_fma_f32 v249, v249, s52, -v46
    v_cvt_pk_bf16_f32 v241, v242, v243
    v_mfma_f32_16x16x32_bf16 a[24:27], a[168:171], v[212:215], a[24:27]
    v_exp_f32 v248, v248
    v_mfma_f32_16x16x32_bf16 a[28:31], a[168:171], v[220:223], a[28:31]
    v_exp_f32 v249, v249
    v_mfma_f32_16x16x32_bf16 a[32:35], a[168:171], v[228:231], a[32:35]
    v_fma_f32 v250, v250, s52, -v46
    v_fma_f32 v251, v251, s52, -v46
    v_mfma_f32_16x16x32_bf16 a[36:39], a[172:175], v[212:215], a[36:39]
    v_cvt_pk_bf16_f32 v242, v244, v245
    v_cvt_pk_bf16_f32 v243, v246, v247
    v_mfma_f32_16x16x32_bf16 a[40:43], a[172:175], v[220:223], a[40:43]
    ds_write_b128 v27, v[240:243] offset:13312
    v_mfma_f32_16x16x32_bf16 a[44:47], a[172:175], v[228:231], a[44:47]
    v_exp_f32 v250, v250
    v_mfma_f32_16x16x32_bf16 a[48:51], a[176:179], v[212:215], a[48:51]
    v_exp_f32 v251, v251
    v_mfma_f32_16x16x32_bf16 a[52:55], a[176:179], v[220:223], a[52:55]
    v_fma_f32 v252, v252, s52, -v46
    v_fma_f32 v253, v253, s52, -v46
    v_mfma_f32_16x16x32_bf16 a[56:59], a[176:179], v[228:231], a[56:59]
    s_waitcnt lgkmcnt(1)
    v_fma_f32 v254, v254, s52, -v46
    v_fma_f32 v255, v255, s52, -v46
    v_mfma_f32_16x16x32_bf16 a[60:63], a[180:183], v[212:215], a[60:63]
    v_exp_f32 v252, v252
    v_mfma_f32_16x16x32_bf16 a[64:67], a[180:183], v[220:223], a[64:67]
    v_exp_f32 v253, v253
    v_mfma_f32_16x16x32_bf16 a[68:71], a[180:183], v[228:231], a[68:71]
    v_exp_f32 v254, v254
    v_mfma_f32_16x16x32_bf16 a[144:147], a[156:159], v[232:235], a[144:147]
    v_exp_f32 v255, v255
    v_mfma_f32_16x16x32_bf16 a[148:151], a[156:159], v[240:243], a[148:151]
    v_cvt_pk_bf16_f32 v248, v248, v249
    v_cvt_pk_bf16_f32 v249, v250, v251
    v_cvt_pk_bf16_f32 v250, v252, v253
    v_cvt_pk_bf16_f32 v251, v254, v255
    v_accvgpr_read_b32 v64, a72
    v_accvgpr_read_b32 v65, a73
    v_mfma_f32_16x16x32_bf16 a[152:155], a[156:159], v[248:251], a[152:155]
    ds_write_b128 v27, v[248:251] offset:14336
    v_accvgpr_read_b32 v68, a76
    v_accvgpr_read_b32 v69, a77
    v_accvgpr_read_b32 v72, a80
    v_accvgpr_read_b32 v73, a81
    v_accvgpr_read_b32 v76, a84
    v_accvgpr_read_b32 v77, a85
    v_accvgpr_read_b32 v80, a88
    v_accvgpr_read_b32 v81, a89
    v_accvgpr_read_b32 v84, a92
    v_accvgpr_read_b32 v85, a93
    v_accvgpr_read_b32 v66, a74
    v_accvgpr_read_b32 v67, a75
    v_cvt_pk_bf16_f32 v64, v64, v65
    v_accvgpr_read_b32 v70, a78
    v_accvgpr_read_b32 v71, a79
    v_cvt_pk_bf16_f32 v68, v68, v69
    v_accvgpr_read_b32 v74, a82
    v_accvgpr_read_b32 v75, a83
    v_cvt_pk_bf16_f32 v72, v72, v73
    v_accvgpr_read_b32 v78, a86
    v_accvgpr_read_b32 v79, a87
    v_cvt_pk_bf16_f32 v76, v76, v77
    v_accvgpr_read_b32 v82, a90
    v_accvgpr_read_b32 v83, a91
    v_cvt_pk_bf16_f32 v80, v80, v81
    v_accvgpr_read_b32 v86, a94
    v_accvgpr_read_b32 v87, a95
    v_cvt_pk_bf16_f32 v84, v84, v85
    v_cvt_pk_bf16_f32 v65, v66, v67
    v_cvt_pk_bf16_f32 v69, v70, v71
    v_cvt_pk_bf16_f32 v73, v74, v75
    v_cvt_pk_bf16_f32 v77, v78, v79
    v_cvt_pk_bf16_f32 v81, v82, v83
    v_cvt_pk_bf16_f32 v85, v86, v87
    v_accvgpr_read_b32 v88, a96
    v_accvgpr_read_b32 v89, a97
    v_accvgpr_read_b32 v92, a100
    v_accvgpr_read_b32 v93, a101
    v_accvgpr_read_b32 v96, a104
    v_accvgpr_read_b32 v97, a105
    v_accvgpr_read_b32 v100, a108
    v_accvgpr_read_b32 v101, a109
    v_accvgpr_read_b32 v104, a112
    v_accvgpr_read_b32 v105, a113
    v_accvgpr_read_b32 v108, a116
    v_accvgpr_read_b32 v109, a117
    v_accvgpr_read_b32 v90, a98
    v_accvgpr_read_b32 v91, a99
    v_cvt_pk_bf16_f32 v88, v88, v89
    v_accvgpr_read_b32 v94, a102
    v_accvgpr_read_b32 v95, a103
    v_cvt_pk_bf16_f32 v92, v92, v93
    v_accvgpr_read_b32 v98, a106
    v_accvgpr_read_b32 v99, a107
    v_cvt_pk_bf16_f32 v96, v96, v97
    v_accvgpr_read_b32 v102, a110
    v_accvgpr_read_b32 v103, a111
    v_cvt_pk_bf16_f32 v100, v100, v101
    v_accvgpr_read_b32 v106, a114
    v_accvgpr_read_b32 v107, a115
    v_cvt_pk_bf16_f32 v104, v104, v105
    v_accvgpr_read_b32 v110, a118
    v_accvgpr_read_b32 v111, a119
    v_cvt_pk_bf16_f32 v108, v108, v109
    v_accvgpr_read_b32 v66, a122
    v_accvgpr_read_b32 v67, a123
    v_accvgpr_read_b32 v70, a126
    v_accvgpr_read_b32 v71, a127
    v_accvgpr_read_b32 v74, a130
    v_accvgpr_read_b32 v75, a131
    v_accvgpr_read_b32 v78, a134
    v_accvgpr_read_b32 v79, a135
    v_accvgpr_read_b32 v82, a138
    v_accvgpr_read_b32 v83, a139
    v_accvgpr_read_b32 v86, a142
    v_accvgpr_read_b32 v87, a143
    v_accvgpr_read_b32 v36, a144
    v_accvgpr_read_b32 v37, a148
    v_accvgpr_read_b32 v38, a152
    v_cvt_pk_bf16_f32 v89, v90, v91
    v_cvt_pk_bf16_f32 v93, v94, v95
    v_cvt_pk_bf16_f32 v97, v98, v99
    v_cvt_pk_bf16_f32 v101, v102, v103
    v_cvt_pk_bf16_f32 v105, v106, v107
    v_cvt_pk_bf16_f32 v109, v110, v111
    ds_write_b64 v29, v[64:65] offset:0
    v_accvgpr_read_b32 v64, a120
    v_accvgpr_read_b32 v65, a121
    v_cvt_pk_bf16_f32 v64, v64, v65
    v_cvt_pk_bf16_f32 v65, v66, v67
    ds_write_b64 v29, v[68:69] offset:6144
    v_accvgpr_read_b32 v68, a124
    v_accvgpr_read_b32 v69, a125
    v_cvt_pk_bf16_f32 v68, v68, v69
    v_cvt_pk_bf16_f32 v69, v70, v71
    ds_write_b64 v29, v[72:73] offset:12288
    v_accvgpr_read_b32 v72, a128
    v_accvgpr_read_b32 v73, a129
    v_cvt_pk_bf16_f32 v72, v72, v73
    v_cvt_pk_bf16_f32 v73, v74, v75
    ds_write_b64 v29, v[76:77] offset:18432
    v_accvgpr_read_b32 v76, a132
    v_accvgpr_read_b32 v77, a133
    v_cvt_pk_bf16_f32 v76, v76, v77
    v_cvt_pk_bf16_f32 v77, v78, v79
    ds_write_b64 v29, v[80:81] offset:24576
    v_accvgpr_read_b32 v80, a136
    v_accvgpr_read_b32 v81, a137
    v_cvt_pk_bf16_f32 v80, v80, v81
    v_cvt_pk_bf16_f32 v81, v82, v83
    ds_write_b64 v29, v[84:85] offset:30720
    v_accvgpr_read_b32 v84, a140
    v_accvgpr_read_b32 v85, a141
    v_cvt_pk_bf16_f32 v84, v84, v85
    v_cvt_pk_bf16_f32 v85, v86, v87
    ds_write_b128 v31, v[36:39]
    v_add_u32 v21, 0, v58
    v_add_u32 v23, 49152, v58
    v_add_u32 v25, 98304, v58
    v_xor_b32 v22, 32, v21
    v_xor_b32 v24, 32, v23
    v_xor_b32 v26, 32, v25
    ds_write_b64 v29, v[88:89] offset:512
    ds_write_b64 v29, v[92:93] offset:6656
    ds_write_b64 v29, v[96:97] offset:12800
    ds_write_b64 v29, v[100:101] offset:18944
    ds_write_b64 v29, v[104:105] offset:25088
    ds_write_b64 v29, v[108:109] offset:31232
    ds_write_b64 v29, v[64:65] offset:1024
    ds_write_b64 v29, v[68:69] offset:7168
    ds_write_b64 v29, v[72:73] offset:13312
    ds_write_b64 v29, v[76:77] offset:19456
    ds_write_b64 v29, v[80:81] offset:25600
    ds_write_b64 v29, v[84:85] offset:31744
    v_mul_u32_u24 v29, 2560, v48
    s_waitcnt vmcnt(6) lgkmcnt(0)
    s_barrier
    ds_read_b64_tr_b16 a[160:161], v13 offset:0
    ds_read_b64_tr_b16 a[162:163], v13 offset:6144
    ds_read_b64_tr_b16 a[164:165], v14 offset:0
    buffer_load_dwordx4 v2, s[12:15], s57 offen nt lds
    ds_read_b64_tr_b16 a[166:167], v14 offset:6144
    ds_read_b64_tr_b16 a[168:169], v15 offset:0
    ds_read_b64_tr_b16 a[170:171], v15 offset:6144
    ds_read_b64_tr_b16 a[172:173], v16 offset:0
    ds_read_b64_tr_b16 a[174:175], v16 offset:6144
    ds_read_b64_tr_b16 a[176:177], v13 offset:128
    ds_read_b64_tr_b16 a[178:179], v13 offset:6272
    ds_read_b64_tr_b16 a[180:181], v14 offset:128
    ds_read_b64_tr_b16 a[182:183], v14 offset:6272
    s_waitcnt vmcnt(6)
    buffer_load_dwordx4 v3, s[12:15], s57 offen offset:1024 nt lds
    ds_read_b128 v[236:239], v28 offset:12288
    s_waitcnt lgkmcnt(11)
    v_mfma_f32_16x16x32_bf16 a[0:3], a[160:163], v[232:235], a[0:3]
    ds_read_b128 v[244:247], v28 offset:13312
    v_mfma_f32_16x16x32_bf16 a[4:7], a[160:163], v[240:243], a[4:7]
    ds_read_b128 v[252:255], v28 offset:14336
    v_mfma_f32_16x16x32_bf16 a[8:11], a[160:163], v[248:251], a[8:11]
    s_waitcnt lgkmcnt(9)
    ds_read_b64_tr_b16 a[160:161], v17 offset:0
    ds_read_b64_tr_b16 a[162:163], v17 offset:6144
    v_mfma_f32_16x16x32_bf16 a[12:15], a[164:167], v[232:235], a[12:15]
    s_waitcnt vmcnt(6)
    buffer_load_dwordx4 v4, s[12:15], s57 offen offset:2048 nt lds
    v_mfma_f32_16x16x32_bf16 a[16:19], a[164:167], v[240:243], a[16:19]
    s_mov_b32 s57, 3182592
    ds_read_b128 a[72:75], v30 offset:0
    s_add_u32 m0, s51, 61440
    v_mfma_f32_16x16x32_bf16 a[20:23], a[164:167], v[248:251], a[20:23]
    ds_read_b64_tr_b16 a[164:165], v18 offset:0
    ds_read_b64_tr_b16 a[166:167], v18 offset:6144
    v_mfma_f32_16x16x32_bf16 a[24:27], a[168:171], v[232:235], a[24:27]
    ds_read_b128 a[76:79], v30 offset:6144
    v_mfma_f32_16x16x32_bf16 a[28:31], a[168:171], v[240:243], a[28:31]
    ds_read_b128 a[80:83], v30 offset:12288
    v_mfma_f32_16x16x32_bf16 a[32:35], a[168:171], v[248:251], a[32:35]
    s_waitcnt lgkmcnt(7)
    s_waitcnt vmcnt(6)
    buffer_load_dwordx4 v2, s[12:15], s57 offen nt lds
    v_mfma_f32_16x16x32_bf16 a[36:39], a[172:175], v[232:235], a[36:39]
    ds_read_b64_tr_b16 a[168:169], v19 offset:0
    ds_read_b64_tr_b16 a[170:171], v19 offset:6144
    v_mfma_f32_16x16x32_bf16 a[40:43], a[172:175], v[240:243], a[40:43]
    ds_read_b128 a[84:87], v30 offset:1024
    v_mfma_f32_16x16x32_bf16 a[44:47], a[172:175], v[248:251], a[44:47]
    ds_read_b64_tr_b16 a[172:173], v20 offset:0
    ds_read_b64_tr_b16 a[174:175], v20 offset:6144
    v_mfma_f32_16x16x32_bf16 a[48:51], a[176:179], v[232:235], a[48:51]
    ds_read_b128 a[88:91], v30 offset:7168
    v_mfma_f32_16x16x32_bf16 a[52:55], a[176:179], v[240:243], a[52:55]
    s_waitcnt vmcnt(6)
    buffer_load_dwordx4 v3, s[12:15], s57 offen offset:1024 nt lds
    v_mfma_f32_16x16x32_bf16 a[56:59], a[176:179], v[248:251], a[56:59]
    ds_read_b64_tr_b16 a[176:177], v17 offset:128
    ds_read_b64_tr_b16 a[178:179], v17 offset:6272
    v_mfma_f32_16x16x32_bf16 a[60:63], a[180:183], v[232:235], a[60:63]
    ds_read_b128 a[92:95], v30 offset:13312
    v_mfma_f32_16x16x32_bf16 a[64:67], a[180:183], v[240:243], a[64:67]
    ds_read_b128 a[96:99], v30 offset:2048
    v_mfma_f32_16x16x32_bf16 a[68:71], a[180:183], v[248:251], a[68:71]
    s_waitcnt lgkmcnt(7)
    ds_read_b64_tr_b16 a[180:181], v18 offset:128
    ds_read_b64_tr_b16 a[182:183], v18 offset:6272
    v_mfma_f32_16x16x32_bf16 a[0:3], a[160:163], v[236:239], a[0:3]
    s_waitcnt vmcnt(6)
    buffer_load_dwordx4 v4, s[12:15], s57 offen offset:2048 nt lds
    v_mfma_f32_16x16x32_bf16 a[4:7], a[160:163], v[244:247], a[4:7]
    s_mov_b32 s57, 3194880
    ds_read_b128 a[100:103], v30 offset:8192
    s_add_u32 m0, s51, 0
    v_mfma_f32_16x16x32_bf16 a[8:11], a[160:163], v[252:255], a[8:11]
    ds_read_b128 a[104:107], v30 offset:14336
    v_mfma_f32_16x16x32_bf16 a[12:15], a[164:167], v[236:239], a[12:15]
    ds_read_b128 a[108:111], v30 offset:3072
    v_accvgpr_read_b32 v184, a0
    v_mfma_f32_16x16x32_bf16 a[16:19], a[164:167], v[244:247], a[16:19]
    ds_read_b128 a[112:115], v30 offset:9216
    v_accvgpr_read_b32 v185, a1
    v_mfma_f32_16x16x32_bf16 a[20:23], a[164:167], v[252:255], a[20:23]
    ds_read_b128 a[116:119], v30 offset:15360
    v_accvgpr_read_b32 v192, a4
    v_mfma_f32_16x16x32_bf16 a[24:27], a[168:171], v[236:239], a[24:27]
    ds_read_b128 a[120:123], v30 offset:4096
    v_accvgpr_read_b32 v193, a5
    v_mfma_f32_16x16x32_bf16 a[28:31], a[168:171], v[244:247], a[28:31]
    ds_read_b128 a[124:127], v30 offset:10240
    v_accvgpr_read_b32 v200, a8
    v_mfma_f32_16x16x32_bf16 a[32:35], a[168:171], v[252:255], a[32:35]
    s_waitcnt lgkmcnt(6)
    ds_read_b128 a[128:131], v30 offset:16384
    v_accvgpr_read_b32 v201, a9
    v_mfma_f32_16x16x32_bf16 a[36:39], a[172:175], v[236:239], a[36:39]
    ds_read_b128 a[132:135], v30 offset:5120
    v_accvgpr_read_b32 v208, a24
    v_mfma_f32_16x16x32_bf16 a[40:43], a[172:175], v[244:247], a[40:43]
    ds_read_b128 a[136:139], v30 offset:11264
    v_accvgpr_read_b32 v209, a25
    v_mfma_f32_16x16x32_bf16 a[44:47], a[172:175], v[252:255], a[44:47]
    ds_read_b128 a[140:143], v30 offset:17408
    v_accvgpr_read_b32 v216, a28
    v_mfma_f32_16x16x32_bf16 a[48:51], a[176:179], v[236:239], a[48:51]
    ds_read_b128 v[40:43], v32
    v_accvgpr_read_b32 v217, a29
    v_mfma_f32_16x16x32_bf16 a[52:55], a[176:179], v[244:247], a[52:55]
    v_accvgpr_read_b32 v224, a32
    v_accvgpr_read_b32 v225, a33
    v_mfma_f32_16x16x32_bf16 a[56:59], a[176:179], v[252:255], a[56:59]
    v_accvgpr_read_b32 v186, a2
    v_accvgpr_read_b32 v187, a3
    v_mfma_f32_16x16x32_bf16 a[60:63], a[180:183], v[236:239], a[60:63]
    v_accvgpr_read_b32 v232, a48
    v_accvgpr_read_b32 v233, a49
    v_mfma_f32_16x16x32_bf16 a[64:67], a[180:183], v[244:247], a[64:67]
    v_accvgpr_read_b32 v240, a52
    v_accvgpr_read_b32 v241, a53
    v_mfma_f32_16x16x32_bf16 a[68:71], a[180:183], v[252:255], a[68:71]
    v_accvgpr_read_b32 v248, a56
    v_accvgpr_read_b32 v249, a57
    v_accvgpr_read_b32 v194, a6
    s_waitcnt vmcnt(6) lgkmcnt(0)
    s_barrier
    ds_read_b128 a[160:163], v11 offset:24576
    buffer_load_dwordx4 v2, s[12:15], s57 offen nt lds
    ds_read_b128 a[164:167], v12 offset:24576
    v_add_f32 v52, v36, v40
    v_add_f32 v53, v37, v41
    ds_read_b128 a[168:171], v11 offset:24704
    v_add_f32 v54, v38, v42
    ds_read_b128 a[172:175], v12 offset:24704
    s_waitcnt vmcnt(6)
    buffer_load_dwordx4 v3, s[12:15], s57 offen offset:1024 nt lds
    ds_read_b128 a[176:179], v11 offset:24832
    v_rcp_f32 v52, v52
    ds_read_b128 a[180:183], v12 offset:24832
    v_mul_f32 v184, v52, v184
    v_rcp_f32 v53, v53
    s_waitcnt lgkmcnt(5)
    v_mfma_f32_16x16x32_bf16 v[64:67], a[160:163], a[72:75], 0
    s_waitcnt vmcnt(6)
    buffer_load_dwordx4 v4, s[12:15], s57 offen offset:2048 nt lds
    v_mfma_f32_16x16x32_bf16 v[72:75], a[160:163], a[76:79], 0
    s_mov_b32 s57, 3207168
    s_add_u32 m0, s51, 12288
    v_mul_f32 v185, v52, v185
    v_mfma_f32_16x16x32_bf16 v[80:83], a[160:163], a[80:83], 0
    s_waitcnt lgkmcnt(3)
    ds_read_b128 a[160:163], v11 offset:30720
    v_mul_f32 v192, v53, v192
    v_mfma_f32_16x16x32_bf16 v[64:67], a[164:167], a[84:87], v[64:67]
    s_waitcnt vmcnt(6)
    buffer_load_dwordx4 v2, s[12:15], s57 offen nt lds
    v_mfma_f32_16x16x32_bf16 v[72:75], a[164:167], a[88:91], v[72:75]
    v_rcp_f32 v54, v54
    v_mfma_f32_16x16x32_bf16 v[80:83], a[164:167], a[92:95], v[80:83]
    ds_read_b128 a[164:167], v12 offset:30720
    v_mul_f32 v193, v53, v193
    v_mfma_f32_16x16x32_bf16 v[64:67], a[168:171], a[96:99], v[64:67]
    s_waitcnt vmcnt(6)
    buffer_load_dwordx4 v3, s[12:15], s57 offen offset:1024 nt lds
    v_mfma_f32_16x16x32_bf16 v[72:75], a[168:171], a[100:103], v[72:75]
    v_accvgpr_read_b32 v195, a7
    v_mul_f32 v200, v54, v200
    v_mfma_f32_16x16x32_bf16 v[80:83], a[168:171], a[104:107], v[80:83]
    s_waitcnt lgkmcnt(2)
    ds_read_b128 a[168:171], v11 offset:30848
    v_mul_f32 v201, v54, v201
    v_mfma_f32_16x16x32_bf16 v[64:67], a[172:175], a[108:111], v[64:67]
    s_waitcnt vmcnt(6)
    buffer_load_dwordx4 v4, s[12:15], s57 offen offset:2048 nt lds
    v_mfma_f32_16x16x32_bf16 v[72:75], a[172:175], a[112:115], v[72:75]
    s_add_u32 m0, s51, 73728
    s_sub_u32 s57, s45, 1280
    s_cselect_b32 s45, s45, s57
    v_mfma_f32_16x16x32_bf16 v[80:83], a[172:175], a[116:119], v[80:83]
    s_add_u32 s57, s45, 0
    ds_read_b128 a[172:175], v12 offset:30848
    v_accvgpr_read_b32 v202, a10
    v_mfma_f32_16x16x32_bf16 v[64:67], a[176:179], a[120:123], v[64:67]
    s_add_u32 s45, s44, 1024
    s_waitcnt vmcnt(6)
    buffer_load_dwordx4 v8, s[24:27], s57 offen lds
    v_mfma_f32_16x16x32_bf16 v[72:75], a[176:179], a[124:127], v[72:75]
    v_accvgpr_read_b32 v203, a11
    v_mul_f32 v208, v52, v208
    v_mfma_f32_16x16x32_bf16 v[80:83], a[176:179], a[128:131], v[80:83]
    ds_read_b128 a[176:179], v11 offset:30976
    v_mul_f32 v209, v52, v209
    v_mfma_f32_16x16x32_bf16 v[64:67], a[180:183], a[132:135], v[64:67]
    s_waitcnt vmcnt(6)
    buffer_load_dwordx4 v9, s[24:27], s57 offen offset:1024 lds
    v_mfma_f32_16x16x32_bf16 v[72:75], a[180:183], a[136:139], v[72:75]
    v_accvgpr_read_b32 v210, a26
    v_accvgpr_read_b32 v211, a27
    v_mfma_f32_16x16x32_bf16 v[80:83], a[180:183], a[140:143], v[80:83]
    s_waitcnt lgkmcnt(2)
    ds_read_b128 a[180:183], v12 offset:30976
    v_mul_f32 v216, v53, v216
    v_mfma_f32_16x16x32_bf16 v[68:71], a[160:163], a[72:75], 0
    s_waitcnt vmcnt(6)
    buffer_load_dwordx4 v10, s[24:27], s57 offen offset:2048 lds
    v_mfma_f32_16x16x32_bf16 v[76:79], a[160:163], a[76:79], 0
    s_add_u32 m0, s51, 86016
    v_mul_f32 v217, v53, v217
    v_accvgpr_read_b32 v218, a30
    v_mfma_f32_16x16x32_bf16 v[84:87], a[160:163], a[80:83], 0
    v_accvgpr_read_b32 v219, a31
    v_mul_f32 v224, v54, v224
    v_mfma_f32_16x16x32_bf16 v[68:71], a[164:167], a[84:87], v[68:71]
    v_mul_f32 v225, v54, v225
    v_accvgpr_read_b32 v226, a34
    v_mfma_f32_16x16x32_bf16 v[76:79], a[164:167], a[88:91], v[76:79]
    v_accvgpr_read_b32 v227, a35
    v_mul_f32 v232, v52, v232
    v_mfma_f32_16x16x32_bf16 v[84:87], a[164:167], a[92:95], v[84:87]
    v_mul_f32 v233, v52, v233
    v_accvgpr_read_b32 v234, a50
    v_mfma_f32_16x16x32_bf16 v[68:71], a[168:171], a[96:99], v[68:71]
    v_accvgpr_read_b32 v235, a51
    v_mul_f32 v240, v53, v240
    v_mfma_f32_16x16x32_bf16 v[76:79], a[168:171], a[100:103], v[76:79]
    v_mul_f32 v241, v53, v241
    v_accvgpr_read_b32 v242, a54
    v_mfma_f32_16x16x32_bf16 v[84:87], a[168:171], a[104:107], v[84:87]
    s_waitcnt lgkmcnt(0)
    v_accvgpr_read_b32 v243, a55
    v_mul_f32 v248, v54, v248
    v_mfma_f32_16x16x32_bf16 v[68:71], a[172:175], a[108:111], v[68:71]
    v_mul_f32 v249, v54, v249
    v_accvgpr_read_b32 v250, a58
    v_mfma_f32_16x16x32_bf16 v[76:79], a[172:175], a[112:115], v[76:79]
    v_accvgpr_read_b32 v251, a59
    v_mul_f32 v186, v52, v186
    v_mfma_f32_16x16x32_bf16 v[84:87], a[172:175], a[116:119], v[84:87]
    v_mul_f32 v187, v52, v187
    v_accvgpr_read_b32 v188, a12
    v_mfma_f32_16x16x32_bf16 v[68:71], a[176:179], a[120:123], v[68:71]
    v_accvgpr_read_b32 v189, a13
    v_accvgpr_read_b32 v190, a14
    v_mfma_f32_16x16x32_bf16 v[76:79], a[176:179], a[124:127], v[76:79]
    v_accvgpr_read_b32 v191, a15
    v_cvt_pk_bf16_f32 v184, v184, v185
    v_mfma_f32_16x16x32_bf16 v[84:87], a[176:179], a[128:131], v[84:87]
    v_mul_f32 v194, v53, v194
    v_mul_f32 v195, v53, v195
    v_mfma_f32_16x16x32_bf16 v[68:71], a[180:183], a[132:135], v[68:71]
    v_accvgpr_read_b32 v196, a16
    v_accvgpr_read_b32 v197, a17
    v_mfma_f32_16x16x32_bf16 v[76:79], a[180:183], a[136:139], v[76:79]
    v_accvgpr_read_b32 v198, a18
    v_accvgpr_read_b32 v199, a19
    v_mfma_f32_16x16x32_bf16 v[84:87], a[180:183], a[140:143], v[84:87]
    v_cvt_pk_bf16_f32 v192, v192, v193
    v_mul_f32 v202, v54, v202
    v_mul_f32 v203, v54, v203
    v_accvgpr_read_b32 v204, a20
    v_accvgpr_read_b32 v205, a21
    v_accvgpr_read_b32 v206, a22
    v_accvgpr_read_b32 v207, a23
    v_cvt_pk_bf16_f32 v200, v200, v201
    v_mul_f32 v210, v52, v210
    v_mul_f32 v211, v52, v211
    v_accvgpr_read_b32 v212, a36
    v_accvgpr_read_b32 v213, a37
    v_accvgpr_read_b32 v214, a38
    v_accvgpr_read_b32 v215, a39
    v_cvt_pk_bf16_f32 v208, v208, v209
    v_mul_f32 v218, v53, v218
    v_mul_f32 v219, v53, v219
    v_accvgpr_read_b32 v220, a40
    v_accvgpr_read_b32 v221, a41
    v_accvgpr_read_b32 v222, a42
    v_accvgpr_read_b32 v223, a43
    v_cvt_pk_bf16_f32 v216, v216, v217
    v_mul_f32 v226, v54, v226
    v_mul_f32 v227, v54, v227
    v_accvgpr_read_b32 v228, a44
    v_accvgpr_read_b32 v229, a45
    v_accvgpr_read_b32 v230, a46
    v_accvgpr_read_b32 v231, a47
    v_cvt_pk_bf16_f32 v224, v224, v225
    v_mul_f32 v234, v52, v234
    v_mul_f32 v235, v52, v235
    v_accvgpr_read_b32 v236, a60
    v_accvgpr_read_b32 v237, a61
    v_accvgpr_read_b32 v238, a62
    v_accvgpr_read_b32 v239, a63
    v_cvt_pk_bf16_f32 v232, v232, v233
    v_mul_f32 v242, v53, v242
    v_mul_f32 v243, v53, v243
    v_accvgpr_read_b32 v244, a64
    v_accvgpr_read_b32 v245, a65
    v_accvgpr_read_b32 v246, a66
    v_accvgpr_read_b32 v247, a67
    v_cvt_pk_bf16_f32 v240, v240, v241
    v_mul_f32 v250, v54, v250
    v_mul_f32 v251, v54, v251
    v_accvgpr_read_b32 v252, a68
    v_accvgpr_read_b32 v253, a69
    v_accvgpr_read_b32 v254, a70
    v_accvgpr_read_b32 v255, a71
    v_cvt_pk_bf16_f32 v248, v248, v249
    v_mul_f32 v188, v52, v188
    v_mul_f32 v189, v52, v189
    v_mul_f32 v190, v52, v190
    v_mul_f32 v191, v52, v191
    v_cvt_pk_bf16_f32 v185, v186, v187
    v_mul_f32 v196, v53, v196
    v_mul_f32 v197, v53, v197
    v_mul_f32 v198, v53, v198
    v_mul_f32 v199, v53, v199
    v_cvt_pk_bf16_f32 v193, v194, v195
    v_mul_f32 v204, v54, v204
    v_mul_f32 v205, v54, v205
    v_mul_f32 v206, v54, v206
    v_mul_f32 v207, v54, v207
    v_cvt_pk_bf16_f32 v201, v202, v203
    v_mul_f32 v212, v52, v212
    v_mul_f32 v213, v52, v213
    v_mul_f32 v214, v52, v214
    v_mul_f32 v215, v52, v215
    v_cvt_pk_bf16_f32 v209, v210, v211
    v_mul_f32 v220, v53, v220
    v_mul_f32 v221, v53, v221
    v_mul_f32 v222, v53, v222
    v_mul_f32 v223, v53, v223
    v_cvt_pk_bf16_f32 v217, v218, v219
    v_mul_f32 v228, v54, v228
    v_mul_f32 v229, v54, v229
    v_mul_f32 v230, v54, v230
    v_mul_f32 v231, v54, v231
    v_cvt_pk_bf16_f32 v225, v226, v227
    v_mul_f32 v236, v52, v236
    v_mul_f32 v237, v52, v237
    v_mul_f32 v238, v52, v238
    v_mul_f32 v239, v52, v239
    v_cvt_pk_bf16_f32 v233, v234, v235
    v_mul_f32 v244, v53, v244
    v_mul_f32 v245, v53, v245
    v_mul_f32 v246, v53, v246
    v_mul_f32 v247, v53, v247
    v_cvt_pk_bf16_f32 v241, v242, v243
    v_mul_f32 v252, v54, v252
    v_mul_f32 v253, v54, v253
    v_mul_f32 v254, v54, v254
    v_mul_f32 v255, v54, v255
    v_cvt_pk_bf16_f32 v249, v250, v251
    v_cvt_pk_bf16_f32 v186, v188, v189
    v_cvt_pk_bf16_f32 v187, v190, v191
    v_cvt_pk_bf16_f32 v194, v196, v197
    v_cvt_pk_bf16_f32 v195, v198, v199
    v_cvt_pk_bf16_f32 v202, v204, v205
    v_cvt_pk_bf16_f32 v203, v206, v207
    v_cvt_pk_bf16_f32 v210, v212, v213
    v_cvt_pk_bf16_f32 v211, v214, v215
    v_cvt_pk_bf16_f32 v218, v220, v221
    v_cvt_pk_bf16_f32 v219, v222, v223
    v_cvt_pk_bf16_f32 v226, v228, v229
    v_cvt_pk_bf16_f32 v227, v230, v231
    v_cvt_pk_bf16_f32 v234, v236, v237
    v_cvt_pk_bf16_f32 v235, v238, v239
    v_cvt_pk_bf16_f32 v242, v244, v245
    v_cvt_pk_bf16_f32 v243, v246, v247
    v_cvt_pk_bf16_f32 v250, v252, v253
    v_cvt_pk_bf16_f32 v251, v254, v255
    ds_write_b128 v33, v[184:187] offset:24576
    v_max3_f32 v36, v64, v65, v66
    v_max3_f32 v37, v72, v73, v74
    v_max3_f32 v38, v80, v81, v82
    v_max_f32 v36, v36, v67
    v_max_f32 v37, v37, v75
    v_max_f32 v38, v38, v83
    ds_write_b128 v33, v[192:195] offset:25600
    s_sub_u32 s57, s45, 1280
    s_cselect_b32 s45, s45, s57
    s_add_u32 s57, s45, 122880
    v_max3_f32 v36, v36, v68, v69
    v_max3_f32 v37, v37, v76, v77
    v_max3_f32 v38, v38, v84, v85
    ds_write_b128 v33, v[200:203] offset:26624
    v_max3_f32 v36, v36, v70, v71
    v_max3_f32 v37, v37, v78, v79
    v_max3_f32 v38, v38, v86, v87
    s_add_u32 s45, s44, 896
    v_lshlrev_b32 v30, 2, v48
    ds_write_b128 v33, v[208:211] offset:30720
    ds_write_b128 v33, v[216:219] offset:31744
    ds_write_b128 v33, v[224:227] offset:32768
    ds_write_b128 v33, v[232:235] offset:36864
    ds_write_b128 v33, v[240:243] offset:37888
    ds_write_b128 v33, v[248:251] offset:38912
    s_waitcnt lgkmcnt(0)
    s_barrier
    ds_read_b128 a[160:163], v11 offset:49152
    s_waitcnt vmcnt(6)
    buffer_load_dwordx4 v8, s[24:27], s57 offen lds
    ds_read_b128 a[164:167], v12 offset:49152
    s_getpc_b64 s[6:7]
LB_pc0:
    s_mov_b32 s58, LB_code_end-LB_pc0-4
    v_min_u32 v62, s58, v62
    v_mov_b32 v63, s7
    v_add_co_u32 v62, vcc, s6, v62
    s_nop 1
    v_addc_co_u32 v63, vcc, 0, v63, vcc
    ds_read_b128 a[168:171], v11 offset:49280
    s_waitcnt vmcnt(6)
    buffer_load_dwordx4 v9, s[24:27], s57 offen offset:1024 lds
    ds_read_b128 a[172:175], v12 offset:49280
    global_load_dword v43, v[62:63], off
    ds_read_b128 a[176:179], v11 offset:49408
    s_mul_i32 s58, s48, 3072
    v_add_u32 v5, s58, v1
    s_waitcnt lgkmcnt(4)
    v_mfma_f32_16x16x32_bf16 v[88:91], a[160:163], a[72:75], 0
    s_add_u32 s58, s64, 0
    ds_read_b128 a[180:183], v12 offset:49408
    s_mul_i32 s59, s58, 171
    v_mfma_f32_16x16x32_bf16 v[96:99], a[160:163], a[76:79], 0
    s_lshr_b32 s59, s59, 9
    s_waitcnt vmcnt(6)
    buffer_load_dwordx4 v10, s[24:27], s57 offen offset:2048 lds
    v_mfma_f32_16x16x32_bf16 v[104:107], a[160:163], a[80:83], 0
    s_mov_b32 s57, 3219456
    ds_read_b128 a[160:163], v11 offset:55296
    s_add_u32 m0, s51, 24576
    s_waitcnt lgkmcnt(5)
    v_mfma_f32_16x16x32_bf16 v[88:91], a[164:167], a[84:87], v[88:91]
    s_mul_i32 s59, s59, 9
    ds_read_b128 a[0:3], v35 offset:24576
    s_add_u32 s58, s58, s59
    v_mfma_f32_16x16x32_bf16 v[96:99], a[164:167], a[88:91], v[96:99]
    s_mul_i32 s59, s48, 3
    s_waitcnt vmcnt(6)
    buffer_load_dwordx4 v2, s[12:15], s57 offen nt lds
    v_mfma_f32_16x16x32_bf16 v[104:107], a[164:167], a[92:95], v[104:107]
    s_add_u32 s58, s58, s59
    ds_read_b128 a[164:167], v12 offset:55296
    s_mul_i32 s59, s58, 171
    s_waitcnt lgkmcnt(4)
    v_mfma_f32_16x16x32_bf16 v[88:91], a[168:171], a[96:99], v[88:91]
    s_lshr_b32 s59, s59, 9
    ds_read_b128 a[4:7], v35 offset:25600
    s_mul_i32 s8, s58, 1024
    v_mfma_f32_16x16x32_bf16 v[96:99], a[168:171], a[100:103], v[96:99]
    s_mul_i32 s60, s59, 3
    s_waitcnt vmcnt(6)
    buffer_load_dwordx4 v3, s[12:15], s57 offen offset:1024 nt lds
    v_mfma_f32_16x16x32_bf16 v[104:107], a[168:171], a[104:107], v[104:107]
    s_sub_u32 s58, s58, s60
    ds_read_b128 a[168:171], v11 offset:55424
    s_and_b32 s60, s59, 3
    v_mfma_f32_16x16x32_bf16 v[88:91], a[172:175], a[108:111], v[88:91]
    s_lshl_b32 s9, s60, 6
    ds_read_b128 a[8:11], v35 offset:26624
    s_lshr_b32 s10, s60, 1
    v_mfma_f32_16x16x32_bf16 v[96:99], a[172:175], a[112:115], v[96:99]
    s_and_b32 s60, s60, 1
    s_waitcnt vmcnt(6)
    buffer_load_dwordx4 v4, s[12:15], s57 offen offset:2048 nt lds
    v_mfma_f32_16x16x32_bf16 v[104:107], a[172:175], a[116:119], v[104:107]
    s_mov_b32 s57, 3231744
    ds_read_b128 a[172:175], v12 offset:55424
    s_add_u32 m0, s51, 36864
    v_mfma_f32_16x16x32_bf16 v[88:91], a[176:179], a[120:123], v[88:91]
    s_mul_i32 s10, s10, 122880
    ds_read_b128 a[12:15], v35 offset:30720
    s_lshl_b32 s60, s60, 6
    v_mfma_f32_16x16x32_bf16 v[96:99], a[176:179], a[124:127], v[96:99]
    s_add_u32 s10, s10, s60
    s_waitcnt vmcnt(6)
    buffer_load_dwordx4 v2, s[12:15], s57 offen nt lds
    v_mfma_f32_16x16x32_bf16 v[104:107], a[176:179], a[128:131], v[104:107]
    s_lshr_b32 s59, s59, 2
    ds_read_b128 a[176:179], v11 offset:55552
    s_mul_i32 s60, s58, 40960
    s_waitcnt lgkmcnt(4)
    v_mfma_f32_16x16x32_bf16 v[88:91], a[180:183], a[132:135], v[88:91]
    s_lshl_b32 s59, s59, 7
    ds_read_b128 a[16:19], v35 offset:31744
    s_add_u32 s10, s10, s60
    v_mfma_f32_16x16x32_bf16 v[96:99], a[180:183], a[136:139], v[96:99]
    s_add_u32 s59, s59, s44
    s_waitcnt vmcnt(6)
    buffer_load_dwordx4 v3, s[12:15], s57 offen offset:1024 nt lds
    v_mfma_f32_16x16x32_bf16 v[104:107], a[180:183], a[140:143], v[104:107]
    s_add_u32 s58, s64, 16
    ds_read_b128 a[180:183], v12 offset:55552
    s_add_u32 s9, s9, 1966080
    v_mfma_f32_16x16x32_bf16 v[92:95], a[160:163], a[72:75], 0
    ds_read_b128 a[20:23], v35 offset:32768
    v_max3_f32 v36, v36, v88, v89
    v_mfma_f32_16x16x32_bf16 v[100:103], a[160:163], a[76:79], 0
    s_waitcnt vmcnt(6)
    buffer_load_dwordx4 v4, s[12:15], s57 offen offset:2048 nt lds
    v_mfma_f32_16x16x32_bf16 v[108:111], a[160:163], a[80:83], 0
    s_mov_b32 s57, 3244032
    ds_read_b128 a[24:27], v35 offset:36864
    v_max3_f32 v37, v37, v96, v97
    v_mfma_f32_16x16x32_bf16 v[92:95], a[164:167], a[84:87], v[92:95]
    s_add_u32 m0, s51, 49152
    ds_read_b128 a[28:31], v35 offset:37888
    v_max3_f32 v38, v38, v104, v105
    v_mfma_f32_16x16x32_bf16 v[100:103], a[164:167], a[88:91], v[100:103]
    ds_read_b128 a[32:35], v35 offset:38912
    v_max3_f32 v36, v36, v90, v91
    v_mfma_f32_16x16x32_bf16 v[108:111], a[164:167], a[92:95], v[108:111]
    ds_read_b128 a[36:39], v35 offset:43008
    v_max3_f32 v37, v37, v98, v99
    v_mfma_f32_16x16x32_bf16 v[92:95], a[168:171], a[96:99], v[92:95]
    ds_read_b128 a[40:43], v35 offset:44032
    v_max3_f32 v38, v38, v106, v107
    v_mfma_f32_16x16x32_bf16 v[100:103], a[168:171], a[100:103], v[100:103]
    ds_read_b128 a[44:47], v35 offset:45056
    v_mul_u32_u24 v63, 410, v34
    v_mfma_f32_16x16x32_bf16 v[108:111], a[168:171], a[104:107], v[108:111]
    s_waitcnt lgkmcnt(6)
    ds_read_b128 a[48:51], v35 offset:49152
    v_lshrrev_b32 v63, 12, v63
    v_mfma_f32_16x16x32_bf16 v[92:95], a[172:175], a[108:111], v[92:95]
    ds_read_b128 a[52:55], v35 offset:50176
    v_mul_u32_u24 v62, 0, v63
    v_mfma_f32_16x16x32_bf16 v[100:103], a[172:175], a[112:115], v[100:103]
    ds_read_b128 a[56:59], v35 offset:51200
    v_lshl_add_u32 v62, v34, 7, v62
    v_mfma_f32_16x16x32_bf16 v[108:111], a[172:175], a[116:119], v[108:111]
    ds_read_b128 a[60:63], v35 offset:55296
    v_bfrev_b32 v63, 1
    v_mfma_f32_16x16x32_bf16 v[92:95], a[176:179], a[120:123], v[92:95]
    ds_read_b128 a[64:67], v35 offset:56320
    s_sub_u32 s60, s59, 1280
    s_cselect_b32 s59, s59, s60
    v_mfma_f32_16x16x32_bf16 v[100:103], a[176:179], a[124:127], v[100:103]
    s_add_u32 s10, s10, s59
    ds_read_b128 a[68:71], v35 offset:57344
    s_mul_i32 s59, s58, 171
    v_mfma_f32_16x16x32_bf16 v[108:111], a[176:179], a[128:131], v[108:111]
    s_lshr_b32 s59, s59, 9
    s_mul_i32 s59, s59, 9
    s_add_u32 s58, s58, s59
    v_mfma_f32_16x16x32_bf16 v[92:95], a[180:183], a[132:135], v[92:95]
    s_mul_i32 s59, s48, 3
    s_add_u32 s58, s58, s59
    s_mul_i32 s59, s58, 171
    v_mfma_f32_16x16x32_bf16 v[100:103], a[180:183], a[136:139], v[100:103]
    s_lshr_b32 s59, s59, 9
    s_mul_i32 s20, s58, 1024
    s_mul_i32 s60, s59, 3
    v_mfma_f32_16x16x32_bf16 v[108:111], a[180:183], a[140:143], v[108:111]
    s_sub_u32 s58, s58, s60
    s_and_b32 s60, s59, 3
    s_lshl_b32 s21, s60, 6
    v_max3_f32 v36, v36, v92, v93
    v_max3_f32 v36, v36, v94, v95
    s_lshr_b32 s22, s60, 1
    s_and_b32 s60, s60, 1
    v_max3_f32 v37, v37, v100, v101
    s_waitcnt vmcnt(6) lgkmcnt(0)
    s_barrier
    ds_read_b128 a[160:163], v11 offset:0
    buffer_load_dwordx4 v2, s[12:15], s57 offen nt lds
    ds_read_b128 a[164:167], v12 offset:0
    v_max3_f32 v38, v38, v108, v109
    v_max3_f32 v37, v37, v102, v103
    ds_read_b128 a[168:171], v11 offset:128
    v_max3_f32 v38, v38, v110, v111
    ds_read_b128 a[172:175], v12 offset:128
    buffer_load_dwordx4 v[56:59], off, s[40:43], 0 sc1
    ds_read_b128 a[176:179], v11 offset:256
    s_mul_i32 s22, s22, 122880
    s_lshl_b32 s60, s60, 6
    ds_read_b128 a[180:183], v12 offset:256
    s_waitcnt vmcnt(6)
    buffer_load_dwordx4 v3, s[12:15], s57 offen offset:1024 nt lds
    s_add_u32 s22, s22, s60
    ds_read_b64_tr_b16 a[184:185], v23 offset:24576
    s_waitcnt lgkmcnt(6)
    v_mfma_f32_16x16x32_bf16 v[112:115], a[160:163], a[72:75], 0
    s_lshr_b32 s59, s59, 2
    ds_read_b64_tr_b16 a[186:187], v23 offset:26624
    ds_read_b64_tr_b16 a[188:189], v24 offset:24576
    v_mfma_f32_16x16x32_bf16 v[120:123], a[160:163], a[76:79], 0
    s_mul_i32 s60, s58, 40960
    ds_read_b64_tr_b16 a[190:191], v24 offset:26624
    ds_read_b64_tr_b16 a[192:193], v23 offset:28672
    v_mfma_f32_16x16x32_bf16 v[128:131], a[160:163], a[80:83], 0
    s_lshl_b32 s59, s59, 7
    ds_read_b128 a[160:163], v11 offset:6144
    s_add_u32 s22, s22, s60
    s_waitcnt lgkmcnt(8)
    v_mfma_f32_16x16x32_bf16 v[112:115], a[164:167], a[84:87], v[112:115]
    s_add_u32 s59, s59, s44
    s_waitcnt vmcnt(6)
    buffer_load_dwordx4 v4, s[12:15], s57 offen offset:2048 nt lds
    v_mfma_f32_16x16x32_bf16 v[120:123], a[164:167], a[88:91], v[120:123]
    s_mov_b32 s57, 3256320
    s_add_u32 m0, s51, 61440
    ds_read_b64_tr_b16 a[194:195], v23 offset:30720
    v_mfma_f32_16x16x32_bf16 v[128:131], a[164:167], a[92:95], v[128:131]
    s_add_u32 s21, s21, 1966336
    ds_read_b128 a[164:167], v12 offset:6144
    s_lshl_b32 s58, s55, 2
    v_mfma_f32_16x16x32_bf16 v[112:115], a[168:171], a[96:99], v[112:115]
    s_add_u32 s58, s58, s48
    ds_read_b64_tr_b16 a[196:197], v24 offset:28672
    ds_read_b64_tr_b16 a[198:199], v24 offset:30720
    v_mfma_f32_16x16x32_bf16 v[120:123], a[168:171], a[100:103], v[120:123]
    s_mul_i32 s58, s58, 7680
    ds_read_b64_tr_b16 a[200:201], v23 offset:32768
    ds_read_b64_tr_b16 a[202:203], v23 offset:34816
    v_mfma_f32_16x16x32_bf16 v[128:131], a[168:171], a[104:107], v[128:131]
    s_add_u32 s66, s58, 3932160
    s_waitcnt vmcnt(6)
    buffer_load_dwordx4 v2, s[12:15], s57 offen nt lds
    v_mfma_f32_16x16x32_bf16 v[112:115], a[172:175], a[108:111], v[112:115]
    ds_read_b128 a[168:171], v11 offset:6272
    s_sub_u32 s60, s59, 1280
    s_cselect_b32 s59, s59, s60
    v_mfma_f32_16x16x32_bf16 v[120:123], a[172:175], a[112:115], v[120:123]
    s_add_u32 s22, s22, s59
    ds_read_b64_tr_b16 a[204:205], v24 offset:32768
    ds_read_b64_tr_b16 a[206:207], v24 offset:34816
    v_mfma_f32_16x16x32_bf16 v[128:131], a[172:175], a[116:119], v[128:131]
    s_waitcnt lgkmcnt(7)
    ds_read_b128 a[172:175], v12 offset:6272
    s_cmp_ge_u32 s20, 122880
    s_cselect_b32 s21, s9, s21
    s_cselect_b32 s22, 0x40000000, s22
    s_cselect_b32 s20, s8, s20
    s_cselect_b32 s23, 0x40000000, 0
    v_mfma_f32_16x16x32_bf16 v[112:115], a[176:179], a[120:123], v[112:115]
    s_mov_b32 s9, 1966080
    s_waitcnt vmcnt(6)
    buffer_load_dwordx4 v3, s[12:15], s57 offen offset:1024 nt lds
    v_mfma_f32_16x16x32_bf16 v[120:123], a[176:179], a[124:127], v[120:123]
    s_mov_b32 s21, 1966336
    s_cmp_eq_u32 s48, 0
    s_cselect_b32 s58, 0, 0x40000000
    s_cselect_b32 s11, 1, 0
    v_mfma_f32_16x16x32_bf16 v[128:131], a[176:179], a[128:131], v[128:131]
    ds_read_b128 a[176:179], v11 offset:6400
    v_add_u32 v30, s58, v30
    v_mfma_f32_16x16x32_bf16 v[112:115], a[180:183], a[132:135], v[112:115]
    v_mfma_f32_16x16x32_bf16 v[120:123], a[180:183], a[136:139], v[120:123]
    s_waitcnt vmcnt(6)
    buffer_load_dwordx4 v4, s[12:15], s57 offen offset:2048 nt lds
    v_mfma_f32_16x16x32_bf16 v[128:131], a[180:183], a[140:143], v[128:131]
    s_add_u32 m0, s51, 98304
    s_sub_u32 s57, s45, 1280
    s_cselect_b32 s45, s45, s57
    v_mfma_f32_16x16x32_bf16 v[116:119], a[160:163], a[72:75], 0
    s_add_u32 s57, s45, 0
    ds_read_b128 a[180:183], v12 offset:6400
    v_max3_f32 v36, v36, v112, v113
    v_mfma_f32_16x16x32_bf16 v[124:127], a[160:163], a[76:79], 0
    s_add_u32 s45, s44, 896
    v_max3_f32 v37, v37, v120, v121
    v_max3_f32 v36, v36, v114, v115
    v_mfma_f32_16x16x32_bf16 v[132:135], a[160:163], a[80:83], 0
    v_max3_f32 v38, v38, v128, v129
    v_max3_f32 v37, v37, v122, v123
    v_mfma_f32_16x16x32_bf16 v[116:119], a[164:167], a[84:87], v[116:119]
    s_waitcnt vmcnt(6)
    buffer_load_dwordx4 v8, s[24:27], s57 offen lds
    v_mfma_f32_16x16x32_bf16 v[124:127], a[164:167], a[88:91], v[124:127]
    v_max3_f32 v38, v38, v130, v131
    v_mfma_f32_16x16x32_bf16 v[132:135], a[164:167], a[92:95], v[132:135]
    s_waitcnt lgkmcnt(1)
    v_mfma_f32_16x16x32_bf16 v[116:119], a[168:171], a[96:99], v[116:119]
    v_mfma_f32_16x16x32_bf16 v[124:127], a[168:171], a[100:103], v[124:127]
    v_mfma_f32_16x16x32_bf16 v[132:135], a[168:171], a[104:107], v[132:135]
    s_waitcnt vmcnt(6)
    buffer_load_dwordx4 v9, s[24:27], s57 offen offset:1024 lds
    v_mfma_f32_16x16x32_bf16 v[116:119], a[172:175], a[108:111], v[116:119]
    v_mfma_f32_16x16x32_bf16 v[124:127], a[172:175], a[112:115], v[124:127]
    v_mfma_f32_16x16x32_bf16 v[132:135], a[172:175], a[116:119], v[132:135]
    v_mfma_f32_16x16x32_bf16 v[116:119], a[176:179], a[120:123], v[116:119]
    v_mfma_f32_16x16x32_bf16 v[124:127], a[176:179], a[124:127], v[124:127]
    s_waitcnt vmcnt(6)
    buffer_load_dwordx4 v10, s[24:27], s57 offen offset:2048 lds
    v_mfma_f32_16x16x32_bf16 v[132:135], a[176:179], a[128:131], v[132:135]
    s_add_u32 m0, s51, 110592
    s_waitcnt lgkmcnt(0)
    s_barrier
    v_mfma_f32_16x16x32_bf16 v[116:119], a[180:183], a[132:135], v[116:119]
    ds_read_b128 a[160:163], v11 offset:24576
    s_sub_u32 s57, s45, 1280
    s_cselect_b32 s45, s45, s57
    v_mfma_f32_16x16x32_bf16 v[124:127], a[180:183], a[136:139], v[124:127]
    s_add_u32 s57, s45, 122880
    ds_read_b128 a[164:167], v12 offset:24576
    s_add_u32 s45, s44, 640
    v_mfma_f32_16x16x32_bf16 v[132:135], a[180:183], a[140:143], v[132:135]
    ds_read_b128 a[168:171], v11 offset:24704
    v_max3_f32 v36, v36, v116, v117
    v_mfma_f32_16x16x32_bf16 v[208:211], a[184:187], a[0:3], 0
    ds_read_b128 a[172:175], v12 offset:24704
    v_max3_f32 v36, v36, v118, v119
    v_mfma_f32_16x16x32_bf16 v[216:219], a[184:187], a[4:7], 0
    ds_read_b128 a[176:179], v11 offset:24832
    v_max3_f32 v37, v37, v124, v125
    v_mfma_f32_16x16x32_bf16 v[224:227], a[184:187], a[8:11], 0
    ds_read_b128 a[180:183], v12 offset:24832
    v_max3_f32 v38, v38, v132, v133
    v_mfma_f32_16x16x32_bf16 v[212:215], a[188:191], a[0:3], 0
    s_waitcnt vmcnt(6)
    buffer_load_dwordx4 v8, s[24:27], s57 offen lds
    v_mfma_f32_16x16x32_bf16 v[220:223], a[188:191], a[4:7], 0
    v_max3_f32 v37, v37, v126, v127
    v_max3_f32 v38, v38, v134, v135
    v_mfma_f32_16x16x32_bf16 v[228:231], a[188:191], a[8:11], 0
    ds_read_b64_tr_b16 a[184:185], v23 offset:36864
    ds_read_b64_tr_b16 a[186:187], v23 offset:38912
    v_mfma_f32_16x16x32_bf16 v[208:211], a[192:195], a[12:15], v[208:211]
    ds_read_b64_tr_b16 a[188:189], v24 offset:36864
    ds_read_b64_tr_b16 a[190:191], v24 offset:38912
    v_mfma_f32_16x16x32_bf16 v[216:219], a[192:195], a[16:19], v[216:219]
    v_mfma_f32_16x16x32_bf16 v[224:227], a[192:195], a[20:23], v[224:227]
    s_waitcnt vmcnt(6)
    buffer_load_dwordx4 v9, s[24:27], s57 offen offset:1024 lds
    v_mfma_f32_16x16x32_bf16 v[212:215], a[196:199], a[12:15], v[212:215]
    ds_read_b64_tr_b16 a[192:193], v23 offset:40960
    ds_read_b64_tr_b16 a[194:195], v23 offset:43008
    v_mfma_f32_16x16x32_bf16 v[220:223], a[196:199], a[16:19], v[220:223]
    v_mfma_f32_16x16x32_bf16 v[228:231], a[196:199], a[20:23], v[228:231]
    ds_read_b64_tr_b16 a[196:197], v24 offset:40960
    ds_read_b64_tr_b16 a[198:199], v24 offset:43008
    v_mfma_f32_16x16x32_bf16 v[208:211], a[200:203], a[24:27], v[208:211]
    v_mfma_f32_16x16x32_bf16 v[216:219], a[200:203], a[28:31], v[216:219]
    s_waitcnt vmcnt(6)
    buffer_load_dwordx4 v10, s[24:27], s57 offen offset:2048 lds
    v_mfma_f32_16x16x32_bf16 v[224:227], a[200:203], a[32:35], v[224:227]
    s_mov_b32 s57, 3268608
    s_add_u32 m0, s51, 0
    ds_read_b64_tr_b16 a[200:201], v23 offset:45056
    v_mfma_f32_16x16x32_bf16 v[212:215], a[204:207], a[24:27], v[212:215]
    ds_read_b64_tr_b16 a[202:203], v23 offset:47104
    v_mfma_f32_16x16x32_bf16 v[220:223], a[204:207], a[28:31], v[220:223]
    v_mfma_f32_16x16x32_bf16 v[228:231], a[204:207], a[32:35], v[228:231]
    s_waitcnt lgkmcnt(4)
    ds_read_b64_tr_b16 a[204:205], v24 offset:45056
    ds_read_b64_tr_b16 a[206:207], v24 offset:47104
    v_mfma_f32_16x16x32_bf16 v[136:139], a[160:163], a[72:75], 0
    s_waitcnt vmcnt(6)
    buffer_load_dwordx4 v2, s[12:15], s57 offen nt lds
    v_mfma_f32_16x16x32_bf16 v[144:147], a[160:163], a[76:79], 0
    v_mfma_f32_16x16x32_bf16 v[152:155], a[160:163], a[80:83], 0
    ds_read_b128 a[160:163], v11 offset:30720
    v_mfma_f32_16x16x32_bf16 v[136:139], a[164:167], a[84:87], v[136:139]
    v_mfma_f32_16x16x32_bf16 v[144:147], a[164:167], a[88:91], v[144:147]
    v_mfma_f32_16x16x32_bf16 v[152:155], a[164:167], a[92:95], v[152:155]
    s_waitcnt vmcnt(6)
    buffer_load_dwordx4 v3, s[12:15], s57 offen offset:1024 nt lds
    v_mfma_f32_16x16x32_bf16 v[136:139], a[168:171], a[96:99], v[136:139]
    ds_read_b128 a[164:167], v12 offset:30720
    v_mfma_f32_16x16x32_bf16 v[144:147], a[168:171], a[100:103], v[144:147]
    v_mfma_f32_16x16x32_bf16 v[152:155], a[168:171], a[104:107], v[152:155]
    ds_read_b128 a[168:171], v11 offset:30848
    v_mfma_f32_16x16x32_bf16 v[136:139], a[172:175], a[108:111], v[136:139]
    v_mfma_f32_16x16x32_bf16 v[144:147], a[172:175], a[112:115], v[144:147]
    s_waitcnt vmcnt(6)
    buffer_load_dwordx4 v4, s[12:15], s57 offen offset:2048 nt lds
    v_mfma_f32_16x16x32_bf16 v[152:155], a[172:175], a[116:119], v[152:155]
    s_mov_b32 s57, 3280896
    ds_read_b128 a[172:175], v12 offset:30848
    s_add_u32 m0, s51, 12288
    v_mfma_f32_16x16x32_bf16 v[136:139], a[176:179], a[120:123], v[136:139]
    v_mfma_f32_16x16x32_bf16 v[144:147], a[176:179], a[124:127], v[144:147]
    v_mfma_f32_16x16x32_bf16 v[152:155], a[176:179], a[128:131], v[152:155]
    ds_read_b128 a[176:179], v11 offset:30976
    v_mfma_f32_16x16x32_bf16 v[136:139], a[180:183], a[132:135], v[136:139]
    s_waitcnt vmcnt(6)
    buffer_load_dwordx4 v2, s[12:15], s57 offen nt lds
    v_mfma_f32_16x16x32_bf16 v[144:147], a[180:183], a[136:139], v[144:147]
    v_mfma_f32_16x16x32_bf16 v[152:155], a[180:183], a[140:143], v[152:155]
    s_waitcnt lgkmcnt(2)
    ds_read_b128 a[180:183], v12 offset:30976
    v_mfma_f32_16x16x32_bf16 v[140:143], a[160:163], a[72:75], 0
    s_nop 0
    v_max3_f32 v36, v36, v136, v137
    v_max3_f32 v36, v36, v138, v139
    v_mfma_f32_16x16x32_bf16 v[148:151], a[160:163], a[76:79], 0
    v_max3_f32 v37, v37, v144, v145
    v_max3_f32 v37, v37, v146, v147
    v_mfma_f32_16x16x32_bf16 v[156:159], a[160:163], a[80:83], 0
    s_waitcnt vmcnt(6)
    buffer_load_dwordx4 v3, s[12:15], s57 offen offset:1024 nt lds
    v_mfma_f32_16x16x32_bf16 v[140:143], a[164:167], a[84:87], v[140:143]
    v_max3_f32 v38, v38, v152, v153
    v_max3_f32 v38, v38, v154, v155
    v_mfma_f32_16x16x32_bf16 v[148:151], a[164:167], a[88:91], v[148:151]
    v_mfma_f32_16x16x32_bf16 v[156:159], a[164:167], a[92:95], v[156:159]
    v_mfma_f32_16x16x32_bf16 v[140:143], a[168:171], a[96:99], v[140:143]
    v_mfma_f32_16x16x32_bf16 v[148:151], a[168:171], a[100:103], v[148:151]
    s_waitcnt vmcnt(6)
    buffer_load_dwordx4 v4, s[12:15], s57 offen offset:2048 nt lds
    v_mfma_f32_16x16x32_bf16 v[156:159], a[168:171], a[104:107], v[156:159]
    s_mov_b32 s57, 3293184
    s_waitcnt vmcnt(6) lgkmcnt(0)
    s_barrier
    v_mfma_f32_16x16x32_bf16 v[140:143], a[172:175], a[108:111], v[140:143]
    s_add_u32 m0, s51, 24576
    ds_read_b128 a[160:163], v11 offset:49152
    v_mfma_f32_16x16x32_bf16 v[148:151], a[172:175], a[112:115], v[148:151]
    ds_read_b128 a[164:167], v12 offset:49152
    v_mfma_f32_16x16x32_bf16 v[156:159], a[172:175], a[116:119], v[156:159]
    ds_read_b128 a[168:171], v11 offset:49280
    v_mfma_f32_16x16x32_bf16 v[140:143], a[176:179], a[120:123], v[140:143]
    ds_read_b128 a[172:175], v12 offset:49280
    buffer_load_dwordx4 v2, s[12:15], s57 offen nt lds
    v_mfma_f32_16x16x32_bf16 v[148:151], a[176:179], a[124:127], v[148:151]
    v_mfma_f32_16x16x32_bf16 v[156:159], a[176:179], a[128:131], v[156:159]
    ds_read_b128 a[176:179], v11 offset:49408
    v_mfma_f32_16x16x32_bf16 v[140:143], a[180:183], a[132:135], v[140:143]
    v_mfma_f32_16x16x32_bf16 v[148:151], a[180:183], a[136:139], v[148:151]
    v_mfma_f32_16x16x32_bf16 v[156:159], a[180:183], a[140:143], v[156:159]
    ds_read_b128 a[180:183], v12 offset:49408
    s_waitcnt vmcnt(6)
    buffer_load_dwordx4 v3, s[12:15], s57 offen offset:1024 nt lds
    v_mfma_f32_16x16x32_bf16 v[208:211], a[184:187], a[36:39], v[208:211]
    s_nop 1
    v_max3_f32 v36, v36, v140, v141
    v_max3_f32 v37, v37, v148, v149
    v_mfma_f32_16x16x32_bf16 v[216:219], a[184:187], a[40:43], v[216:219]
    v_max3_f32 v36, v36, v142, v143
    v_max3_f32 v38, v38, v156, v157
    v_mfma_f32_16x16x32_bf16 v[224:227], a[184:187], a[44:47], v[224:227]
    v_max3_f32 v37, v37, v150, v151
    v_max3_f32 v38, v38, v158, v159
    v_mfma_f32_16x16x32_bf16 v[212:215], a[188:191], a[36:39], v[212:215]
    ds_read_b64_tr_b16 a[184:185], v25 offset:0
    ds_read_b64_tr_b16 a[186:187], v25 offset:2048
    v_mfma_f32_16x16x32_bf16 v[220:223], a[188:191], a[40:43], v[220:223]
    s_waitcnt vmcnt(6)
    buffer_load_dwordx4 v4, s[12:15], s57 offen offset:2048 nt lds
    v_mfma_f32_16x16x32_bf16 v[228:231], a[188:191], a[44:47], v[228:231]
    s_mov_b32 s57, 3305472
    s_add_u32 m0, s51, 36864
    ds_read_b64_tr_b16 a[188:189], v26 offset:0
    v_mfma_f32_16x16x32_bf16 v[208:211], a[192:195], a[48:51], v[208:211]
    ds_read_b64_tr_b16 a[190:191], v26 offset:2048
    v_mfma_f32_16x16x32_bf16 v[216:219], a[192:195], a[52:55], v[216:219]
    v_mfma_f32_16x16x32_bf16 v[224:227], a[192:195], a[56:59], v[224:227]
    ds_read_b64_tr_b16 a[192:193], v25 offset:4096
    ds_read_b64_tr_b16 a[194:195], v25 offset:6144
    v_mfma_f32_16x16x32_bf16 v[212:215], a[196:199], a[48:51], v[212:215]
    s_waitcnt vmcnt(6)
    buffer_load_dwordx4 v2, s[12:15], s57 offen nt lds
    v_mfma_f32_16x16x32_bf16 v[220:223], a[196:199], a[52:55], v[220:223]
    v_mfma_f32_16x16x32_bf16 v[228:231], a[196:199], a[56:59], v[228:231]
    ds_read_b64_tr_b16 a[196:197], v26 offset:4096
    ds_read_b64_tr_b16 a[198:199], v26 offset:6144
    v_mfma_f32_16x16x32_bf16 v[208:211], a[200:203], a[60:63], v[208:211]
    v_mfma_f32_16x16x32_bf16 v[216:219], a[200:203], a[64:67], v[216:219]
    v_mfma_f32_16x16x32_bf16 v[224:227], a[200:203], a[68:71], v[224:227]
    s_waitcnt vmcnt(6)
    buffer_load_dwordx4 v3, s[12:15], s57 offen offset:1024 nt lds
    v_mfma_f32_16x16x32_bf16 v[212:215], a[204:207], a[60:63], v[212:215]
    s_nop 2
    v_cvt_pk_bf16_f32 v208, v208, v209
    v_cvt_pk_bf16_f32 v209, v210, v211
    v_mfma_f32_16x16x32_bf16 v[220:223], a[204:207], a[64:67], v[220:223]
    v_cvt_pk_bf16_f32 v216, v216, v217
    v_cvt_pk_bf16_f32 v217, v218, v219
    v_mfma_f32_16x16x32_bf16 v[228:231], a[204:207], a[68:71], v[228:231]
    s_waitcnt lgkmcnt(2)
    v_cvt_pk_bf16_f32 v224, v224, v225
    v_cvt_pk_bf16_f32 v225, v226, v227
    v_mfma_f32_16x16x32_bf16 v[160:163], a[160:163], a[72:75], 0
    v_cvt_pk_bf16_f32 v210, v212, v213
    v_cvt_pk_bf16_f32 v211, v214, v215
    v_mfma_f32_16x16x32_bf16 v[168:171], a[160:163], a[76:79], 0
    s_waitcnt vmcnt(6)
    buffer_load_dwordx4 v4, s[12:15], s57 offen offset:2048 nt lds
    v_mfma_f32_16x16x32_bf16 v[176:179], a[160:163], a[80:83], 0
    s_add_u32 m0, s51, 73728
    ds_read_b128 a[160:163], v11 offset:55296
    v_cvt_pk_bf16_f32 v218, v220, v221
    v_mfma_f32_16x16x32_bf16 v[160:163], a[164:167], a[84:87], v[160:163]
    s_sub_u32 s57, s45, 1280
    s_cselect_b32 s45, s45, s57
    s_add_u32 s57, s45, 0
    v_mfma_f32_16x16x32_bf16 v[168:171], a[164:167], a[88:91], v[168:171]
    s_add_u32 s45, s44, 640
    v_cvt_pk_bf16_f32 v219, v222, v223
    v_cvt_pk_bf16_f32 v226, v228, v229
    v_mfma_f32_16x16x32_bf16 v[176:179], a[164:167], a[92:95], v[176:179]
    ds_read_b128 a[164:167], v12 offset:55296
    v_cvt_pk_bf16_f32 v227, v230, v231
    v_mfma_f32_16x16x32_bf16 v[160:163], a[168:171], a[96:99], v[160:163]
    s_waitcnt vmcnt(6)
    buffer_load_dwordx4 v8, s[24:27], s57 offen lds
    v_mfma_f32_16x16x32_bf16 v[168:171], a[168:171], a[100:103], v[168:171]
    v_accvgpr_write_b32 a208, v208
    v_accvgpr_write_b32 a209, v209
    v_mfma_f32_16x16x32_bf16 v[176:179], a[168:171], a[104:107], v[176:179]
    ds_read_b128 a[168:171], v11 offset:55424
    v_accvgpr_write_b32 a210, v210
    v_mfma_f32_16x16x32_bf16 v[160:163], a[172:175], a[108:111], v[160:163]
    v_accvgpr_write_b32 a211, v211
    v_accvgpr_write_b32 a212, v216
    v_mfma_f32_16x16x32_bf16 v[168:171], a[172:175], a[112:115], v[168:171]
    v_accvgpr_write_b32 a213, v217
    v_accvgpr_write_b32 a214, v218
    v_mfma_f32_16x16x32_bf16 v[176:179], a[172:175], a[116:119], v[176:179]
    s_waitcnt vmcnt(6)
    buffer_load_dwordx4 v9, s[24:27], s57 offen offset:1024 lds
    v_mfma_f32_16x16x32_bf16 v[160:163], a[176:179], a[120:123], v[160:163]
    ds_read_b128 a[172:175], v12 offset:55424
    v_accvgpr_write_b32 a215, v219
    v_mfma_f32_16x16x32_bf16 v[168:171], a[176:179], a[124:127], v[168:171]
    v_accvgpr_write_b32 a216, v224
    v_accvgpr_write_b32 a217, v225
    v_mfma_f32_16x16x32_bf16 v[176:179], a[176:179], a[128:131], v[176:179]
    ds_read_b128 a[176:179], v11 offset:55552
    v_accvgpr_write_b32 a218, v226
    v_mfma_f32_16x16x32_bf16 v[160:163], a[180:183], a[132:135], v[160:163]
    v_accvgpr_write_b32 a219, v227
    v_mfma_f32_16x16x32_bf16 v[168:171], a[180:183], a[136:139], v[168:171]
    s_waitcnt vmcnt(6)
    buffer_load_dwordx4 v10, s[24:27], s57 offen offset:2048 lds
    v_mfma_f32_16x16x32_bf16 v[176:179], a[180:183], a[140:143], v[176:179]
    s_add_u32 m0, s51, 86016
    ds_read_b128 a[180:183], v12 offset:55552
    s_sub_u32 s57, s45, 1280
    s_cselect_b32 s45, s45, s57
    s_waitcnt lgkmcnt(2)
    v_mfma_f32_16x16x32_bf16 v[164:167], a[160:163], a[72:75], 0
    s_add_u32 s57, s45, 122880
    ds_read_b64_tr_b16 a[200:201], v25 offset:8192
    ds_read_b64_tr_b16 a[202:203], v25 offset:10240
    v_mfma_f32_16x16x32_bf16 v[172:175], a[160:163], a[76:79], 0
    s_add_u32 s45, s44, 0
    ds_read_b64_tr_b16 a[204:205], v26 offset:8192
    ds_read_b64_tr_b16 a[206:207], v26 offset:10240
    v_mfma_f32_16x16x32_bf16 v[180:183], a[160:163], a[80:83], 0
    v_max3_f32 v36, v36, v160, v161
    v_max3_f32 v37, v37, v168, v169
    v_mfma_f32_16x16x32_bf16 v[164:167], a[164:167], a[84:87], v[164:167]
    v_max3_f32 v38, v38, v176, v177
    v_max3_f32 v36, v36, v162, v163
    v_mfma_f32_16x16x32_bf16 v[172:175], a[164:167], a[88:91], v[172:175]
    v_max3_f32 v37, v37, v170, v171
    v_max3_f32 v38, v38, v178, v179
    v_mfma_f32_16x16x32_bf16 v[180:183], a[164:167], a[92:95], v[180:183]
    s_waitcnt lgkmcnt(4)
    s_barrier
    ds_read_b128 a[160:163], v11 offset:0
    v_mfma_f32_16x16x32_bf16 v[164:167], a[168:171], a[96:99], v[164:167]
    ds_read_b128 a[164:167], v12 offset:0
    s_waitcnt vmcnt(6)
    buffer_load_dwordx4 v8, s[24:27], s57 offen lds
    v_mfma_f32_16x16x32_bf16 v[172:175], a[168:171], a[100:103], v[172:175]
    v_and_b32 v56, v56, v57
    v_and_b32 v58, v58, v59
    v_and_b32 v56, v56, v58
    s_nop 0
    v_readfirstlane_b32 s47, v56
    s_nop 0
    s_cmp_eq_u32 s47, 0x1
    s_cbranch_scc0 LB_slow0
LB_back0:
    v_mfma_f32_16x16x32_bf16 v[180:183], a[168:171], a[104:107], v[180:183]
    ds_read_b128 a[168:171], v11 offset:128
    v_mov_b32 v56, 0x3f80
    v_mfma_f32_16x16x32_bf16 v[164:167], a[172:175], a[108:111], v[164:167]
    s_waitcnt vmcnt(6)
    buffer_load_dwordx4 v9, s[24:27], s57 offen offset:1024 lds
    v_mfma_f32_16x16x32_bf16 v[172:175], a[172:175], a[112:115], v[172:175]
    v_lshlrev_b32 v50, v50, v56
    v_lshrrev_b32 v56, 1, v48
    v_mfma_f32_16x16x32_bf16 v[180:183], a[172:175], a[116:119], v[180:183]
    ds_read_b128 a[172:175], v12 offset:128
    v_lshlrev_b32 v57, 1, v49
    v_mfma_f32_16x16x32_bf16 v[164:167], a[176:179], a[120:123], v[164:167]
    v_cmp_eq_u32 vcc, v56, v57
    s_nop 1
    v_cndmask_b32 v58, 0, v50, vcc
    v_mfma_f32_16x16x32_bf16 v[172:175], a[176:179], a[124:127], v[172:175]
    v_add_u32 v57, 1, v57
    v_cmp_eq_u32 vcc, v56, v57
    v_mfma_f32_16x16x32_bf16 v[180:183], a[176:179], a[128:131], v[180:183]
    ds_read_b128 a[176:179], v11 offset:256
    v_cndmask_b32 v59, 0, v50, vcc
    v_mfma_f32_16x16x32_bf16 v[164:167], a[180:183], a[132:135], v[164:167]
    s_waitcnt vmcnt(6)
    buffer_load_dwordx4 v10, s[24:27], s57 offen offset:2048 lds
    v_mfma_f32_16x16x32_bf16 v[172:175], a[180:183], a[136:139], v[172:175]
    s_mov_b32 s57, 3317760
    s_add_u32 m0, s51, 49152
    v_and_b32 v50, 1, v49
    v_mfma_f32_16x16x32_bf16 v[180:183], a[180:183], a[140:143], v[180:183]
    ds_read_b128 a[180:183], v12 offset:256
    v_lshl_add_u32 v29, v50, 5, v29
    v_mfma_f32_16x16x32_bf16 v[232:235], a[184:187], a[0:3], 0
    v_max3_f32 v36, v36, v164, v165
    v_max3_f32 v36, v36, v166, v167
    v_mfma_f32_16x16x32_bf16 v[240:243], a[184:187], a[4:7], 0
    v_max3_f32 v37, v37, v172, v173
    v_max3_f32 v37, v37, v174, v175
    v_mfma_f32_16x16x32_bf16 v[248:251], a[184:187], a[8:11], 0
    s_waitcnt vmcnt(6)
    buffer_load_dwordx4 v2, s[12:15], s57 offen nt lds
    v_mfma_f32_16x16x32_bf16 v[236:239], a[188:191], a[0:3], 0
    v_max3_f32 v38, v38, v180, v181
    v_max3_f32 v38, v38, v182, v183
    v_mfma_f32_16x16x32_bf16 v[244:247], a[188:191], a[4:7], 0
    ds_read_b64_tr_b16 a[184:185], v25 offset:12288
    ds_read_b64_tr_b16 a[186:187], v25 offset:14336
    v_mfma_f32_16x16x32_bf16 v[252:255], a[188:191], a[8:11], 0
    ds_read_b64_tr_b16 a[188:189], v26 offset:12288
    ds_read_b64_tr_b16 a[190:191], v26 offset:14336
    v_mfma_f32_16x16x32_bf16 v[232:235], a[192:195], a[12:15], v[232:235]
    v_lshrrev_b32 v50, 1, v49
    v_lshl_add_u32 v29, v50, 4, v29
    v_mfma_f32_16x16x32_bf16 v[240:243], a[192:195], a[16:19], v[240:243]
    s_waitcnt vmcnt(6)
    buffer_load_dwordx4 v3, s[12:15], s57 offen offset:1024 nt lds
    v_mfma_f32_16x16x32_bf16 v[248:251], a[192:195], a[20:23], v[248:251]
    ds_read_b64_tr_b16 a[192:193], v25 offset:16384
    ds_read_b64_tr_b16 a[194:195], v25 offset:18432
    v_mfma_f32_16x16x32_bf16 v[236:239], a[196:199], a[12:15], v[236:239]
    v_add_u32 v0, s22, v29
    v_mov_b32 v56, 0
    v_mfma_f32_16x16x32_bf16 v[244:247], a[196:199], a[16:19], v[244:247]
    v_mov_b32 v57, 0
    v_add_u32 v29, s10, v29
    v_mfma_f32_16x16x32_bf16 v[252:255], a[196:199], a[20:23], v[252:255]
    s_waitcnt lgkmcnt(4)
    ds_read_b64_tr_b16 a[196:197], v26 offset:16384
    ds_read_b64_tr_b16 a[198:199], v26 offset:18432
    v_mfma_f32_16x16x32_bf16 v[232:235], a[200:203], a[24:27], v[232:235]
    s_waitcnt vmcnt(6)
    buffer_load_dwordx4 v4, s[12:15], s57 offen offset:2048 nt lds
    v_mfma_f32_16x16x32_bf16 v[240:243], a[200:203], a[28:31], v[240:243]
    s_mov_b32 s57, 3330048
    s_add_u32 m0, s51, 61440
    v_cmp_gt_u32 vcc, 60, v34
    v_mfma_f32_16x16x32_bf16 v[248:251], a[200:203], a[32:35], v[248:251]
    ds_read_b64_tr_b16 a[200:201], v25 offset:20480
    ds_read_b64_tr_b16 a[202:203], v25 offset:22528
    v_mfma_f32_16x16x32_bf16 v[236:239], a[204:207], a[24:27], v[236:239]
    v_cndmask_b32 v62, v63, v62, vcc
    v_mov_b32 v63, 1
    v_mfma_f32_16x16x32_bf16 v[244:247], a[204:207], a[28:31], v[244:247]
    v_mfma_f32_16x16x32_bf16 v[252:255], a[204:207], a[32:35], v[252:255]
    s_waitcnt vmcnt(6)
    buffer_load_dwordx4 v2, s[12:15], s57 offen nt lds
    v_mfma_f32_16x16x32_bf16 v[184:187], a[160:163], a[72:75], 0
    ds_read_b64_tr_b16 a[204:205], v26 offset:20480
    ds_read_b64_tr_b16 a[206:207], v26 offset:22528
    v_mfma_f32_16x16x32_bf16 v[192:195], a[160:163], a[76:79], 0
    v_mfma_f32_16x16x32_bf16 v[200:203], a[160:163], a[80:83], 0
    ds_read_b128 a[160:163], v11 offset:6144
    v_mfma_f32_16x16x32_bf16 v[184:187], a[164:167], a[84:87], v[184:187]
    v_mfma_f32_16x16x32_bf16 v[192:195], a[164:167], a[88:91], v[192:195]
    s_waitcnt vmcnt(6)
    buffer_load_dwordx4 v3, s[12:15], s57 offen offset:1024 nt lds
    v_mfma_f32_16x16x32_bf16 v[200:203], a[164:167], a[92:95], v[200:203]
    ds_read_b128 a[164:167], v12 offset:6144
    v_mfma_f32_16x16x32_bf16 v[184:187], a[168:171], a[96:99], v[184:187]
    v_mfma_f32_16x16x32_bf16 v[192:195], a[168:171], a[100:103], v[192:195]
    v_mfma_f32_16x16x32_bf16 v[200:203], a[168:171], a[104:107], v[200:203]
    ds_read_b128 a[168:171], v11 offset:6272
    v_mfma_f32_16x16x32_bf16 v[184:187], a[172:175], a[108:111], v[184:187]
    s_waitcnt vmcnt(6)
    buffer_load_dwordx4 v4, s[12:15], s57 offen offset:2048 nt lds
    v_mfma_f32_16x16x32_bf16 v[192:195], a[172:175], a[112:115], v[192:195]
    s_mov_b32 s57, 3145728
    s_add_u32 m0, s51, 0
    v_mfma_f32_16x16x32_bf16 v[200:203], a[172:175], a[116:119], v[200:203]
    ds_read_b128 a[172:175], v12 offset:6272
    v_mfma_f32_16x16x32_bf16 v[184:187], a[176:179], a[120:123], v[184:187]
    v_mfma_f32_16x16x32_bf16 v[192:195], a[176:179], a[124:127], v[192:195]
    v_mfma_f32_16x16x32_bf16 v[200:203], a[176:179], a[128:131], v[200:203]
    ds_read_b128 a[176:179], v11 offset:6400
    v_mfma_f32_16x16x32_bf16 v[184:187], a[180:183], a[132:135], v[184:187]
    v_mfma_f32_16x16x32_bf16 v[192:195], a[180:183], a[136:139], v[192:195]
    v_mfma_f32_16x16x32_bf16 v[200:203], a[180:183], a[140:143], v[200:203]
    s_waitcnt lgkmcnt(2)
    ds_read_b128 a[180:183], v12 offset:6400
    v_mfma_f32_16x16x32_bf16 v[188:191], a[160:163], a[72:75], 0
    s_nop 2
    v_max3_f32 v36, v36, v184, v185
    v_max3_f32 v36, v36, v186, v187
    v_mfma_f32_16x16x32_bf16 v[196:199], a[160:163], a[76:79], 0
    v_max3_f32 v37, v37, v192, v193
    v_max3_f32 v37, v37, v194, v195
    v_mfma_f32_16x16x32_bf16 v[204:207], a[160:163], a[80:83], 0
    v_max3_f32 v38, v38, v200, v201
    v_max3_f32 v38, v38, v202, v203
    v_mfma_f32_16x16x32_bf16 v[188:191], a[164:167], a[84:87], v[188:191]
    v_mfma_f32_16x16x32_bf16 v[196:199], a[164:167], a[88:91], v[196:199]
    v_mfma_f32_16x16x32_bf16 v[204:207], a[164:167], a[92:95], v[204:207]
    s_waitcnt vmcnt(6) lgkmcnt(0)
    s_barrier
    ds_read_b128 a[160:163], v11 offset:24576
    v_mfma_f32_16x16x32_bf16 v[188:191], a[168:171], a[96:99], v[188:191]
    ds_read_b128 a[164:167], v12 offset:24576
    buffer_load_dwordx4 v2, s[16:19], s57 offen nt lds
    v_mfma_f32_16x16x32_bf16 v[196:199], a[168:171], a[100:103], v[196:199]
    v_mfma_f32_16x16x32_bf16 v[204:207], a[168:171], a[104:107], v[204:207]
    ds_read_b128 a[168:171], v11 offset:24704
    v_mfma_f32_16x16x32_bf16 v[188:191], a[172:175], a[108:111], v[188:191]
    v_mfma_f32_16x16x32_bf16 v[196:199], a[172:175], a[112:115], v[196:199]
    v_mfma_f32_16x16x32_bf16 v[204:207], a[172:175], a[116:119], v[204:207]
    ds_read_b128 a[172:175], v12 offset:24704
    v_mfma_f32_16x16x32_bf16 v[188:191], a[176:179], a[120:123], v[188:191]
    v_mfma_f32_16x16x32_bf16 v[196:199], a[176:179], a[124:127], v[196:199]
    s_waitcnt vmcnt(6)
    buffer_load_dwordx4 v3, s[16:19], s57 offen offset:1024 nt lds
    v_mfma_f32_16x16x32_bf16 v[204:207], a[176:179], a[128:131], v[204:207]
    ds_read_b128 a[176:179], v11 offset:24832
    v_mfma_f32_16x16x32_bf16 v[188:191], a[180:183], a[132:135], v[188:191]
    v_mfma_f32_16x16x32_bf16 v[196:199], a[180:183], a[136:139], v[196:199]
    v_mfma_f32_16x16x32_bf16 v[204:207], a[180:183], a[140:143], v[204:207]
    ds_read_b128 a[180:183], v12 offset:24832
    v_mfma_f32_16x16x32_bf16 v[232:235], a[184:187], a[36:39], v[232:235]
    s_nop 3
    v_max3_f32 v36, v36, v188, v189
    v_max3_f32 v36, v36, v190, v191
    v_mfma_f32_16x16x32_bf16 v[240:243], a[184:187], a[40:43], v[240:243]
    v_max3_f32 v37, v37, v196, v197
    v_max3_f32 v37, v37, v198, v199
    v_mfma_f32_16x16x32_bf16 v[248:251], a[184:187], a[44:47], v[248:251]
    s_waitcnt vmcnt(6)
    buffer_load_dwordx4 v4, s[16:19], s57 offen offset:2048 nt lds
    v_mfma_f32_16x16x32_bf16 v[236:239], a[188:191], a[36:39], v[236:239]
    s_mov_b32 s57, 3158016
    v_max3_f32 v38, v38, v204, v205
    v_max3_f32 v38, v38, v206, v207
    v_mfma_f32_16x16x32_bf16 v[244:247], a[188:191], a[40:43], v[244:247]
    s_add_u32 m0, s51, 12288
    ds_read_b64_tr_b16 a[184:185], v23 offset:24576
    ds_read_b64_tr_b16 a[186:187], v23 offset:26624
    v_mfma_f32_16x16x32_bf16 v[252:255], a[188:191], a[44:47], v[252:255]
    ds_read_b64_tr_b16 a[188:189], v24 offset:24576
    ds_read_b64_tr_b16 a[190:191], v24 offset:26624
    v_mfma_f32_16x16x32_bf16 v[232:235], a[192:195], a[48:51], v[232:235]
    v_mfma_f32_16x16x32_bf16 v[240:243], a[192:195], a[52:55], v[240:243]
    v_mfma_f32_16x16x32_bf16 v[248:251], a[192:195], a[56:59], v[248:251]
    ds_read_b64_tr_b16 a[192:193], v23 offset:28672
    ds_read_b64_tr_b16 a[194:195], v23 offset:30720
    v_mfma_f32_16x16x32_bf16 v[236:239], a[196:199], a[48:51], v[236:239]
    s_waitcnt vmcnt(6)
    buffer_load_dwordx4 v2, s[16:19], s57 offen nt lds
    v_mfma_f32_16x16x32_bf16 v[244:247], a[196:199], a[52:55], v[244:247]
    v_mfma_f32_16x16x32_bf16 v[252:255], a[196:199], a[56:59], v[252:255]
    ds_read_b64_tr_b16 a[196:197], v24 offset:28672
    ds_read_b64_tr_b16 a[198:199], v24 offset:30720
    v_mfma_f32_16x16x32_bf16 v[232:235], a[200:203], a[60:63], v[232:235]
    v_mfma_f32_16x16x32_bf16 v[240:243], a[200:203], a[64:67], v[240:243]
    v_mfma_f32_16x16x32_bf16 v[248:251], a[200:203], a[68:71], v[248:251]
    ds_read_b64_tr_b16 a[200:201], v23 offset:32768
    ds_read_b64_tr_b16 a[202:203], v23 offset:34816
    v_mfma_f32_16x16x32_bf16 v[236:239], a[204:207], a[60:63], v[236:239]
    s_nop 2
    v_cvt_pk_bf16_f32 v232, v232, v233
    v_cvt_pk_bf16_f32 v233, v234, v235
    v_mfma_f32_16x16x32_bf16 v[244:247], a[204:207], a[64:67], v[244:247]
    s_waitcnt vmcnt(6)
    buffer_load_dwordx4 v3, s[16:19], s57 offen offset:1024 nt lds
    v_mfma_f32_16x16x32_bf16 v[252:255], a[204:207], a[68:71], v[252:255]
    s_waitcnt lgkmcnt(4)
    v_cvt_pk_bf16_f32 v240, v240, v241
    v_cvt_pk_bf16_f32 v248, v248, v249
    v_mfma_f32_16x16x32_bf16 v[208:211], a[160:163], a[72:75], 0
    v_cvt_pk_bf16_f32 v241, v242, v243
    v_cvt_pk_bf16_f32 v249, v250, v251
    v_mfma_f32_16x16x32_bf16 v[216:219], a[160:163], a[76:79], 0
    v_cvt_pk_bf16_f32 v234, v236, v237
    v_cvt_pk_bf16_f32 v235, v238, v239
    v_mfma_f32_16x16x32_bf16 v[224:227], a[160:163], a[80:83], 0
    ds_read_b128 a[160:163], v11 offset:30720
    v_cvt_pk_bf16_f32 v242, v244, v245
    v_mfma_f32_16x16x32_bf16 v[208:211], a[164:167], a[84:87], v[208:211]
    v_cvt_pk_bf16_f32 v243, v246, v247
    v_cvt_pk_bf16_f32 v250, v252, v253
    v_mfma_f32_16x16x32_bf16 v[216:219], a[164:167], a[88:91], v[216:219]
    v_cvt_pk_bf16_f32 v251, v254, v255
    v_accvgpr_write_b32 a220, v232
    v_mfma_f32_16x16x32_bf16 v[224:227], a[164:167], a[92:95], v[224:227]
    ds_read_b128 a[164:167], v12 offset:30720
    v_accvgpr_write_b32 a221, v233
    v_mfma_f32_16x16x32_bf16 v[208:211], a[168:171], a[96:99], v[208:211]
    s_waitcnt vmcnt(6)
    buffer_load_dwordx4 v4, s[16:19], s57 offen offset:2048 nt lds
    v_mfma_f32_16x16x32_bf16 v[216:219], a[168:171], a[100:103], v[216:219]
    s_mov_b32 s57, 3170304
    v_accvgpr_write_b32 a222, v234
    v_accvgpr_write_b32 a223, v235
    v_mfma_f32_16x16x32_bf16 v[224:227], a[168:171], a[104:107], v[224:227]
    s_add_u32 m0, s51, 24576
    ds_read_b128 a[168:171], v11 offset:30848
    v_accvgpr_write_b32 a224, v240
    v_mfma_f32_16x16x32_bf16 v[208:211], a[172:175], a[108:111], v[208:211]
    v_accvgpr_write_b32 a225, v241
    v_accvgpr_write_b32 a226, v242
    v_mfma_f32_16x16x32_bf16 v[216:219], a[172:175], a[112:115], v[216:219]
    v_accvgpr_write_b32 a227, v243
    v_accvgpr_write_b32 a228, v248
    v_mfma_f32_16x16x32_bf16 v[224:227], a[172:175], a[116:119], v[224:227]
    ds_read_b128 a[172:175], v12 offset:30848
    v_accvgpr_write_b32 a229, v249
    v_mfma_f32_16x16x32_bf16 v[208:211], a[176:179], a[120:123], v[208:211]
    v_accvgpr_write_b32 a230, v250
    v_accvgpr_write_b32 a231, v251
    v_mfma_f32_16x16x32_bf16 v[216:219], a[176:179], a[124:127], v[216:219]
    ds_read_b64_tr_b16 a[204:205], v24 offset:32768
    ds_read_b64_tr_b16 a[206:207], v24 offset:34816
    v_mfma_f32_16x16x32_bf16 v[224:227], a[176:179], a[128:131], v[224:227]
    ds_read_b128 a[176:179], v11 offset:30976
    v_mfma_f32_16x16x32_bf16 v[208:211], a[180:183], a[132:135], v[208:211]
    v_mfma_f32_16x16x32_bf16 v[216:219], a[180:183], a[136:139], v[216:219]
    v_mfma_f32_16x16x32_bf16 v[224:227], a[180:183], a[140:143], v[224:227]
    s_waitcnt lgkmcnt(4)
    ds_read_b128 a[180:183], v12 offset:30976
    v_mfma_f32_16x16x32_bf16 v[212:215], a[160:163], a[72:75], 0
    s_nop 2
    v_max3_f32 v36, v36, v208, v209
    v_max3_f32 v36, v36, v210, v211
    v_mfma_f32_16x16x32_bf16 v[220:223], a[160:163], a[76:79], 0
    v_max3_f32 v37, v37, v216, v217
    v_max3_f32 v37, v37, v218, v219
    v_mfma_f32_16x16x32_bf16 v[228:231], a[160:163], a[80:83], 0
    v_max3_f32 v38, v38, v224, v225
    v_max3_f32 v38, v38, v226, v227
    v_mfma_f32_16x16x32_bf16 v[212:215], a[164:167], a[84:87], v[212:215]
    v_mfma_f32_16x16x32_bf16 v[220:223], a[164:167], a[88:91], v[220:223]
    v_mfma_f32_16x16x32_bf16 v[228:231], a[164:167], a[92:95], v[228:231]
    s_waitcnt vmcnt(6) lgkmcnt(0)
    s_barrier
    ds_read_b128 a[160:163], v11 offset:49152
    v_mfma_f32_16x16x32_bf16 v[212:215], a[168:171], a[96:99], v[212:215]
    ds_read_b128 a[164:167], v12 offset:49152
    buffer_load_dwordx4 v2, s[16:19], s57 offen nt lds
    v_mfma_f32_16x16x32_bf16 v[220:223], a[168:171], a[100:103], v[220:223]
    v_mfma_f32_16x16x32_bf16 v[228:231], a[168:171], a[104:107], v[228:231]
    ds_read_b128 a[168:171], v11 offset:49280
    v_mfma_f32_16x16x32_bf16 v[212:215], a[172:175], a[108:111], v[212:215]
    v_mfma_f32_16x16x32_bf16 v[220:223], a[172:175], a[112:115], v[220:223]
    v_mfma_f32_16x16x32_bf16 v[228:231], a[172:175], a[116:119], v[228:231]
    ds_read_b128 a[172:175], v12 offset:49280
    v_mfma_f32_16x16x32_bf16 v[212:215], a[176:179], a[120:123], v[212:215]
    s_waitcnt vmcnt(6)
    buffer_load_dwordx4 v3, s[16:19], s57 offen offset:1024 nt lds
    v_mfma_f32_16x16x32_bf16 v[220:223], a[176:179], a[124:127], v[220:223]
    v_mfma_f32_16x16x32_bf16 v[228:231], a[176:179], a[128:131], v[228:231]
    ds_read_b128 a[176:179], v11 offset:49408
    v_mfma_f32_16x16x32_bf16 v[212:215], a[180:183], a[132:135], v[212:215]
    v_mfma_f32_16x16x32_bf16 v[220:223], a[180:183], a[136:139], v[220:223]
    v_mfma_f32_16x16x32_bf16 v[228:231], a[180:183], a[140:143], v[228:231]
    ds_read_b128 a[180:183], v12 offset:49408
    v_mfma_f32_16x16x32_bf16 a[232:235], a[184:187], a[0:3], 0
    s_waitcnt vmcnt(6)
    buffer_load_dwordx4 v4, s[16:19], s57 offen offset:2048 nt lds
    v_mfma_f32_16x16x32_bf16 a[240:243], a[184:187], a[4:7], 0
    s_mov_b32 s57, 3182592
    v_max3_f32 v36, v36, v212, v213
    v_max3_f32 v37, v37, v220, v221
    v_mfma_f32_16x16x32_bf16 a[248:251], a[184:187], a[8:11], 0
    s_add_u32 m0, s51, 36864
    v_max3_f32 v38, v38, v228, v229
    v_max3_f32 v36, v36, v214, v215
    v_mfma_f32_16x16x32_bf16 a[236:239], a[188:191], a[0:3], 0
    v_max3_f32 v37, v37, v222, v223
    v_max3_f32 v38, v38, v230, v231
    v_mfma_f32_16x16x32_bf16 a[244:247], a[188:191], a[4:7], 0
    ds_read_b64_tr_b16 a[184:185], v23 offset:36864
    ds_read_b64_tr_b16 a[186:187], v23 offset:38912
    v_mfma_f32_16x16x32_bf16 a[252:255], a[188:191], a[8:11], 0
    ds_read_b64_tr_b16 a[188:189], v24 offset:36864
    ds_read_b64_tr_b16 a[190:191], v24 offset:38912
    v_mfma_f32_16x16x32_bf16 a[232:235], a[192:195], a[12:15], a[232:235]
    s_waitcnt vmcnt(6)
    buffer_load_dwordx4 v2, s[16:19], s57 offen nt lds
    v_mfma_f32_16x16x32_bf16 a[240:243], a[192:195], a[16:19], a[240:243]
    v_mfma_f32_16x16x32_bf16 a[248:251], a[192:195], a[20:23], a[248:251]
    ds_read_b64_tr_b16 a[192:193], v23 offset:40960
    ds_read_b64_tr_b16 a[194:195], v23 offset:43008
    v_mfma_f32_16x16x32_bf16 a[236:239], a[196:199], a[12:15], a[236:239]
    v_mfma_f32_16x16x32_bf16 a[244:247], a[196:199], a[16:19], a[244:247]
    v_mfma_f32_16x16x32_bf16 a[252:255], a[196:199], a[20:23], a[252:255]
    ds_read_b64_tr_b16 a[196:197], v24 offset:40960
    ds_read_b64_tr_b16 a[198:199], v24 offset:43008
    v_mfma_f32_16x16x32_bf16 a[232:235], a[200:203], a[24:27], a[232:235]
    s_waitcnt vmcnt(6)
    buffer_load_dwordx4 v3, s[16:19], s57 offen offset:1024 nt lds
    v_mfma_f32_16x16x32_bf16 a[240:243], a[200:203], a[28:31], a[240:243]
    v_mfma_f32_16x16x32_bf16 a[248:251], a[200:203], a[32:35], a[248:251]
    ds_read_b64_tr_b16 a[200:201], v23 offset:45056
    ds_read_b64_tr_b16 a[202:203], v23 offset:47104
    v_mfma_f32_16x16x32_bf16 a[236:239], a[204:207], a[24:27], a[236:239]
    v_mfma_f32_16x16x32_bf16 a[244:247], a[204:207], a[28:31], a[244:247]
    v_mfma_f32_16x16x32_bf16 a[252:255], a[204:207], a[32:35], a[252:255]
    s_waitcnt lgkmcnt(4)
    ds_read_b64_tr_b16 a[204:205], v24 offset:45056
    ds_read_b64_tr_b16 a[206:207], v24 offset:47104
    v_mfma_f32_16x16x32_bf16 v[232:235], a[160:163], a[72:75], 0
    s_waitcnt vmcnt(6)
    buffer_load_dwordx4 v4, s[16:19], s57 offen offset:2048 nt lds
    v_mfma_f32_16x16x32_bf16 v[240:243], a[160:163], a[76:79], 0
    s_add_u32 m0, s51, 98304
    s_sub_u32 s57, s45, 1280
    s_cselect_b32 s45, s45, s57
    v_mfma_f32_16x16x32_bf16 v[248:251], a[160:163], a[80:83], 0
    s_add_u32 s57, s45, 0
    ds_read_b128 a[160:163], v11 offset:55296
    s_add_u32 s45, s44, 0
    v_mfma_f32_16x16x32_bf16 v[232:235], a[164:167], a[84:87], v[232:235]
    v_mfma_f32_16x16x32_bf16 v[240:243], a[164:167], a[88:91], v[240:243]
    v_mfma_f32_16x16x32_bf16 v[248:251], a[164:167], a[92:95], v[248:251]
    ds_read_b128 a[164:167], v12 offset:55296
    v_mfma_f32_16x16x32_bf16 v[232:235], a[168:171], a[96:99], v[232:235]
    v_mfma_f32_16x16x32_bf16 v[240:243], a[168:171], a[100:103], v[240:243]
    v_mfma_f32_16x16x32_bf16 v[248:251], a[168:171], a[104:107], v[248:251]
    ds_read_b128 a[168:171], v11 offset:55424
    v_mfma_f32_16x16x32_bf16 v[232:235], a[172:175], a[108:111], v[232:235]
    v_mfma_f32_16x16x32_bf16 v[240:243], a[172:175], a[112:115], v[240:243]
    v_mfma_f32_16x16x32_bf16 v[248:251], a[172:175], a[116:119], v[248:251]
    ds_read_b128 a[172:175], v12 offset:55424
    v_mfma_f32_16x16x32_bf16 v[232:235], a[176:179], a[120:123], v[232:235]
    v_mfma_f32_16x16x32_bf16 v[240:243], a[176:179], a[124:127], v[240:243]
    v_mfma_f32_16x16x32_bf16 v[248:251], a[176:179], a[128:131], v[248:251]
    ds_read_b128 a[176:179], v11 offset:55552
    v_mfma_f32_16x16x32_bf16 v[232:235], a[180:183], a[132:135], v[232:235]
    v_mfma_f32_16x16x32_bf16 v[240:243], a[180:183], a[136:139], v[240:243]
    v_mfma_f32_16x16x32_bf16 v[248:251], a[180:183], a[140:143], v[248:251]
    s_waitcnt lgkmcnt(2)
    ds_read_b128 a[180:183], v12 offset:55552
    v_mov_b32 v12, 0
    v_mfma_f32_16x16x32_bf16 v[236:239], a[160:163], a[72:75], 0
    s_nop 1
    v_max3_f32 v36, v36, v232, v233
    v_max3_f32 v36, v36, v234, v235
    v_mfma_f32_16x16x32_bf16 v[244:247], a[160:163], a[76:79], 0
    v_max3_f32 v37, v37, v240, v241
    v_max3_f32 v37, v37, v242, v243
    v_mfma_f32_16x16x32_bf16 v[252:255], a[160:163], a[80:83], 0
    v_max3_f32 v38, v38, v248, v249
    v_max3_f32 v38, v38, v250, v251
    v_mfma_f32_16x16x32_bf16 v[236:239], a[164:167], a[84:87], v[236:239]
    v_mfma_f32_16x16x32_bf16 v[244:247], a[164:167], a[88:91], v[244:247]
    v_mfma_f32_16x16x32_bf16 v[252:255], a[164:167], a[92:95], v[252:255]
    v_mfma_f32_16x16x32_bf16 v[236:239], a[168:171], a[96:99], v[236:239]
    v_mfma_f32_16x16x32_bf16 v[244:247], a[168:171], a[100:103], v[244:247]
    v_mfma_f32_16x16x32_bf16 v[252:255], a[168:171], a[104:107], v[252:255]
    s_waitcnt lgkmcnt(0)
    v_mfma_f32_16x16x32_bf16 v[236:239], a[172:175], a[108:111], v[236:239]
    v_mfma_f32_16x16x32_bf16 v[244:247], a[172:175], a[112:115], v[244:247]
    v_mfma_f32_16x16x32_bf16 v[252:255], a[172:175], a[116:119], v[252:255]
    v_mfma_f32_16x16x32_bf16 v[236:239], a[176:179], a[120:123], v[236:239]
    v_mfma_f32_16x16x32_bf16 v[244:247], a[176:179], a[124:127], v[244:247]
    v_mfma_f32_16x16x32_bf16 v[252:255], a[176:179], a[128:131], v[252:255]
    v_mfma_f32_16x16x32_bf16 v[236:239], a[180:183], a[132:135], v[236:239]
    v_mfma_f32_16x16x32_bf16 v[244:247], a[180:183], a[136:139], v[244:247]
    v_mfma_f32_16x16x32_bf16 v[252:255], a[180:183], a[140:143], v[252:255]
    v_mfma_f32_16x16x32_bf16 a[232:235], a[184:187], a[36:39], a[232:235]
    s_nop 4
    v_max3_f32 v36, v36, v236, v237
    v_max3_f32 v36, v36, v238, v239
    v_mfma_f32_16x16x32_bf16 a[240:243], a[184:187], a[40:43], a[240:243]
    v_max3_f32 v37, v37, v244, v245
    v_max3_f32 v37, v37, v246, v247
    v_mfma_f32_16x16x32_bf16 a[248:251], a[184:187], a[44:47], a[248:251]
    v_max3_f32 v38, v38, v252, v253
    v_max3_f32 v38, v38, v254, v255
    v_mfma_f32_16x16x32_bf16 a[236:239], a[188:191], a[36:39], a[236:239]
    v_mov_b32 v48, v36
    v_mov_b32 v49, v37
    v_mfma_f32_16x16x32_bf16 a[244:247], a[188:191], a[40:43], a[244:247]
    v_mov_b32 v50, v38
    v_permlane32_swap_b32 v48, v36
    v_mfma_f32_16x16x32_bf16 a[252:255], a[188:191], a[44:47], a[252:255]
    v_permlane32_swap_b32 v49, v37
    v_permlane32_swap_b32 v50, v38
    v_mfma_f32_16x16x32_bf16 a[232:235], a[192:195], a[48:51], a[232:235]
    v_max_f32 v36, v48, v36
    v_max_f32 v37, v49, v37
    v_mfma_f32_16x16x32_bf16 a[240:243], a[192:195], a[52:55], a[240:243]
    v_max_f32 v38, v50, v38
    v_mov_b32 v48, v36
    v_mfma_f32_16x16x32_bf16 a[248:251], a[192:195], a[56:59], a[248:251]
    v_mov_b32 v49, v37
    v_mov_b32 v50, v38
    v_mfma_f32_16x16x32_bf16 a[236:239], a[196:199], a[48:51], a[236:239]
    v_permlane16_swap_b32 v48, v36
    v_permlane16_swap_b32 v49, v37
    v_mfma_f32_16x16x32_bf16 a[244:247], a[196:199], a[52:55], a[244:247]
    v_permlane16_swap_b32 v50, v38
    v_max_f32 v36, v48, v36
    v_mfma_f32_16x16x32_bf16 a[252:255], a[196:199], a[56:59], a[252:255]
    v_max_f32 v37, v49, v37
    v_max_f32 v38, v50, v38
    v_mfma_f32_16x16x32_bf16 a[232:235], a[200:203], a[60:63], a[232:235]
    ds_write_b128 v31, v[36:39]
    v_mfma_f32_16x16x32_bf16 a[240:243], a[200:203], a[64:67], a[240:243]
    v_mfma_f32_16x16x32_bf16 a[248:251], a[200:203], a[68:71], a[248:251]
    v_mfma_f32_16x16x32_bf16 a[236:239], a[204:207], a[60:63], a[236:239]
    v_mfma_f32_16x16x32_bf16 a[244:247], a[204:207], a[64:67], a[244:247]
    v_mfma_f32_16x16x32_bf16 a[252:255], a[204:207], a[68:71], a[252:255]
    s_waitcnt lgkmcnt(0)
    s_barrier
    ds_read_b128 v[40:43], v32
    s_waitcnt vmcnt(6)
    buffer_load_dwordx4 v8, s[24:27], s57 offen lds
    s_waitcnt vmcnt(6)
    buffer_load_dwordx4 v9, s[24:27], s57 offen offset:1024 lds
    s_waitcnt vmcnt(6)
    buffer_load_dwordx4 v10, s[24:27], s57 offen offset:2048 lds
    s_mov_b32 s57, 3194880
    s_add_u32 m0, s51, 49152
    s_waitcnt vmcnt(6)
    buffer_load_dwordx4 v2, s[16:19], s57 offen nt lds
    s_waitcnt vmcnt(6)
    buffer_load_dwordx4 v3, s[16:19], s57 offen offset:1024 nt lds
    s_waitcnt vmcnt(6)
    buffer_load_dwordx4 v4, s[16:19], s57 offen offset:2048 nt lds
    s_mov_b32 s57, 3207168
    s_add_u32 m0, s51, 61440
    s_waitcnt lgkmcnt(0)
    v_max_f32 v44, v36, v40
    v_max_f32 v45, v37, v41
    v_max_f32 v46, v38, v42
    v_mul_f32 v44, s52, v44
    v_mul_f32 v45, s52, v45
    v_mul_f32 v46, s52, v46
    v_fma_f32 v64, v64, s52, -v44
    v_fma_f32 v65, v65, s52, -v44
    v_fma_f32 v72, v72, s52, -v45
    v_fma_f32 v73, v73, s52, -v45
    v_fma_f32 v80, v80, s52, -v46
    v_fma_f32 v81, v81, s52, -v46
    v_exp_f32 v64, v64
    v_exp_f32 v65, v65
    v_fma_f32 v66, v66, s52, -v44
    v_fma_f32 v67, v67, s52, -v44
    v_exp_f32 v72, v72
    v_exp_f32 v73, v73
    v_fma_f32 v74, v74, s52, -v45
    v_fma_f32 v75, v75, s52, -v45
    v_exp_f32 v80, v80
    v_exp_f32 v81, v81
    v_fma_f32 v82, v82, s52, -v46
    v_fma_f32 v83, v83, s52, -v46
    v_exp_f32 v66, v66
    v_exp_f32 v67, v67
    v_fma_f32 v68, v68, s52, -v44
    v_fma_f32 v69, v69, s52, -v44
    v_fma_f32 v70, v70, s52, -v44
    v_fma_f32 v71, v71, s52, -v44
    v_exp_f32 v74, v74
    v_exp_f32 v75, v75
    v_fma_f32 v76, v76, s52, -v45
    v_fma_f32 v77, v77, s52, -v45
    v_fma_f32 v78, v78, s52, -v45
    v_fma_f32 v79, v79, s52, -v45
    v_exp_f32 v82, v82
    v_exp_f32 v83, v83
    v_fma_f32 v84, v84, s52, -v46
    v_fma_f32 v85, v85, s52, -v46
    v_fma_f32 v86, v86, s52, -v46
    v_fma_f32 v87, v87, s52, -v46
    v_exp_f32 v68, v68
    v_exp_f32 v69, v69
    v_exp_f32 v70, v70
    v_exp_f32 v71, v71
    v_exp_f32 v76, v76
    v_exp_f32 v77, v77
    v_exp_f32 v78, v78
    v_exp_f32 v79, v79
    v_exp_f32 v84, v84
    v_exp_f32 v85, v85
    v_exp_f32 v86, v86
    v_exp_f32 v87, v87
    v_cvt_pk_bf16_f32 v64, v64, v65
    v_cvt_pk_bf16_f32 v72, v72, v73
    v_cvt_pk_bf16_f32 v80, v80, v81
    v_cvt_pk_bf16_f32 v65, v66, v67
    v_cvt_pk_bf16_f32 v73, v74, v75
    v_cvt_pk_bf16_f32 v81, v82, v83
    v_cvt_pk_bf16_f32 v66, v68, v69
    v_cvt_pk_bf16_f32 v67, v70, v71
    v_cvt_pk_bf16_f32 v74, v76, v77
    v_cvt_pk_bf16_f32 v75, v78, v79
    v_mfma_f32_16x16x32_bf16 a[144:147], a[156:159], v[64:67], 0
    s_waitcnt vmcnt(6)
    buffer_load_dwordx4 v2, s[16:19], s57 offen nt lds
    v_mfma_f32_16x16x32_bf16 a[148:151], a[156:159], v[72:75], 0
    s_waitcnt vmcnt(6)
    buffer_load_dwordx4 v3, s[16:19], s57 offen offset:1024 nt lds
    ds_write_b128 v27, v[64:67] offset:0
    s_waitcnt vmcnt(6)
    buffer_load_dwordx4 v4, s[16:19], s57 offen offset:2048 nt lds
    v_cvt_pk_bf16_f32 v82, v84, v85
    v_cvt_pk_bf16_f32 v83, v86, v87
    s_sub_u32 s57, s45, 1280
    s_cselect_b32 s45, s45, s57
    v_mfma_f32_16x16x32_bf16 a[152:155], a[156:159], v[80:83], 0
    s_add_u32 s57, s45, 122880
    ds_write_b128 v27, v[72:75] offset:1024
    s_add_u32 m0, s51, 110592
    v_fma_f32 v88, v88, s52, -v44
    v_fma_f32 v89, v89, s52, -v44
    v_fma_f32 v96, v96, s52, -v45
    v_fma_f32 v97, v97, s52, -v45
    v_fma_f32 v104, v104, s52, -v46
    ds_write_b128 v27, v[80:83] offset:2048
    v_fma_f32 v105, v105, s52, -v46
    v_exp_f32 v88, v88
    v_exp_f32 v89, v89
    v_fma_f32 v90, v90, s52, -v44
    v_fma_f32 v91, v91, s52, -v44
    v_exp_f32 v96, v96
    v_exp_f32 v97, v97
    v_fma_f32 v98, v98, s52, -v45
    v_fma_f32 v99, v99, s52, -v45
    v_exp_f32 v104, v104
    v_exp_f32 v105, v105
    v_fma_f32 v106, v106, s52, -v46
    v_fma_f32 v107, v107, s52, -v46
    v_exp_f32 v90, v90
    v_exp_f32 v91, v91
    v_fma_f32 v92, v92, s52, -v44
    v_fma_f32 v93, v93, s52, -v44
    s_waitcnt lgkmcnt(0)
    s_barrier
    ds_read_b64_tr_b16 a[160:161], v13 offset:0
    ds_read_b64_tr_b16 a[162:163], v13 offset:6144
    ds_read_b64_tr_b16 a[164:165], v14 offset:0
    s_waitcnt vmcnt(6)
    buffer_load_dwordx4 v8, s[24:27], s57 offen lds
    ds_read_b64_tr_b16 a[166:167], v14 offset:6144
    ds_read_b64_tr_b16 a[168:169], v15 offset:0
    v_fma_f32 v94, v94, s52, -v44
    ds_read_b64_tr_b16 a[170:171], v15 offset:6144
    ds_read_b64_tr_b16 a[172:173], v16 offset:0
    ds_read_b64_tr_b16 a[174:175], v16 offset:6144
    v_fma_f32 v95, v95, s52, -v44
    ds_read_b64_tr_b16 a[176:177], v13 offset:128
    ds_read_b64_tr_b16 a[178:179], v13 offset:6272
    ds_read_b64_tr_b16 a[180:181], v14 offset:128
    v_exp_f32 v98, v98
    ds_read_b64_tr_b16 a[182:183], v14 offset:6272
    ds_read_b128 v[68:71], v28 offset:0
    s_waitcnt lgkmcnt(11)
    v_mfma_f32_16x16x32_bf16 a[72:75], a[160:163], v[64:67], 0
    s_add_u32 s45, s44, 1152
    ds_read_b128 v[76:79], v28 offset:1024
    v_fma_f32 v100, v100, s52, -v45
    v_mfma_f32_16x16x32_bf16 a[76:79], a[160:163], v[72:75], 0
    ds_read_b128 v[84:87], v28 offset:2048
    v_fma_f32 v101, v101, s52, -v45
    v_mfma_f32_16x16x32_bf16 a[80:83], a[160:163], v[80:83], 0
    s_waitcnt lgkmcnt(9)
    ds_read_b64_tr_b16 a[160:161], v17 offset:0
    v_fma_f32 v102, v102, s52, -v45
    v_mfma_f32_16x16x32_bf16 a[84:87], a[164:167], v[64:67], 0
    ds_read_b64_tr_b16 a[162:163], v17 offset:6144
    v_fma_f32 v103, v103, s52, -v45
    v_mfma_f32_16x16x32_bf16 a[88:91], a[164:167], v[72:75], 0
    s_waitcnt vmcnt(6)
    buffer_load_dwordx4 v9, s[24:27], s57 offen offset:1024 lds
    v_mfma_f32_16x16x32_bf16 a[92:95], a[164:167], v[80:83], 0
    ds_read_b64_tr_b16 a[164:165], v18 offset:0
    ds_read_b64_tr_b16 a[166:167], v18 offset:6144
    v_mfma_f32_16x16x32_bf16 a[96:99], a[168:171], v[64:67], 0
    v_exp_f32 v99, v99
    v_mfma_f32_16x16x32_bf16 a[100:103], a[168:171], v[72:75], 0
    v_exp_f32 v106, v106
    v_mfma_f32_16x16x32_bf16 a[104:107], a[168:171], v[80:83], 0
    s_waitcnt lgkmcnt(4)
    ds_read_b64_tr_b16 a[168:169], v19 offset:0
    ds_read_b64_tr_b16 a[170:171], v19 offset:6144
    v_mfma_f32_16x16x32_bf16 a[108:111], a[172:175], v[64:67], 0
    v_exp_f32 v107, v107
    v_mfma_f32_16x16x32_bf16 a[112:115], a[172:175], v[72:75], 0
    v_fma_f32 v108, v108, s52, -v46
    v_fma_f32 v109, v109, s52, -v46
    v_mfma_f32_16x16x32_bf16 a[116:119], a[172:175], v[80:83], 0
    ds_read_b64_tr_b16 a[172:173], v20 offset:0
    ds_read_b64_tr_b16 a[174:175], v20 offset:6144
    v_mfma_f32_16x16x32_bf16 a[120:123], a[176:179], v[64:67], 0
    v_fma_f32 v110, v110, s52, -v46
    v_fma_f32 v111, v111, s52, -v46
    v_mfma_f32_16x16x32_bf16 a[124:127], a[176:179], v[72:75], 0
    v_exp_f32 v92, v92
    v_mfma_f32_16x16x32_bf16 a[128:131], a[176:179], v[80:83], 0
    s_waitcnt vmcnt(6)
    buffer_load_dwordx4 v10, s[24:27], s57 offen offset:2048 lds
    v_mfma_f32_16x16x32_bf16 a[132:135], a[180:183], v[64:67], 0
    s_mov_b32 s57, 3219456
    ds_read_b64_tr_b16 a[176:177], v17 offset:128
    ds_read_b64_tr_b16 a[178:179], v17 offset:6272
    v_mfma_f32_16x16x32_bf16 a[136:139], a[180:183], v[72:75], 0
    s_add_u32 m0, s51, 0
    v_exp_f32 v93, v93
    v_mfma_f32_16x16x32_bf16 a[140:143], a[180:183], v[80:83], 0
    s_waitcnt lgkmcnt(4)
    ds_read_b64_tr_b16 a[180:181], v18 offset:128
    ds_read_b64_tr_b16 a[182:183], v18 offset:6272
    v_mfma_f32_16x16x32_bf16 a[72:75], a[160:163], v[68:71], a[72:75]
    v_exp_f32 v94, v94
    v_mfma_f32_16x16x32_bf16 a[76:79], a[160:163], v[76:79], a[76:79]
    v_exp_f32 v95, v95
    v_mfma_f32_16x16x32_bf16 a[80:83], a[160:163], v[84:87], a[80:83]
    v_exp_f32 v100, v100
    v_mfma_f32_16x16x32_bf16 a[84:87], a[164:167], v[68:71], a[84:87]
    v_exp_f32 v101, v101
    v_mfma_f32_16x16x32_bf16 a[88:91], a[164:167], v[76:79], a[88:91]
    v_exp_f32 v102, v102
    v_mfma_f32_16x16x32_bf16 a[92:95], a[164:167], v[84:87], a[92:95]
    v_exp_f32 v103, v103
    v_mfma_f32_16x16x32_bf16 a[96:99], a[168:171], v[68:71], a[96:99]
    v_exp_f32 v108, v108
    v_mfma_f32_16x16x32_bf16 a[100:103], a[168:171], v[76:79], a[100:103]
    v_exp_f32 v109, v109
    v_mfma_f32_16x16x32_bf16 a[104:107], a[168:171], v[84:87], a[104:107]
    s_waitcnt lgkmcnt(0)
    v_exp_f32 v110, v110
    v_mfma_f32_16x16x32_bf16 a[108:111], a[172:175], v[68:71], a[108:111]
    v_exp_f32 v111, v111
    v_mfma_f32_16x16x32_bf16 a[112:115], a[172:175], v[76:79], a[112:115]
    v_cvt_pk_bf16_f32 v88, v88, v89
    v_cvt_pk_bf16_f32 v96, v96, v97
    v_mfma_f32_16x16x32_bf16 a[116:119], a[172:175], v[84:87], a[116:119]
    v_cvt_pk_bf16_f32 v104, v104, v105
    v_cvt_pk_bf16_f32 v89, v90, v91
    v_mfma_f32_16x16x32_bf16 a[120:123], a[176:179], v[68:71], a[120:123]
    v_cvt_pk_bf16_f32 v97, v98, v99
    v_cvt_pk_bf16_f32 v105, v106, v107
    v_mfma_f32_16x16x32_bf16 a[124:127], a[176:179], v[76:79], a[124:127]
    v_cvt_pk_bf16_f32 v90, v92, v93
    v_cvt_pk_bf16_f32 v91, v94, v95
    v_mfma_f32_16x16x32_bf16 a[128:131], a[176:179], v[84:87], a[128:131]
    ds_write_b128 v27, v[88:91] offset:12288
    v_mfma_f32_16x16x32_bf16 a[132:135], a[180:183], v[68:71], a[132:135]
    v_cvt_pk_bf16_f32 v98, v100, v101
    v_cvt_pk_bf16_f32 v99, v102, v103
    v_mfma_f32_16x16x32_bf16 a[136:139], a[180:183], v[76:79], a[136:139]
    ds_write_b128 v27, v[96:99] offset:13312
    v_mfma_f32_16x16x32_bf16 a[140:143], a[180:183], v[84:87], a[140:143]
    v_cvt_pk_bf16_f32 v106, v108, v109
    v_cvt_pk_bf16_f32 v107, v110, v111
    v_mfma_f32_16x16x32_bf16 a[144:147], a[156:159], v[88:91], a[144:147]
    v_fma_f32 v112, v112, s52, -v44
    v_fma_f32 v113, v113, s52, -v44
    v_mfma_f32_16x16x32_bf16 a[148:151], a[156:159], v[96:99], a[148:151]
    ds_write_b128 v27, v[104:107] offset:14336
    v_mfma_f32_16x16x32_bf16 a[152:155], a[156:159], v[104:107], a[152:155]
    v_fma_f32 v120, v120, s52, -v45
    v_fma_f32 v121, v121, s52, -v45
    v_fma_f32 v128, v128, s52, -v46
    v_fma_f32 v129, v129, s52, -v46
    v_exp_f32 v112, v112
    v_exp_f32 v113, v113
    v_fma_f32 v114, v114, s52, -v44
    v_fma_f32 v115, v115, s52, -v44
    v_exp_f32 v120, v120
    v_exp_f32 v121, v121
    v_fma_f32 v122, v122, s52, -v45
    v_fma_f32 v123, v123, s52, -v45
    v_exp_f32 v128, v128
    v_exp_f32 v129, v129
    v_fma_f32 v130, v130, s52, -v46
    v_fma_f32 v131, v131, s52, -v46
    v_exp_f32 v114, v114
    s_waitcnt vmcnt(0) lgkmcnt(0)
    s_barrier
    ds_read_b64_tr_b16 a[160:161], v13 offset:24576
    ds_read_b64_tr_b16 a[162:163], v13 offset:30720
    ds_read_b64_tr_b16 a[164:165], v14 offset:24576
    buffer_load_dwordx4 v2, s[16:19], s57 offen nt lds
    ds_read_b64_tr_b16 a[166:167], v14 offset:30720
    ds_read_b64_tr_b16 a[168:169], v15 offset:24576
    v_exp_f32 v115, v115
    ds_read_b64_tr_b16 a[170:171], v15 offset:30720
    ds_read_b64_tr_b16 a[172:173], v16 offset:24576
    ds_read_b64_tr_b16 a[174:175], v16 offset:30720
    v_fma_f32 v116, v116, s52, -v44
    ds_read_b64_tr_b16 a[176:177], v13 offset:24704
    ds_read_b64_tr_b16 a[178:179], v13 offset:30848
    ds_read_b64_tr_b16 a[180:181], v14 offset:24704
    v_fma_f32 v117, v117, s52, -v44
    ds_read_b64_tr_b16 a[182:183], v14 offset:30848
    ds_read_b128 v[92:95], v28 offset:12288
    s_waitcnt lgkmcnt(11)
    v_mfma_f32_16x16x32_bf16 a[72:75], a[160:163], v[88:91], a[72:75]
    ds_read_b128 v[100:103], v28 offset:13312
    v_fma_f32 v118, v118, s52, -v44
    v_mfma_f32_16x16x32_bf16 a[76:79], a[160:163], v[96:99], a[76:79]
    buffer_load_dwordx4 v3, s[16:19], s57 offen offset:1024 nt lds
    v_mfma_f32_16x16x32_bf16 a[80:83], a[160:163], v[104:107], a[80:83]
    s_waitcnt lgkmcnt(9)
    ds_read_b64_tr_b16 a[160:161], v17 offset:24576
    ds_read_b64_tr_b16 a[162:163], v17 offset:30720
    v_mfma_f32_16x16x32_bf16 a[84:87], a[164:167], v[88:91], a[84:87]
    ds_read_b128 v[108:111], v28 offset:14336
    v_fma_f32 v119, v119, s52, -v44
    v_mfma_f32_16x16x32_bf16 a[88:91], a[164:167], v[96:99], a[88:91]
    ds_read_b64_tr_b16 a[184:185], v25 offset:0
    ds_read_b64_tr_b16 a[186:187], v25 offset:2048
    v_mfma_f32_16x16x32_bf16 a[92:95], a[164:167], v[104:107], a[92:95]
    s_waitcnt lgkmcnt(8)
    ds_read_b64_tr_b16 a[164:165], v18 offset:24576
    ds_read_b64_tr_b16 a[166:167], v18 offset:30720
    v_mfma_f32_16x16x32_bf16 a[96:99], a[168:171], v[88:91], a[96:99]
    ds_read_b64_tr_b16 a[188:189], v26 offset:0
    ds_read_b64_tr_b16 a[190:191], v26 offset:2048
    v_mfma_f32_16x16x32_bf16 a[100:103], a[168:171], v[96:99], a[100:103]
    ds_read_b64_tr_b16 a[192:193], v25 offset:4096
    ds_read_b64_tr_b16 a[194:195], v25 offset:6144
    v_mfma_f32_16x16x32_bf16 a[104:107], a[168:171], v[104:107], a[104:107]
    buffer_load_dwordx4 v4, s[16:19], s57 offen offset:2048 nt lds
    v_mfma_f32_16x16x32_bf16 a[108:111], a[172:175], v[88:91], a[108:111]
    s_mov_b32 s57, 3231744
    ds_read_b64_tr_b16 a[168:169], v19 offset:24576
    ds_read_b64_tr_b16 a[170:171], v19 offset:30720
    v_mfma_f32_16x16x32_bf16 a[112:115], a[172:175], v[96:99], a[112:115]
    s_add_u32 m0, s51, 12288
    ds_read_b64_tr_b16 a[196:197], v26 offset:4096
    ds_read_b64_tr_b16 a[198:199], v26 offset:6144
    v_mfma_f32_16x16x32_bf16 a[116:119], a[172:175], v[104:107], a[116:119]
    ds_read_b64_tr_b16 a[172:173], v20 offset:24576
    ds_read_b64_tr_b16 a[174:175], v20 offset:30720
    v_mfma_f32_16x16x32_bf16 a[120:123], a[176:179], v[88:91], a[120:123]
    v_exp_f32 v122, v122
    v_mfma_f32_16x16x32_bf16 a[124:127], a[176:179], v[96:99], a[124:127]
    v_exp_f32 v123, v123
    v_mfma_f32_16x16x32_bf16 a[128:131], a[176:179], v[104:107], a[128:131]
    s_waitcnt lgkmcnt(6)
    ds_read_b64_tr_b16 a[176:177], v17 offset:24704
    ds_read_b64_tr_b16 a[178:179], v17 offset:30848
    v_mfma_f32_16x16x32_bf16 a[132:135], a[180:183], v[88:91], a[132:135]
    buffer_load_dwordx4 v2, s[16:19], s57 offen nt lds
    v_mfma_f32_16x16x32_bf16 a[136:139], a[180:183], v[96:99], a[136:139]
    v_fma_f32 v124, v124, s52, -v45
    v_fma_f32 v125, v125, s52, -v45
    v_mfma_f32_16x16x32_bf16 a[140:143], a[180:183], v[104:107], a[140:143]
    ds_read_b64_tr_b16 a[180:181], v18 offset:24704
    ds_read_b64_tr_b16 a[182:183], v18 offset:30848
    v_mfma_f32_16x16x32_bf16 a[72:75], a[160:163], v[92:95], a[72:75]
    v_fma_f32 v126, v126, s52, -v45
    v_fma_f32 v127, v127, s52, -v45
    v_mfma_f32_16x16x32_bf16 a[76:79], a[160:163], v[100:103], a[76:79]
    v_exp_f32 v130, v130
    v_mfma_f32_16x16x32_bf16 a[80:83], a[160:163], v[108:111], a[80:83]
    v_exp_f32 v131, v131
    v_mfma_f32_16x16x32_bf16 a[84:87], a[164:167], v[92:95], a[84:87]
    v_fma_f32 v132, v132, s52, -v46
    v_fma_f32 v133, v133, s52, -v46
    v_mfma_f32_16x16x32_bf16 a[88:91], a[164:167], v[100:103], a[88:91]
    buffer_load_dwordx4 v3, s[16:19], s57 offen offset:1024 nt lds
    v_mfma_f32_16x16x32_bf16 a[92:95], a[164:167], v[108:111], a[92:95]
    s_waitcnt lgkmcnt(2)
    v_fma_f32 v134, v134, s52, -v46
    v_fma_f32 v135, v135, s52, -v46
    v_mfma_f32_16x16x32_bf16 a[96:99], a[168:171], v[92:95], a[96:99]
    v_exp_f32 v116, v116
    v_mfma_f32_16x16x32_bf16 a[100:103], a[168:171], v[100:103], a[100:103]
    v_exp_f32 v117, v117
    v_mfma_f32_16x16x32_bf16 a[104:107], a[168:171], v[108:111], a[104:107]
    v_exp_f32 v118, v118
    v_mfma_f32_16x16x32_bf16 a[108:111], a[172:175], v[92:95], a[108:111]
    v_exp_f32 v119, v119
    v_mfma_f32_16x16x32_bf16 a[112:115], a[172:175], v[100:103], a[112:115]
    v_exp_f32 v124, v124
    v_mfma_f32_16x16x32_bf16 a[116:119], a[172:175], v[108:111], a[116:119]
    buffer_load_dwordx4 v4, s[16:19], s57 offen offset:2048 nt lds
    v_mfma_f32_16x16x32_bf16 a[120:123], a[176:179], v[92:95], a[120:123]
    s_mov_b32 s57, 3244032
    v_exp_f32 v125, v125
    v_mfma_f32_16x16x32_bf16 a[124:127], a[176:179], v[100:103], a[124:127]
    s_add_u32 m0, s51, 24576
    v_exp_f32 v126, v126
    v_mfma_f32_16x16x32_bf16 a[128:131], a[176:179], v[108:111], a[128:131]
    s_waitcnt lgkmcnt(0)
    v_exp_f32 v127, v127
    v_mfma_f32_16x16x32_bf16 a[132:135], a[180:183], v[92:95], a[132:135]
    v_exp_f32 v132, v132
    v_mfma_f32_16x16x32_bf16 a[136:139], a[180:183], v[100:103], a[136:139]
    v_exp_f32 v133, v133
    v_mfma_f32_16x16x32_bf16 a[140:143], a[180:183], v[108:111], a[140:143]
    v_exp_f32 v134, v134
    v_mfma_f32_16x16x32_bf16 v[64:67], a[184:187], a[0:3], 0
    v_exp_f32 v135, v135
    v_mfma_f32_16x16x32_bf16 v[72:75], a[184:187], a[4:7], 0
    v_cvt_pk_bf16_f32 v112, v112, v113
    v_cvt_pk_bf16_f32 v120, v120, v121
    v_mfma_f32_16x16x32_bf16 v[80:83], a[184:187], a[8:11], 0
    v_cvt_pk_bf16_f32 v128, v128, v129
    v_cvt_pk_bf16_f32 v113, v114, v115
    v_mfma_f32_16x16x32_bf16 v[68:71], a[188:191], a[0:3], 0
    v_cvt_pk_bf16_f32 v121, v122, v123
    v_cvt_pk_bf16_f32 v129, v130, v131
    v_mfma_f32_16x16x32_bf16 v[76:79], a[188:191], a[4:7], 0
    v_cvt_pk_bf16_f32 v114, v116, v117
    v_cvt_pk_bf16_f32 v115, v118, v119
    v_mfma_f32_16x16x32_bf16 v[84:87], a[188:191], a[8:11], 0
    ds_write_b128 v27, v[112:115] offset:0
    v_mfma_f32_16x16x32_bf16 v[64:67], a[192:195], a[12:15], v[64:67]
    v_cvt_pk_bf16_f32 v122, v124, v125
    v_cvt_pk_bf16_f32 v123, v126, v127
    v_mfma_f32_16x16x32_bf16 v[72:75], a[192:195], a[16:19], v[72:75]
    ds_write_b128 v27, v[120:123] offset:1024
    v_mfma_f32_16x16x32_bf16 v[80:83], a[192:195], a[20:23], v[80:83]
    v_cvt_pk_bf16_f32 v130, v132, v133
    v_cvt_pk_bf16_f32 v131, v134, v135
    v_mfma_f32_16x16x32_bf16 v[68:71], a[196:199], a[12:15], v[68:71]
    v_fma_f32 v136, v136, s52, -v44
    v_fma_f32 v137, v137, s52, -v44
    v_mfma_f32_16x16x32_bf16 v[76:79], a[196:199], a[16:19], v[76:79]
    ds_write_b128 v27, v[128:131] offset:2048
    v_mfma_f32_16x16x32_bf16 v[84:87], a[196:199], a[20:23], v[84:87]
    v_fma_f32 v144, v144, s52, -v45
    v_fma_f32 v145, v145, s52, -v45
    v_mfma_f32_16x16x32_bf16 a[144:147], a[156:159], v[112:115], a[144:147]
    ds_read_b64_tr_b16 a[200:201], v25 offset:8192
    v_fma_f32 v152, v152, s52, -v46
    v_mfma_f32_16x16x32_bf16 a[148:151], a[156:159], v[120:123], a[148:151]
    ds_read_b64_tr_b16 a[202:203], v25 offset:10240
    ds_read_b64_tr_b16 a[204:205], v26 offset:8192
    v_mfma_f32_16x16x32_bf16 a[152:155], a[156:159], v[128:131], a[152:155]
    ds_read_b64_tr_b16 a[206:207], v26 offset:10240
    ds_read_b64_tr_b16 a[184:185], v25 offset:12288
    ds_read_b64_tr_b16 a[186:187], v25 offset:14336
    v_fma_f32 v153, v153, s52, -v46
    v_exp_f32 v136, v136
    v_exp_f32 v137, v137
    v_fma_f32 v138, v138, s52, -v44
    v_fma_f32 v139, v139, s52, -v44
    v_exp_f32 v144, v144
    s_waitcnt lgkmcnt(6)
    s_barrier
    ds_read_b64_tr_b16 a[160:161], v13 offset:49152
    ds_read_b64_tr_b16 a[162:163], v13 offset:55296
    ds_read_b64_tr_b16 a[164:165], v14 offset:49152
    buffer_load_dwordx4 v2, s[16:19], s57 offen nt lds
    ds_read_b64_tr_b16 a[166:167], v14 offset:55296
    ds_read_b64_tr_b16 a[168:169], v15 offset:49152
    v_exp_f32 v145, v145
    ds_read_b64_tr_b16 a[170:171], v15 offset:55296
    ds_read_b64_tr_b16 a[172:173], v16 offset:49152
    ds_read_b64_tr_b16 a[174:175], v16 offset:55296
    v_fma_f32 v146, v146, s52, -v45
    ds_read_b64_tr_b16 a[176:177], v13 offset:49280
    ds_read_b64_tr_b16 a[178:179], v13 offset:55424
    ds_read_b64_tr_b16 a[180:181], v14 offset:49280
    s_waitcnt vmcnt(6)
    buffer_load_dwordx4 v3, s[16:19], s57 offen offset:1024 nt lds
    ds_read_b64_tr_b16 a[182:183], v14 offset:55424
    ds_read_b128 v[116:119], v28 offset:0
    v_fma_f32 v147, v147, s52, -v45
    s_waitcnt lgkmcnt(11)
    v_mfma_f32_16x16x32_bf16 a[72:75], a[160:163], v[112:115], a[72:75]
    ds_read_b128 v[124:127], v28 offset:1024
    v_fma_f32 v154, v154, s52, -v46
    v_mfma_f32_16x16x32_bf16 a[76:79], a[160:163], v[120:123], a[76:79]
    ds_read_b128 v[132:135], v28 offset:2048
    v_fma_f32 v155, v155, s52, -v46
    v_mfma_f32_16x16x32_bf16 a[80:83], a[160:163], v[128:131], a[80:83]
    s_waitcnt lgkmcnt(10)
    ds_read_b64_tr_b16 a[160:161], v17 offset:49152
    v_fma_f32 v140, v140, s52, -v44
    v_mfma_f32_16x16x32_bf16 a[84:87], a[164:167], v[112:115], a[84:87]
    s_waitcnt vmcnt(6)
    buffer_load_dwordx4 v4, s[16:19], s57 offen offset:2048 nt lds
    v_mfma_f32_16x16x32_bf16 a[88:91], a[164:167], v[120:123], a[88:91]
    s_mov_b32 s57, 3256320
    ds_read_b64_tr_b16 a[162:163], v17 offset:55296
    s_add_u32 m0, s51, 36864
    v_mfma_f32_16x16x32_bf16 a[92:95], a[164:167], v[128:131], a[92:95]
    s_waitcnt lgkmcnt(6)
    ds_read_b64_tr_b16 a[164:165], v18 offset:49152
    ds_read_b64_tr_b16 a[166:167], v18 offset:55296
    v_mfma_f32_16x16x32_bf16 a[96:99], a[168:171], v[112:115], a[96:99]
    ds_read_b64_tr_b16 a[188:189], v26 offset:12288
    ds_read_b64_tr_b16 a[190:191], v26 offset:14336
    v_mfma_f32_16x16x32_bf16 a[100:103], a[168:171], v[120:123], a[100:103]
    v_exp_f32 v152, v152
    v_mfma_f32_16x16x32_bf16 a[104:107], a[168:171], v[128:131], a[104:107]
    s_waitcnt vmcnt(6)
    buffer_load_dwordx4 v2, s[16:19], s57 offen nt lds
    v_mfma_f32_16x16x32_bf16 a[108:111], a[172:175], v[112:115], a[108:111]
    ds_read_b64_tr_b16 a[168:169], v19 offset:49152
    ds_read_b64_tr_b16 a[170:171], v19 offset:55296
    v_mfma_f32_16x16x32_bf16 a[112:115], a[172:175], v[120:123], a[112:115]
    v_exp_f32 v153, v153
    v_mfma_f32_16x16x32_bf16 a[116:119], a[172:175], v[128:131], a[116:119]
    ds_read_b64_tr_b16 a[172:173], v20 offset:49152
    ds_read_b64_tr_b16 a[174:175], v20 offset:55296
    v_mfma_f32_16x16x32_bf16 a[120:123], a[176:179], v[112:115], a[120:123]
    v_exp_f32 v138, v138
    v_mfma_f32_16x16x32_bf16 a[124:127], a[176:179], v[120:123], a[124:127]
    s_waitcnt vmcnt(6)
    buffer_load_dwordx4 v3, s[16:19], s57 offen offset:1024 nt lds
    v_mfma_f32_16x16x32_bf16 a[128:131], a[176:179], v[128:131], a[128:131]
    s_waitcnt lgkmcnt(4)
    ds_read_b64_tr_b16 a[176:177], v17 offset:49280
    ds_read_b64_tr_b16 a[178:179], v17 offset:55424
    v_mfma_f32_16x16x32_bf16 a[132:135], a[180:183], v[112:115], a[132:135]
    v_exp_f32 v139, v139
    v_mfma_f32_16x16x32_bf16 a[136:139], a[180:183], v[120:123], a[136:139]
    v_fma_f32 v141, v141, s52, -v44
    v_fma_f32 v142, v142, s52, -v44
    v_mfma_f32_16x16x32_bf16 a[140:143], a[180:183], v[128:131], a[140:143]
    ds_read_b64_tr_b16 a[180:181], v18 offset:49280
    ds_read_b64_tr_b16 a[182:183], v18 offset:55424
    v_mfma_f32_16x16x32_bf16 a[72:75], a[160:163], v[116:119], a[72:75]
    s_waitcnt vmcnt(6)
    buffer_load_dwordx4 v4, s[16:19], s57 offen offset:2048 nt lds
    v_mfma_f32_16x16x32_bf16 a[76:79], a[160:163], v[124:127], a[76:79]
    s_add_u32 m0, s51, 73728
    s_sub_u32 s57, s45, 1280
    s_cselect_b32 s45, s45, s57
    v_mfma_f32_16x16x32_bf16 a[80:83], a[160:163], v[132:135], a[80:83]
    s_add_u32 s57, s45, 0
    v_fma_f32 v143, v143, s52, -v44
    v_fma_f32 v148, v148, s52, -v45
    v_mfma_f32_16x16x32_bf16 a[84:87], a[164:167], v[116:119], a[84:87]
    s_add_u32 s45, s44, 1152
    v_exp_f32 v146, v146
    v_mfma_f32_16x16x32_bf16 a[88:91], a[164:167], v[124:127], a[88:91]
    v_exp_f32 v147, v147
    v_mfma_f32_16x16x32_bf16 a[92:95], a[164:167], v[132:135], a[92:95]
    s_waitcnt lgkmcnt(2)
    s_waitcnt vmcnt(6)
    buffer_load_dwordx4 v8, s[24:27], s57 offen lds
    v_mfma_f32_16x16x32_bf16 a[96:99], a[168:171], v[116:119], a[96:99]
    v_fma_f32 v149, v149, s52, -v45
    v_fma_f32 v150, v150, s52, -v45
    v_mfma_f32_16x16x32_bf16 a[100:103], a[168:171], v[124:127], a[100:103]
    v_fma_f32 v151, v151, s52, -v45
    v_fma_f32 v156, v156, s52, -v46
    v_mfma_f32_16x16x32_bf16 a[104:107], a[168:171], v[132:135], a[104:107]
    v_exp_f32 v154, v154
    v_mfma_f32_16x16x32_bf16 a[108:111], a[172:175], v[116:119], a[108:111]
    v_exp_f32 v155, v155
    v_mfma_f32_16x16x32_bf16 a[112:115], a[172:175], v[124:127], a[112:115]
    s_waitcnt vmcnt(6)
    buffer_load_dwordx4 v9, s[24:27], s57 offen offset:1024 lds
    v_mfma_f32_16x16x32_bf16 a[116:119], a[172:175], v[132:135], a[116:119]
    v_fma_f32 v157, v157, s52, -v46
    v_fma_f32 v158, v158, s52, -v46
    v_mfma_f32_16x16x32_bf16 a[120:123], a[176:179], v[116:119], a[120:123]
    v_fma_f32 v159, v159, s52, -v46
    v_cvt_pk_bf16_f32 v136, v136, v137
    v_mfma_f32_16x16x32_bf16 a[124:127], a[176:179], v[124:127], a[124:127]
    v_exp_f32 v140, v140
    v_mfma_f32_16x16x32_bf16 a[128:131], a[176:179], v[132:135], a[128:131]
    s_waitcnt lgkmcnt(0)
    v_exp_f32 v141, v141
    v_mfma_f32_16x16x32_bf16 a[132:135], a[180:183], v[116:119], a[132:135]
    s_waitcnt vmcnt(6)
    buffer_load_dwordx4 v10, s[24:27], s57 offen offset:2048 lds
    v_mfma_f32_16x16x32_bf16 a[136:139], a[180:183], v[124:127], a[136:139]
    s_add_u32 m0, s51, 86016
    v_exp_f32 v142, v142
    v_mfma_f32_16x16x32_bf16 a[140:143], a[180:183], v[132:135], a[140:143]
    v_exp_f32 v143, v143
    v_mfma_f32_16x16x32_bf16 v[64:67], a[200:203], a[24:27], v[64:67]
    v_exp_f32 v148, v148
    v_mfma_f32_16x16x32_bf16 v[72:75], a[200:203], a[28:31], v[72:75]
    v_exp_f32 v149, v149
    v_mfma_f32_16x16x32_bf16 v[80:83], a[200:203], a[32:35], v[80:83]
    v_exp_f32 v150, v150
    v_mfma_f32_16x16x32_bf16 v[68:71], a[204:207], a[24:27], v[68:71]
    v_exp_f32 v151, v151
    v_mfma_f32_16x16x32_bf16 v[76:79], a[204:207], a[28:31], v[76:79]
    v_exp_f32 v156, v156
    v_mfma_f32_16x16x32_bf16 v[84:87], a[204:207], a[32:35], v[84:87]
    v_exp_f32 v157, v157
    v_mfma_f32_16x16x32_bf16 v[64:67], a[184:187], a[36:39], v[64:67]
    v_exp_f32 v158, v158
    v_mfma_f32_16x16x32_bf16 v[72:75], a[184:187], a[40:43], v[72:75]
    v_exp_f32 v159, v159
    v_mfma_f32_16x16x32_bf16 v[80:83], a[184:187], a[44:47], v[80:83]
    v_cvt_pk_bf16_f32 v144, v144, v145
    v_cvt_pk_bf16_f32 v152, v152, v153
    v_mfma_f32_16x16x32_bf16 v[68:71], a[188:191], a[36:39], v[68:71]
    v_cvt_pk_bf16_f32 v137, v138, v139
    v_cvt_pk_bf16_f32 v145, v146, v147
    v_mfma_f32_16x16x32_bf16 v[76:79], a[188:191], a[40:43], v[76:79]
    v_cvt_pk_bf16_f32 v153, v154, v155
    v_cvt_pk_bf16_f32 v138, v140, v141
    v_mfma_f32_16x16x32_bf16 v[84:87], a[188:191], a[44:47], v[84:87]
    v_cvt_pk_bf16_f32 v139, v142, v143
    v_cvt_pk_bf16_f32 v146, v148, v149
    v_cvt_pk_bf16_f32 v147, v150, v151
    v_mfma_f32_16x16x32_bf16 a[144:147], a[156:159], v[136:139], a[144:147]
    ds_write_b128 v27, v[136:139] offset:12288
    v_mfma_f32_16x16x32_bf16 a[148:151], a[156:159], v[144:147], a[148:151]
    v_cvt_pk_bf16_f32 v154, v156, v157
    v_cvt_pk_bf16_f32 v155, v158, v159
    s_sub_u32 s57, s45, 1280
    s_cselect_b32 s45, s45, s57
    v_mfma_f32_16x16x32_bf16 a[152:155], a[156:159], v[152:155], a[152:155]
    s_add_u32 s57, s45, 122880
    ds_write_b128 v27, v[144:147] offset:13312
    v_fma_f32 v160, v160, s52, -v44
    v_fma_f32 v161, v161, s52, -v44
    v_fma_f32 v168, v168, s52, -v45
    v_fma_f32 v169, v169, s52, -v45
    v_fma_f32 v176, v176, s52, -v46
    v_fma_f32 v177, v177, s52, -v46
    ds_write_b128 v27, v[152:155] offset:14336
    v_exp_f32 v160, v160
    v_exp_f32 v161, v161
    v_fma_f32 v162, v162, s52, -v44
    v_fma_f32 v163, v163, s52, -v44
    ds_read_b64_tr_b16 a[192:193], v25 offset:16384
    ds_read_b64_tr_b16 a[194:195], v25 offset:18432
    ds_read_b64_tr_b16 a[196:197], v26 offset:16384
    v_exp_f32 v168, v168
    v_exp_f32 v169, v169
    v_fma_f32 v170, v170, s52, -v45
    v_fma_f32 v171, v171, s52, -v45
    v_exp_f32 v176, v176
    v_exp_f32 v177, v177
    v_fma_f32 v178, v178, s52, -v46
    v_fma_f32 v179, v179, s52, -v46
    v_exp_f32 v162, v162
    s_waitcnt lgkmcnt(3)
    s_barrier
    ds_read_b64_tr_b16 a[160:161], v13 offset:0
    ds_read_b64_tr_b16 a[162:163], v13 offset:6144
    ds_read_b64_tr_b16 a[164:165], v14 offset:0
    s_waitcnt vmcnt(6)
    buffer_load_dwordx4 v8, s[24:27], s57 offen lds
    ds_read_b64_tr_b16 a[166:167], v14 offset:6144
    ds_read_b64_tr_b16 a[168:169], v15 offset:0
    v_exp_f32 v163, v163
    ds_read_b64_tr_b16 a[170:171], v15 offset:6144
    ds_read_b64_tr_b16 a[172:173], v16 offset:0
    ds_read_b64_tr_b16 a[174:175], v16 offset:6144
    v_fma_f32 v164, v164, s52, -v44
    ds_read_b64_tr_b16 a[176:177], v13 offset:128
    ds_read_b64_tr_b16 a[178:179], v13 offset:6272
    ds_read_b64_tr_b16 a[180:181], v14 offset:128
    s_waitcnt vmcnt(6)
    buffer_load_dwordx4 v9, s[24:27], s57 offen offset:1024 lds
    ds_read_b64_tr_b16 a[182:183], v14 offset:6272
    ds_read_b128 v[140:143], v28 offset:12288
    v_fma_f32 v165, v165, s52, -v44
    s_waitcnt lgkmcnt(11)
    v_mfma_f32_16x16x32_bf16 a[72:75], a[160:163], v[136:139], a[72:75]
    s_add_u32 s45, s44, 128
    ds_read_b128 v[148:151], v28 offset:13312
    v_fma_f32 v166, v166, s52, -v44
    v_mfma_f32_16x16x32_bf16 a[76:79], a[160:163], v[144:147], a[76:79]
    ds_read_b128 v[156:159], v28 offset:14336
    v_fma_f32 v167, v167, s52, -v44
    v_mfma_f32_16x16x32_bf16 a[80:83], a[160:163], v[152:155], a[80:83]
    s_waitcnt lgkmcnt(10)
    ds_read_b64_tr_b16 a[160:161], v17 offset:0
    v_fma_f32 v172, v172, s52, -v45
    v_mfma_f32_16x16x32_bf16 a[84:87], a[164:167], v[136:139], a[84:87]
    s_waitcnt vmcnt(6)
    buffer_load_dwordx4 v10, s[24:27], s57 offen offset:2048 lds
    v_mfma_f32_16x16x32_bf16 a[88:91], a[164:167], v[144:147], a[88:91]
    s_mov_b32 s57, 3268608
    ds_read_b64_tr_b16 a[162:163], v17 offset:6144
    s_add_u32 m0, s51, 49152
    v_mfma_f32_16x16x32_bf16 a[92:95], a[164:167], v[152:155], a[92:95]
    s_waitcnt lgkmcnt(6)
    ds_read_b64_tr_b16 a[164:165], v18 offset:0
    ds_read_b64_tr_b16 a[166:167], v18 offset:6144
    v_mfma_f32_16x16x32_bf16 a[96:99], a[168:171], v[136:139], a[96:99]
    ds_read_b64_tr_b16 a[198:199], v26 offset:18432
    ds_read_b64_tr_b16 a[200:201], v25 offset:20480
    v_mfma_f32_16x16x32_bf16 a[100:103], a[168:171], v[144:147], a[100:103]
    ds_read_b64_tr_b16 a[202:203], v25 offset:22528
    v_fma_f32 v173, v173, s52, -v45
    v_mfma_f32_16x16x32_bf16 a[104:107], a[168:171], v[152:155], a[104:107]
    s_waitcnt vmcnt(6)
    buffer_load_dwordx4 v2, s[16:19], s57 offen nt lds
    v_mfma_f32_16x16x32_bf16 a[108:111], a[172:175], v[136:139], a[108:111]
    ds_read_b64_tr_b16 a[168:169], v19 offset:0
    ds_read_b64_tr_b16 a[170:171], v19 offset:6144
    v_mfma_f32_16x16x32_bf16 a[112:115], a[172:175], v[144:147], a[112:115]
    ds_read_b64_tr_b16 a[204:205], v26 offset:20480
    ds_read_b64_tr_b16 a[206:207], v26 offset:22528
    v_mfma_f32_16x16x32_bf16 a[116:119], a[172:175], v[152:155], a[116:119]
    ds_read_b64_tr_b16 a[172:173], v20 offset:0
    ds_read_b64_tr_b16 a[174:175], v20 offset:6144
    v_mfma_f32_16x16x32_bf16 a[120:123], a[176:179], v[136:139], a[120:123]
    v_exp_f32 v170, v170
    v_mfma_f32_16x16x32_bf16 a[124:127], a[176:179], v[144:147], a[124:127]
    s_waitcnt vmcnt(6)
    buffer_load_dwordx4 v3, s[16:19], s57 offen offset:1024 nt lds
    v_mfma_f32_16x16x32_bf16 a[128:131], a[176:179], v[152:155], a[128:131]
    s_waitcnt lgkmcnt(6)
    ds_read_b64_tr_b16 a[176:177], v17 offset:128
    ds_read_b64_tr_b16 a[178:179], v17 offset:6272
    v_mfma_f32_16x16x32_bf16 a[132:135], a[180:183], v[136:139], a[132:135]
    v_exp_f32 v171, v171
    v_mfma_f32_16x16x32_bf16 a[136:139], a[180:183], v[144:147], a[136:139]
    v_fma_f32 v174, v174, s52, -v45
    v_fma_f32 v175, v175, s52, -v45
    v_mfma_f32_16x16x32_bf16 a[140:143], a[180:183], v[152:155], a[140:143]
    ds_read_b64_tr_b16 a[180:181], v18 offset:128
    ds_read_b64_tr_b16 a[182:183], v18 offset:6272
    v_mfma_f32_16x16x32_bf16 a[72:75], a[160:163], v[140:143], a[72:75]
    s_waitcnt vmcnt(6)
    buffer_load_dwordx4 v4, s[16:19], s57 offen offset:2048 nt lds
    v_mfma_f32_16x16x32_bf16 a[76:79], a[160:163], v[148:151], a[76:79]
    s_mov_b32 s57, 3280896
    s_add_u32 m0, s51, 61440
    v_fma_f32 v180, v180, s52, -v46
    v_mfma_f32_16x16x32_bf16 a[80:83], a[160:163], v[156:159], a[80:83]
    v_exp_f32 v178, v178
    v_mfma_f32_16x16x32_bf16 a[84:87], a[164:167], v[140:143], a[84:87]
    v_exp_f32 v179, v179
    v_mfma_f32_16x16x32_bf16 a[88:91], a[164:167], v[148:151], a[88:91]
    v_fma_f32 v181, v181, s52, -v46
    v_fma_f32 v182, v182, s52, -v46
    v_mfma_f32_16x16x32_bf16 a[92:95], a[164:167], v[156:159], a[92:95]
    s_waitcnt lgkmcnt(2)
    s_waitcnt vmcnt(6)
    buffer_load_dwordx4 v2, s[16:19], s57 offen nt lds
    v_mfma_f32_16x16x32_bf16 a[96:99], a[168:171], v[140:143], a[96:99]
    v_fma_f32 v183, v183, s52, -v46
    v_cvt_pk_bf16_f32 v160, v160, v161
    v_mfma_f32_16x16x32_bf16 a[100:103], a[168:171], v[148:151], a[100:103]
    v_exp_f32 v164, v164
    v_mfma_f32_16x16x32_bf16 a[104:107], a[168:171], v[156:159], a[104:107]
    v_exp_f32 v165, v165
    v_mfma_f32_16x16x32_bf16 a[108:111], a[172:175], v[140:143], a[108:111]
    v_exp_f32 v166, v166
    v_mfma_f32_16x16x32_bf16 a[112:115], a[172:175], v[148:151], a[112:115]
    s_waitcnt vmcnt(6)
    buffer_load_dwordx4 v3, s[16:19], s57 offen offset:1024 nt lds
    v_mfma_f32_16x16x32_bf16 a[116:119], a[172:175], v[156:159], a[116:119]
    v_exp_f32 v167, v167
    v_mfma_f32_16x16x32_bf16 a[120:123], a[176:179], v[140:143], a[120:123]
    v_exp_f32 v172, v172
    v_mfma_f32_16x16x32_bf16 a[124:127], a[176:179], v[148:151], a[124:127]
    v_exp_f32 v173, v173
    v_mfma_f32_16x16x32_bf16 a[128:131], a[176:179], v[156:159], a[128:131]
    s_waitcnt lgkmcnt(0)
    v_exp_f32 v174, v174
    v_mfma_f32_16x16x32_bf16 a[132:135], a[180:183], v[140:143], a[132:135]
    s_waitcnt vmcnt(6)
    buffer_load_dwordx4 v4, s[16:19], s57 offen offset:2048 nt lds
    v_mfma_f32_16x16x32_bf16 a[136:139], a[180:183], v[148:151], a[136:139]
    s_mov_b32 s57, 3293184
    v_exp_f32 v175, v175
    v_mfma_f32_16x16x32_bf16 a[140:143], a[180:183], v[156:159], a[140:143]
    s_add_u32 m0, s51, 0
    v_exp_f32 v180, v180
    v_mfma_f32_16x16x32_bf16 v[64:67], a[192:195], a[48:51], v[64:67]
    v_exp_f32 v181, v181
    v_mfma_f32_16x16x32_bf16 v[72:75], a[192:195], a[52:55], v[72:75]
    v_exp_f32 v182, v182
    v_mfma_f32_16x16x32_bf16 v[80:83], a[192:195], a[56:59], v[80:83]
    v_exp_f32 v183, v183
    v_mfma_f32_16x16x32_bf16 v[68:71], a[196:199], a[48:51], v[68:71]
    v_cvt_pk_bf16_f32 v168, v168, v169
    v_cvt_pk_bf16_f32 v176, v176, v177
    v_mfma_f32_16x16x32_bf16 v[76:79], a[196:199], a[52:55], v[76:79]
    v_cvt_pk_bf16_f32 v161, v162, v163
    v_cvt_pk_bf16_f32 v169, v170, v171
    v_mfma_f32_16x16x32_bf16 v[84:87], a[196:199], a[56:59], v[84:87]
    v_cvt_pk_bf16_f32 v177, v178, v179
    v_cvt_pk_bf16_f32 v162, v164, v165
    v_mfma_f32_16x16x32_bf16 v[64:67], a[200:203], a[60:63], v[64:67]
    v_cvt_pk_bf16_f32 v163, v166, v167
    v_cvt_pk_bf16_f32 v170, v172, v173
    v_mfma_f32_16x16x32_bf16 v[72:75], a[200:203], a[64:67], v[72:75]
    ds_write_b128 v27, v[160:163] offset:0
    v_mfma_f32_16x16x32_bf16 v[80:83], a[200:203], a[68:71], v[80:83]
    v_cvt_pk_bf16_f32 v171, v174, v175
    v_cvt_pk_bf16_f32 v178, v180, v181
    v_mfma_f32_16x16x32_bf16 v[68:71], a[204:207], a[60:63], v[68:71]
    ds_write_b128 v27, v[168:171] offset:1024
    v_mfma_f32_16x16x32_bf16 v[76:79], a[204:207], a[64:67], v[76:79]
    v_cvt_pk_bf16_f32 v179, v182, v183
    v_fma_f32 v184, v184, s52, -v44
    v_mfma_f32_16x16x32_bf16 v[84:87], a[204:207], a[68:71], v[84:87]
    v_fma_f32 v185, v185, s52, -v44
    v_fma_f32 v192, v192, s52, -v45
    v_mfma_f32_16x16x32_bf16 a[144:147], a[156:159], v[160:163], a[144:147]
    ds_write_b128 v27, v[176:179] offset:2048
    v_mfma_f32_16x16x32_bf16 a[148:151], a[156:159], v[168:171], a[148:151]
    v_fma_f32 v193, v193, s52, -v45
    v_fma_f32 v200, v200, s52, -v46
    v_mfma_f32_16x16x32_bf16 a[152:155], a[156:159], v[176:179], a[152:155]
    v_fma_f32 v201, v201, s52, -v46
    v_exp_f32 v184, v184
    v_exp_f32 v185, v185
    v_fma_f32 v186, v186, s52, -v44
    v_fma_f32 v187, v187, s52, -v44
    v_exp_f32 v192, v192
    v_exp_f32 v193, v193
    v_fma_f32 v194, v194, s52, -v45
    v_fma_f32 v195, v195, s52, -v45
    v_exp_f32 v200, v200
    v_exp_f32 v201, v201
    v_fma_f32 v202, v202, s52, -v46
    v_fma_f32 v203, v203, s52, -v46
    s_waitcnt vmcnt(6) lgkmcnt(0)
    s_barrier
    ds_read_b64_tr_b16 a[160:161], v13 offset:24576
    ds_read_b64_tr_b16 a[162:163], v13 offset:30720
    ds_read_b64_tr_b16 a[164:165], v14 offset:24576
    buffer_load_dwordx4 v2, s[16:19], s57 offen nt lds
    ds_read_b64_tr_b16 a[166:167], v14 offset:30720
    ds_read_b64_tr_b16 a[168:169], v15 offset:24576
    v_exp_f32 v186, v186
    ds_read_b64_tr_b16 a[170:171], v15 offset:30720
    ds_read_b64_tr_b16 a[172:173], v16 offset:24576
    ds_read_b64_tr_b16 a[174:175], v16 offset:30720
    v_exp_f32 v187, v187
    ds_read_b64_tr_b16 a[176:177], v13 offset:24704
    ds_read_b64_tr_b16 a[178:179], v13 offset:30848
    ds_read_b64_tr_b16 a[180:181], v14 offset:24704
    v_fma_f32 v188, v188, s52, -v44
    v_fma_f32 v189, v189, s52, -v44
    v_fma_f32 v190, v190, s52, -v44
    v_fma_f32 v191, v191, s52, -v44
    s_waitcnt lgkmcnt(9)
    v_mfma_f32_16x16x32_bf16 a[72:75], a[160:163], v[160:163], a[72:75]
    ds_read_b64_tr_b16 a[182:183], v14 offset:30848
    ds_read_b128 v[164:167], v28 offset:0
    v_mfma_f32_16x16x32_bf16 a[76:79], a[160:163], v[168:171], a[76:79]
    s_waitcnt vmcnt(6)
    buffer_load_dwordx4 v3, s[16:19], s57 offen offset:1024 nt lds
    v_mfma_f32_16x16x32_bf16 a[80:83], a[160:163], v[176:179], a[80:83]
    s_waitcnt lgkmcnt(8)
    ds_read_b64_tr_b16 a[160:161], v17 offset:24576
    ds_read_b64_tr_b16 a[162:163], v17 offset:30720
    v_mfma_f32_16x16x32_bf16 a[84:87], a[164:167], v[160:163], a[84:87]
    ds_read_b128 v[172:175], v28 offset:1024
    v_fma_f32 v196, v196, s52, -v45
    v_mfma_f32_16x16x32_bf16 a[88:91], a[164:167], v[168:171], a[88:91]
    ds_read_b128 v[180:183], v28 offset:2048
    v_fma_f32 v197, v197, s52, -v45
    v_mfma_f32_16x16x32_bf16 a[92:95], a[164:167], v[176:179], a[92:95]
    s_waitcnt lgkmcnt(6)
    ds_read_b64_tr_b16 a[164:165], v18 offset:24576
    ds_read_b64_tr_b16 a[166:167], v18 offset:30720
    v_mfma_f32_16x16x32_bf16 a[96:99], a[168:171], v[160:163], a[96:99]
    ds_read_b64_tr_b16 a[184:185], v23 offset:24576
    ds_read_b64_tr_b16 a[186:187], v23 offset:26624
    v_mfma_f32_16x16x32_bf16 a[100:103], a[168:171], v[168:171], a[100:103]
    ds_read_b64_tr_b16 a[188:189], v24 offset:24576
    ds_read_b64_tr_b16 a[190:191], v24 offset:26624
    v_mfma_f32_16x16x32_bf16 a[104:107], a[168:171], v[176:179], a[104:107]
    s_waitcnt vmcnt(6)
    buffer_load_dwordx4 v4, s[16:19], s57 offen offset:2048 nt lds
    v_mfma_f32_16x16x32_bf16 a[108:111], a[172:175], v[160:163], a[108:111]
    s_mov_b32 s57, 3305472
    ds_read_b64_tr_b16 a[168:169], v19 offset:24576
    ds_read_b64_tr_b16 a[170:171], v19 offset:30720
    v_mfma_f32_16x16x32_bf16 a[112:115], a[172:175], v[168:171], a[112:115]
    s_add_u32 m0, s51, 12288
    ds_read_b64_tr_b16 a[192:193], v23 offset:28672
    ds_read_b64_tr_b16 a[194:195], v23 offset:30720
    v_mfma_f32_16x16x32_bf16 a[116:119], a[172:175], v[176:179], a[116:119]
    ds_read_b64_tr_b16 a[172:173], v20 offset:24576
    ds_read_b64_tr_b16 a[174:175], v20 offset:30720
    v_mfma_f32_16x16x32_bf16 a[120:123], a[176:179], v[160:163], a[120:123]
    ds_read_b64_tr_b16 a[196:197], v24 offset:28672
    ds_read_b64_tr_b16 a[198:199], v24 offset:30720
    v_mfma_f32_16x16x32_bf16 a[124:127], a[176:179], v[168:171], a[124:127]
    v_exp_f32 v194, v194
    v_mfma_f32_16x16x32_bf16 a[128:131], a[176:179], v[176:179], a[128:131]
    s_waitcnt lgkmcnt(8)
    ds_read_b64_tr_b16 a[176:177], v17 offset:24704
    ds_read_b64_tr_b16 a[178:179], v17 offset:30848
    v_mfma_f32_16x16x32_bf16 a[132:135], a[180:183], v[160:163], a[132:135]
    s_waitcnt vmcnt(6)
    buffer_load_dwordx4 v2, s[16:19], s57 offen nt lds
    v_mfma_f32_16x16x32_bf16 a[136:139], a[180:183], v[168:171], a[136:139]
    v_exp_f32 v195, v195
    v_mfma_f32_16x16x32_bf16 a[140:143], a[180:183], v[176:179], a[140:143]
    ds_read_b64_tr_b16 a[180:181], v18 offset:24704
    ds_read_b64_tr_b16 a[182:183], v18 offset:30848
    v_mfma_f32_16x16x32_bf16 a[72:75], a[160:163], v[164:167], a[72:75]
    v_fma_f32 v198, v198, s52, -v45
    v_fma_f32 v199, v199, s52, -v45
    v_mfma_f32_16x16x32_bf16 a[76:79], a[160:163], v[172:175], a[76:79]
    v_exp_f32 v202, v202
    v_mfma_f32_16x16x32_bf16 a[80:83], a[160:163], v[180:183], a[80:83]
    v_exp_f32 v203, v203
    v_mfma_f32_16x16x32_bf16 a[84:87], a[164:167], v[164:167], a[84:87]
    v_fma_f32 v204, v204, s52, -v46
    v_fma_f32 v205, v205, s52, -v46
    v_mfma_f32_16x16x32_bf16 a[88:91], a[164:167], v[172:175], a[88:91]
    s_waitcnt vmcnt(6)
    buffer_load_dwordx4 v3, s[16:19], s57 offen offset:1024 nt lds
    v_mfma_f32_16x16x32_bf16 a[92:95], a[164:167], v[180:183], a[92:95]
    s_waitcnt lgkmcnt(2)
    v_fma_f32 v206, v206, s52, -v46
    v_fma_f32 v207, v207, s52, -v46
    v_mfma_f32_16x16x32_bf16 a[96:99], a[168:171], v[164:167], a[96:99]
    v_exp_f32 v188, v188
    v_mfma_f32_16x16x32_bf16 a[100:103], a[168:171], v[172:175], a[100:103]
    v_exp_f32 v189, v189
    v_mfma_f32_16x16x32_bf16 a[104:107], a[168:171], v[180:183], a[104:107]
    v_exp_f32 v190, v190
    v_mfma_f32_16x16x32_bf16 a[108:111], a[172:175], v[164:167], a[108:111]
    v_exp_f32 v191, v191
    v_mfma_f32_16x16x32_bf16 a[112:115], a[172:175], v[172:175], a[112:115]
    v_exp_f32 v196, v196
    v_mfma_f32_16x16x32_bf16 a[116:119], a[172:175], v[180:183], a[116:119]
    s_waitcnt vmcnt(6)
    buffer_load_dwordx4 v4, s[16:19], s57 offen offset:2048 nt lds
    v_mfma_f32_16x16x32_bf16 a[120:123], a[176:179], v[164:167], a[120:123]
    s_mov_b32 s57, 3317760
    v_exp_f32 v197, v197
    v_mfma_f32_16x16x32_bf16 a[124:127], a[176:179], v[172:175], a[124:127]
    s_add_u32 m0, s51, 24576
    v_exp_f32 v198, v198
    v_mfma_f32_16x16x32_bf16 a[128:131], a[176:179], v[180:183], a[128:131]
    s_waitcnt lgkmcnt(0)
    v_exp_f32 v199, v199
    v_mfma_f32_16x16x32_bf16 a[132:135], a[180:183], v[164:167], a[132:135]
    v_exp_f32 v204, v204
    v_mfma_f32_16x16x32_bf16 a[136:139], a[180:183], v[172:175], a[136:139]
    v_exp_f32 v205, v205
    v_mfma_f32_16x16x32_bf16 a[140:143], a[180:183], v[180:183], a[140:143]
    v_exp_f32 v206, v206
    v_mfma_f32_16x16x32_bf16 v[88:91], a[184:187], a[0:3], 0
    v_exp_f32 v207, v207
    v_mfma_f32_16x16x32_bf16 v[96:99], a[184:187], a[4:7], 0
    v_cvt_pk_bf16_f32 v184, v184, v185
    v_cvt_pk_bf16_f32 v192, v192, v193
    v_mfma_f32_16x16x32_bf16 v[104:107], a[184:187], a[8:11], 0
    v_cvt_pk_bf16_f32 v200, v200, v201
    v_cvt_pk_bf16_f32 v185, v186, v187
    v_mfma_f32_16x16x32_bf16 v[92:95], a[188:191], a[0:3], 0
    v_cvt_pk_bf16_f32 v193, v194, v195
    v_cvt_pk_bf16_f32 v201, v202, v203
    v_mfma_f32_16x16x32_bf16 v[100:103], a[188:191], a[4:7], 0
    v_cvt_pk_bf16_f32 v186, v188, v189
    v_cvt_pk_bf16_f32 v187, v190, v191
    v_mfma_f32_16x16x32_bf16 v[108:111], a[188:191], a[8:11], 0
    ds_write_b128 v27, v[184:187] offset:12288
    v_mfma_f32_16x16x32_bf16 v[88:91], a[192:195], a[12:15], v[88:91]
    v_cvt_pk_bf16_f32 v194, v196, v197
    v_cvt_pk_bf16_f32 v195, v198, v199
    v_mfma_f32_16x16x32_bf16 v[96:99], a[192:195], a[16:19], v[96:99]
    ds_write_b128 v27, v[192:195] offset:13312
    v_mfma_f32_16x16x32_bf16 v[104:107], a[192:195], a[20:23], v[104:107]
    v_cvt_pk_bf16_f32 v202, v204, v205
    v_cvt_pk_bf16_f32 v203, v206, v207
    v_mfma_f32_16x16x32_bf16 v[92:95], a[196:199], a[12:15], v[92:95]
    v_fma_f32 v208, v208, s52, -v44
    v_fma_f32 v209, v209, s52, -v44
    v_mfma_f32_16x16x32_bf16 v[100:103], a[196:199], a[16:19], v[100:103]
    ds_write_b128 v27, v[200:203] offset:14336
    v_mfma_f32_16x16x32_bf16 v[108:111], a[196:199], a[20:23], v[108:111]
    v_fma_f32 v216, v216, s52, -v45
    v_fma_f32 v217, v217, s52, -v45
    v_mfma_f32_16x16x32_bf16 a[144:147], a[156:159], v[184:187], a[144:147]
    ds_read_b64_tr_b16 a[200:201], v23 offset:32768
    v_fma_f32 v224, v224, s52, -v46
    v_mfma_f32_16x16x32_bf16 a[148:151], a[156:159], v[192:195], a[148:151]
    ds_read_b64_tr_b16 a[202:203], v23 offset:34816
    ds_read_b64_tr_b16 a[204:205], v24 offset:32768
    v_mfma_f32_16x16x32_bf16 a[152:155], a[156:159], v[200:203], a[152:155]
    ds_read_b64_tr_b16 a[206:207], v24 offset:34816
    ds_read_b64_tr_b16 a[184:185], v23 offset:36864
    ds_read_b64_tr_b16 a[186:187], v23 offset:38912
    v_fma_f32 v225, v225, s52, -v46
    v_exp_f32 v208, v208
    v_exp_f32 v209, v209
    v_fma_f32 v210, v210, s52, -v44
    v_fma_f32 v211, v211, s52, -v44
    v_exp_f32 v216, v216
    s_waitcnt vmcnt(6) lgkmcnt(6)
    s_barrier
    ds_read_b64_tr_b16 a[160:161], v13 offset:49152
    ds_read_b64_tr_b16 a[162:163], v13 offset:55296
    ds_read_b64_tr_b16 a[164:165], v14 offset:49152
    buffer_load_dwordx4 v2, s[16:19], s57 offen nt lds
    ds_read_b64_tr_b16 a[166:167], v14 offset:55296
    ds_read_b64_tr_b16 a[168:169], v15 offset:49152
    v_exp_f32 v217, v217
    ds_read_b64_tr_b16 a[170:171], v15 offset:55296
    ds_read_b64_tr_b16 a[172:173], v16 offset:49152
    ds_read_b64_tr_b16 a[174:175], v16 offset:55296
    v_fma_f32 v218, v218, s52, -v45
    ds_read_b64_tr_b16 a[176:177], v13 offset:49280
    ds_read_b64_tr_b16 a[178:179], v13 offset:55424
    ds_read_b64_tr_b16 a[180:181], v14 offset:49280
    v_fma_f32 v219, v219, s52, -v45
    ds_read_b64_tr_b16 a[182:183], v14 offset:55424
    ds_read_b128 v[188:191], v28 offset:12288
    s_waitcnt lgkmcnt(11)
    v_mfma_f32_16x16x32_bf16 a[72:75], a[160:163], v[184:187], a[72:75]
    ds_read_b128 v[196:199], v28 offset:13312
    v_fma_f32 v226, v226, s52, -v46
    v_mfma_f32_16x16x32_bf16 a[76:79], a[160:163], v[192:195], a[76:79]
    s_waitcnt vmcnt(6)
    buffer_load_dwordx4 v3, s[16:19], s57 offen offset:1024 nt lds
    v_mfma_f32_16x16x32_bf16 a[80:83], a[160:163], v[200:203], a[80:83]
    s_waitcnt lgkmcnt(9)
    ds_read_b64_tr_b16 a[160:161], v17 offset:49152
    ds_read_b64_tr_b16 a[162:163], v17 offset:55296
    v_mfma_f32_16x16x32_bf16 a[84:87], a[164:167], v[184:187], a[84:87]
    ds_read_b128 v[204:207], v28 offset:14336
    v_fma_f32 v227, v227, s52, -v46
    v_mfma_f32_16x16x32_bf16 a[88:91], a[164:167], v[192:195], a[88:91]
    ds_read_b64_tr_b16 a[188:189], v24 offset:36864
    ds_read_b64_tr_b16 a[190:191], v24 offset:38912
    v_mfma_f32_16x16x32_bf16 a[92:95], a[164:167], v[200:203], a[92:95]
    s_waitcnt lgkmcnt(8)
    ds_read_b64_tr_b16 a[164:165], v18 offset:49152
    ds_read_b64_tr_b16 a[166:167], v18 offset:55296
    v_mfma_f32_16x16x32_bf16 a[96:99], a[168:171], v[184:187], a[96:99]
    v_exp_f32 v224, v224
    v_mfma_f32_16x16x32_bf16 a[100:103], a[168:171], v[192:195], a[100:103]
    v_exp_f32 v225, v225
    v_mfma_f32_16x16x32_bf16 a[104:107], a[168:171], v[200:203], a[104:107]
    s_waitcnt vmcnt(6)
    buffer_load_dwordx4 v4, s[16:19], s57 offen offset:2048 nt lds
    v_mfma_f32_16x16x32_bf16 a[108:111], a[172:175], v[184:187], a[108:111]
    s_mov_b32 s57, 3330048
    ds_read_b64_tr_b16 a[168:169], v19 offset:49152
    ds_read_b64_tr_b16 a[170:171], v19 offset:55296
    v_mfma_f32_16x16x32_bf16 a[112:115], a[172:175], v[192:195], a[112:115]
    s_add_u32 m0, s51, 36864
    v_exp_f32 v210, v210
    v_mfma_f32_16x16x32_bf16 a[116:119], a[172:175], v[200:203], a[116:119]
    ds_read_b64_tr_b16 a[172:173], v20 offset:49152
    ds_read_b64_tr_b16 a[174:175], v20 offset:55296
    v_mfma_f32_16x16x32_bf16 a[120:123], a[176:179], v[184:187], a[120:123]
    v_exp_f32 v211, v211
    v_mfma_f32_16x16x32_bf16 a[124:127], a[176:179], v[192:195], a[124:127]
    v_fma_f32 v212, v212, s52, -v44
    v_fma_f32 v213, v213, s52, -v44
    v_mfma_f32_16x16x32_bf16 a[128:131], a[176:179], v[200:203], a[128:131]
    s_waitcnt lgkmcnt(4)
    ds_read_b64_tr_b16 a[176:177], v17 offset:49280
    ds_read_b64_tr_b16 a[178:179], v17 offset:55424
    v_mfma_f32_16x16x32_bf16 a[132:135], a[180:183], v[184:187], a[132:135]
    s_waitcnt vmcnt(6)
    buffer_load_dwordx4 v2, s[16:19], s57 offen nt lds
    v_mfma_f32_16x16x32_bf16 a[136:139], a[180:183], v[192:195], a[136:139]
    v_fma_f32 v214, v214, s52, -v44
    v_fma_f32 v215, v215, s52, -v44
    v_mfma_f32_16x16x32_bf16 a[140:143], a[180:183], v[200:203], a[140:143]
    ds_read_b64_tr_b16 a[180:181], v18 offset:49280
    ds_read_b64_tr_b16 a[182:183], v18 offset:55424
    v_mfma_f32_16x16x32_bf16 a[72:75], a[160:163], v[188:191], a[72:75]
    v_exp_f32 v218, v218
    v_mfma_f32_16x16x32_bf16 a[76:79], a[160:163], v[196:199], a[76:79]
    v_exp_f32 v219, v219
    v_mfma_f32_16x16x32_bf16 a[80:83], a[160:163], v[204:207], a[80:83]
    v_fma_f32 v220, v220, s52, -v45
    v_fma_f32 v221, v221, s52, -v45
    v_mfma_f32_16x16x32_bf16 a[84:87], a[164:167], v[188:191], a[84:87]
    v_fma_f32 v222, v222, s52, -v45
    v_fma_f32 v223, v223, s52, -v45
    v_mfma_f32_16x16x32_bf16 a[88:91], a[164:167], v[196:199], a[88:91]
    s_waitcnt vmcnt(6)
    buffer_load_dwordx4 v3, s[16:19], s57 offen offset:1024 nt lds
    v_mfma_f32_16x16x32_bf16 a[92:95], a[164:167], v[204:207], a[92:95]
    s_waitcnt lgkmcnt(2)
    v_exp_f32 v226, v226
    v_mfma_f32_16x16x32_bf16 a[96:99], a[168:171], v[188:191], a[96:99]
    v_exp_f32 v227, v227
    v_mfma_f32_16x16x32_bf16 a[100:103], a[168:171], v[196:199], a[100:103]
    v_fma_f32 v228, v228, s52, -v46
    v_fma_f32 v229, v229, s52, -v46
    v_mfma_f32_16x16x32_bf16 a[104:107], a[168:171], v[204:207], a[104:107]
    v_fma_f32 v230, v230, s52, -v46
    v_fma_f32 v231, v231, s52, -v46
    v_mfma_f32_16x16x32_bf16 a[108:111], a[172:175], v[188:191], a[108:111]
    v_exp_f32 v212, v212
    v_mfma_f32_16x16x32_bf16 a[112:115], a[172:175], v[196:199], a[112:115]
    v_exp_f32 v213, v213
    v_mfma_f32_16x16x32_bf16 a[116:119], a[172:175], v[204:207], a[116:119]
    s_waitcnt vmcnt(6)
    buffer_load_dwordx4 v4, s[16:19], s57 offen offset:2048 nt lds
    v_mfma_f32_16x16x32_bf16 a[120:123], a[176:179], v[188:191], a[120:123]
    s_add_u32 m0, s51, 49152
    v_exp_f32 v214, v214
    v_mfma_f32_16x16x32_bf16 a[124:127], a[176:179], v[196:199], a[124:127]
    v_exp_f32 v215, v215
    v_mfma_f32_16x16x32_bf16 a[128:131], a[176:179], v[204:207], a[128:131]
    s_waitcnt lgkmcnt(0)
    v_exp_f32 v220, v220
    v_mfma_f32_16x16x32_bf16 a[132:135], a[180:183], v[188:191], a[132:135]
    v_exp_f32 v221, v221
    v_mfma_f32_16x16x32_bf16 a[136:139], a[180:183], v[196:199], a[136:139]
    v_exp_f32 v222, v222
    v_mfma_f32_16x16x32_bf16 a[140:143], a[180:183], v[204:207], a[140:143]
    v_exp_f32 v223, v223
    v_mfma_f32_16x16x32_bf16 v[88:91], a[200:203], a[24:27], v[88:91]
    v_exp_f32 v228, v228
    v_mfma_f32_16x16x32_bf16 v[96:99], a[200:203], a[28:31], v[96:99]
    v_exp_f32 v229, v229
    v_mfma_f32_16x16x32_bf16 v[104:107], a[200:203], a[32:35], v[104:107]
    v_exp_f32 v230, v230
    v_mfma_f32_16x16x32_bf16 v[92:95], a[204:207], a[24:27], v[92:95]
    v_exp_f32 v231, v231
    v_mfma_f32_16x16x32_bf16 v[100:103], a[204:207], a[28:31], v[100:103]
    v_cvt_pk_bf16_f32 v208, v208, v209
    v_cvt_pk_bf16_f32 v216, v216, v217
    v_mfma_f32_16x16x32_bf16 v[108:111], a[204:207], a[32:35], v[108:111]
    v_cvt_pk_bf16_f32 v224, v224, v225
    v_cvt_pk_bf16_f32 v209, v210, v211
    v_mfma_f32_16x16x32_bf16 v[88:91], a[184:187], a[36:39], v[88:91]
    v_cvt_pk_bf16_f32 v217, v218, v219
    v_cvt_pk_bf16_f32 v225, v226, v227
    v_mfma_f32_16x16x32_bf16 v[96:99], a[184:187], a[40:43], v[96:99]
    v_cvt_pk_bf16_f32 v210, v212, v213
    v_cvt_pk_bf16_f32 v211, v214, v215
    v_mfma_f32_16x16x32_bf16 v[104:107], a[184:187], a[44:47], v[104:107]
    ds_write_b128 v27, v[208:211] offset:0
    v_mfma_f32_16x16x32_bf16 v[92:95], a[188:191], a[36:39], v[92:95]
    v_cvt_pk_bf16_f32 v218, v220, v221
    v_cvt_pk_bf16_f32 v219, v222, v223
    v_mfma_f32_16x16x32_bf16 v[100:103], a[188:191], a[40:43], v[100:103]
    ds_write_b128 v27, v[216:219] offset:1024
    v_mfma_f32_16x16x32_bf16 v[108:111], a[188:191], a[44:47], v[108:111]
    v_cvt_pk_bf16_f32 v226, v228, v229
    v_cvt_pk_bf16_f32 v227, v230, v231
    v_mfma_f32_16x16x32_bf16 a[144:147], a[156:159], v[208:211], a[144:147]
    s_sub_u32 s57, s45, 1280
    s_cselect_b32 s45, s45, s57
    s_add_u32 s57, s45, 0
    v_mfma_f32_16x16x32_bf16 a[148:151], a[156:159], v[216:219], a[148:151]
    ds_write_b128 v27, v[224:227] offset:2048
    v_mfma_f32_16x16x32_bf16 a[152:155], a[156:159], v[224:227], a[152:155]
    buffer_load_dword v55, v62, s[24:27], s66 offen
    v_fma_f32 v232, v232, s52, -v44
    v_fma_f32 v233, v233, s52, -v44
    ds_read_b64_tr_b16 a[192:193], v23 offset:40960
    ds_read_b64_tr_b16 a[194:195], v23 offset:43008
    ds_read_b64_tr_b16 a[196:197], v24 offset:40960
    v_exp_f32 v232, v232
    ds_read_b64_tr_b16 a[198:199], v24 offset:43008
    ds_read_b64_tr_b16 a[200:201], v23 offset:45056
    ds_read_b64_tr_b16 a[202:203], v23 offset:47104
    v_exp_f32 v233, v233
    ds_read_b64_tr_b16 a[204:205], v24 offset:45056
    ds_read_b64_tr_b16 a[206:207], v24 offset:47104
    v_fma_f32 v234, v234, s52, -v44
    s_waitcnt vmcnt(7) lgkmcnt(8)
    s_barrier
    ds_read_b64_tr_b16 a[160:161], v13 offset:0
    ds_read_b64_tr_b16 a[162:163], v13 offset:6144
    ds_read_b64_tr_b16 a[164:165], v14 offset:0
    buffer_load_dwordx4 v8, s[24:27], s57 offen lds
    ds_read_b64_tr_b16 a[166:167], v14 offset:6144
    ds_read_b64_tr_b16 a[168:169], v15 offset:0
    v_fma_f32 v235, v235, s52, -v44
    ds_read_b64_tr_b16 a[170:171], v15 offset:6144
    ds_read_b64_tr_b16 a[172:173], v16 offset:0
    ds_read_b64_tr_b16 a[174:175], v16 offset:6144
    v_exp_f32 v234, v234
    ds_read_b64_tr_b16 a[176:177], v13 offset:128
    ds_read_b64_tr_b16 a[178:179], v13 offset:6272
    ds_read_b64_tr_b16 a[180:181], v14 offset:128
    v_exp_f32 v235, v235
    v_fma_f32 v236, v236, s52, -v44
    v_fma_f32 v237, v237, s52, -v44
    v_fma_f32 v238, v238, s52, -v44
    s_waitcnt lgkmcnt(9)
    v_mfma_f32_16x16x32_bf16 a[72:75], a[160:163], v[208:211], a[72:75]
    s_sub_u32 s66, s64, 0
    ds_read_b64_tr_b16 a[182:183], v14 offset:6272
    ds_read_b128 v[212:215], v28 offset:0
    v_mfma_f32_16x16x32_bf16 a[76:79], a[160:163], v[216:219], a[76:79]
    buffer_load_dwordx4 v9, s[24:27], s57 offen offset:1024 lds
    v_mfma_f32_16x16x32_bf16 a[80:83], a[160:163], v[224:227], a[80:83]
    s_waitcnt lgkmcnt(7)
    ds_read_b64_tr_b16 a[160:161], v17 offset:0
    ds_read_b64_tr_b16 a[162:163], v17 offset:6144
    v_mfma_f32_16x16x32_bf16 a[84:87], a[164:167], v[208:211], a[84:87]
    ds_read_b128 v[220:223], v28 offset:1024
    v_fma_f32 v239, v239, s52, -v44
    v_mfma_f32_16x16x32_bf16 a[88:91], a[164:167], v[216:219], a[88:91]
    ds_read_b128 v[228:231], v28 offset:2048
    v_cvt_pk_bf16_f32 v232, v232, v233
    v_mfma_f32_16x16x32_bf16 a[92:95], a[164:167], v[224:227], a[92:95]
    ds_read_b64_tr_b16 a[164:165], v18 offset:0
    ds_read_b64_tr_b16 a[166:167], v18 offset:6144
    v_mfma_f32_16x16x32_bf16 a[96:99], a[168:171], v[208:211], a[96:99]
    v_exp_f32 v236, v236
    v_mfma_f32_16x16x32_bf16 a[100:103], a[168:171], v[216:219], a[100:103]
    v_exp_f32 v237, v237
    v_mfma_f32_16x16x32_bf16 a[104:107], a[168:171], v[224:227], a[104:107]
    s_waitcnt lgkmcnt(6)
    buffer_load_dwordx4 v10, s[24:27], s57 offen offset:2048 lds
    v_mfma_f32_16x16x32_bf16 a[108:111], a[172:175], v[208:211], a[108:111]
    s_add_u32 s57, s45, 122880
    ds_read_b64_tr_b16 a[168:169], v19 offset:0
    ds_read_b64_tr_b16 a[170:171], v19 offset:6144
    v_mfma_f32_16x16x32_bf16 a[112:115], a[172:175], v[216:219], a[112:115]
    s_add_u32 m0, s51, 61440
    v_exp_f32 v238, v238
    v_mfma_f32_16x16x32_bf16 a[116:119], a[172:175], v[224:227], a[116:119]
    s_add_u32 s45, s44, 0
    ds_read_b64_tr_b16 a[172:173], v20 offset:0
    ds_read_b64_tr_b16 a[174:175], v20 offset:6144
    v_mfma_f32_16x16x32_bf16 a[120:123], a[176:179], v[208:211], a[120:123]
    v_exp_f32 v239, v239
    v_mfma_f32_16x16x32_bf16 a[124:127], a[176:179], v[216:219], a[124:127]
    v_fma_f32 v240, v240, s52, -v45
    v_fma_f32 v241, v241, s52, -v45
    v_mfma_f32_16x16x32_bf16 a[128:131], a[176:179], v[224:227], a[128:131]
    ds_read_b64_tr_b16 a[176:177], v17 offset:128
    ds_read_b64_tr_b16 a[178:179], v17 offset:6272
    v_mfma_f32_16x16x32_bf16 a[132:135], a[180:183], v[208:211], a[132:135]
    buffer_load_dwordx4 v8, s[24:27], s57 offen lds
    v_mfma_f32_16x16x32_bf16 a[136:139], a[180:183], v[216:219], a[136:139]
    v_cvt_pk_bf16_f32 v233, v234, v235
    v_fma_f32 v242, v242, s52, -v45
    v_mfma_f32_16x16x32_bf16 a[140:143], a[180:183], v[224:227], a[140:143]
    s_waitcnt lgkmcnt(4)
    ds_read_b64_tr_b16 a[180:181], v18 offset:128
    ds_read_b64_tr_b16 a[182:183], v18 offset:6272
    v_mfma_f32_16x16x32_bf16 a[72:75], a[160:163], v[212:215], a[72:75]
    v_exp_f32 v240, v240
    v_mfma_f32_16x16x32_bf16 a[76:79], a[160:163], v[220:223], a[76:79]
    v_exp_f32 v241, v241
    v_mfma_f32_16x16x32_bf16 a[80:83], a[160:163], v[228:231], a[80:83]
    v_fma_f32 v243, v243, s52, -v45
    v_cvt_pk_bf16_f32 v234, v236, v237
    v_mfma_f32_16x16x32_bf16 a[84:87], a[164:167], v[212:215], a[84:87]
    v_cvt_pk_bf16_f32 v235, v238, v239
    v_fma_f32 v244, v244, s52, -v45
    v_mfma_f32_16x16x32_bf16 a[88:91], a[164:167], v[220:223], a[88:91]
    buffer_load_dwordx4 v9, s[24:27], s57 offen offset:1024 lds
    v_mfma_f32_16x16x32_bf16 a[92:95], a[164:167], v[228:231], a[92:95]
    ds_write_b128 v27, v[232:235] offset:12288
    v_mfma_f32_16x16x32_bf16 a[96:99], a[168:171], v[212:215], a[96:99]
    v_exp_f32 v242, v242
    v_mfma_f32_16x16x32_bf16 a[100:103], a[168:171], v[220:223], a[100:103]
    v_exp_f32 v243, v243
    v_mfma_f32_16x16x32_bf16 a[104:107], a[168:171], v[228:231], a[104:107]
    s_waitcnt lgkmcnt(1)
    v_fma_f32 v245, v245, s52, -v45
    v_fma_f32 v246, v246, s52, -v45
    v_mfma_f32_16x16x32_bf16 a[108:111], a[172:175], v[212:215], a[108:111]
    v_fma_f32 v247, v247, s52, -v45
    v_cvt_pk_bf16_f32 v240, v240, v241
    v_mfma_f32_16x16x32_bf16 a[112:115], a[172:175], v[220:223], a[112:115]
    buffer_load_dwordx4 v10, s[24:27], s57 offen offset:2048 lds
    v_mfma_f32_16x16x32_bf16 a[116:119], a[172:175], v[228:231], a[116:119]
    s_add_u32 m0, s51, 0
    v_exp_f32 v244, v244
    v_mfma_f32_16x16x32_bf16 a[120:123], a[176:179], v[212:215], a[120:123]
    v_exp_f32 v245, v245
    v_mfma_f32_16x16x32_bf16 a[124:127], a[176:179], v[220:223], a[124:127]
    v_exp_f32 v246, v246
    v_mfma_f32_16x16x32_bf16 a[128:131], a[176:179], v[228:231], a[128:131]
    v_exp_f32 v247, v247
    v_mfma_f32_16x16x32_bf16 a[132:135], a[180:183], v[212:215], a[132:135]
    v_fma_f32 v248, v248, s52, -v46
    v_fma_f32 v249, v249, s52, -v46
    v_mfma_f32_16x16x32_bf16 a[136:139], a[180:183], v[220:223], a[136:139]
    v_cvt_pk_bf16_f32 v241, v242, v243
    v_fma_f32 v250, v250, s52, -v46
    v_mfma_f32_16x16x32_bf16 a[140:143], a[180:183], v[228:231], a[140:143]
    v_exp_f32 v248, v248
    v_mfma_f32_16x16x32_bf16 v[88:91], a[192:195], a[48:51], v[88:91]
    v_exp_f32 v249, v249
    v_mfma_f32_16x16x32_bf16 v[96:99], a[192:195], a[52:55], v[96:99]
    v_fma_f32 v251, v251, s52, -v46
    v_cvt_pk_bf16_f32 v242, v244, v245
    v_mfma_f32_16x16x32_bf16 v[104:107], a[192:195], a[56:59], v[104:107]
    v_cvt_pk_bf16_f32 v243, v246, v247
    v_fma_f32 v252, v252, s52, -v46
    v_mfma_f32_16x16x32_bf16 v[92:95], a[196:199], a[48:51], v[92:95]
    ds_write_b128 v27, v[240:243] offset:13312
    v_mfma_f32_16x16x32_bf16 v[100:103], a[196:199], a[52:55], v[100:103]
    v_exp_f32 v250, v250
    v_mfma_f32_16x16x32_bf16 v[108:111], a[196:199], a[56:59], v[108:111]
    v_exp_f32 v251, v251
    v_mfma_f32_16x16x32_bf16 v[88:91], a[200:203], a[60:63], v[88:91]
    v_fma_f32 v253, v253, s52, -v46
    v_fma_f32 v254, v254, s52, -v46
    v_mfma_f32_16x16x32_bf16 v[96:99], a[200:203], a[64:67], v[96:99]
    v_fma_f32 v255, v255, s52, -v46
    v_cvt_pk_bf16_f32 v248, v248, v249
    v_mfma_f32_16x16x32_bf16 v[104:107], a[200:203], a[68:71], v[104:107]
    v_exp_f32 v252, v252
    v_mfma_f32_16x16x32_bf16 v[92:95], a[204:207], a[60:63], v[92:95]
    v_exp_f32 v253, v253
    v_mfma_f32_16x16x32_bf16 v[100:103], a[204:207], a[64:67], v[100:103]
    v_exp_f32 v254, v254
    v_mfma_f32_16x16x32_bf16 v[108:111], a[204:207], a[68:71], v[108:111]
    v_exp_f32 v255, v255
    v_mfma_f32_16x16x32_bf16 a[144:147], a[156:159], v[232:235], a[144:147]
    v_cvt_pk_bf16_f32 v249, v250, v251
    v_cvt_pk_bf16_f32 v250, v252, v253
    v_mfma_f32_16x16x32_bf16 a[148:151], a[156:159], v[240:243], a[148:151]
    v_cvt_pk_bf16_f32 v251, v254, v255
    s_sub_u32 s57, s45, 1280
    s_cselect_b32 s45, s45, s57
    v_mfma_f32_16x16x32_bf16 a[152:155], a[156:159], v[248:251], a[152:155]
    s_add_u32 s57, s45, 3932160
    ds_write_b128 v27, v[248:251] offset:14336
    v_accvgpr_read_b32 v36, a144
    s_nop 0
    v_accvgpr_read_b32 v37, a148
    v_add_u32 v62, s23, v1
    v_add_u32 v4, s58, v47
    s_and_b32 s66, s66, 15
    s_cselect_b64 s[6:7], 0, -1
    v_accvgpr_read_b32 v38, a152
    ds_write_b128 v31, v[36:39]
    s_mul_i32 s66, s66, 122880
    s_add_u32 s66, s66, 0
    s_waitcnt vmcnt(7) lgkmcnt(0)
    s_barrier
    ds_read_b64_tr_b16 a[160:161], v13 offset:24576
    ds_read_b64_tr_b16 a[162:163], v13 offset:30720
    ds_read_b128 v[236:239], v28 offset:12288
    buffer_load_dwordx4 v8, s[24:27], s57 offen lds
    ds_read_b64_tr_b16 a[164:165], v17 offset:24576
    ds_read_b64_tr_b16 a[166:167], v17 offset:30720
    ds_read_b128 v[244:247], v28 offset:13312
    buffer_load_dwordx4 v9, s[24:27], s57 offen offset:1024 lds
    ds_read_b128 v[252:255], v28 offset:14336
    ds_read_b64_tr_b16 a[168:169], v14 offset:24576
    ds_read_b64_tr_b16 a[170:171], v14 offset:30720
    buffer_load_dwordx4 v10, s[24:27], s57 offen offset:2048 lds
    ds_read_b64_tr_b16 a[172:173], v18 offset:24576
    ds_read_b64_tr_b16 a[174:175], v18 offset:30720
    s_waitcnt lgkmcnt(9)
    v_mfma_f32_16x16x32_bf16 a[72:75], a[160:163], v[232:235], a[72:75]
    s_add_u32 s57, s45, 4055040
    ds_read_b64_tr_b16 a[176:177], v15 offset:24576
    ds_read_b64_tr_b16 a[178:179], v15 offset:30720
    v_mfma_f32_16x16x32_bf16 a[76:79], a[160:163], v[240:243], a[76:79]
    s_add_u32 m0, s51, 12288
    ds_read_b64_tr_b16 a[180:181], v19 offset:24576
    ds_read_b64_tr_b16 a[182:183], v19 offset:30720
    v_mfma_f32_16x16x32_bf16 a[80:83], a[160:163], v[248:251], a[80:83]
    s_add_u32 s45, s44, 256
    buffer_load_dwordx4 v8, s[24:27], s57 offen lds
    s_waitcnt lgkmcnt(9)
    v_mfma_f32_16x16x32_bf16 a[72:75], a[164:167], v[236:239], a[72:75]
    ds_read_b64_tr_b16 a[160:161], v16 offset:24576
    ds_read_b64_tr_b16 a[162:163], v16 offset:30720
    v_mfma_f32_16x16x32_bf16 a[76:79], a[164:167], v[244:247], a[76:79]
    s_waitcnt lgkmcnt(10)
    ds_read_b128 v[40:43], v32
    v_mov_b32 v15, 0
    v_mfma_f32_16x16x32_bf16 a[80:83], a[164:167], v[252:255], a[80:83]
    s_waitcnt lgkmcnt(9)
    buffer_load_dwordx4 v9, s[24:27], s57 offen offset:1024 lds
    v_mfma_f32_16x16x32_bf16 a[84:87], a[168:171], v[232:235], a[84:87]
    ds_read_b64_tr_b16 a[164:165], v20 offset:24576
    ds_read_b64_tr_b16 a[166:167], v20 offset:30720
    v_mfma_f32_16x16x32_bf16 a[88:91], a[168:171], v[240:243], a[88:91]
    v_accvgpr_read_b32 v208, a72
    v_accvgpr_read_b32 v209, a73
    v_mfma_f32_16x16x32_bf16 a[92:95], a[168:171], v[248:251], a[92:95]
    s_waitcnt lgkmcnt(5)
    buffer_load_dwordx4 v10, s[24:27], s57 offen offset:2048 lds
    v_mfma_f32_16x16x32_bf16 a[84:87], a[172:175], v[236:239], a[84:87]
    s_add_u32 m0, s51, 73728
    ds_read_b64_tr_b16 a[168:169], v13 offset:24704
    ds_read_b64_tr_b16 a[170:171], v13 offset:30848
    v_mfma_f32_16x16x32_bf16 a[88:91], a[172:175], v[244:247], a[88:91]
    s_sub_u32 s57, s45, 1280
    s_cselect_b32 s45, s45, s57
    s_add_u32 s57, s45, 0
    v_mfma_f32_16x16x32_bf16 a[92:95], a[172:175], v[252:255], a[92:95]
    buffer_load_dwordx4 v8, s[24:27], s57 offen lds
    v_mfma_f32_16x16x32_bf16 a[96:99], a[176:179], v[232:235], a[96:99]
    ds_read_b64_tr_b16 a[172:173], v17 offset:24704
    ds_read_b64_tr_b16 a[174:175], v17 offset:30848
    v_mfma_f32_16x16x32_bf16 a[100:103], a[176:179], v[240:243], a[100:103]
    s_waitcnt lgkmcnt(4)
    v_add_f32 v52, v36, v40
    v_add_f32 v53, v37, v41
    v_mfma_f32_16x16x32_bf16 a[104:107], a[176:179], v[248:251], a[104:107]
    buffer_load_dwordx4 v9, s[24:27], s57 offen offset:1024 lds
    v_mfma_f32_16x16x32_bf16 a[96:99], a[180:183], v[236:239], a[96:99]
    ds_read_b64_tr_b16 a[176:177], v14 offset:24704
    ds_read_b64_tr_b16 a[178:179], v14 offset:30848
    v_mfma_f32_16x16x32_bf16 a[100:103], a[180:183], v[244:247], a[100:103]
    v_add_f32 v54, v38, v42
    v_accvgpr_read_b32 v216, a76
    v_mfma_f32_16x16x32_bf16 a[104:107], a[180:183], v[252:255], a[104:107]
    buffer_load_dwordx4 v10, s[24:27], s57 offen offset:2048 lds
    v_mfma_f32_16x16x32_bf16 a[108:111], a[160:163], v[232:235], a[108:111]
    s_add_u32 s57, s45, 122880
    s_add_u32 m0, s51, 86016
    ds_read_b64_tr_b16 a[180:181], v18 offset:24704
    v_mfma_f32_16x16x32_bf16 a[112:115], a[160:163], v[240:243], a[112:115]
    s_add_u32 s45, s44, 128
    ds_read_b64_tr_b16 a[182:183], v18 offset:30848
    v_accvgpr_read_b32 v217, a77
    v_mfma_f32_16x16x32_bf16 a[116:119], a[160:163], v[248:251], a[116:119]
    buffer_load_dwordx4 v8, s[24:27], s57 offen lds
    v_mfma_f32_16x16x32_bf16 a[108:111], a[164:167], v[236:239], a[108:111]
    v_rcp_f32 v52, v52
    v_mfma_f32_16x16x32_bf16 a[112:115], a[164:167], v[244:247], a[112:115]
    v_rcp_f32 v53, v53
    v_mfma_f32_16x16x32_bf16 a[116:119], a[164:167], v[252:255], a[116:119]
    s_waitcnt lgkmcnt(2)
    buffer_load_dwordx4 v9, s[24:27], s57 offen offset:1024 lds
    v_mfma_f32_16x16x32_bf16 a[120:123], a[168:171], v[232:235], a[120:123]
    v_rcp_f32 v54, v54
    v_mfma_f32_16x16x32_bf16 a[124:127], a[168:171], v[240:243], a[124:127]
    v_accvgpr_read_b32 v224, a80
    v_accvgpr_read_b32 v225, a81
    v_mfma_f32_16x16x32_bf16 a[128:131], a[168:171], v[248:251], a[128:131]
    buffer_load_dwordx4 v10, s[24:27], s57 offen offset:2048 lds
    v_mfma_f32_16x16x32_bf16 a[120:123], a[172:175], v[236:239], a[120:123]
    s_add_u32 m0, s51, 24576
    v_mul_f32 v208, v52, v208
    v_mul_f32 v209, v52, v209
    v_mfma_f32_16x16x32_bf16 a[124:127], a[172:175], v[244:247], a[124:127]
    v_accvgpr_read_b32 v210, a74
    v_accvgpr_read_b32 v211, a75
    v_mfma_f32_16x16x32_bf16 a[128:131], a[172:175], v[252:255], a[128:131]
    v_mul_f32 v216, v53, v216
    v_mul_f32 v217, v53, v217
    v_mfma_f32_16x16x32_bf16 a[132:135], a[176:179], v[232:235], a[132:135]
    v_accvgpr_read_b32 v218, a78
    v_accvgpr_read_b32 v219, a79
    v_mfma_f32_16x16x32_bf16 a[136:139], a[176:179], v[240:243], a[136:139]
    v_mul_f32 v224, v54, v224
    v_mul_f32 v225, v54, v225
    v_mfma_f32_16x16x32_bf16 a[140:143], a[176:179], v[248:251], a[140:143]
    s_waitcnt lgkmcnt(0)
    v_accvgpr_read_b32 v226, a82
    v_accvgpr_read_b32 v227, a83
    v_mfma_f32_16x16x32_bf16 a[132:135], a[180:183], v[236:239], a[132:135]
    v_mul_f32 v210, v52, v210
    v_mul_f32 v211, v52, v211
    v_mfma_f32_16x16x32_bf16 a[136:139], a[180:183], v[244:247], a[136:139]
    v_accvgpr_read_b32 v212, a84
    v_accvgpr_read_b32 v213, a85
    v_mfma_f32_16x16x32_bf16 a[140:143], a[180:183], v[252:255], a[140:143]
    v_accvgpr_read_b32 v214, a86
    v_accvgpr_read_b32 v215, a87
    v_cvt_pk_bf16_f32 v208, v208, v209
    v_mul_f32 v218, v53, v218
    v_mul_f32 v219, v53, v219
    v_accvgpr_read_b32 v220, a88
    v_accvgpr_read_b32 v221, a89
    v_accvgpr_read_b32 v222, a90
    v_accvgpr_read_b32 v223, a91
    v_cvt_pk_bf16_f32 v216, v216, v217
    v_mul_f32 v226, v54, v226
    v_mul_f32 v227, v54, v227
    v_accvgpr_read_b32 v228, a92
    v_accvgpr_read_b32 v229, a93
    v_accvgpr_read_b32 v230, a94
    v_accvgpr_read_b32 v231, a95
    v_cvt_pk_bf16_f32 v224, v224, v225
    v_mul_f32 v212, v52, v212
    v_mul_f32 v213, v52, v213
    v_mul_f32 v214, v52, v214
    v_mul_f32 v215, v52, v215
    v_cvt_pk_bf16_f32 v209, v210, v211
    v_mul_f32 v220, v53, v220
    v_mul_f32 v221, v53, v221
    v_mul_f32 v222, v53, v222
    v_mul_f32 v223, v53, v223
    v_cvt_pk_bf16_f32 v217, v218, v219
    v_mul_f32 v228, v54, v228
    v_mul_f32 v229, v54, v229
    v_mul_f32 v230, v54, v230
    v_mul_f32 v231, v54, v231
    v_cvt_pk_bf16_f32 v225, v226, v227
    v_cvt_pk_bf16_f32 v210, v212, v213
    v_cvt_pk_bf16_f32 v211, v214, v215
    v_cvt_pk_bf16_f32 v218, v220, v221
    v_cvt_pk_bf16_f32 v219, v222, v223
    v_cvt_pk_bf16_f32 v226, v228, v229
    v_cvt_pk_bf16_f32 v227, v230, v231
    v_accvgpr_read_b32 v232, a96
    v_accvgpr_read_b32 v233, a97
    v_accvgpr_read_b32 v240, a100
    v_accvgpr_read_b32 v241, a101
    v_accvgpr_read_b32 v248, a104
    v_accvgpr_read_b32 v249, a105
    v_mul_f32 v232, v52, v232
    v_mul_f32 v233, v52, v233
    v_accvgpr_read_b32 v234, a98
    v_accvgpr_read_b32 v235, a99
    v_mul_f32 v240, v53, v240
    v_mul_f32 v241, v53, v241
    v_accvgpr_read_b32 v242, a102
    v_accvgpr_read_b32 v243, a103
    v_mul_f32 v248, v54, v248
    v_mul_f32 v249, v54, v249
    v_accvgpr_read_b32 v250, a106
    v_accvgpr_read_b32 v251, a107
    v_mul_f32 v234, v52, v234
    v_mul_f32 v235, v52, v235
    v_accvgpr_read_b32 v236, a108
    v_accvgpr_read_b32 v237, a109
    v_accvgpr_read_b32 v238, a110
    v_accvgpr_read_b32 v239, a111
    v_cvt_pk_bf16_f32 v232, v232, v233
    v_mul_f32 v242, v53, v242
    v_mul_f32 v243, v53, v243
    v_accvgpr_read_b32 v244, a112
    v_accvgpr_read_b32 v245, a113
    v_accvgpr_read_b32 v246, a114
    v_accvgpr_read_b32 v247, a115
    v_cvt_pk_bf16_f32 v240, v240, v241
    v_mul_f32 v250, v54, v250
    v_mul_f32 v251, v54, v251
    v_accvgpr_read_b32 v252, a116
    v_accvgpr_read_b32 v253, a117
    v_accvgpr_read_b32 v254, a118
    v_accvgpr_read_b32 v255, a119
    v_cvt_pk_bf16_f32 v248, v248, v249
    v_accvgpr_read_b32 v212, a132
    v_accvgpr_read_b32 v213, a133
    v_accvgpr_read_b32 v214, a134
    v_accvgpr_read_b32 v215, a135
    v_accvgpr_read_b32 v220, a136
    v_accvgpr_read_b32 v221, a137
    v_accvgpr_read_b32 v222, a138
    v_accvgpr_read_b32 v223, a139
    v_accvgpr_read_b32 v228, a140
    v_accvgpr_read_b32 v229, a141
    v_accvgpr_read_b32 v230, a142
    v_accvgpr_read_b32 v231, a143
    v_mul_f32 v236, v52, v236
    v_mul_f32 v237, v52, v237
    v_mul_f32 v238, v52, v238
    v_mul_f32 v239, v52, v239
    v_cvt_pk_bf16_f32 v233, v234, v235
    v_mul_f32 v244, v53, v244
    v_mul_f32 v245, v53, v245
    v_mul_f32 v246, v53, v246
    v_mul_f32 v247, v53, v247
    v_cvt_pk_bf16_f32 v241, v242, v243
    v_mul_f32 v252, v54, v252
    v_mul_f32 v253, v54, v253
    v_mul_f32 v254, v54, v254
    v_mul_f32 v255, v54, v255
    v_cvt_pk_bf16_f32 v249, v250, v251
    v_mul_f32 v212, v52, v212
    v_mul_f32 v213, v52, v213
    v_mul_f32 v214, v52, v214
    v_mul_f32 v215, v52, v215
    v_mul_f32 v220, v53, v220
    v_mul_f32 v221, v53, v221
    v_mul_f32 v222, v53, v222
    v_mul_f32 v223, v53, v223
    v_mul_f32 v228, v54, v228
    v_mul_f32 v229, v54, v229
    v_mul_f32 v230, v54, v230
    v_mul_f32 v231, v54, v231
    v_cvt_pk_bf16_f32 v234, v236, v237
    v_cvt_pk_bf16_f32 v235, v238, v239
    v_cvt_pk_bf16_f32 v242, v244, v245
    v_cvt_pk_bf16_f32 v243, v246, v247
    v_cvt_pk_bf16_f32 v250, v252, v253
    v_cvt_pk_bf16_f32 v251, v254, v255
    ds_write_b128 v33, v[208:211] offset:0
    v_accvgpr_read_b32 v208, a120
    v_accvgpr_read_b32 v209, a121
    v_mul_f32 v208, v52, v208
    v_mul_f32 v209, v52, v209
    v_accvgpr_read_b32 v210, a122
    v_accvgpr_read_b32 v211, a123
    v_mul_f32 v210, v52, v210
    v_mul_f32 v211, v52, v211
    v_cvt_pk_bf16_f32 v208, v208, v209
    v_cvt_pk_bf16_f32 v209, v210, v211
    v_cvt_pk_bf16_f32 v210, v212, v213
    v_cvt_pk_bf16_f32 v211, v214, v215
    ds_write_b128 v33, v[216:219] offset:1024
    v_accvgpr_read_b32 v216, a124
    v_accvgpr_read_b32 v217, a125
    v_mul_f32 v216, v53, v216
    v_mul_f32 v217, v53, v217
    v_accvgpr_read_b32 v218, a126
    v_accvgpr_read_b32 v219, a127
    v_mul_f32 v218, v53, v218
    v_mul_f32 v219, v53, v219
    v_cvt_pk_bf16_f32 v216, v216, v217
    v_cvt_pk_bf16_f32 v217, v218, v219
    v_cvt_pk_bf16_f32 v218, v220, v221
    v_cvt_pk_bf16_f32 v219, v222, v223
    ds_write_b128 v33, v[224:227] offset:2048
    v_accvgpr_read_b32 v224, a128
    v_accvgpr_read_b32 v225, a129
    v_mul_f32 v224, v54, v224
    v_mul_f32 v225, v54, v225
    v_accvgpr_read_b32 v226, a130
    v_accvgpr_read_b32 v227, a131
    v_mul_f32 v226, v54, v226
    v_mul_f32 v227, v54, v227
    v_cvt_pk_bf16_f32 v224, v224, v225
    v_cvt_pk_bf16_f32 v225, v226, v227
    v_cvt_pk_bf16_f32 v226, v228, v229
    v_cvt_pk_bf16_f32 v227, v230, v231
    ds_write_b128 v33, v[232:235] offset:6144
    s_sub_u32 s57, s45, 1280
    s_cselect_b32 s45, s45, s57
    s_add_u32 s57, s45, 3932160
    v_mov_b32 v13, 0
    v_mov_b32 v14, 0
    v_mov_b32 v16, 0
    ds_write_b128 v33, v[240:243] offset:7168
    v_mov_b32 v17, 0
    v_mov_b32 v18, 0
    v_mov_b32 v19, 0
    v_mov_b32 v20, 0x40000000
    ds_write_b128 v33, v[248:251] offset:8192
    ds_write_b128 v33, v[208:211] offset:12288
    ds_write_b128 v33, v[216:219] offset:13312
    ds_write_b128 v33, v[224:227] offset:14336
    s_waitcnt vmcnt(12) lgkmcnt(0)
    s_barrier
    ds_read_b64_tr_b16 a[184:185], v23 offset:0
    ds_read_b64_tr_b16 a[186:187], v23 offset:2048
    ds_read_b64_tr_b16 a[188:189], v24 offset:0
    buffer_load_dwordx4 v8, s[24:27], s57 offen lds
    ds_read_b64_tr_b16 a[190:191], v24 offset:2048
    ds_read_b64_tr_b16 a[192:193], v23 offset:4096
    ds_read_b64_tr_b16 a[194:195], v23 offset:6144
    ds_read_b64_tr_b16 a[196:197], v24 offset:4096
    ds_read_b64_tr_b16 a[198:199], v24 offset:6144
    buffer_load_dwordx4 v9, s[24:27], s57 offen offset:1024 lds
    ds_read_b64_tr_b16 a[200:201], v23 offset:8192
    ds_read_b64_tr_b16 a[202:203], v23 offset:10240
    ds_read_b64_tr_b16 a[204:205], v24 offset:8192
    ds_read_b64_tr_b16 a[206:207], v24 offset:10240
    buffer_load_dwordx4 v10, s[24:27], s57 offen offset:2048 lds
    s_add_u32 s57, s45, 4055040
    s_waitcnt lgkmcnt(10)
    v_mfma_f32_16x16x32_bf16 v[112:115], a[184:187], a[0:3], 0
    s_add_u32 m0, s51, 36864
    s_add_u32 s45, s44, 384
    ds_read_b128 a[72:75], v35 offset:0
    v_mfma_f32_16x16x32_bf16 v[120:123], a[184:187], a[4:7], 0
    buffer_load_dwordx4 v8, s[24:27], s57 offen lds
    v_mfma_f32_16x16x32_bf16 v[128:131], a[184:187], a[8:11], 0
    s_waitcnt lgkmcnt(7)
    ds_read_b64_tr_b16 a[184:185], v23 offset:12288
    ds_read_b64_tr_b16 a[186:187], v23 offset:14336
    v_mfma_f32_16x16x32_bf16 v[116:119], a[188:191], a[0:3], 0
    ds_read_b128 a[76:79], v35 offset:1024
    buffer_load_dwordx4 v9, s[24:27], s57 offen offset:1024 lds
    v_mfma_f32_16x16x32_bf16 v[124:127], a[188:191], a[4:7], 0
    ds_read_b128 a[80:83], v35 offset:2048
    v_mfma_f32_16x16x32_bf16 v[132:135], a[188:191], a[8:11], 0
    ds_read_b64_tr_b16 a[188:189], v24 offset:12288
    ds_read_b64_tr_b16 a[190:191], v24 offset:14336
    v_mfma_f32_16x16x32_bf16 v[112:115], a[192:195], a[12:15], v[112:115]
    buffer_load_dwordx4 v10, s[24:27], s57 offen offset:2048 lds
    v_mfma_f32_16x16x32_bf16 v[120:123], a[192:195], a[16:19], v[120:123]
    s_add_u32 m0, s51, 135168
    s_sub_u32 s57, s45, 1280
    s_cselect_b32 s45, s45, s57
    v_mfma_f32_16x16x32_bf16 v[128:131], a[192:195], a[20:23], v[128:131]
    s_add_u32 s57, s45, 0
    ds_read_b64_tr_b16 a[192:193], v23 offset:16384
    ds_read_b64_tr_b16 a[194:195], v23 offset:18432
    s_waitcnt lgkmcnt(5)
    v_mfma_f32_16x16x32_bf16 v[116:119], a[196:199], a[12:15], v[116:119]
    buffer_load_dwordx4 v8, s[24:27], s57 offen lds
    v_mfma_f32_16x16x32_bf16 v[124:127], a[196:199], a[16:19], v[124:127]
    ds_read_b128 a[84:87], v35 offset:6144
    v_mfma_f32_16x16x32_bf16 v[132:135], a[196:199], a[20:23], v[132:135]
    ds_read_b64_tr_b16 a[196:197], v24 offset:16384
    ds_read_b64_tr_b16 a[198:199], v24 offset:18432
    v_mfma_f32_16x16x32_bf16 v[112:115], a[200:203], a[24:27], v[112:115]
    buffer_load_dwordx4 v9, s[24:27], s57 offen offset:1024 lds
    v_mfma_f32_16x16x32_bf16 v[120:123], a[200:203], a[28:31], v[120:123]
    ds_read_b128 a[88:91], v35 offset:7168
    v_mfma_f32_16x16x32_bf16 v[128:131], a[200:203], a[32:35], v[128:131]
    ds_read_b128 a[92:95], v35 offset:8192
    buffer_load_dwordx4 v10, s[24:27], s57 offen offset:2048 lds
    v_mfma_f32_16x16x32_bf16 v[116:119], a[204:207], a[24:27], v[116:119]
    s_add_u32 s57, s45, 122880
    ds_read_b128 a[96:99], v35 offset:12288
    s_add_u32 m0, s51, 147456
    v_mfma_f32_16x16x32_bf16 v[124:127], a[204:207], a[28:31], v[124:127]
    s_add_u32 s45, s44, 256
    ds_read_b128 a[100:103], v35 offset:13312
    buffer_load_dwordx4 v8, s[24:27], s57 offen lds
    v_mfma_f32_16x16x32_bf16 v[132:135], a[204:207], a[32:35], v[132:135]
    ds_read_b128 a[104:107], v35 offset:14336
    v_mfma_f32_16x16x32_bf16 v[112:115], a[184:187], a[36:39], v[112:115]
    ds_read_b128 a[108:111], v35 offset:18432
    buffer_load_dwordx4 v9, s[24:27], s57 offen offset:1024 lds
    v_mfma_f32_16x16x32_bf16 v[120:123], a[184:187], a[40:43], v[120:123]
    ds_read_b128 a[112:115], v35 offset:19456
    v_mfma_f32_16x16x32_bf16 v[128:131], a[184:187], a[44:47], v[128:131]
    s_waitcnt lgkmcnt(5)
    ds_read_b128 a[116:119], v35 offset:20480
    buffer_load_dwordx4 v10, s[24:27], s57 offen offset:2048 lds
    v_mfma_f32_16x16x32_bf16 v[116:119], a[188:191], a[36:39], v[116:119]
    s_add_u32 m0, s51, 49152
    ds_read_b128 a[120:123], v35 offset:24576
    s_sub_u32 s57, s45, 1280
    s_cselect_b32 s45, s45, s57
    v_mfma_f32_16x16x32_bf16 v[124:127], a[188:191], a[40:43], v[124:127]
    s_add_u32 s57, s45, 3932160
    ds_read_b128 a[124:127], v35 offset:25600
    v_mfma_f32_16x16x32_bf16 v[132:135], a[188:191], a[44:47], v[132:135]
    ds_read_b128 a[128:131], v35 offset:26624
    v_mfma_f32_16x16x32_bf16 v[112:115], a[192:195], a[48:51], v[112:115]
    ds_read_b128 a[132:135], v35 offset:30720
    v_mfma_f32_16x16x32_bf16 v[120:123], a[192:195], a[52:55], v[120:123]
    ds_read_b128 a[136:139], v35 offset:31744
    v_mfma_f32_16x16x32_bf16 v[128:131], a[192:195], a[56:59], v[128:131]
    ds_read_b128 a[140:143], v35 offset:32768
    v_mfma_f32_16x16x32_bf16 v[116:119], a[196:199], a[48:51], v[116:119]
    ds_read_b64_tr_b16 a[200:201], v23 offset:20480
    ds_read_b64_tr_b16 a[202:203], v23 offset:22528
    v_mfma_f32_16x16x32_bf16 v[124:127], a[196:199], a[52:55], v[124:127]
    ds_read_b64_tr_b16 a[204:205], v24 offset:20480
    ds_read_b64_tr_b16 a[206:207], v24 offset:22528
    v_mfma_f32_16x16x32_bf16 v[132:135], a[196:199], a[56:59], v[132:135]
    s_waitcnt lgkmcnt(2)
    v_mfma_f32_16x16x32_bf16 v[112:115], a[200:203], a[60:63], v[112:115]
    v_mfma_f32_16x16x32_bf16 v[120:123], a[200:203], a[64:67], v[120:123]
    s_waitcnt vmcnt(18) lgkmcnt(0)
    s_barrier
    ds_read_b64_tr_b16 a[184:185], v21 offset:0
    v_mfma_f32_16x16x32_bf16 v[128:131], a[200:203], a[68:71], v[128:131]
    ds_read_b64_tr_b16 a[186:187], v21 offset:2048
    ds_read_b64_tr_b16 a[188:189], v22 offset:0
    v_mfma_f32_16x16x32_bf16 v[116:119], a[204:207], a[60:63], v[116:119]
    ds_read_b64_tr_b16 a[190:191], v22 offset:2048
    ds_read_b64_tr_b16 a[192:193], v21 offset:4096
    v_mfma_f32_16x16x32_bf16 v[124:127], a[204:207], a[64:67], v[124:127]
    ds_read_b64_tr_b16 a[194:195], v21 offset:6144
    ds_read_b64_tr_b16 a[196:197], v22 offset:4096
    v_mfma_f32_16x16x32_bf16 v[132:135], a[204:207], a[68:71], v[132:135]
    ds_read_b64_tr_b16 a[198:199], v22 offset:6144
    ds_read_b64_tr_b16 a[200:201], v21 offset:8192
    ds_read_b64_tr_b16 a[202:203], v21 offset:10240
    buffer_load_dwordx4 v8, s[24:27], s57 offen lds
    ds_read_b64_tr_b16 a[204:205], v22 offset:8192
    ds_read_b64_tr_b16 a[206:207], v22 offset:10240
    s_waitcnt lgkmcnt(10)
    v_mfma_f32_16x16x32_bf16 v[64:67], a[184:187], a[72:75], v[64:67]
    buffer_load_dwordx4 v9, s[24:27], s57 offen offset:1024 lds
    v_mfma_f32_16x16x32_bf16 v[72:75], a[184:187], a[76:79], v[72:75]
    v_mfma_f32_16x16x32_bf16 v[80:83], a[184:187], a[80:83], v[80:83]
    s_waitcnt lgkmcnt(6)
    ds_read_b64_tr_b16 a[184:185], v21 offset:12288
    ds_read_b64_tr_b16 a[186:187], v21 offset:14336
    v_mfma_f32_16x16x32_bf16 v[68:71], a[188:191], a[72:75], v[68:71]
    buffer_load_dwordx4 v10, s[24:27], s57 offen offset:2048 lds
    v_mfma_f32_16x16x32_bf16 v[76:79], a[188:191], a[76:79], v[76:79]
    s_add_u32 s57, s45, 4055040
    s_add_u32 m0, s51, 61440
    s_add_u32 s45, s44, 512
    v_mfma_f32_16x16x32_bf16 v[84:87], a[188:191], a[80:83], v[84:87]
    ds_read_b64_tr_b16 a[188:189], v22 offset:12288
    ds_read_b64_tr_b16 a[190:191], v22 offset:14336
    v_mfma_f32_16x16x32_bf16 v[64:67], a[192:195], a[84:87], v[64:67]
    buffer_load_dwordx4 v8, s[24:27], s57 offen lds
    v_mfma_f32_16x16x32_bf16 v[72:75], a[192:195], a[88:91], v[72:75]
    v_mfma_f32_16x16x32_bf16 v[80:83], a[192:195], a[92:95], v[80:83]
    s_waitcnt lgkmcnt(4)
    ds_read_b64_tr_b16 a[192:193], v21 offset:16384
    ds_read_b64_tr_b16 a[194:195], v21 offset:18432
    v_mfma_f32_16x16x32_bf16 v[68:71], a[196:199], a[84:87], v[68:71]
    buffer_load_dwordx4 v9, s[24:27], s57 offen offset:1024 lds
    v_mfma_f32_16x16x32_bf16 v[76:79], a[196:199], a[88:91], v[76:79]
    v_mfma_f32_16x16x32_bf16 v[84:87], a[196:199], a[92:95], v[84:87]
    ds_read_b64_tr_b16 a[196:197], v22 offset:16384
    ds_read_b64_tr_b16 a[198:199], v22 offset:18432
    v_mfma_f32_16x16x32_bf16 v[64:67], a[200:203], a[96:99], v[64:67]
    buffer_load_dwordx4 v10, s[24:27], s57 offen offset:2048 lds
    v_mfma_f32_16x16x32_bf16 v[72:75], a[200:203], a[100:103], v[72:75]
    s_add_u32 m0, s51, 98304
    s_sub_u32 s57, s45, 1280
    s_cselect_b32 s45, s45, s57
    v_mfma_f32_16x16x32_bf16 v[80:83], a[200:203], a[104:107], v[80:83]
    s_add_u32 s57, s45, 0
    ds_read_b64_tr_b16 a[200:201], v21 offset:20480
    ds_read_b64_tr_b16 a[202:203], v21 offset:22528
    v_mfma_f32_16x16x32_bf16 v[68:71], a[204:207], a[96:99], v[68:71]
    buffer_load_dwordx4 v8, s[24:27], s57 offen lds
    v_mfma_f32_16x16x32_bf16 v[76:79], a[204:207], a[100:103], v[76:79]
    v_mfma_f32_16x16x32_bf16 v[84:87], a[204:207], a[104:107], v[84:87]
    s_waitcnt lgkmcnt(4)
    ds_read_b64_tr_b16 a[204:205], v22 offset:20480
    ds_read_b64_tr_b16 a[206:207], v22 offset:22528
    v_mfma_f32_16x16x32_bf16 v[64:67], a[184:187], a[108:111], v[64:67]
    buffer_load_dwordx4 v9, s[24:27], s57 offen offset:1024 lds
    v_mfma_f32_16x16x32_bf16 v[72:75], a[184:187], a[112:115], v[72:75]
    v_mfma_f32_16x16x32_bf16 v[80:83], a[184:187], a[116:119], v[80:83]
    buffer_load_dwordx4 v10, s[24:27], s57 offen offset:2048 lds
    v_mfma_f32_16x16x32_bf16 v[68:71], a[188:191], a[108:111], v[68:71]
    s_add_u32 s57, s45, 122880
    s_add_u32 m0, s51, 110592
    s_add_u32 s45, s44, 384
    v_mfma_f32_16x16x32_bf16 v[76:79], a[188:191], a[112:115], v[76:79]
    buffer_load_dwordx4 v8, s[24:27], s57 offen lds
    v_mfma_f32_16x16x32_bf16 v[84:87], a[188:191], a[116:119], v[84:87]
    v_mfma_f32_16x16x32_bf16 v[64:67], a[192:195], a[120:123], v[64:67]
    buffer_load_dwordx4 v9, s[24:27], s57 offen offset:1024 lds
    v_mfma_f32_16x16x32_bf16 v[72:75], a[192:195], a[124:127], v[72:75]
    v_mfma_f32_16x16x32_bf16 v[80:83], a[192:195], a[128:131], v[80:83]
    s_waitcnt lgkmcnt(0)
    buffer_load_dwordx4 v10, s[24:27], s57 offen offset:2048 lds
    v_mfma_f32_16x16x32_bf16 v[68:71], a[196:199], a[120:123], v[68:71]
    s_add_u32 m0, s51, 0
    s_waitcnt vmcnt(24)
    s_barrier
    v_mfma_f32_16x16x32_bf16 v[76:79], a[196:199], a[124:127], v[76:79]
    ds_read_b64_tr_b16 a[184:185], v23 offset:24576
    ds_read_b64_tr_b16 a[186:187], v23 offset:26624
    v_mfma_f32_16x16x32_bf16 v[84:87], a[196:199], a[128:131], v[84:87]
    ds_read_b64_tr_b16 a[188:189], v24 offset:24576
    ds_read_b64_tr_b16 a[190:191], v24 offset:26624
    v_mfma_f32_16x16x32_bf16 v[64:67], a[200:203], a[132:135], v[64:67]
    ds_read_b64_tr_b16 a[192:193], v23 offset:28672
    ds_read_b64_tr_b16 a[194:195], v23 offset:30720
    v_mfma_f32_16x16x32_bf16 v[72:75], a[200:203], a[136:139], v[72:75]
    ds_read_b64_tr_b16 a[196:197], v24 offset:28672
    ds_read_b64_tr_b16 a[198:199], v24 offset:30720
    v_mfma_f32_16x16x32_bf16 v[80:83], a[200:203], a[140:143], v[80:83]
    ds_read_b64_tr_b16 a[200:201], v23 offset:32768
    ds_read_b64_tr_b16 a[202:203], v23 offset:34816
    v_mfma_f32_16x16x32_bf16 v[68:71], a[204:207], a[132:135], v[68:71]
    v_cvt_pk_bf16_f32 v64, v64, v65
    v_cvt_pk_bf16_f32 v65, v66, v67
    v_mfma_f32_16x16x32_bf16 v[76:79], a[204:207], a[136:139], v[76:79]
    v_cndmask_b32 v12, v12, v64, s[6:7]
    v_cndmask_b32 v13, v13, v65, s[6:7]
    v_mfma_f32_16x16x32_bf16 v[84:87], a[204:207], a[140:143], v[84:87]
    s_waitcnt lgkmcnt(8)
    ds_read_b64_tr_b16 a[204:205], v24 offset:32768
    ds_read_b64_tr_b16 a[206:207], v24 offset:34816
    v_mfma_f32_16x16x32_bf16 v[136:139], a[184:187], a[0:3], 0
    v_cvt_pk_bf16_f32 v66, v68, v69
    v_cvt_pk_bf16_f32 v67, v70, v71
    v_mfma_f32_16x16x32_bf16 v[144:147], a[184:187], a[4:7], 0
    v_cndmask_b32 v68, v5, v20, s[6:7]
    v_cndmask_b32 v14, v14, v66, s[6:7]
    v_mfma_f32_16x16x32_bf16 v[152:155], a[184:187], a[8:11], 0
    s_waitcnt lgkmcnt(4)
    buffer_store_dwordx4 v[64:67], v68, s[32:35], s66 offen sc1
    v_mfma_f32_16x16x32_bf16 v[140:143], a[188:191], a[0:3], 0
    s_nop 0
    s_sub_u32 s66, s64, 1
    ds_read_b64_tr_b16 a[184:185], v23 offset:36864
    ds_read_b64_tr_b16 a[186:187], v23 offset:38912
    v_mfma_f32_16x16x32_bf16 v[148:151], a[188:191], a[4:7], 0
    v_cndmask_b32 v15, v15, v67, s[6:7]
    v_cvt_pk_bf16_f32 v72, v72, v73
    v_mfma_f32_16x16x32_bf16 v[156:159], a[188:191], a[8:11], 0
    ds_read_b64_tr_b16 a[188:189], v24 offset:36864
    ds_read_b64_tr_b16 a[190:191], v24 offset:38912
    v_mfma_f32_16x16x32_bf16 v[136:139], a[192:195], a[12:15], v[136:139]
    s_and_b32 s66, s66, 15
    s_cselect_b64 s[6:7], 0, -1
    v_cvt_pk_bf16_f32 v73, v74, v75
    v_mfma_f32_16x16x32_bf16 v[144:147], a[192:195], a[16:19], v[144:147]
    s_mul_i32 s66, s66, 122880
    v_cvt_pk_bf16_f32 v74, v76, v77
    v_cvt_pk_bf16_f32 v75, v78, v79
    v_mfma_f32_16x16x32_bf16 v[152:155], a[192:195], a[20:23], v[152:155]
    s_add_u32 s66, s66, 1024
    v_cndmask_b32 v76, v5, v20, s[6:7]
    v_cndmask_b32 v12, v12, v72, s[6:7]
    v_mfma_f32_16x16x32_bf16 v[140:143], a[196:199], a[12:15], v[140:143]
    buffer_store_dwordx4 v[72:75], v76, s[32:35], s66 offen sc1
    v_mfma_f32_16x16x32_bf16 v[148:151], a[196:199], a[16:19], v[148:151]
    s_nop 0
    s_sub_u32 s66, s64, 2
    v_cndmask_b32 v13, v13, v73, s[6:7]
    v_cndmask_b32 v14, v14, v74, s[6:7]
    v_mfma_f32_16x16x32_bf16 v[156:159], a[196:199], a[20:23], v[156:159]
    s_waitcnt lgkmcnt(1)
    v_cndmask_b32 v15, v15, v75, s[6:7]
    v_cvt_pk_bf16_f32 v80, v80, v81
    v_mfma_f32_16x16x32_bf16 v[136:139], a[200:203], a[24:27], v[136:139]
    s_and_b32 s66, s66, 15
    s_cselect_b64 s[6:7], 0, -1
    v_cvt_pk_bf16_f32 v81, v82, v83
    v_mfma_f32_16x16x32_bf16 v[144:147], a[200:203], a[28:31], v[144:147]
    s_mul_i32 s66, s66, 122880
    v_cvt_pk_bf16_f32 v82, v84, v85
    v_cvt_pk_bf16_f32 v83, v86, v87
    v_mfma_f32_16x16x32_bf16 v[152:155], a[200:203], a[32:35], v[152:155]
    s_add_u32 s66, s66, 2048
    ds_read_b64_tr_b16 a[192:193], v23 offset:40960
    ds_read_b64_tr_b16 a[194:195], v23 offset:43008
    v_mfma_f32_16x16x32_bf16 v[140:143], a[204:207], a[24:27], v[140:143]
    v_cndmask_b32 v84, v5, v20, s[6:7]
    v_cndmask_b32 v12, v12, v80, s[6:7]
    v_mfma_f32_16x16x32_bf16 v[148:151], a[204:207], a[28:31], v[148:151]
    buffer_store_dwordx4 v[80:83], v84, s[32:35], s66 offen sc1
    v_mfma_f32_16x16x32_bf16 v[156:159], a[204:207], a[32:35], v[156:159]
    s_nop 0
    s_sub_u32 s66, s64, 3
    v_cndmask_b32 v13, v13, v81, s[6:7]
    v_cndmask_b32 v14, v14, v82, s[6:7]
    v_mfma_f32_16x16x32_bf16 v[136:139], a[184:187], a[36:39], v[136:139]
    v_cndmask_b32 v15, v15, v83, s[6:7]
    s_sub_u32 s57, s45, 1280
    s_cselect_b32 s45, s45, s57
    v_mfma_f32_16x16x32_bf16 v[144:147], a[184:187], a[40:43], v[144:147]
    s_add_u32 s57, s45, 3932160
    ds_read_b64_tr_b16 a[196:197], v24 offset:40960
    ds_read_b64_tr_b16 a[198:199], v24 offset:43008
    v_mfma_f32_16x16x32_bf16 v[152:155], a[184:187], a[44:47], v[152:155]
    s_waitcnt lgkmcnt(3)
    buffer_load_dwordx4 v8, s[24:27], s57 offen lds
    v_mfma_f32_16x16x32_bf16 v[140:143], a[188:191], a[36:39], v[140:143]
    ds_read_b64_tr_b16 a[200:201], v23 offset:45056
    ds_read_b64_tr_b16 a[202:203], v23 offset:47104
    v_mfma_f32_16x16x32_bf16 v[148:151], a[188:191], a[40:43], v[148:151]
    ds_read_b64_tr_b16 a[204:205], v24 offset:45056
    ds_read_b64_tr_b16 a[206:207], v24 offset:47104
    v_mfma_f32_16x16x32_bf16 v[156:159], a[188:191], a[44:47], v[156:159]
    s_and_b32 s66, s66, 15
    s_cselect_b64 s[6:7], 0, -1
    s_mul_i32 s66, s66, 122880
    s_waitcnt lgkmcnt(6)
    v_mfma_f32_16x16x32_bf16 v[136:139], a[192:195], a[48:51], v[136:139]
    s_add_u32 s66, s66, 12288
    v_mfma_f32_16x16x32_bf16 v[144:147], a[192:195], a[52:55], v[144:147]
    buffer_load_dwordx4 v9, s[24:27], s57 offen offset:1024 lds
    v_mfma_f32_16x16x32_bf16 v[152:155], a[192:195], a[56:59], v[152:155]
    s_waitcnt lgkmcnt(4)
    v_mfma_f32_16x16x32_bf16 v[140:143], a[196:199], a[48:51], v[140:143]
    v_mfma_f32_16x16x32_bf16 v[148:151], a[196:199], a[52:55], v[148:151]
    v_mfma_f32_16x16x32_bf16 v[156:159], a[196:199], a[56:59], v[156:159]
    s_waitcnt lgkmcnt(0)
    v_mfma_f32_16x16x32_bf16 v[136:139], a[200:203], a[60:63], v[136:139]
    buffer_load_dwordx4 v10, s[24:27], s57 offen offset:2048 lds
    v_mfma_f32_16x16x32_bf16 v[144:147], a[200:203], a[64:67], v[144:147]
    s_add_u32 s57, s45, 4055040
    s_add_u32 m0, s51, 12288
    s_add_u32 s45, s44, 768
    v_mfma_f32_16x16x32_bf16 v[152:155], a[200:203], a[68:71], v[152:155]
    v_mfma_f32_16x16x32_bf16 v[140:143], a[204:207], a[60:63], v[140:143]
    v_mfma_f32_16x16x32_bf16 v[148:151], a[204:207], a[64:67], v[148:151]
    v_mfma_f32_16x16x32_bf16 v[156:159], a[204:207], a[68:71], v[156:159]
    buffer_load_dwordx4 v8, s[24:27], s57 offen lds
    buffer_load_dwordx4 v9, s[24:27], s57 offen offset:1024 lds
    buffer_load_dwordx4 v10, s[24:27], s57 offen offset:2048 lds
    s_waitcnt vmcnt(27)
    s_barrier
    ds_read_b64_tr_b16 a[184:185], v21 offset:24576
    ds_read_b64_tr_b16 a[186:187], v21 offset:26624
    ds_read_b64_tr_b16 a[188:189], v22 offset:24576
    s_sub_u32 s57, s45, 1280
    s_cselect_b32 s45, s45, s57
    ds_read_b64_tr_b16 a[190:191], v22 offset:26624
    ds_read_b64_tr_b16 a[192:193], v21 offset:28672
    s_add_u32 s57, s45, 0
    ds_read_b64_tr_b16 a[194:195], v21 offset:30720
    s_add_u32 m0, s51, 73728
    ds_read_b64_tr_b16 a[196:197], v22 offset:28672
    ds_read_b64_tr_b16 a[198:199], v22 offset:30720
    ds_read_b64_tr_b16 a[200:201], v21 offset:32768
    buffer_load_dwordx4 v8, s[24:27], s57 offen lds
    ds_read_b64_tr_b16 a[202:203], v21 offset:34816
    ds_read_b64_tr_b16 a[204:205], v22 offset:32768
    ds_read_b64_tr_b16 a[206:207], v22 offset:34816
    s_waitcnt lgkmcnt(10)
    v_mfma_f32_16x16x32_bf16 v[112:115], a[184:187], a[72:75], v[112:115]
    v_mfma_f32_16x16x32_bf16 v[120:123], a[184:187], a[76:79], v[120:123]
    v_mfma_f32_16x16x32_bf16 v[128:131], a[184:187], a[80:83], v[128:131]
    s_waitcnt lgkmcnt(6)
    ds_read_b64_tr_b16 a[184:185], v21 offset:36864
    ds_read_b64_tr_b16 a[186:187], v21 offset:38912
    v_mfma_f32_16x16x32_bf16 v[116:119], a[188:191], a[72:75], v[116:119]
    buffer_load_dwordx4 v9, s[24:27], s57 offen offset:1024 lds
    v_mfma_f32_16x16x32_bf16 v[124:127], a[188:191], a[76:79], v[124:127]
    v_mfma_f32_16x16x32_bf16 v[132:135], a[188:191], a[80:83], v[132:135]
    ds_read_b64_tr_b16 a[188:189], v22 offset:36864
    ds_read_b64_tr_b16 a[190:191], v22 offset:38912
    v_mfma_f32_16x16x32_bf16 v[112:115], a[192:195], a[84:87], v[112:115]
    v_mfma_f32_16x16x32_bf16 v[120:123], a[192:195], a[88:91], v[120:123]
    v_mfma_f32_16x16x32_bf16 v[128:131], a[192:195], a[92:95], v[128:131]
    s_waitcnt lgkmcnt(4)
    buffer_load_dwordx4 v10, s[24:27], s57 offen offset:2048 lds
    v_mfma_f32_16x16x32_bf16 v[116:119], a[196:199], a[84:87], v[116:119]
    s_add_u32 s57, s45, 122880
    ds_read_b64_tr_b16 a[192:193], v21 offset:40960
    ds_read_b64_tr_b16 a[194:195], v21 offset:43008
    v_mfma_f32_16x16x32_bf16 v[124:127], a[196:199], a[88:91], v[124:127]
    s_add_u32 m0, s51, 86016
    s_add_u32 s45, s44, 512
    v_mfma_f32_16x16x32_bf16 v[132:135], a[196:199], a[92:95], v[132:135]
    ds_read_b64_tr_b16 a[196:197], v22 offset:40960
    ds_read_b64_tr_b16 a[198:199], v22 offset:43008
    v_mfma_f32_16x16x32_bf16 v[112:115], a[200:203], a[96:99], v[112:115]
    v_mfma_f32_16x16x32_bf16 v[120:123], a[200:203], a[100:103], v[120:123]
    buffer_load_dwordx4 v8, s[24:27], s57 offen lds
    v_mfma_f32_16x16x32_bf16 v[128:131], a[200:203], a[104:107], v[128:131]
    ds_read_b64_tr_b16 a[200:201], v21 offset:45056
    ds_read_b64_tr_b16 a[202:203], v21 offset:47104
    v_mfma_f32_16x16x32_bf16 v[116:119], a[204:207], a[96:99], v[116:119]
    v_mfma_f32_16x16x32_bf16 v[124:127], a[204:207], a[100:103], v[124:127]
    v_mfma_f32_16x16x32_bf16 v[132:135], a[204:207], a[104:107], v[132:135]
    s_waitcnt lgkmcnt(4)
    ds_read_b64_tr_b16 a[204:205], v22 offset:45056
    ds_read_b64_tr_b16 a[206:207], v22 offset:47104
    v_mfma_f32_16x16x32_bf16 v[112:115], a[184:187], a[108:111], v[112:115]
    buffer_load_dwordx4 v9, s[24:27], s57 offen offset:1024 lds
    v_mfma_f32_16x16x32_bf16 v[120:123], a[184:187], a[112:115], v[120:123]
    v_mfma_f32_16x16x32_bf16 v[128:131], a[184:187], a[116:119], v[128:131]
    v_mfma_f32_16x16x32_bf16 v[116:119], a[188:191], a[108:111], v[116:119]
    v_mfma_f32_16x16x32_bf16 v[124:127], a[188:191], a[112:115], v[124:127]
    v_mfma_f32_16x16x32_bf16 v[132:135], a[188:191], a[116:119], v[132:135]
    buffer_load_dwordx4 v10, s[24:27], s57 offen offset:2048 lds
    v_mfma_f32_16x16x32_bf16 v[112:115], a[192:195], a[120:123], v[112:115]
    s_add_u32 m0, s51, 24576
    s_waitcnt vmcnt(27) lgkmcnt(0)
    s_barrier
    v_mfma_f32_16x16x32_bf16 v[120:123], a[192:195], a[124:127], v[120:123]
    ds_read_b64_tr_b16 a[184:185], v25 offset:36864
    ds_read_b64_tr_b16 a[186:187], v25 offset:38912
    v_mfma_f32_16x16x32_bf16 v[128:131], a[192:195], a[128:131], v[128:131]
    ds_read_b64_tr_b16 a[188:189], v26 offset:36864
    ds_read_b64_tr_b16 a[190:191], v26 offset:38912
    v_mfma_f32_16x16x32_bf16 v[116:119], a[196:199], a[120:123], v[116:119]
    ds_read_b64_tr_b16 a[192:193], v25 offset:40960
    ds_read_b64_tr_b16 a[194:195], v25 offset:43008
    v_mfma_f32_16x16x32_bf16 v[124:127], a[196:199], a[124:127], v[124:127]
    s_sub_u32 s57, s45, 1280
    s_cselect_b32 s45, s45, s57
    s_add_u32 s57, s45, 3932160
    v_mfma_f32_16x16x32_bf16 v[132:135], a[196:199], a[128:131], v[132:135]
    ds_read_b64_tr_b16 a[196:197], v26 offset:40960
    ds_read_b64_tr_b16 a[198:199], v26 offset:43008
    v_mfma_f32_16x16x32_bf16 v[112:115], a[200:203], a[132:135], v[112:115]
    buffer_load_dwordx4 v8, s[24:27], s57 offen lds
    v_mfma_f32_16x16x32_bf16 v[120:123], a[200:203], a[136:139], v[120:123]
    v_mfma_f32_16x16x32_bf16 v[128:131], a[200:203], a[140:143], v[128:131]
    ds_read_b64_tr_b16 a[200:201], v25 offset:45056
    ds_read_b64_tr_b16 a[202:203], v25 offset:47104
    v_mfma_f32_16x16x32_bf16 v[116:119], a[204:207], a[132:135], v[116:119]
    s_nop 1
    v_cvt_pk_bf16_f32 v112, v112, v113
    v_cvt_pk_bf16_f32 v113, v114, v115
    v_mfma_f32_16x16x32_bf16 v[124:127], a[204:207], a[136:139], v[124:127]
    v_cndmask_b32 v12, v12, v112, s[6:7]
    v_cndmask_b32 v13, v13, v113, s[6:7]
    v_mfma_f32_16x16x32_bf16 v[132:135], a[204:207], a[140:143], v[132:135]
    s_waitcnt lgkmcnt(4)
    ds_read_b64_tr_b16 a[204:205], v26 offset:45056
    ds_read_b64_tr_b16 a[206:207], v26 offset:47104
    v_mfma_f32_16x16x32_bf16 v[160:163], a[184:187], a[0:3], 0
    buffer_load_dwordx4 v9, s[24:27], s57 offen offset:1024 lds
    v_mfma_f32_16x16x32_bf16 v[168:171], a[184:187], a[4:7], 0
    v_cvt_pk_bf16_f32 v114, v116, v117
    v_cvt_pk_bf16_f32 v115, v118, v119
    v_mfma_f32_16x16x32_bf16 v[176:179], a[184:187], a[8:11], 0
    ds_read_b64_tr_b16 a[184:185], v25 offset:49152
    ds_read_b64_tr_b16 a[186:187], v25 offset:51200
    v_mfma_f32_16x16x32_bf16 v[164:167], a[188:191], a[0:3], 0
    v_cndmask_b32 v116, v5, v20, s[6:7]
    v_cndmask_b32 v14, v14, v114, s[6:7]
    v_mfma_f32_16x16x32_bf16 v[172:175], a[188:191], a[4:7], 0
    buffer_store_dwordx4 v[112:115], v116, s[32:35], s66 offen sc1
    v_mfma_f32_16x16x32_bf16 v[180:183], a[188:191], a[8:11], 0
    s_nop 0
    s_sub_u32 s66, s64, 4
    buffer_load_dwordx4 v10, s[24:27], s57 offen offset:2048 lds
    v_mfma_f32_16x16x32_bf16 v[160:163], a[192:195], a[12:15], v[160:163]
    s_add_u32 s57, s45, 4055040
    v_cndmask_b32 v15, v15, v115, s[6:7]
    v_cvt_pk_bf16_f32 v120, v120, v121
    v_mfma_f32_16x16x32_bf16 v[168:171], a[192:195], a[16:19], v[168:171]
    s_add_u32 m0, s51, 36864
    ds_read_b64_tr_b16 a[188:189], v26 offset:49152
    ds_read_b64_tr_b16 a[190:191], v26 offset:51200
    v_mfma_f32_16x16x32_bf16 v[176:179], a[192:195], a[20:23], v[176:179]
    s_add_u32 s45, s44, 640
    s_and_b32 s66, s66, 15
    s_cselect_b64 s[6:7], 0, -1
    s_waitcnt lgkmcnt(2)
    v_mfma_f32_16x16x32_bf16 v[164:167], a[196:199], a[12:15], v[164:167]
    s_mul_i32 s66, s66, 122880
    v_cvt_pk_bf16_f32 v121, v122, v123
    v_cvt_pk_bf16_f32 v122, v124, v125
    v_mfma_f32_16x16x32_bf16 v[172:175], a[196:199], a[16:19], v[172:175]
    s_add_u32 s66, s66, 13312
    buffer_load_dwordx4 v8, s[24:27], s57 offen lds
    v_mfma_f32_16x16x32_bf16 v[180:183], a[196:199], a[20:23], v[180:183]
    v_cvt_pk_bf16_f32 v123, v126, v127
    v_cndmask_b32 v124, v5, v20, s[6:7]
    v_mfma_f32_16x16x32_bf16 v[160:163], a[200:203], a[24:27], v[160:163]
    buffer_store_dwordx4 v[120:123], v124, s[32:35], s66 offen sc1
    v_mfma_f32_16x16x32_bf16 v[168:171], a[200:203], a[28:31], v[168:171]
    s_nop 0
    s_sub_u32 s66, s64, 5
    v_cndmask_b32 v12, v12, v120, s[6:7]
    v_cndmask_b32 v13, v13, v121, s[6:7]
    v_mfma_f32_16x16x32_bf16 v[176:179], a[200:203], a[32:35], v[176:179]
    v_cndmask_b32 v14, v14, v122, s[6:7]
    v_cndmask_b32 v15, v15, v123, s[6:7]
    v_mfma_f32_16x16x32_bf16 v[164:167], a[204:207], a[24:27], v[164:167]
    buffer_load_dwordx4 v9, s[24:27], s57 offen offset:1024 lds
    v_mfma_f32_16x16x32_bf16 v[172:175], a[204:207], a[28:31], v[172:175]
    v_cvt_pk_bf16_f32 v128, v128, v129
    v_cvt_pk_bf16_f32 v129, v130, v131
    v_mfma_f32_16x16x32_bf16 v[180:183], a[204:207], a[32:35], v[180:183]
    s_and_b32 s66, s66, 15
    s_cselect_b64 s[6:7], 0, -1
    v_cvt_pk_bf16_f32 v130, v132, v133
    v_mfma_f32_16x16x32_bf16 v[160:163], a[184:187], a[36:39], v[160:163]
    s_mul_i32 s66, s66, 122880
    ds_read_b64_tr_b16 a[192:193], v25 offset:53248
    ds_read_b64_tr_b16 a[194:195], v25 offset:55296
    v_mfma_f32_16x16x32_bf16 v[168:171], a[184:187], a[40:43], v[168:171]
    s_add_u32 s66, s66, 14336
    v_cvt_pk_bf16_f32 v131, v134, v135
    v_cndmask_b32 v132, v5, v20, s[6:7]
    v_mfma_f32_16x16x32_bf16 v[176:179], a[184:187], a[44:47], v[176:179]
    s_waitcnt lgkmcnt(2)
    buffer_store_dwordx4 v[128:131], v132, s[32:35], s66 offen sc1
    v_mfma_f32_16x16x32_bf16 v[164:167], a[188:191], a[36:39], v[164:167]
    s_nop 0
    s_sub_u32 s66, s64, 6
    buffer_load_dwordx4 v10, s[24:27], s57 offen offset:2048 lds
    v_mfma_f32_16x16x32_bf16 v[172:175], a[188:191], a[40:43], v[172:175]
    s_add_u32 m0, s51, 135168
    v_cndmask_b32 v12, v12, v128, s[6:7]
    v_cndmask_b32 v13, v13, v129, s[6:7]
    v_mfma_f32_16x16x32_bf16 v[180:183], a[188:191], a[44:47], v[180:183]
    s_waitcnt lgkmcnt(1)
    v_cndmask_b32 v14, v14, v130, s[6:7]
    v_cndmask_b32 v15, v15, v131, s[6:7]
    s_sub_u32 s57, s45, 1280
    s_cselect_b32 s45, s45, s57
    s_waitcnt lgkmcnt(0)
    v_mfma_f32_16x16x32_bf16 v[160:163], a[192:195], a[48:51], v[160:163]
    s_add_u32 s57, s45, 3932160
    ds_read_b64_tr_b16 a[196:197], v26 offset:53248
    ds_read_b64_tr_b16 a[198:199], v26 offset:55296
    v_mfma_f32_16x16x32_bf16 v[168:171], a[192:195], a[52:55], v[168:171]
    ds_read_b64_tr_b16 a[200:201], v25 offset:57344
    ds_read_b64_tr_b16 a[202:203], v25 offset:59392
    v_mfma_f32_16x16x32_bf16 v[176:179], a[192:195], a[56:59], v[176:179]
    ds_read_b64_tr_b16 a[204:205], v26 offset:57344
    ds_read_b64_tr_b16 a[206:207], v26 offset:59392
    s_and_b32 s66, s66, 15
    s_cselect_b64 s[6:7], 0, -1
    s_mul_i32 s66, s66, 122880
    s_add_u32 s66, s66, 24576
    s_waitcnt lgkmcnt(4)
    v_mfma_f32_16x16x32_bf16 v[164:167], a[196:199], a[48:51], v[164:167]
    v_mfma_f32_16x16x32_bf16 v[172:175], a[196:199], a[52:55], v[172:175]
    v_mfma_f32_16x16x32_bf16 v[180:183], a[196:199], a[56:59], v[180:183]
    s_waitcnt vmcnt(30) lgkmcnt(0)
    s_barrier
    ds_read_b64_tr_b16 a[184:185], v23 offset:0
    v_mfma_f32_16x16x32_bf16 v[160:163], a[200:203], a[60:63], v[160:163]
    ds_read_b64_tr_b16 a[186:187], v23 offset:2048
    ds_read_b64_tr_b16 a[188:189], v24 offset:0
    v_mfma_f32_16x16x32_bf16 v[168:171], a[200:203], a[64:67], v[168:171]
    ds_read_b64_tr_b16 a[190:191], v24 offset:2048
    ds_read_b64_tr_b16 a[192:193], v23 offset:4096
    v_mfma_f32_16x16x32_bf16 v[176:179], a[200:203], a[68:71], v[176:179]
    ds_read_b64_tr_b16 a[194:195], v23 offset:6144
    ds_read_b64_tr_b16 a[196:197], v24 offset:4096
    v_mfma_f32_16x16x32_bf16 v[164:167], a[204:207], a[60:63], v[164:167]
    ds_read_b64_tr_b16 a[198:199], v24 offset:6144
    ds_read_b64_tr_b16 a[200:201], v23 offset:8192
    v_mfma_f32_16x16x32_bf16 v[172:175], a[204:207], a[64:67], v[172:175]
    ds_read_b64_tr_b16 a[202:203], v23 offset:10240
    buffer_load_dwordx4 v8, s[24:27], s57 offen lds
    v_mfma_f32_16x16x32_bf16 v[180:183], a[204:207], a[68:71], v[180:183]
    s_waitcnt lgkmcnt(8)
    ds_read_b64_tr_b16 a[204:205], v24 offset:8192
    ds_read_b64_tr_b16 a[206:207], v24 offset:10240
    v_mfma_f32_16x16x32_bf16 v[136:139], a[184:187], a[72:75], v[136:139]
    v_mfma_f32_16x16x32_bf16 v[144:147], a[184:187], a[76:79], v[144:147]
    v_mfma_f32_16x16x32_bf16 v[152:155], a[184:187], a[80:83], v[152:155]
    s_waitcnt lgkmcnt(6)
    ds_read_b64_tr_b16 a[184:185], v23 offset:12288
    ds_read_b64_tr_b16 a[186:187], v23 offset:14336
    v_mfma_f32_16x16x32_bf16 v[140:143], a[188:191], a[72:75], v[140:143]
    buffer_load_dwordx4 v9, s[24:27], s57 offen offset:1024 lds
    v_mfma_f32_16x16x32_bf16 v[148:151], a[188:191], a[76:79], v[148:151]
    v_mfma_f32_16x16x32_bf16 v[156:159], a[188:191], a[80:83], v[156:159]
    ds_read_b64_tr_b16 a[188:189], v24 offset:12288
    ds_read_b64_tr_b16 a[190:191], v24 offset:14336
    v_mfma_f32_16x16x32_bf16 v[136:139], a[192:195], a[84:87], v[136:139]
    v_mfma_f32_16x16x32_bf16 v[144:147], a[192:195], a[88:91], v[144:147]
    v_mfma_f32_16x16x32_bf16 v[152:155], a[192:195], a[92:95], v[152:155]
    s_waitcnt lgkmcnt(4)
    buffer_load_dwordx4 v10, s[24:27], s57 offen offset:2048 lds
    v_mfma_f32_16x16x32_bf16 v[140:143], a[196:199], a[84:87], v[140:143]
    s_add_u32 s57, s45, 4055040
    ds_read_b64_tr_b16 a[192:193], v23 offset:16384
    ds_read_b64_tr_b16 a[194:195], v23 offset:18432
    v_mfma_f32_16x16x32_bf16 v[148:151], a[196:199], a[88:91], v[148:151]
    s_add_u32 m0, s51, 147456
    s_add_u32 s45, s44, 768
    v_mfma_f32_16x16x32_bf16 v[156:159], a[196:199], a[92:95], v[156:159]
    ds_read_b64_tr_b16 a[196:197], v24 offset:16384
    ds_read_b64_tr_b16 a[198:199], v24 offset:18432
    v_mfma_f32_16x16x32_bf16 v[136:139], a[200:203], a[96:99], v[136:139]
    v_mfma_f32_16x16x32_bf16 v[144:147], a[200:203], a[100:103], v[144:147]
    buffer_load_dwordx4 v8, s[24:27], s57 offen lds
    v_mfma_f32_16x16x32_bf16 v[152:155], a[200:203], a[104:107], v[152:155]
    ds_read_b64_tr_b16 a[200:201], v23 offset:20480
    ds_read_b64_tr_b16 a[202:203], v23 offset:22528
    v_mfma_f32_16x16x32_bf16 v[140:143], a[204:207], a[96:99], v[140:143]
    v_mfma_f32_16x16x32_bf16 v[148:151], a[204:207], a[100:103], v[148:151]
    v_mfma_f32_16x16x32_bf16 v[156:159], a[204:207], a[104:107], v[156:159]
    s_waitcnt lgkmcnt(4)
    ds_read_b64_tr_b16 a[204:205], v24 offset:20480
    ds_read_b64_tr_b16 a[206:207], v24 offset:22528
    v_mfma_f32_16x16x32_bf16 v[136:139], a[184:187], a[108:111], v[136:139]
    buffer_load_dwordx4 v9, s[24:27], s57 offen offset:1024 lds
    v_mfma_f32_16x16x32_bf16 v[144:147], a[184:187], a[112:115], v[144:147]
    v_mfma_f32_16x16x32_bf16 v[152:155], a[184:187], a[116:119], v[152:155]
    v_mfma_f32_16x16x32_bf16 v[140:143], a[188:191], a[108:111], v[140:143]
    v_mfma_f32_16x16x32_bf16 v[148:151], a[188:191], a[112:115], v[148:151]
    v_mfma_f32_16x16x32_bf16 v[156:159], a[188:191], a[116:119], v[156:159]
    buffer_load_dwordx4 v10, s[24:27], s57 offen offset:2048 lds
    v_mfma_f32_16x16x32_bf16 v[136:139], a[192:195], a[120:123], v[136:139]
    s_add_u32 m0, s51, 49152
    s_waitcnt vmcnt(30) lgkmcnt(0)
    s_barrier
    v_mfma_f32_16x16x32_bf16 v[144:147], a[192:195], a[124:127], v[144:147]
    ds_read_b64_tr_b16 a[184:185], v25 offset:0
    ds_read_b64_tr_b16 a[186:187], v25 offset:2048
    v_mfma_f32_16x16x32_bf16 v[152:155], a[192:195], a[128:131], v[152:155]
    ds_read_b64_tr_b16 a[188:189], v26 offset:0
    ds_read_b64_tr_b16 a[190:191], v26 offset:2048
    v_mfma_f32_16x16x32_bf16 v[140:143], a[196:199], a[120:123], v[140:143]
    ds_read_b64_tr_b16 a[192:193], v25 offset:4096
    ds_read_b64_tr_b16 a[194:195], v25 offset:6144
    v_mfma_f32_16x16x32_bf16 v[148:151], a[196:199], a[124:127], v[148:151]
    s_sub_u32 s57, s45, 1280
    s_cselect_b32 s45, s45, s57
    s_add_u32 s57, s45, 3932160
    v_mfma_f32_16x16x32_bf16 v[156:159], a[196:199], a[128:131], v[156:159]
    ds_read_b64_tr_b16 a[196:197], v26 offset:4096
    ds_read_b64_tr_b16 a[198:199], v26 offset:6144
    v_mfma_f32_16x16x32_bf16 v[136:139], a[200:203], a[132:135], v[136:139]
    buffer_load_dwordx4 v8, s[24:27], s57 offen lds
    v_mfma_f32_16x16x32_bf16 v[144:147], a[200:203], a[136:139], v[144:147]
    v_mfma_f32_16x16x32_bf16 v[152:155], a[200:203], a[140:143], v[152:155]
    ds_read_b64_tr_b16 a[200:201], v25 offset:8192
    ds_read_b64_tr_b16 a[202:203], v25 offset:10240
    v_mfma_f32_16x16x32_bf16 v[140:143], a[204:207], a[132:135], v[140:143]
    s_nop 1
    v_cvt_pk_bf16_f32 v136, v136, v137
    v_cvt_pk_bf16_f32 v137, v138, v139
    v_mfma_f32_16x16x32_bf16 v[148:151], a[204:207], a[136:139], v[148:151]
    v_cndmask_b32 v12, v12, v136, s[6:7]
    v_cndmask_b32 v13, v13, v137, s[6:7]
    v_mfma_f32_16x16x32_bf16 v[156:159], a[204:207], a[140:143], v[156:159]
    s_waitcnt lgkmcnt(4)
    ds_read_b64_tr_b16 a[204:205], v26 offset:8192
    ds_read_b64_tr_b16 a[206:207], v26 offset:10240
    v_mfma_f32_16x16x32_bf16 v[184:187], a[184:187], a[0:3], 0
    buffer_load_dwordx4 v9, s[24:27], s57 offen offset:1024 lds
    v_mfma_f32_16x16x32_bf16 v[192:195], a[184:187], a[4:7], 0
    v_cvt_pk_bf16_f32 v138, v140, v141
    v_cvt_pk_bf16_f32 v139, v142, v143
    v_mfma_f32_16x16x32_bf16 v[200:203], a[184:187], a[8:11], 0
    ds_read_b64_tr_b16 a[184:185], v25 offset:12288
    ds_read_b64_tr_b16 a[186:187], v25 offset:14336
    v_mfma_f32_16x16x32_bf16 v[188:191], a[188:191], a[0:3], 0
    v_cndmask_b32 v140, v5, v20, s[6:7]
    v_cndmask_b32 v14, v14, v138, s[6:7]
    v_mfma_f32_16x16x32_bf16 v[196:199], a[188:191], a[4:7], 0
    buffer_store_dwordx4 v[136:139], v140, s[32:35], s66 offen sc1
    v_mfma_f32_16x16x32_bf16 v[204:207], a[188:191], a[8:11], 0
    s_nop 0
    s_sub_u32 s66, s64, 7
    buffer_load_dwordx4 v10, s[24:27], s57 offen offset:2048 lds
    v_mfma_f32_16x16x32_bf16 v[184:187], a[192:195], a[12:15], v[184:187]
    s_add_u32 s57, s45, 4055040
    v_cndmask_b32 v15, v15, v139, s[6:7]
    v_cvt_pk_bf16_f32 v144, v144, v145
    v_mfma_f32_16x16x32_bf16 v[192:195], a[192:195], a[16:19], v[192:195]
    s_add_u32 m0, s51, 61440
    ds_read_b64_tr_b16 a[188:189], v26 offset:12288
    ds_read_b64_tr_b16 a[190:191], v26 offset:14336
    v_mfma_f32_16x16x32_bf16 v[200:203], a[192:195], a[20:23], v[200:203]
    s_add_u32 s45, s44, 896
    s_and_b32 s66, s66, 15
    s_cselect_b64 s[6:7], 0, -1
    s_waitcnt lgkmcnt(2)
    v_mfma_f32_16x16x32_bf16 v[188:191], a[196:199], a[12:15], v[188:191]
    s_mul_i32 s66, s66, 122880
    v_cvt_pk_bf16_f32 v145, v146, v147
    v_cvt_pk_bf16_f32 v146, v148, v149
    v_mfma_f32_16x16x32_bf16 v[196:199], a[196:199], a[16:19], v[196:199]
    s_add_u32 s66, s66, 25600
    buffer_load_dwordx4 v8, s[24:27], s57 offen lds
    v_mfma_f32_16x16x32_bf16 v[204:207], a[196:199], a[20:23], v[204:207]
    v_cvt_pk_bf16_f32 v147, v150, v151
    v_cndmask_b32 v148, v5, v20, s[6:7]
    v_mfma_f32_16x16x32_bf16 v[184:187], a[200:203], a[24:27], v[184:187]
    buffer_store_dwordx4 v[144:147], v148, s[32:35], s66 offen sc1
    v_mfma_f32_16x16x32_bf16 v[192:195], a[200:203], a[28:31], v[192:195]
    s_nop 0
    s_sub_u32 s66, s64, 8
    v_cndmask_b32 v12, v12, v144, s[6:7]
    v_cndmask_b32 v13, v13, v145, s[6:7]
    v_mfma_f32_16x16x32_bf16 v[200:203], a[200:203], a[32:35], v[200:203]
    v_cndmask_b32 v14, v14, v146, s[6:7]
    v_cndmask_b32 v15, v15, v147, s[6:7]
    v_mfma_f32_16x16x32_bf16 v[188:191], a[204:207], a[24:27], v[188:191]
    buffer_load_dwordx4 v9, s[24:27], s57 offen offset:1024 lds
    v_mfma_f32_16x16x32_bf16 v[196:199], a[204:207], a[28:31], v[196:199]
    v_cvt_pk_bf16_f32 v152, v152, v153
    v_cvt_pk_bf16_f32 v153, v154, v155
    v_mfma_f32_16x16x32_bf16 v[204:207], a[204:207], a[32:35], v[204:207]
    s_and_b32 s66, s66, 15
    s_cselect_b64 s[6:7], 0, -1
    v_cvt_pk_bf16_f32 v154, v156, v157
    v_mfma_f32_16x16x32_bf16 v[184:187], a[184:187], a[36:39], v[184:187]
    s_mul_i32 s66, s66, 122880
    ds_read_b64_tr_b16 a[192:193], v25 offset:16384
    ds_read_b64_tr_b16 a[194:195], v25 offset:18432
    v_mfma_f32_16x16x32_bf16 v[192:195], a[184:187], a[40:43], v[192:195]
    s_add_u32 s66, s66, 26624
    v_cvt_pk_bf16_f32 v155, v158, v159
    v_cndmask_b32 v156, v5, v20, s[6:7]
    v_mfma_f32_16x16x32_bf16 v[200:203], a[184:187], a[44:47], v[200:203]
    s_waitcnt lgkmcnt(2)
    buffer_store_dwordx4 v[152:155], v156, s[32:35], s66 offen sc1
    v_mfma_f32_16x16x32_bf16 v[188:191], a[188:191], a[36:39], v[188:191]
    s_nop 0
    s_sub_u32 s66, s64, 9
    buffer_load_dwordx4 v10, s[24:27], s57 offen offset:2048 lds
    v_mfma_f32_16x16x32_bf16 v[196:199], a[188:191], a[40:43], v[196:199]
    s_add_u32 m0, s51, 98304
    v_cndmask_b32 v12, v12, v152, s[6:7]
    v_cndmask_b32 v13, v13, v153, s[6:7]
    v_mfma_f32_16x16x32_bf16 v[204:207], a[188:191], a[44:47], v[204:207]
    s_waitcnt lgkmcnt(1)
    v_cndmask_b32 v14, v14, v154, s[6:7]
    v_cndmask_b32 v15, v15, v155, s[6:7]
    s_sub_u32 s57, s45, 1280
    s_cselect_b32 s45, s45, s57
    s_waitcnt lgkmcnt(0)
    v_mfma_f32_16x16x32_bf16 v[184:187], a[192:195], a[48:51], v[184:187]
    s_add_u32 s57, s45, 3932160
    ds_read_b64_tr_b16 a[196:197], v26 offset:16384
    ds_read_b64_tr_b16 a[198:199], v26 offset:18432
    v_mfma_f32_16x16x32_bf16 v[192:195], a[192:195], a[52:55], v[192:195]
    ds_read_b64_tr_b16 a[200:201], v25 offset:20480
    ds_read_b64_tr_b16 a[202:203], v25 offset:22528
    v_mfma_f32_16x16x32_bf16 v[200:203], a[192:195], a[56:59], v[200:203]
    ds_read_b64_tr_b16 a[204:205], v26 offset:20480
    ds_read_b64_tr_b16 a[206:207], v26 offset:22528
    s_and_b32 s66, s66, 15
    s_cselect_b64 s[6:7], 0, -1
    s_mul_i32 s66, s66, 122880
    s_add_u32 s66, s66, 36864
    s_waitcnt lgkmcnt(4)
    v_mfma_f32_16x16x32_bf16 v[188:191], a[196:199], a[48:51], v[188:191]
    v_mfma_f32_16x16x32_bf16 v[196:199], a[196:199], a[52:55], v[196:199]
    v_mfma_f32_16x16x32_bf16 v[204:207], a[196:199], a[56:59], v[204:207]
    s_waitcnt vmcnt(30) lgkmcnt(0)
    s_barrier
    ds_read_b64_tr_b16 a[184:185], v21 offset:0
    v_mfma_f32_16x16x32_bf16 v[184:187], a[200:203], a[60:63], v[184:187]
    ds_read_b64_tr_b16 a[186:187], v21 offset:2048
    ds_read_b64_tr_b16 a[188:189], v22 offset:0
    v_mfma_f32_16x16x32_bf16 v[192:195], a[200:203], a[64:67], v[192:195]
    ds_read_b64_tr_b16 a[190:191], v22 offset:2048
    ds_read_b64_tr_b16 a[192:193], v21 offset:4096
    v_mfma_f32_16x16x32_bf16 v[200:203], a[200:203], a[68:71], v[200:203]
    ds_read_b64_tr_b16 a[194:195], v21 offset:6144
    ds_read_b64_tr_b16 a[196:197], v22 offset:4096
    v_mfma_f32_16x16x32_bf16 v[188:191], a[204:207], a[60:63], v[188:191]
    ds_read_b64_tr_b16 a[198:199], v22 offset:6144
    ds_read_b64_tr_b16 a[200:201], v21 offset:8192
    v_mfma_f32_16x16x32_bf16 v[196:199], a[204:207], a[64:67], v[196:199]
    ds_read_b64_tr_b16 a[202:203], v21 offset:10240
    buffer_load_dwordx4 v8, s[24:27], s57 offen lds
    v_mfma_f32_16x16x32_bf16 v[204:207], a[204:207], a[68:71], v[204:207]
    s_waitcnt lgkmcnt(8)
    ds_read_b64_tr_b16 a[204:205], v22 offset:8192
    ds_read_b64_tr_b16 a[206:207], v22 offset:10240
    v_mfma_f32_16x16x32_bf16 v[160:163], a[184:187], a[72:75], v[160:163]
    v_mfma_f32_16x16x32_bf16 v[168:171], a[184:187], a[76:79], v[168:171]
    v_mfma_f32_16x16x32_bf16 v[176:179], a[184:187], a[80:83], v[176:179]
    s_waitcnt lgkmcnt(6)
    ds_read_b64_tr_b16 a[184:185], v21 offset:12288
    ds_read_b64_tr_b16 a[186:187], v21 offset:14336
    v_mfma_f32_16x16x32_bf16 v[164:167], a[188:191], a[72:75], v[164:167]
    buffer_load_dwordx4 v9, s[24:27], s57 offen offset:1024 lds
    v_mfma_f32_16x16x32_bf16 v[172:175], a[188:191], a[76:79], v[172:175]
    v_mfma_f32_16x16x32_bf16 v[180:183], a[188:191], a[80:83], v[180:183]
    ds_read_b64_tr_b16 a[188:189], v22 offset:12288
    ds_read_b64_tr_b16 a[190:191], v22 offset:14336
    v_mfma_f32_16x16x32_bf16 v[160:163], a[192:195], a[84:87], v[160:163]
    v_mfma_f32_16x16x32_bf16 v[168:171], a[192:195], a[88:91], v[168:171]
    v_mfma_f32_16x16x32_bf16 v[176:179], a[192:195], a[92:95], v[176:179]
    s_waitcnt lgkmcnt(4)
    buffer_load_dwordx4 v10, s[24:27], s57 offen offset:2048 lds
    v_mfma_f32_16x16x32_bf16 v[164:167], a[196:199], a[84:87], v[164:167]
    s_add_u32 s57, s45, 4055040
    ds_read_b64_tr_b16 a[192:193], v21 offset:16384
    ds_read_b64_tr_b16 a[194:195], v21 offset:18432
    v_mfma_f32_16x16x32_bf16 v[172:175], a[196:199], a[88:91], v[172:175]
    s_add_u32 m0, s51, 110592
    s_add_u32 s45, s44, 1024
    v_mfma_f32_16x16x32_bf16 v[180:183], a[196:199], a[92:95], v[180:183]
    ds_read_b64_tr_b16 a[196:197], v22 offset:16384
    ds_read_b64_tr_b16 a[198:199], v22 offset:18432
    v_mfma_f32_16x16x32_bf16 v[160:163], a[200:203], a[96:99], v[160:163]
    v_mfma_f32_16x16x32_bf16 v[168:171], a[200:203], a[100:103], v[168:171]
    buffer_load_dwordx4 v8, s[24:27], s57 offen lds
    v_mfma_f32_16x16x32_bf16 v[176:179], a[200:203], a[104:107], v[176:179]
    ds_read_b64_tr_b16 a[200:201], v21 offset:20480
    ds_read_b64_tr_b16 a[202:203], v21 offset:22528
    v_mfma_f32_16x16x32_bf16 v[164:167], a[204:207], a[96:99], v[164:167]
    v_mfma_f32_16x16x32_bf16 v[172:175], a[204:207], a[100:103], v[172:175]
    v_mfma_f32_16x16x32_bf16 v[180:183], a[204:207], a[104:107], v[180:183]
    s_waitcnt lgkmcnt(4)
    ds_read_b64_tr_b16 a[204:205], v22 offset:20480
    ds_read_b64_tr_b16 a[206:207], v22 offset:22528
    v_mfma_f32_16x16x32_bf16 v[160:163], a[184:187], a[108:111], v[160:163]
    buffer_load_dwordx4 v9, s[24:27], s57 offen offset:1024 lds
    v_mfma_f32_16x16x32_bf16 v[168:171], a[184:187], a[112:115], v[168:171]
    v_mfma_f32_16x16x32_bf16 v[176:179], a[184:187], a[116:119], v[176:179]
    v_mfma_f32_16x16x32_bf16 v[164:167], a[188:191], a[108:111], v[164:167]
    v_mfma_f32_16x16x32_bf16 v[172:175], a[188:191], a[112:115], v[172:175]
    v_mfma_f32_16x16x32_bf16 v[180:183], a[188:191], a[116:119], v[180:183]
    buffer_load_dwordx4 v10, s[24:27], s57 offen offset:2048 lds
    v_mfma_f32_16x16x32_bf16 v[160:163], a[192:195], a[120:123], v[160:163]
    s_add_u32 m0, s51, 0
    s_waitcnt vmcnt(30) lgkmcnt(0)
    s_barrier
    v_mfma_f32_16x16x32_bf16 v[168:171], a[192:195], a[124:127], v[168:171]
    ds_read_b64_tr_b16 a[184:185], v23 offset:24576
    ds_read_b64_tr_b16 a[186:187], v23 offset:26624
    v_mfma_f32_16x16x32_bf16 v[176:179], a[192:195], a[128:131], v[176:179]
    ds_read_b64_tr_b16 a[188:189], v24 offset:24576
    ds_read_b64_tr_b16 a[190:191], v24 offset:26624
    v_mfma_f32_16x16x32_bf16 v[164:167], a[196:199], a[120:123], v[164:167]
    ds_read_b64_tr_b16 a[192:193], v23 offset:28672
    ds_read_b64_tr_b16 a[194:195], v23 offset:30720
    v_mfma_f32_16x16x32_bf16 v[172:175], a[196:199], a[124:127], v[172:175]
    s_sub_u32 s57, s45, 1280
    s_cselect_b32 s45, s45, s57
    s_add_u32 s57, s45, 3932160
    v_mfma_f32_16x16x32_bf16 v[180:183], a[196:199], a[128:131], v[180:183]
    ds_read_b64_tr_b16 a[196:197], v24 offset:28672
    ds_read_b64_tr_b16 a[198:199], v24 offset:30720
    v_mfma_f32_16x16x32_bf16 v[160:163], a[200:203], a[132:135], v[160:163]
    buffer_load_dwordx4 v8, s[24:27], s57 offen lds
    v_mfma_f32_16x16x32_bf16 v[168:171], a[200:203], a[136:139], v[168:171]
    v_mfma_f32_16x16x32_bf16 v[176:179], a[200:203], a[140:143], v[176:179]
    ds_read_b64_tr_b16 a[200:201], v23 offset:32768
    ds_read_b64_tr_b16 a[202:203], v23 offset:34816
    v_mfma_f32_16x16x32_bf16 v[164:167], a[204:207], a[132:135], v[164:167]
    s_nop 1
    v_cvt_pk_bf16_f32 v160, v160, v161
    v_cvt_pk_bf16_f32 v161, v162, v163
    v_mfma_f32_16x16x32_bf16 v[172:175], a[204:207], a[136:139], v[172:175]
    v_cndmask_b32 v12, v12, v160, s[6:7]
    v_cndmask_b32 v13, v13, v161, s[6:7]
    v_mfma_f32_16x16x32_bf16 v[180:183], a[204:207], a[140:143], v[180:183]
    s_waitcnt lgkmcnt(4)
    ds_read_b64_tr_b16 a[204:205], v24 offset:32768
    ds_read_b64_tr_b16 a[206:207], v24 offset:34816
    v_mfma_f32_16x16x32_bf16 v[208:211], a[184:187], a[0:3], 0
    buffer_load_dwordx4 v9, s[24:27], s57 offen offset:1024 lds
    v_mfma_f32_16x16x32_bf16 v[216:219], a[184:187], a[4:7], 0
    v_cvt_pk_bf16_f32 v162, v164, v165
    v_cvt_pk_bf16_f32 v163, v166, v167
    v_mfma_f32_16x16x32_bf16 v[224:227], a[184:187], a[8:11], 0
    ds_read_b64_tr_b16 a[184:185], v23 offset:36864
    ds_read_b64_tr_b16 a[186:187], v23 offset:38912
    v_mfma_f32_16x16x32_bf16 v[212:215], a[188:191], a[0:3], 0
    v_cndmask_b32 v164, v5, v20, s[6:7]
    v_cndmask_b32 v14, v14, v162, s[6:7]
    v_mfma_f32_16x16x32_bf16 v[220:223], a[188:191], a[4:7], 0
    buffer_store_dwordx4 v[160:163], v164, s[32:35], s66 offen sc1
    v_mfma_f32_16x16x32_bf16 v[228:231], a[188:191], a[8:11], 0
    s_nop 0
    s_sub_u32 s66, s64, 10
    buffer_load_dwordx4 v10, s[24:27], s57 offen offset:2048 lds
    v_mfma_f32_16x16x32_bf16 v[208:211], a[192:195], a[12:15], v[208:211]
    s_add_u32 s57, s45, 4055040
    v_cndmask_b32 v15, v15, v163, s[6:7]
    v_cvt_pk_bf16_f32 v168, v168, v169
    v_mfma_f32_16x16x32_bf16 v[216:219], a[192:195], a[16:19], v[216:219]
    s_add_u32 m0, s51, 12288
    ds_read_b64_tr_b16 a[188:189], v24 offset:36864
    ds_read_b64_tr_b16 a[190:191], v24 offset:38912
    v_mfma_f32_16x16x32_bf16 v[224:227], a[192:195], a[20:23], v[224:227]
    s_add_u32 s45, s44, 1152
    s_and_b32 s66, s66, 15
    s_cselect_b64 s[6:7], 0, -1
    s_waitcnt lgkmcnt(2)
    v_mfma_f32_16x16x32_bf16 v[212:215], a[196:199], a[12:15], v[212:215]
    s_mul_i32 s66, s66, 122880
    v_cvt_pk_bf16_f32 v169, v170, v171
    v_cvt_pk_bf16_f32 v170, v172, v173
    v_mfma_f32_16x16x32_bf16 v[220:223], a[196:199], a[16:19], v[220:223]
    s_add_u32 s66, s66, 37888
    buffer_load_dwordx4 v8, s[24:27], s57 offen lds
    v_mfma_f32_16x16x32_bf16 v[228:231], a[196:199], a[20:23], v[228:231]
    v_cvt_pk_bf16_f32 v171, v174, v175
    v_cndmask_b32 v172, v5, v20, s[6:7]
    v_mfma_f32_16x16x32_bf16 v[208:211], a[200:203], a[24:27], v[208:211]
    buffer_store_dwordx4 v[168:171], v172, s[32:35], s66 offen sc1
    v_mfma_f32_16x16x32_bf16 v[216:219], a[200:203], a[28:31], v[216:219]
    s_nop 0
    s_sub_u32 s66, s64, 11
    v_cndmask_b32 v12, v12, v168, s[6:7]
    v_cndmask_b32 v13, v13, v169, s[6:7]
    v_mfma_f32_16x16x32_bf16 v[224:227], a[200:203], a[32:35], v[224:227]
    v_cndmask_b32 v14, v14, v170, s[6:7]
    v_cndmask_b32 v15, v15, v171, s[6:7]
    v_mfma_f32_16x16x32_bf16 v[212:215], a[204:207], a[24:27], v[212:215]
    buffer_load_dwordx4 v9, s[24:27], s57 offen offset:1024 lds
    v_mfma_f32_16x16x32_bf16 v[220:223], a[204:207], a[28:31], v[220:223]
    v_cvt_pk_bf16_f32 v176, v176, v177
    v_cvt_pk_bf16_f32 v177, v178, v179
    v_mfma_f32_16x16x32_bf16 v[228:231], a[204:207], a[32:35], v[228:231]
    s_and_b32 s66, s66, 15
    s_cselect_b64 s[6:7], 0, -1
    v_cvt_pk_bf16_f32 v178, v180, v181
    v_mfma_f32_16x16x32_bf16 v[208:211], a[184:187], a[36:39], v[208:211]
    s_mul_i32 s66, s66, 122880
    ds_read_b64_tr_b16 a[192:193], v23 offset:40960
    ds_read_b64_tr_b16 a[194:195], v23 offset:43008
    v_mfma_f32_16x16x32_bf16 v[216:219], a[184:187], a[40:43], v[216:219]
    s_add_u32 s66, s66, 38912
    v_cvt_pk_bf16_f32 v179, v182, v183
    v_cndmask_b32 v180, v5, v20, s[6:7]
    v_mfma_f32_16x16x32_bf16 v[224:227], a[184:187], a[44:47], v[224:227]
    s_waitcnt lgkmcnt(2)
    buffer_store_dwordx4 v[176:179], v180, s[32:35], s66 offen sc1
    v_mfma_f32_16x16x32_bf16 v[212:215], a[188:191], a[36:39], v[212:215]
    s_nop 0
    s_sub_u32 s66, s64, 12
    buffer_load_dwordx4 v10, s[24:27], s57 offen offset:2048 lds
    v_mfma_f32_16x16x32_bf16 v[220:223], a[188:191], a[40:43], v[220:223]
    s_add_u32 m0, s51, 73728
    v_cndmask_b32 v12, v12, v176, s[6:7]
    v_cndmask_b32 v13, v13, v177, s[6:7]
    v_mfma_f32_16x16x32_bf16 v[228:231], a[188:191], a[44:47], v[228:231]
    s_waitcnt lgkmcnt(1)
    v_cndmask_b32 v14, v14, v178, s[6:7]
    v_cndmask_b32 v15, v15, v179, s[6:7]
    s_sub_u32 s57, s45, 1280
    s_cselect_b32 s45, s45, s57
    s_waitcnt lgkmcnt(0)
    v_mfma_f32_16x16x32_bf16 v[208:211], a[192:195], a[48:51], v[208:211]
    s_add_u32 s57, s45, 3932160
    ds_read_b64_tr_b16 a[196:197], v24 offset:40960
    ds_read_b64_tr_b16 a[198:199], v24 offset:43008
    v_mfma_f32_16x16x32_bf16 v[216:219], a[192:195], a[52:55], v[216:219]
    ds_read_b64_tr_b16 a[200:201], v23 offset:45056
    ds_read_b64_tr_b16 a[202:203], v23 offset:47104
    v_mfma_f32_16x16x32_bf16 v[224:227], a[192:195], a[56:59], v[224:227]
    ds_read_b64_tr_b16 a[204:205], v24 offset:45056
    ds_read_b64_tr_b16 a[206:207], v24 offset:47104
    s_and_b32 s66, s66, 15
    s_cselect_b64 s[6:7], 0, -1
    s_mul_i32 s66, s66, 122880
    s_add_u32 s66, s66, 49152
    s_waitcnt lgkmcnt(4)
    v_mfma_f32_16x16x32_bf16 v[212:215], a[196:199], a[48:51], v[212:215]
    v_mfma_f32_16x16x32_bf16 v[220:223], a[196:199], a[52:55], v[220:223]
    v_mfma_f32_16x16x32_bf16 v[228:231], a[196:199], a[56:59], v[228:231]
    s_waitcnt vmcnt(30) lgkmcnt(0)
    s_barrier
    ds_read_b64_tr_b16 a[184:185], v21 offset:24576
    v_mfma_f32_16x16x32_bf16 v[208:211], a[200:203], a[60:63], v[208:211]
    ds_read_b64_tr_b16 a[186:187], v21 offset:26624
    ds_read_b64_tr_b16 a[188:189], v22 offset:24576
    v_mfma_f32_16x16x32_bf16 v[216:219], a[200:203], a[64:67], v[216:219]
    ds_read_b64_tr_b16 a[190:191], v22 offset:26624
    ds_read_b64_tr_b16 a[192:193], v21 offset:28672
    v_mfma_f32_16x16x32_bf16 v[224:227], a[200:203], a[68:71], v[224:227]
    ds_read_b64_tr_b16 a[194:195], v21 offset:30720
    ds_read_b64_tr_b16 a[196:197], v22 offset:28672
    v_mfma_f32_16x16x32_bf16 v[212:215], a[204:207], a[60:63], v[212:215]
    ds_read_b64_tr_b16 a[198:199], v22 offset:30720
    ds_read_b64_tr_b16 a[200:201], v21 offset:32768
    v_mfma_f32_16x16x32_bf16 v[220:223], a[204:207], a[64:67], v[220:223]
    ds_read_b64_tr_b16 a[202:203], v21 offset:34816
    buffer_load_dwordx4 v8, s[24:27], s57 offen lds
    v_mfma_f32_16x16x32_bf16 v[228:231], a[204:207], a[68:71], v[228:231]
    s_waitcnt lgkmcnt(8)
    ds_read_b64_tr_b16 a[204:205], v22 offset:32768
    ds_read_b64_tr_b16 a[206:207], v22 offset:34816
    v_mfma_f32_16x16x32_bf16 v[184:187], a[184:187], a[72:75], v[184:187]
    v_mfma_f32_16x16x32_bf16 v[192:195], a[184:187], a[76:79], v[192:195]
    v_mfma_f32_16x16x32_bf16 v[200:203], a[184:187], a[80:83], v[200:203]
    s_waitcnt lgkmcnt(6)
    ds_read_b64_tr_b16 a[184:185], v21 offset:36864
    ds_read_b64_tr_b16 a[186:187], v21 offset:38912
    v_mfma_f32_16x16x32_bf16 v[188:191], a[188:191], a[72:75], v[188:191]
    buffer_load_dwordx4 v9, s[24:27], s57 offen offset:1024 lds
    v_mfma_f32_16x16x32_bf16 v[196:199], a[188:191], a[76:79], v[196:199]
    v_mfma_f32_16x16x32_bf16 v[204:207], a[188:191], a[80:83], v[204:207]
    ds_read_b64_tr_b16 a[188:189], v22 offset:36864
    ds_read_b64_tr_b16 a[190:191], v22 offset:38912
    v_mfma_f32_16x16x32_bf16 v[184:187], a[192:195], a[84:87], v[184:187]
    v_mfma_f32_16x16x32_bf16 v[192:195], a[192:195], a[88:91], v[192:195]
    v_mfma_f32_16x16x32_bf16 v[200:203], a[192:195], a[92:95], v[200:203]
    s_waitcnt lgkmcnt(4)
    buffer_load_dwordx4 v10, s[24:27], s57 offen offset:2048 lds
    v_mfma_f32_16x16x32_bf16 v[188:191], a[196:199], a[84:87], v[188:191]
    s_add_u32 s57, s45, 4055040
    ds_read_b64_tr_b16 a[192:193], v21 offset:40960
    ds_read_b64_tr_b16 a[194:195], v21 offset:43008
    v_mfma_f32_16x16x32_bf16 v[196:199], a[196:199], a[88:91], v[196:199]
    s_add_u32 m0, s51, 86016
    v_mfma_f32_16x16x32_bf16 v[204:207], a[196:199], a[92:95], v[204:207]
    ds_read_b64_tr_b16 a[196:197], v22 offset:40960
    ds_read_b64_tr_b16 a[198:199], v22 offset:43008
    v_mfma_f32_16x16x32_bf16 v[184:187], a[200:203], a[96:99], v[184:187]
    v_mfma_f32_16x16x32_bf16 v[192:195], a[200:203], a[100:103], v[192:195]
    buffer_load_dwordx4 v8, s[24:27], s57 offen lds
    v_mfma_f32_16x16x32_bf16 v[200:203], a[200:203], a[104:107], v[200:203]
    ds_read_b64_tr_b16 a[200:201], v21 offset:45056
    ds_read_b64_tr_b16 a[202:203], v21 offset:47104
    v_mfma_f32_16x16x32_bf16 v[188:191], a[204:207], a[96:99], v[188:191]
    v_mfma_f32_16x16x32_bf16 v[196:199], a[204:207], a[100:103], v[196:199]
    v_mfma_f32_16x16x32_bf16 v[204:207], a[204:207], a[104:107], v[204:207]
    s_waitcnt lgkmcnt(4)
    ds_read_b64_tr_b16 a[204:205], v22 offset:45056
    ds_read_b64_tr_b16 a[206:207], v22 offset:47104
    v_mfma_f32_16x16x32_bf16 v[184:187], a[184:187], a[108:111], v[184:187]
    buffer_load_dwordx4 v9, s[24:27], s57 offen offset:1024 lds
    v_mfma_f32_16x16x32_bf16 v[192:195], a[184:187], a[112:115], v[192:195]
    v_mfma_f32_16x16x32_bf16 v[200:203], a[184:187], a[116:119], v[200:203]
    v_mfma_f32_16x16x32_bf16 v[188:191], a[188:191], a[108:111], v[188:191]
    v_mfma_f32_16x16x32_bf16 v[196:199], a[188:191], a[112:115], v[196:199]
    v_mfma_f32_16x16x32_bf16 v[204:207], a[188:191], a[116:119], v[204:207]
    buffer_load_dwordx4 v10, s[24:27], s57 offen offset:2048 lds
    v_mfma_f32_16x16x32_bf16 v[184:187], a[192:195], a[120:123], v[184:187]
    s_waitcnt vmcnt(30) lgkmcnt(0)
    s_barrier
    ds_read_b64_tr_b16 a[184:185], v25 offset:36864
    v_mfma_f32_16x16x32_bf16 v[192:195], a[192:195], a[124:127], v[192:195]
    ds_read_b64_tr_b16 a[186:187], v25 offset:38912
    ds_read_b64_tr_b16 a[188:189], v26 offset:36864
    v_mfma_f32_16x16x32_bf16 v[200:203], a[192:195], a[128:131], v[200:203]
    ds_read_b64_tr_b16 a[190:191], v26 offset:38912
    ds_read_b64_tr_b16 a[192:193], v25 offset:40960
    v_mfma_f32_16x16x32_bf16 v[188:191], a[196:199], a[120:123], v[188:191]
    ds_read_b64_tr_b16 a[194:195], v25 offset:43008
    v_mfma_f32_16x16x32_bf16 v[196:199], a[196:199], a[124:127], v[196:199]
    v_mfma_f32_16x16x32_bf16 v[204:207], a[196:199], a[128:131], v[204:207]
    ds_read_b64_tr_b16 a[196:197], v26 offset:40960
    ds_read_b64_tr_b16 a[198:199], v26 offset:43008
    v_mfma_f32_16x16x32_bf16 v[184:187], a[200:203], a[132:135], v[184:187]
    v_mfma_f32_16x16x32_bf16 v[192:195], a[200:203], a[136:139], v[192:195]
    v_mfma_f32_16x16x32_bf16 v[200:203], a[200:203], a[140:143], v[200:203]
    ds_read_b64_tr_b16 a[200:201], v25 offset:45056
    ds_read_b64_tr_b16 a[202:203], v25 offset:47104
    v_mfma_f32_16x16x32_bf16 v[188:191], a[204:207], a[132:135], v[188:191]
    s_nop 2
    v_cvt_pk_bf16_f32 v184, v184, v185
    v_cvt_pk_bf16_f32 v185, v186, v187
    v_mfma_f32_16x16x32_bf16 v[196:199], a[204:207], a[136:139], v[196:199]
    v_cndmask_b32 v12, v12, v184, s[6:7]
    v_cndmask_b32 v13, v13, v185, s[6:7]
    v_mfma_f32_16x16x32_bf16 v[204:207], a[204:207], a[140:143], v[204:207]
    s_waitcnt lgkmcnt(4)
    ds_read_b64_tr_b16 a[204:205], v26 offset:45056
    ds_read_b64_tr_b16 a[206:207], v26 offset:47104
    v_mfma_f32_16x16x32_bf16 a[232:235], a[184:187], a[72:75], a[232:235]
    v_cvt_pk_bf16_f32 v186, v188, v189
    v_cvt_pk_bf16_f32 v187, v190, v191
    v_mfma_f32_16x16x32_bf16 a[240:243], a[184:187], a[76:79], a[240:243]
    v_cndmask_b32 v188, v5, v20, s[6:7]
    v_cndmask_b32 v14, v14, v186, s[6:7]
    v_mfma_f32_16x16x32_bf16 a[248:251], a[184:187], a[80:83], a[248:251]
    buffer_store_dwordx4 v[184:187], v188, s[32:35], s66 offen sc1
    v_mfma_f32_16x16x32_bf16 a[236:239], a[188:191], a[72:75], a[236:239]
    s_nop 0
    s_sub_u32 s66, s64, 13
    ds_read_b64_tr_b16 a[184:185], v25 offset:49152
    ds_read_b64_tr_b16 a[186:187], v25 offset:51200
    v_mfma_f32_16x16x32_bf16 a[244:247], a[188:191], a[76:79], a[244:247]
    v_cndmask_b32 v15, v15, v187, s[6:7]
    v_cvt_pk_bf16_f32 v192, v192, v193
    v_mfma_f32_16x16x32_bf16 a[252:255], a[188:191], a[80:83], a[252:255]
    ds_read_b64_tr_b16 a[188:189], v26 offset:49152
    ds_read_b64_tr_b16 a[190:191], v26 offset:51200
    v_mfma_f32_16x16x32_bf16 a[232:235], a[192:195], a[84:87], a[232:235]
    s_and_b32 s66, s66, 15
    s_cselect_b64 s[6:7], 0, -1
    v_cvt_pk_bf16_f32 v193, v194, v195
    v_mfma_f32_16x16x32_bf16 a[240:243], a[192:195], a[88:91], a[240:243]
    s_mul_i32 s66, s66, 122880
    v_cvt_pk_bf16_f32 v194, v196, v197
    v_cvt_pk_bf16_f32 v195, v198, v199
    v_mfma_f32_16x16x32_bf16 a[248:251], a[192:195], a[92:95], a[248:251]
    s_add_u32 s66, s66, 50176
    v_cndmask_b32 v196, v5, v20, s[6:7]
    v_cndmask_b32 v12, v12, v192, s[6:7]
    s_waitcnt lgkmcnt(4)
    v_mfma_f32_16x16x32_bf16 a[236:239], a[196:199], a[84:87], a[236:239]
    buffer_store_dwordx4 v[192:195], v196, s[32:35], s66 offen sc1
    v_mfma_f32_16x16x32_bf16 a[244:247], a[196:199], a[88:91], a[244:247]
    s_nop 0
    s_sub_u32 s66, s64, 14
    v_cndmask_b32 v13, v13, v193, s[6:7]
    v_cndmask_b32 v14, v14, v194, s[6:7]
    v_mfma_f32_16x16x32_bf16 a[252:255], a[196:199], a[92:95], a[252:255]
    v_cndmask_b32 v15, v15, v195, s[6:7]
    v_cvt_pk_bf16_f32 v200, v200, v201
    v_mfma_f32_16x16x32_bf16 a[232:235], a[200:203], a[96:99], a[232:235]
    s_and_b32 s66, s66, 15
    s_cselect_b64 s[6:7], 0, -1
    v_cvt_pk_bf16_f32 v201, v202, v203
    v_mfma_f32_16x16x32_bf16 a[240:243], a[200:203], a[100:103], a[240:243]
    s_mul_i32 s66, s66, 122880
    v_cvt_pk_bf16_f32 v202, v204, v205
    v_cvt_pk_bf16_f32 v203, v206, v207
    v_mfma_f32_16x16x32_bf16 a[248:251], a[200:203], a[104:107], a[248:251]
    s_add_u32 s66, s66, 51200
    ds_read_b64_tr_b16 a[192:193], v25 offset:53248
    ds_read_b64_tr_b16 a[194:195], v25 offset:55296
    v_mfma_f32_16x16x32_bf16 a[236:239], a[204:207], a[96:99], a[236:239]
    v_cndmask_b32 v204, v5, v20, s[6:7]
    v_cndmask_b32 v12, v12, v200, s[6:7]
    v_mfma_f32_16x16x32_bf16 a[244:247], a[204:207], a[100:103], a[244:247]
    buffer_store_dwordx4 v[200:203], v204, s[32:35], s66 offen sc1
    v_mfma_f32_16x16x32_bf16 a[252:255], a[204:207], a[104:107], a[252:255]
    s_nop 0
    s_sub_u32 s66, s64, 15
    v_cndmask_b32 v13, v13, v201, s[6:7]
    v_cndmask_b32 v14, v14, v202, s[6:7]
    s_waitcnt lgkmcnt(2)
    v_mfma_f32_16x16x32_bf16 a[232:235], a[184:187], a[108:111], a[232:235]
    v_cndmask_b32 v15, v15, v203, s[6:7]
    s_and_b32 s66, s66, 15
    s_cselect_b64 s[6:7], 0, -1
    v_mfma_f32_16x16x32_bf16 a[240:243], a[184:187], a[112:115], a[240:243]
    s_mul_i32 s66, s66, 122880
    ds_read_b64_tr_b16 a[196:197], v26 offset:53248
    ds_read_b64_tr_b16 a[198:199], v26 offset:55296
    v_mfma_f32_16x16x32_bf16 a[248:251], a[184:187], a[116:119], a[248:251]
    s_add_u32 s66, s66, 61440
    ds_read_b64_tr_b16 a[200:201], v25 offset:57344
    ds_read_b64_tr_b16 a[202:203], v25 offset:59392
    v_mfma_f32_16x16x32_bf16 a[236:239], a[188:191], a[108:111], a[236:239]
    ds_read_b64_tr_b16 a[204:205], v26 offset:57344
    ds_read_b64_tr_b16 a[206:207], v26 offset:59392
    v_mfma_f32_16x16x32_bf16 a[244:247], a[188:191], a[112:115], a[244:247]
    v_mfma_f32_16x16x32_bf16 a[252:255], a[188:191], a[116:119], a[252:255]
    s_waitcnt lgkmcnt(6)
    v_mfma_f32_16x16x32_bf16 a[232:235], a[192:195], a[120:123], a[232:235]
    v_mfma_f32_16x16x32_bf16 a[240:243], a[192:195], a[124:127], a[240:243]
    v_mfma_f32_16x16x32_bf16 a[248:251], a[192:195], a[128:131], a[248:251]
    s_waitcnt lgkmcnt(4)
    v_mfma_f32_16x16x32_bf16 a[236:239], a[196:199], a[120:123], a[236:239]
    s_waitcnt vmcnt(24) lgkmcnt(0)
    s_barrier
    v_mfma_f32_16x16x32_bf16 a[244:247], a[196:199], a[124:127], a[244:247]
    ds_read_b64_tr_b16 a[184:185], v23 offset:0
    ds_read_b64_tr_b16 a[186:187], v23 offset:2048
    v_mfma_f32_16x16x32_bf16 a[252:255], a[196:199], a[128:131], a[252:255]
    ds_read_b64_tr_b16 a[188:189], v24 offset:0
    ds_read_b64_tr_b16 a[190:191], v24 offset:2048
    v_mfma_f32_16x16x32_bf16 a[232:235], a[200:203], a[132:135], a[232:235]
    ds_read_b64_tr_b16 a[192:193], v23 offset:4096
    ds_read_b64_tr_b16 a[194:195], v23 offset:6144
    v_mfma_f32_16x16x32_bf16 a[240:243], a[200:203], a[136:139], a[240:243]
    ds_read_b64_tr_b16 a[196:197], v24 offset:4096
    ds_read_b64_tr_b16 a[198:199], v24 offset:6144
    v_mfma_f32_16x16x32_bf16 a[248:251], a[200:203], a[140:143], a[248:251]
    ds_read_b64_tr_b16 a[200:201], v23 offset:8192
    ds_read_b64_tr_b16 a[202:203], v23 offset:10240
    v_mfma_f32_16x16x32_bf16 a[236:239], a[204:207], a[132:135], a[236:239]
    v_accvgpr_read_b32 v232, a232
    v_accvgpr_read_b32 v233, a233
    v_mfma_f32_16x16x32_bf16 a[244:247], a[204:207], a[136:139], a[244:247]
    v_accvgpr_read_b32 v234, a234
    v_accvgpr_read_b32 v235, a235
    v_mfma_f32_16x16x32_bf16 a[252:255], a[204:207], a[140:143], a[252:255]
    s_waitcnt lgkmcnt(8)
    ds_read_b64_tr_b16 a[204:205], v24 offset:8192
    ds_read_b64_tr_b16 a[206:207], v24 offset:10240
    v_mfma_f32_16x16x32_bf16 v[208:211], a[184:187], a[72:75], v[208:211]
    v_cvt_pk_bf16_f32 v232, v232, v233
    v_accvgpr_read_b32 v236, a236
    v_mfma_f32_16x16x32_bf16 v[216:219], a[184:187], a[76:79], v[216:219]
    v_accvgpr_read_b32 v237, a237
    v_cvt_pk_bf16_f32 v233, v234, v235
    v_mfma_f32_16x16x32_bf16 v[224:227], a[184:187], a[80:83], v[224:227]
    s_waitcnt lgkmcnt(4)
    ds_read_b64_tr_b16 a[184:185], v23 offset:12288
    ds_read_b64_tr_b16 a[186:187], v23 offset:14336
    v_mfma_f32_16x16x32_bf16 v[212:215], a[188:191], a[72:75], v[212:215]
    v_accvgpr_read_b32 v238, a238
    v_accvgpr_read_b32 v239, a239
    v_mfma_f32_16x16x32_bf16 v[220:223], a[188:191], a[76:79], v[220:223]
    v_cvt_pk_bf16_f32 v234, v236, v237
    v_cvt_pk_bf16_f32 v235, v238, v239
    v_mfma_f32_16x16x32_bf16 v[228:231], a[188:191], a[80:83], v[228:231]
    v_cndmask_b32 v236, v5, v20, s[6:7]
    v_cndmask_b32 v12, v12, v232, s[6:7]
    v_mfma_f32_16x16x32_bf16 v[208:211], a[192:195], a[84:87], v[208:211]
    buffer_store_dwordx4 v[232:235], v236, s[32:35], s66 offen sc1
    v_mfma_f32_16x16x32_bf16 v[216:219], a[192:195], a[88:91], v[216:219]
    s_nop 0
    s_sub_u32 s66, s64, 0
    v_cndmask_b32 v13, v13, v233, s[6:7]
    v_cndmask_b32 v14, v14, v234, s[6:7]
    v_mfma_f32_16x16x32_bf16 v[224:227], a[192:195], a[92:95], v[224:227]
    v_cndmask_b32 v15, v15, v235, s[6:7]
    v_accvgpr_read_b32 v240, a240
    v_mfma_f32_16x16x32_bf16 v[212:215], a[196:199], a[84:87], v[212:215]
    v_accvgpr_read_b32 v241, a241
    v_accvgpr_read_b32 v242, a242
    v_mfma_f32_16x16x32_bf16 v[220:223], a[196:199], a[88:91], v[220:223]
    ds_read_b64_tr_b16 a[188:189], v24 offset:12288
    ds_read_b64_tr_b16 a[190:191], v24 offset:14336
    v_mfma_f32_16x16x32_bf16 v[228:231], a[196:199], a[92:95], v[228:231]
    s_waitcnt lgkmcnt(2)
    v_accvgpr_read_b32 v243, a243
    v_cvt_pk_bf16_f32 v240, v240, v241
    v_mfma_f32_16x16x32_bf16 v[208:211], a[200:203], a[96:99], v[208:211]
    s_and_b32 s66, s66, 15
    s_cselect_b64 s[6:7], 0, -1
    v_accvgpr_read_b32 v244, a244
    v_mfma_f32_16x16x32_bf16 v[216:219], a[200:203], a[100:103], v[216:219]
    s_mul_i32 s66, s66, 122880
    v_accvgpr_read_b32 v245, a245
    v_cvt_pk_bf16_f32 v241, v242, v243
    v_mfma_f32_16x16x32_bf16 v[224:227], a[200:203], a[104:107], v[224:227]
    s_add_u32 s66, s66, 62464
    v_accvgpr_read_b32 v246, a246
    v_accvgpr_read_b32 v247, a247
    v_mfma_f32_16x16x32_bf16 v[212:215], a[204:207], a[96:99], v[212:215]
    v_cvt_pk_bf16_f32 v242, v244, v245
    v_cvt_pk_bf16_f32 v243, v246, v247
    v_mfma_f32_16x16x32_bf16 v[220:223], a[204:207], a[100:103], v[220:223]
    v_cndmask_b32 v244, v5, v20, s[6:7]
    v_cndmask_b32 v16, v16, v240, s[6:7]
    v_mfma_f32_16x16x32_bf16 v[228:231], a[204:207], a[104:107], v[228:231]
    buffer_store_dwordx4 v[240:243], v244, s[32:35], s66 offen sc1
    v_mfma_f32_16x16x32_bf16 v[208:211], a[184:187], a[108:111], v[208:211]
    s_nop 0
    s_sub_u32 s66, s64, 1
    v_cndmask_b32 v17, v17, v241, s[6:7]
    v_cndmask_b32 v18, v18, v242, s[6:7]
    v_mfma_f32_16x16x32_bf16 v[216:219], a[184:187], a[112:115], v[216:219]
    v_cndmask_b32 v19, v19, v243, s[6:7]
    v_accvgpr_read_b32 v248, a248
    v_mfma_f32_16x16x32_bf16 v[224:227], a[184:187], a[116:119], v[224:227]
    s_waitcnt lgkmcnt(0)
    v_accvgpr_read_b32 v249, a249
    v_accvgpr_read_b32 v250, a250
    v_mfma_f32_16x16x32_bf16 v[212:215], a[188:191], a[108:111], v[212:215]
    v_accvgpr_read_b32 v251, a251
    v_cvt_pk_bf16_f32 v248, v248, v249
    v_mfma_f32_16x16x32_bf16 v[220:223], a[188:191], a[112:115], v[220:223]
    s_and_b32 s66, s66, 15
    s_cselect_b64 s[6:7], 0, -1
    v_accvgpr_read_b32 v252, a252
    v_mfma_f32_16x16x32_bf16 v[228:231], a[188:191], a[116:119], v[228:231]
    s_mul_i32 s66, s66, 122880
    v_accvgpr_read_b32 v253, a253
    v_cvt_pk_bf16_f32 v249, v250, v251
    v_accvgpr_read_b32 v254, a254
    v_accvgpr_read_b32 v255, a255
    v_cvt_pk_bf16_f32 v250, v252, v253
    v_cvt_pk_bf16_f32 v251, v254, v255
    s_add_u32 s66, s66, 63488
    v_cndmask_b32 v252, v5, v20, s[6:7]
    v_cndmask_b32 v16, v16, v248, s[6:7]
    v_cndmask_b32 v17, v17, v249, s[6:7]
    v_cndmask_b32 v18, v18, v250, s[6:7]
    v_cndmask_b32 v19, v19, v251, s[6:7]
    buffer_store_dwordx4 v[248:251], v252, s[32:35], s66 offen sc1
    ds_read_b64_tr_b16 a[192:193], v23 offset:16384
    ds_read_b64_tr_b16 a[194:195], v23 offset:18432
    ds_read_b64_tr_b16 a[196:197], v24 offset:16384
    s_sub_u32 s66, s64, 2
    ds_read_b64_tr_b16 a[198:199], v24 offset:18432
    s_and_b32 s66, s66, 15
    s_cselect_b64 s[6:7], 0, -1
    ds_read_b64_tr_b16 a[200:201], v23 offset:20480
    ds_read_b64_tr_b16 a[202:203], v23 offset:22528
    s_mul_i32 s66, s66, 122880
    ds_read_b64_tr_b16 a[204:205], v24 offset:20480
    s_add_u32 s66, s66, 73728
    ds_read_b64_tr_b16 a[206:207], v24 offset:22528
    s_waitcnt lgkmcnt(6)
    v_mfma_f32_16x16x32_bf16 v[208:211], a[192:195], a[120:123], v[208:211]
    v_mfma_f32_16x16x32_bf16 v[216:219], a[192:195], a[124:127], v[216:219]
    v_mfma_f32_16x16x32_bf16 v[224:227], a[192:195], a[128:131], v[224:227]
    s_waitcnt lgkmcnt(2)
    v_mfma_f32_16x16x32_bf16 v[212:215], a[196:199], a[120:123], v[212:215]
    s_waitcnt vmcnt(21) lgkmcnt(0)
    s_barrier
    ds_read_b64_tr_b16 a[184:185], v25 offset:0
    v_mfma_f32_16x16x32_bf16 v[220:223], a[196:199], a[124:127], v[220:223]
    ds_read_b64_tr_b16 a[186:187], v25 offset:2048
    ds_read_b64_tr_b16 a[188:189], v26 offset:0
    v_mfma_f32_16x16x32_bf16 v[228:231], a[196:199], a[128:131], v[228:231]
    ds_read_b64_tr_b16 a[190:191], v26 offset:2048
    ds_read_b64_tr_b16 a[192:193], v25 offset:4096
    v_mfma_f32_16x16x32_bf16 v[208:211], a[200:203], a[132:135], v[208:211]
    ds_read_b64_tr_b16 a[194:195], v25 offset:6144
    ds_read_b64_tr_b16 a[196:197], v26 offset:4096
    v_mfma_f32_16x16x32_bf16 v[216:219], a[200:203], a[136:139], v[216:219]
    ds_read_b64_tr_b16 a[198:199], v26 offset:6144
    v_mfma_f32_16x16x32_bf16 v[224:227], a[200:203], a[140:143], v[224:227]
    ds_read_b64_tr_b16 a[200:201], v25 offset:8192
    ds_read_b64_tr_b16 a[202:203], v25 offset:10240
    v_mfma_f32_16x16x32_bf16 v[212:215], a[204:207], a[132:135], v[212:215]
    v_cvt_pk_bf16_f32 v208, v208, v209
    v_cvt_pk_bf16_f32 v209, v210, v211
    v_mfma_f32_16x16x32_bf16 v[220:223], a[204:207], a[136:139], v[220:223]
    v_cndmask_b32 v16, v16, v208, s[6:7]
    v_cndmask_b32 v17, v17, v209, s[6:7]
    v_mfma_f32_16x16x32_bf16 v[228:231], a[204:207], a[140:143], v[228:231]
    ds_read_b64_tr_b16 a[204:205], v26 offset:8192
    ds_read_b64_tr_b16 a[206:207], v26 offset:10240
    v_mfma_f32_16x16x32_bf16 v[64:67], v[58:61], a[220:223], 0
    v_cvt_pk_bf16_f32 v210, v212, v213
    v_cvt_pk_bf16_f32 v211, v214, v215
    v_mfma_f32_16x16x32_bf16 v[72:75], v[58:61], a[224:227], 0
    v_cndmask_b32 v212, v5, v20, s[6:7]
    v_cndmask_b32 v18, v18, v210, s[6:7]
    v_mfma_f32_16x16x32_bf16 v[80:83], v[58:61], a[228:231], 0
    buffer_store_dwordx4 v[208:211], v212, s[32:35], s66 offen sc1
    v_mfma_f32_16x16x32_bf16 v[68:71], v[56:59], a[220:223], 0
    s_nop 0
    s_sub_u32 s66, s64, 3
    v_cndmask_b32 v19, v19, v211, s[6:7]
    v_cvt_pk_bf16_f32 v216, v216, v217
    v_mfma_f32_16x16x32_bf16 v[76:79], v[56:59], a[224:227], 0
    s_and_b32 s66, s66, 15
    s_cselect_b64 s[6:7], 0, -1
    v_cvt_pk_bf16_f32 v217, v218, v219
    v_mfma_f32_16x16x32_bf16 v[84:87], v[56:59], a[228:231], 0
    s_mul_i32 s66, s66, 122880
    v_cvt_pk_bf16_f32 v218, v220, v221
    v_cvt_pk_bf16_f32 v219, v222, v223
    s_waitcnt lgkmcnt(0)
    v_mfma_f32_16x16x32_bf16 v[64:67], a[184:187], a[72:75], v[64:67]
    s_add_u32 s66, s66, 74752
    v_cndmask_b32 v220, v5, v20, s[6:7]
    v_cndmask_b32 v16, v16, v216, s[6:7]
    v_mfma_f32_16x16x32_bf16 v[72:75], a[184:187], a[76:79], v[72:75]
    buffer_store_dwordx4 v[216:219], v220, s[32:35], s66 offen sc1
    v_mfma_f32_16x16x32_bf16 v[80:83], a[184:187], a[80:83], v[80:83]
    s_nop 0
    s_sub_u32 s66, s64, 4
    v_cndmask_b32 v17, v17, v217, s[6:7]
    v_cndmask_b32 v18, v18, v218, s[6:7]
    v_mfma_f32_16x16x32_bf16 v[68:71], a[188:191], a[72:75], v[68:71]
    v_cndmask_b32 v19, v19, v219, s[6:7]
    v_cvt_pk_bf16_f32 v224, v224, v225
    v_mfma_f32_16x16x32_bf16 v[76:79], a[188:191], a[76:79], v[76:79]
    s_and_b32 s66, s66, 15
    s_cselect_b64 s[6:7], 0, -1
    v_cvt_pk_bf16_f32 v225, v226, v227
    v_mfma_f32_16x16x32_bf16 v[84:87], a[188:191], a[80:83], v[84:87]
    s_mul_i32 s66, s66, 122880
    v_cvt_pk_bf16_f32 v226, v228, v229
    v_cvt_pk_bf16_f32 v227, v230, v231
    v_mfma_f32_16x16x32_bf16 v[64:67], a[192:195], a[84:87], v[64:67]
    s_add_u32 s66, s66, 75776
    ds_read_b64_tr_b16 a[184:185], v25 offset:12288
    ds_read_b64_tr_b16 a[186:187], v25 offset:14336
    v_mfma_f32_16x16x32_bf16 v[72:75], a[192:195], a[88:91], v[72:75]
    v_cndmask_b32 v228, v5, v20, s[6:7]
    v_cndmask_b32 v16, v16, v224, s[6:7]
    v_mfma_f32_16x16x32_bf16 v[80:83], a[192:195], a[92:95], v[80:83]
    buffer_store_dwordx4 v[224:227], v228, s[32:35], s66 offen sc1
    v_mfma_f32_16x16x32_bf16 v[68:71], a[196:199], a[84:87], v[68:71]
    s_nop 0
    s_sub_u32 s66, s64, 5
    v_cndmask_b32 v17, v17, v225, s[6:7]
    v_cndmask_b32 v18, v18, v226, s[6:7]
    v_mfma_f32_16x16x32_bf16 v[76:79], a[196:199], a[88:91], v[76:79]
    v_cndmask_b32 v19, v19, v227, s[6:7]
    s_and_b32 s66, s66, 15
    s_cselect_b64 s[6:7], 0, -1
    v_mfma_f32_16x16x32_bf16 v[84:87], a[196:199], a[92:95], v[84:87]
    s_mul_i32 s66, s66, 122880
    ds_read_b64_tr_b16 a[188:189], v26 offset:12288
    ds_read_b64_tr_b16 a[190:191], v26 offset:14336
    v_mfma_f32_16x16x32_bf16 v[64:67], a[200:203], a[96:99], v[64:67]
    s_add_u32 s66, s66, 86016
    ds_read_b64_tr_b16 a[192:193], v25 offset:16384
    ds_read_b64_tr_b16 a[194:195], v25 offset:18432
    v_mfma_f32_16x16x32_bf16 v[72:75], a[200:203], a[100:103], v[72:75]
    ds_read_b64_tr_b16 a[196:197], v26 offset:16384
    ds_read_b64_tr_b16 a[198:199], v26 offset:18432
    v_mfma_f32_16x16x32_bf16 v[80:83], a[200:203], a[104:107], v[80:83]
    ds_read_b64_tr_b16 a[200:201], v25 offset:20480
    ds_read_b64_tr_b16 a[202:203], v25 offset:22528
    v_mfma_f32_16x16x32_bf16 v[68:71], a[204:207], a[96:99], v[68:71]
    v_mfma_f32_16x16x32_bf16 v[76:79], a[204:207], a[100:103], v[76:79]
    v_mfma_f32_16x16x32_bf16 v[84:87], a[204:207], a[104:107], v[84:87]
    s_waitcnt lgkmcnt(8)
    ds_read_b64_tr_b16 a[204:205], v26 offset:20480
    ds_read_b64_tr_b16 a[206:207], v26 offset:22528
    v_mfma_f32_16x16x32_bf16 v[64:67], a[184:187], a[108:111], v[64:67]
    v_mfma_f32_16x16x32_bf16 v[72:75], a[184:187], a[112:115], v[72:75]
    v_mfma_f32_16x16x32_bf16 v[80:83], a[184:187], a[116:119], v[80:83]
    s_waitcnt lgkmcnt(4)
    v_mfma_f32_16x16x32_bf16 v[68:71], a[188:191], a[108:111], v[68:71]
    v_mfma_f32_16x16x32_bf16 v[76:79], a[188:191], a[112:115], v[76:79]
    v_mfma_f32_16x16x32_bf16 v[84:87], a[188:191], a[116:119], v[84:87]
    s_waitcnt vmcnt(3) lgkmcnt(0)
    s_barrier
    v_mfma_f32_16x16x32_bf16 v[64:67], a[192:195], a[120:123], v[64:67]
    ds_read_b64_tr_b16 a[184:185], v21 offset:0
    ds_read_b64_tr_b16 a[186:187], v21 offset:2048
    v_mfma_f32_16x16x32_bf16 v[72:75], a[192:195], a[124:127], v[72:75]
    ds_read_b64_tr_b16 a[188:189], v22 offset:0
    ds_read_b64_tr_b16 a[190:191], v22 offset:2048
    v_mfma_f32_16x16x32_bf16 v[80:83], a[192:195], a[128:131], v[80:83]
    ds_read_b64_tr_b16 a[192:193], v21 offset:4096
    ds_read_b64_tr_b16 a[194:195], v21 offset:6144
    v_mfma_f32_16x16x32_bf16 v[68:71], a[196:199], a[120:123], v[68:71]
    v_mfma_f32_16x16x32_bf16 v[76:79], a[196:199], a[124:127], v[76:79]
    v_mfma_f32_16x16x32_bf16 v[84:87], a[196:199], a[128:131], v[84:87]
    ds_read_b64_tr_b16 a[196:197], v22 offset:4096
    ds_read_b64_tr_b16 a[198:199], v22 offset:6144
    v_mfma_f32_16x16x32_bf16 v[64:67], a[200:203], a[132:135], v[64:67]
    v_mfma_f32_16x16x32_bf16 v[72:75], a[200:203], a[136:139], v[72:75]
    v_mfma_f32_16x16x32_bf16 v[80:83], a[200:203], a[140:143], v[80:83]
    ds_read_b64_tr_b16 a[200:201], v21 offset:8192
    ds_read_b64_tr_b16 a[202:203], v21 offset:10240
    v_mfma_f32_16x16x32_bf16 v[68:71], a[204:207], a[132:135], v[68:71]
    s_nop 2
    v_cvt_pk_bf16_f32 v64, v64, v65
    v_cvt_pk_bf16_f32 v65, v66, v67
    v_mfma_f32_16x16x32_bf16 v[76:79], a[204:207], a[136:139], v[76:79]
    v_cndmask_b32 v16, v16, v64, s[6:7]
    v_cndmask_b32 v17, v17, v65, s[6:7]
    v_mfma_f32_16x16x32_bf16 v[84:87], a[204:207], a[140:143], v[84:87]
    v_cvt_pk_bf16_f32 v72, v72, v73
    v_cvt_pk_bf16_f32 v73, v74, v75
    v_mfma_f32_16x16x32_bf16 v[112:115], v[58:61], a[208:211], 0
    v_cvt_pk_bf16_f32 v66, v68, v69
    v_cvt_pk_bf16_f32 v67, v70, v71
    v_mfma_f32_16x16x32_bf16 v[120:123], v[58:61], a[212:215], 0
    v_cndmask_b32 v68, v5, v20, s[6:7]
    v_cndmask_b32 v18, v18, v66, s[6:7]
    v_mfma_f32_16x16x32_bf16 v[128:131], v[58:61], a[216:219], 0
    buffer_store_dwordx4 v[64:67], v68, s[32:35], s66 offen sc1
    v_mfma_f32_16x16x32_bf16 v[116:119], v[56:59], a[208:211], 0
    s_nop 0
    s_sub_u32 s66, s64, 6
    v_cndmask_b32 v19, v19, v67, s[6:7]
    v_cvt_pk_bf16_f32 v74, v76, v77
    v_mfma_f32_16x16x32_bf16 v[124:127], v[56:59], a[212:215], 0
    s_and_b32 s66, s66, 15
    s_cselect_b64 s[6:7], 0, -1
    s_mul_i32 s66, s66, 122880
    v_mfma_f32_16x16x32_bf16 v[132:135], v[56:59], a[216:219], 0
    s_add_u32 s66, s66, 87040
    ds_read_b64_tr_b16 a[204:205], v22 offset:8192
    ds_read_b64_tr_b16 a[206:207], v22 offset:10240
    s_waitcnt lgkmcnt(2)
    v_mfma_f32_16x16x32_bf16 v[112:115], a[184:187], a[72:75], v[112:115]
    v_cvt_pk_bf16_f32 v75, v78, v79
    v_cndmask_b32 v76, v5, v20, s[6:7]
    v_mfma_f32_16x16x32_bf16 v[120:123], a[184:187], a[76:79], v[120:123]
    buffer_store_dwordx4 v[72:75], v76, s[32:35], s66 offen sc1
    v_mfma_f32_16x16x32_bf16 v[128:131], a[184:187], a[80:83], v[128:131]
    s_nop 0
    s_sub_u32 s66, s64, 7
    v_cndmask_b32 v16, v16, v72, s[6:7]
    v_cndmask_b32 v17, v17, v73, s[6:7]
    v_mfma_f32_16x16x32_bf16 v[116:119], a[188:191], a[72:75], v[116:119]
    v_cndmask_b32 v18, v18, v74, s[6:7]
    v_cndmask_b32 v19, v19, v75, s[6:7]
    v_mfma_f32_16x16x32_bf16 v[124:127], a[188:191], a[76:79], v[124:127]
    v_cvt_pk_bf16_f32 v80, v80, v81
    v_cvt_pk_bf16_f32 v81, v82, v83
    v_mfma_f32_16x16x32_bf16 v[132:135], a[188:191], a[80:83], v[132:135]
    s_and_b32 s66, s66, 15
    s_cselect_b64 s[6:7], 0, -1
    v_cvt_pk_bf16_f32 v82, v84, v85
    v_mfma_f32_16x16x32_bf16 v[112:115], a[192:195], a[84:87], v[112:115]
    s_mul_i32 s66, s66, 122880
    v_cvt_pk_bf16_f32 v83, v86, v87
    s_add_u32 s66, s66, 88064
    v_mfma_f32_16x16x32_bf16 v[120:123], a[192:195], a[88:91], v[120:123]
    v_cndmask_b32 v84, v5, v20, s[6:7]
    v_cndmask_b32 v16, v16, v80, s[6:7]
    v_mfma_f32_16x16x32_bf16 v[128:131], a[192:195], a[92:95], v[128:131]
    buffer_store_dwordx4 v[80:83], v84, s[32:35], s66 offen sc1
    v_mfma_f32_16x16x32_bf16 v[116:119], a[196:199], a[84:87], v[116:119]
    s_nop 0
    s_sub_u32 s66, s64, 8
    buffer_store_dword v63, v4, s[32:35], s65 offen sc1
    v_mfma_f32_16x16x32_bf16 v[124:127], a[196:199], a[88:91], v[124:127]
    ds_read_b64_tr_b16 a[184:185], v21 offset:12288
    ds_read_b64_tr_b16 a[186:187], v21 offset:14336
    v_mfma_f32_16x16x32_bf16 v[132:135], a[196:199], a[92:95], v[132:135]
    v_cndmask_b32 v17, v17, v81, s[6:7]
    v_cndmask_b32 v18, v18, v82, s[6:7]
    v_mfma_f32_16x16x32_bf16 v[112:115], a[200:203], a[96:99], v[112:115]
    v_cndmask_b32 v19, v19, v83, s[6:7]
    s_and_b32 s66, s66, 15
    s_cselect_b64 s[6:7], 0, -1
    v_mfma_f32_16x16x32_bf16 v[120:123], a[200:203], a[100:103], v[120:123]
    s_mul_i32 s66, s66, 122880
    ds_read_b64_tr_b16 a[188:189], v22 offset:12288
    ds_read_b64_tr_b16 a[190:191], v22 offset:14336
    v_mfma_f32_16x16x32_bf16 v[128:131], a[200:203], a[104:107], v[128:131]
    s_add_u32 s66, s66, 98304
    ds_read_b64_tr_b16 a[192:193], v21 offset:16384
    ds_read_b64_tr_b16 a[194:195], v21 offset:18432
    s_waitcnt lgkmcnt(6)
    v_mfma_f32_16x16x32_bf16 v[116:119], a[204:207], a[96:99], v[116:119]
    ds_read_b64_tr_b16 a[196:197], v22 offset:16384
    ds_read_b64_tr_b16 a[198:199], v22 offset:18432
    v_mfma_f32_16x16x32_bf16 v[124:127], a[204:207], a[100:103], v[124:127]
    ds_read_b64_tr_b16 a[200:201], v21 offset:20480
    ds_read_b64_tr_b16 a[202:203], v21 offset:22528
    v_mfma_f32_16x16x32_bf16 v[132:135], a[204:207], a[104:107], v[132:135]
    s_waitcnt lgkmcnt(8)
    ds_read_b64_tr_b16 a[204:205], v22 offset:20480
    ds_read_b64_tr_b16 a[206:207], v22 offset:22528
    v_mfma_f32_16x16x32_bf16 v[112:115], a[184:187], a[108:111], v[112:115]
    v_mfma_f32_16x16x32_bf16 v[120:123], a[184:187], a[112:115], v[120:123]
    v_mfma_f32_16x16x32_bf16 v[128:131], a[184:187], a[116:119], v[128:131]
    s_waitcnt lgkmcnt(8)
    v_mfma_f32_16x16x32_bf16 v[116:119], a[188:191], a[108:111], v[116:119]
    v_mfma_f32_16x16x32_bf16 v[124:127], a[188:191], a[112:115], v[124:127]
    v_mfma_f32_16x16x32_bf16 v[132:135], a[188:191], a[116:119], v[132:135]
    s_waitcnt lgkmcnt(0)
    s_barrier
    v_mfma_f32_16x16x32_bf16 v[112:115], a[192:195], a[120:123], v[112:115]
    ds_read_b64_tr_b16 a[184:185], v23 offset:24576
    ds_read_b64_tr_b16 a[186:187], v23 offset:26624
    v_mfma_f32_16x16x32_bf16 v[120:123], a[192:195], a[124:127], v[120:123]
    ds_read_b64_tr_b16 a[188:189], v24 offset:24576
    ds_read_b64_tr_b16 a[190:191], v24 offset:26624
    v_mfma_f32_16x16x32_bf16 v[128:131], a[192:195], a[128:131], v[128:131]
    ds_read_b64_tr_b16 a[192:193], v23 offset:28672
    ds_read_b64_tr_b16 a[194:195], v23 offset:30720
    v_mfma_f32_16x16x32_bf16 v[116:119], a[196:199], a[120:123], v[116:119]
    v_mfma_f32_16x16x32_bf16 v[124:127], a[196:199], a[124:127], v[124:127]
    v_mfma_f32_16x16x32_bf16 v[132:135], a[196:199], a[128:131], v[132:135]
    ds_read_b64_tr_b16 a[196:197], v24 offset:28672
    ds_read_b64_tr_b16 a[198:199], v24 offset:30720
    v_mfma_f32_16x16x32_bf16 v[112:115], a[200:203], a[132:135], v[112:115]
    v_mfma_f32_16x16x32_bf16 v[120:123], a[200:203], a[136:139], v[120:123]
    v_mfma_f32_16x16x32_bf16 v[128:131], a[200:203], a[140:143], v[128:131]
    ds_read_b64_tr_b16 a[200:201], v23 offset:32768
    ds_read_b64_tr_b16 a[202:203], v23 offset:34816
    v_mfma_f32_16x16x32_bf16 v[116:119], a[204:207], a[132:135], v[116:119]
    s_nop 2
    v_cvt_pk_bf16_f32 v112, v112, v113
    v_cvt_pk_bf16_f32 v113, v114, v115
    v_mfma_f32_16x16x32_bf16 v[124:127], a[204:207], a[136:139], v[124:127]
    v_cndmask_b32 v16, v16, v112, s[6:7]
    v_cndmask_b32 v17, v17, v113, s[6:7]
    v_mfma_f32_16x16x32_bf16 v[132:135], a[204:207], a[140:143], v[132:135]
    s_waitcnt lgkmcnt(4)
    ds_read_b64_tr_b16 a[204:205], v24 offset:32768
    ds_read_b64_tr_b16 a[206:207], v24 offset:34816
    v_mfma_f32_16x16x32_bf16 v[88:91], a[184:187], a[72:75], v[88:91]
    v_cvt_pk_bf16_f32 v114, v116, v117
    v_cvt_pk_bf16_f32 v115, v118, v119
    v_mfma_f32_16x16x32_bf16 v[96:99], a[184:187], a[76:79], v[96:99]
    v_cndmask_b32 v116, v5, v20, s[6:7]
    v_cndmask_b32 v18, v18, v114, s[6:7]
    v_mfma_f32_16x16x32_bf16 v[104:107], a[184:187], a[80:83], v[104:107]
    buffer_store_dwordx4 v[112:115], v116, s[32:35], s66 offen sc1
    v_mfma_f32_16x16x32_bf16 v[92:95], a[188:191], a[72:75], v[92:95]
    s_nop 0
    s_sub_u32 s66, s64, 9
    ds_read_b64_tr_b16 a[184:185], v23 offset:36864
    ds_read_b64_tr_b16 a[186:187], v23 offset:38912
    v_mfma_f32_16x16x32_bf16 v[100:103], a[188:191], a[76:79], v[100:103]
    v_cndmask_b32 v19, v19, v115, s[6:7]
    v_cvt_pk_bf16_f32 v120, v120, v121
    v_mfma_f32_16x16x32_bf16 v[108:111], a[188:191], a[80:83], v[108:111]
    ds_read_b64_tr_b16 a[188:189], v24 offset:36864
    ds_read_b64_tr_b16 a[190:191], v24 offset:38912
    v_mfma_f32_16x16x32_bf16 v[88:91], a[192:195], a[84:87], v[88:91]
    s_and_b32 s66, s66, 15
    s_cselect_b64 s[6:7], 0, -1
    v_cvt_pk_bf16_f32 v121, v122, v123
    v_mfma_f32_16x16x32_bf16 v[96:99], a[192:195], a[88:91], v[96:99]
    s_mul_i32 s66, s66, 122880
    v_cvt_pk_bf16_f32 v122, v124, v125
    v_cvt_pk_bf16_f32 v123, v126, v127
    v_mfma_f32_16x16x32_bf16 v[104:107], a[192:195], a[92:95], v[104:107]
    s_add_u32 s66, s66, 99328
    v_cndmask_b32 v124, v5, v20, s[6:7]
    v_cndmask_b32 v16, v16, v120, s[6:7]
    s_waitcnt lgkmcnt(4)
    v_mfma_f32_16x16x32_bf16 v[92:95], a[196:199], a[84:87], v[92:95]
    buffer_store_dwordx4 v[120:123], v124, s[32:35], s66 offen sc1
    v_mfma_f32_16x16x32_bf16 v[100:103], a[196:199], a[88:91], v[100:103]
    s_nop 0
    s_sub_u32 s66, s64, 10
    v_cndmask_b32 v17, v17, v121, s[6:7]
    v_cndmask_b32 v18, v18, v122, s[6:7]
    v_mfma_f32_16x16x32_bf16 v[108:111], a[196:199], a[92:95], v[108:111]
    v_cndmask_b32 v19, v19, v123, s[6:7]
    v_cvt_pk_bf16_f32 v128, v128, v129
    v_mfma_f32_16x16x32_bf16 v[88:91], a[200:203], a[96:99], v[88:91]
    s_and_b32 s66, s66, 15
    s_cselect_b64 s[6:7], 0, -1
    v_cvt_pk_bf16_f32 v129, v130, v131
    v_mfma_f32_16x16x32_bf16 v[96:99], a[200:203], a[100:103], v[96:99]
    s_mul_i32 s66, s66, 122880
    v_cvt_pk_bf16_f32 v130, v132, v133
    v_cvt_pk_bf16_f32 v131, v134, v135
    v_mfma_f32_16x16x32_bf16 v[104:107], a[200:203], a[104:107], v[104:107]
    s_add_u32 s66, s66, 100352
    ds_read_b64_tr_b16 a[192:193], v23 offset:40960
    ds_read_b64_tr_b16 a[194:195], v23 offset:43008
    v_mfma_f32_16x16x32_bf16 v[92:95], a[204:207], a[96:99], v[92:95]
    v_cndmask_b32 v132, v5, v20, s[6:7]
    v_cndmask_b32 v16, v16, v128, s[6:7]
    v_mfma_f32_16x16x32_bf16 v[100:103], a[204:207], a[100:103], v[100:103]
    buffer_store_dwordx4 v[128:131], v132, s[32:35], s66 offen sc1
    v_mfma_f32_16x16x32_bf16 v[108:111], a[204:207], a[104:107], v[108:111]
    s_nop 0
    s_sub_u32 s66, s64, 11
    v_cndmask_b32 v17, v17, v129, s[6:7]
    v_cndmask_b32 v18, v18, v130, s[6:7]
    s_waitcnt lgkmcnt(2)
    v_mfma_f32_16x16x32_bf16 v[88:91], a[184:187], a[108:111], v[88:91]
    v_cndmask_b32 v19, v19, v131, s[6:7]
    s_and_b32 s66, s66, 15
    s_cselect_b64 s[6:7], 0, -1
    v_mfma_f32_16x16x32_bf16 v[96:99], a[184:187], a[112:115], v[96:99]
    s_mul_i32 s66, s66, 122880
    ds_read_b64_tr_b16 a[196:197], v24 offset:40960
    ds_read_b64_tr_b16 a[198:199], v24 offset:43008
    v_mfma_f32_16x16x32_bf16 v[104:107], a[184:187], a[116:119], v[104:107]
    s_add_u32 s66, s66, 110592
    ds_read_b64_tr_b16 a[200:201], v23 offset:45056
    ds_read_b64_tr_b16 a[202:203], v23 offset:47104
    v_mfma_f32_16x16x32_bf16 v[92:95], a[188:191], a[108:111], v[92:95]
    ds_read_b64_tr_b16 a[204:205], v24 offset:45056
    ds_read_b64_tr_b16 a[206:207], v24 offset:47104
    v_mfma_f32_16x16x32_bf16 v[100:103], a[188:191], a[112:115], v[100:103]
    v_mfma_f32_16x16x32_bf16 v[108:111], a[188:191], a[116:119], v[108:111]
    s_waitcnt lgkmcnt(6)
    v_mfma_f32_16x16x32_bf16 v[88:91], a[192:195], a[120:123], v[88:91]
    v_mfma_f32_16x16x32_bf16 v[96:99], a[192:195], a[124:127], v[96:99]
    v_mfma_f32_16x16x32_bf16 v[104:107], a[192:195], a[128:131], v[104:107]
    s_waitcnt lgkmcnt(4)
    v_mfma_f32_16x16x32_bf16 v[92:95], a[196:199], a[120:123], v[92:95]
    v_mfma_f32_16x16x32_bf16 v[100:103], a[196:199], a[124:127], v[100:103]
    v_mfma_f32_16x16x32_bf16 v[108:111], a[196:199], a[128:131], v[108:111]
    s_waitcnt lgkmcnt(0)
    v_mfma_f32_16x16x32_bf16 v[88:91], a[200:203], a[132:135], v[88:91]
    v_mfma_f32_16x16x32_bf16 v[96:99], a[200:203], a[136:139], v[96:99]
    v_mfma_f32_16x16x32_bf16 v[104:107], a[200:203], a[140:143], v[104:107]
    v_mfma_f32_16x16x32_bf16 v[92:95], a[204:207], a[132:135], v[92:95]
    s_nop 4
    v_cvt_pk_bf16_f32 v88, v88, v89
    v_cvt_pk_bf16_f32 v89, v90, v91
    v_mfma_f32_16x16x32_bf16 v[100:103], a[204:207], a[136:139], v[100:103]
    v_cndmask_b32 v16, v16, v88, s[6:7]
    v_cndmask_b32 v17, v17, v89, s[6:7]
    v_mfma_f32_16x16x32_bf16 v[108:111], a[204:207], a[140:143], v[108:111]
    v_cvt_pk_bf16_f32 v96, v96, v97
    v_cvt_pk_bf16_f32 v97, v98, v99
    v_cvt_pk_bf16_f32 v90, v92, v93
    v_cvt_pk_bf16_f32 v91, v94, v95
    v_cndmask_b32 v92, v5, v20, s[6:7]
    v_cndmask_b32 v18, v18, v90, s[6:7]
    v_cndmask_b32 v19, v19, v91, s[6:7]
    v_cvt_pk_bf16_f32 v98, v100, v101
    v_cvt_pk_bf16_f32 v99, v102, v103
    v_cvt_pk_bf16_f32 v104, v104, v105
    v_cvt_pk_bf16_f32 v105, v106, v107
    v_cvt_pk_bf16_f32 v106, v108, v109
    buffer_store_dwordx4 v[88:91], v92, s[32:35], s66 offen sc1
    v_cvt_pk_bf16_f32 v107, v110, v111
    s_nop 0
    s_sub_u32 s66, s64, 12
    s_and_b32 s66, s66, 15
    s_cselect_b64 s[6:7], 0, -1
    s_mul_i32 s66, s66, 122880
    s_add_u32 s66, s66, 111616
    v_cndmask_b32 v100, v5, v20, s[6:7]
    v_cndmask_b32 v16, v16, v96, s[6:7]
    v_cndmask_b32 v17, v17, v97, s[6:7]
    v_cndmask_b32 v18, v18, v98, s[6:7]
    v_cndmask_b32 v19, v19, v99, s[6:7]
    buffer_store_dwordx4 v[96:99], v100, s[32:35], s66 offen sc1
    s_nop 1
    s_sub_u32 s66, s64, 13
    s_and_b32 s66, s66, 15
    s_cselect_b64 s[6:7], 0, -1
    s_mul_i32 s66, s66, 122880
    s_add_u32 s66, s66, 112640
    v_cndmask_b32 v108, v5, v20, s[6:7]
    buffer_store_dwordx4 v[104:107], v108, s[32:35], s66 offen sc1
    buffer_load_dword v6, v30, s[32:35], s9 offen sc1
    v_cndmask_b32 v16, v16, v104, s[6:7]
    v_cndmask_b32 v17, v17, v105, s[6:7]
    v_cndmask_b32 v18, v18, v106, s[6:7]
    v_cndmask_b32 v19, v19, v107, s[6:7]
    s_waitcnt vmcnt(1)
    s_barrier
    buffer_store_dword v63, v4, s[32:35], s65 offen offset:256 sc1
    s_waitcnt vmcnt(1)
    v_cmp_ne_u32 vcc, s11, v6
    s_nop 3
    s_cbranch_vccnz LB_ps0
LB_backp0:
    s_barrier
    s_add_u32 s58, s8, 122880
    buffer_load_dwordx4 a[4:7], v1, s[32:35], s58 offen sc1
    s_add_u32 s58, s8, 245760
    buffer_load_dwordx4 a[8:11], v1, s[32:35], s58 offen sc1
    s_add_u32 s58, s8, 368640
    buffer_load_dwordx4 a[12:15], v1, s[32:35], s58 offen sc1
    s_add_u32 s58, s8, 491520
    buffer_load_dwordx4 a[16:19], v1, s[32:35], s58 offen sc1
    buffer_load_dword v7, v30, s[32:35], s21 offen sc1
    s_add_u32 s58, s8, 614400
    buffer_load_dwordx4 a[20:23], v1, s[32:35], s58 offen sc1
    s_add_u32 s58, s8, 737280
    buffer_load_dwordx4 a[24:27], v1, s[32:35], s58 offen sc1
    s_add_u32 s58, s8, 860160
    buffer_load_dwordx4 a[28:31], v1, s[32:35], s58 offen sc1
    s_add_u32 s58, s8, 983040
    buffer_load_dwordx4 a[32:35], v1, s[32:35], s58 offen sc1
    s_add_u32 s58, s8, 1105920
    buffer_load_dwordx4 a[36:39], v1, s[32:35], s58 offen sc1
    s_add_u32 s58, s8, 1228800
    buffer_load_dwordx4 a[40:43], v1, s[32:35], s58 offen sc1
    s_add_u32 s58, s8, 1351680
    buffer_load_dwordx4 a[44:47], v1, s[32:35], s58 offen sc1
    s_add_u32 s58, s8, 1474560
    buffer_load_dwordx4 a[48:51], v1, s[32:35], s58 offen sc1
    s_add_u32 s58, s8, 1597440
    buffer_load_dwordx4 a[52:55], v1, s[32:35], s58 offen sc1
    s_add_u32 s58, s8, 1720320
    buffer_load_dwordx4 a[56:59], v1, s[32:35], s58 offen sc1
    s_add_u32 s58, s8, 1843200
    buffer_load_dwordx4 a[60:63], v1, s[32:35], s58 offen sc1
    s_waitcnt vmcnt(11)
    v_cmp_ne_u32 vcc, s11, v7
    s_nop 3
    s_cbranch_vccnz LB_ps1
LB_backp1:
    s_barrier
    s_add_u32 s58, s20, 122880
    buffer_load_dwordx4 a[76:79], v62, s[32:35], s58 offen sc1
    s_add_u32 s58, s20, 245760
    buffer_load_dwordx4 a[80:83], v62, s[32:35], s58 offen sc1
    s_add_u32 s58, s20, 368640
    buffer_load_dwordx4 a[84:87], v62, s[32:35], s58 offen sc1
    s_add_u32 s58, s20, 491520
    buffer_load_dwordx4 a[88:91], v62, s[32:35], s58 offen sc1
    s_add_u32 s58, s20, 614400
    buffer_load_dwordx4 a[92:95], v62, s[32:35], s58 offen sc1
    s_add_u32 s58, s20, 737280
    buffer_load_dwordx4 a[96:99], v62, s[32:35], s58 offen sc1
    s_add_u32 s58, s20, 860160
    buffer_load_dwordx4 a[100:103], v62, s[32:35], s58 offen sc1
    s_add_u32 s58, s20, 983040
    buffer_load_dwordx4 a[104:107], v62, s[32:35], s58 offen sc1
    s_add_u32 s58, s20, 1105920
    buffer_load_dwordx4 a[108:111], v62, s[32:35], s58 offen sc1
    s_add_u32 s58, s20, 1228800
    buffer_load_dwordx4 a[112:115], v62, s[32:35], s58 offen sc1
    s_add_u32 s58, s20, 1351680
    buffer_load_dwordx4 a[116:119], v62, s[32:35], s58 offen sc1
    s_add_u32 s58, s20, 1474560
    buffer_load_dwordx4 a[120:123], v62, s[32:35], s58 offen sc1
    s_add_u32 s58, s20, 1597440
    buffer_load_dwordx4 a[124:127], v62, s[32:35], s58 offen sc1
    s_add_u32 s58, s20, 1720320
    buffer_load_dwordx4 a[128:131], v62, s[32:35], s58 offen sc1
    s_add_u32 s58, s20, 1843200
    buffer_load_dwordx4 a[132:135], v62, s[32:35], s58 offen sc1
    v_mfma_f32_16x16x32_bf16 v[136:139], v[58:61], v[12:15], 0
    v_mfma_f32_16x16x32_bf16 v[140:143], v[56:59], v[12:15], 0
    v_mfma_f32_16x16x32_bf16 v[136:139], v[58:61], a[4:7], v[136:139]
    v_mfma_f32_16x16x32_bf16 v[140:143], v[56:59], a[4:7], v[140:143]
    v_mfma_f32_16x16x32_bf16 v[136:139], v[58:61], a[8:11], v[136:139]
    v_mfma_f32_16x16x32_bf16 v[140:143], v[56:59], a[8:11], v[140:143]
    v_mfma_f32_16x16x32_bf16 v[136:139], v[58:61], a[12:15], v[136:139]
    v_mfma_f32_16x16x32_bf16 v[140:143], v[56:59], a[12:15], v[140:143]
    v_mfma_f32_16x16x32_bf16 v[136:139], v[58:61], a[16:19], v[136:139]
    v_mfma_f32_16x16x32_bf16 v[140:143], v[56:59], a[16:19], v[140:143]
    s_waitcnt vmcnt(25)
    v_mfma_f32_16x16x32_bf16 v[136:139], v[58:61], a[20:23], v[136:139]
    v_mfma_f32_16x16x32_bf16 v[140:143], v[56:59], a[20:23], v[140:143]
    s_waitcnt vmcnt(24)
    v_mfma_f32_16x16x32_bf16 v[136:139], v[58:61], a[24:27], v[136:139]
    v_mfma_f32_16x16x32_bf16 v[140:143], v[56:59], a[24:27], v[140:143]
    s_waitcnt vmcnt(23)
    v_mfma_f32_16x16x32_bf16 v[136:139], v[58:61], a[28:31], v[136:139]
    v_mfma_f32_16x16x32_bf16 v[140:143], v[56:59], a[28:31], v[140:143]
    s_waitcnt vmcnt(22)
    v_mfma_f32_16x16x32_bf16 v[136:139], v[58:61], a[32:35], v[136:139]
    v_mfma_f32_16x16x32_bf16 v[140:143], v[56:59], a[32:35], v[140:143]
    s_waitcnt vmcnt(21)
    v_mfma_f32_16x16x32_bf16 v[136:139], v[58:61], a[36:39], v[136:139]
    v_mfma_f32_16x16x32_bf16 v[140:143], v[56:59], a[36:39], v[140:143]
    s_waitcnt vmcnt(20)
    v_mfma_f32_16x16x32_bf16 v[136:139], v[58:61], a[40:43], v[136:139]
    v_mfma_f32_16x16x32_bf16 v[140:143], v[56:59], a[40:43], v[140:143]
    s_waitcnt vmcnt(19)
    v_mfma_f32_16x16x32_bf16 v[136:139], v[58:61], a[44:47], v[136:139]
    v_mfma_f32_16x16x32_bf16 v[140:143], v[56:59], a[44:47], v[140:143]
    s_waitcnt vmcnt(18)
    v_mfma_f32_16x16x32_bf16 v[136:139], v[58:61], a[48:51], v[136:139]
    v_mfma_f32_16x16x32_bf16 v[140:143], v[56:59], a[48:51], v[140:143]
    s_waitcnt vmcnt(17)
    v_mfma_f32_16x16x32_bf16 v[136:139], v[58:61], a[52:55], v[136:139]
    v_mfma_f32_16x16x32_bf16 v[140:143], v[56:59], a[52:55], v[140:143]
    s_waitcnt vmcnt(16)
    v_mfma_f32_16x16x32_bf16 v[136:139], v[58:61], a[56:59], v[136:139]
    v_mfma_f32_16x16x32_bf16 v[140:143], v[56:59], a[56:59], v[140:143]
    s_waitcnt vmcnt(15)
    v_mfma_f32_16x16x32_bf16 v[136:139], v[58:61], a[60:63], v[136:139]
    v_mfma_f32_16x16x32_bf16 v[140:143], v[56:59], a[60:63], v[140:143]
    v_mfma_f32_16x16x32_bf16 v[144:147], v[58:61], v[16:19], 0
    v_mfma_f32_16x16x32_bf16 v[148:151], v[56:59], v[16:19], 0
    s_nop 4
    v_cvt_pk_bf16_f32 v136, v136, v137
    v_cvt_pk_bf16_f32 v137, v138, v139
    s_waitcnt vmcnt(14)
    v_mfma_f32_16x16x32_bf16 v[144:147], v[58:61], a[76:79], v[144:147]
    v_cvt_pk_bf16_f32 v138, v140, v141
    v_cvt_pk_bf16_f32 v139, v142, v143
    v_mfma_f32_16x16x32_bf16 v[148:151], v[56:59], a[76:79], v[148:151]
    v_permlane16_swap_b32 v136, v138
    v_permlane16_swap_b32 v137, v139
    s_waitcnt vmcnt(13)
    v_mfma_f32_16x16x32_bf16 v[144:147], v[58:61], a[80:83], v[144:147]
    buffer_store_dwordx4 v[136:139], v29, s[36:39], 0 offen sc1
    v_mfma_f32_16x16x32_bf16 v[148:151], v[56:59], a[80:83], v[148:151]
    s_waitcnt vmcnt(13)
    v_mfma_f32_16x16x32_bf16 v[144:147], v[58:61], a[84:87], v[144:147]
    v_mfma_f32_16x16x32_bf16 v[148:151], v[56:59], a[84:87], v[148:151]
    s_waitcnt vmcnt(12)
    v_mfma_f32_16x16x32_bf16 v[144:147], v[58:61], a[88:91], v[144:147]
    v_mfma_f32_16x16x32_bf16 v[148:151], v[56:59], a[88:91], v[148:151]
    s_waitcnt vmcnt(11)
    v_mfma_f32_16x16x32_bf16 v[144:147], v[58:61], a[92:95], v[144:147]
    v_mfma_f32_16x16x32_bf16 v[148:151], v[56:59], a[92:95], v[148:151]
    s_waitcnt vmcnt(10)
    v_mfma_f32_16x16x32_bf16 v[144:147], v[58:61], a[96:99], v[144:147]
    v_mfma_f32_16x16x32_bf16 v[148:151], v[56:59], a[96:99], v[148:151]
    s_waitcnt vmcnt(9)
    v_mfma_f32_16x16x32_bf16 v[144:147], v[58:61], a[100:103], v[144:147]
    v_mfma_f32_16x16x32_bf16 v[148:151], v[56:59], a[100:103], v[148:151]
    s_waitcnt vmcnt(8)
    v_mfma_f32_16x16x32_bf16 v[144:147], v[58:61], a[104:107], v[144:147]
    v_mfma_f32_16x16x32_bf16 v[148:151], v[56:59], a[104:107], v[148:151]
    s_waitcnt vmcnt(7)
    v_mfma_f32_16x16x32_bf16 v[144:147], v[58:61], a[108:111], v[144:147]
    v_mfma_f32_16x16x32_bf16 v[148:151], v[56:59], a[108:111], v[148:151]
    s_waitcnt vmcnt(6)
    v_mfma_f32_16x16x32_bf16 v[144:147], v[58:61], a[112:115], v[144:147]
    v_mfma_f32_16x16x32_bf16 v[148:151], v[56:59], a[112:115], v[148:151]
    s_waitcnt vmcnt(5)
    v_mfma_f32_16x16x32_bf16 v[144:147], v[58:61], a[116:119], v[144:147]
    v_mfma_f32_16x16x32_bf16 v[148:151], v[56:59], a[116:119], v[148:151]
    s_waitcnt vmcnt(4)
    v_mfma_f32_16x16x32_bf16 v[144:147], v[58:61], a[120:123], v[144:147]
    v_mfma_f32_16x16x32_bf16 v[148:151], v[56:59], a[120:123], v[148:151]
    s_waitcnt vmcnt(3)
    v_mfma_f32_16x16x32_bf16 v[144:147], v[58:61], a[124:127], v[144:147]
    v_mfma_f32_16x16x32_bf16 v[148:151], v[56:59], a[124:127], v[148:151]
    s_waitcnt vmcnt(2)
    v_mfma_f32_16x16x32_bf16 v[144:147], v[58:61], a[128:131], v[144:147]
    v_mfma_f32_16x16x32_bf16 v[148:151], v[56:59], a[128:131], v[148:151]
    s_waitcnt vmcnt(1)
    v_mfma_f32_16x16x32_bf16 v[144:147], v[58:61], a[132:135], v[144:147]
    v_mfma_f32_16x16x32_bf16 v[148:151], v[56:59], a[132:135], v[148:151]
    s_nop 6
    v_cvt_pk_bf16_f32 v144, v144, v145
    v_cvt_pk_bf16_f32 v145, v146, v147
    v_cvt_pk_bf16_f32 v146, v148, v149
    v_cvt_pk_bf16_f32 v147, v150, v151
    s_nop 0
    v_permlane16_swap_b32 v144, v146
    v_permlane16_swap_b32 v145, v147
    buffer_store_dwordx4 v[144:147], v0, s[36:39], 0 offen sc1
    s_endpgm
LB_slow0:
    s_mov_b32 s3, 524288
LB_spin0:
    buffer_load_dwordx4 v[56:59], off, s[40:43], 0 sc1
    s_waitcnt vmcnt(0)
    v_and_b32 v56, v56, v57
    v_and_b32 v58, v58, v59
    v_and_b32 v56, v56, v58
    s_nop 0
    v_readfirstlane_b32 s47, v56
    s_nop 0
    s_cmp_eq_u32 s47, 0x1
    s_cbranch_scc1 LB_back0
    s_sub_u32 s3, s3, 1
    s_cmp_lg_u32 s3, 0
    s_cbranch_scc1 LB_spin0
    s_branch LB_back0
LB_ps0:
    s_mov_b32 s3, 524288
LB_poll0:
    buffer_load_dword v6, v30, s[32:35], s9 offen sc1
    s_waitcnt vmcnt(0)
    v_cmp_ne_u32 vcc, s11, v6
    s_sub_u32 s3, s3, 1
    s_cbranch_scc1 LB_backp0
    s_nop 1
    s_cbranch_vccnz LB_poll0
    s_branch LB_backp0
LB_ps1:
    s_mov_b32 s3, 524288
LB_poll1:
    buffer_load_dword v7, v30, s[32:35], s21 offen sc1
    s_waitcnt vmcnt(0)
    v_cmp_ne_u32 vcc, s11, v7
    s_sub_u32 s3, s3, 1
    s_cbranch_scc1 LB_backp1
    s_nop 1
    s_cbranch_vccnz LB_poll1
    s_branch LB_backp1
LB_code_end:
.p2align 6
L_second:
    v_lshrrev_b32 v48, 6, v0
    v_and_b32 v34, 63, v0
    v_readfirstlane_b32 s48, v48
    s_getpc_b64 s[4:5]
    s_bfe_u32 s58, s2, 196611
    s_lshl_b32 s58, 1, s58
    s_sub_u32 s58, s58, 1
    s_and_b32 s58, s58, 85
    s_bcnt1_i32_b32 s58, s58
    s_lshr_b32 s59, s2, 6
    s_mul_i32 s59, s59, 4
    s_add_u32 s58, s58, s59
    s_lshl_b32 s58, s58, 2
    s_add_u32 s58, s58, s48
    s_mul_i32 s58, s58, 4
    v_min_u32 v62, 3, v34
    v_add_u32 v62, s58, v62
    v_min_u32 v62, 486, v62
    v_lshlrev_b32 v62, 7, v62
    v_mov_b32 v63, s5
    v_add_co_u32 v62, vcc, s4, v62
    v_addc_co_u32 v63, vcc, 0, v63, vcc
    global_load_dword v36, v[62:63], off
    s_and_b32 s57, s2, 7
    s_lshr_b32 s58, s2, 3
    s_lshr_b32 s53, s57, 2
    s_and_b32 s54, s57, 3
    s_and_b32 s55, s58, 7
    s_lshr_b32 s56, s58, 3
    s_lshr_b32 s49, s48, 1
    s_and_b32 s50, s48, 1
    s_mul_i32 s51, s48, 3072
    v_lshlrev_b32 v1, 4, v34
    s_mov_b32 s52, 0x3dd53b95
    v_lshrrev_b32 v48, 3, v34
    v_and_b32 v49, 7, v34
    v_and_b32 v53, 6, v48
    v_xor_b32 v53, v53, v49
    v_lshlrev_b32 v53, 4, v53
    v_mul_u32_u24 v8, 1280, v48
    s_mul_i32 s58, s48, 30720
    v_add3_u32 v8, v8, v53, s58
    v_add_u32 v9, 9216, v8
    v_add_u32 v10, 18432, v8
    v_add_u32 v50, 0, v48
    v_mul_u32_u24 v51, 43, v50
    v_lshrrev_b32 v51, 7, v51
    v_mul_u32_u24 v52, 3, v51
    v_sub_u32 v52, v50, v52
    s_lshl_b32 s58, s50, 2
    v_and_b32 v53, 2, v51
    v_or_b32 v53, s58, v53
    v_xor_b32 v53, v53, v49
    v_lshlrev_b32 v53, 4, v53
    v_lshl_add_u32 v53, v52, 7, v53
    v_mul_u32_u24 v5, 12288, v51
    s_mul_i32 s58, s48, 98304
    s_sub_u32 s58, s58, 0
    v_add3_u32 v5, v5, v53, s58
    v_add_u32 v50, 8, v48
    v_mul_u32_u24 v51, 43, v50
    v_lshrrev_b32 v51, 7, v51
    v_mul_u32_u24 v52, 3, v51
    v_sub_u32 v52, v50, v52
    s_lshl_b32 s58, s50, 2
    v_and_b32 v53, 2, v51
    v_or_b32 v53, s58, v53
    v_xor_b32 v53, v53, v49
    v_lshlrev_b32 v53, 4, v53
    v_lshl_add_u32 v53, v52, 7, v53
    v_mul_u32_u24 v6, 12288, v51
    s_mul_i32 s58, s48, 98304
    s_sub_u32 s58, s58, 1024
    v_add3_u32 v6, v6, v53, s58
    v_add_u32 v50, 16, v48
    v_mul_u32_u24 v51, 43, v50
    v_lshrrev_b32 v51, 7, v51
    v_mul_u32_u24 v52, 3, v51
    v_sub_u32 v52, v50, v52
    s_lshl_b32 s58, s50, 2
    v_and_b32 v53, 2, v51
    v_or_b32 v53, s58, v53
    v_xor_b32 v53, v53, v49
    v_lshlrev_b32 v53, 4, v53
    v_lshl_add_u32 v53, v52, 7, v53
    v_mul_u32_u24 v7, 12288, v51
    s_mul_i32 s58, s48, 98304
    s_sub_u32 s58, s58, 2048
    v_add3_u32 v7, v7, v53, s58
    s_mul_i32 s59, s54, 4
    s_mul_i32 s63, s56, 1
    s_add_u32 s63, s59, s63
    s_mul_i32 s61, s56, 3
    s_lshr_b32 s59, s55, 1
    s_mul_i32 s59, s59, 5
    s_lshr_b32 s59, s59, 1
    s_add_u32 s61, s61, s59
    s_mul_i32 s59, s61, 26
    s_lshr_b32 s59, s59, 8
    s_mul_i32 s59, s59, 10
    s_sub_u32 s61, s61, s59
    s_lshl_b32 s61, s61, 7
    s_waitcnt lgkmcnt(0)
    s_mul_i32 s58, s55, 122880
    s_cmp_eq_u32 s53, 0
    s_cselect_b64 s[8:9], s[64:65], s[74:75]
    s_add_u32 s8, s8, s58
    s_addc_u32 s9, s9, 0
    s_mov_b32 s10, 122880
    s_mov_b32 s11, 0x00020000
    s_mul_i32 s58, s63, 384
    s_cmp_eq_u32 s53, 0
    s_cselect_b64 s[20:21], s[70:71], s[80:81]
    s_add_u32 s20, s20, s58
    s_addc_u32 s21, s21, 0
    s_sub_u32 s22, 7864320, s58
    s_mov_b32 s23, 0x00020000
    v_lshrrev_b32 v56, 4, v34
    v_and_b32 v57, 15, v34
    v_and_b32 v58, 1, v56
    v_lshlrev_b32 v58, 1, v58
    v_lshrrev_b32 v60, 3, v57
    v_or_b32 v58, v58, v60
    v_lshlrev_b32 v58, 5, v58
    v_and_b32 v60, 3, v57
    s_mul_i32 s58, s48, 3
    v_lshl_add_u32 v58, v60, 3, v58
    s_add_u32 s60, s58, 0
    v_lshrrev_b32 v60, 2, v57
    s_and_b32 s60, s60, 3
    v_lshl_add_u32 v59, v56, 3, v60
    s_lshl_b32 s60, s60, 5
    v_xor_b32 v60, s60, v58
    s_add_u32 s60, s58, 0
    s_lshr_b32 s60, s60, 2
    s_mov_b32 s59, 0
    s_lshl_b32 s60, s60, 7
    v_mul_u32_u24 v59, 384, v59
    s_add_u32 s60, s60, s59
    v_add3_u32 v24, v60, v59, s60
    s_add_u32 s60, s58, 1
    s_and_b32 s60, s60, 3
    s_lshl_b32 s60, s60, 5
    v_xor_b32 v60, s60, v58
    s_add_u32 s60, s58, 1
    s_lshr_b32 s60, s60, 2
    s_lshl_b32 s60, s60, 7
    s_add_u32 s60, s60, s59
    v_add3_u32 v37, v60, v59, s60
    s_add_u32 s60, s58, 2
    s_and_b32 s60, s60, 3
    s_lshl_b32 s60, s60, 5
    v_xor_b32 v60, s60, v58
    s_add_u32 s60, s58, 2
    s_lshr_b32 s60, s60, 2
    s_lshl_b32 s60, s60, 7
    s_add_u32 s60, s60, s59
    s_lshl_b32 s59, s55, 5
    s_add_u32 s59, s59, s63
    s_cmp_eq_u32 s53, 0
    s_cselect_b64 s[12:13], s[66:67], s[76:77]
    s_cmp_eq_u32 s53, 0
    s_cselect_b64 s[16:17], s[68:69], s[78:79]
    s_mul_i32 s58, s59, 196608
    s_add_u32 m0, s51, 147456
    s_add_u32 s12, s12, s58
    s_addc_u32 s13, s13, 0
    buffer_load_dwordx4 v8, s[8:11], s61 offen lds
    s_add_u32 s16, s16, s58
    s_addc_u32 s17, s17, 0
    buffer_load_dwordx4 v9, s[8:11], s61 offen offset:1024 lds
    s_cmp_eq_u32 s53, 0
    s_cselect_b64 s[24:25], s[72:73], s[82:83]
    buffer_load_dwordx4 v10, s[8:11], s61 offen offset:2048 lds
    s_mul_i32 s58, s63, 245760
    s_add_u32 s24, s24, s58
    s_addc_u32 s25, s25, 0
    s_lshl_b32 s59, s53, 3
    s_add_u32 s59, s59, s55
    s_mul_i32 s58, s59, 1982464
    s_add_u32 s32, s88, s58
    s_addc_u32 s33, s89, 0
    s_mul_i32 s62, s61, 6144
    v_add3_u32 v38, v60, v59, s60
    s_add_u32 s57, s62, 0
    s_add_u32 m0, s51, 73728
    v_and_b32 v60, 6, v57
    s_lshl_b32 s58, s59, 4
    v_xor_b32 v60, v60, v56
    s_add_u32 s40, s86, s58
    s_addc_u32 s41, s87, 0
    buffer_load_dwordx4 v5, s[20:23], s57 offen lds
    v_lshlrev_b32 v60, 4, v60
    v_lshl_add_u32 v60, v57, 7, v60
    s_mul_i32 s58, s55, 245760
    s_mul_i32 s59, s53, 1280
    buffer_load_dwordx4 v6, s[20:23], s57 offen offset:1024 lds
    v_lshrrev_b32 v56, 4, v34
    v_add_u32 v25, 98304, v60
    s_add_u32 s58, s58, s59
    v_and_b32 v57, 15, v34
    v_and_b32 v58, 1, v56
    s_add_u32 s36, s84, s58
    s_addc_u32 s37, s85, 0
    buffer_load_dwordx4 v7, s[20:23], s57 offen offset:2048 lds
    v_lshlrev_b32 v58, 1, v58
    v_lshrrev_b32 v60, 3, v57
    v_or_b32 v58, v58, v60
    v_lshlrev_b32 v58, 5, v58
    v_and_b32 v60, 3, v57
    s_mul_i32 s58, s50, 6
    s_add_u32 s57, s62, 6144
    s_add_u32 m0, s51, 86016
    v_lshl_add_u32 v58, v60, 3, v58
    s_add_u32 s60, s58, 0
    v_lshrrev_b32 v60, 2, v57
    s_and_b32 s60, s60, 3
    v_lshl_add_u32 v59, v56, 2, v60
    s_lshl_b32 s60, s60, 5
    v_xor_b32 v60, s60, v58
    s_add_u32 s60, s58, 0
    s_lshr_b32 s60, s60, 2
    buffer_load_dwordx4 v5, s[20:23], s57 offen lds
    s_mul_i32 s59, s50, 12288
    s_lshl_b32 s60, s60, 7
    buffer_load_dwordx4 v6, s[20:23], s57 offen offset:1024 lds
    v_mul_u32_u24 v59, 384, v59
    s_add_u32 s60, s60, s59
    v_add3_u32 v13, v60, v59, s60
    s_add_u32 s60, s58, 1
    s_and_b32 s60, s60, 3
    buffer_load_dwordx4 v7, s[20:23], s57 offen offset:2048 lds
    s_add_u32 s57, s62, 393216
    s_add_u32 m0, s51, 98304
    s_lshl_b32 s60, s60, 5
    buffer_load_dwordx4 v5, s[20:23], s57 offen lds
    v_xor_b32 v60, s60, v58
    s_add_u32 s60, s58, 1
    s_lshr_b32 s60, s60, 2
    buffer_load_dwordx4 v6, s[20:23], s57 offen offset:1024 lds
    s_lshl_b32 s60, s60, 7
    s_add_u32 s60, s60, s59
    buffer_load_dwordx4 v7, s[20:23], s57 offen offset:2048 lds
    s_add_u32 s57, s62, 399360
    s_add_u32 m0, s51, 110592
    v_add3_u32 v14, v60, v59, s60
    s_add_u32 s60, s58, 2
    s_and_b32 s60, s60, 3
    buffer_load_dwordx4 v5, s[20:23], s57 offen lds
    s_lshl_b32 s60, s60, 5
    v_xor_b32 v60, s60, v58
    s_add_u32 s60, s58, 2
    s_lshr_b32 s60, s60, 2
    buffer_load_dwordx4 v6, s[20:23], s57 offen offset:1024 lds
    s_lshl_b32 s60, s60, 7
    s_add_u32 s60, s60, s59
    buffer_load_dwordx4 v7, s[20:23], s57 offen offset:2048 lds
    v_add3_u32 v15, v60, v59, s60
    s_add_u32 s60, s58, 3
    s_and_b32 s60, s60, 3
    s_lshl_b32 s60, s60, 5
    v_xor_b32 v60, s60, v58
    s_add_u32 s60, s58, 3
    s_lshr_b32 s60, s60, 2
    s_lshl_b32 s60, s60, 7
    s_add_u32 s60, s60, s59
    v_add3_u32 v16, v60, v59, s60
    s_mul_i32 s58, s50, 4294942720
    v_and_b32 v60, 6, v57
    s_add_u32 s58, s58, 12288
    v_xor_b32 v60, v60, v56
    v_add_u32 v17, s58, v13
    v_add_u32 v18, s58, v14
    v_add_u32 v19, s58, v15
    v_add_u32 v20, s58, v16
    v_lshlrev_b32 v60, 4, v60
    v_mul_u32_u24 v11, 384, v57
    v_add3_u32 v11, v11, v60, s59
    s_add_u32 s58, s51, 135168
    v_add_u32 v27, s58, v1
    s_xor_b32 s59, s48, 1
    s_mul_i32 s58, s59, 3072
    v_lshrrev_b32 v48, 3, v34
    s_add_u32 s58, s58, 135168
    v_add_u32 v50, 0, v48
    v_add_u32 v28, s58, v1
    v_mul_u32_u24 v51, 43, v50
    s_lshl_b32 s58, s48, 10
    v_lshrrev_b32 v51, 7, v51
    s_add_u32 s58, s58, 159744
    v_mul_u32_u24 v52, 3, v51
    v_add_u32 v31, s58, v1
    v_sub_u32 v52, v50, v52
    v_lshrrev_b32 v60, 1, v56
    s_mul_i32 s58, s49, 18432
    v_and_b32 v49, 7, v34
    v_and_b32 v53, 6, v51
    v_add_u32 v50, 8, v48
    v_lshlrev_b32 v60, 8, v60
    s_add_u32 s58, s58, 73728
    v_xor_b32 v53, v53, v49
    v_mul_u32_u24 v51, 43, v50
    v_lshl_add_u32 v60, v57, 4, v60
    v_and_b32 v29, 1, v56
    v_add_u32 v30, s58, v1
    s_mul_i32 s59, s50, 3072
    v_lshlrev_b32 v53, 4, v53
    v_lshrrev_b32 v51, 7, v51
    v_lshl_add_u32 v29, v29, 3, v60
    s_add_u32 s58, s58, s59
    v_lshl_add_u32 v2, v48, 7, v53
    v_mul_u32_u24 v52, 3, v51
    v_add_u32 v29, s58, v29
    v_sub_u32 v52, v50, v52
    v_and_b32 v53, 6, v51
    s_mul_i32 s58, s50, 18432
    s_mul_i32 s59, s49, 3072
    v_xor_b32 v53, v53, v49
    v_add_u32 v50, 16, v48
    s_add_u32 s58, s58, s59
    v_lshlrev_b32 v53, 4, v53
    v_mul_u32_u24 v51, 43, v50
    v_add_u32 v33, s58, v1
    v_lshl_add_u32 v3, v48, 7, v53
    v_lshrrev_b32 v51, 7, v51
    s_mul_i32 s58, s49, 4294951936
    s_mul_i32 s59, s50, 4294965760
    v_and_b32 v53, 6, v51
    s_add_u32 s58, s58, s59
    v_xor_b32 v53, v53, v49
    v_add_u32 v29, s58, v29
    v_lshlrev_b32 v53, 4, v53
    s_mul_i32 s58, s49, 3072
    s_lshl_b32 s46, s54, 2
    v_mul_u32_u24 v52, 3, v51
    v_lshl_add_u32 v4, v48, 7, v53
    v_cmp_eq_u32 vcc, 0, v34
    v_bfrev_b32 v47, 1
    v_mov_b32 v60, 0x3f803f80
    s_add_u32 s58, s58, 98304
    v_add_u32 v21, 73728, v24
    v_add_u32 v22, 73728, v37
    v_add_u32 v23, 73728, v38
    v_xor_b32 v26, 64, v25
    s_mov_b32 s14, 3342336
    s_mov_b32 s15, 0x00020000
    s_mov_b32 s18, 3342336
    s_mov_b32 s19, 0x00020000
    s_mov_b32 s26, 4177920
    s_mov_b32 s27, 0x00020000
    s_mov_b32 s34, 1982464
    s_mov_b32 s35, 0x00020000
    s_mov_b32 s42, 16
    s_mov_b32 s43, 0x00020000
    s_mov_b32 s38, 244480
    s_mov_b32 s39, 0x00020000
    s_add_u32 s46, s46, s56
    s_mul_i32 s44, s55, 128
    v_add_u32 v2, s51, v2
    v_add_u32 v3, s51, v3
    v_sub_u32 v52, v50, v52
    v_add_u32 v4, s51, v4
    v_cndmask_b32 v47, v47, v34, vcc
    v_xor_b32 v12, 64, v11
    v_xor_b32 v32, 1024, v31
    v_mov_b32 v39, 0
    v_accvgpr_write_b32 a156, v60
    v_accvgpr_write_b32 a157, v60
    v_accvgpr_write_b32 a158, v60
    v_accvgpr_write_b32 a159, v60
    v_add_u32 v33, 98304, v33
    v_add_u32 v35, s58, v1
    s_waitcnt vmcnt(6)
    s_barrier
    ds_read_b128 a[208:211], v25 offset:49152
    s_add_u32 s61, s61, 128
    ds_read_b64_tr_b16 a[184:185], v21 offset:0
    s_cmp_eq_u32 s61, 1280
    s_cselect_b32 s61, 0, s61
    ds_read_b64_tr_b16 a[186:187], v21 offset:1536
    ds_read_b128 a[212:215], v25 offset:51200
    s_add_u32 m0, s51, 135168
    s_mul_i32 s62, s61, 6144
    buffer_load_dwordx4 v8, s[8:11], s61 offen lds
    ds_read_b128 a[216:219], v25 offset:53248
    s_add_u32 s57, s62, 0
    s_lshl_b32 s58, s48, 6
    ds_read_b128 a[220:223], v25 offset:55296
    s_lshl_b32 s59, s46, 2
    s_add_u32 s58, s58, s59
    s_add_u32 s65, s58, 1966080
    ds_read_b128 a[224:227], v25 offset:57344
    s_cmp_eq_u32 s58, 0
    s_cselect_b32 s58, 0, 0x40000000
    buffer_load_dwordx4 v9, s[8:11], s61 offen offset:1024 lds
    ds_read_b128 a[228:231], v25 offset:59392
    v_lshlrev_b32 v44, 4, v34
    v_add_u32 v44, s58, v44
    v_mov_b32 v40, 0
    v_mov_b32 v41, 0
    v_mov_b32 v42, 0
    s_waitcnt lgkmcnt(5)
    v_mfma_f32_16x16x32_bf16 a[0:3], a[184:187], a[208:211], 0
    s_add_u32 s45, s44, 1024
    ds_read_b64_tr_b16 a[188:189], v22 offset:0
    ds_read_b64_tr_b16 a[190:191], v22 offset:1536
    s_waitcnt lgkmcnt(6)
    v_mfma_f32_16x16x32_bf16 a[4:7], a[184:187], a[212:215], 0
    s_lshr_b32 s59, s2, 6
    ds_read_b64_tr_b16 a[192:193], v23 offset:0
    ds_read_b64_tr_b16 a[194:195], v23 offset:1536
    s_waitcnt lgkmcnt(7)
    v_mfma_f32_16x16x32_bf16 a[8:11], a[184:187], a[216:219], 0
    s_mul_i32 s59, s59, 4
    buffer_load_dwordx4 v10, s[8:11], s61 offen offset:2048 lds
    s_waitcnt lgkmcnt(6)
    v_mfma_f32_16x16x32_bf16 a[12:15], a[184:187], a[220:223], 0
    s_add_u32 m0, s51, 122880
    ds_read_b64_tr_b16 a[196:197], v21 offset:12288
    ds_read_b64_tr_b16 a[198:199], v21 offset:13824
    s_waitcnt lgkmcnt(7)
    v_mfma_f32_16x16x32_bf16 a[16:19], a[184:187], a[224:227], 0
    s_add_u32 s61, s61, 128
    ds_read_b64_tr_b16 a[200:201], v22 offset:12288
    ds_read_b64_tr_b16 a[202:203], v22 offset:13824
    s_waitcnt lgkmcnt(8)
    v_mfma_f32_16x16x32_bf16 a[20:23], a[184:187], a[228:231], 0
    s_waitcnt lgkmcnt(7)
    buffer_load_dwordx4 v5, s[20:23], s57 offen lds
    ds_read_b64_tr_b16 a[204:205], v23 offset:12288
    ds_read_b64_tr_b16 a[206:207], v23 offset:13824
    ds_read_b128 a[232:235], v26 offset:49152
    s_waitcnt lgkmcnt(9)
    v_mfma_f32_16x16x32_bf16 a[24:27], a[188:191], a[208:211], 0
    v_mov_b32 v43, 0
    v_add_u32 v45, s58, v47
    v_mfma_f32_16x16x32_bf16 a[28:31], a[188:191], a[212:215], 0
    s_lshl_b32 s58, s50, 1
    ds_read_b128 a[236:239], v26 offset:51200
    v_lshrrev_b32 v56, 4, v34
    v_mfma_f32_16x16x32_bf16 a[32:35], a[188:191], a[216:219], 0
    buffer_load_dwordx4 v6, s[20:23], s57 offen offset:1024 lds
    v_mfma_f32_16x16x32_bf16 a[36:39], a[188:191], a[220:223], 0
    ds_read_b128 a[240:243], v26 offset:53248
    v_bfe_u32 v57, v34, 2, 2
    v_mfma_f32_16x16x32_bf16 a[40:43], a[188:191], a[224:227], 0
    ds_read_b128 a[244:247], v26 offset:55296
    v_lshl_add_u32 v57, v56, 2, v57
    v_mfma_f32_16x16x32_bf16 a[44:47], a[188:191], a[228:231], 0
    s_waitcnt lgkmcnt(5)
    buffer_load_dwordx4 v7, s[20:23], s57 offen offset:2048 lds
    v_mfma_f32_16x16x32_bf16 a[48:51], a[192:195], a[208:211], 0
    s_add_u32 s57, s62, 6144
    s_add_u32 m0, s51, 61440
    ds_read_b128 a[248:251], v26 offset:57344
    v_mfma_f32_16x16x32_bf16 a[52:55], a[192:195], a[212:215], 0
    ds_read_b128 a[252:255], v26 offset:59392
    v_bfe_u32 v58, v57, 1, 2
    v_mfma_f32_16x16x32_bf16 a[56:59], a[192:195], a[216:219], 0
    buffer_load_dwordx4 v5, s[20:23], s57 offen lds
    v_mfma_f32_16x16x32_bf16 a[60:63], a[192:195], a[220:223], 0
    buffer_store_dwordx4 v[40:43], v44, s[32:35], s65 offen sc1
    v_mfma_f32_16x16x32_bf16 a[64:67], a[192:195], a[224:227], 0
    s_cmp_eq_u32 s61, 1280
    s_cselect_b32 s61, 0, s61
    v_mov_b32 v40, 1
    v_mfma_f32_16x16x32_bf16 a[68:71], a[192:195], a[228:231], 0
    buffer_load_dwordx4 v6, s[20:23], s57 offen offset:1024 lds
    v_mfma_f32_16x16x32_bf16 a[72:75], a[196:199], a[208:211], 0
    v_mov_b32 v41, 1
    v_mov_b32 v42, 1
    v_mfma_f32_16x16x32_bf16 a[76:79], a[196:199], a[212:215], 0
    v_mov_b32 v43, 1
    v_xor_b32 v58, s58, v58
    v_mfma_f32_16x16x32_bf16 a[80:83], a[196:199], a[216:219], 0
    s_bfe_u32 s58, s2, 196611
    buffer_load_dwordx4 v7, s[20:23], s57 offen offset:2048 lds
    v_mfma_f32_16x16x32_bf16 a[84:87], a[196:199], a[220:223], 0
    s_add_u32 s57, s62, 393216
    s_waitcnt vmcnt(10) lgkmcnt(0)
    s_barrier
    v_mfma_f32_16x16x32_bf16 a[88:91], a[196:199], a[224:227], 0
    s_add_u32 m0, s51, 73728
    ds_read_b64_tr_b16 a[184:185], v21 offset:24576
    ds_read_b64_tr_b16 a[186:187], v21 offset:26112
    v_mfma_f32_16x16x32_bf16 a[92:95], a[196:199], a[228:231], 0
    s_lshl_b32 s58, 1, s58
    ds_read_b64_tr_b16 a[188:189], v22 offset:24576
    ds_read_b64_tr_b16 a[190:191], v22 offset:26112
    v_mfma_f32_16x16x32_bf16 a[96:99], a[200:203], a[208:211], 0
    s_sub_u32 s58, s58, 1
    ds_read_b64_tr_b16 a[192:193], v23 offset:24576
    ds_read_b64_tr_b16 a[194:195], v23 offset:26112
    v_mfma_f32_16x16x32_bf16 a[100:103], a[200:203], a[212:215], 0
    s_and_b32 s58, s58, 85
    ds_read_b64_tr_b16 a[196:197], v21 offset:36864
    ds_read_b64_tr_b16 a[198:199], v21 offset:38400
    v_mfma_f32_16x16x32_bf16 a[104:107], a[200:203], a[216:219], 0
    s_bcnt1_i32_b32 s58, s58
    buffer_load_dwordx4 v5, s[20:23], s57 offen lds
    v_mfma_f32_16x16x32_bf16 a[108:111], a[200:203], a[220:223], 0
    s_add_u32 s58, s58, s59
    s_lshl_b32 s58, s58, 2
    s_add_u32 s58, s58, s48
    v_mfma_f32_16x16x32_bf16 a[112:115], a[200:203], a[224:227], 0
    s_mul_i32 s58, s58, 4
    v_lshlrev_b32 v58, 5, v58
    v_lshl_add_u32 v58, v57, 7, v58
    v_mfma_f32_16x16x32_bf16 a[116:119], a[200:203], a[228:231], 0
    s_add_u32 s58, s58, 8
    ds_read_b64_tr_b16 a[200:201], v22 offset:36864
    ds_read_b64_tr_b16 a[202:203], v22 offset:38400
    v_mfma_f32_16x16x32_bf16 a[120:123], a[204:207], a[208:211], 0
    s_lshl_b32 s59, s49, 3
    v_min_u32 v62, 3, v34
    v_and_b32 v57, 3, v34
    v_mfma_f32_16x16x32_bf16 a[124:127], a[204:207], a[212:215], 0
    s_add_u32 s59, s59, s46
    buffer_load_dwordx4 v6, s[20:23], s57 offen offset:1024 lds
    v_mfma_f32_16x16x32_bf16 a[128:131], a[204:207], a[216:219], 0
    s_and_b32 s64, s59, 15
    v_add_u32 v62, s58, v62
    v_lshl_add_u32 v58, v57, 3, v58
    v_mfma_f32_16x16x32_bf16 a[132:135], a[204:207], a[220:223], 0
    v_lshlrev_b32 v62, 7, v62
    v_mov_b32 v60, 0
    v_mfma_f32_16x16x32_bf16 a[136:139], a[204:207], a[224:227], 0
    v_mov_b32 v61, 0
    v_mfma_f32_16x16x32_bf16 a[140:143], a[204:207], a[228:231], 0
    s_waitcnt lgkmcnt(2)
    ds_read_b64_tr_b16 a[204:205], v23 offset:36864
    ds_read_b64_tr_b16 a[206:207], v23 offset:38400
    v_mfma_f32_16x16x32_bf16 a[0:3], a[184:187], a[232:235], a[0:3]
    buffer_load_dwordx4 v7, s[20:23], s57 offen offset:2048 lds
    v_mfma_f32_16x16x32_bf16 a[4:7], a[184:187], a[236:239], a[4:7]
    s_add_u32 s57, s62, 399360
    s_add_u32 m0, s51, 86016
    s_mul_i32 s62, s61, 6144
    v_mfma_f32_16x16x32_bf16 a[8:11], a[184:187], a[240:243], a[8:11]
    v_mfma_f32_16x16x32_bf16 a[12:15], a[184:187], a[244:247], a[12:15]
    v_mfma_f32_16x16x32_bf16 a[16:19], a[184:187], a[248:251], a[16:19]
    v_mfma_f32_16x16x32_bf16 a[20:23], a[184:187], a[252:255], a[20:23]
    buffer_load_dwordx4 v5, s[20:23], s57 offen lds
    v_mfma_f32_16x16x32_bf16 a[24:27], a[188:191], a[232:235], a[24:27]
    v_mfma_f32_16x16x32_bf16 a[28:31], a[188:191], a[236:239], a[28:31]
    v_mfma_f32_16x16x32_bf16 a[32:35], a[188:191], a[240:243], a[32:35]
    v_mfma_f32_16x16x32_bf16 a[36:39], a[188:191], a[244:247], a[36:39]
    v_mfma_f32_16x16x32_bf16 a[40:43], a[188:191], a[248:251], a[40:43]
    buffer_load_dwordx4 v6, s[20:23], s57 offen offset:1024 lds
    v_mfma_f32_16x16x32_bf16 a[44:47], a[188:191], a[252:255], a[44:47]
    v_mfma_f32_16x16x32_bf16 a[48:51], a[192:195], a[232:235], a[48:51]
    v_mfma_f32_16x16x32_bf16 a[52:55], a[192:195], a[236:239], a[52:55]
    v_mfma_f32_16x16x32_bf16 a[56:59], a[192:195], a[240:243], a[56:59]
    v_mfma_f32_16x16x32_bf16 a[60:63], a[192:195], a[244:247], a[60:63]
    buffer_load_dwordx4 v7, s[20:23], s57 offen offset:2048 lds
    v_mfma_f32_16x16x32_bf16 a[64:67], a[192:195], a[248:251], a[64:67]
    s_add_u32 m0, s51, 147456
    s_waitcnt vmcnt(6) lgkmcnt(0)
    s_barrier
    v_mfma_f32_16x16x32_bf16 a[68:71], a[192:195], a[252:255], a[68:71]
    s_add_u32 s57, s62, 0
    ds_read_b128 a[208:211], v25 offset:36864
    v_mfma_f32_16x16x32_bf16 a[72:75], a[196:199], a[232:235], a[72:75]
    ds_read_b64_tr_b16 a[184:185], v21 offset:49152
    ds_read_b64_tr_b16 a[186:187], v21 offset:50688
    v_mfma_f32_16x16x32_bf16 a[76:79], a[196:199], a[236:239], a[76:79]
    ds_read_b128 a[212:215], v25 offset:38912
    v_mfma_f32_16x16x32_bf16 a[80:83], a[196:199], a[240:243], a[80:83]
    ds_read_b128 a[216:219], v25 offset:40960
    buffer_load_dwordx4 v8, s[8:11], s61 offen lds
    v_mfma_f32_16x16x32_bf16 a[84:87], a[196:199], a[244:247], a[84:87]
    ds_read_b128 a[220:223], v25 offset:43008
    v_mfma_f32_16x16x32_bf16 a[88:91], a[196:199], a[248:251], a[88:91]
    ds_read_b128 a[224:227], v25 offset:45056
    v_mfma_f32_16x16x32_bf16 a[92:95], a[196:199], a[252:255], a[92:95]
    ds_read_b128 a[228:231], v25 offset:47104
    v_mfma_f32_16x16x32_bf16 a[96:99], a[200:203], a[232:235], a[96:99]
    ds_read_b64_tr_b16 a[188:189], v22 offset:49152
    ds_read_b64_tr_b16 a[190:191], v22 offset:50688
    v_mfma_f32_16x16x32_bf16 a[100:103], a[200:203], a[236:239], a[100:103]
    ds_read_b64_tr_b16 a[192:193], v23 offset:49152
    ds_read_b64_tr_b16 a[194:195], v23 offset:50688
    v_mfma_f32_16x16x32_bf16 a[104:107], a[200:203], a[240:243], a[104:107]
    ds_read_b64_tr_b16 a[196:197], v24 offset:61440
    ds_read_b64_tr_b16 a[198:199], v24 offset:62976
    v_mfma_f32_16x16x32_bf16 a[108:111], a[200:203], a[244:247], a[108:111]
    buffer_load_dwordx4 v9, s[8:11], s61 offen offset:1024 lds
    v_mfma_f32_16x16x32_bf16 a[112:115], a[200:203], a[248:251], a[112:115]
    v_mfma_f32_16x16x32_bf16 a[116:119], a[200:203], a[252:255], a[116:119]
    ds_read_b64_tr_b16 a[200:201], v37 offset:61440
    ds_read_b64_tr_b16 a[202:203], v37 offset:62976
    v_mfma_f32_16x16x32_bf16 a[120:123], a[204:207], a[232:235], a[120:123]
    ds_read_b128 a[232:235], v26 offset:36864
    v_mfma_f32_16x16x32_bf16 a[124:127], a[204:207], a[236:239], a[124:127]
    ds_read_b128 a[236:239], v26 offset:38912
    v_mfma_f32_16x16x32_bf16 a[128:131], a[204:207], a[240:243], a[128:131]
    buffer_load_dwordx4 v10, s[8:11], s61 offen offset:2048 lds
    v_mfma_f32_16x16x32_bf16 a[132:135], a[204:207], a[244:247], a[132:135]
    s_add_u32 m0, s51, 98304
    ds_read_b128 a[240:243], v26 offset:40960
    s_add_u32 s61, s61, 128
    v_mfma_f32_16x16x32_bf16 a[136:139], a[204:207], a[248:251], a[136:139]
    ds_read_b128 a[244:247], v26 offset:43008
    s_cmp_eq_u32 s61, 1280
    s_cselect_b32 s61, 0, s61
    v_mfma_f32_16x16x32_bf16 a[140:143], a[204:207], a[252:255], a[140:143]
    s_waitcnt lgkmcnt(5)
    ds_read_b64_tr_b16 a[204:205], v38 offset:61440
    ds_read_b64_tr_b16 a[206:207], v38 offset:62976
    v_mfma_f32_16x16x32_bf16 a[0:3], a[184:187], a[208:211], a[0:3]
    ds_read_b128 a[248:251], v26 offset:45056
    buffer_load_dwordx4 v5, s[20:23], s57 offen lds
    v_mfma_f32_16x16x32_bf16 a[4:7], a[184:187], a[212:215], a[4:7]
    ds_read_b128 a[252:255], v26 offset:47104
    v_mfma_f32_16x16x32_bf16 a[8:11], a[184:187], a[216:219], a[8:11]
    v_mfma_f32_16x16x32_bf16 a[12:15], a[184:187], a[220:223], a[12:15]
    v_mfma_f32_16x16x32_bf16 a[16:19], a[184:187], a[224:227], a[16:19]
    v_mfma_f32_16x16x32_bf16 a[20:23], a[184:187], a[228:231], a[20:23]
    buffer_load_dwordx4 v6, s[20:23], s57 offen offset:1024 lds
    v_mfma_f32_16x16x32_bf16 a[24:27], a[188:191], a[208:211], a[24:27]
    v_mfma_f32_16x16x32_bf16 a[28:31], a[188:191], a[212:215], a[28:31]
    v_mfma_f32_16x16x32_bf16 a[32:35], a[188:191], a[216:219], a[32:35]
    v_mfma_f32_16x16x32_bf16 a[36:39], a[188:191], a[220:223], a[36:39]
    v_mfma_f32_16x16x32_bf16 a[40:43], a[188:191], a[224:227], a[40:43]
    buffer_load_dwordx4 v7, s[20:23], s57 offen offset:2048 lds
    v_mfma_f32_16x16x32_bf16 a[44:47], a[188:191], a[228:231], a[44:47]
    s_add_u32 s57, s62, 6144
    s_waitcnt vmcnt(6) lgkmcnt(0)
    s_barrier
    v_mfma_f32_16x16x32_bf16 a[48:51], a[192:195], a[208:211], a[48:51]
    s_add_u32 m0, s51, 110592
    ds_read_b64_tr_b16 a[184:185], v21 offset:0
    ds_read_b64_tr_b16 a[186:187], v21 offset:1536
    v_mfma_f32_16x16x32_bf16 a[52:55], a[192:195], a[212:215], a[52:55]
    ds_read_b64_tr_b16 a[188:189], v22 offset:0
    ds_read_b64_tr_b16 a[190:191], v22 offset:1536
    v_mfma_f32_16x16x32_bf16 a[56:59], a[192:195], a[216:219], a[56:59]
    buffer_load_dwordx4 v5, s[20:23], s57 offen lds
    v_mfma_f32_16x16x32_bf16 a[60:63], a[192:195], a[220:223], a[60:63]
    v_mfma_f32_16x16x32_bf16 a[64:67], a[192:195], a[224:227], a[64:67]
    v_mfma_f32_16x16x32_bf16 a[68:71], a[192:195], a[228:231], a[68:71]
    ds_read_b64_tr_b16 a[192:193], v23 offset:0
    ds_read_b64_tr_b16 a[194:195], v23 offset:1536
    v_mfma_f32_16x16x32_bf16 a[72:75], a[196:199], a[208:211], a[72:75]
    buffer_load_dwordx4 v6, s[20:23], s57 offen offset:1024 lds
    v_mfma_f32_16x16x32_bf16 a[76:79], a[196:199], a[212:215], a[76:79]
    v_mfma_f32_16x16x32_bf16 a[80:83], a[196:199], a[216:219], a[80:83]
    v_mfma_f32_16x16x32_bf16 a[84:87], a[196:199], a[220:223], a[84:87]
    buffer_load_dwordx4 v7, s[20:23], s57 offen offset:2048 lds
    v_mfma_f32_16x16x32_bf16 a[88:91], a[196:199], a[224:227], a[88:91]
    s_add_u32 s57, s62, 393216
    s_add_u32 m0, s51, 122880
    v_mfma_f32_16x16x32_bf16 a[92:95], a[196:199], a[228:231], a[92:95]
    ds_read_b64_tr_b16 a[196:197], v21 offset:12288
    ds_read_b64_tr_b16 a[198:199], v21 offset:13824
    v_mfma_f32_16x16x32_bf16 a[96:99], a[200:203], a[208:211], a[96:99]
    buffer_load_dwordx4 v5, s[20:23], s57 offen lds
    v_mfma_f32_16x16x32_bf16 a[100:103], a[200:203], a[212:215], a[100:103]
    v_mfma_f32_16x16x32_bf16 a[104:107], a[200:203], a[216:219], a[104:107]
    v_mfma_f32_16x16x32_bf16 a[108:111], a[200:203], a[220:223], a[108:111]
    buffer_load_dwordx4 v6, s[20:23], s57 offen offset:1024 lds
    v_mfma_f32_16x16x32_bf16 a[112:115], a[200:203], a[224:227], a[112:115]
    v_mfma_f32_16x16x32_bf16 a[116:119], a[200:203], a[228:231], a[116:119]
    ds_read_b64_tr_b16 a[200:201], v22 offset:12288
    ds_read_b64_tr_b16 a[202:203], v22 offset:13824
    v_mfma_f32_16x16x32_bf16 a[120:123], a[204:207], a[208:211], a[120:123]
    buffer_load_dwordx4 v7, s[20:23], s57 offen offset:2048 lds
    v_mfma_f32_16x16x32_bf16 a[124:127], a[204:207], a[212:215], a[124:127]
    s_add_u32 s57, s62, 399360
    s_add_u32 m0, s51, 61440
    s_mul_i32 s62, s61, 6144
    v_mfma_f32_16x16x32_bf16 a[128:131], a[204:207], a[216:219], a[128:131]
    v_mfma_f32_16x16x32_bf16 a[132:135], a[204:207], a[220:223], a[132:135]
    buffer_load_dwordx4 v5, s[20:23], s57 offen lds
    v_mfma_f32_16x16x32_bf16 a[136:139], a[204:207], a[224:227], a[136:139]
    v_mfma_f32_16x16x32_bf16 a[140:143], a[204:207], a[228:231], a[140:143]
    s_waitcnt lgkmcnt(2)
    ds_read_b64_tr_b16 a[204:205], v23 offset:12288
    ds_read_b64_tr_b16 a[206:207], v23 offset:13824
    v_mfma_f32_16x16x32_bf16 a[0:3], a[184:187], a[232:235], a[0:3]
    buffer_load_dwordx4 v6, s[20:23], s57 offen offset:1024 lds
    v_mfma_f32_16x16x32_bf16 a[4:7], a[184:187], a[236:239], a[4:7]
    v_mfma_f32_16x16x32_bf16 a[8:11], a[184:187], a[240:243], a[8:11]
    v_mfma_f32_16x16x32_bf16 a[12:15], a[184:187], a[244:247], a[12:15]
    buffer_load_dwordx4 v7, s[20:23], s57 offen offset:2048 lds
    v_mfma_f32_16x16x32_bf16 a[16:19], a[184:187], a[248:251], a[16:19]
    s_add_u32 m0, s51, 135168
    s_add_u32 s57, s62, 0
    v_mfma_f32_16x16x32_bf16 a[20:23], a[184:187], a[252:255], a[20:23]
    s_waitcnt vmcnt(6) lgkmcnt(0)
    s_barrier
    v_mfma_f32_16x16x32_bf16 a[24:27], a[188:191], a[232:235], a[24:27]
    ds_read_b128 a[208:211], v25 offset:49152
    buffer_load_dwordx4 v8, s[8:11], s61 offen lds
    v_mfma_f32_16x16x32_bf16 a[28:31], a[188:191], a[236:239], a[28:31]
    ds_read_b64_tr_b16 a[184:185], v21 offset:24576
    ds_read_b64_tr_b16 a[186:187], v21 offset:26112
    v_mfma_f32_16x16x32_bf16 a[32:35], a[188:191], a[240:243], a[32:35]
    ds_read_b128 a[212:215], v25 offset:51200
    buffer_load_dwordx4 v9, s[8:11], s61 offen offset:1024 lds
    v_mfma_f32_16x16x32_bf16 a[36:39], a[188:191], a[244:247], a[36:39]
    ds_read_b128 a[216:219], v25 offset:53248
    v_mfma_f32_16x16x32_bf16 a[40:43], a[188:191], a[248:251], a[40:43]
    ds_read_b128 a[220:223], v25 offset:55296
    buffer_load_dwordx4 v10, s[8:11], s61 offen offset:2048 lds
    v_mfma_f32_16x16x32_bf16 a[44:47], a[188:191], a[252:255], a[44:47]
    s_add_u32 m0, s51, 73728
    ds_read_b128 a[224:227], v25 offset:57344
    s_add_u32 s61, s61, 128
    v_mfma_f32_16x16x32_bf16 a[48:51], a[192:195], a[232:235], a[48:51]
    ds_read_b128 a[228:231], v25 offset:59392
    buffer_load_dwordx4 v5, s[20:23], s57 offen lds
    v_mfma_f32_16x16x32_bf16 a[52:55], a[192:195], a[236:239], a[52:55]
    ds_read_b64_tr_b16 a[188:189], v22 offset:24576
    ds_read_b64_tr_b16 a[190:191], v22 offset:26112
    v_mfma_f32_16x16x32_bf16 a[56:59], a[192:195], a[240:243], a[56:59]
    s_cmp_eq_u32 s61, 1280
    s_cselect_b32 s61, 0, s61
    buffer_load_dwordx4 v6, s[20:23], s57 offen offset:1024 lds
    v_mfma_f32_16x16x32_bf16 a[60:63], a[192:195], a[244:247], a[60:63]
    v_mfma_f32_16x16x32_bf16 a[64:67], a[192:195], a[248:251], a[64:67]
    buffer_load_dwordx4 v7, s[20:23], s57 offen offset:2048 lds
    v_mfma_f32_16x16x32_bf16 a[68:71], a[192:195], a[252:255], a[68:71]
    s_add_u32 s57, s62, 6144
    ds_read_b64_tr_b16 a[192:193], v23 offset:24576
    ds_read_b64_tr_b16 a[194:195], v23 offset:26112
    v_mfma_f32_16x16x32_bf16 a[72:75], a[196:199], a[232:235], a[72:75]
    s_add_u32 m0, s51, 86016
    s_nop 0
    buffer_load_dwordx4 v5, s[20:23], s57 offen lds
    v_mfma_f32_16x16x32_bf16 a[76:79], a[196:199], a[236:239], a[76:79]
    v_mfma_f32_16x16x32_bf16 a[80:83], a[196:199], a[240:243], a[80:83]
    buffer_load_dwordx4 v6, s[20:23], s57 offen offset:1024 lds
    v_mfma_f32_16x16x32_bf16 a[84:87], a[196:199], a[244:247], a[84:87]
    v_mfma_f32_16x16x32_bf16 a[88:91], a[196:199], a[248:251], a[88:91]
    buffer_load_dwordx4 v7, s[20:23], s57 offen offset:2048 lds
    v_mfma_f32_16x16x32_bf16 a[92:95], a[196:199], a[252:255], a[92:95]
    s_add_u32 s57, s62, 393216
    ds_read_b64_tr_b16 a[196:197], v21 offset:36864
    ds_read_b64_tr_b16 a[198:199], v21 offset:38400
    v_mfma_f32_16x16x32_bf16 a[96:99], a[200:203], a[232:235], a[96:99]
    s_add_u32 m0, s51, 49152
    s_nop 0
    buffer_load_dwordx4 v5, s[20:23], s57 offen lds
    v_mfma_f32_16x16x32_bf16 a[100:103], a[200:203], a[236:239], a[100:103]
    v_mfma_f32_16x16x32_bf16 a[104:107], a[200:203], a[240:243], a[104:107]
    buffer_load_dwordx4 v6, s[20:23], s57 offen offset:1024 lds
    v_mfma_f32_16x16x32_bf16 a[108:111], a[200:203], a[244:247], a[108:111]
    v_mfma_f32_16x16x32_bf16 a[112:115], a[200:203], a[248:251], a[112:115]
    buffer_load_dwordx4 v7, s[20:23], s57 offen offset:2048 lds
    v_mfma_f32_16x16x32_bf16 a[116:119], a[200:203], a[252:255], a[116:119]
    s_mov_b32 s57, 24576
    ds_read_b64_tr_b16 a[200:201], v22 offset:36864
    ds_read_b64_tr_b16 a[202:203], v22 offset:38400
    v_mfma_f32_16x16x32_bf16 a[120:123], a[204:207], a[232:235], a[120:123]
    s_add_u32 m0, s51, 0
    ds_read_b128 a[232:235], v26 offset:49152
    v_mfma_f32_16x16x32_bf16 a[124:127], a[204:207], a[236:239], a[124:127]
    ds_read_b128 a[236:239], v26 offset:51200
    v_mfma_f32_16x16x32_bf16 a[128:131], a[204:207], a[240:243], a[128:131]
    ds_read_b128 a[240:243], v26 offset:53248
    v_mfma_f32_16x16x32_bf16 a[132:135], a[204:207], a[244:247], a[132:135]
    ds_read_b128 a[244:247], v26 offset:55296
    v_mfma_f32_16x16x32_bf16 a[136:139], a[204:207], a[248:251], a[136:139]
    ds_read_b128 a[248:251], v26 offset:57344
    v_mfma_f32_16x16x32_bf16 a[140:143], a[204:207], a[252:255], a[140:143]
    s_waitcnt lgkmcnt(7)
    ds_read_b64_tr_b16 a[204:205], v23 offset:36864
    ds_read_b64_tr_b16 a[206:207], v23 offset:38400
    v_mfma_f32_16x16x32_bf16 a[0:3], a[184:187], a[208:211], a[0:3]
    ds_read_b128 a[252:255], v26 offset:59392
    v_mfma_f32_16x16x32_bf16 a[4:7], a[184:187], a[212:215], a[4:7]
    v_mfma_f32_16x16x32_bf16 a[8:11], a[184:187], a[216:219], a[8:11]
    v_mfma_f32_16x16x32_bf16 a[12:15], a[184:187], a[220:223], a[12:15]
    v_mfma_f32_16x16x32_bf16 a[16:19], a[184:187], a[224:227], a[16:19]
    v_mfma_f32_16x16x32_bf16 a[20:23], a[184:187], a[228:231], a[20:23]
    s_waitcnt vmcnt(12) lgkmcnt(1)
    s_barrier
    v_mfma_f32_16x16x32_bf16 a[24:27], a[188:191], a[208:211], a[24:27]
    ds_read_b64_tr_b16 a[184:185], v21 offset:49152
    ds_read_b64_tr_b16 a[186:187], v21 offset:50688
    v_mfma_f32_16x16x32_bf16 a[28:31], a[188:191], a[212:215], a[28:31]
    buffer_load_dwordx4 v2, s[12:15], s57 offen nt lds
    v_mfma_f32_16x16x32_bf16 a[32:35], a[188:191], a[216:219], a[32:35]
    v_mfma_f32_16x16x32_bf16 a[36:39], a[188:191], a[220:223], a[36:39]
    v_mfma_f32_16x16x32_bf16 a[40:43], a[188:191], a[224:227], a[40:43]
    v_mfma_f32_16x16x32_bf16 a[44:47], a[188:191], a[228:231], a[44:47]
    ds_read_b64_tr_b16 a[188:189], v22 offset:49152
    ds_read_b64_tr_b16 a[190:191], v22 offset:50688
    v_mfma_f32_16x16x32_bf16 a[48:51], a[192:195], a[208:211], a[48:51]
    buffer_load_dwordx4 v3, s[12:15], s57 offen offset:1024 nt lds
    v_mfma_f32_16x16x32_bf16 a[52:55], a[192:195], a[212:215], a[52:55]
    v_mfma_f32_16x16x32_bf16 a[56:59], a[192:195], a[216:219], a[56:59]
    v_mfma_f32_16x16x32_bf16 a[60:63], a[192:195], a[220:223], a[60:63]
    v_mfma_f32_16x16x32_bf16 a[64:67], a[192:195], a[224:227], a[64:67]
    v_mfma_f32_16x16x32_bf16 a[68:71], a[192:195], a[228:231], a[68:71]
    ds_read_b64_tr_b16 a[192:193], v23 offset:49152
    ds_read_b64_tr_b16 a[194:195], v23 offset:50688
    v_mfma_f32_16x16x32_bf16 a[72:75], a[196:199], a[208:211], a[72:75]
    buffer_load_dwordx4 v4, s[12:15], s57 offen offset:2048 nt lds
    v_mfma_f32_16x16x32_bf16 a[76:79], a[196:199], a[212:215], a[76:79]
    s_add_u32 s57, s62, 399360
    s_add_u32 m0, s51, 98304
    s_mul_i32 s62, s61, 6144
    v_mfma_f32_16x16x32_bf16 a[80:83], a[196:199], a[216:219], a[80:83]
    v_mfma_f32_16x16x32_bf16 a[84:87], a[196:199], a[220:223], a[84:87]
    v_mfma_f32_16x16x32_bf16 a[88:91], a[196:199], a[224:227], a[88:91]
    v_mfma_f32_16x16x32_bf16 a[92:95], a[196:199], a[228:231], a[92:95]
    ds_read_b64_tr_b16 a[196:197], v24 offset:61440
    ds_read_b64_tr_b16 a[198:199], v24 offset:62976
    v_mfma_f32_16x16x32_bf16 a[96:99], a[200:203], a[208:211], a[96:99]
    buffer_load_dwordx4 v5, s[20:23], s57 offen lds
    v_mfma_f32_16x16x32_bf16 a[100:103], a[200:203], a[212:215], a[100:103]
    v_mfma_f32_16x16x32_bf16 a[104:107], a[200:203], a[216:219], a[104:107]
    v_mfma_f32_16x16x32_bf16 a[108:111], a[200:203], a[220:223], a[108:111]
    v_mfma_f32_16x16x32_bf16 a[112:115], a[200:203], a[224:227], a[112:115]
    v_mfma_f32_16x16x32_bf16 a[116:119], a[200:203], a[228:231], a[116:119]
    buffer_load_dwordx4 v6, s[20:23], s57 offen offset:1024 lds
    v_mfma_f32_16x16x32_bf16 a[120:123], a[204:207], a[208:211], a[120:123]
    ds_read_b64_tr_b16 a[200:201], v37 offset:61440
    ds_read_b64_tr_b16 a[202:203], v37 offset:62976
    v_mfma_f32_16x16x32_bf16 a[124:127], a[204:207], a[212:215], a[124:127]
    v_mfma_f32_16x16x32_bf16 a[128:131], a[204:207], a[216:219], a[128:131]
    v_mfma_f32_16x16x32_bf16 a[132:135], a[204:207], a[220:223], a[132:135]
    v_mfma_f32_16x16x32_bf16 a[136:139], a[204:207], a[224:227], a[136:139]
    buffer_load_dwordx4 v7, s[20:23], s57 offen offset:2048 lds
    v_mfma_f32_16x16x32_bf16 a[140:143], a[204:207], a[228:231], a[140:143]
    s_add_u32 m0, s51, 147456
    ds_read_b64_tr_b16 a[204:205], v38 offset:61440
    ds_read_b64_tr_b16 a[206:207], v38 offset:62976
    s_waitcnt lgkmcnt(4)
    v_mfma_f32_16x16x32_bf16 a[0:3], a[184:187], a[232:235], a[0:3]
    s_add_u32 s57, s62, 0
    v_mfma_f32_16x16x32_bf16 a[4:7], a[184:187], a[236:239], a[4:7]
    v_mfma_f32_16x16x32_bf16 a[8:11], a[184:187], a[240:243], a[8:11]
    v_mfma_f32_16x16x32_bf16 a[12:15], a[184:187], a[244:247], a[12:15]
    v_mfma_f32_16x16x32_bf16 a[16:19], a[184:187], a[248:251], a[16:19]
    v_mfma_f32_16x16x32_bf16 a[20:23], a[184:187], a[252:255], a[20:23]
    s_waitcnt vmcnt(9) lgkmcnt(0)
    s_barrier
    v_mfma_f32_16x16x32_bf16 a[24:27], a[188:191], a[232:235], a[24:27]
    ds_read_b128 a[208:211], v25 offset:36864
    buffer_load_dwordx4 v8, s[8:11], s61 offen lds
    v_mfma_f32_16x16x32_bf16 a[28:31], a[188:191], a[236:239], a[28:31]
    ds_read_b64_tr_b16 a[184:185], v21 offset:0
    ds_read_b64_tr_b16 a[186:187], v21 offset:1536
    v_mfma_f32_16x16x32_bf16 a[32:35], a[188:191], a[240:243], a[32:35]
    ds_read_b128 a[212:215], v25 offset:38912
    buffer_load_dwordx4 v9, s[8:11], s61 offen offset:1024 lds
    v_mfma_f32_16x16x32_bf16 a[36:39], a[188:191], a[244:247], a[36:39]
    ds_read_b128 a[216:219], v25 offset:40960
    buffer_store_dwordx4 v[40:43], v45, s[40:43], 0 offen sc1
    v_mfma_f32_16x16x32_bf16 a[40:43], a[188:191], a[248:251], a[40:43]
    ds_read_b128 a[220:223], v25 offset:43008
    buffer_load_dwordx4 v10, s[8:11], s61 offen offset:2048 lds
    v_mfma_f32_16x16x32_bf16 a[44:47], a[188:191], a[252:255], a[44:47]
    s_add_u32 m0, s51, 110592
    ds_read_b128 a[224:227], v25 offset:45056
    s_add_u32 s61, s61, 128
    v_mfma_f32_16x16x32_bf16 a[48:51], a[192:195], a[232:235], a[48:51]
    ds_read_b128 a[228:231], v25 offset:47104
    buffer_load_dwordx4 v5, s[20:23], s57 offen lds
    v_mfma_f32_16x16x32_bf16 a[52:55], a[192:195], a[236:239], a[52:55]
    ds_read_b64_tr_b16 a[188:189], v22 offset:0
    ds_read_b64_tr_b16 a[190:191], v22 offset:1536
    v_mfma_f32_16x16x32_bf16 a[56:59], a[192:195], a[240:243], a[56:59]
    s_cmp_eq_u32 s61, 1280
    s_cselect_b32 s61, 0, s61
    buffer_load_dwordx4 v6, s[20:23], s57 offen offset:1024 lds
    v_mfma_f32_16x16x32_bf16 a[60:63], a[192:195], a[244:247], a[60:63]
    v_mfma_f32_16x16x32_bf16 a[64:67], a[192:195], a[248:251], a[64:67]
    buffer_load_dwordx4 v7, s[20:23], s57 offen offset:2048 lds
    v_mfma_f32_16x16x32_bf16 a[68:71], a[192:195], a[252:255], a[68:71]
    s_add_u32 s57, s62, 6144
    ds_read_b64_tr_b16 a[192:193], v23 offset:0
    ds_read_b64_tr_b16 a[194:195], v23 offset:1536
    v_mfma_f32_16x16x32_bf16 a[72:75], a[196:199], a[232:235], a[72:75]
    s_add_u32 m0, s51, 122880
    s_nop 0
    buffer_load_dwordx4 v5, s[20:23], s57 offen lds
    v_mfma_f32_16x16x32_bf16 a[76:79], a[196:199], a[236:239], a[76:79]
    v_mfma_f32_16x16x32_bf16 a[80:83], a[196:199], a[240:243], a[80:83]
    buffer_load_dwordx4 v6, s[20:23], s57 offen offset:1024 lds
    v_mfma_f32_16x16x32_bf16 a[84:87], a[196:199], a[244:247], a[84:87]
    v_mfma_f32_16x16x32_bf16 a[88:91], a[196:199], a[248:251], a[88:91]
    buffer_load_dwordx4 v7, s[20:23], s57 offen offset:2048 lds
    v_mfma_f32_16x16x32_bf16 a[92:95], a[196:199], a[252:255], a[92:95]
    s_add_u32 s57, s62, 393216
    ds_read_b64_tr_b16 a[196:197], v21 offset:12288
    ds_read_b64_tr_b16 a[198:199], v21 offset:13824
    v_mfma_f32_16x16x32_bf16 a[96:99], a[200:203], a[232:235], a[96:99]
    s_add_u32 m0, s51, 61440
    s_nop 0
    buffer_load_dwordx4 v5, s[20:23], s57 offen lds
    v_mfma_f32_16x16x32_bf16 a[100:103], a[200:203], a[236:239], a[100:103]
    v_mfma_f32_16x16x32_bf16 a[104:107], a[200:203], a[240:243], a[104:107]
    buffer_load_dwordx4 v6, s[20:23], s57 offen offset:1024 lds
    v_mfma_f32_16x16x32_bf16 a[108:111], a[200:203], a[244:247], a[108:111]
    v_mfma_f32_16x16x32_bf16 a[112:115], a[200:203], a[248:251], a[112:115]
    buffer_load_dwordx4 v7, s[20:23], s57 offen offset:2048 lds
    v_mfma_f32_16x16x32_bf16 a[116:119], a[200:203], a[252:255], a[116:119]
    s_mov_b32 s57, 36864
    ds_read_b64_tr_b16 a[200:201], v22 offset:12288
    ds_read_b64_tr_b16 a[202:203], v22 offset:13824
    v_mfma_f32_16x16x32_bf16 a[120:123], a[204:207], a[232:235], a[120:123]
    s_add_u32 m0, s51, 12288
    ds_read_b128 a[232:235], v26 offset:36864
    v_mfma_f32_16x16x32_bf16 a[124:127], a[204:207], a[236:239], a[124:127]
    ds_read_b128 a[236:239], v26 offset:38912
    v_mfma_f32_16x16x32_bf16 a[128:131], a[204:207], a[240:243], a[128:131]
    ds_read_b128 a[240:243], v26 offset:40960
    v_mfma_f32_16x16x32_bf16 a[132:135], a[204:207], a[244:247], a[132:135]
    ds_read_b128 a[244:247], v26 offset:43008
    v_mfma_f32_16x16x32_bf16 a[136:139], a[204:207], a[248:251], a[136:139]
    ds_read_b128 a[248:251], v26 offset:45056
    v_mfma_f32_16x16x32_bf16 a[140:143], a[204:207], a[252:255], a[140:143]
    s_waitcnt lgkmcnt(7)
    ds_read_b64_tr_b16 a[204:205], v23 offset:12288
    ds_read_b64_tr_b16 a[206:207], v23 offset:13824
    v_mfma_f32_16x16x32_bf16 a[0:3], a[184:187], a[208:211], a[0:3]
    ds_read_b128 a[252:255], v26 offset:47104
    v_mfma_f32_16x16x32_bf16 a[4:7], a[184:187], a[212:215], a[4:7]
    v_mfma_f32_16x16x32_bf16 a[8:11], a[184:187], a[216:219], a[8:11]
    v_mfma_f32_16x16x32_bf16 a[12:15], a[184:187], a[220:223], a[12:15]
    v_mfma_f32_16x16x32_bf16 a[16:19], a[184:187], a[224:227], a[16:19]
    v_mfma_f32_16x16x32_bf16 a[20:23], a[184:187], a[228:231], a[20:23]
    s_waitcnt vmcnt(13) lgkmcnt(1)
    s_barrier
    v_mfma_f32_16x16x32_bf16 a[24:27], a[188:191], a[208:211], a[24:27]
    ds_read_b64_tr_b16 a[184:185], v24 offset:49152
    ds_read_b64_tr_b16 a[186:187], v24 offset:50688
    v_mfma_f32_16x16x32_bf16 a[28:31], a[188:191], a[212:215], a[28:31]
    buffer_load_dwordx4 v2, s[12:15], s57 offen nt lds
    v_mfma_f32_16x16x32_bf16 a[32:35], a[188:191], a[216:219], a[32:35]
    v_mfma_f32_16x16x32_bf16 a[36:39], a[188:191], a[220:223], a[36:39]
    v_mfma_f32_16x16x32_bf16 a[40:43], a[188:191], a[224:227], a[40:43]
    v_mfma_f32_16x16x32_bf16 a[44:47], a[188:191], a[228:231], a[44:47]
    ds_read_b64_tr_b16 a[188:189], v37 offset:49152
    ds_read_b64_tr_b16 a[190:191], v37 offset:50688
    v_mfma_f32_16x16x32_bf16 a[48:51], a[192:195], a[208:211], a[48:51]
    buffer_load_dwordx4 v3, s[12:15], s57 offen offset:1024 nt lds
    v_mfma_f32_16x16x32_bf16 a[52:55], a[192:195], a[212:215], a[52:55]
    v_mfma_f32_16x16x32_bf16 a[56:59], a[192:195], a[216:219], a[56:59]
    v_mfma_f32_16x16x32_bf16 a[60:63], a[192:195], a[220:223], a[60:63]
    v_mfma_f32_16x16x32_bf16 a[64:67], a[192:195], a[224:227], a[64:67]
    v_mfma_f32_16x16x32_bf16 a[68:71], a[192:195], a[228:231], a[68:71]
    ds_read_b64_tr_b16 a[192:193], v38 offset:49152
    ds_read_b64_tr_b16 a[194:195], v38 offset:50688
    v_mfma_f32_16x16x32_bf16 a[72:75], a[196:199], a[208:211], a[72:75]
    buffer_load_dwordx4 v4, s[12:15], s57 offen offset:2048 nt lds
    v_mfma_f32_16x16x32_bf16 a[76:79], a[196:199], a[212:215], a[76:79]
    s_add_u32 s57, s62, 399360
    s_add_u32 m0, s51, 73728
    s_mul_i32 s62, s61, 6144
    v_mfma_f32_16x16x32_bf16 a[80:83], a[196:199], a[216:219], a[80:83]
    v_mfma_f32_16x16x32_bf16 a[84:87], a[196:199], a[220:223], a[84:87]
    v_mfma_f32_16x16x32_bf16 a[88:91], a[196:199], a[224:227], a[88:91]
    v_mfma_f32_16x16x32_bf16 a[92:95], a[196:199], a[228:231], a[92:95]
    ds_read_b64_tr_b16 a[196:197], v21 offset:24576
    ds_read_b64_tr_b16 a[198:199], v21 offset:26112
    v_mfma_f32_16x16x32_bf16 a[96:99], a[200:203], a[208:211], a[96:99]
    buffer_load_dwordx4 v5, s[20:23], s57 offen lds
    v_mfma_f32_16x16x32_bf16 a[100:103], a[200:203], a[212:215], a[100:103]
    v_mfma_f32_16x16x32_bf16 a[104:107], a[200:203], a[216:219], a[104:107]
    v_mfma_f32_16x16x32_bf16 a[108:111], a[200:203], a[220:223], a[108:111]
    v_mfma_f32_16x16x32_bf16 a[112:115], a[200:203], a[224:227], a[112:115]
    v_mfma_f32_16x16x32_bf16 a[116:119], a[200:203], a[228:231], a[116:119]
    buffer_load_dwordx4 v6, s[20:23], s57 offen offset:1024 lds
    v_mfma_f32_16x16x32_bf16 a[120:123], a[204:207], a[208:211], a[120:123]
    ds_read_b64_tr_b16 a[200:201], v22 offset:24576
    ds_read_b64_tr_b16 a[202:203], v22 offset:26112
    v_mfma_f32_16x16x32_bf16 a[124:127], a[204:207], a[212:215], a[124:127]
    v_mfma_f32_16x16x32_bf16 a[128:131], a[204:207], a[216:219], a[128:131]
    v_mfma_f32_16x16x32_bf16 a[132:135], a[204:207], a[220:223], a[132:135]
    v_mfma_f32_16x16x32_bf16 a[136:139], a[204:207], a[224:227], a[136:139]
    buffer_load_dwordx4 v7, s[20:23], s57 offen offset:2048 lds
    v_mfma_f32_16x16x32_bf16 a[140:143], a[204:207], a[228:231], a[140:143]
    s_add_u32 m0, s51, 135168
    ds_read_b64_tr_b16 a[204:205], v23 offset:24576
    ds_read_b64_tr_b16 a[206:207], v23 offset:26112
    s_waitcnt lgkmcnt(4)
    v_mfma_f32_16x16x32_bf16 a[0:3], a[184:187], a[232:235], a[0:3]
    s_add_u32 s57, s62, 0
    v_mfma_f32_16x16x32_bf16 a[4:7], a[184:187], a[236:239], a[4:7]
    v_mfma_f32_16x16x32_bf16 a[8:11], a[184:187], a[240:243], a[8:11]
    v_mfma_f32_16x16x32_bf16 a[12:15], a[184:187], a[244:247], a[12:15]
    v_mfma_f32_16x16x32_bf16 a[16:19], a[184:187], a[248:251], a[16:19]
    v_mfma_f32_16x16x32_bf16 a[20:23], a[184:187], a[252:255], a[20:23]
    s_waitcnt vmcnt(9) lgkmcnt(0)
    s_barrier
    v_mfma_f32_16x16x32_bf16 a[24:27], a[188:191], a[232:235], a[24:27]
    ds_read_b128 a[208:211], v25 offset:49152
    buffer_load_dwordx4 v8, s[8:11], s61 offen lds
    v_mfma_f32_16x16x32_bf16 a[28:31], a[188:191], a[236:239], a[28:31]
    ds_read_b64_tr_b16 a[184:185], v21 offset:36864
    ds_read_b64_tr_b16 a[186:187], v21 offset:38400
    v_mfma_f32_16x16x32_bf16 a[32:35], a[188:191], a[240:243], a[32:35]
    ds_read_b128 a[212:215], v25 offset:51200
    buffer_load_dwordx4 v9, s[8:11], s61 offen offset:1024 lds
    v_mfma_f32_16x16x32_bf16 a[36:39], a[188:191], a[244:247], a[36:39]
    ds_read_b128 a[216:219], v25 offset:53248
    v_mfma_f32_16x16x32_bf16 a[40:43], a[188:191], a[248:251], a[40:43]
    ds_read_b128 a[220:223], v25 offset:55296
    buffer_load_dwordx4 v10, s[8:11], s61 offen offset:2048 lds
    v_mfma_f32_16x16x32_bf16 a[44:47], a[188:191], a[252:255], a[44:47]
    s_add_u32 m0, s51, 86016
    ds_read_b128 a[224:227], v25 offset:57344
    s_add_u32 s61, s61, 128
    v_mfma_f32_16x16x32_bf16 a[48:51], a[192:195], a[232:235], a[48:51]
    ds_read_b128 a[228:231], v25 offset:59392
    buffer_load_dwordx4 v5, s[20:23], s57 offen lds
    v_mfma_f32_16x16x32_bf16 a[52:55], a[192:195], a[236:239], a[52:55]
    ds_read_b64_tr_b16 a[188:189], v22 offset:36864
    ds_read_b64_tr_b16 a[190:191], v22 offset:38400
    v_mfma_f32_16x16x32_bf16 a[56:59], a[192:195], a[240:243], a[56:59]
    s_cmp_eq_u32 s61, 1280
    s_cselect_b32 s61, 0, s61
    buffer_load_dwordx4 v6, s[20:23], s57 offen offset:1024 lds
    v_mfma_f32_16x16x32_bf16 a[60:63], a[192:195], a[244:247], a[60:63]
    v_mfma_f32_16x16x32_bf16 a[64:67], a[192:195], a[248:251], a[64:67]
    buffer_load_dwordx4 v7, s[20:23], s57 offen offset:2048 lds
    v_mfma_f32_16x16x32_bf16 a[68:71], a[192:195], a[252:255], a[68:71]
    s_add_u32 s57, s62, 6144
    ds_read_b64_tr_b16 a[192:193], v23 offset:36864
    ds_read_b64_tr_b16 a[194:195], v23 offset:38400
    v_mfma_f32_16x16x32_bf16 a[72:75], a[196:199], a[232:235], a[72:75]
    s_add_u32 m0, s51, 98304
    s_nop 0
    buffer_load_dwordx4 v5, s[20:23], s57 offen lds
    v_mfma_f32_16x16x32_bf16 a[76:79], a[196:199], a[236:239], a[76:79]
    v_mfma_f32_16x16x32_bf16 a[80:83], a[196:199], a[240:243], a[80:83]
    buffer_load_dwordx4 v6, s[20:23], s57 offen offset:1024 lds
    v_mfma_f32_16x16x32_bf16 a[84:87], a[196:199], a[244:247], a[84:87]
    v_mfma_f32_16x16x32_bf16 a[88:91], a[196:199], a[248:251], a[88:91]
    buffer_load_dwordx4 v7, s[20:23], s57 offen offset:2048 lds
    v_mfma_f32_16x16x32_bf16 a[92:95], a[196:199], a[252:255], a[92:95]
    s_add_u32 s57, s62, 393216
    ds_read_b64_tr_b16 a[196:197], v21 offset:49152
    ds_read_b64_tr_b16 a[198:199], v21 offset:50688
    v_mfma_f32_16x16x32_bf16 a[96:99], a[200:203], a[232:235], a[96:99]
    s_add_u32 m0, s51, 49152
    s_nop 0
    buffer_load_dwordx4 v5, s[20:23], s57 offen lds
    v_mfma_f32_16x16x32_bf16 a[100:103], a[200:203], a[236:239], a[100:103]
    v_mfma_f32_16x16x32_bf16 a[104:107], a[200:203], a[240:243], a[104:107]
    buffer_load_dwordx4 v6, s[20:23], s57 offen offset:1024 lds
    v_mfma_f32_16x16x32_bf16 a[108:111], a[200:203], a[244:247], a[108:111]
    v_mfma_f32_16x16x32_bf16 a[112:115], a[200:203], a[248:251], a[112:115]
    buffer_load_dwordx4 v7, s[20:23], s57 offen offset:2048 lds
    v_mfma_f32_16x16x32_bf16 a[116:119], a[200:203], a[252:255], a[116:119]
    s_add_u32 s57, s62, 399360
    ds_read_b64_tr_b16 a[200:201], v22 offset:49152
    ds_read_b64_tr_b16 a[202:203], v22 offset:50688
    v_mfma_f32_16x16x32_bf16 a[120:123], a[204:207], a[232:235], a[120:123]
    s_add_u32 m0, s51, 110592
    ds_read_b128 a[232:235], v26 offset:49152
    s_mul_i32 s62, s61, 6144
    v_mfma_f32_16x16x32_bf16 a[124:127], a[204:207], a[236:239], a[124:127]
    ds_read_b128 a[236:239], v26 offset:51200
    v_mfma_f32_16x16x32_bf16 a[128:131], a[204:207], a[240:243], a[128:131]
    ds_read_b128 a[240:243], v26 offset:53248
    v_mfma_f32_16x16x32_bf16 a[132:135], a[204:207], a[244:247], a[132:135]
    ds_read_b128 a[244:247], v26 offset:55296
    v_mfma_f32_16x16x32_bf16 a[136:139], a[204:207], a[248:251], a[136:139]
    ds_read_b128 a[248:251], v26 offset:57344
    v_mfma_f32_16x16x32_bf16 a[140:143], a[204:207], a[252:255], a[140:143]
    s_waitcnt lgkmcnt(7)
    ds_read_b64_tr_b16 a[204:205], v23 offset:49152
    ds_read_b64_tr_b16 a[206:207], v23 offset:50688
    v_mfma_f32_16x16x32_bf16 a[0:3], a[184:187], a[208:211], a[0:3]
    ds_read_b128 a[252:255], v26 offset:59392
    v_mfma_f32_16x16x32_bf16 a[4:7], a[184:187], a[212:215], a[4:7]
    v_mfma_f32_16x16x32_bf16 a[8:11], a[184:187], a[216:219], a[8:11]
    v_mfma_f32_16x16x32_bf16 a[12:15], a[184:187], a[220:223], a[12:15]
    v_mfma_f32_16x16x32_bf16 a[16:19], a[184:187], a[224:227], a[16:19]
    v_mfma_f32_16x16x32_bf16 a[20:23], a[184:187], a[228:231], a[20:23]
    s_waitcnt vmcnt(12) lgkmcnt(1)
    s_barrier
    v_mfma_f32_16x16x32_bf16 a[24:27], a[188:191], a[208:211], a[24:27]
    ds_read_b64_tr_b16 a[184:185], v24 offset:61440
    ds_read_b64_tr_b16 a[186:187], v24 offset:62976
    v_mfma_f32_16x16x32_bf16 a[28:31], a[188:191], a[212:215], a[28:31]
    buffer_load_dwordx4 v5, s[20:23], s57 offen lds
    v_mfma_f32_16x16x32_bf16 a[32:35], a[188:191], a[216:219], a[32:35]
    ds_read_b128 v[112:115], v11 offset:0
    v_mfma_f32_16x16x32_bf16 a[36:39], a[188:191], a[220:223], a[36:39]
    ds_read_b128 v[116:119], v12 offset:0
    buffer_load_dwordx4 v6, s[20:23], s57 offen offset:1024 lds
    v_mfma_f32_16x16x32_bf16 a[40:43], a[188:191], a[224:227], a[40:43]
    ds_read_b128 v[120:123], v11 offset:128
    v_mfma_f32_16x16x32_bf16 a[44:47], a[188:191], a[228:231], a[44:47]
    ds_read_b64_tr_b16 a[188:189], v37 offset:61440
    ds_read_b64_tr_b16 a[190:191], v37 offset:62976
    v_mfma_f32_16x16x32_bf16 a[48:51], a[192:195], a[208:211], a[48:51]
    buffer_load_dwordx4 v7, s[20:23], s57 offen offset:2048 lds
    v_mfma_f32_16x16x32_bf16 a[52:55], a[192:195], a[212:215], a[52:55]
    s_add_u32 m0, s51, 122880
    ds_read_b128 v[124:127], v12 offset:128
    s_add_u32 s57, s62, 0
    v_mfma_f32_16x16x32_bf16 a[56:59], a[192:195], a[216:219], a[56:59]
    ds_read_b128 v[128:131], v11 offset:256
    buffer_load_dwordx4 v8, s[8:11], s61 offen lds
    v_mfma_f32_16x16x32_bf16 a[60:63], a[192:195], a[220:223], a[60:63]
    ds_read_b128 v[132:135], v12 offset:256
    v_mfma_f32_16x16x32_bf16 a[64:67], a[192:195], a[224:227], a[64:67]
    ds_read_b128 v[136:139], v11 offset:6144
    buffer_load_dwordx4 v9, s[8:11], s61 offen offset:1024 lds
    v_mfma_f32_16x16x32_bf16 a[68:71], a[192:195], a[228:231], a[68:71]
    ds_read_b64_tr_b16 a[192:193], v38 offset:61440
    ds_read_b64_tr_b16 a[194:195], v38 offset:62976
    v_mfma_f32_16x16x32_bf16 a[72:75], a[196:199], a[208:211], a[72:75]
    ds_read_b128 v[140:143], v12 offset:6144
    buffer_load_dwordx4 v10, s[8:11], s61 offen offset:2048 lds
    v_mfma_f32_16x16x32_bf16 a[76:79], a[196:199], a[212:215], a[76:79]
    s_add_u32 m0, s51, 36864
    ds_read_b128 v[144:147], v11 offset:6272
    s_add_u32 s61, s61, 128
    v_mfma_f32_16x16x32_bf16 a[80:83], a[196:199], a[216:219], a[80:83]
    ds_read_b128 v[148:151], v12 offset:6272
    buffer_load_dwordx4 v5, s[20:23], s57 offen lds
    v_mfma_f32_16x16x32_bf16 a[84:87], a[196:199], a[220:223], a[84:87]
    ds_read_b128 v[152:155], v11 offset:6400
    s_cmp_eq_u32 s61, 1280
    s_cselect_b32 s61, 0, s61
    v_mfma_f32_16x16x32_bf16 a[88:91], a[196:199], a[224:227], a[88:91]
    buffer_load_dwordx4 v6, s[20:23], s57 offen offset:1024 lds
    v_mfma_f32_16x16x32_bf16 a[92:95], a[196:199], a[228:231], a[92:95]
    ds_read_b64_tr_b16 a[196:197], v21 offset:0
    ds_read_b64_tr_b16 a[198:199], v21 offset:1536
    v_mfma_f32_16x16x32_bf16 a[96:99], a[200:203], a[208:211], a[96:99]
    ds_read_b128 v[156:159], v12 offset:6400
    buffer_load_dwordx4 v7, s[20:23], s57 offen offset:2048 lds
    v_mfma_f32_16x16x32_bf16 a[100:103], a[200:203], a[212:215], a[100:103]
    s_add_u32 s57, s62, 6144
    s_add_u32 m0, s51, 24576
    v_mfma_f32_16x16x32_bf16 a[104:107], a[200:203], a[216:219], a[104:107]
    buffer_load_dwordx4 v5, s[20:23], s57 offen lds
    v_mfma_f32_16x16x32_bf16 a[108:111], a[200:203], a[220:223], a[108:111]
    v_mfma_f32_16x16x32_bf16 a[112:115], a[200:203], a[224:227], a[112:115]
    buffer_load_dwordx4 v6, s[20:23], s57 offen offset:1024 lds
    v_mfma_f32_16x16x32_bf16 a[116:119], a[200:203], a[228:231], a[116:119]
    ds_read_b64_tr_b16 a[200:201], v22 offset:0
    ds_read_b64_tr_b16 a[202:203], v22 offset:1536
    v_mfma_f32_16x16x32_bf16 a[120:123], a[204:207], a[208:211], a[120:123]
    buffer_load_dwordx4 v7, s[20:23], s57 offen offset:2048 lds
    v_mfma_f32_16x16x32_bf16 a[124:127], a[204:207], a[212:215], a[124:127]
    s_mov_b32 s57, 73728
    s_add_u32 m0, s51, 0
    v_mfma_f32_16x16x32_bf16 a[128:131], a[204:207], a[216:219], a[128:131]
    v_mfma_f32_16x16x32_bf16 a[132:135], a[204:207], a[220:223], a[132:135]
    v_mfma_f32_16x16x32_bf16 a[136:139], a[204:207], a[224:227], a[136:139]
    v_mfma_f32_16x16x32_bf16 a[140:143], a[204:207], a[228:231], a[140:143]
    s_waitcnt lgkmcnt(1)
    ds_read_b64_tr_b16 a[204:205], v23 offset:0
    ds_read_b64_tr_b16 a[206:207], v23 offset:1536
    v_mfma_f32_16x16x32_bf16 a[0:3], a[184:187], a[232:235], a[0:3]
    v_mfma_f32_16x16x32_bf16 a[4:7], a[184:187], a[236:239], a[4:7]
    v_mfma_f32_16x16x32_bf16 a[8:11], a[184:187], a[240:243], a[8:11]
    v_mfma_f32_16x16x32_bf16 a[12:15], a[184:187], a[244:247], a[12:15]
    v_mfma_f32_16x16x32_bf16 a[16:19], a[184:187], a[248:251], a[16:19]
    v_mfma_f32_16x16x32_bf16 a[20:23], a[184:187], a[252:255], a[20:23]
    s_waitcnt vmcnt(15) lgkmcnt(0)
    s_barrier
    v_mfma_f32_16x16x32_bf16 a[24:27], a[188:191], a[232:235], a[24:27]
    ds_read_b128 a[208:211], v25 offset:36864
    buffer_load_dwordx4 v2, s[12:15], s57 offen nt lds
    v_mfma_f32_16x16x32_bf16 a[28:31], a[188:191], a[236:239], a[28:31]
    ds_read_b64_tr_b16 a[184:185], v21 offset:12288
    ds_read_b64_tr_b16 a[186:187], v21 offset:13824
    v_mfma_f32_16x16x32_bf16 a[32:35], a[188:191], a[240:243], a[32:35]
    ds_read_b128 a[212:215], v25 offset:38912
    v_mfma_f32_16x16x32_bf16 a[36:39], a[188:191], a[244:247], a[36:39]
    ds_read_b128 a[216:219], v25 offset:40960
    v_mfma_f32_16x16x32_bf16 a[40:43], a[188:191], a[248:251], a[40:43]
    ds_read_b128 a[220:223], v25 offset:43008
    v_mfma_f32_16x16x32_bf16 a[44:47], a[188:191], a[252:255], a[44:47]
    ds_read_b128 a[224:227], v25 offset:45056
    buffer_load_dwordx4 v3, s[12:15], s57 offen offset:1024 nt lds
    v_mfma_f32_16x16x32_bf16 a[48:51], a[192:195], a[232:235], a[48:51]
    ds_read_b128 a[228:231], v25 offset:47104
    v_mfma_f32_16x16x32_bf16 a[52:55], a[192:195], a[236:239], a[52:55]
    ds_read_b64_tr_b16 a[188:189], v22 offset:12288
    ds_read_b64_tr_b16 a[190:191], v22 offset:13824
    v_mfma_f32_16x16x32_bf16 a[56:59], a[192:195], a[240:243], a[56:59]
    v_mfma_f32_16x16x32_bf16 a[60:63], a[192:195], a[244:247], a[60:63]
    v_mfma_f32_16x16x32_bf16 a[64:67], a[192:195], a[248:251], a[64:67]
    buffer_load_dwordx4 v4, s[12:15], s57 offen offset:2048 nt lds
    v_mfma_f32_16x16x32_bf16 a[68:71], a[192:195], a[252:255], a[68:71]
    s_add_u32 s57, s62, 393216
    ds_read_b64_tr_b16 a[192:193], v23 offset:12288
    ds_read_b64_tr_b16 a[194:195], v23 offset:13824
    v_mfma_f32_16x16x32_bf16 a[72:75], a[196:199], a[232:235], a[72:75]
    s_add_u32 m0, s51, 73728
    v_mfma_f32_16x16x32_bf16 a[76:79], a[196:199], a[236:239], a[76:79]
    v_mfma_f32_16x16x32_bf16 a[80:83], a[196:199], a[240:243], a[80:83]
    v_mfma_f32_16x16x32_bf16 a[84:87], a[196:199], a[244:247], a[84:87]
    buffer_load_dwordx4 v5, s[20:23], s57 offen lds
    v_mfma_f32_16x16x32_bf16 a[88:91], a[196:199], a[248:251], a[88:91]
    v_mfma_f32_16x16x32_bf16 a[92:95], a[196:199], a[252:255], a[92:95]
    ds_read_b64_tr_b16 a[196:197], v21 offset:24576
    ds_read_b64_tr_b16 a[198:199], v21 offset:26112
    v_mfma_f32_16x16x32_bf16 a[96:99], a[200:203], a[232:235], a[96:99]
    v_mfma_f32_16x16x32_bf16 a[100:103], a[200:203], a[236:239], a[100:103]
    v_mfma_f32_16x16x32_bf16 a[104:107], a[200:203], a[240:243], a[104:107]
    buffer_load_dwordx4 v6, s[20:23], s57 offen offset:1024 lds
    v_mfma_f32_16x16x32_bf16 a[108:111], a[200:203], a[244:247], a[108:111]
    v_mfma_f32_16x16x32_bf16 a[112:115], a[200:203], a[248:251], a[112:115]
    v_mfma_f32_16x16x32_bf16 a[116:119], a[200:203], a[252:255], a[116:119]
    ds_read_b64_tr_b16 a[200:201], v22 offset:24576
    ds_read_b64_tr_b16 a[202:203], v22 offset:26112
    v_mfma_f32_16x16x32_bf16 a[120:123], a[204:207], a[232:235], a[120:123]
    ds_read_b128 a[232:235], v26 offset:36864
    v_mfma_f32_16x16x32_bf16 a[124:127], a[204:207], a[236:239], a[124:127]
    buffer_load_dwordx4 v7, s[20:23], s57 offen offset:2048 lds
    v_mfma_f32_16x16x32_bf16 a[128:131], a[204:207], a[240:243], a[128:131]
    s_add_u32 s57, s62, 399360
    ds_read_b128 a[236:239], v26 offset:38912
    s_add_u32 m0, s51, 86016
    v_mfma_f32_16x16x32_bf16 a[132:135], a[204:207], a[244:247], a[132:135]
    s_mul_i32 s62, s61, 6144
    ds_read_b128 a[240:243], v26 offset:40960
    v_mfma_f32_16x16x32_bf16 a[136:139], a[204:207], a[248:251], a[136:139]
    ds_read_b128 a[244:247], v26 offset:43008
    v_mfma_f32_16x16x32_bf16 a[140:143], a[204:207], a[252:255], a[140:143]
    s_waitcnt lgkmcnt(6)
    ds_read_b64_tr_b16 a[204:205], v23 offset:24576
    ds_read_b64_tr_b16 a[206:207], v23 offset:26112
    v_mfma_f32_16x16x32_bf16 a[0:3], a[184:187], a[208:211], a[0:3]
    ds_read_b128 a[248:251], v26 offset:45056
    v_mfma_f32_16x16x32_bf16 a[4:7], a[184:187], a[212:215], a[4:7]
    ds_read_b128 a[252:255], v26 offset:47104
    v_mfma_f32_16x16x32_bf16 a[8:11], a[184:187], a[216:219], a[8:11]
    v_mfma_f32_16x16x32_bf16 a[12:15], a[184:187], a[220:223], a[12:15]
    v_mfma_f32_16x16x32_bf16 a[16:19], a[184:187], a[224:227], a[16:19]
    v_mfma_f32_16x16x32_bf16 a[20:23], a[184:187], a[228:231], a[20:23]
    s_waitcnt vmcnt(15) lgkmcnt(2)
    s_barrier
    v_mfma_f32_16x16x32_bf16 a[24:27], a[188:191], a[208:211], a[24:27]
    ds_read_b64_tr_b16 a[184:185], v24 offset:49152
    ds_read_b64_tr_b16 a[186:187], v24 offset:50688
    v_mfma_f32_16x16x32_bf16 a[28:31], a[188:191], a[212:215], a[28:31]
    buffer_load_dwordx4 v5, s[20:23], s57 offen lds
    v_mfma_f32_16x16x32_bf16 a[32:35], a[188:191], a[216:219], a[32:35]
    v_mfma_f32_16x16x32_bf16 a[36:39], a[188:191], a[220:223], a[36:39]
    buffer_load_dwordx4 v6, s[20:23], s57 offen offset:1024 lds
    v_mfma_f32_16x16x32_bf16 a[40:43], a[188:191], a[224:227], a[40:43]
    v_mfma_f32_16x16x32_bf16 a[44:47], a[188:191], a[228:231], a[44:47]
    ds_read_b64_tr_b16 a[188:189], v37 offset:49152
    ds_read_b64_tr_b16 a[190:191], v37 offset:50688
    v_mfma_f32_16x16x32_bf16 a[48:51], a[192:195], a[208:211], a[48:51]
    buffer_load_dwordx4 v7, s[20:23], s57 offen offset:2048 lds
    v_mfma_f32_16x16x32_bf16 a[52:55], a[192:195], a[212:215], a[52:55]
    s_add_u32 m0, s51, 147456
    s_add_u32 s57, s62, 0
    v_mfma_f32_16x16x32_bf16 a[56:59], a[192:195], a[216:219], a[56:59]
    buffer_load_dwordx4 v8, s[8:11], s61 offen lds
    v_mfma_f32_16x16x32_bf16 a[60:63], a[192:195], a[220:223], a[60:63]
    v_mfma_f32_16x16x32_bf16 a[64:67], a[192:195], a[224:227], a[64:67]
    buffer_load_dwordx4 v9, s[8:11], s61 offen offset:1024 lds
    v_mfma_f32_16x16x32_bf16 a[68:71], a[192:195], a[228:231], a[68:71]
    ds_read_b64_tr_b16 a[192:193], v38 offset:49152
    ds_read_b64_tr_b16 a[194:195], v38 offset:50688
    v_mfma_f32_16x16x32_bf16 a[72:75], a[196:199], a[208:211], a[72:75]
    buffer_load_dwordx4 v10, s[8:11], s61 offen offset:2048 lds
    v_mfma_f32_16x16x32_bf16 a[76:79], a[196:199], a[212:215], a[76:79]
    s_add_u32 m0, s51, 98304
    s_add_u32 s61, s61, 128
    s_cmp_eq_u32 s61, 1280
    s_cselect_b32 s61, 0, s61
    v_mfma_f32_16x16x32_bf16 a[80:83], a[196:199], a[216:219], a[80:83]
    buffer_load_dwordx4 v5, s[20:23], s57 offen lds
    v_mfma_f32_16x16x32_bf16 a[84:87], a[196:199], a[220:223], a[84:87]
    v_mfma_f32_16x16x32_bf16 a[88:91], a[196:199], a[224:227], a[88:91]
    buffer_load_dwordx4 v6, s[20:23], s57 offen offset:1024 lds
    v_mfma_f32_16x16x32_bf16 a[92:95], a[196:199], a[228:231], a[92:95]
    ds_read_b64_tr_b16 a[196:197], v21 offset:36864
    ds_read_b64_tr_b16 a[198:199], v21 offset:38400
    v_mfma_f32_16x16x32_bf16 a[96:99], a[200:203], a[208:211], a[96:99]
    buffer_load_dwordx4 v7, s[20:23], s57 offen offset:2048 lds
    v_mfma_f32_16x16x32_bf16 a[100:103], a[200:203], a[212:215], a[100:103]
    s_add_u32 s57, s62, 6144
    s_add_u32 m0, s51, 61440
    v_mfma_f32_16x16x32_bf16 a[104:107], a[200:203], a[216:219], a[104:107]
    buffer_load_dwordx4 v5, s[20:23], s57 offen lds
    v_mfma_f32_16x16x32_bf16 a[108:111], a[200:203], a[220:223], a[108:111]
    v_mfma_f32_16x16x32_bf16 a[112:115], a[200:203], a[224:227], a[112:115]
    buffer_load_dwordx4 v6, s[20:23], s57 offen offset:1024 lds
    v_mfma_f32_16x16x32_bf16 a[116:119], a[200:203], a[228:231], a[116:119]
    ds_read_b64_tr_b16 a[200:201], v22 offset:36864
    ds_read_b64_tr_b16 a[202:203], v22 offset:38400
    v_mfma_f32_16x16x32_bf16 a[120:123], a[204:207], a[208:211], a[120:123]
    buffer_load_dwordx4 v7, s[20:23], s57 offen offset:2048 lds
    v_mfma_f32_16x16x32_bf16 a[124:127], a[204:207], a[212:215], a[124:127]
    s_mov_b32 s57, 86016
    s_add_u32 m0, s51, 12288
    v_mfma_f32_16x16x32_bf16 a[128:131], a[204:207], a[216:219], a[128:131]
    v_mfma_f32_16x16x32_bf16 a[132:135], a[204:207], a[220:223], a[132:135]
    v_mfma_f32_16x16x32_bf16 a[136:139], a[204:207], a[224:227], a[136:139]
    v_mfma_f32_16x16x32_bf16 a[140:143], a[204:207], a[228:231], a[140:143]
    s_waitcnt lgkmcnt(1)
    ds_read_b64_tr_b16 a[204:205], v23 offset:36864
    ds_read_b64_tr_b16 a[206:207], v23 offset:38400
    v_mfma_f32_16x16x32_bf16 a[0:3], a[184:187], a[232:235], a[0:3]
    v_mfma_f32_16x16x32_bf16 a[4:7], a[184:187], a[236:239], a[4:7]
    v_mfma_f32_16x16x32_bf16 a[8:11], a[184:187], a[240:243], a[8:11]
    v_mfma_f32_16x16x32_bf16 a[12:15], a[184:187], a[244:247], a[12:15]
    v_mfma_f32_16x16x32_bf16 a[16:19], a[184:187], a[248:251], a[16:19]
    v_mfma_f32_16x16x32_bf16 a[20:23], a[184:187], a[252:255], a[20:23]
    s_waitcnt vmcnt(18) lgkmcnt(0)
    s_barrier
    v_mfma_f32_16x16x32_bf16 a[24:27], a[188:191], a[232:235], a[24:27]
    ds_read_b128 a[208:211], v25 offset:24576
    buffer_load_dwordx4 v2, s[12:15], s57 offen nt lds
    v_mfma_f32_16x16x32_bf16 a[28:31], a[188:191], a[236:239], a[28:31]
    ds_read_b64_tr_b16 a[184:185], v24 offset:36864
    ds_read_b64_tr_b16 a[186:187], v24 offset:38400
    v_mfma_f32_16x16x32_bf16 a[32:35], a[188:191], a[240:243], a[32:35]
    ds_read_b128 a[212:215], v25 offset:26624
    v_mfma_f32_16x16x32_bf16 a[36:39], a[188:191], a[244:247], a[36:39]
    ds_read_b128 a[216:219], v25 offset:28672
    v_mfma_f32_16x16x32_bf16 a[40:43], a[188:191], a[248:251], a[40:43]
    ds_read_b128 a[220:223], v25 offset:30720
    v_mfma_f32_16x16x32_bf16 a[44:47], a[188:191], a[252:255], a[44:47]
    ds_read_b128 a[224:227], v25 offset:32768
    buffer_load_dwordx4 v3, s[12:15], s57 offen offset:1024 nt lds
    v_mfma_f32_16x16x32_bf16 a[48:51], a[192:195], a[232:235], a[48:51]
    ds_read_b128 a[228:231], v25 offset:34816
    v_mfma_f32_16x16x32_bf16 a[52:55], a[192:195], a[236:239], a[52:55]
    ds_read_b64_tr_b16 a[188:189], v37 offset:36864
    ds_read_b64_tr_b16 a[190:191], v37 offset:38400
    v_mfma_f32_16x16x32_bf16 a[56:59], a[192:195], a[240:243], a[56:59]
    v_mfma_f32_16x16x32_bf16 a[60:63], a[192:195], a[244:247], a[60:63]
    v_mfma_f32_16x16x32_bf16 a[64:67], a[192:195], a[248:251], a[64:67]
    buffer_load_dwordx4 v4, s[12:15], s57 offen offset:2048 nt lds
    v_mfma_f32_16x16x32_bf16 a[68:71], a[192:195], a[252:255], a[68:71]
    s_add_u32 s57, s62, 393216
    ds_read_b64_tr_b16 a[192:193], v38 offset:36864
    ds_read_b64_tr_b16 a[194:195], v38 offset:38400
    v_mfma_f32_16x16x32_bf16 a[72:75], a[196:199], a[232:235], a[72:75]
    s_add_u32 m0, s51, 110592
    v_mfma_f32_16x16x32_bf16 a[76:79], a[196:199], a[236:239], a[76:79]
    v_mfma_f32_16x16x32_bf16 a[80:83], a[196:199], a[240:243], a[80:83]
    v_mfma_f32_16x16x32_bf16 a[84:87], a[196:199], a[244:247], a[84:87]
    buffer_load_dwordx4 v5, s[20:23], s57 offen lds
    v_mfma_f32_16x16x32_bf16 a[88:91], a[196:199], a[248:251], a[88:91]
    v_mfma_f32_16x16x32_bf16 a[92:95], a[196:199], a[252:255], a[92:95]
    ds_read_b64_tr_b16 a[196:197], v24 offset:24576
    ds_read_b64_tr_b16 a[198:199], v24 offset:26112
    v_mfma_f32_16x16x32_bf16 a[96:99], a[200:203], a[232:235], a[96:99]
    v_mfma_f32_16x16x32_bf16 a[100:103], a[200:203], a[236:239], a[100:103]
    v_mfma_f32_16x16x32_bf16 a[104:107], a[200:203], a[240:243], a[104:107]
    buffer_load_dwordx4 v6, s[20:23], s57 offen offset:1024 lds
    v_mfma_f32_16x16x32_bf16 a[108:111], a[200:203], a[244:247], a[108:111]
    v_mfma_f32_16x16x32_bf16 a[112:115], a[200:203], a[248:251], a[112:115]
    v_mfma_f32_16x16x32_bf16 a[116:119], a[200:203], a[252:255], a[116:119]
    ds_read_b64_tr_b16 a[200:201], v37 offset:24576
    ds_read_b64_tr_b16 a[202:203], v37 offset:26112
    v_mfma_f32_16x16x32_bf16 a[120:123], a[204:207], a[232:235], a[120:123]
    ds_read_b128 a[232:235], v26 offset:24576
    v_mfma_f32_16x16x32_bf16 a[124:127], a[204:207], a[236:239], a[124:127]
    buffer_load_dwordx4 v7, s[20:23], s57 offen offset:2048 lds
    v_mfma_f32_16x16x32_bf16 a[128:131], a[204:207], a[240:243], a[128:131]
    s_add_u32 s57, s62, 399360
    ds_read_b128 a[236:239], v26 offset:26624
    s_add_u32 m0, s51, 49152
    v_mfma_f32_16x16x32_bf16 a[132:135], a[204:207], a[244:247], a[132:135]
    s_mul_i32 s62, s61, 6144
    ds_read_b128 a[240:243], v26 offset:28672
    v_mfma_f32_16x16x32_bf16 a[136:139], a[204:207], a[248:251], a[136:139]
    ds_read_b128 a[244:247], v26 offset:30720
    v_mfma_f32_16x16x32_bf16 a[140:143], a[204:207], a[252:255], a[140:143]
    s_waitcnt lgkmcnt(6)
    ds_read_b64_tr_b16 a[204:205], v38 offset:24576
    ds_read_b64_tr_b16 a[206:207], v38 offset:26112
    v_mfma_f32_16x16x32_bf16 a[0:3], a[184:187], a[208:211], a[0:3]
    ds_read_b128 a[248:251], v26 offset:32768
    v_mfma_f32_16x16x32_bf16 a[4:7], a[184:187], a[212:215], a[4:7]
    ds_read_b128 a[252:255], v26 offset:34816
    v_mfma_f32_16x16x32_bf16 a[8:11], a[184:187], a[216:219], a[8:11]
    v_mfma_f32_16x16x32_bf16 a[12:15], a[184:187], a[220:223], a[12:15]
    v_mfma_f32_16x16x32_bf16 a[16:19], a[184:187], a[224:227], a[16:19]
    v_mfma_f32_16x16x32_bf16 a[20:23], a[184:187], a[228:231], a[20:23]
    s_waitcnt vmcnt(15) lgkmcnt(2)
    s_barrier
    v_mfma_f32_16x16x32_bf16 a[24:27], a[188:191], a[208:211], a[24:27]
    ds_read_b64_tr_b16 a[184:185], v21 offset:0
    ds_read_b64_tr_b16 a[186:187], v21 offset:1536
    v_mfma_f32_16x16x32_bf16 a[28:31], a[188:191], a[212:215], a[28:31]
    buffer_load_dwordx4 v5, s[20:23], s57 offen lds
    v_mfma_f32_16x16x32_bf16 a[32:35], a[188:191], a[216:219], a[32:35]
    v_mfma_f32_16x16x32_bf16 a[36:39], a[188:191], a[220:223], a[36:39]
    buffer_load_dwordx4 v6, s[20:23], s57 offen offset:1024 lds
    v_mfma_f32_16x16x32_bf16 a[40:43], a[188:191], a[224:227], a[40:43]
    v_mfma_f32_16x16x32_bf16 a[44:47], a[188:191], a[228:231], a[44:47]
    ds_read_b64_tr_b16 a[188:189], v22 offset:0
    ds_read_b64_tr_b16 a[190:191], v22 offset:1536
    v_mfma_f32_16x16x32_bf16 a[48:51], a[192:195], a[208:211], a[48:51]
    buffer_load_dwordx4 v7, s[20:23], s57 offen offset:2048 lds
    v_mfma_f32_16x16x32_bf16 a[52:55], a[192:195], a[212:215], a[52:55]
    s_add_u32 m0, s51, 135168
    s_add_u32 s57, s62, 0
    v_mfma_f32_16x16x32_bf16 a[56:59], a[192:195], a[216:219], a[56:59]
    buffer_load_dwordx4 v8, s[8:11], s61 offen lds
    v_mfma_f32_16x16x32_bf16 a[60:63], a[192:195], a[220:223], a[60:63]
    v_mfma_f32_16x16x32_bf16 a[64:67], a[192:195], a[224:227], a[64:67]
    buffer_load_dwordx4 v9, s[8:11], s61 offen offset:1024 lds
    v_mfma_f32_16x16x32_bf16 a[68:71], a[192:195], a[228:231], a[68:71]
    ds_read_b64_tr_b16 a[192:193], v23 offset:0
    ds_read_b64_tr_b16 a[194:195], v23 offset:1536
    v_mfma_f32_16x16x32_bf16 a[72:75], a[196:199], a[208:211], a[72:75]
    buffer_load_dwordx4 v10, s[8:11], s61 offen offset:2048 lds
    v_mfma_f32_16x16x32_bf16 a[76:79], a[196:199], a[212:215], a[76:79]
    s_add_u32 m0, s51, 36864
    s_add_u32 s61, s61, 128
    s_cmp_eq_u32 s61, 1280
    s_cselect_b32 s61, 0, s61
    v_mfma_f32_16x16x32_bf16 a[80:83], a[196:199], a[216:219], a[80:83]
    buffer_load_dwordx4 v5, s[20:23], s57 offen lds
    v_mfma_f32_16x16x32_bf16 a[84:87], a[196:199], a[220:223], a[84:87]
    v_mfma_f32_16x16x32_bf16 a[88:91], a[196:199], a[224:227], a[88:91]
    buffer_load_dwordx4 v6, s[20:23], s57 offen offset:1024 lds
    v_mfma_f32_16x16x32_bf16 a[92:95], a[196:199], a[228:231], a[92:95]
    ds_read_b64_tr_b16 a[196:197], v21 offset:12288
    ds_read_b64_tr_b16 a[198:199], v21 offset:13824
    v_mfma_f32_16x16x32_bf16 a[96:99], a[200:203], a[208:211], a[96:99]
    buffer_load_dwordx4 v7, s[20:23], s57 offen offset:2048 lds
    v_mfma_f32_16x16x32_bf16 a[100:103], a[200:203], a[212:215], a[100:103]
    s_add_u32 s57, s62, 6144
    s_add_u32 m0, s51, 24576
    v_mfma_f32_16x16x32_bf16 a[104:107], a[200:203], a[216:219], a[104:107]
    buffer_load_dwordx4 v5, s[20:23], s57 offen lds
    v_mfma_f32_16x16x32_bf16 a[108:111], a[200:203], a[220:223], a[108:111]
    v_mfma_f32_16x16x32_bf16 a[112:115], a[200:203], a[224:227], a[112:115]
    buffer_load_dwordx4 v6, s[20:23], s57 offen offset:1024 lds
    v_mfma_f32_16x16x32_bf16 a[116:119], a[200:203], a[228:231], a[116:119]
    ds_read_b64_tr_b16 a[200:201], v22 offset:12288
    ds_read_b64_tr_b16 a[202:203], v22 offset:13824
    v_mfma_f32_16x16x32_bf16 a[120:123], a[204:207], a[208:211], a[120:123]
    buffer_load_dwordx4 v7, s[20:23], s57 offen offset:2048 lds
    v_mfma_f32_16x16x32_bf16 a[124:127], a[204:207], a[212:215], a[124:127]
    s_add_u32 s57, s62, 393216
    s_add_u32 m0, s51, 73728
    v_mfma_f32_16x16x32_bf16 a[128:131], a[204:207], a[216:219], a[128:131]
    v_mfma_f32_16x16x32_bf16 a[132:135], a[204:207], a[220:223], a[132:135]
    v_mfma_f32_16x16x32_bf16 a[136:139], a[204:207], a[224:227], a[136:139]
    v_mfma_f32_16x16x32_bf16 a[140:143], a[204:207], a[228:231], a[140:143]
    s_waitcnt lgkmcnt(1)
    ds_read_b64_tr_b16 a[204:205], v23 offset:12288
    ds_read_b64_tr_b16 a[206:207], v23 offset:13824
    v_mfma_f32_16x16x32_bf16 a[0:3], a[184:187], a[232:235], a[0:3]
    v_mfma_f32_16x16x32_bf16 a[4:7], a[184:187], a[236:239], a[4:7]
    v_mfma_f32_16x16x32_bf16 a[8:11], a[184:187], a[240:243], a[8:11]
    v_mfma_f32_16x16x32_bf16 a[12:15], a[184:187], a[244:247], a[12:15]
    v_mfma_f32_16x16x32_bf16 a[16:19], a[184:187], a[248:251], a[16:19]
    v_mfma_f32_16x16x32_bf16 a[20:23], a[184:187], a[252:255], a[20:23]
    s_waitcnt vmcnt(15) lgkmcnt(0)
    s_barrier
    v_mfma_f32_16x16x32_bf16 a[24:27], a[188:191], a[232:235], a[24:27]
    ds_read_b128 a[208:211], v25 offset:49152
    buffer_load_dwordx4 v5, s[20:23], s57 offen lds
    v_mfma_f32_16x16x32_bf16 a[28:31], a[188:191], a[236:239], a[28:31]
    ds_read_b64_tr_b16 a[184:185], v21 offset:24576
    ds_read_b64_tr_b16 a[186:187], v21 offset:26112
    v_mfma_f32_16x16x32_bf16 a[32:35], a[188:191], a[240:243], a[32:35]
    ds_read_b128 a[212:215], v25 offset:51200
    v_mfma_f32_16x16x32_bf16 a[36:39], a[188:191], a[244:247], a[36:39]
    ds_read_b128 a[216:219], v25 offset:53248
    v_mfma_f32_16x16x32_bf16 a[40:43], a[188:191], a[248:251], a[40:43]
    ds_read_b128 a[220:223], v25 offset:55296
    v_mfma_f32_16x16x32_bf16 a[44:47], a[188:191], a[252:255], a[44:47]
    ds_read_b128 a[224:227], v25 offset:57344
    buffer_load_dwordx4 v6, s[20:23], s57 offen offset:1024 lds
    v_mfma_f32_16x16x32_bf16 a[48:51], a[192:195], a[232:235], a[48:51]
    ds_read_b128 a[228:231], v25 offset:59392
    v_mfma_f32_16x16x32_bf16 a[52:55], a[192:195], a[236:239], a[52:55]
    ds_read_b64_tr_b16 a[188:189], v22 offset:24576
    ds_read_b64_tr_b16 a[190:191], v22 offset:26112
    v_mfma_f32_16x16x32_bf16 a[56:59], a[192:195], a[240:243], a[56:59]
    ds_read_b128 v[160:163], v11 offset:0
    v_mfma_f32_16x16x32_bf16 a[60:63], a[192:195], a[244:247], a[60:63]
    ds_read_b128 v[164:167], v12 offset:0
    v_mfma_f32_16x16x32_bf16 a[64:67], a[192:195], a[248:251], a[64:67]
    buffer_load_dwordx4 v7, s[20:23], s57 offen offset:2048 lds
    v_mfma_f32_16x16x32_bf16 a[68:71], a[192:195], a[252:255], a[68:71]
    s_add_u32 s57, s62, 399360
    ds_read_b64_tr_b16 a[192:193], v23 offset:24576
    ds_read_b64_tr_b16 a[194:195], v23 offset:26112
    v_mfma_f32_16x16x32_bf16 a[72:75], a[196:199], a[232:235], a[72:75]
    s_add_u32 m0, s51, 86016
    ds_read_b128 v[168:171], v11 offset:128
    s_mul_i32 s62, s61, 6144
    v_mfma_f32_16x16x32_bf16 a[76:79], a[196:199], a[236:239], a[76:79]
    ds_read_b128 v[172:175], v12 offset:128
    v_mfma_f32_16x16x32_bf16 a[80:83], a[196:199], a[240:243], a[80:83]
    ds_read_b128 v[176:179], v11 offset:256
    v_mfma_f32_16x16x32_bf16 a[84:87], a[196:199], a[244:247], a[84:87]
    buffer_load_dwordx4 v5, s[20:23], s57 offen lds
    v_mfma_f32_16x16x32_bf16 a[88:91], a[196:199], a[248:251], a[88:91]
    ds_read_b128 v[180:183], v12 offset:256
    v_mfma_f32_16x16x32_bf16 a[92:95], a[196:199], a[252:255], a[92:95]
    ds_read_b64_tr_b16 a[196:197], v24 offset:61440
    ds_read_b64_tr_b16 a[198:199], v24 offset:62976
    v_mfma_f32_16x16x32_bf16 a[96:99], a[200:203], a[232:235], a[96:99]
    ds_read_b128 v[184:187], v11 offset:6144
    v_mfma_f32_16x16x32_bf16 a[100:103], a[200:203], a[236:239], a[100:103]
    ds_read_b128 v[188:191], v12 offset:6144
    v_mfma_f32_16x16x32_bf16 a[104:107], a[200:203], a[240:243], a[104:107]
    buffer_load_dwordx4 v6, s[20:23], s57 offen offset:1024 lds
    v_mfma_f32_16x16x32_bf16 a[108:111], a[200:203], a[244:247], a[108:111]
    ds_read_b128 v[192:195], v11 offset:6272
    v_mfma_f32_16x16x32_bf16 a[112:115], a[200:203], a[248:251], a[112:115]
    ds_read_b128 v[196:199], v12 offset:6272
    v_mfma_f32_16x16x32_bf16 a[116:119], a[200:203], a[252:255], a[116:119]
    ds_read_b64_tr_b16 a[200:201], v37 offset:61440
    ds_read_b64_tr_b16 a[202:203], v37 offset:62976
    v_mfma_f32_16x16x32_bf16 a[120:123], a[204:207], a[232:235], a[120:123]
    ds_read_b128 v[200:203], v11 offset:6400
    v_mfma_f32_16x16x32_bf16 a[124:127], a[204:207], a[236:239], a[124:127]
    buffer_load_dwordx4 v7, s[20:23], s57 offen offset:2048 lds
    v_mfma_f32_16x16x32_bf16 a[128:131], a[204:207], a[240:243], a[128:131]
    s_add_u32 m0, s51, 122880
    ds_read_b128 v[204:207], v12 offset:6400
    s_add_u32 s57, s62, 0
    v_mfma_f32_16x16x32_bf16 a[132:135], a[204:207], a[244:247], a[132:135]
    ds_read_b128 a[232:235], v26 offset:49152
    v_mfma_f32_16x16x32_bf16 a[136:139], a[204:207], a[248:251], a[136:139]
    ds_read_b128 a[236:239], v26 offset:51200
    v_mfma_f32_16x16x32_bf16 a[140:143], a[204:207], a[252:255], a[140:143]
    s_waitcnt lgkmcnt(6)
    ds_read_b64_tr_b16 a[204:205], v38 offset:61440
    ds_read_b64_tr_b16 a[206:207], v38 offset:62976
    v_mfma_f32_16x16x32_bf16 a[0:3], a[184:187], a[208:211], a[0:3]
    ds_read_b128 a[240:243], v26 offset:53248
    v_mfma_f32_16x16x32_bf16 a[4:7], a[184:187], a[212:215], a[4:7]
    ds_read_b128 a[244:247], v26 offset:55296
    v_mfma_f32_16x16x32_bf16 a[8:11], a[184:187], a[216:219], a[8:11]
    ds_read_b128 a[248:251], v26 offset:57344
    v_mfma_f32_16x16x32_bf16 a[12:15], a[184:187], a[220:223], a[12:15]
    ds_read_b128 a[252:255], v26 offset:59392
    v_mfma_f32_16x16x32_bf16 a[16:19], a[184:187], a[224:227], a[16:19]
    v_mfma_f32_16x16x32_bf16 a[20:23], a[184:187], a[228:231], a[20:23]
    s_waitcnt vmcnt(15) lgkmcnt(4)
    s_barrier
    v_mfma_f32_16x16x32_bf16 a[24:27], a[188:191], a[208:211], a[24:27]
    ds_read_b64_tr_b16 a[184:185], v21 offset:36864
    ds_read_b64_tr_b16 a[186:187], v21 offset:38400
    v_mfma_f32_16x16x32_bf16 a[28:31], a[188:191], a[212:215], a[28:31]
    buffer_load_dwordx4 v8, s[8:11], s61 offen lds
    v_mfma_f32_16x16x32_bf16 a[32:35], a[188:191], a[216:219], a[32:35]
    v_mfma_f32_16x16x32_bf16 a[36:39], a[188:191], a[220:223], a[36:39]
    v_mfma_f32_16x16x32_bf16 a[40:43], a[188:191], a[224:227], a[40:43]
    buffer_load_dwordx4 v9, s[8:11], s61 offen offset:1024 lds
    v_mfma_f32_16x16x32_bf16 a[44:47], a[188:191], a[228:231], a[44:47]
    ds_read_b64_tr_b16 a[188:189], v22 offset:36864
    ds_read_b64_tr_b16 a[190:191], v22 offset:38400
    v_mfma_f32_16x16x32_bf16 a[48:51], a[192:195], a[208:211], a[48:51]
    v_mfma_f32_16x16x32_bf16 a[52:55], a[192:195], a[212:215], a[52:55]
    buffer_load_dwordx4 v10, s[8:11], s61 offen offset:2048 lds
    v_mfma_f32_16x16x32_bf16 a[56:59], a[192:195], a[216:219], a[56:59]
    s_add_u32 m0, s51, 98304
    s_mul_i32 s61, s46, 122880
    v_mfma_f32_16x16x32_bf16 a[60:63], a[192:195], a[220:223], a[60:63]
    v_mfma_f32_16x16x32_bf16 a[64:67], a[192:195], a[224:227], a[64:67]
    buffer_load_dwordx4 v5, s[20:23], s57 offen lds
    v_mfma_f32_16x16x32_bf16 a[68:71], a[192:195], a[228:231], a[68:71]
    ds_read_b64_tr_b16 a[192:193], v23 offset:36864
    ds_read_b64_tr_b16 a[194:195], v23 offset:38400
    v_mfma_f32_16x16x32_bf16 a[72:75], a[196:199], a[208:211], a[72:75]
    v_mfma_f32_16x16x32_bf16 a[76:79], a[196:199], a[212:215], a[76:79]
    buffer_load_dwordx4 v6, s[20:23], s57 offen offset:1024 lds
    v_mfma_f32_16x16x32_bf16 a[80:83], a[196:199], a[216:219], a[80:83]
    v_mfma_f32_16x16x32_bf16 a[84:87], a[196:199], a[220:223], a[84:87]
    v_mfma_f32_16x16x32_bf16 a[88:91], a[196:199], a[224:227], a[88:91]
    buffer_load_dwordx4 v7, s[20:23], s57 offen offset:2048 lds
    v_mfma_f32_16x16x32_bf16 a[92:95], a[196:199], a[228:231], a[92:95]
    s_add_u32 s57, s62, 6144
    ds_read_b64_tr_b16 a[196:197], v24 offset:49152
    ds_read_b64_tr_b16 a[198:199], v24 offset:50688
    v_mfma_f32_16x16x32_bf16 a[96:99], a[200:203], a[208:211], a[96:99]
    s_add_u32 m0, s51, 61440
    v_mfma_f32_16x16x32_bf16 a[100:103], a[200:203], a[212:215], a[100:103]
    buffer_load_dwordx4 v5, s[20:23], s57 offen lds
    v_mfma_f32_16x16x32_bf16 a[104:107], a[200:203], a[216:219], a[104:107]
    v_mfma_f32_16x16x32_bf16 a[108:111], a[200:203], a[220:223], a[108:111]
    v_mfma_f32_16x16x32_bf16 a[112:115], a[200:203], a[224:227], a[112:115]
    buffer_load_dwordx4 v6, s[20:23], s57 offen offset:1024 lds
    v_mfma_f32_16x16x32_bf16 a[116:119], a[200:203], a[228:231], a[116:119]
    ds_read_b64_tr_b16 a[200:201], v37 offset:49152
    ds_read_b64_tr_b16 a[202:203], v37 offset:50688
    v_mfma_f32_16x16x32_bf16 a[120:123], a[204:207], a[208:211], a[120:123]
    v_mfma_f32_16x16x32_bf16 a[124:127], a[204:207], a[212:215], a[124:127]
    buffer_load_dwordx4 v7, s[20:23], s57 offen offset:2048 lds
    v_mfma_f32_16x16x32_bf16 a[128:131], a[204:207], a[216:219], a[128:131]
    s_add_u32 s57, s62, 393216
    s_add_u32 m0, s51, 110592
    v_mfma_f32_16x16x32_bf16 a[132:135], a[204:207], a[220:223], a[132:135]
    v_mfma_f32_16x16x32_bf16 a[136:139], a[204:207], a[224:227], a[136:139]
    v_mfma_f32_16x16x32_bf16 a[140:143], a[204:207], a[228:231], a[140:143]
    s_waitcnt lgkmcnt(2)
    ds_read_b64_tr_b16 a[204:205], v38 offset:49152
    ds_read_b64_tr_b16 a[206:207], v38 offset:50688
    v_mfma_f32_16x16x32_bf16 a[0:3], a[184:187], a[232:235], a[0:3]
    v_mfma_f32_16x16x32_bf16 a[4:7], a[184:187], a[236:239], a[4:7]
    v_mfma_f32_16x16x32_bf16 a[8:11], a[184:187], a[240:243], a[8:11]
    v_mfma_f32_16x16x32_bf16 a[12:15], a[184:187], a[244:247], a[12:15]
    v_mfma_f32_16x16x32_bf16 a[16:19], a[184:187], a[248:251], a[16:19]
    v_mfma_f32_16x16x32_bf16 a[20:23], a[184:187], a[252:255], a[20:23]
    s_waitcnt vmcnt(15) lgkmcnt(0)
    s_barrier
    v_mfma_f32_16x16x32_bf16 a[24:27], a[188:191], a[232:235], a[24:27]
    ds_read_b128 a[208:211], v25 offset:36864
    buffer_load_dwordx4 v5, s[20:23], s57 offen lds
    v_mfma_f32_16x16x32_bf16 a[28:31], a[188:191], a[236:239], a[28:31]
    ds_read_b64_tr_b16 a[184:185], v24 offset:36864
    ds_read_b64_tr_b16 a[186:187], v24 offset:38400
    v_mfma_f32_16x16x32_bf16 a[32:35], a[188:191], a[240:243], a[32:35]
    ds_read_b128 a[212:215], v25 offset:38912
    v_mfma_f32_16x16x32_bf16 a[36:39], a[188:191], a[244:247], a[36:39]
    ds_read_b128 a[216:219], v25 offset:40960
    buffer_load_dwordx4 v6, s[20:23], s57 offen offset:1024 lds
    v_mfma_f32_16x16x32_bf16 a[40:43], a[188:191], a[248:251], a[40:43]
    ds_read_b128 a[220:223], v25 offset:43008
    v_mfma_f32_16x16x32_bf16 a[44:47], a[188:191], a[252:255], a[44:47]
    ds_read_b128 a[224:227], v25 offset:45056
    v_mfma_f32_16x16x32_bf16 a[48:51], a[192:195], a[232:235], a[48:51]
    ds_read_b128 a[228:231], v25 offset:47104
    buffer_load_dwordx4 v7, s[20:23], s57 offen offset:2048 lds
    v_mfma_f32_16x16x32_bf16 a[52:55], a[192:195], a[236:239], a[52:55]
    s_mov_b32 s57, 0
    ds_read_b64_tr_b16 a[188:189], v37 offset:36864
    ds_read_b64_tr_b16 a[190:191], v37 offset:38400
    v_mfma_f32_16x16x32_bf16 a[56:59], a[192:195], a[240:243], a[56:59]
    s_add_u32 m0, s51, 0
    v_mfma_f32_16x16x32_bf16 a[60:63], a[192:195], a[244:247], a[60:63]
    buffer_load_dwordx4 v2, s[12:15], s57 offen nt lds
    v_mfma_f32_16x16x32_bf16 a[64:67], a[192:195], a[248:251], a[64:67]
    v_mfma_f32_16x16x32_bf16 a[68:71], a[192:195], a[252:255], a[68:71]
    ds_read_b64_tr_b16 a[192:193], v38 offset:36864
    ds_read_b64_tr_b16 a[194:195], v38 offset:38400
    v_mfma_f32_16x16x32_bf16 a[72:75], a[196:199], a[232:235], a[72:75]
    buffer_load_dwordx4 v3, s[12:15], s57 offen offset:1024 nt lds
    v_mfma_f32_16x16x32_bf16 a[76:79], a[196:199], a[236:239], a[76:79]
    v_mfma_f32_16x16x32_bf16 a[80:83], a[196:199], a[240:243], a[80:83]
    v_mfma_f32_16x16x32_bf16 a[84:87], a[196:199], a[244:247], a[84:87]
    buffer_load_dwordx4 v4, s[12:15], s57 offen offset:2048 nt lds
    v_mfma_f32_16x16x32_bf16 a[88:91], a[196:199], a[248:251], a[88:91]
    s_mov_b32 s57, 12288
    s_add_u32 m0, s51, 12288
    v_mfma_f32_16x16x32_bf16 a[92:95], a[196:199], a[252:255], a[92:95]
    ds_read_b64_tr_b16 a[196:197], v24 offset:24576
    ds_read_b64_tr_b16 a[198:199], v24 offset:26112
    v_mfma_f32_16x16x32_bf16 a[96:99], a[200:203], a[232:235], a[96:99]
    buffer_load_dwordx4 v2, s[12:15], s57 offen nt lds
    v_mfma_f32_16x16x32_bf16 a[100:103], a[200:203], a[236:239], a[100:103]
    v_mfma_f32_16x16x32_bf16 a[104:107], a[200:203], a[240:243], a[104:107]
    v_mfma_f32_16x16x32_bf16 a[108:111], a[200:203], a[244:247], a[108:111]
    buffer_load_dwordx4 v3, s[12:15], s57 offen offset:1024 nt lds
    v_mfma_f32_16x16x32_bf16 a[112:115], a[200:203], a[248:251], a[112:115]
    v_mfma_f32_16x16x32_bf16 a[116:119], a[200:203], a[252:255], a[116:119]
    ds_read_b64_tr_b16 a[200:201], v37 offset:24576
    ds_read_b64_tr_b16 a[202:203], v37 offset:26112
    v_mfma_f32_16x16x32_bf16 a[120:123], a[204:207], a[232:235], a[120:123]
    buffer_load_dwordx4 v4, s[12:15], s57 offen offset:2048 nt lds
    v_mfma_f32_16x16x32_bf16 a[124:127], a[204:207], a[236:239], a[124:127]
    s_add_u32 s57, s62, 399360
    ds_read_b128 a[232:235], v26 offset:36864
    s_add_u32 m0, s51, 73728
    v_mfma_f32_16x16x32_bf16 a[128:131], a[204:207], a[240:243], a[128:131]
    ds_read_b128 a[236:239], v26 offset:38912
    v_mfma_f32_16x16x32_bf16 a[132:135], a[204:207], a[244:247], a[132:135]
    ds_read_b128 a[240:243], v26 offset:40960
    v_mfma_f32_16x16x32_bf16 a[136:139], a[204:207], a[248:251], a[136:139]
    ds_read_b128 a[244:247], v26 offset:43008
    v_mfma_f32_16x16x32_bf16 a[140:143], a[204:207], a[252:255], a[140:143]
    s_waitcnt lgkmcnt(6)
    ds_read_b64_tr_b16 a[204:205], v38 offset:24576
    ds_read_b64_tr_b16 a[206:207], v38 offset:26112
    v_mfma_f32_16x16x32_bf16 a[0:3], a[184:187], a[208:211], a[0:3]
    ds_read_b128 a[248:251], v26 offset:45056
    v_mfma_f32_16x16x32_bf16 a[4:7], a[184:187], a[212:215], a[4:7]
    ds_read_b128 a[252:255], v26 offset:47104
    v_mfma_f32_16x16x32_bf16 a[8:11], a[184:187], a[216:219], a[8:11]
    v_mfma_f32_16x16x32_bf16 a[12:15], a[184:187], a[220:223], a[12:15]
    v_mfma_f32_16x16x32_bf16 a[16:19], a[184:187], a[224:227], a[16:19]
    v_mfma_f32_16x16x32_bf16 a[20:23], a[184:187], a[228:231], a[20:23]
    s_waitcnt vmcnt(18) lgkmcnt(2)
    s_barrier
    v_mfma_f32_16x16x32_bf16 a[24:27], a[188:191], a[208:211], a[24:27]
    ds_read_b64_tr_b16 a[184:185], v21 offset:0
    ds_read_b64_tr_b16 a[186:187], v21 offset:1536
    v_mfma_f32_16x16x32_bf16 a[28:31], a[188:191], a[212:215], a[28:31]
    v_mfma_f32_16x16x32_bf16 a[32:35], a[188:191], a[216:219], a[32:35]
    v_mfma_f32_16x16x32_bf16 a[36:39], a[188:191], a[220:223], a[36:39]
    v_mfma_f32_16x16x32_bf16 a[40:43], a[188:191], a[224:227], a[40:43]
    v_mfma_f32_16x16x32_bf16 a[44:47], a[188:191], a[228:231], a[44:47]
    ds_read_b64_tr_b16 a[188:189], v22 offset:0
    ds_read_b64_tr_b16 a[190:191], v22 offset:1536
    v_mfma_f32_16x16x32_bf16 a[48:51], a[192:195], a[208:211], a[48:51]
    v_mfma_f32_16x16x32_bf16 a[52:55], a[192:195], a[212:215], a[52:55]
    v_mfma_f32_16x16x32_bf16 a[56:59], a[192:195], a[216:219], a[56:59]
    v_mfma_f32_16x16x32_bf16 a[60:63], a[192:195], a[220:223], a[60:63]
    v_mfma_f32_16x16x32_bf16 a[64:67], a[192:195], a[224:227], a[64:67]
    v_mfma_f32_16x16x32_bf16 a[68:71], a[192:195], a[228:231], a[68:71]
    ds_read_b64_tr_b16 a[192:193], v23 offset:0
    ds_read_b64_tr_b16 a[194:195], v23 offset:1536
    v_mfma_f32_16x16x32_bf16 a[72:75], a[196:199], a[208:211], a[72:75]
    v_mfma_f32_16x16x32_bf16 a[76:79], a[196:199], a[212:215], a[76:79]
    v_mfma_f32_16x16x32_bf16 a[80:83], a[196:199], a[216:219], a[80:83]
    v_mfma_f32_16x16x32_bf16 a[84:87], a[196:199], a[220:223], a[84:87]
    v_mfma_f32_16x16x32_bf16 a[88:91], a[196:199], a[224:227], a[88:91]
    v_mfma_f32_16x16x32_bf16 a[92:95], a[196:199], a[228:231], a[92:95]
    ds_read_b64_tr_b16 a[196:197], v21 offset:12288
    ds_read_b64_tr_b16 a[198:199], v21 offset:13824
    v_mfma_f32_16x16x32_bf16 a[96:99], a[200:203], a[208:211], a[96:99]
    v_mfma_f32_16x16x32_bf16 a[100:103], a[200:203], a[212:215], a[100:103]
    v_mfma_f32_16x16x32_bf16 a[104:107], a[200:203], a[216:219], a[104:107]
    v_mfma_f32_16x16x32_bf16 a[108:111], a[200:203], a[220:223], a[108:111]
    v_mfma_f32_16x16x32_bf16 a[112:115], a[200:203], a[224:227], a[112:115]
    v_mfma_f32_16x16x32_bf16 a[116:119], a[200:203], a[228:231], a[116:119]
    ds_read_b64_tr_b16 a[200:201], v22 offset:12288
    ds_read_b64_tr_b16 a[202:203], v22 offset:13824
    v_mfma_f32_16x16x32_bf16 a[120:123], a[204:207], a[208:211], a[120:123]
    v_mfma_f32_16x16x32_bf16 a[124:127], a[204:207], a[212:215], a[124:127]
    v_mfma_f32_16x16x32_bf16 a[128:131], a[204:207], a[216:219], a[128:131]
    v_mfma_f32_16x16x32_bf16 a[132:135], a[204:207], a[220:223], a[132:135]
    v_mfma_f32_16x16x32_bf16 a[136:139], a[204:207], a[224:227], a[136:139]
    v_mfma_f32_16x16x32_bf16 a[140:143], a[204:207], a[228:231], a[140:143]
    s_waitcnt lgkmcnt(2)
    ds_read_b64_tr_b16 a[204:205], v23 offset:12288
    ds_read_b64_tr_b16 a[206:207], v23 offset:13824
    v_mfma_f32_16x16x32_bf16 a[0:3], a[184:187], a[232:235], a[0:3]
    v_mfma_f32_16x16x32_bf16 a[4:7], a[184:187], a[236:239], a[4:7]
    v_mfma_f32_16x16x32_bf16 a[8:11], a[184:187], a[240:243], a[8:11]
    v_mfma_f32_16x16x32_bf16 a[12:15], a[184:187], a[244:247], a[12:15]
    v_mfma_f32_16x16x32_bf16 a[16:19], a[184:187], a[248:251], a[16:19]
    v_mfma_f32_16x16x32_bf16 a[20:23], a[184:187], a[252:255], a[20:23]
    s_waitcnt vmcnt(9) lgkmcnt(0)
    s_barrier
    v_mfma_f32_16x16x32_bf16 a[24:27], a[188:191], a[232:235], a[24:27]
    ds_read_b128 a[208:211], v25 offset:24576
    buffer_load_dwordx4 v5, s[20:23], s57 offen lds
    v_mfma_f32_16x16x32_bf16 a[28:31], a[188:191], a[236:239], a[28:31]
    ds_read_b64_tr_b16 a[184:185], v21 offset:24576
    ds_read_b64_tr_b16 a[186:187], v21 offset:26112
    v_mfma_f32_16x16x32_bf16 a[32:35], a[188:191], a[240:243], a[32:35]
    ds_read_b128 a[212:215], v25 offset:26624
    v_mfma_f32_16x16x32_bf16 a[36:39], a[188:191], a[244:247], a[36:39]
    ds_read_b128 a[216:219], v25 offset:28672
    buffer_load_dwordx4 v6, s[20:23], s57 offen offset:1024 lds
    v_mfma_f32_16x16x32_bf16 a[40:43], a[188:191], a[248:251], a[40:43]
    ds_read_b128 a[220:223], v25 offset:30720
    v_mfma_f32_16x16x32_bf16 a[44:47], a[188:191], a[252:255], a[44:47]
    ds_read_b128 a[224:227], v25 offset:32768
    v_mfma_f32_16x16x32_bf16 a[48:51], a[192:195], a[232:235], a[48:51]
    ds_read_b128 a[228:231], v25 offset:34816
    v_add_u32 v25, 98304, v58
    v_mfma_f32_16x16x32_bf16 a[52:55], a[192:195], a[236:239], a[52:55]
    ds_read_b64_tr_b16 a[188:189], v22 offset:24576
    ds_read_b64_tr_b16 a[190:191], v22 offset:26112
    v_mfma_f32_16x16x32_bf16 a[56:59], a[192:195], a[240:243], a[56:59]
    buffer_load_dwordx4 v7, s[20:23], s57 offen offset:2048 lds
    v_mfma_f32_16x16x32_bf16 a[60:63], a[192:195], a[244:247], a[60:63]
    s_mov_b32 s57, 49152
    s_add_u32 m0, s51, 24576
    v_mfma_f32_16x16x32_bf16 a[64:67], a[192:195], a[248:251], a[64:67]
    v_mfma_f32_16x16x32_bf16 a[68:71], a[192:195], a[252:255], a[68:71]
    ds_read_b64_tr_b16 a[192:193], v23 offset:24576
    ds_read_b64_tr_b16 a[194:195], v23 offset:26112
    v_mfma_f32_16x16x32_bf16 a[72:75], a[196:199], a[232:235], a[72:75]
    buffer_load_dwordx4 v2, s[12:15], s57 offen nt lds
    v_mfma_f32_16x16x32_bf16 a[76:79], a[196:199], a[236:239], a[76:79]
    v_mfma_f32_16x16x32_bf16 a[80:83], a[196:199], a[240:243], a[80:83]
    v_mfma_f32_16x16x32_bf16 a[84:87], a[196:199], a[244:247], a[84:87]
    buffer_load_dwordx4 v3, s[12:15], s57 offen offset:1024 nt lds
    v_mfma_f32_16x16x32_bf16 a[88:91], a[196:199], a[248:251], a[88:91]
    v_mfma_f32_16x16x32_bf16 a[92:95], a[196:199], a[252:255], a[92:95]
    ds_read_b64_tr_b16 a[196:197], v24 offset:61440
    ds_read_b64_tr_b16 a[198:199], v24 offset:62976
    v_mfma_f32_16x16x32_bf16 a[96:99], a[200:203], a[232:235], a[96:99]
    buffer_load_dwordx4 v4, s[12:15], s57 offen offset:2048 nt lds
    v_mfma_f32_16x16x32_bf16 a[100:103], a[200:203], a[236:239], a[100:103]
    s_mov_b32 s57, 61440
    s_add_u32 m0, s51, 36864
    v_mfma_f32_16x16x32_bf16 a[104:107], a[200:203], a[240:243], a[104:107]
    v_mfma_f32_16x16x32_bf16 a[108:111], a[200:203], a[244:247], a[108:111]
    buffer_load_dwordx4 v2, s[12:15], s57 offen nt lds
    v_mfma_f32_16x16x32_bf16 a[112:115], a[200:203], a[248:251], a[112:115]
    v_mfma_f32_16x16x32_bf16 a[116:119], a[200:203], a[252:255], a[116:119]
    ds_read_b64_tr_b16 a[200:201], v37 offset:61440
    ds_read_b64_tr_b16 a[202:203], v37 offset:62976
    v_mfma_f32_16x16x32_bf16 a[120:123], a[204:207], a[232:235], a[120:123]
    buffer_load_dwordx4 v3, s[12:15], s57 offen offset:1024 nt lds
    v_mfma_f32_16x16x32_bf16 a[124:127], a[204:207], a[236:239], a[124:127]
    ds_read_b128 a[232:235], v26 offset:24576
    v_mfma_f32_16x16x32_bf16 a[128:131], a[204:207], a[240:243], a[128:131]
    ds_read_b128 a[236:239], v26 offset:26624
    v_mfma_f32_16x16x32_bf16 a[132:135], a[204:207], a[244:247], a[132:135]
    buffer_load_dwordx4 v4, s[12:15], s57 offen offset:2048 nt lds
    v_mfma_f32_16x16x32_bf16 a[136:139], a[204:207], a[248:251], a[136:139]
    s_mov_b32 s57, 98304
    ds_read_b128 a[240:243], v26 offset:28672
    s_add_u32 m0, s51, 49152
    v_mfma_f32_16x16x32_bf16 a[140:143], a[204:207], a[252:255], a[140:143]
    s_waitcnt lgkmcnt(5)
    ds_read_b64_tr_b16 a[204:205], v38 offset:61440
    ds_read_b64_tr_b16 a[206:207], v38 offset:62976
    v_mfma_f32_16x16x32_bf16 a[0:3], a[184:187], a[208:211], a[0:3]
    ds_read_b128 a[244:247], v26 offset:30720
    v_mfma_f32_16x16x32_bf16 a[4:7], a[184:187], a[212:215], a[4:7]
    ds_read_b128 a[248:251], v26 offset:32768
    v_mfma_f32_16x16x32_bf16 a[8:11], a[184:187], a[216:219], a[8:11]
    ds_read_b128 a[252:255], v26 offset:34816
    v_xor_b32 v26, 32, v25
    v_mfma_f32_16x16x32_bf16 a[12:15], a[184:187], a[220:223], a[12:15]
    v_mfma_f32_16x16x32_bf16 a[16:19], a[184:187], a[224:227], a[16:19]
    v_mfma_f32_16x16x32_bf16 a[20:23], a[184:187], a[228:231], a[20:23]
    s_waitcnt vmcnt(6) lgkmcnt(3)
    s_barrier
    v_mfma_f32_16x16x32_bf16 a[24:27], a[188:191], a[208:211], a[24:27]
    ds_read_b64_tr_b16 a[184:185], v21 offset:36864
    ds_read_b64_tr_b16 a[186:187], v21 offset:38400
    v_mfma_f32_16x16x32_bf16 a[28:31], a[188:191], a[212:215], a[28:31]
    buffer_load_dwordx4 v2, s[12:15], s57 offen nt lds
    v_mfma_f32_16x16x32_bf16 a[32:35], a[188:191], a[216:219], a[32:35]
    v_mfma_f32_16x16x32_bf16 a[36:39], a[188:191], a[220:223], a[36:39]
    v_mfma_f32_16x16x32_bf16 a[40:43], a[188:191], a[224:227], a[40:43]
    v_mfma_f32_16x16x32_bf16 a[44:47], a[188:191], a[228:231], a[44:47]
    ds_read_b64_tr_b16 a[188:189], v22 offset:36864
    ds_read_b64_tr_b16 a[190:191], v22 offset:38400
    v_mfma_f32_16x16x32_bf16 a[48:51], a[192:195], a[208:211], a[48:51]
    buffer_load_dwordx4 v3, s[12:15], s57 offen offset:1024 nt lds
    v_mfma_f32_16x16x32_bf16 a[52:55], a[192:195], a[212:215], a[52:55]
    v_mfma_f32_16x16x32_bf16 a[56:59], a[192:195], a[216:219], a[56:59]
    v_mfma_f32_16x16x32_bf16 a[60:63], a[192:195], a[220:223], a[60:63]
    v_mfma_f32_16x16x32_bf16 a[64:67], a[192:195], a[224:227], a[64:67]
    v_mfma_f32_16x16x32_bf16 a[68:71], a[192:195], a[228:231], a[68:71]
    ds_read_b64_tr_b16 a[192:193], v23 offset:36864
    ds_read_b64_tr_b16 a[194:195], v23 offset:38400
    v_mfma_f32_16x16x32_bf16 a[72:75], a[196:199], a[208:211], a[72:75]
    buffer_load_dwordx4 v4, s[12:15], s57 offen offset:2048 nt lds
    v_mfma_f32_16x16x32_bf16 a[76:79], a[196:199], a[212:215], a[76:79]
    s_mov_b32 s57, 110592
    s_add_u32 m0, s51, 61440
    v_mfma_f32_16x16x32_bf16 a[80:83], a[196:199], a[216:219], a[80:83]
    v_mfma_f32_16x16x32_bf16 a[84:87], a[196:199], a[220:223], a[84:87]
    v_mfma_f32_16x16x32_bf16 a[88:91], a[196:199], a[224:227], a[88:91]
    v_mfma_f32_16x16x32_bf16 a[92:95], a[196:199], a[228:231], a[92:95]
    buffer_load_dwordx4 v2, s[12:15], s57 offen nt lds
    v_mfma_f32_16x16x32_bf16 a[96:99], a[200:203], a[208:211], a[96:99]
    ds_read_b64_tr_b16 a[196:197], v21 offset:0
    ds_read_b64_tr_b16 a[198:199], v21 offset:1536
    v_mfma_f32_16x16x32_bf16 a[100:103], a[200:203], a[212:215], a[100:103]
    v_add_u32 v21, 0, v58
    v_mfma_f32_16x16x32_bf16 a[104:107], a[200:203], a[216:219], a[104:107]
    v_mfma_f32_16x16x32_bf16 a[108:111], a[200:203], a[220:223], a[108:111]
    v_mfma_f32_16x16x32_bf16 a[112:115], a[200:203], a[224:227], a[112:115]
    buffer_load_dwordx4 v3, s[12:15], s57 offen offset:1024 nt lds
    v_mfma_f32_16x16x32_bf16 a[116:119], a[200:203], a[228:231], a[116:119]
    ds_read_b64_tr_b16 a[200:201], v22 offset:0
    ds_read_b64_tr_b16 a[202:203], v22 offset:1536
    v_mfma_f32_16x16x32_bf16 a[120:123], a[204:207], a[208:211], a[120:123]
    v_xor_b32 v22, 32, v21
    v_mfma_f32_16x16x32_bf16 a[124:127], a[204:207], a[212:215], a[124:127]
    v_mfma_f32_16x16x32_bf16 a[128:131], a[204:207], a[216:219], a[128:131]
    v_mfma_f32_16x16x32_bf16 a[132:135], a[204:207], a[220:223], a[132:135]
    buffer_load_dwordx4 v4, s[12:15], s57 offen offset:2048 nt lds
    v_mfma_f32_16x16x32_bf16 a[136:139], a[204:207], a[224:227], a[136:139]
    s_mov_b32 s57, 122880
    s_add_u32 m0, s51, 0
    v_mfma_f32_16x16x32_bf16 a[140:143], a[204:207], a[228:231], a[140:143]
    s_waitcnt lgkmcnt(2)
    ds_read_b64_tr_b16 a[204:205], v23 offset:0
    ds_read_b64_tr_b16 a[206:207], v23 offset:1536
    v_mfma_f32_16x16x32_bf16 a[0:3], a[184:187], a[232:235], a[0:3]
    v_add_u32 v23, 49152, v58
    v_xor_b32 v24, 32, v23
    v_mfma_f32_16x16x32_bf16 a[4:7], a[184:187], a[236:239], a[4:7]
    v_mfma_f32_16x16x32_bf16 a[8:11], a[184:187], a[240:243], a[8:11]
    v_mfma_f32_16x16x32_bf16 a[12:15], a[184:187], a[244:247], a[12:15]
    s_nop 2
    v_accvgpr_read_b32 v64, a0
    v_accvgpr_read_b32 v65, a1
    v_mfma_f32_16x16x32_bf16 a[16:19], a[184:187], a[248:251], a[16:19]
    v_accvgpr_read_b32 v68, a4
    v_accvgpr_read_b32 v69, a5
    v_mfma_f32_16x16x32_bf16 a[20:23], a[184:187], a[252:255], a[20:23]
    v_accvgpr_read_b32 v72, a8
    v_accvgpr_read_b32 v73, a9
    v_mfma_f32_16x16x32_bf16 a[24:27], a[188:191], a[232:235], a[24:27]
    v_accvgpr_read_b32 v76, a12
    v_accvgpr_read_b32 v77, a13
    v_mfma_f32_16x16x32_bf16 a[28:31], a[188:191], a[236:239], a[28:31]
    v_accvgpr_read_b32 v80, a16
    v_accvgpr_read_b32 v81, a17
    v_mfma_f32_16x16x32_bf16 a[32:35], a[188:191], a[240:243], a[32:35]
    v_accvgpr_read_b32 v84, a20
    v_accvgpr_read_b32 v85, a21
    v_mfma_f32_16x16x32_bf16 a[36:39], a[188:191], a[244:247], a[36:39]
    s_waitcnt lgkmcnt(0)
    s_barrier
    v_accvgpr_read_b32 v66, a2
    v_mfma_f32_16x16x32_bf16 a[40:43], a[188:191], a[248:251], a[40:43]
    v_accvgpr_read_b32 v67, a3
    v_cvt_pk_bf16_f32 v64, v64, v65
    v_mfma_f32_16x16x32_bf16 a[44:47], a[188:191], a[252:255], a[44:47]
    v_accvgpr_read_b32 v70, a6
    v_accvgpr_read_b32 v71, a7
    v_mfma_f32_16x16x32_bf16 a[48:51], a[192:195], a[232:235], a[48:51]
    v_cvt_pk_bf16_f32 v68, v68, v69
    v_accvgpr_read_b32 v74, a10
    v_mfma_f32_16x16x32_bf16 a[52:55], a[192:195], a[236:239], a[52:55]
    v_accvgpr_read_b32 v75, a11
    v_cvt_pk_bf16_f32 v72, v72, v73
    v_mfma_f32_16x16x32_bf16 a[56:59], a[192:195], a[240:243], a[56:59]
    v_accvgpr_read_b32 v78, a14
    v_accvgpr_read_b32 v79, a15
    v_mfma_f32_16x16x32_bf16 a[60:63], a[192:195], a[244:247], a[60:63]
    v_cvt_pk_bf16_f32 v76, v76, v77
    v_accvgpr_read_b32 v82, a18
    v_mfma_f32_16x16x32_bf16 a[64:67], a[192:195], a[248:251], a[64:67]
    v_accvgpr_read_b32 v83, a19
    v_cvt_pk_bf16_f32 v80, v80, v81
    v_mfma_f32_16x16x32_bf16 a[68:71], a[192:195], a[252:255], a[68:71]
    v_accvgpr_read_b32 v86, a22
    v_accvgpr_read_b32 v87, a23
    v_mfma_f32_16x16x32_bf16 a[72:75], a[196:199], a[232:235], a[72:75]
    v_cvt_pk_bf16_f32 v84, v84, v85
    v_cvt_pk_bf16_f32 v65, v66, v67
    v_mfma_f32_16x16x32_bf16 a[76:79], a[196:199], a[236:239], a[76:79]
    ds_write_b64 v29, v[64:65] offset:0
    v_mfma_f32_16x16x32_bf16 a[80:83], a[196:199], a[240:243], a[80:83]
    v_cvt_pk_bf16_f32 v69, v70, v71
    v_cvt_pk_bf16_f32 v73, v74, v75
    v_mfma_f32_16x16x32_bf16 a[84:87], a[196:199], a[244:247], a[84:87]
    ds_write_b64 v29, v[68:69] offset:6144
    v_mfma_f32_16x16x32_bf16 a[88:91], a[196:199], a[248:251], a[88:91]
    ds_write_b64 v29, v[72:73] offset:12288
    v_mfma_f32_16x16x32_bf16 a[92:95], a[196:199], a[252:255], a[92:95]
    v_cvt_pk_bf16_f32 v77, v78, v79
    v_cvt_pk_bf16_f32 v81, v82, v83
    v_mfma_f32_16x16x32_bf16 a[96:99], a[200:203], a[232:235], a[96:99]
    ds_write_b64 v29, v[76:77] offset:18432
    v_mfma_f32_16x16x32_bf16 a[100:103], a[200:203], a[236:239], a[100:103]
    ds_write_b64 v29, v[80:81] offset:24576
    v_mfma_f32_16x16x32_bf16 a[104:107], a[200:203], a[240:243], a[104:107]
    v_cvt_pk_bf16_f32 v85, v86, v87
    v_accvgpr_read_b32 v88, a24
    v_mfma_f32_16x16x32_bf16 a[108:111], a[200:203], a[244:247], a[108:111]
    ds_write_b64 v29, v[84:85] offset:30720
    v_mfma_f32_16x16x32_bf16 a[112:115], a[200:203], a[248:251], a[112:115]
    v_accvgpr_read_b32 v89, a25
    v_accvgpr_read_b32 v92, a28
    v_mfma_f32_16x16x32_bf16 a[116:119], a[200:203], a[252:255], a[116:119]
    v_accvgpr_read_b32 v93, a29
    v_accvgpr_read_b32 v96, a32
    v_mfma_f32_16x16x32_bf16 a[120:123], a[204:207], a[232:235], a[120:123]
    v_accvgpr_read_b32 v97, a33
    v_accvgpr_read_b32 v100, a36
    v_mfma_f32_16x16x32_bf16 a[124:127], a[204:207], a[236:239], a[124:127]
    v_accvgpr_read_b32 v101, a37
    v_accvgpr_read_b32 v104, a40
    v_mfma_f32_16x16x32_bf16 a[128:131], a[204:207], a[240:243], a[128:131]
    v_accvgpr_read_b32 v105, a41
    v_accvgpr_read_b32 v108, a44
    v_mfma_f32_16x16x32_bf16 a[132:135], a[204:207], a[244:247], a[132:135]
    v_accvgpr_read_b32 v109, a45
    v_accvgpr_read_b32 v64, a48
    v_mfma_f32_16x16x32_bf16 a[136:139], a[204:207], a[248:251], a[136:139]
    v_accvgpr_read_b32 v65, a49
    v_accvgpr_read_b32 v68, a52
    v_mfma_f32_16x16x32_bf16 a[140:143], a[204:207], a[252:255], a[140:143]
    v_accvgpr_read_b32 v69, a53
    v_accvgpr_read_b32 v72, a56
    v_accvgpr_read_b32 v73, a57
    v_accvgpr_read_b32 v76, a60
    v_accvgpr_read_b32 v77, a61
    v_accvgpr_read_b32 v80, a64
    v_accvgpr_read_b32 v81, a65
    v_accvgpr_read_b32 v84, a68
    v_accvgpr_read_b32 v85, a69
    v_accvgpr_read_b32 v90, a26
    v_accvgpr_read_b32 v91, a27
    v_cvt_pk_bf16_f32 v88, v88, v89
    v_accvgpr_read_b32 v94, a30
    v_accvgpr_read_b32 v95, a31
    v_cvt_pk_bf16_f32 v92, v92, v93
    v_accvgpr_read_b32 v98, a34
    v_accvgpr_read_b32 v99, a35
    v_cvt_pk_bf16_f32 v96, v96, v97
    v_accvgpr_read_b32 v102, a38
    v_accvgpr_read_b32 v103, a39
    v_cvt_pk_bf16_f32 v100, v100, v101
    v_accvgpr_read_b32 v106, a42
    v_accvgpr_read_b32 v107, a43
    v_cvt_pk_bf16_f32 v104, v104, v105
    v_accvgpr_read_b32 v110, a46
    v_accvgpr_read_b32 v111, a47
    v_cvt_pk_bf16_f32 v108, v108, v109
    v_accvgpr_read_b32 v66, a50
    v_accvgpr_read_b32 v67, a51
    v_cvt_pk_bf16_f32 v64, v64, v65
    v_accvgpr_read_b32 v70, a54
    v_accvgpr_read_b32 v71, a55
    v_cvt_pk_bf16_f32 v68, v68, v69
    v_accvgpr_read_b32 v74, a58
    v_accvgpr_read_b32 v75, a59
    v_cvt_pk_bf16_f32 v72, v72, v73
    v_accvgpr_read_b32 v78, a62
    v_accvgpr_read_b32 v79, a63
    v_cvt_pk_bf16_f32 v76, v76, v77
    v_accvgpr_read_b32 v82, a66
    v_accvgpr_read_b32 v83, a67
    v_cvt_pk_bf16_f32 v80, v80, v81
    v_accvgpr_read_b32 v86, a70
    v_accvgpr_read_b32 v87, a71
    v_cvt_pk_bf16_f32 v84, v84, v85
    v_cvt_pk_bf16_f32 v89, v90, v91
    v_cvt_pk_bf16_f32 v93, v94, v95
    v_cvt_pk_bf16_f32 v97, v98, v99
    v_cvt_pk_bf16_f32 v101, v102, v103
    v_cvt_pk_bf16_f32 v105, v106, v107
    v_cvt_pk_bf16_f32 v109, v110, v111
    v_cvt_pk_bf16_f32 v65, v66, v67
    v_cvt_pk_bf16_f32 v69, v70, v71
    v_cvt_pk_bf16_f32 v73, v74, v75
    v_cvt_pk_bf16_f32 v77, v78, v79
    v_cvt_pk_bf16_f32 v81, v82, v83
    v_cvt_pk_bf16_f32 v85, v86, v87
    ds_write_b64 v29, v[88:89] offset:512
    ds_write_b64 v29, v[92:93] offset:6656
    ds_write_b64 v29, v[96:97] offset:12800
    ds_write_b64 v29, v[100:101] offset:18944
    ds_write_b64 v29, v[104:105] offset:25088
    ds_write_b64 v29, v[108:109] offset:31232
    ds_write_b64 v29, v[64:65] offset:1024
    ds_write_b64 v29, v[68:69] offset:7168
    ds_write_b64 v29, v[72:73] offset:13312
    ds_write_b64 v29, v[76:77] offset:19456
    ds_write_b64 v29, v[80:81] offset:25600
    ds_write_b64 v29, v[84:85] offset:31744
    s_waitcnt lgkmcnt(0)
    s_barrier
    ds_read_b128 a[0:3], v30 offset:0
    ds_read_b128 a[160:163], v11 offset:0
    ds_read_b128 a[4:7], v30 offset:6144
    ds_read_b128 a[8:11], v30 offset:12288
    ds_read_b128 a[12:15], v30 offset:1024
    ds_read_b128 a[164:167], v12 offset:0
    ds_read_b128 a[16:19], v30 offset:7168
    ds_read_b128 a[20:23], v30 offset:13312
    s_waitcnt lgkmcnt(6)
    v_mfma_f32_16x16x32_bf16 v[64:67], a[160:163], a[0:3], 0
    s_waitcnt lgkmcnt(5)
    ds_read_b128 a[24:27], v30 offset:2048
    v_mfma_f32_16x16x32_bf16 v[72:75], a[160:163], a[4:7], 0
    s_waitcnt lgkmcnt(5)
    ds_read_b128 a[168:171], v11 offset:128
    v_mfma_f32_16x16x32_bf16 v[80:83], a[160:163], a[8:11], 0
    s_waitcnt lgkmcnt(5)
    ds_read_b128 a[28:31], v30 offset:8192
    ds_read_b128 a[32:35], v30 offset:14336
    s_waitcnt lgkmcnt(6)
    v_mfma_f32_16x16x32_bf16 v[64:67], a[164:167], a[12:15], v[64:67]
    s_waitcnt lgkmcnt(5)
    ds_read_b128 a[36:39], v30 offset:3072
    v_mfma_f32_16x16x32_bf16 v[72:75], a[164:167], a[16:19], v[72:75]
    s_waitcnt lgkmcnt(5)
    ds_read_b128 a[172:175], v12 offset:128
    v_mfma_f32_16x16x32_bf16 v[80:83], a[164:167], a[20:23], v[80:83]
    s_waitcnt lgkmcnt(5)
    ds_read_b128 a[40:43], v30 offset:9216
    ds_read_b128 a[44:47], v30 offset:15360
    s_waitcnt lgkmcnt(6)
    v_mfma_f32_16x16x32_bf16 v[64:67], a[168:171], a[24:27], v[64:67]
    s_waitcnt lgkmcnt(5)
    ds_read_b128 a[48:51], v30 offset:4096
    v_mfma_f32_16x16x32_bf16 v[72:75], a[168:171], a[28:31], v[72:75]
    s_waitcnt lgkmcnt(5)
    ds_read_b128 a[176:179], v11 offset:256
    v_mfma_f32_16x16x32_bf16 v[80:83], a[168:171], a[32:35], v[80:83]
    s_waitcnt lgkmcnt(5)
    ds_read_b128 a[52:55], v30 offset:10240
    ds_read_b128 a[56:59], v30 offset:16384
    s_waitcnt lgkmcnt(6)
    v_mfma_f32_16x16x32_bf16 v[64:67], a[172:175], a[36:39], v[64:67]
    s_waitcnt lgkmcnt(5)
    ds_read_b128 a[60:63], v30 offset:5120
    v_mfma_f32_16x16x32_bf16 v[72:75], a[172:175], a[40:43], v[72:75]
    s_waitcnt lgkmcnt(5)
    ds_read_b128 a[180:183], v12 offset:256
    v_mfma_f32_16x16x32_bf16 v[80:83], a[172:175], a[44:47], v[80:83]
    s_waitcnt lgkmcnt(5)
    ds_read_b128 a[64:67], v30 offset:11264
    ds_read_b128 a[68:71], v30 offset:17408
    s_waitcnt lgkmcnt(6)
    v_mfma_f32_16x16x32_bf16 v[64:67], a[176:179], a[48:51], v[64:67]
    s_waitcnt lgkmcnt(5)
    ds_read_b128 a[160:163], v11 offset:6144
    v_mfma_f32_16x16x32_bf16 v[72:75], a[176:179], a[52:55], v[72:75]
    s_waitcnt lgkmcnt(5)
    ds_read_b128 a[164:167], v12 offset:6144
    v_mfma_f32_16x16x32_bf16 v[80:83], a[176:179], a[56:59], v[80:83]
    s_waitcnt lgkmcnt(5)
    ds_read_b128 a[168:171], v11 offset:6272
    ds_read_b128 a[172:175], v12 offset:6272
    s_waitcnt lgkmcnt(6)
    v_mfma_f32_16x16x32_bf16 v[64:67], a[180:183], a[60:63], v[64:67]
    s_waitcnt lgkmcnt(5)
    ds_read_b128 a[176:179], v11 offset:6400
    v_mfma_f32_16x16x32_bf16 v[72:75], a[180:183], a[64:67], v[72:75]
    s_waitcnt lgkmcnt(5)
    v_mfma_f32_16x16x32_bf16 v[80:83], a[180:183], a[68:71], v[80:83]
    s_waitcnt lgkmcnt(4)
    ds_read_b128 a[180:183], v12 offset:6400
    v_mfma_f32_16x16x32_bf16 v[68:71], a[160:163], a[0:3], 0
    v_max3_f32 v36, v64, v65, v66
    v_max_f32 v36, v36, v67
    v_mfma_f32_16x16x32_bf16 v[76:79], a[160:163], a[4:7], 0
    v_max3_f32 v37, v72, v73, v74
    v_max_f32 v37, v37, v75
    v_mfma_f32_16x16x32_bf16 v[84:87], a[160:163], a[8:11], 0
    s_waitcnt lgkmcnt(3)
    v_max3_f32 v38, v80, v81, v82
    v_max_f32 v38, v38, v83
    v_mfma_f32_16x16x32_bf16 v[68:71], a[164:167], a[12:15], v[68:71]
    v_mfma_f32_16x16x32_bf16 v[76:79], a[164:167], a[16:19], v[76:79]
    v_mfma_f32_16x16x32_bf16 v[84:87], a[164:167], a[20:23], v[84:87]
    s_waitcnt lgkmcnt(0)
    s_barrier
    buffer_load_dwordx4 v2, s[12:15], s57 offen nt lds
    v_mfma_f32_16x16x32_bf16 v[68:71], a[168:171], a[24:27], v[68:71]
    v_mfma_f32_16x16x32_bf16 v[76:79], a[168:171], a[28:31], v[76:79]
    v_mfma_f32_16x16x32_bf16 v[84:87], a[168:171], a[32:35], v[84:87]
    v_mfma_f32_16x16x32_bf16 v[68:71], a[172:175], a[36:39], v[68:71]
    v_mfma_f32_16x16x32_bf16 v[76:79], a[172:175], a[40:43], v[76:79]
    buffer_load_dwordx4 v3, s[12:15], s57 offen offset:1024 nt lds
    v_mfma_f32_16x16x32_bf16 v[84:87], a[172:175], a[44:47], v[84:87]
    v_mfma_f32_16x16x32_bf16 v[68:71], a[176:179], a[48:51], v[68:71]
    v_mfma_f32_16x16x32_bf16 v[76:79], a[176:179], a[52:55], v[76:79]
    v_mfma_f32_16x16x32_bf16 v[84:87], a[176:179], a[56:59], v[84:87]
    v_mfma_f32_16x16x32_bf16 v[68:71], a[180:183], a[60:63], v[68:71]
    buffer_load_dwordx4 v4, s[12:15], s57 offen offset:2048 nt lds
    v_mfma_f32_16x16x32_bf16 v[76:79], a[180:183], a[64:67], v[76:79]
    s_mov_b32 s57, 135168
    s_add_u32 m0, s51, 12288
    v_mfma_f32_16x16x32_bf16 v[84:87], a[180:183], a[68:71], v[84:87]
    v_mfma_f32_16x16x32_bf16 v[88:91], v[112:115], a[0:3], 0
    s_nop 1
    v_max3_f32 v36, v36, v68, v69
    v_max3_f32 v36, v36, v70, v71
    v_mfma_f32_16x16x32_bf16 v[96:99], v[112:115], a[4:7], 0
    v_max3_f32 v37, v37, v76, v77
    v_max3_f32 v37, v37, v78, v79
    v_mfma_f32_16x16x32_bf16 v[104:107], v[112:115], a[8:11], 0
    buffer_load_dwordx4 v2, s[12:15], s57 offen nt lds
    v_mfma_f32_16x16x32_bf16 v[88:91], v[116:119], a[12:15], v[88:91]
    v_max3_f32 v38, v38, v84, v85
    v_max3_f32 v38, v38, v86, v87
    v_mfma_f32_16x16x32_bf16 v[96:99], v[116:119], a[16:19], v[96:99]
    v_mfma_f32_16x16x32_bf16 v[104:107], v[116:119], a[20:23], v[104:107]
    v_mfma_f32_16x16x32_bf16 v[88:91], v[120:123], a[24:27], v[88:91]
    v_mfma_f32_16x16x32_bf16 v[96:99], v[120:123], a[28:31], v[96:99]
    buffer_load_dwordx4 v3, s[12:15], s57 offen offset:1024 nt lds
    v_mfma_f32_16x16x32_bf16 v[104:107], v[120:123], a[32:35], v[104:107]
    v_mfma_f32_16x16x32_bf16 v[88:91], v[124:127], a[36:39], v[88:91]
    v_mfma_f32_16x16x32_bf16 v[96:99], v[124:127], a[40:43], v[96:99]
    v_mfma_f32_16x16x32_bf16 v[104:107], v[124:127], a[44:47], v[104:107]
    v_mfma_f32_16x16x32_bf16 v[88:91], v[128:131], a[48:51], v[88:91]
    buffer_load_dwordx4 v4, s[12:15], s57 offen offset:2048 nt lds
    v_mfma_f32_16x16x32_bf16 v[96:99], v[128:131], a[52:55], v[96:99]
    s_mov_b32 s57, 147456
    s_waitcnt vmcnt(12)
    s_barrier
    v_mfma_f32_16x16x32_bf16 v[104:107], v[128:131], a[56:59], v[104:107]
    s_add_u32 m0, s51, 24576
    ds_read_b128 a[160:163], v11 offset:24576
    v_mfma_f32_16x16x32_bf16 v[88:91], v[132:135], a[60:63], v[88:91]
    ds_read_b128 a[164:167], v12 offset:24576
    v_mfma_f32_16x16x32_bf16 v[96:99], v[132:135], a[64:67], v[96:99]
    ds_read_b128 a[168:171], v11 offset:24704
    v_mfma_f32_16x16x32_bf16 v[104:107], v[132:135], a[68:71], v[104:107]
    ds_read_b128 a[172:175], v12 offset:24704
    v_mfma_f32_16x16x32_bf16 v[92:95], v[136:139], a[0:3], 0
    ds_read_b128 a[176:179], v11 offset:24832
    s_nop 0
    v_max3_f32 v36, v36, v88, v89
    v_mfma_f32_16x16x32_bf16 v[100:103], v[136:139], a[4:7], 0
    ds_read_b128 a[180:183], v12 offset:24832
    v_max3_f32 v37, v37, v96, v97
    v_mfma_f32_16x16x32_bf16 v[108:111], v[136:139], a[8:11], 0
    v_max3_f32 v38, v38, v104, v105
    v_max3_f32 v36, v36, v90, v91
    v_mfma_f32_16x16x32_bf16 v[92:95], v[140:143], a[12:15], v[92:95]
    v_max3_f32 v37, v37, v98, v99
    v_max3_f32 v38, v38, v106, v107
    v_mfma_f32_16x16x32_bf16 v[100:103], v[140:143], a[16:19], v[100:103]
    v_mfma_f32_16x16x32_bf16 v[108:111], v[140:143], a[20:23], v[108:111]
    v_mfma_f32_16x16x32_bf16 v[92:95], v[144:147], a[24:27], v[92:95]
    v_mfma_f32_16x16x32_bf16 v[100:103], v[144:147], a[28:31], v[100:103]
    v_mfma_f32_16x16x32_bf16 v[108:111], v[144:147], a[32:35], v[108:111]
    v_mfma_f32_16x16x32_bf16 v[92:95], v[148:151], a[36:39], v[92:95]
    v_mfma_f32_16x16x32_bf16 v[100:103], v[148:151], a[40:43], v[100:103]
    v_mfma_f32_16x16x32_bf16 v[108:111], v[148:151], a[44:47], v[108:111]
    v_mfma_f32_16x16x32_bf16 v[92:95], v[152:155], a[48:51], v[92:95]
    v_mfma_f32_16x16x32_bf16 v[100:103], v[152:155], a[52:55], v[100:103]
    v_mfma_f32_16x16x32_bf16 v[108:111], v[152:155], a[56:59], v[108:111]
    v_mfma_f32_16x16x32_bf16 v[92:95], v[156:159], a[60:63], v[92:95]
    v_mfma_f32_16x16x32_bf16 v[100:103], v[156:159], a[64:67], v[100:103]
    v_mfma_f32_16x16x32_bf16 v[108:111], v[156:159], a[68:71], v[108:111]
    s_waitcnt lgkmcnt(0)
    v_mfma_f32_16x16x32_bf16 v[112:115], a[160:163], a[0:3], 0
    s_nop 3
    v_max3_f32 v36, v36, v92, v93
    v_max3_f32 v36, v36, v94, v95
    v_mfma_f32_16x16x32_bf16 v[120:123], a[160:163], a[4:7], 0
    v_max3_f32 v37, v37, v100, v101
    v_max3_f32 v37, v37, v102, v103
    v_mfma_f32_16x16x32_bf16 v[128:131], a[160:163], a[8:11], 0
    ds_read_b128 a[160:163], v11 offset:30720
    v_max3_f32 v38, v38, v108, v109
    v_mfma_f32_16x16x32_bf16 v[112:115], a[164:167], a[12:15], v[112:115]
    v_max3_f32 v38, v38, v110, v111
    v_mfma_f32_16x16x32_bf16 v[120:123], a[164:167], a[16:19], v[120:123]
    v_mfma_f32_16x16x32_bf16 v[128:131], a[164:167], a[20:23], v[128:131]
    ds_read_b128 a[164:167], v12 offset:30720
    v_mfma_f32_16x16x32_bf16 v[112:115], a[168:171], a[24:27], v[112:115]
    v_mfma_f32_16x16x32_bf16 v[120:123], a[168:171], a[28:31], v[120:123]
    v_mfma_f32_16x16x32_bf16 v[128:131], a[168:171], a[32:35], v[128:131]
    ds_read_b128 a[168:171], v11 offset:30848
    v_mfma_f32_16x16x32_bf16 v[112:115], a[172:175], a[36:39], v[112:115]
    v_mfma_f32_16x16x32_bf16 v[120:123], a[172:175], a[40:43], v[120:123]
    v_mfma_f32_16x16x32_bf16 v[128:131], a[172:175], a[44:47], v[128:131]
    ds_read_b128 a[172:175], v12 offset:30848
    v_mfma_f32_16x16x32_bf16 v[112:115], a[176:179], a[48:51], v[112:115]
    v_mfma_f32_16x16x32_bf16 v[120:123], a[176:179], a[52:55], v[120:123]
    v_mfma_f32_16x16x32_bf16 v[128:131], a[176:179], a[56:59], v[128:131]
    ds_read_b128 a[176:179], v11 offset:30976
    v_mfma_f32_16x16x32_bf16 v[112:115], a[180:183], a[60:63], v[112:115]
    v_mfma_f32_16x16x32_bf16 v[120:123], a[180:183], a[64:67], v[120:123]
    v_mfma_f32_16x16x32_bf16 v[128:131], a[180:183], a[68:71], v[128:131]
    s_waitcnt lgkmcnt(2)
    ds_read_b128 a[180:183], v12 offset:30976
    v_mfma_f32_16x16x32_bf16 v[116:119], a[160:163], a[0:3], 0
    s_nop 2
    v_max3_f32 v36, v36, v112, v113
    v_max3_f32 v36, v36, v114, v115
    v_mfma_f32_16x16x32_bf16 v[124:127], a[160:163], a[4:7], 0
    v_max3_f32 v37, v37, v120, v121
    v_max3_f32 v37, v37, v122, v123
    v_mfma_f32_16x16x32_bf16 v[132:135], a[160:163], a[8:11], 0
    v_max3_f32 v38, v38, v128, v129
    v_max3_f32 v38, v38, v130, v131
    v_mfma_f32_16x16x32_bf16 v[116:119], a[164:167], a[12:15], v[116:119]
    v_mfma_f32_16x16x32_bf16 v[124:127], a[164:167], a[16:19], v[124:127]
    v_mfma_f32_16x16x32_bf16 v[132:135], a[164:167], a[20:23], v[132:135]
    s_waitcnt lgkmcnt(0)
    s_barrier
    buffer_load_dwordx4 v2, s[12:15], s57 offen nt lds
    v_mfma_f32_16x16x32_bf16 v[116:119], a[168:171], a[24:27], v[116:119]
    v_mfma_f32_16x16x32_bf16 v[124:127], a[168:171], a[28:31], v[124:127]
    v_mfma_f32_16x16x32_bf16 v[132:135], a[168:171], a[32:35], v[132:135]
    v_mfma_f32_16x16x32_bf16 v[116:119], a[172:175], a[36:39], v[116:119]
    v_mfma_f32_16x16x32_bf16 v[124:127], a[172:175], a[40:43], v[124:127]
    buffer_load_dwordx4 v3, s[12:15], s57 offen offset:1024 nt lds
    v_mfma_f32_16x16x32_bf16 v[132:135], a[172:175], a[44:47], v[132:135]
    v_mfma_f32_16x16x32_bf16 v[116:119], a[176:179], a[48:51], v[116:119]
    v_mfma_f32_16x16x32_bf16 v[124:127], a[176:179], a[52:55], v[124:127]
    v_mfma_f32_16x16x32_bf16 v[132:135], a[176:179], a[56:59], v[132:135]
    v_mfma_f32_16x16x32_bf16 v[116:119], a[180:183], a[60:63], v[116:119]
    buffer_load_dwordx4 v4, s[12:15], s57 offen offset:2048 nt lds
    v_mfma_f32_16x16x32_bf16 v[124:127], a[180:183], a[64:67], v[124:127]
    s_mov_b32 s57, 159744
    s_add_u32 m0, s51, 36864
    v_mfma_f32_16x16x32_bf16 v[132:135], a[180:183], a[68:71], v[132:135]
    v_mfma_f32_16x16x32_bf16 v[136:139], v[160:163], a[0:3], 0
    s_nop 1
    v_max3_f32 v36, v36, v116, v117
    v_max3_f32 v36, v36, v118, v119
    v_mfma_f32_16x16x32_bf16 v[144:147], v[160:163], a[4:7], 0
    v_max3_f32 v37, v37, v124, v125
    v_max3_f32 v37, v37, v126, v127
    v_mfma_f32_16x16x32_bf16 v[152:155], v[160:163], a[8:11], 0
    buffer_load_dwordx4 v2, s[12:15], s57 offen nt lds
    v_mfma_f32_16x16x32_bf16 v[136:139], v[164:167], a[12:15], v[136:139]
    v_max3_f32 v38, v38, v132, v133
    v_max3_f32 v38, v38, v134, v135
    v_mfma_f32_16x16x32_bf16 v[144:147], v[164:167], a[16:19], v[144:147]
    v_mfma_f32_16x16x32_bf16 v[152:155], v[164:167], a[20:23], v[152:155]
    v_mfma_f32_16x16x32_bf16 v[136:139], v[168:171], a[24:27], v[136:139]
    v_mfma_f32_16x16x32_bf16 v[144:147], v[168:171], a[28:31], v[144:147]
    buffer_load_dwordx4 v3, s[12:15], s57 offen offset:1024 nt lds
    v_mfma_f32_16x16x32_bf16 v[152:155], v[168:171], a[32:35], v[152:155]
    v_mfma_f32_16x16x32_bf16 v[136:139], v[172:175], a[36:39], v[136:139]
    v_mfma_f32_16x16x32_bf16 v[144:147], v[172:175], a[40:43], v[144:147]
    v_mfma_f32_16x16x32_bf16 v[152:155], v[172:175], a[44:47], v[152:155]
    v_mfma_f32_16x16x32_bf16 v[136:139], v[176:179], a[48:51], v[136:139]
    buffer_load_dwordx4 v4, s[12:15], s57 offen offset:2048 nt lds
    v_mfma_f32_16x16x32_bf16 v[144:147], v[176:179], a[52:55], v[144:147]
    s_mov_b32 s57, 172032
    s_waitcnt vmcnt(12)
    s_barrier
    v_mfma_f32_16x16x32_bf16 v[152:155], v[176:179], a[56:59], v[152:155]
    s_add_u32 m0, s51, 49152
    ds_read_b128 a[160:163], v11 offset:49152
    v_mfma_f32_16x16x32_bf16 v[136:139], v[180:183], a[60:63], v[136:139]
    ds_read_b128 a[164:167], v12 offset:49152
    v_mfma_f32_16x16x32_bf16 v[144:147], v[180:183], a[64:67], v[144:147]
    ds_read_b128 a[168:171], v11 offset:49280
    v_mfma_f32_16x16x32_bf16 v[152:155], v[180:183], a[68:71], v[152:155]
    ds_read_b128 a[172:175], v12 offset:49280
    v_mfma_f32_16x16x32_bf16 v[140:143], v[184:187], a[0:3], 0
    ds_read_b128 a[176:179], v11 offset:49408
    s_nop 0
    v_max3_f32 v36, v36, v136, v137
    v_mfma_f32_16x16x32_bf16 v[148:151], v[184:187], a[4:7], 0
    ds_read_b128 a[180:183], v12 offset:49408
    v_max3_f32 v37, v37, v144, v145
    v_mfma_f32_16x16x32_bf16 v[156:159], v[184:187], a[8:11], 0
    v_max3_f32 v38, v38, v152, v153
    v_max3_f32 v36, v36, v138, v139
    v_mfma_f32_16x16x32_bf16 v[140:143], v[188:191], a[12:15], v[140:143]
    v_max3_f32 v37, v37, v146, v147
    v_max3_f32 v38, v38, v154, v155
    v_mfma_f32_16x16x32_bf16 v[148:151], v[188:191], a[16:19], v[148:151]
    v_mfma_f32_16x16x32_bf16 v[156:159], v[188:191], a[20:23], v[156:159]
    v_mfma_f32_16x16x32_bf16 v[140:143], v[192:195], a[24:27], v[140:143]
    v_mfma_f32_16x16x32_bf16 v[148:151], v[192:195], a[28:31], v[148:151]
    v_mfma_f32_16x16x32_bf16 v[156:159], v[192:195], a[32:35], v[156:159]
    v_mfma_f32_16x16x32_bf16 v[140:143], v[196:199], a[36:39], v[140:143]
    v_mfma_f32_16x16x32_bf16 v[148:151], v[196:199], a[40:43], v[148:151]
    v_mfma_f32_16x16x32_bf16 v[156:159], v[196:199], a[44:47], v[156:159]
    v_mfma_f32_16x16x32_bf16 v[140:143], v[200:203], a[48:51], v[140:143]
    v_mfma_f32_16x16x32_bf16 v[148:151], v[200:203], a[52:55], v[148:151]
    v_mfma_f32_16x16x32_bf16 v[156:159], v[200:203], a[56:59], v[156:159]
    v_mfma_f32_16x16x32_bf16 v[140:143], v[204:207], a[60:63], v[140:143]
    v_mfma_f32_16x16x32_bf16 v[148:151], v[204:207], a[64:67], v[148:151]
    v_mfma_f32_16x16x32_bf16 v[156:159], v[204:207], a[68:71], v[156:159]
    s_waitcnt lgkmcnt(0)
    v_mfma_f32_16x16x32_bf16 v[160:163], a[160:163], a[0:3], 0
    s_nop 3
    v_max3_f32 v36, v36, v140, v141
    v_max3_f32 v36, v36, v142, v143
    v_mfma_f32_16x16x32_bf16 v[168:171], a[160:163], a[4:7], 0
    v_max3_f32 v37, v37, v148, v149
    v_max3_f32 v37, v37, v150, v151
    v_mfma_f32_16x16x32_bf16 v[176:179], a[160:163], a[8:11], 0
    ds_read_b128 a[160:163], v11 offset:55296
    v_max3_f32 v38, v38, v156, v157
    v_mfma_f32_16x16x32_bf16 v[160:163], a[164:167], a[12:15], v[160:163]
    v_max3_f32 v38, v38, v158, v159
    v_mfma_f32_16x16x32_bf16 v[168:171], a[164:167], a[16:19], v[168:171]
    v_mfma_f32_16x16x32_bf16 v[176:179], a[164:167], a[20:23], v[176:179]
    ds_read_b128 a[164:167], v12 offset:55296
    v_mfma_f32_16x16x32_bf16 v[160:163], a[168:171], a[24:27], v[160:163]
    v_mfma_f32_16x16x32_bf16 v[168:171], a[168:171], a[28:31], v[168:171]
    v_mfma_f32_16x16x32_bf16 v[176:179], a[168:171], a[32:35], v[176:179]
    ds_read_b128 a[168:171], v11 offset:55424
    v_mfma_f32_16x16x32_bf16 v[160:163], a[172:175], a[36:39], v[160:163]
    v_mfma_f32_16x16x32_bf16 v[168:171], a[172:175], a[40:43], v[168:171]
    v_mfma_f32_16x16x32_bf16 v[176:179], a[172:175], a[44:47], v[176:179]
    ds_read_b128 a[172:175], v12 offset:55424
    v_mfma_f32_16x16x32_bf16 v[160:163], a[176:179], a[48:51], v[160:163]
    v_mfma_f32_16x16x32_bf16 v[168:171], a[176:179], a[52:55], v[168:171]
    v_mfma_f32_16x16x32_bf16 v[176:179], a[176:179], a[56:59], v[176:179]
    ds_read_b128 a[176:179], v11 offset:55552
    v_mfma_f32_16x16x32_bf16 v[160:163], a[180:183], a[60:63], v[160:163]
    v_mfma_f32_16x16x32_bf16 v[168:171], a[180:183], a[64:67], v[168:171]
    v_mfma_f32_16x16x32_bf16 v[176:179], a[180:183], a[68:71], v[176:179]
    s_waitcnt lgkmcnt(2)
    ds_read_b128 a[180:183], v12 offset:55552
    v_mfma_f32_16x16x32_bf16 v[164:167], a[160:163], a[0:3], 0
    s_nop 2
    v_max3_f32 v36, v36, v160, v161
    v_max3_f32 v36, v36, v162, v163
    v_mfma_f32_16x16x32_bf16 v[172:175], a[160:163], a[4:7], 0
    v_max3_f32 v37, v37, v168, v169
    v_max3_f32 v37, v37, v170, v171
    v_mfma_f32_16x16x32_bf16 v[180:183], a[160:163], a[8:11], 0
    v_max3_f32 v38, v38, v176, v177
    v_max3_f32 v38, v38, v178, v179
    v_mfma_f32_16x16x32_bf16 v[164:167], a[164:167], a[12:15], v[164:167]
    v_mfma_f32_16x16x32_bf16 v[172:175], a[164:167], a[16:19], v[172:175]
    v_mfma_f32_16x16x32_bf16 v[180:183], a[164:167], a[20:23], v[180:183]
    s_waitcnt vmcnt(6) lgkmcnt(0)
    s_barrier
    ds_read_b128 a[160:163], v11 offset:0
    v_mfma_f32_16x16x32_bf16 v[164:167], a[168:171], a[24:27], v[164:167]
    ds_read_b128 a[164:167], v12 offset:0
    buffer_load_dwordx4 v2, s[12:15], s57 offen nt lds
    v_mfma_f32_16x16x32_bf16 v[172:175], a[168:171], a[28:31], v[172:175]
    v_mfma_f32_16x16x32_bf16 v[180:183], a[168:171], a[32:35], v[180:183]
    ds_read_b128 a[168:171], v11 offset:128
    v_mfma_f32_16x16x32_bf16 v[164:167], a[172:175], a[36:39], v[164:167]
    v_mfma_f32_16x16x32_bf16 v[172:175], a[172:175], a[40:43], v[172:175]
    v_mfma_f32_16x16x32_bf16 v[180:183], a[172:175], a[44:47], v[180:183]
    ds_read_b128 a[172:175], v12 offset:128
    buffer_load_dwordx4 v3, s[12:15], s57 offen offset:1024 nt lds
    v_mfma_f32_16x16x32_bf16 v[164:167], a[176:179], a[48:51], v[164:167]
    v_mfma_f32_16x16x32_bf16 v[172:175], a[176:179], a[52:55], v[172:175]
    v_mfma_f32_16x16x32_bf16 v[180:183], a[176:179], a[56:59], v[180:183]
    ds_read_b128 a[176:179], v11 offset:256
    v_mfma_f32_16x16x32_bf16 v[164:167], a[180:183], a[60:63], v[164:167]
    v_mfma_f32_16x16x32_bf16 v[172:175], a[180:183], a[64:67], v[172:175]
    buffer_load_dwordx4 v4, s[12:15], s57 offen offset:2048 nt lds
    v_mfma_f32_16x16x32_bf16 v[180:183], a[180:183], a[68:71], v[180:183]
    s_mov_b32 s57, 184320
    ds_read_b128 a[180:183], v12 offset:256
    s_add_u32 m0, s51, 61440
    s_waitcnt lgkmcnt(2)
    v_mfma_f32_16x16x32_bf16 v[184:187], a[160:163], a[0:3], 0
    v_max3_f32 v36, v36, v164, v165
    v_max3_f32 v36, v36, v166, v167
    v_mfma_f32_16x16x32_bf16 v[192:195], a[160:163], a[4:7], 0
    v_max3_f32 v37, v37, v172, v173
    v_max3_f32 v37, v37, v174, v175
    v_mfma_f32_16x16x32_bf16 v[200:203], a[160:163], a[8:11], 0
    ds_read_b128 a[160:163], v11 offset:6144
    v_max3_f32 v38, v38, v180, v181
    v_mfma_f32_16x16x32_bf16 v[184:187], a[164:167], a[12:15], v[184:187]
    buffer_load_dwordx4 v2, s[12:15], s57 offen nt lds
    v_mfma_f32_16x16x32_bf16 v[192:195], a[164:167], a[16:19], v[192:195]
    v_max3_f32 v38, v38, v182, v183
    v_mfma_f32_16x16x32_bf16 v[200:203], a[164:167], a[20:23], v[200:203]
    ds_read_b128 a[164:167], v12 offset:6144
    v_mfma_f32_16x16x32_bf16 v[184:187], a[168:171], a[24:27], v[184:187]
    v_mfma_f32_16x16x32_bf16 v[192:195], a[168:171], a[28:31], v[192:195]
    v_mfma_f32_16x16x32_bf16 v[200:203], a[168:171], a[32:35], v[200:203]
    buffer_load_dwordx4 v3, s[12:15], s57 offen offset:1024 nt lds
    v_mfma_f32_16x16x32_bf16 v[184:187], a[172:175], a[36:39], v[184:187]
    ds_read_b128 a[168:171], v11 offset:6272
    v_mfma_f32_16x16x32_bf16 v[192:195], a[172:175], a[40:43], v[192:195]
    v_mfma_f32_16x16x32_bf16 v[200:203], a[172:175], a[44:47], v[200:203]
    s_waitcnt lgkmcnt(2)
    ds_read_b128 a[172:175], v12 offset:6272
    v_mfma_f32_16x16x32_bf16 v[184:187], a[176:179], a[48:51], v[184:187]
    v_mfma_f32_16x16x32_bf16 v[192:195], a[176:179], a[52:55], v[192:195]
    buffer_load_dwordx4 v4, s[12:15], s57 offen offset:2048 nt lds
    v_mfma_f32_16x16x32_bf16 v[200:203], a[176:179], a[56:59], v[200:203]
    s_mov_b32 s57, 0
    ds_read_b128 a[176:179], v11 offset:6400
    s_add_u32 m0, s51, 0
    v_mfma_f32_16x16x32_bf16 v[184:187], a[180:183], a[60:63], v[184:187]
    v_mfma_f32_16x16x32_bf16 v[192:195], a[180:183], a[64:67], v[192:195]
    v_mfma_f32_16x16x32_bf16 v[200:203], a[180:183], a[68:71], v[200:203]
    ds_read_b128 a[180:183], v12 offset:6400
    v_mfma_f32_16x16x32_bf16 v[188:191], a[160:163], a[0:3], 0
    s_nop 3
    v_max3_f32 v36, v36, v184, v185
    v_max3_f32 v36, v36, v186, v187
    v_mfma_f32_16x16x32_bf16 v[196:199], a[160:163], a[4:7], 0
    v_max3_f32 v37, v37, v192, v193
    v_max3_f32 v37, v37, v194, v195
    v_mfma_f32_16x16x32_bf16 v[204:207], a[160:163], a[8:11], 0
    s_waitcnt lgkmcnt(2)
    v_max3_f32 v38, v38, v200, v201
    v_max3_f32 v38, v38, v202, v203
    v_mfma_f32_16x16x32_bf16 v[188:191], a[164:167], a[12:15], v[188:191]
    v_mfma_f32_16x16x32_bf16 v[196:199], a[164:167], a[16:19], v[196:199]
    v_mfma_f32_16x16x32_bf16 v[204:207], a[164:167], a[20:23], v[204:207]
    s_waitcnt vmcnt(6) lgkmcnt(0)
    s_barrier
    ds_read_b128 a[160:163], v11 offset:24576
    v_mfma_f32_16x16x32_bf16 v[188:191], a[168:171], a[24:27], v[188:191]
    ds_read_b128 a[164:167], v12 offset:24576
    buffer_load_dwordx4 v2, s[16:19], s57 offen nt lds
    v_mfma_f32_16x16x32_bf16 v[196:199], a[168:171], a[28:31], v[196:199]
    v_mfma_f32_16x16x32_bf16 v[204:207], a[168:171], a[32:35], v[204:207]
    ds_read_b128 a[168:171], v11 offset:24704
    v_mfma_f32_16x16x32_bf16 v[188:191], a[172:175], a[36:39], v[188:191]
    v_mfma_f32_16x16x32_bf16 v[196:199], a[172:175], a[40:43], v[196:199]
    v_mfma_f32_16x16x32_bf16 v[204:207], a[172:175], a[44:47], v[204:207]
    ds_read_b128 a[172:175], v12 offset:24704
    buffer_load_dwordx4 v3, s[16:19], s57 offen offset:1024 nt lds
    v_mfma_f32_16x16x32_bf16 v[188:191], a[176:179], a[48:51], v[188:191]
    v_mfma_f32_16x16x32_bf16 v[196:199], a[176:179], a[52:55], v[196:199]
    v_mfma_f32_16x16x32_bf16 v[204:207], a[176:179], a[56:59], v[204:207]
    ds_read_b128 a[176:179], v11 offset:24832
    v_mfma_f32_16x16x32_bf16 v[188:191], a[180:183], a[60:63], v[188:191]
    v_mfma_f32_16x16x32_bf16 v[196:199], a[180:183], a[64:67], v[196:199]
    buffer_load_dwordx4 v4, s[16:19], s57 offen offset:2048 nt lds
    v_mfma_f32_16x16x32_bf16 v[204:207], a[180:183], a[68:71], v[204:207]
    s_mov_b32 s57, 12288
    ds_read_b128 a[180:183], v12 offset:24832
    s_add_u32 m0, s51, 12288
    s_waitcnt lgkmcnt(2)
    v_mfma_f32_16x16x32_bf16 v[208:211], a[160:163], a[0:3], 0
    v_max3_f32 v36, v36, v188, v189
    v_max3_f32 v36, v36, v190, v191
    v_mfma_f32_16x16x32_bf16 v[216:219], a[160:163], a[4:7], 0
    v_max3_f32 v37, v37, v196, v197
    v_max3_f32 v37, v37, v198, v199
    v_mfma_f32_16x16x32_bf16 v[224:227], a[160:163], a[8:11], 0
    ds_read_b128 a[160:163], v11 offset:30720
    v_max3_f32 v38, v38, v204, v205
    v_mfma_f32_16x16x32_bf16 v[208:211], a[164:167], a[12:15], v[208:211]
    buffer_load_dwordx4 v2, s[16:19], s57 offen nt lds
    v_mfma_f32_16x16x32_bf16 v[216:219], a[164:167], a[16:19], v[216:219]
    v_max3_f32 v38, v38, v206, v207
    v_mfma_f32_16x16x32_bf16 v[224:227], a[164:167], a[20:23], v[224:227]
    ds_read_b128 a[164:167], v12 offset:30720
    v_mfma_f32_16x16x32_bf16 v[208:211], a[168:171], a[24:27], v[208:211]
    v_mfma_f32_16x16x32_bf16 v[216:219], a[168:171], a[28:31], v[216:219]
    v_mfma_f32_16x16x32_bf16 v[224:227], a[168:171], a[32:35], v[224:227]
    buffer_load_dwordx4 v3, s[16:19], s57 offen offset:1024 nt lds
    v_mfma_f32_16x16x32_bf16 v[208:211], a[172:175], a[36:39], v[208:211]
    ds_read_b128 a[168:171], v11 offset:30848
    v_mfma_f32_16x16x32_bf16 v[216:219], a[172:175], a[40:43], v[216:219]
    v_mfma_f32_16x16x32_bf16 v[224:227], a[172:175], a[44:47], v[224:227]
    s_waitcnt lgkmcnt(2)
    ds_read_b128 a[172:175], v12 offset:30848
    v_mfma_f32_16x16x32_bf16 v[208:211], a[176:179], a[48:51], v[208:211]
    v_mfma_f32_16x16x32_bf16 v[216:219], a[176:179], a[52:55], v[216:219]
    buffer_load_dwordx4 v4, s[16:19], s57 offen offset:2048 nt lds
    v_mfma_f32_16x16x32_bf16 v[224:227], a[176:179], a[56:59], v[224:227]
    s_mov_b32 s57, 24576
    ds_read_b128 a[176:179], v11 offset:30976
    s_add_u32 m0, s51, 24576
    v_mfma_f32_16x16x32_bf16 v[208:211], a[180:183], a[60:63], v[208:211]
    v_mfma_f32_16x16x32_bf16 v[216:219], a[180:183], a[64:67], v[216:219]
    v_mfma_f32_16x16x32_bf16 v[224:227], a[180:183], a[68:71], v[224:227]
    ds_read_b128 a[180:183], v12 offset:30976
    v_mfma_f32_16x16x32_bf16 v[212:215], a[160:163], a[0:3], 0
    s_nop 3
    v_max3_f32 v36, v36, v208, v209
    v_max3_f32 v36, v36, v210, v211
    v_mfma_f32_16x16x32_bf16 v[220:223], a[160:163], a[4:7], 0
    v_max3_f32 v37, v37, v216, v217
    v_max3_f32 v37, v37, v218, v219
    v_mfma_f32_16x16x32_bf16 v[228:231], a[160:163], a[8:11], 0
    s_waitcnt lgkmcnt(2)
    v_max3_f32 v38, v38, v224, v225
    v_max3_f32 v38, v38, v226, v227
    v_mfma_f32_16x16x32_bf16 v[212:215], a[164:167], a[12:15], v[212:215]
    v_mfma_f32_16x16x32_bf16 v[220:223], a[164:167], a[16:19], v[220:223]
    v_mfma_f32_16x16x32_bf16 v[228:231], a[164:167], a[20:23], v[228:231]
    s_waitcnt vmcnt(6) lgkmcnt(0)
    s_barrier
    ds_read_b128 a[160:163], v11 offset:49152
    v_mfma_f32_16x16x32_bf16 v[212:215], a[168:171], a[24:27], v[212:215]
    ds_read_b128 a[164:167], v12 offset:49152
    buffer_load_dwordx4 v2, s[16:19], s57 offen nt lds
    v_mfma_f32_16x16x32_bf16 v[220:223], a[168:171], a[28:31], v[220:223]
    v_mfma_f32_16x16x32_bf16 v[228:231], a[168:171], a[32:35], v[228:231]
    ds_read_b128 a[168:171], v11 offset:49280
    v_mfma_f32_16x16x32_bf16 v[212:215], a[172:175], a[36:39], v[212:215]
    v_mfma_f32_16x16x32_bf16 v[220:223], a[172:175], a[40:43], v[220:223]
    v_mfma_f32_16x16x32_bf16 v[228:231], a[172:175], a[44:47], v[228:231]
    ds_read_b128 a[172:175], v12 offset:49280
    buffer_load_dwordx4 v3, s[16:19], s57 offen offset:1024 nt lds
    v_mfma_f32_16x16x32_bf16 v[212:215], a[176:179], a[48:51], v[212:215]
    v_mfma_f32_16x16x32_bf16 v[220:223], a[176:179], a[52:55], v[220:223]
    v_mfma_f32_16x16x32_bf16 v[228:231], a[176:179], a[56:59], v[228:231]
    ds_read_b128 a[176:179], v11 offset:49408
    v_mfma_f32_16x16x32_bf16 v[212:215], a[180:183], a[60:63], v[212:215]
    v_mfma_f32_16x16x32_bf16 v[220:223], a[180:183], a[64:67], v[220:223]
    buffer_load_dwordx4 v4, s[16:19], s57 offen offset:2048 nt lds
    v_mfma_f32_16x16x32_bf16 v[228:231], a[180:183], a[68:71], v[228:231]
    s_mov_b32 s57, 36864
    ds_read_b128 a[180:183], v12 offset:49408
    s_add_u32 m0, s51, 36864
    s_waitcnt lgkmcnt(2)
    v_mfma_f32_16x16x32_bf16 v[232:235], a[160:163], a[0:3], 0
    v_max3_f32 v36, v36, v212, v213
    v_max3_f32 v36, v36, v214, v215
    v_mfma_f32_16x16x32_bf16 v[240:243], a[160:163], a[4:7], 0
    v_max3_f32 v37, v37, v220, v221
    v_max3_f32 v37, v37, v222, v223
    v_mfma_f32_16x16x32_bf16 v[248:251], a[160:163], a[8:11], 0
    ds_read_b128 a[160:163], v11 offset:55296
    v_max3_f32 v38, v38, v228, v229
    v_mfma_f32_16x16x32_bf16 v[232:235], a[164:167], a[12:15], v[232:235]
    buffer_load_dwordx4 v2, s[16:19], s57 offen nt lds
    v_mfma_f32_16x16x32_bf16 v[240:243], a[164:167], a[16:19], v[240:243]
    v_max3_f32 v38, v38, v230, v231
    v_mfma_f32_16x16x32_bf16 v[248:251], a[164:167], a[20:23], v[248:251]
    ds_read_b128 a[164:167], v12 offset:55296
    v_mfma_f32_16x16x32_bf16 v[232:235], a[168:171], a[24:27], v[232:235]
    v_mfma_f32_16x16x32_bf16 v[240:243], a[168:171], a[28:31], v[240:243]
    v_mfma_f32_16x16x32_bf16 v[248:251], a[168:171], a[32:35], v[248:251]
    buffer_load_dwordx4 v3, s[16:19], s57 offen offset:1024 nt lds
    v_mfma_f32_16x16x32_bf16 v[232:235], a[172:175], a[36:39], v[232:235]
    ds_read_b128 a[168:171], v11 offset:55424
    v_mfma_f32_16x16x32_bf16 v[240:243], a[172:175], a[40:43], v[240:243]
    v_mfma_f32_16x16x32_bf16 v[248:251], a[172:175], a[44:47], v[248:251]
    s_waitcnt lgkmcnt(2)
    ds_read_b128 a[172:175], v12 offset:55424
    v_mfma_f32_16x16x32_bf16 v[232:235], a[176:179], a[48:51], v[232:235]
    v_mfma_f32_16x16x32_bf16 v[240:243], a[176:179], a[52:55], v[240:243]
    buffer_load_dwordx4 v4, s[16:19], s57 offen offset:2048 nt lds
    v_mfma_f32_16x16x32_bf16 v[248:251], a[176:179], a[56:59], v[248:251]
    s_mov_b32 s57, 49152
    ds_read_b128 a[176:179], v11 offset:55552
    s_add_u32 m0, s51, 49152
    v_mfma_f32_16x16x32_bf16 v[232:235], a[180:183], a[60:63], v[232:235]
    v_mfma_f32_16x16x32_bf16 v[240:243], a[180:183], a[64:67], v[240:243]
    v_mfma_f32_16x16x32_bf16 v[248:251], a[180:183], a[68:71], v[248:251]
    ds_read_b128 a[180:183], v12 offset:55552
    v_mfma_f32_16x16x32_bf16 v[236:239], a[160:163], a[0:3], 0
    s_nop 3
    v_max3_f32 v36, v36, v232, v233
    v_max3_f32 v36, v36, v234, v235
    v_mfma_f32_16x16x32_bf16 v[244:247], a[160:163], a[4:7], 0
    v_max3_f32 v37, v37, v240, v241
    v_max3_f32 v37, v37, v242, v243
    v_mfma_f32_16x16x32_bf16 v[252:255], a[160:163], a[8:11], 0
    s_waitcnt lgkmcnt(2)
    v_max3_f32 v38, v38, v248, v249
    v_max3_f32 v38, v38, v250, v251
    v_mfma_f32_16x16x32_bf16 v[236:239], a[164:167], a[12:15], v[236:239]
    v_mfma_f32_16x16x32_bf16 v[244:247], a[164:167], a[16:19], v[244:247]
    v_mfma_f32_16x16x32_bf16 v[252:255], a[164:167], a[20:23], v[252:255]
    v_mfma_f32_16x16x32_bf16 v[236:239], a[168:171], a[24:27], v[236:239]
    v_mfma_f32_16x16x32_bf16 v[244:247], a[168:171], a[28:31], v[244:247]
    v_mfma_f32_16x16x32_bf16 v[252:255], a[168:171], a[32:35], v[252:255]
    v_mfma_f32_16x16x32_bf16 v[236:239], a[172:175], a[36:39], v[236:239]
    v_mfma_f32_16x16x32_bf16 v[244:247], a[172:175], a[40:43], v[244:247]
    v_mfma_f32_16x16x32_bf16 v[252:255], a[172:175], a[44:47], v[252:255]
    s_waitcnt lgkmcnt(0)
    v_mfma_f32_16x16x32_bf16 v[236:239], a[176:179], a[48:51], v[236:239]
    v_mfma_f32_16x16x32_bf16 v[244:247], a[176:179], a[52:55], v[244:247]
    v_mfma_f32_16x16x32_bf16 v[252:255], a[176:179], a[56:59], v[252:255]
    v_mfma_f32_16x16x32_bf16 v[236:239], a[180:183], a[60:63], v[236:239]
    v_mfma_f32_16x16x32_bf16 v[244:247], a[180:183], a[64:67], v[244:247]
    v_mfma_f32_16x16x32_bf16 v[252:255], a[180:183], a[68:71], v[252:255]
    s_nop 5
    v_max3_f32 v36, v36, v236, v237
    v_max3_f32 v36, v36, v238, v239
    v_mov_b32 v48, v36
    v_max3_f32 v37, v37, v244, v245
    v_max3_f32 v37, v37, v246, v247
    v_mov_b32 v49, v37
    v_permlane32_swap_b32 v48, v36
    v_max3_f32 v38, v38, v252, v253
    v_max3_f32 v38, v38, v254, v255
    v_mov_b32 v50, v38
    v_permlane32_swap_b32 v49, v37
    v_max_f32 v36, v48, v36
    v_permlane32_swap_b32 v50, v38
    v_max_f32 v37, v49, v37
    v_max_f32 v38, v50, v38
    v_mov_b32 v48, v36
    v_mov_b32 v49, v37
    v_mov_b32 v50, v38
    v_permlane16_swap_b32 v48, v36
    v_permlane16_swap_b32 v49, v37
    v_permlane16_swap_b32 v50, v38
    v_max_f32 v36, v48, v36
    v_max_f32 v37, v49, v37
    v_max_f32 v38, v50, v38
    ds_write_b128 v31, v[36:39]
    v_and_b32 v48, 15, v34
    v_and_b32 v50, 1, v48
    v_lshlrev_b32 v50, 4, v50
    v_lshrrev_b32 v49, 4, v34
    s_waitcnt lgkmcnt(0)
    s_barrier
    ds_read_b128 v[40:43], v32
    buffer_load_dwordx4 v2, s[16:19], s57 offen nt lds
    buffer_load_dwordx4 v3, s[16:19], s57 offen offset:1024 nt lds
    buffer_load_dwordx4 v4, s[16:19], s57 offen offset:2048 nt lds
    s_mov_b32 s57, 61440
    s_add_u32 m0, s51, 61440
    s_nop 0
    buffer_load_dwordx4 v2, s[16:19], s57 offen nt lds
    buffer_load_dwordx4 v3, s[16:19], s57 offen offset:1024 nt lds
    buffer_load_dwordx4 v4, s[16:19], s57 offen offset:2048 nt lds
    s_waitcnt lgkmcnt(0)
    v_max_f32 v44, v36, v40
    v_max_f32 v45, v37, v41
    v_max_f32 v46, v38, v42
    v_mul_f32 v44, s52, v44
    v_mul_f32 v45, s52, v45
    v_mul_f32 v46, s52, v46
    v_fma_f32 v64, v64, s52, -v44
    v_fma_f32 v65, v65, s52, -v44
    v_fma_f32 v72, v72, s52, -v45
    v_fma_f32 v73, v73, s52, -v45
    v_fma_f32 v80, v80, s52, -v46
    v_fma_f32 v81, v81, s52, -v46
    v_exp_f32 v64, v64
    v_exp_f32 v65, v65
    v_fma_f32 v66, v66, s52, -v44
    v_fma_f32 v67, v67, s52, -v44
    v_exp_f32 v72, v72
    v_exp_f32 v73, v73
    v_fma_f32 v74, v74, s52, -v45
    v_fma_f32 v75, v75, s52, -v45
    v_exp_f32 v80, v80
    v_exp_f32 v81, v81
    v_fma_f32 v82, v82, s52, -v46
    v_fma_f32 v83, v83, s52, -v46
    v_exp_f32 v66, v66
    v_exp_f32 v67, v67
    v_fma_f32 v68, v68, s52, -v44
    v_fma_f32 v69, v69, s52, -v44
    v_fma_f32 v70, v70, s52, -v44
    v_fma_f32 v71, v71, s52, -v44
    v_exp_f32 v74, v74
    v_exp_f32 v75, v75
    v_fma_f32 v76, v76, s52, -v45
    v_fma_f32 v77, v77, s52, -v45
    v_fma_f32 v78, v78, s52, -v45
    v_fma_f32 v79, v79, s52, -v45
    v_exp_f32 v82, v82
    v_exp_f32 v83, v83
    v_fma_f32 v84, v84, s52, -v46
    v_fma_f32 v85, v85, s52, -v46
    v_fma_f32 v86, v86, s52, -v46
    v_fma_f32 v87, v87, s52, -v46
    v_exp_f32 v68, v68
    v_exp_f32 v69, v69
    v_exp_f32 v70, v70
    v_exp_f32 v71, v71
    v_exp_f32 v76, v76
    v_exp_f32 v77, v77
    v_exp_f32 v78, v78
    v_exp_f32 v79, v79
    v_exp_f32 v84, v84
    v_exp_f32 v85, v85
    v_exp_f32 v86, v86
    v_exp_f32 v87, v87
    v_cvt_pk_bf16_f32 v64, v64, v65
    v_cvt_pk_bf16_f32 v72, v72, v73
    v_cvt_pk_bf16_f32 v80, v80, v81
    v_cvt_pk_bf16_f32 v65, v66, v67
    v_cvt_pk_bf16_f32 v73, v74, v75
    v_cvt_pk_bf16_f32 v81, v82, v83
    v_cvt_pk_bf16_f32 v66, v68, v69
    v_cvt_pk_bf16_f32 v67, v70, v71
    v_cvt_pk_bf16_f32 v74, v76, v77
    v_cvt_pk_bf16_f32 v75, v78, v79
    v_mfma_f32_16x16x32_bf16 a[144:147], a[156:159], v[64:67], 0
    s_mov_b32 s57, 73728
    ds_write_b128 v27, v[64:67] offset:0
    v_mfma_f32_16x16x32_bf16 a[148:151], a[156:159], v[72:75], 0
    s_add_u32 m0, s51, 0
    v_cvt_pk_bf16_f32 v82, v84, v85
    v_cvt_pk_bf16_f32 v83, v86, v87
    v_fma_f32 v88, v88, s52, -v44
    v_fma_f32 v89, v89, s52, -v44
    v_mfma_f32_16x16x32_bf16 a[152:155], a[156:159], v[80:83], 0
    ds_write_b128 v27, v[72:75] offset:1024
    v_fma_f32 v96, v96, s52, -v45
    v_fma_f32 v97, v97, s52, -v45
    v_fma_f32 v104, v104, s52, -v46
    v_fma_f32 v105, v105, s52, -v46
    v_exp_f32 v88, v88
    ds_write_b128 v27, v[80:83] offset:2048
    v_exp_f32 v89, v89
    v_fma_f32 v90, v90, s52, -v44
    v_fma_f32 v91, v91, s52, -v44
    v_exp_f32 v96, v96
    v_exp_f32 v97, v97
    v_fma_f32 v98, v98, s52, -v45
    v_fma_f32 v99, v99, s52, -v45
    v_exp_f32 v104, v104
    v_exp_f32 v105, v105
    v_fma_f32 v106, v106, s52, -v46
    v_fma_f32 v107, v107, s52, -v46
    v_exp_f32 v90, v90
    v_exp_f32 v91, v91
    v_fma_f32 v92, v92, s52, -v44
    v_fma_f32 v93, v93, s52, -v44
    v_fma_f32 v94, v94, s52, -v44
    v_fma_f32 v95, v95, s52, -v44
    v_exp_f32 v98, v98
    s_waitcnt vmcnt(12) lgkmcnt(0)
    s_barrier
    ds_read_b64_tr_b16 a[160:161], v13 offset:0
    ds_read_b64_tr_b16 a[162:163], v13 offset:6144
    ds_read_b64_tr_b16 a[164:165], v14 offset:0
    v_exp_f32 v99, v99
    ds_read_b64_tr_b16 a[166:167], v14 offset:6144
    ds_read_b64_tr_b16 a[168:169], v15 offset:0
    ds_read_b64_tr_b16 a[170:171], v15 offset:6144
    v_fma_f32 v100, v100, s52, -v45
    ds_read_b64_tr_b16 a[172:173], v16 offset:0
    ds_read_b64_tr_b16 a[174:175], v16 offset:6144
    ds_read_b64_tr_b16 a[176:177], v13 offset:128
    v_fma_f32 v101, v101, s52, -v45
    ds_read_b64_tr_b16 a[178:179], v13 offset:6272
    ds_read_b64_tr_b16 a[180:181], v14 offset:128
    ds_read_b64_tr_b16 a[182:183], v14 offset:6272
    v_fma_f32 v102, v102, s52, -v45
    v_fma_f32 v103, v103, s52, -v45
    v_exp_f32 v106, v106
    s_waitcnt lgkmcnt(10)
    v_mfma_f32_16x16x32_bf16 a[0:3], a[160:163], v[64:67], 0
    ds_read_b128 v[68:71], v28 offset:0
    v_fma_f32 v108, v108, s52, -v46
    v_mfma_f32_16x16x32_bf16 a[4:7], a[160:163], v[72:75], 0
    ds_read_b128 v[76:79], v28 offset:1024
    v_fma_f32 v109, v109, s52, -v46
    v_mfma_f32_16x16x32_bf16 a[8:11], a[160:163], v[80:83], 0
    s_waitcnt lgkmcnt(8)
    ds_read_b64_tr_b16 a[160:161], v17 offset:0
    ds_read_b64_tr_b16 a[162:163], v17 offset:6144
    v_mfma_f32_16x16x32_bf16 a[12:15], a[164:167], v[64:67], 0
    ds_read_b128 v[84:87], v28 offset:2048
    v_fma_f32 v110, v110, s52, -v46
    v_mfma_f32_16x16x32_bf16 a[16:19], a[164:167], v[72:75], 0
    v_exp_f32 v107, v107
    v_mfma_f32_16x16x32_bf16 a[20:23], a[164:167], v[80:83], 0
    ds_read_b64_tr_b16 a[164:165], v18 offset:0
    ds_read_b64_tr_b16 a[166:167], v18 offset:6144
    v_mfma_f32_16x16x32_bf16 a[24:27], a[168:171], v[64:67], 0
    v_fma_f32 v111, v111, s52, -v46
    v_cvt_pk_bf16_f32 v88, v88, v89
    v_mfma_f32_16x16x32_bf16 a[28:31], a[168:171], v[72:75], 0
    v_exp_f32 v92, v92
    v_mfma_f32_16x16x32_bf16 a[32:35], a[168:171], v[80:83], 0
    s_waitcnt lgkmcnt(5)
    ds_read_b64_tr_b16 a[168:169], v19 offset:0
    ds_read_b64_tr_b16 a[170:171], v19 offset:6144
    v_mfma_f32_16x16x32_bf16 a[36:39], a[172:175], v[64:67], 0
    v_exp_f32 v93, v93
    v_mfma_f32_16x16x32_bf16 a[40:43], a[172:175], v[72:75], 0
    v_exp_f32 v94, v94
    v_mfma_f32_16x16x32_bf16 a[44:47], a[172:175], v[80:83], 0
    ds_read_b64_tr_b16 a[172:173], v20 offset:0
    ds_read_b64_tr_b16 a[174:175], v20 offset:6144
    v_mfma_f32_16x16x32_bf16 a[48:51], a[176:179], v[64:67], 0
    v_exp_f32 v95, v95
    v_mfma_f32_16x16x32_bf16 a[52:55], a[176:179], v[72:75], 0
    v_exp_f32 v100, v100
    v_mfma_f32_16x16x32_bf16 a[56:59], a[176:179], v[80:83], 0
    ds_read_b64_tr_b16 a[176:177], v17 offset:128
    ds_read_b64_tr_b16 a[178:179], v17 offset:6272
    v_mfma_f32_16x16x32_bf16 a[60:63], a[180:183], v[64:67], 0
    v_exp_f32 v101, v101
    v_mfma_f32_16x16x32_bf16 a[64:67], a[180:183], v[72:75], 0
    v_exp_f32 v102, v102
    v_mfma_f32_16x16x32_bf16 a[68:71], a[180:183], v[80:83], 0
    s_waitcnt lgkmcnt(4)
    ds_read_b64_tr_b16 a[180:181], v18 offset:128
    ds_read_b64_tr_b16 a[182:183], v18 offset:6272
    v_mfma_f32_16x16x32_bf16 a[0:3], a[160:163], v[68:71], a[0:3]
    v_exp_f32 v103, v103
    v_mfma_f32_16x16x32_bf16 a[4:7], a[160:163], v[76:79], a[4:7]
    v_exp_f32 v108, v108
    v_mfma_f32_16x16x32_bf16 a[8:11], a[160:163], v[84:87], a[8:11]
    v_exp_f32 v109, v109
    v_mfma_f32_16x16x32_bf16 a[12:15], a[164:167], v[68:71], a[12:15]
    v_exp_f32 v110, v110
    v_mfma_f32_16x16x32_bf16 a[16:19], a[164:167], v[76:79], a[16:19]
    v_exp_f32 v111, v111
    v_mfma_f32_16x16x32_bf16 a[20:23], a[164:167], v[84:87], a[20:23]
    v_cvt_pk_bf16_f32 v96, v96, v97
    v_cvt_pk_bf16_f32 v104, v104, v105
    v_mfma_f32_16x16x32_bf16 a[24:27], a[168:171], v[68:71], a[24:27]
    v_cvt_pk_bf16_f32 v89, v90, v91
    v_cvt_pk_bf16_f32 v97, v98, v99
    v_mfma_f32_16x16x32_bf16 a[28:31], a[168:171], v[76:79], a[28:31]
    v_cvt_pk_bf16_f32 v105, v106, v107
    v_cvt_pk_bf16_f32 v90, v92, v93
    v_mfma_f32_16x16x32_bf16 a[32:35], a[168:171], v[84:87], a[32:35]
    s_waitcnt lgkmcnt(0)
    v_cvt_pk_bf16_f32 v91, v94, v95
    v_cvt_pk_bf16_f32 v98, v100, v101
    v_mfma_f32_16x16x32_bf16 a[36:39], a[172:175], v[68:71], a[36:39]
    ds_write_b128 v27, v[88:91] offset:12288
    v_mfma_f32_16x16x32_bf16 a[40:43], a[172:175], v[76:79], a[40:43]
    v_cvt_pk_bf16_f32 v99, v102, v103
    v_cvt_pk_bf16_f32 v106, v108, v109
    v_mfma_f32_16x16x32_bf16 a[44:47], a[172:175], v[84:87], a[44:47]
    ds_write_b128 v27, v[96:99] offset:13312
    v_mfma_f32_16x16x32_bf16 a[48:51], a[176:179], v[68:71], a[48:51]
    v_cvt_pk_bf16_f32 v107, v110, v111
    v_fma_f32 v112, v112, s52, -v44
    v_mfma_f32_16x16x32_bf16 a[52:55], a[176:179], v[76:79], a[52:55]
    v_fma_f32 v113, v113, s52, -v44
    v_fma_f32 v120, v120, s52, -v45
    v_mfma_f32_16x16x32_bf16 a[56:59], a[176:179], v[84:87], a[56:59]
    ds_write_b128 v27, v[104:107] offset:14336
    v_mfma_f32_16x16x32_bf16 a[60:63], a[180:183], v[68:71], a[60:63]
    v_fma_f32 v121, v121, s52, -v45
    v_fma_f32 v128, v128, s52, -v46
    v_mfma_f32_16x16x32_bf16 a[64:67], a[180:183], v[76:79], a[64:67]
    v_fma_f32 v129, v129, s52, -v46
    v_fma_f32 v114, v114, s52, -v44
    v_mfma_f32_16x16x32_bf16 a[68:71], a[180:183], v[84:87], a[68:71]
    v_exp_f32 v112, v112
    v_mfma_f32_16x16x32_bf16 a[144:147], a[156:159], v[88:91], a[144:147]
    v_exp_f32 v113, v113
    v_mfma_f32_16x16x32_bf16 a[148:151], a[156:159], v[96:99], a[148:151]
    v_fma_f32 v115, v115, s52, -v44
    v_fma_f32 v122, v122, s52, -v45
    v_mfma_f32_16x16x32_bf16 a[152:155], a[156:159], v[104:107], a[152:155]
    v_exp_f32 v120, v120
    v_exp_f32 v121, v121
    s_waitcnt vmcnt(6) lgkmcnt(0)
    s_barrier
    ds_read_b64_tr_b16 a[160:161], v13 offset:24576
    ds_read_b64_tr_b16 a[162:163], v13 offset:30720
    ds_read_b64_tr_b16 a[164:165], v14 offset:24576
    buffer_load_dwordx4 v2, s[16:19], s57 offen nt lds
    ds_read_b64_tr_b16 a[166:167], v14 offset:30720
    ds_read_b64_tr_b16 a[168:169], v15 offset:24576
    v_fma_f32 v123, v123, s52, -v45
    ds_read_b64_tr_b16 a[170:171], v15 offset:30720
    ds_read_b64_tr_b16 a[172:173], v16 offset:24576
    ds_read_b64_tr_b16 a[174:175], v16 offset:30720
    v_exp_f32 v128, v128
    ds_read_b64_tr_b16 a[176:177], v13 offset:24704
    ds_read_b64_tr_b16 a[178:179], v13 offset:30848
    ds_read_b64_tr_b16 a[180:181], v14 offset:24704
    v_exp_f32 v129, v129
    v_fma_f32 v130, v130, s52, -v46
    v_fma_f32 v131, v131, s52, -v46
    v_exp_f32 v114, v114
    s_waitcnt lgkmcnt(9)
    v_mfma_f32_16x16x32_bf16 a[0:3], a[160:163], v[88:91], a[0:3]
    ds_read_b64_tr_b16 a[182:183], v14 offset:30848
    ds_read_b128 v[92:95], v28 offset:12288
    v_mfma_f32_16x16x32_bf16 a[4:7], a[160:163], v[96:99], a[4:7]
    buffer_load_dwordx4 v3, s[16:19], s57 offen offset:1024 nt lds
    v_mfma_f32_16x16x32_bf16 a[8:11], a[160:163], v[104:107], a[8:11]
    s_waitcnt lgkmcnt(7)
    ds_read_b64_tr_b16 a[160:161], v17 offset:24576
    ds_read_b64_tr_b16 a[162:163], v17 offset:30720
    v_mfma_f32_16x16x32_bf16 a[12:15], a[164:167], v[88:91], a[12:15]
    ds_read_b128 v[100:103], v28 offset:13312
    v_fma_f32 v116, v116, s52, -v44
    v_mfma_f32_16x16x32_bf16 a[16:19], a[164:167], v[96:99], a[16:19]
    ds_read_b128 v[108:111], v28 offset:14336
    v_fma_f32 v117, v117, s52, -v44
    v_mfma_f32_16x16x32_bf16 a[20:23], a[164:167], v[104:107], a[20:23]
    ds_read_b64_tr_b16 a[164:165], v18 offset:24576
    ds_read_b64_tr_b16 a[166:167], v18 offset:30720
    v_mfma_f32_16x16x32_bf16 a[24:27], a[168:171], v[88:91], a[24:27]
    buffer_load_dwordx4 v4, s[16:19], s57 offen offset:2048 nt lds
    v_mfma_f32_16x16x32_bf16 a[28:31], a[168:171], v[96:99], a[28:31]
    s_mov_b32 s57, 86016
    s_add_u32 m0, s51, 12288
    v_fma_f32 v118, v118, s52, -v44
    v_mfma_f32_16x16x32_bf16 a[32:35], a[168:171], v[104:107], a[32:35]
    s_waitcnt lgkmcnt(6)
    ds_read_b64_tr_b16 a[168:169], v19 offset:24576
    ds_read_b64_tr_b16 a[170:171], v19 offset:30720
    v_mfma_f32_16x16x32_bf16 a[36:39], a[172:175], v[88:91], a[36:39]
    v_exp_f32 v115, v115
    v_mfma_f32_16x16x32_bf16 a[40:43], a[172:175], v[96:99], a[40:43]
    v_fma_f32 v119, v119, s52, -v44
    v_fma_f32 v124, v124, s52, -v45
    v_mfma_f32_16x16x32_bf16 a[44:47], a[172:175], v[104:107], a[44:47]
    buffer_load_dwordx4 v2, s[16:19], s57 offen nt lds
    v_mfma_f32_16x16x32_bf16 a[48:51], a[176:179], v[88:91], a[48:51]
    ds_read_b64_tr_b16 a[172:173], v20 offset:24576
    ds_read_b64_tr_b16 a[174:175], v20 offset:30720
    v_mfma_f32_16x16x32_bf16 a[52:55], a[176:179], v[96:99], a[52:55]
    v_exp_f32 v122, v122
    v_mfma_f32_16x16x32_bf16 a[56:59], a[176:179], v[104:107], a[56:59]
    ds_read_b64_tr_b16 a[176:177], v17 offset:24704
    ds_read_b64_tr_b16 a[178:179], v17 offset:30848
    v_mfma_f32_16x16x32_bf16 a[60:63], a[180:183], v[88:91], a[60:63]
    v_exp_f32 v123, v123
    v_mfma_f32_16x16x32_bf16 a[64:67], a[180:183], v[96:99], a[64:67]
    buffer_load_dwordx4 v3, s[16:19], s57 offen offset:1024 nt lds
    v_mfma_f32_16x16x32_bf16 a[68:71], a[180:183], v[104:107], a[68:71]
    s_waitcnt lgkmcnt(4)
    ds_read_b64_tr_b16 a[180:181], v18 offset:24704
    ds_read_b64_tr_b16 a[182:183], v18 offset:30848
    v_mfma_f32_16x16x32_bf16 a[0:3], a[160:163], v[92:95], a[0:3]
    v_fma_f32 v125, v125, s52, -v45
    v_fma_f32 v126, v126, s52, -v45
    v_mfma_f32_16x16x32_bf16 a[4:7], a[160:163], v[100:103], a[4:7]
    v_fma_f32 v127, v127, s52, -v45
    v_fma_f32 v132, v132, s52, -v46
    v_mfma_f32_16x16x32_bf16 a[8:11], a[160:163], v[108:111], a[8:11]
    v_exp_f32 v130, v130
    v_mfma_f32_16x16x32_bf16 a[12:15], a[164:167], v[92:95], a[12:15]
    buffer_load_dwordx4 v4, s[16:19], s57 offen offset:2048 nt lds
    v_mfma_f32_16x16x32_bf16 a[16:19], a[164:167], v[100:103], a[16:19]
    s_mov_b32 s57, 98304
    v_exp_f32 v131, v131
    v_mfma_f32_16x16x32_bf16 a[20:23], a[164:167], v[108:111], a[20:23]
    s_add_u32 m0, s51, 24576
    v_fma_f32 v133, v133, s52, -v46
    v_fma_f32 v134, v134, s52, -v46
    v_mfma_f32_16x16x32_bf16 a[24:27], a[168:171], v[92:95], a[24:27]
    v_fma_f32 v135, v135, s52, -v46
    v_cvt_pk_bf16_f32 v112, v112, v113
    v_mfma_f32_16x16x32_bf16 a[28:31], a[168:171], v[100:103], a[28:31]
    v_exp_f32 v116, v116
    v_mfma_f32_16x16x32_bf16 a[32:35], a[168:171], v[108:111], a[32:35]
    s_waitcnt lgkmcnt(0)
    v_exp_f32 v117, v117
    v_mfma_f32_16x16x32_bf16 a[36:39], a[172:175], v[92:95], a[36:39]
    v_exp_f32 v118, v118
    v_mfma_f32_16x16x32_bf16 a[40:43], a[172:175], v[100:103], a[40:43]
    v_exp_f32 v119, v119
    v_mfma_f32_16x16x32_bf16 a[44:47], a[172:175], v[108:111], a[44:47]
    v_exp_f32 v124, v124
    v_mfma_f32_16x16x32_bf16 a[48:51], a[176:179], v[92:95], a[48:51]
    v_exp_f32 v125, v125
    v_mfma_f32_16x16x32_bf16 a[52:55], a[176:179], v[100:103], a[52:55]
    v_exp_f32 v126, v126
    v_mfma_f32_16x16x32_bf16 a[56:59], a[176:179], v[108:111], a[56:59]
    v_exp_f32 v127, v127
    v_mfma_f32_16x16x32_bf16 a[60:63], a[180:183], v[92:95], a[60:63]
    v_exp_f32 v132, v132
    v_mfma_f32_16x16x32_bf16 a[64:67], a[180:183], v[100:103], a[64:67]
    v_exp_f32 v133, v133
    v_mfma_f32_16x16x32_bf16 a[68:71], a[180:183], v[108:111], a[68:71]
    v_exp_f32 v134, v134
    v_exp_f32 v135, v135
    v_cvt_pk_bf16_f32 v120, v120, v121
    v_cvt_pk_bf16_f32 v128, v128, v129
    v_cvt_pk_bf16_f32 v113, v114, v115
    v_cvt_pk_bf16_f32 v121, v122, v123
    v_cvt_pk_bf16_f32 v129, v130, v131
    v_cvt_pk_bf16_f32 v114, v116, v117
    v_cvt_pk_bf16_f32 v115, v118, v119
    v_cvt_pk_bf16_f32 v122, v124, v125
    v_cvt_pk_bf16_f32 v123, v126, v127
    v_mfma_f32_16x16x32_bf16 a[144:147], a[156:159], v[112:115], a[144:147]
    ds_write_b128 v27, v[112:115] offset:0
    v_mfma_f32_16x16x32_bf16 a[148:151], a[156:159], v[120:123], a[148:151]
    v_cvt_pk_bf16_f32 v130, v132, v133
    v_cvt_pk_bf16_f32 v131, v134, v135
    v_fma_f32 v136, v136, s52, -v44
    v_fma_f32 v137, v137, s52, -v44
    v_mfma_f32_16x16x32_bf16 a[152:155], a[156:159], v[128:131], a[152:155]
    ds_write_b128 v27, v[120:123] offset:1024
    v_fma_f32 v144, v144, s52, -v45
    v_fma_f32 v145, v145, s52, -v45
    v_fma_f32 v152, v152, s52, -v46
    v_fma_f32 v153, v153, s52, -v46
    v_exp_f32 v136, v136
    ds_write_b128 v27, v[128:131] offset:2048
    v_exp_f32 v137, v137
    v_fma_f32 v138, v138, s52, -v44
    v_fma_f32 v139, v139, s52, -v44
    v_exp_f32 v144, v144
    v_exp_f32 v145, v145
    v_fma_f32 v146, v146, s52, -v45
    v_fma_f32 v147, v147, s52, -v45
    v_exp_f32 v152, v152
    v_exp_f32 v153, v153
    v_fma_f32 v154, v154, s52, -v46
    v_fma_f32 v155, v155, s52, -v46
    v_exp_f32 v138, v138
    v_exp_f32 v139, v139
    v_fma_f32 v140, v140, s52, -v44
    v_fma_f32 v141, v141, s52, -v44
    v_fma_f32 v142, v142, s52, -v44
    v_fma_f32 v143, v143, s52, -v44
    v_exp_f32 v146, v146
    s_waitcnt vmcnt(6) lgkmcnt(0)
    s_barrier
    ds_read_b64_tr_b16 a[160:161], v13 offset:49152
    ds_read_b64_tr_b16 a[162:163], v13 offset:55296
    ds_read_b64_tr_b16 a[164:165], v14 offset:49152
    buffer_load_dwordx4 v2, s[16:19], s57 offen nt lds
    ds_read_b64_tr_b16 a[166:167], v14 offset:55296
    ds_read_b64_tr_b16 a[168:169], v15 offset:49152
    v_exp_f32 v147, v147
    ds_read_b64_tr_b16 a[170:171], v15 offset:55296
    ds_read_b64_tr_b16 a[172:173], v16 offset:49152
    ds_read_b64_tr_b16 a[174:175], v16 offset:55296
    v_fma_f32 v148, v148, s52, -v45
    ds_read_b64_tr_b16 a[176:177], v13 offset:49280
    ds_read_b64_tr_b16 a[178:179], v13 offset:55424
    ds_read_b64_tr_b16 a[180:181], v14 offset:49280
    v_fma_f32 v149, v149, s52, -v45
    ds_read_b64_tr_b16 a[182:183], v14 offset:55424
    ds_read_b128 v[116:119], v28 offset:0
    s_waitcnt lgkmcnt(11)
    v_mfma_f32_16x16x32_bf16 a[0:3], a[160:163], v[112:115], a[0:3]
    buffer_load_dwordx4 v3, s[16:19], s57 offen offset:1024 nt lds
    v_mfma_f32_16x16x32_bf16 a[4:7], a[160:163], v[120:123], a[4:7]
    ds_read_b128 v[124:127], v28 offset:1024
    v_fma_f32 v150, v150, s52, -v45
    v_mfma_f32_16x16x32_bf16 a[8:11], a[160:163], v[128:131], a[8:11]
    s_waitcnt lgkmcnt(9)
    ds_read_b64_tr_b16 a[160:161], v17 offset:49152
    ds_read_b64_tr_b16 a[162:163], v17 offset:55296
    v_mfma_f32_16x16x32_bf16 a[12:15], a[164:167], v[112:115], a[12:15]
    ds_read_b128 v[132:135], v28 offset:2048
    v_fma_f32 v151, v151, s52, -v45
    v_mfma_f32_16x16x32_bf16 a[16:19], a[164:167], v[120:123], a[16:19]
    v_exp_f32 v154, v154
    v_mfma_f32_16x16x32_bf16 a[20:23], a[164:167], v[128:131], a[20:23]
    s_waitcnt lgkmcnt(6)
    buffer_load_dwordx4 v4, s[16:19], s57 offen offset:2048 nt lds
    v_mfma_f32_16x16x32_bf16 a[24:27], a[168:171], v[112:115], a[24:27]
    s_mov_b32 s57, 110592
    ds_read_b64_tr_b16 a[164:165], v18 offset:49152
    ds_read_b64_tr_b16 a[166:167], v18 offset:55296
    v_mfma_f32_16x16x32_bf16 a[28:31], a[168:171], v[120:123], a[28:31]
    s_add_u32 m0, s51, 36864
    v_exp_f32 v155, v155
    v_mfma_f32_16x16x32_bf16 a[32:35], a[168:171], v[128:131], a[32:35]
    ds_read_b64_tr_b16 a[168:169], v19 offset:49152
    ds_read_b64_tr_b16 a[170:171], v19 offset:55296
    v_mfma_f32_16x16x32_bf16 a[36:39], a[172:175], v[112:115], a[36:39]
    v_fma_f32 v156, v156, s52, -v46
    v_fma_f32 v157, v157, s52, -v46
    v_mfma_f32_16x16x32_bf16 a[40:43], a[172:175], v[120:123], a[40:43]
    buffer_load_dwordx4 v2, s[16:19], s57 offen nt lds
    v_mfma_f32_16x16x32_bf16 a[44:47], a[172:175], v[128:131], a[44:47]
    ds_read_b64_tr_b16 a[172:173], v20 offset:49152
    ds_read_b64_tr_b16 a[174:175], v20 offset:55296
    v_mfma_f32_16x16x32_bf16 a[48:51], a[176:179], v[112:115], a[48:51]
    v_fma_f32 v158, v158, s52, -v46
    v_fma_f32 v159, v159, s52, -v46
    v_mfma_f32_16x16x32_bf16 a[52:55], a[176:179], v[120:123], a[52:55]
    v_exp_f32 v140, v140
    v_mfma_f32_16x16x32_bf16 a[56:59], a[176:179], v[128:131], a[56:59]
    s_waitcnt lgkmcnt(4)
    ds_read_b64_tr_b16 a[176:177], v17 offset:49280
    ds_read_b64_tr_b16 a[178:179], v17 offset:55424
    v_mfma_f32_16x16x32_bf16 a[60:63], a[180:183], v[112:115], a[60:63]
    buffer_load_dwordx4 v3, s[16:19], s57 offen offset:1024 nt lds
    v_mfma_f32_16x16x32_bf16 a[64:67], a[180:183], v[120:123], a[64:67]
    v_exp_f32 v141, v141
    v_mfma_f32_16x16x32_bf16 a[68:71], a[180:183], v[128:131], a[68:71]
    ds_read_b64_tr_b16 a[180:181], v18 offset:49280
    ds_read_b64_tr_b16 a[182:183], v18 offset:55424
    v_mfma_f32_16x16x32_bf16 a[0:3], a[160:163], v[116:119], a[0:3]
    v_exp_f32 v142, v142
    v_mfma_f32_16x16x32_bf16 a[4:7], a[160:163], v[124:127], a[4:7]
    v_exp_f32 v143, v143
    v_mfma_f32_16x16x32_bf16 a[8:11], a[160:163], v[132:135], a[8:11]
    buffer_load_dwordx4 v4, s[16:19], s57 offen offset:2048 nt lds
    v_mfma_f32_16x16x32_bf16 a[12:15], a[164:167], v[116:119], a[12:15]
    s_mov_b32 s57, 122880
    v_exp_f32 v148, v148
    v_mfma_f32_16x16x32_bf16 a[16:19], a[164:167], v[124:127], a[16:19]
    s_add_u32 m0, s51, 49152
    v_exp_f32 v149, v149
    v_mfma_f32_16x16x32_bf16 a[20:23], a[164:167], v[132:135], a[20:23]
    s_waitcnt lgkmcnt(2)
    v_exp_f32 v150, v150
    v_mfma_f32_16x16x32_bf16 a[24:27], a[168:171], v[116:119], a[24:27]
    v_exp_f32 v151, v151
    v_mfma_f32_16x16x32_bf16 a[28:31], a[168:171], v[124:127], a[28:31]
    v_exp_f32 v156, v156
    v_mfma_f32_16x16x32_bf16 a[32:35], a[168:171], v[132:135], a[32:35]
    v_exp_f32 v157, v157
    v_mfma_f32_16x16x32_bf16 a[36:39], a[172:175], v[116:119], a[36:39]
    v_exp_f32 v158, v158
    v_mfma_f32_16x16x32_bf16 a[40:43], a[172:175], v[124:127], a[40:43]
    v_exp_f32 v159, v159
    v_mfma_f32_16x16x32_bf16 a[44:47], a[172:175], v[132:135], a[44:47]
    v_cvt_pk_bf16_f32 v136, v136, v137
    v_cvt_pk_bf16_f32 v144, v144, v145
    v_mfma_f32_16x16x32_bf16 a[48:51], a[176:179], v[116:119], a[48:51]
    v_cvt_pk_bf16_f32 v152, v152, v153
    v_cvt_pk_bf16_f32 v137, v138, v139
    v_mfma_f32_16x16x32_bf16 a[52:55], a[176:179], v[124:127], a[52:55]
    v_cvt_pk_bf16_f32 v145, v146, v147
    v_cvt_pk_bf16_f32 v153, v154, v155
    v_mfma_f32_16x16x32_bf16 a[56:59], a[176:179], v[132:135], a[56:59]
    s_waitcnt lgkmcnt(0)
    v_cvt_pk_bf16_f32 v138, v140, v141
    v_cvt_pk_bf16_f32 v139, v142, v143
    v_mfma_f32_16x16x32_bf16 a[60:63], a[180:183], v[116:119], a[60:63]
    ds_write_b128 v27, v[136:139] offset:12288
    v_mfma_f32_16x16x32_bf16 a[64:67], a[180:183], v[124:127], a[64:67]
    v_cvt_pk_bf16_f32 v146, v148, v149
    v_cvt_pk_bf16_f32 v147, v150, v151
    v_mfma_f32_16x16x32_bf16 a[68:71], a[180:183], v[132:135], a[68:71]
    ds_write_b128 v27, v[144:147] offset:13312
    v_mfma_f32_16x16x32_bf16 a[144:147], a[156:159], v[136:139], a[144:147]
    v_cvt_pk_bf16_f32 v154, v156, v157
    v_cvt_pk_bf16_f32 v155, v158, v159
    v_mfma_f32_16x16x32_bf16 a[148:151], a[156:159], v[144:147], a[148:151]
    v_fma_f32 v160, v160, s52, -v44
    v_fma_f32 v161, v161, s52, -v44
    v_mfma_f32_16x16x32_bf16 a[152:155], a[156:159], v[152:155], a[152:155]
    ds_write_b128 v27, v[152:155] offset:14336
    v_fma_f32 v168, v168, s52, -v45
    v_fma_f32 v169, v169, s52, -v45
    v_fma_f32 v176, v176, s52, -v46
    v_fma_f32 v177, v177, s52, -v46
    v_exp_f32 v160, v160
    v_exp_f32 v161, v161
    v_fma_f32 v162, v162, s52, -v44
    v_fma_f32 v163, v163, s52, -v44
    v_exp_f32 v168, v168
    v_exp_f32 v169, v169
    v_fma_f32 v170, v170, s52, -v45
    v_fma_f32 v171, v171, s52, -v45
    v_exp_f32 v176, v176
    v_exp_f32 v177, v177
    v_fma_f32 v178, v178, s52, -v46
    v_fma_f32 v179, v179, s52, -v46
    v_exp_f32 v162, v162
    v_exp_f32 v163, v163
    s_waitcnt vmcnt(6) lgkmcnt(0)
    s_barrier
    ds_read_b64_tr_b16 a[160:161], v13 offset:0
    ds_read_b64_tr_b16 a[162:163], v13 offset:6144
    ds_read_b64_tr_b16 a[164:165], v14 offset:0
    buffer_load_dwordx4 v2, s[16:19], s57 offen nt lds
    ds_read_b64_tr_b16 a[166:167], v14 offset:6144
    ds_read_b64_tr_b16 a[168:169], v15 offset:0
    v_fma_f32 v164, v164, s52, -v44
    ds_read_b64_tr_b16 a[170:171], v15 offset:6144
    ds_read_b64_tr_b16 a[172:173], v16 offset:0
    ds_read_b64_tr_b16 a[174:175], v16 offset:6144
    v_fma_f32 v165, v165, s52, -v44
    ds_read_b64_tr_b16 a[176:177], v13 offset:128
    ds_read_b64_tr_b16 a[178:179], v13 offset:6272
    ds_read_b64_tr_b16 a[180:181], v14 offset:128
    v_fma_f32 v166, v166, s52, -v44
    ds_read_b64_tr_b16 a[182:183], v14 offset:6272
    ds_read_b128 v[140:143], v28 offset:12288
    buffer_load_dwordx4 v3, s[16:19], s57 offen offset:1024 nt lds
    s_waitcnt lgkmcnt(11)
    v_mfma_f32_16x16x32_bf16 a[0:3], a[160:163], v[136:139], a[0:3]
    ds_read_b128 v[148:151], v28 offset:13312
    v_fma_f32 v167, v167, s52, -v44
    v_mfma_f32_16x16x32_bf16 a[4:7], a[160:163], v[144:147], a[4:7]
    ds_read_b128 v[156:159], v28 offset:14336
    v_fma_f32 v172, v172, s52, -v45
    v_mfma_f32_16x16x32_bf16 a[8:11], a[160:163], v[152:155], a[8:11]
    s_waitcnt lgkmcnt(9)
    ds_read_b64_tr_b16 a[160:161], v17 offset:0
    ds_read_b64_tr_b16 a[162:163], v17 offset:6144
    v_mfma_f32_16x16x32_bf16 a[12:15], a[164:167], v[136:139], a[12:15]
    v_exp_f32 v170, v170
    v_mfma_f32_16x16x32_bf16 a[16:19], a[164:167], v[144:147], a[16:19]
    buffer_load_dwordx4 v4, s[16:19], s57 offen offset:2048 nt lds
    v_mfma_f32_16x16x32_bf16 a[20:23], a[164:167], v[152:155], a[20:23]
    s_mov_b32 s57, 135168
    ds_read_b64_tr_b16 a[164:165], v18 offset:0
    ds_read_b64_tr_b16 a[166:167], v18 offset:6144
    v_mfma_f32_16x16x32_bf16 a[24:27], a[168:171], v[136:139], a[24:27]
    s_add_u32 m0, s51, 61440
    v_exp_f32 v171, v171
    v_mfma_f32_16x16x32_bf16 a[28:31], a[168:171], v[144:147], a[28:31]
    v_fma_f32 v173, v173, s52, -v45
    v_fma_f32 v174, v174, s52, -v45
    v_mfma_f32_16x16x32_bf16 a[32:35], a[168:171], v[152:155], a[32:35]
    s_waitcnt lgkmcnt(4)
    ds_read_b64_tr_b16 a[168:169], v19 offset:0
    ds_read_b64_tr_b16 a[170:171], v19 offset:6144
    v_mfma_f32_16x16x32_bf16 a[36:39], a[172:175], v[136:139], a[36:39]
    buffer_load_dwordx4 v2, s[16:19], s57 offen nt lds
    v_mfma_f32_16x16x32_bf16 a[40:43], a[172:175], v[144:147], a[40:43]
    v_fma_f32 v175, v175, s52, -v45
    v_fma_f32 v180, v180, s52, -v46
    v_mfma_f32_16x16x32_bf16 a[44:47], a[172:175], v[152:155], a[44:47]
    ds_read_b64_tr_b16 a[172:173], v20 offset:0
    ds_read_b64_tr_b16 a[174:175], v20 offset:6144
    v_mfma_f32_16x16x32_bf16 a[48:51], a[176:179], v[136:139], a[48:51]
    v_exp_f32 v178, v178
    v_mfma_f32_16x16x32_bf16 a[52:55], a[176:179], v[144:147], a[52:55]
    v_exp_f32 v179, v179
    v_mfma_f32_16x16x32_bf16 a[56:59], a[176:179], v[152:155], a[56:59]
    buffer_load_dwordx4 v3, s[16:19], s57 offen offset:1024 nt lds
    v_mfma_f32_16x16x32_bf16 a[60:63], a[180:183], v[136:139], a[60:63]
    ds_read_b64_tr_b16 a[176:177], v17 offset:128
    ds_read_b64_tr_b16 a[178:179], v17 offset:6272
    v_mfma_f32_16x16x32_bf16 a[64:67], a[180:183], v[144:147], a[64:67]
    v_fma_f32 v181, v181, s52, -v46
    v_fma_f32 v182, v182, s52, -v46
    v_mfma_f32_16x16x32_bf16 a[68:71], a[180:183], v[152:155], a[68:71]
    s_waitcnt lgkmcnt(4)
    ds_read_b64_tr_b16 a[180:181], v18 offset:128
    ds_read_b64_tr_b16 a[182:183], v18 offset:6272
    v_mfma_f32_16x16x32_bf16 a[0:3], a[160:163], v[140:143], a[0:3]
    v_fma_f32 v183, v183, s52, -v46
    v_cvt_pk_bf16_f32 v160, v160, v161
    v_mfma_f32_16x16x32_bf16 a[4:7], a[160:163], v[148:151], a[4:7]
    buffer_load_dwordx4 v4, s[16:19], s57 offen offset:2048 nt lds
    v_mfma_f32_16x16x32_bf16 a[8:11], a[160:163], v[156:159], a[8:11]
    s_mov_b32 s57, 147456
    v_exp_f32 v164, v164
    v_mfma_f32_16x16x32_bf16 a[12:15], a[164:167], v[140:143], a[12:15]
    s_add_u32 m0, s51, 0
    v_exp_f32 v165, v165
    v_mfma_f32_16x16x32_bf16 a[16:19], a[164:167], v[148:151], a[16:19]
    v_exp_f32 v166, v166
    v_mfma_f32_16x16x32_bf16 a[20:23], a[164:167], v[156:159], a[20:23]
    v_exp_f32 v167, v167
    v_mfma_f32_16x16x32_bf16 a[24:27], a[168:171], v[140:143], a[24:27]
    v_exp_f32 v172, v172
    v_mfma_f32_16x16x32_bf16 a[28:31], a[168:171], v[148:151], a[28:31]
    v_exp_f32 v173, v173
    v_mfma_f32_16x16x32_bf16 a[32:35], a[168:171], v[156:159], a[32:35]
    s_waitcnt lgkmcnt(0)
    v_exp_f32 v174, v174
    v_mfma_f32_16x16x32_bf16 a[36:39], a[172:175], v[140:143], a[36:39]
    v_exp_f32 v175, v175
    v_mfma_f32_16x16x32_bf16 a[40:43], a[172:175], v[148:151], a[40:43]
    v_exp_f32 v180, v180
    v_mfma_f32_16x16x32_bf16 a[44:47], a[172:175], v[156:159], a[44:47]
    v_exp_f32 v181, v181
    v_mfma_f32_16x16x32_bf16 a[48:51], a[176:179], v[140:143], a[48:51]
    v_exp_f32 v182, v182
    v_mfma_f32_16x16x32_bf16 a[52:55], a[176:179], v[148:151], a[52:55]
    v_exp_f32 v183, v183
    v_mfma_f32_16x16x32_bf16 a[56:59], a[176:179], v[156:159], a[56:59]
    v_cvt_pk_bf16_f32 v168, v168, v169
    v_cvt_pk_bf16_f32 v176, v176, v177
    v_mfma_f32_16x16x32_bf16 a[60:63], a[180:183], v[140:143], a[60:63]
    v_cvt_pk_bf16_f32 v161, v162, v163
    v_cvt_pk_bf16_f32 v169, v170, v171
    v_mfma_f32_16x16x32_bf16 a[64:67], a[180:183], v[148:151], a[64:67]
    v_cvt_pk_bf16_f32 v177, v178, v179
    v_cvt_pk_bf16_f32 v162, v164, v165
    v_mfma_f32_16x16x32_bf16 a[68:71], a[180:183], v[156:159], a[68:71]
    v_cvt_pk_bf16_f32 v163, v166, v167
    v_cvt_pk_bf16_f32 v170, v172, v173
    v_cvt_pk_bf16_f32 v171, v174, v175
    v_mfma_f32_16x16x32_bf16 a[144:147], a[156:159], v[160:163], a[144:147]
    ds_write_b128 v27, v[160:163] offset:0
    v_mfma_f32_16x16x32_bf16 a[148:151], a[156:159], v[168:171], a[148:151]
    v_cvt_pk_bf16_f32 v178, v180, v181
    v_cvt_pk_bf16_f32 v179, v182, v183
    v_accvgpr_read_b32 v64, a72
    v_accvgpr_read_b32 v65, a73
    v_mfma_f32_16x16x32_bf16 a[152:155], a[156:159], v[176:179], a[152:155]
    ds_write_b128 v27, v[168:171] offset:1024
    v_accvgpr_read_b32 v68, a76
    v_accvgpr_read_b32 v69, a77
    v_accvgpr_read_b32 v72, a80
    v_accvgpr_read_b32 v73, a81
    v_accvgpr_read_b32 v76, a84
    v_accvgpr_read_b32 v77, a85
    ds_write_b128 v27, v[176:179] offset:2048
    v_accvgpr_read_b32 v80, a88
    v_accvgpr_read_b32 v81, a89
    v_accvgpr_read_b32 v84, a92
    v_accvgpr_read_b32 v85, a93
    v_accvgpr_read_b32 v66, a74
    v_accvgpr_read_b32 v67, a75
    v_cvt_pk_bf16_f32 v64, v64, v65
    v_accvgpr_read_b32 v70, a78
    v_accvgpr_read_b32 v71, a79
    v_cvt_pk_bf16_f32 v68, v68, v69
    v_accvgpr_read_b32 v74, a82
    v_accvgpr_read_b32 v75, a83
    v_cvt_pk_bf16_f32 v72, v72, v73
    v_accvgpr_read_b32 v78, a86
    v_accvgpr_read_b32 v79, a87
    v_cvt_pk_bf16_f32 v76, v76, v77
    v_accvgpr_read_b32 v82, a90
    v_accvgpr_read_b32 v83, a91
    v_cvt_pk_bf16_f32 v80, v80, v81
    v_accvgpr_read_b32 v86, a94
    v_accvgpr_read_b32 v87, a95
    v_cvt_pk_bf16_f32 v84, v84, v85
    v_cvt_pk_bf16_f32 v65, v66, v67
    v_cvt_pk_bf16_f32 v69, v70, v71
    v_cvt_pk_bf16_f32 v73, v74, v75
    s_waitcnt vmcnt(6) lgkmcnt(0)
    s_barrier
    ds_read_b64_tr_b16 a[160:161], v13 offset:24576
    ds_read_b64_tr_b16 a[162:163], v13 offset:30720
    ds_read_b64_tr_b16 a[164:165], v14 offset:24576
    buffer_load_dwordx4 v2, s[16:19], s57 offen nt lds
    ds_read_b64_tr_b16 a[166:167], v14 offset:30720
    ds_read_b64_tr_b16 a[168:169], v15 offset:24576
    v_cvt_pk_bf16_f32 v77, v78, v79
    ds_read_b64_tr_b16 a[170:171], v15 offset:30720
    ds_read_b64_tr_b16 a[172:173], v16 offset:24576
    ds_read_b64_tr_b16 a[174:175], v16 offset:30720
    v_cvt_pk_bf16_f32 v81, v82, v83
    ds_read_b64_tr_b16 a[176:177], v13 offset:24704
    ds_read_b64_tr_b16 a[178:179], v13 offset:30848
    ds_read_b64_tr_b16 a[180:181], v14 offset:24704
    v_cvt_pk_bf16_f32 v85, v86, v87
    ds_read_b64_tr_b16 a[182:183], v14 offset:30848
    ds_read_b128 v[164:167], v28 offset:0
    buffer_load_dwordx4 v3, s[16:19], s57 offen offset:1024 nt lds
    s_waitcnt lgkmcnt(11)
    v_mfma_f32_16x16x32_bf16 a[0:3], a[160:163], v[160:163], a[0:3]
    ds_read_b128 v[172:175], v28 offset:1024
    v_fma_f32 v184, v184, s52, -v44
    v_mfma_f32_16x16x32_bf16 a[4:7], a[160:163], v[168:171], a[4:7]
    ds_read_b128 v[180:183], v28 offset:2048
    v_fma_f32 v185, v185, s52, -v44
    v_mfma_f32_16x16x32_bf16 a[8:11], a[160:163], v[176:179], a[8:11]
    s_waitcnt lgkmcnt(9)
    ds_read_b64_tr_b16 a[160:161], v17 offset:24576
    ds_read_b64_tr_b16 a[162:163], v17 offset:30720
    v_mfma_f32_16x16x32_bf16 a[12:15], a[164:167], v[160:163], a[12:15]
    ds_write_b64 v29, v[64:65] offset:0
    v_mfma_f32_16x16x32_bf16 a[16:19], a[164:167], v[168:171], a[16:19]
    buffer_load_dwordx4 v4, s[16:19], s57 offen offset:2048 nt lds
    v_mfma_f32_16x16x32_bf16 a[20:23], a[164:167], v[176:179], a[20:23]
    s_mov_b32 s57, 159744
    ds_read_b64_tr_b16 a[164:165], v18 offset:24576
    ds_read_b64_tr_b16 a[166:167], v18 offset:30720
    v_mfma_f32_16x16x32_bf16 a[24:27], a[168:171], v[160:163], a[24:27]
    s_add_u32 m0, s51, 12288
    ds_write_b64 v29, v[68:69] offset:6144
    v_mfma_f32_16x16x32_bf16 a[28:31], a[168:171], v[168:171], a[28:31]
    ds_write_b64 v29, v[72:73] offset:12288
    v_mfma_f32_16x16x32_bf16 a[32:35], a[168:171], v[176:179], a[32:35]
    s_waitcnt lgkmcnt(7)
    v_fma_f32 v192, v192, s52, -v45
    v_fma_f32 v193, v193, s52, -v45
    v_mfma_f32_16x16x32_bf16 a[36:39], a[172:175], v[160:163], a[36:39]
    buffer_load_dwordx4 v2, s[16:19], s57 offen nt lds
    v_mfma_f32_16x16x32_bf16 a[40:43], a[172:175], v[168:171], a[40:43]
    ds_read_b64_tr_b16 a[168:169], v19 offset:24576
    ds_read_b64_tr_b16 a[170:171], v19 offset:30720
    v_mfma_f32_16x16x32_bf16 a[44:47], a[172:175], v[176:179], a[44:47]
    ds_read_b64_tr_b16 a[172:173], v20 offset:24576
    ds_read_b64_tr_b16 a[174:175], v20 offset:30720
    v_mfma_f32_16x16x32_bf16 a[48:51], a[176:179], v[160:163], a[48:51]
    ds_write_b64 v29, v[76:77] offset:18432
    v_mfma_f32_16x16x32_bf16 a[52:55], a[176:179], v[168:171], a[52:55]
    ds_write_b64 v29, v[80:81] offset:24576
    v_mfma_f32_16x16x32_bf16 a[56:59], a[176:179], v[176:179], a[56:59]
    buffer_load_dwordx4 v3, s[16:19], s57 offen offset:1024 nt lds
    v_mfma_f32_16x16x32_bf16 a[60:63], a[180:183], v[160:163], a[60:63]
    ds_write_b64 v29, v[84:85] offset:30720
    v_mfma_f32_16x16x32_bf16 a[64:67], a[180:183], v[168:171], a[64:67]
    ds_read_b64_tr_b16 a[176:177], v17 offset:24704
    v_fma_f32 v200, v200, s52, -v46
    v_mfma_f32_16x16x32_bf16 a[68:71], a[180:183], v[176:179], a[68:71]
    s_waitcnt lgkmcnt(6)
    ds_read_b64_tr_b16 a[178:179], v17 offset:30848
    ds_read_b64_tr_b16 a[180:181], v18 offset:24704
    v_mfma_f32_16x16x32_bf16 a[0:3], a[160:163], v[164:167], a[0:3]
    ds_read_b64_tr_b16 a[182:183], v18 offset:30848
    v_fma_f32 v201, v201, s52, -v46
    v_mfma_f32_16x16x32_bf16 a[4:7], a[160:163], v[172:175], a[4:7]
    buffer_load_dwordx4 v4, s[16:19], s57 offen offset:2048 nt lds
    v_mfma_f32_16x16x32_bf16 a[8:11], a[160:163], v[180:183], a[8:11]
    s_mov_b32 s57, 172032
    v_exp_f32 v184, v184
    v_mfma_f32_16x16x32_bf16 a[12:15], a[164:167], v[164:167], a[12:15]
    s_add_u32 m0, s51, 24576
    v_exp_f32 v185, v185
    v_mfma_f32_16x16x32_bf16 a[16:19], a[164:167], v[172:175], a[16:19]
    v_fma_f32 v186, v186, s52, -v44
    v_fma_f32 v187, v187, s52, -v44
    v_mfma_f32_16x16x32_bf16 a[20:23], a[164:167], v[180:183], a[20:23]
    v_exp_f32 v192, v192
    v_mfma_f32_16x16x32_bf16 a[24:27], a[168:171], v[164:167], a[24:27]
    v_exp_f32 v193, v193
    v_mfma_f32_16x16x32_bf16 a[28:31], a[168:171], v[172:175], a[28:31]
    v_fma_f32 v194, v194, s52, -v45
    v_fma_f32 v195, v195, s52, -v45
    v_mfma_f32_16x16x32_bf16 a[32:35], a[168:171], v[180:183], a[32:35]
    s_waitcnt lgkmcnt(0)
    v_exp_f32 v200, v200
    v_mfma_f32_16x16x32_bf16 a[36:39], a[172:175], v[164:167], a[36:39]
    v_exp_f32 v201, v201
    v_mfma_f32_16x16x32_bf16 a[40:43], a[172:175], v[172:175], a[40:43]
    v_fma_f32 v202, v202, s52, -v46
    v_fma_f32 v203, v203, s52, -v46
    v_mfma_f32_16x16x32_bf16 a[44:47], a[172:175], v[180:183], a[44:47]
    v_exp_f32 v186, v186
    v_mfma_f32_16x16x32_bf16 a[48:51], a[176:179], v[164:167], a[48:51]
    v_exp_f32 v187, v187
    v_mfma_f32_16x16x32_bf16 a[52:55], a[176:179], v[172:175], a[52:55]
    v_fma_f32 v188, v188, s52, -v44
    v_fma_f32 v189, v189, s52, -v44
    v_mfma_f32_16x16x32_bf16 a[56:59], a[176:179], v[180:183], a[56:59]
    v_fma_f32 v190, v190, s52, -v44
    v_fma_f32 v191, v191, s52, -v44
    v_mfma_f32_16x16x32_bf16 a[60:63], a[180:183], v[164:167], a[60:63]
    v_exp_f32 v194, v194
    v_mfma_f32_16x16x32_bf16 a[64:67], a[180:183], v[172:175], a[64:67]
    v_exp_f32 v195, v195
    v_mfma_f32_16x16x32_bf16 a[68:71], a[180:183], v[180:183], a[68:71]
    v_fma_f32 v196, v196, s52, -v45
    v_fma_f32 v197, v197, s52, -v45
    v_fma_f32 v198, v198, s52, -v45
    v_fma_f32 v199, v199, s52, -v45
    v_exp_f32 v202, v202
    v_exp_f32 v203, v203
    v_fma_f32 v204, v204, s52, -v46
    v_fma_f32 v205, v205, s52, -v46
    v_fma_f32 v206, v206, s52, -v46
    v_fma_f32 v207, v207, s52, -v46
    v_accvgpr_read_b32 v88, a96
    v_accvgpr_read_b32 v89, a97
    v_accvgpr_read_b32 v92, a100
    v_accvgpr_read_b32 v93, a101
    v_accvgpr_read_b32 v96, a104
    v_accvgpr_read_b32 v97, a105
    v_accvgpr_read_b32 v100, a108
    v_accvgpr_read_b32 v101, a109
    v_accvgpr_read_b32 v104, a112
    v_accvgpr_read_b32 v105, a113
    v_accvgpr_read_b32 v108, a116
    v_accvgpr_read_b32 v109, a117
    v_accvgpr_read_b32 v64, a120
    v_accvgpr_read_b32 v65, a121
    v_accvgpr_read_b32 v68, a124
    v_accvgpr_read_b32 v69, a125
    v_accvgpr_read_b32 v72, a128
    v_accvgpr_read_b32 v73, a129
    v_accvgpr_read_b32 v76, a132
    v_accvgpr_read_b32 v77, a133
    v_accvgpr_read_b32 v80, a136
    v_accvgpr_read_b32 v81, a137
    v_accvgpr_read_b32 v84, a140
    v_accvgpr_read_b32 v85, a141
    v_exp_f32 v188, v188
    v_exp_f32 v189, v189
    v_exp_f32 v190, v190
    v_exp_f32 v191, v191
    v_exp_f32 v196, v196
    v_exp_f32 v197, v197
    v_exp_f32 v198, v198
    v_exp_f32 v199, v199
    v_exp_f32 v204, v204
    v_exp_f32 v205, v205
    v_exp_f32 v206, v206
    v_exp_f32 v207, v207
    v_accvgpr_read_b32 v90, a98
    v_accvgpr_read_b32 v91, a99
    v_cvt_pk_bf16_f32 v88, v88, v89
    v_accvgpr_read_b32 v94, a102
    v_accvgpr_read_b32 v95, a103
    v_cvt_pk_bf16_f32 v92, v92, v93
    v_accvgpr_read_b32 v98, a106
    v_accvgpr_read_b32 v99, a107
    v_cvt_pk_bf16_f32 v96, v96, v97
    v_accvgpr_read_b32 v102, a110
    v_accvgpr_read_b32 v103, a111
    v_cvt_pk_bf16_f32 v100, v100, v101
    v_accvgpr_read_b32 v106, a114
    v_accvgpr_read_b32 v107, a115
    v_cvt_pk_bf16_f32 v104, v104, v105
    v_accvgpr_read_b32 v110, a118
    v_accvgpr_read_b32 v111, a119
    v_cvt_pk_bf16_f32 v108, v108, v109
    v_accvgpr_read_b32 v66, a122
    v_accvgpr_read_b32 v67, a123
    v_cvt_pk_bf16_f32 v64, v64, v65
    v_accvgpr_read_b32 v70, a126
    v_accvgpr_read_b32 v71, a127
    v_cvt_pk_bf16_f32 v68, v68, v69
    v_accvgpr_read_b32 v74, a130
    v_accvgpr_read_b32 v75, a131
    v_cvt_pk_bf16_f32 v72, v72, v73
    v_accvgpr_read_b32 v78, a134
    v_accvgpr_read_b32 v79, a135
    v_cvt_pk_bf16_f32 v76, v76, v77
    v_accvgpr_read_b32 v82, a138
    v_accvgpr_read_b32 v83, a139
    v_cvt_pk_bf16_f32 v80, v80, v81
    v_accvgpr_read_b32 v86, a142
    v_accvgpr_read_b32 v87, a143
    v_cvt_pk_bf16_f32 v84, v84, v85
    v_cvt_pk_bf16_f32 v184, v184, v185
    v_cvt_pk_bf16_f32 v192, v192, v193
    v_cvt_pk_bf16_f32 v200, v200, v201
    v_cvt_pk_bf16_f32 v89, v90, v91
    v_cvt_pk_bf16_f32 v93, v94, v95
    v_cvt_pk_bf16_f32 v97, v98, v99
    v_cvt_pk_bf16_f32 v101, v102, v103
    v_cvt_pk_bf16_f32 v105, v106, v107
    v_cvt_pk_bf16_f32 v109, v110, v111
    v_cvt_pk_bf16_f32 v65, v66, v67
    v_cvt_pk_bf16_f32 v69, v70, v71
    v_cvt_pk_bf16_f32 v73, v74, v75
    v_cvt_pk_bf16_f32 v77, v78, v79
    v_cvt_pk_bf16_f32 v81, v82, v83
    v_cvt_pk_bf16_f32 v85, v86, v87
    v_cvt_pk_bf16_f32 v185, v186, v187
    v_cvt_pk_bf16_f32 v193, v194, v195
    v_cvt_pk_bf16_f32 v201, v202, v203
    v_cvt_pk_bf16_f32 v186, v188, v189
    v_cvt_pk_bf16_f32 v187, v190, v191
    v_cvt_pk_bf16_f32 v194, v196, v197
    v_cvt_pk_bf16_f32 v195, v198, v199
    v_mfma_f32_16x16x32_bf16 a[144:147], a[156:159], v[184:187], a[144:147]
    ds_write_b64 v29, v[88:89] offset:512
    v_mfma_f32_16x16x32_bf16 a[148:151], a[156:159], v[192:195], a[148:151]
    ds_write_b64 v29, v[92:93] offset:6656
    v_cvt_pk_bf16_f32 v202, v204, v205
    v_cvt_pk_bf16_f32 v203, v206, v207
    v_fma_f32 v208, v208, s52, -v44
    v_fma_f32 v209, v209, s52, -v44
    v_mfma_f32_16x16x32_bf16 a[152:155], a[156:159], v[200:203], a[152:155]
    ds_write_b64 v29, v[96:97] offset:12800
    v_fma_f32 v216, v216, s52, -v45
    v_fma_f32 v217, v217, s52, -v45
    ds_write_b64 v29, v[100:101] offset:18944
    v_fma_f32 v224, v224, s52, -v46
    v_fma_f32 v225, v225, s52, -v46
    ds_write_b64 v29, v[104:105] offset:25088
    v_exp_f32 v208, v208
    ds_write_b64 v29, v[108:109] offset:31232
    v_exp_f32 v209, v209
    ds_write_b64 v29, v[64:65] offset:1024
    v_fma_f32 v210, v210, s52, -v44
    v_fma_f32 v211, v211, s52, -v44
    ds_write_b64 v29, v[68:69] offset:7168
    v_exp_f32 v216, v216
    ds_write_b64 v29, v[72:73] offset:13312
    v_exp_f32 v217, v217
    ds_write_b64 v29, v[76:77] offset:19456
    v_fma_f32 v218, v218, s52, -v45
    v_fma_f32 v219, v219, s52, -v45
    ds_write_b64 v29, v[80:81] offset:25600
    v_exp_f32 v224, v224
    ds_write_b64 v29, v[84:85] offset:31744
    v_exp_f32 v225, v225
    ds_write_b128 v27, v[184:187] offset:12288
    v_fma_f32 v226, v226, s52, -v46
    v_fma_f32 v227, v227, s52, -v46
    v_exp_f32 v210, v210
    v_exp_f32 v211, v211
    ds_write_b128 v27, v[192:195] offset:13312
    v_fma_f32 v212, v212, s52, -v44
    v_fma_f32 v213, v213, s52, -v44
    v_fma_f32 v214, v214, s52, -v44
    v_fma_f32 v215, v215, s52, -v44
    v_exp_f32 v218, v218
    ds_write_b128 v27, v[200:203] offset:14336
    v_exp_f32 v219, v219
    v_fma_f32 v220, v220, s52, -v45
    v_fma_f32 v221, v221, s52, -v45
    v_fma_f32 v222, v222, s52, -v45
    v_fma_f32 v223, v223, s52, -v45
    v_exp_f32 v226, v226
    v_exp_f32 v227, v227
    v_fma_f32 v228, v228, s52, -v46
    v_fma_f32 v229, v229, s52, -v46
    v_fma_f32 v230, v230, s52, -v46
    v_fma_f32 v231, v231, s52, -v46
    v_exp_f32 v212, v212
    v_exp_f32 v213, v213
    v_exp_f32 v214, v214
    v_exp_f32 v215, v215
    v_exp_f32 v220, v220
    v_exp_f32 v221, v221
    s_waitcnt vmcnt(6) lgkmcnt(0)
    s_barrier
    ds_read_b64_tr_b16 a[160:161], v13 offset:49152
    ds_read_b64_tr_b16 a[162:163], v13 offset:55296
    ds_read_b64_tr_b16 a[164:165], v14 offset:49152
    buffer_load_dwordx4 v2, s[16:19], s57 offen nt lds
    ds_read_b64_tr_b16 a[166:167], v14 offset:55296
    ds_read_b64_tr_b16 a[168:169], v15 offset:49152
    v_exp_f32 v222, v222
    ds_read_b64_tr_b16 a[170:171], v15 offset:55296
    ds_read_b64_tr_b16 a[172:173], v16 offset:49152
    ds_read_b64_tr_b16 a[174:175], v16 offset:55296
    v_exp_f32 v223, v223
    ds_read_b64_tr_b16 a[176:177], v13 offset:49280
    ds_read_b64_tr_b16 a[178:179], v13 offset:55424
    ds_read_b64_tr_b16 a[180:181], v14 offset:49280
    v_exp_f32 v228, v228
    v_cvt_pk_bf16_f32 v208, v208, v209
    v_exp_f32 v229, v229
    s_waitcnt lgkmcnt(9)
    v_mfma_f32_16x16x32_bf16 a[0:3], a[160:163], v[184:187], a[0:3]
    ds_read_b64_tr_b16 a[182:183], v14 offset:55424
    ds_read_b128 v[188:191], v28 offset:12288
    v_mfma_f32_16x16x32_bf16 a[4:7], a[160:163], v[192:195], a[4:7]
    buffer_load_dwordx4 v3, s[16:19], s57 offen offset:1024 nt lds
    v_mfma_f32_16x16x32_bf16 a[8:11], a[160:163], v[200:203], a[8:11]
    s_waitcnt lgkmcnt(7)
    ds_read_b64_tr_b16 a[160:161], v17 offset:49152
    ds_read_b64_tr_b16 a[162:163], v17 offset:55296
    v_mfma_f32_16x16x32_bf16 a[12:15], a[164:167], v[184:187], a[12:15]
    ds_read_b128 v[196:199], v28 offset:13312
    v_cvt_pk_bf16_f32 v216, v216, v217
    v_mfma_f32_16x16x32_bf16 a[16:19], a[164:167], v[192:195], a[16:19]
    ds_read_b128 v[204:207], v28 offset:14336
    v_cvt_pk_bf16_f32 v224, v224, v225
    v_mfma_f32_16x16x32_bf16 a[20:23], a[164:167], v[200:203], a[20:23]
    ds_read_b64_tr_b16 a[164:165], v18 offset:49152
    ds_read_b64_tr_b16 a[166:167], v18 offset:55296
    v_mfma_f32_16x16x32_bf16 a[24:27], a[168:171], v[184:187], a[24:27]
    buffer_load_dwordx4 v4, s[16:19], s57 offen offset:2048 nt lds
    v_mfma_f32_16x16x32_bf16 a[28:31], a[168:171], v[192:195], a[28:31]
    s_mov_b32 s57, 184320
    s_add_u32 m0, s51, 36864
    ds_read_b128 a[72:75], v30 offset:0
    v_mfma_f32_16x16x32_bf16 a[32:35], a[168:171], v[200:203], a[32:35]
    s_waitcnt lgkmcnt(7)
    ds_read_b64_tr_b16 a[168:169], v19 offset:49152
    ds_read_b64_tr_b16 a[170:171], v19 offset:55296
    v_mfma_f32_16x16x32_bf16 a[36:39], a[172:175], v[184:187], a[36:39]
    ds_read_b128 a[76:79], v30 offset:6144
    v_cvt_pk_bf16_f32 v209, v210, v211
    v_mfma_f32_16x16x32_bf16 a[40:43], a[172:175], v[192:195], a[40:43]
    ds_read_b128 a[80:83], v30 offset:12288
    v_cvt_pk_bf16_f32 v217, v218, v219
    v_mfma_f32_16x16x32_bf16 a[44:47], a[172:175], v[200:203], a[44:47]
    buffer_load_dwordx4 v2, s[16:19], s57 offen nt lds
    v_mfma_f32_16x16x32_bf16 a[48:51], a[176:179], v[184:187], a[48:51]
    ds_read_b64_tr_b16 a[172:173], v20 offset:49152
    ds_read_b64_tr_b16 a[174:175], v20 offset:55296
    v_mfma_f32_16x16x32_bf16 a[52:55], a[176:179], v[192:195], a[52:55]
    ds_read_b128 a[84:87], v30 offset:1024
    v_cvt_pk_bf16_f32 v225, v226, v227
    v_mfma_f32_16x16x32_bf16 a[56:59], a[176:179], v[200:203], a[56:59]
    ds_read_b64_tr_b16 a[176:177], v17 offset:49280
    ds_read_b64_tr_b16 a[178:179], v17 offset:55424
    v_mfma_f32_16x16x32_bf16 a[60:63], a[180:183], v[184:187], a[60:63]
    ds_read_b128 a[88:91], v30 offset:7168
    v_cvt_pk_bf16_f32 v210, v212, v213
    v_mfma_f32_16x16x32_bf16 a[64:67], a[180:183], v[192:195], a[64:67]
    buffer_load_dwordx4 v3, s[16:19], s57 offen offset:1024 nt lds
    v_mfma_f32_16x16x32_bf16 a[68:71], a[180:183], v[200:203], a[68:71]
    s_waitcnt lgkmcnt(6)
    ds_read_b64_tr_b16 a[180:181], v18 offset:49280
    ds_read_b64_tr_b16 a[182:183], v18 offset:55424
    v_mfma_f32_16x16x32_bf16 a[0:3], a[160:163], v[188:191], a[0:3]
    ds_read_b128 a[92:95], v30 offset:13312
    v_cvt_pk_bf16_f32 v211, v214, v215
    v_mfma_f32_16x16x32_bf16 a[4:7], a[160:163], v[196:199], a[4:7]
    ds_write_b128 v27, v[208:211] offset:0
    v_mfma_f32_16x16x32_bf16 a[8:11], a[160:163], v[204:207], a[8:11]
    v_exp_f32 v230, v230
    v_mfma_f32_16x16x32_bf16 a[12:15], a[164:167], v[188:191], a[12:15]
    buffer_load_dwordx4 v4, s[16:19], s57 offen offset:2048 nt lds
    v_mfma_f32_16x16x32_bf16 a[16:19], a[164:167], v[196:199], a[16:19]
    s_mov_b32 s57, 3145728
    ds_read_b128 a[96:99], v30 offset:2048
    v_cvt_pk_bf16_f32 v218, v220, v221
    v_mfma_f32_16x16x32_bf16 a[20:23], a[164:167], v[204:207], a[20:23]
    s_add_u32 m0, s51, 49152
    ds_read_b128 a[100:103], v30 offset:8192
    v_cvt_pk_bf16_f32 v219, v222, v223
    v_mfma_f32_16x16x32_bf16 a[24:27], a[168:171], v[188:191], a[24:27]
    ds_write_b128 v27, v[216:219] offset:1024
    v_mfma_f32_16x16x32_bf16 a[28:31], a[168:171], v[196:199], a[28:31]
    v_exp_f32 v231, v231
    v_mfma_f32_16x16x32_bf16 a[32:35], a[168:171], v[204:207], a[32:35]
    s_waitcnt lgkmcnt(3)
    ds_read_b128 a[104:107], v30 offset:14336
    v_cvt_pk_bf16_f32 v226, v228, v229
    v_mfma_f32_16x16x32_bf16 a[36:39], a[172:175], v[188:191], a[36:39]
    ds_read_b128 a[108:111], v30 offset:3072
    v_cvt_pk_bf16_f32 v227, v230, v231
    v_mfma_f32_16x16x32_bf16 a[40:43], a[172:175], v[196:199], a[40:43]
    ds_write_b128 v27, v[224:227] offset:2048
    v_mfma_f32_16x16x32_bf16 a[44:47], a[172:175], v[204:207], a[44:47]
    v_fma_f32 v232, v232, s52, -v44
    v_fma_f32 v233, v233, s52, -v44
    v_mfma_f32_16x16x32_bf16 a[48:51], a[176:179], v[188:191], a[48:51]
    v_exp_f32 v232, v232
    v_mfma_f32_16x16x32_bf16 a[52:55], a[176:179], v[196:199], a[52:55]
    ds_read_b128 a[112:115], v30 offset:9216
    v_fma_f32 v234, v234, s52, -v44
    v_mfma_f32_16x16x32_bf16 a[56:59], a[176:179], v[204:207], a[56:59]
    ds_read_b128 a[116:119], v30 offset:15360
    v_fma_f32 v235, v235, s52, -v44
    v_mfma_f32_16x16x32_bf16 a[60:63], a[180:183], v[188:191], a[60:63]
    ds_read_b128 a[120:123], v30 offset:4096
    v_fma_f32 v236, v236, s52, -v44
    v_mfma_f32_16x16x32_bf16 a[64:67], a[180:183], v[196:199], a[64:67]
    ds_read_b128 a[124:127], v30 offset:10240
    v_fma_f32 v237, v237, s52, -v44
    v_mfma_f32_16x16x32_bf16 a[68:71], a[180:183], v[204:207], a[68:71]
    ds_read_b128 a[128:131], v30 offset:16384
    v_fma_f32 v238, v238, s52, -v44
    v_mfma_f32_16x16x32_bf16 a[144:147], a[156:159], v[208:211], a[144:147]
    ds_read_b128 a[132:135], v30 offset:5120
    v_fma_f32 v239, v239, s52, -v44
    v_mfma_f32_16x16x32_bf16 a[148:151], a[156:159], v[216:219], a[148:151]
    ds_read_b128 a[136:139], v30 offset:11264
    v_fma_f32 v240, v240, s52, -v45
    v_mfma_f32_16x16x32_bf16 a[152:155], a[156:159], v[224:227], a[152:155]
    ds_read_b128 a[140:143], v30 offset:17408
    v_exp_f32 v233, v233
    v_exp_f32 v234, v234
    v_exp_f32 v235, v235
    v_exp_f32 v236, v236
    v_exp_f32 v237, v237
    v_exp_f32 v238, v238
    v_exp_f32 v239, v239
    v_cvt_pk_bf16_f32 v232, v232, v233
    v_fma_f32 v241, v241, s52, -v45
    v_cvt_pk_bf16_f32 v233, v234, v235
    v_exp_f32 v240, v240
    v_exp_f32 v241, v241
    v_fma_f32 v242, v242, s52, -v45
    s_waitcnt vmcnt(6) lgkmcnt(0)
    s_barrier
    ds_read_b64_tr_b16 a[160:161], v13 offset:0
    ds_read_b64_tr_b16 a[162:163], v13 offset:6144
    ds_read_b64_tr_b16 a[164:165], v14 offset:0
    buffer_load_dwordx4 v2, s[12:15], s57 offen nt lds
    ds_read_b64_tr_b16 a[166:167], v14 offset:6144
    ds_read_b64_tr_b16 a[168:169], v15 offset:0
    v_fma_f32 v243, v243, s52, -v45
    ds_read_b64_tr_b16 a[170:171], v15 offset:6144
    ds_read_b64_tr_b16 a[172:173], v16 offset:0
    ds_read_b64_tr_b16 a[174:175], v16 offset:6144
    v_cvt_pk_bf16_f32 v234, v236, v237
    ds_read_b64_tr_b16 a[176:177], v13 offset:128
    ds_read_b64_tr_b16 a[178:179], v13 offset:6272
    ds_read_b64_tr_b16 a[180:181], v14 offset:128
    v_cvt_pk_bf16_f32 v235, v238, v239
    ds_read_b64_tr_b16 a[182:183], v14 offset:6272
    ds_read_b128 v[212:215], v28 offset:0
    s_waitcnt vmcnt(6)
    buffer_load_dwordx4 v3, s[12:15], s57 offen offset:1024 nt lds
    s_waitcnt lgkmcnt(11)
    v_mfma_f32_16x16x32_bf16 a[0:3], a[160:163], v[208:211], a[0:3]
    ds_read_b128 v[220:223], v28 offset:1024
    v_fma_f32 v244, v244, s52, -v45
    v_mfma_f32_16x16x32_bf16 a[4:7], a[160:163], v[216:219], a[4:7]
    ds_read_b128 v[228:231], v28 offset:2048
    v_fma_f32 v245, v245, s52, -v45
    v_mfma_f32_16x16x32_bf16 a[8:11], a[160:163], v[224:227], a[8:11]
    s_waitcnt lgkmcnt(9)
    ds_read_b64_tr_b16 a[160:161], v17 offset:0
    ds_read_b64_tr_b16 a[162:163], v17 offset:6144
    v_mfma_f32_16x16x32_bf16 a[12:15], a[164:167], v[208:211], a[12:15]
    ds_write_b128 v27, v[232:235] offset:12288
    v_mfma_f32_16x16x32_bf16 a[16:19], a[164:167], v[216:219], a[16:19]
    s_waitcnt vmcnt(6)
    buffer_load_dwordx4 v4, s[12:15], s57 offen offset:2048 nt lds
    v_mfma_f32_16x16x32_bf16 a[20:23], a[164:167], v[224:227], a[20:23]
    s_mov_b32 s57, 3158016
    ds_read_b64_tr_b16 a[164:165], v18 offset:0
    s_add_u32 m0, s51, 61440
    v_mfma_f32_16x16x32_bf16 a[24:27], a[168:171], v[208:211], a[24:27]
    ds_read_b64_tr_b16 a[166:167], v18 offset:6144
    v_fma_f32 v246, v246, s52, -v45
    v_mfma_f32_16x16x32_bf16 a[28:31], a[168:171], v[216:219], a[28:31]
    v_exp_f32 v242, v242
    v_mfma_f32_16x16x32_bf16 a[32:35], a[168:171], v[224:227], a[32:35]
    s_waitcnt lgkmcnt(3)
    ds_read_b64_tr_b16 a[168:169], v19 offset:0
    ds_read_b64_tr_b16 a[170:171], v19 offset:6144
    v_mfma_f32_16x16x32_bf16 a[36:39], a[172:175], v[208:211], a[36:39]
    s_waitcnt vmcnt(6)
    buffer_load_dwordx4 v2, s[12:15], s57 offen nt lds
    v_mfma_f32_16x16x32_bf16 a[40:43], a[172:175], v[216:219], a[40:43]
    v_exp_f32 v243, v243
    v_mfma_f32_16x16x32_bf16 a[44:47], a[172:175], v[224:227], a[44:47]
    ds_read_b64_tr_b16 a[172:173], v20 offset:0
    ds_read_b64_tr_b16 a[174:175], v20 offset:6144
    v_mfma_f32_16x16x32_bf16 a[48:51], a[176:179], v[208:211], a[48:51]
    v_fma_f32 v247, v247, s52, -v45
    v_cvt_pk_bf16_f32 v240, v240, v241
    v_mfma_f32_16x16x32_bf16 a[52:55], a[176:179], v[216:219], a[52:55]
    v_exp_f32 v244, v244
    v_mfma_f32_16x16x32_bf16 a[56:59], a[176:179], v[224:227], a[56:59]
    s_waitcnt vmcnt(6)
    buffer_load_dwordx4 v3, s[12:15], s57 offen offset:1024 nt lds
    v_mfma_f32_16x16x32_bf16 a[60:63], a[180:183], v[208:211], a[60:63]
    ds_read_b64_tr_b16 a[176:177], v17 offset:128
    ds_read_b64_tr_b16 a[178:179], v17 offset:6272
    v_mfma_f32_16x16x32_bf16 a[64:67], a[180:183], v[216:219], a[64:67]
    v_exp_f32 v245, v245
    v_mfma_f32_16x16x32_bf16 a[68:71], a[180:183], v[224:227], a[68:71]
    ds_read_b64_tr_b16 a[180:181], v18 offset:128
    ds_read_b64_tr_b16 a[182:183], v18 offset:6272
    v_mfma_f32_16x16x32_bf16 a[0:3], a[160:163], v[212:215], a[0:3]
    v_exp_f32 v246, v246
    v_mfma_f32_16x16x32_bf16 a[4:7], a[160:163], v[220:223], a[4:7]
    s_waitcnt vmcnt(6)
    buffer_load_dwordx4 v4, s[12:15], s57 offen offset:2048 nt lds
    v_mfma_f32_16x16x32_bf16 a[8:11], a[160:163], v[228:231], a[8:11]
    s_mov_b32 s57, 3170304
    v_exp_f32 v247, v247
    s_waitcnt lgkmcnt(4)
    v_mfma_f32_16x16x32_bf16 a[12:15], a[164:167], v[212:215], a[12:15]
    s_add_u32 m0, s51, 0
    v_fma_f32 v248, v248, s52, -v46
    v_fma_f32 v249, v249, s52, -v46
    v_mfma_f32_16x16x32_bf16 a[16:19], a[164:167], v[220:223], a[16:19]
    v_cvt_pk_bf16_f32 v241, v242, v243
    v_fma_f32 v250, v250, s52, -v46
    v_mfma_f32_16x16x32_bf16 a[20:23], a[164:167], v[228:231], a[20:23]
    v_exp_f32 v248, v248
    v_mfma_f32_16x16x32_bf16 a[24:27], a[168:171], v[212:215], a[24:27]
    v_exp_f32 v249, v249
    v_mfma_f32_16x16x32_bf16 a[28:31], a[168:171], v[220:223], a[28:31]
    v_fma_f32 v251, v251, s52, -v46
    v_cvt_pk_bf16_f32 v242, v244, v245
    v_mfma_f32_16x16x32_bf16 a[32:35], a[168:171], v[228:231], a[32:35]
    v_cvt_pk_bf16_f32 v243, v246, v247
    v_fma_f32 v252, v252, s52, -v46
    v_mfma_f32_16x16x32_bf16 a[36:39], a[172:175], v[212:215], a[36:39]
    ds_write_b128 v27, v[240:243] offset:13312
    v_mfma_f32_16x16x32_bf16 a[40:43], a[172:175], v[220:223], a[40:43]
    v_exp_f32 v250, v250
    v_mfma_f32_16x16x32_bf16 a[44:47], a[172:175], v[228:231], a[44:47]
    s_waitcnt lgkmcnt(1)
    v_exp_f32 v251, v251
    v_mfma_f32_16x16x32_bf16 a[48:51], a[176:179], v[212:215], a[48:51]
    v_fma_f32 v253, v253, s52, -v46
    v_fma_f32 v254, v254, s52, -v46
    v_mfma_f32_16x16x32_bf16 a[52:55], a[176:179], v[220:223], a[52:55]
    v_fma_f32 v255, v255, s52, -v46
    v_cvt_pk_bf16_f32 v248, v248, v249
    v_mfma_f32_16x16x32_bf16 a[56:59], a[176:179], v[228:231], a[56:59]
    v_exp_f32 v252, v252
    v_mfma_f32_16x16x32_bf16 a[60:63], a[180:183], v[212:215], a[60:63]
    v_exp_f32 v253, v253
    v_mfma_f32_16x16x32_bf16 a[64:67], a[180:183], v[220:223], a[64:67]
    v_exp_f32 v254, v254
    v_mfma_f32_16x16x32_bf16 a[68:71], a[180:183], v[228:231], a[68:71]
    v_exp_f32 v255, v255
    v_mfma_f32_16x16x32_bf16 a[144:147], a[156:159], v[232:235], a[144:147]
    v_cvt_pk_bf16_f32 v249, v250, v251
    v_cvt_pk_bf16_f32 v250, v252, v253
    v_mfma_f32_16x16x32_bf16 a[148:151], a[156:159], v[240:243], a[148:151]
    v_cvt_pk_bf16_f32 v251, v254, v255
    v_mul_u32_u24 v29, 2560, v48
    v_lshlrev_b32 v30, 2, v48
    v_mfma_f32_16x16x32_bf16 a[152:155], a[156:159], v[248:251], a[152:155]
    ds_write_b128 v27, v[248:251] offset:14336
    v_accvgpr_read_b32 v36, a144
    s_nop 1
    v_accvgpr_read_b32 v37, a148
    s_nop 2
    v_accvgpr_read_b32 v38, a152
    ds_write_b128 v31, v[36:39]
    s_waitcnt vmcnt(6) lgkmcnt(0)
    s_barrier
    ds_read_b64_tr_b16 a[160:161], v13 offset:24576
    ds_read_b64_tr_b16 a[162:163], v13 offset:30720
    ds_read_b64_tr_b16 a[164:165], v14 offset:24576
    buffer_load_dwordx4 v2, s[12:15], s57 offen nt lds
    ds_read_b64_tr_b16 a[166:167], v14 offset:30720
    ds_read_b64_tr_b16 a[168:169], v15 offset:24576
    ds_read_b64_tr_b16 a[170:171], v15 offset:30720
    ds_read_b64_tr_b16 a[172:173], v16 offset:24576
    ds_read_b64_tr_b16 a[174:175], v16 offset:30720
    ds_read_b64_tr_b16 a[176:177], v13 offset:24704
    ds_read_b64_tr_b16 a[178:179], v13 offset:30848
    ds_read_b64_tr_b16 a[180:181], v14 offset:24704
    ds_read_b64_tr_b16 a[182:183], v14 offset:30848
    s_waitcnt vmcnt(6)
    buffer_load_dwordx4 v3, s[12:15], s57 offen offset:1024 nt lds
    ds_read_b128 v[236:239], v28 offset:12288
    s_waitcnt lgkmcnt(11)
    v_mfma_f32_16x16x32_bf16 a[0:3], a[160:163], v[232:235], a[0:3]
    ds_read_b128 v[244:247], v28 offset:13312
    v_mfma_f32_16x16x32_bf16 a[4:7], a[160:163], v[240:243], a[4:7]
    ds_read_b128 v[252:255], v28 offset:14336
    v_mfma_f32_16x16x32_bf16 a[8:11], a[160:163], v[248:251], a[8:11]
    s_waitcnt lgkmcnt(9)
    ds_read_b64_tr_b16 a[160:161], v17 offset:24576
    ds_read_b64_tr_b16 a[162:163], v17 offset:30720
    v_mfma_f32_16x16x32_bf16 a[12:15], a[164:167], v[232:235], a[12:15]
    s_waitcnt vmcnt(6)
    buffer_load_dwordx4 v4, s[12:15], s57 offen offset:2048 nt lds
    v_mfma_f32_16x16x32_bf16 a[16:19], a[164:167], v[240:243], a[16:19]
    s_mov_b32 s57, 3182592
    ds_read_b128 v[40:43], v32
    s_add_u32 m0, s51, 12288
    v_mfma_f32_16x16x32_bf16 a[20:23], a[164:167], v[248:251], a[20:23]
    ds_read_b64_tr_b16 a[164:165], v18 offset:24576
    ds_read_b64_tr_b16 a[166:167], v18 offset:30720
    v_mfma_f32_16x16x32_bf16 a[24:27], a[168:171], v[232:235], a[24:27]
    v_mfma_f32_16x16x32_bf16 a[28:31], a[168:171], v[240:243], a[28:31]
    v_mfma_f32_16x16x32_bf16 a[32:35], a[168:171], v[248:251], a[32:35]
    s_waitcnt lgkmcnt(5)
    s_waitcnt vmcnt(6)
    buffer_load_dwordx4 v2, s[12:15], s57 offen nt lds
    v_mfma_f32_16x16x32_bf16 a[36:39], a[172:175], v[232:235], a[36:39]
    ds_read_b64_tr_b16 a[168:169], v19 offset:24576
    ds_read_b64_tr_b16 a[170:171], v19 offset:30720
    v_mfma_f32_16x16x32_bf16 a[40:43], a[172:175], v[240:243], a[40:43]
    s_waitcnt lgkmcnt(4)
    v_add_f32 v52, v36, v40
    v_add_f32 v53, v37, v41
    v_mfma_f32_16x16x32_bf16 a[44:47], a[172:175], v[248:251], a[44:47]
    ds_read_b64_tr_b16 a[172:173], v20 offset:24576
    ds_read_b64_tr_b16 a[174:175], v20 offset:30720
    v_mfma_f32_16x16x32_bf16 a[48:51], a[176:179], v[232:235], a[48:51]
    v_add_f32 v54, v38, v42
    v_rcp_f32 v52, v52
    v_mfma_f32_16x16x32_bf16 a[52:55], a[176:179], v[240:243], a[52:55]
    s_waitcnt vmcnt(6)
    buffer_load_dwordx4 v3, s[12:15], s57 offen offset:1024 nt lds
    v_mfma_f32_16x16x32_bf16 a[56:59], a[176:179], v[248:251], a[56:59]
    ds_read_b64_tr_b16 a[176:177], v17 offset:24704
    ds_read_b64_tr_b16 a[178:179], v17 offset:30848
    v_mfma_f32_16x16x32_bf16 a[60:63], a[180:183], v[232:235], a[60:63]
    v_rcp_f32 v53, v53
    v_mfma_f32_16x16x32_bf16 a[64:67], a[180:183], v[240:243], a[64:67]
    v_rcp_f32 v54, v54
    v_mfma_f32_16x16x32_bf16 a[68:71], a[180:183], v[248:251], a[68:71]
    ds_read_b64_tr_b16 a[180:181], v18 offset:24704
    ds_read_b64_tr_b16 a[182:183], v18 offset:30848
    v_mfma_f32_16x16x32_bf16 a[0:3], a[160:163], v[236:239], a[0:3]
    s_waitcnt vmcnt(6)
    buffer_load_dwordx4 v4, s[12:15], s57 offen offset:2048 nt lds
    v_mfma_f32_16x16x32_bf16 a[4:7], a[160:163], v[244:247], a[4:7]
    s_mov_b32 s57, 3194880
    s_add_u32 m0, s51, 24576
    v_mfma_f32_16x16x32_bf16 a[8:11], a[160:163], v[252:255], a[8:11]
    s_waitcnt lgkmcnt(4)
    v_mfma_f32_16x16x32_bf16 a[12:15], a[164:167], v[236:239], a[12:15]
    v_accvgpr_read_b32 v184, a0
    v_accvgpr_read_b32 v185, a1
    v_mfma_f32_16x16x32_bf16 a[16:19], a[164:167], v[244:247], a[16:19]
    v_accvgpr_read_b32 v192, a4
    v_accvgpr_read_b32 v193, a5
    v_mfma_f32_16x16x32_bf16 a[20:23], a[164:167], v[252:255], a[20:23]
    v_accvgpr_read_b32 v200, a8
    v_accvgpr_read_b32 v201, a9
    v_mfma_f32_16x16x32_bf16 a[24:27], a[168:171], v[236:239], a[24:27]
    s_waitcnt vmcnt(6) lgkmcnt(0)
    s_barrier
    ds_read_b128 a[160:163], v11 offset:49152
    v_mfma_f32_16x16x32_bf16 a[28:31], a[168:171], v[244:247], a[28:31]
    ds_read_b128 a[164:167], v12 offset:49152
    v_mul_f32 v184, v52, v184
    v_mfma_f32_16x16x32_bf16 a[32:35], a[168:171], v[252:255], a[32:35]
    ds_read_b128 a[168:171], v11 offset:49280
    v_mul_f32 v185, v52, v185
    v_mfma_f32_16x16x32_bf16 a[36:39], a[172:175], v[236:239], a[36:39]
    buffer_load_dwordx4 v2, s[12:15], s57 offen nt lds
    v_mfma_f32_16x16x32_bf16 a[40:43], a[172:175], v[244:247], a[40:43]
    v_accvgpr_read_b32 v208, a24
    v_accvgpr_read_b32 v209, a25
    v_mfma_f32_16x16x32_bf16 a[44:47], a[172:175], v[252:255], a[44:47]
    ds_read_b128 a[172:175], v12 offset:49280
    v_accvgpr_read_b32 v216, a28
    v_mfma_f32_16x16x32_bf16 a[48:51], a[176:179], v[236:239], a[48:51]
    s_waitcnt vmcnt(6)
    buffer_load_dwordx4 v3, s[12:15], s57 offen offset:1024 nt lds
    v_mfma_f32_16x16x32_bf16 a[52:55], a[176:179], v[244:247], a[52:55]
    v_accvgpr_read_b32 v217, a29
    v_accvgpr_read_b32 v224, a32
    v_mfma_f32_16x16x32_bf16 a[56:59], a[176:179], v[252:255], a[56:59]
    ds_read_b128 a[176:179], v11 offset:49408
    v_accvgpr_read_b32 v225, a33
    v_mfma_f32_16x16x32_bf16 a[60:63], a[180:183], v[236:239], a[60:63]
    s_waitcnt vmcnt(6)
    buffer_load_dwordx4 v4, s[12:15], s57 offen offset:2048 nt lds
    v_mfma_f32_16x16x32_bf16 a[64:67], a[180:183], v[244:247], a[64:67]
    s_mov_b32 s57, 3207168
    s_add_u32 m0, s51, 36864
    v_accvgpr_read_b32 v232, a48
    v_mfma_f32_16x16x32_bf16 a[68:71], a[180:183], v[252:255], a[68:71]
    s_waitcnt lgkmcnt(2)
    ds_read_b128 a[180:183], v12 offset:49408
    v_accvgpr_read_b32 v233, a49
    v_mfma_f32_16x16x32_bf16 v[64:67], a[160:163], a[72:75], 0
    s_waitcnt vmcnt(6)
    buffer_load_dwordx4 v2, s[12:15], s57 offen nt lds
    v_mfma_f32_16x16x32_bf16 v[72:75], a[160:163], a[76:79], 0
    v_accvgpr_read_b32 v240, a52
    v_accvgpr_read_b32 v241, a53
    v_mfma_f32_16x16x32_bf16 v[80:83], a[160:163], a[80:83], 0
    ds_read_b128 a[160:163], v11 offset:55296
    v_accvgpr_read_b32 v248, a56
    v_mfma_f32_16x16x32_bf16 v[64:67], a[164:167], a[84:87], v[64:67]
    s_waitcnt vmcnt(6)
    buffer_load_dwordx4 v3, s[12:15], s57 offen offset:1024 nt lds
    v_mfma_f32_16x16x32_bf16 v[72:75], a[164:167], a[88:91], v[72:75]
    v_accvgpr_read_b32 v249, a57
    v_accvgpr_read_b32 v186, a2
    v_mfma_f32_16x16x32_bf16 v[80:83], a[164:167], a[92:95], v[80:83]
    ds_read_b128 a[164:167], v12 offset:55296
    v_accvgpr_read_b32 v187, a3
    v_mfma_f32_16x16x32_bf16 v[64:67], a[168:171], a[96:99], v[64:67]
    s_waitcnt vmcnt(6)
    buffer_load_dwordx4 v4, s[12:15], s57 offen offset:2048 nt lds
    v_mfma_f32_16x16x32_bf16 v[72:75], a[168:171], a[100:103], v[72:75]
    s_add_u32 m0, s51, 73728
    s_sub_u32 s57, s45, 1280
    s_cselect_b32 s45, s45, s57
    v_mfma_f32_16x16x32_bf16 v[80:83], a[168:171], a[104:107], v[80:83]
    s_add_u32 s57, s45, 0
    ds_read_b128 a[168:171], v11 offset:55424
    v_mul_f32 v192, v53, v192
    s_waitcnt lgkmcnt(2)
    v_mfma_f32_16x16x32_bf16 v[64:67], a[172:175], a[108:111], v[64:67]
    s_add_u32 s45, s44, 1024
    s_waitcnt vmcnt(6)
    buffer_load_dwordx4 v8, s[24:27], s57 offen lds
    v_mfma_f32_16x16x32_bf16 v[72:75], a[172:175], a[112:115], v[72:75]
    v_mul_f32 v193, v53, v193
    v_accvgpr_read_b32 v194, a6
    v_mfma_f32_16x16x32_bf16 v[80:83], a[172:175], a[116:119], v[80:83]
    ds_read_b128 a[172:175], v12 offset:55424
    v_accvgpr_read_b32 v195, a7
    v_mfma_f32_16x16x32_bf16 v[64:67], a[176:179], a[120:123], v[64:67]
    s_waitcnt vmcnt(6)
    buffer_load_dwordx4 v9, s[24:27], s57 offen offset:1024 lds
    v_mfma_f32_16x16x32_bf16 v[72:75], a[176:179], a[124:127], v[72:75]
    v_mul_f32 v200, v54, v200
    v_mul_f32 v201, v54, v201
    v_mfma_f32_16x16x32_bf16 v[80:83], a[176:179], a[128:131], v[80:83]
    ds_read_b128 a[176:179], v11 offset:55552
    v_accvgpr_read_b32 v202, a10
    v_mfma_f32_16x16x32_bf16 v[64:67], a[180:183], a[132:135], v[64:67]
    s_waitcnt vmcnt(6)
    buffer_load_dwordx4 v10, s[24:27], s57 offen offset:2048 lds
    v_mfma_f32_16x16x32_bf16 v[72:75], a[180:183], a[136:139], v[72:75]
    s_add_u32 m0, s51, 86016
    v_accvgpr_read_b32 v203, a11
    v_mul_f32 v208, v52, v208
    v_mfma_f32_16x16x32_bf16 v[80:83], a[180:183], a[140:143], v[80:83]
    ds_read_b128 a[180:183], v12 offset:55552
    v_mul_f32 v209, v52, v209
    v_mfma_f32_16x16x32_bf16 v[68:71], a[160:163], a[72:75], 0
    v_accvgpr_read_b32 v210, a26
    v_accvgpr_read_b32 v211, a27
    v_mfma_f32_16x16x32_bf16 v[76:79], a[160:163], a[76:79], 0
    v_mul_f32 v216, v53, v216
    v_mul_f32 v217, v53, v217
    v_mfma_f32_16x16x32_bf16 v[84:87], a[160:163], a[80:83], 0
    s_waitcnt lgkmcnt(2)
    v_accvgpr_read_b32 v218, a30
    v_accvgpr_read_b32 v219, a31
    v_mfma_f32_16x16x32_bf16 v[68:71], a[164:167], a[84:87], v[68:71]
    v_mul_f32 v224, v54, v224
    v_mul_f32 v225, v54, v225
    v_mfma_f32_16x16x32_bf16 v[76:79], a[164:167], a[88:91], v[76:79]
    v_accvgpr_read_b32 v226, a34
    v_accvgpr_read_b32 v227, a35
    v_mfma_f32_16x16x32_bf16 v[84:87], a[164:167], a[92:95], v[84:87]
    v_mul_f32 v232, v52, v232
    v_mul_f32 v233, v52, v233
    v_mfma_f32_16x16x32_bf16 v[68:71], a[168:171], a[96:99], v[68:71]
    v_accvgpr_read_b32 v234, a50
    v_accvgpr_read_b32 v235, a51
    v_mfma_f32_16x16x32_bf16 v[76:79], a[168:171], a[100:103], v[76:79]
    v_mul_f32 v240, v53, v240
    v_mul_f32 v241, v53, v241
    v_mfma_f32_16x16x32_bf16 v[84:87], a[168:171], a[104:107], v[84:87]
    v_accvgpr_read_b32 v242, a54
    v_accvgpr_read_b32 v243, a55
    v_mfma_f32_16x16x32_bf16 v[68:71], a[172:175], a[108:111], v[68:71]
    v_mul_f32 v248, v54, v248
    v_mul_f32 v249, v54, v249
    v_mfma_f32_16x16x32_bf16 v[76:79], a[172:175], a[112:115], v[76:79]
    v_accvgpr_read_b32 v250, a58
    v_accvgpr_read_b32 v251, a59
    v_mfma_f32_16x16x32_bf16 v[84:87], a[172:175], a[116:119], v[84:87]
    s_waitcnt lgkmcnt(0)
    v_mul_f32 v186, v52, v186
    v_mul_f32 v187, v52, v187
    v_mfma_f32_16x16x32_bf16 v[68:71], a[176:179], a[120:123], v[68:71]
    v_accvgpr_read_b32 v188, a12
    v_accvgpr_read_b32 v189, a13
    v_mfma_f32_16x16x32_bf16 v[76:79], a[176:179], a[124:127], v[76:79]
    v_accvgpr_read_b32 v190, a14
    v_accvgpr_read_b32 v191, a15
    v_mfma_f32_16x16x32_bf16 v[84:87], a[176:179], a[128:131], v[84:87]
    v_cvt_pk_bf16_f32 v184, v184, v185
    v_mul_f32 v194, v53, v194
    v_mfma_f32_16x16x32_bf16 v[68:71], a[180:183], a[132:135], v[68:71]
    v_mul_f32 v195, v53, v195
    v_accvgpr_read_b32 v196, a16
    v_mfma_f32_16x16x32_bf16 v[76:79], a[180:183], a[136:139], v[76:79]
    v_accvgpr_read_b32 v197, a17
    v_accvgpr_read_b32 v198, a18
    v_mfma_f32_16x16x32_bf16 v[84:87], a[180:183], a[140:143], v[84:87]
    v_accvgpr_read_b32 v199, a19
    v_cvt_pk_bf16_f32 v192, v192, v193
    v_mul_f32 v202, v54, v202
    v_mul_f32 v203, v54, v203
    v_accvgpr_read_b32 v204, a20
    v_accvgpr_read_b32 v205, a21
    v_accvgpr_read_b32 v206, a22
    v_accvgpr_read_b32 v207, a23
    v_cvt_pk_bf16_f32 v200, v200, v201
    v_mul_f32 v210, v52, v210
    v_mul_f32 v211, v52, v211
    v_accvgpr_read_b32 v212, a36
    v_accvgpr_read_b32 v213, a37
    v_accvgpr_read_b32 v214, a38
    v_accvgpr_read_b32 v215, a39
    v_cvt_pk_bf16_f32 v208, v208, v209
    v_mul_f32 v218, v53, v218
    v_mul_f32 v219, v53, v219
    v_accvgpr_read_b32 v220, a40
    v_accvgpr_read_b32 v221, a41
    v_accvgpr_read_b32 v222, a42
    v_accvgpr_read_b32 v223, a43
    v_cvt_pk_bf16_f32 v216, v216, v217
    v_mul_f32 v226, v54, v226
    v_mul_f32 v227, v54, v227
    v_accvgpr_read_b32 v228, a44
    v_accvgpr_read_b32 v229, a45
    v_accvgpr_read_b32 v230, a46
    v_accvgpr_read_b32 v231, a47
    v_cvt_pk_bf16_f32 v224, v224, v225
    v_mul_f32 v234, v52, v234
    v_mul_f32 v235, v52, v235
    v_accvgpr_read_b32 v236, a60
    v_accvgpr_read_b32 v237, a61
    v_accvgpr_read_b32 v238, a62
    v_accvgpr_read_b32 v239, a63
    v_cvt_pk_bf16_f32 v232, v232, v233
    v_mul_f32 v242, v53, v242
    v_mul_f32 v243, v53, v243
    v_accvgpr_read_b32 v244, a64
    v_accvgpr_read_b32 v245, a65
    v_accvgpr_read_b32 v246, a66
    v_accvgpr_read_b32 v247, a67
    v_cvt_pk_bf16_f32 v240, v240, v241
    v_mul_f32 v250, v54, v250
    v_mul_f32 v251, v54, v251
    v_accvgpr_read_b32 v252, a68
    v_accvgpr_read_b32 v253, a69
    v_accvgpr_read_b32 v254, a70
    v_accvgpr_read_b32 v255, a71
    v_cvt_pk_bf16_f32 v248, v248, v249
    v_mul_f32 v188, v52, v188
    v_mul_f32 v189, v52, v189
    v_mul_f32 v190, v52, v190
    v_mul_f32 v191, v52, v191
    v_cvt_pk_bf16_f32 v185, v186, v187
    v_mul_f32 v196, v53, v196
    v_mul_f32 v197, v53, v197
    v_mul_f32 v198, v53, v198
    v_mul_f32 v199, v53, v199
    v_cvt_pk_bf16_f32 v193, v194, v195
    v_mul_f32 v204, v54, v204
    v_mul_f32 v205, v54, v205
    v_mul_f32 v206, v54, v206
    v_mul_f32 v207, v54, v207
    v_cvt_pk_bf16_f32 v201, v202, v203
    v_mul_f32 v212, v52, v212
    v_mul_f32 v213, v52, v213
    v_mul_f32 v214, v52, v214
    v_mul_f32 v215, v52, v215
    v_cvt_pk_bf16_f32 v209, v210, v211
    v_mul_f32 v220, v53, v220
    v_mul_f32 v221, v53, v221
    v_mul_f32 v222, v53, v222
    v_mul_f32 v223, v53, v223
    v_cvt_pk_bf16_f32 v217, v218, v219
    v_mul_f32 v228, v54, v228
    v_mul_f32 v229, v54, v229
    v_mul_f32 v230, v54, v230
    v_mul_f32 v231, v54, v231
    v_cvt_pk_bf16_f32 v225, v226, v227
    v_mul_f32 v236, v52, v236
    v_mul_f32 v237, v52, v237
    v_mul_f32 v238, v52, v238
    v_mul_f32 v239, v52, v239
    v_cvt_pk_bf16_f32 v233, v234, v235
    v_mul_f32 v244, v53, v244
    v_mul_f32 v245, v53, v245
    v_mul_f32 v246, v53, v246
    v_mul_f32 v247, v53, v247
    v_cvt_pk_bf16_f32 v241, v242, v243
    v_mul_f32 v252, v54, v252
    v_mul_f32 v253, v54, v253
    v_mul_f32 v254, v54, v254
    v_mul_f32 v255, v54, v255
    v_cvt_pk_bf16_f32 v249, v250, v251
    v_cvt_pk_bf16_f32 v186, v188, v189
    v_cvt_pk_bf16_f32 v187, v190, v191
    v_cvt_pk_bf16_f32 v194, v196, v197
    v_cvt_pk_bf16_f32 v195, v198, v199
    v_cvt_pk_bf16_f32 v202, v204, v205
    v_cvt_pk_bf16_f32 v203, v206, v207
    v_cvt_pk_bf16_f32 v210, v212, v213
    v_cvt_pk_bf16_f32 v211, v214, v215
    v_cvt_pk_bf16_f32 v218, v220, v221
    v_cvt_pk_bf16_f32 v219, v222, v223
    v_cvt_pk_bf16_f32 v226, v228, v229
    v_cvt_pk_bf16_f32 v227, v230, v231
    v_cvt_pk_bf16_f32 v234, v236, v237
    v_cvt_pk_bf16_f32 v235, v238, v239
    v_cvt_pk_bf16_f32 v242, v244, v245
    v_cvt_pk_bf16_f32 v243, v246, v247
    v_cvt_pk_bf16_f32 v250, v252, v253
    v_cvt_pk_bf16_f32 v251, v254, v255
    ds_write_b128 v33, v[184:187] offset:24576
    v_max3_f32 v36, v64, v65, v66
    v_max3_f32 v37, v72, v73, v74
    v_max3_f32 v38, v80, v81, v82
    v_max_f32 v36, v36, v67
    v_max_f32 v37, v37, v75
    v_max_f32 v38, v38, v83
    ds_write_b128 v33, v[192:195] offset:25600
    s_sub_u32 s57, s45, 1280
    s_cselect_b32 s45, s45, s57
    s_add_u32 s57, s45, 122880
    v_max3_f32 v36, v36, v68, v69
    v_max3_f32 v37, v37, v76, v77
    v_max3_f32 v38, v38, v84, v85
    ds_write_b128 v33, v[200:203] offset:26624
    v_max3_f32 v36, v36, v70, v71
    v_max3_f32 v37, v37, v78, v79
    v_max3_f32 v38, v38, v86, v87
    s_add_u32 s45, s44, 896
    ds_write_b128 v33, v[208:211] offset:30720
    ds_write_b128 v33, v[216:219] offset:31744
    ds_write_b128 v33, v[224:227] offset:32768
    ds_write_b128 v33, v[232:235] offset:36864
    ds_write_b128 v33, v[240:243] offset:37888
    ds_write_b128 v33, v[248:251] offset:38912
    s_waitcnt lgkmcnt(0)
    s_barrier
    ds_read_b128 a[160:163], v11 offset:0
    s_waitcnt vmcnt(6)
    buffer_load_dwordx4 v8, s[24:27], s57 offen lds
    ds_read_b128 a[164:167], v12 offset:0
    s_getpc_b64 s[6:7]
LA_pc0:
    s_mov_b32 s58, LA_code_end-LA_pc0-4
    v_min_u32 v62, s58, v62
    v_mov_b32 v63, s7
    v_add_co_u32 v62, vcc, s6, v62
    s_nop 1
    v_addc_co_u32 v63, vcc, 0, v63, vcc
    ds_read_b128 a[168:171], v11 offset:128
    s_waitcnt vmcnt(6)
    buffer_load_dwordx4 v9, s[24:27], s57 offen offset:1024 lds
    ds_read_b128 a[172:175], v12 offset:128
    global_load_dword v43, v[62:63], off
    ds_read_b128 a[176:179], v11 offset:256
    s_mul_i32 s58, s48, 3072
    v_add_u32 v5, s58, v1
    s_waitcnt lgkmcnt(4)
    v_mfma_f32_16x16x32_bf16 v[88:91], a[160:163], a[72:75], 0
    s_add_u32 s58, s64, 0
    ds_read_b128 a[180:183], v12 offset:256
    s_mul_i32 s59, s58, 171
    v_mfma_f32_16x16x32_bf16 v[96:99], a[160:163], a[76:79], 0
    s_lshr_b32 s59, s59, 9
    s_waitcnt vmcnt(6)
    buffer_load_dwordx4 v10, s[24:27], s57 offen offset:2048 lds
    v_mfma_f32_16x16x32_bf16 v[104:107], a[160:163], a[80:83], 0
    s_mov_b32 s57, 3219456
    ds_read_b128 a[160:163], v11 offset:6144
    s_add_u32 m0, s51, 49152
    s_waitcnt lgkmcnt(5)
    v_mfma_f32_16x16x32_bf16 v[88:91], a[164:167], a[84:87], v[88:91]
    s_mul_i32 s59, s59, 9
    ds_read_b128 a[0:3], v35 offset:24576
    s_add_u32 s58, s58, s59
    v_mfma_f32_16x16x32_bf16 v[96:99], a[164:167], a[88:91], v[96:99]
    s_mul_i32 s59, s48, 3
    s_waitcnt vmcnt(6)
    buffer_load_dwordx4 v2, s[12:15], s57 offen nt lds
    v_mfma_f32_16x16x32_bf16 v[104:107], a[164:167], a[92:95], v[104:107]
    s_add_u32 s58, s58, s59
    ds_read_b128 a[164:167], v12 offset:6144
    s_mul_i32 s59, s58, 171
    s_waitcnt lgkmcnt(4)
    v_mfma_f32_16x16x32_bf16 v[88:91], a[168:171], a[96:99], v[88:91]
    s_lshr_b32 s59, s59, 9
    ds_read_b128 a[4:7], v35 offset:25600
    s_mul_i32 s8, s58, 1024
    v_mfma_f32_16x16x32_bf16 v[96:99], a[168:171], a[100:103], v[96:99]
    s_mul_i32 s60, s59, 3
    s_waitcnt vmcnt(6)
    buffer_load_dwordx4 v3, s[12:15], s57 offen offset:1024 nt lds
    v_mfma_f32_16x16x32_bf16 v[104:107], a[168:171], a[104:107], v[104:107]
    s_sub_u32 s58, s58, s60
    ds_read_b128 a[168:171], v11 offset:6272
    s_and_b32 s60, s59, 3
    v_mfma_f32_16x16x32_bf16 v[88:91], a[172:175], a[108:111], v[88:91]
    s_lshl_b32 s9, s60, 6
    ds_read_b128 a[8:11], v35 offset:26624
    s_lshr_b32 s10, s60, 1
    v_mfma_f32_16x16x32_bf16 v[96:99], a[172:175], a[112:115], v[96:99]
    s_and_b32 s60, s60, 1
    s_waitcnt vmcnt(6)
    buffer_load_dwordx4 v4, s[12:15], s57 offen offset:2048 nt lds
    v_mfma_f32_16x16x32_bf16 v[104:107], a[172:175], a[116:119], v[104:107]
    s_mov_b32 s57, 3231744
    ds_read_b128 a[172:175], v12 offset:6272
    s_add_u32 m0, s51, 61440
    v_mfma_f32_16x16x32_bf16 v[88:91], a[176:179], a[120:123], v[88:91]
    s_mul_i32 s10, s10, 122880
    ds_read_b128 a[12:15], v35 offset:30720
    s_lshl_b32 s60, s60, 6
    v_mfma_f32_16x16x32_bf16 v[96:99], a[176:179], a[124:127], v[96:99]
    s_add_u32 s10, s10, s60
    s_waitcnt vmcnt(6)
    buffer_load_dwordx4 v2, s[12:15], s57 offen nt lds
    v_mfma_f32_16x16x32_bf16 v[104:107], a[176:179], a[128:131], v[104:107]
    s_lshr_b32 s59, s59, 2
    ds_read_b128 a[176:179], v11 offset:6400
    s_mul_i32 s60, s58, 40960
    s_waitcnt lgkmcnt(4)
    v_mfma_f32_16x16x32_bf16 v[88:91], a[180:183], a[132:135], v[88:91]
    s_lshl_b32 s59, s59, 7
    ds_read_b128 a[16:19], v35 offset:31744
    s_add_u32 s10, s10, s60
    v_mfma_f32_16x16x32_bf16 v[96:99], a[180:183], a[136:139], v[96:99]
    s_add_u32 s59, s59, s44
    s_waitcnt vmcnt(6)
    buffer_load_dwordx4 v3, s[12:15], s57 offen offset:1024 nt lds
    v_mfma_f32_16x16x32_bf16 v[104:107], a[180:183], a[140:143], v[104:107]
    s_add_u32 s58, s64, 16
    ds_read_b128 a[180:183], v12 offset:6400
    s_add_u32 s9, s9, 1966080
    v_mfma_f32_16x16x32_bf16 v[92:95], a[160:163], a[72:75], 0
    ds_read_b128 a[20:23], v35 offset:32768
    v_max3_f32 v36, v36, v88, v89
    v_mfma_f32_16x16x32_bf16 v[100:103], a[160:163], a[76:79], 0
    s_waitcnt vmcnt(6)
    buffer_load_dwordx4 v4, s[12:15], s57 offen offset:2048 nt lds
    v_mfma_f32_16x16x32_bf16 v[108:111], a[160:163], a[80:83], 0
    s_mov_b32 s57, 3244032
    ds_read_b128 a[24:27], v35 offset:36864
    v_max3_f32 v37, v37, v96, v97
    v_mfma_f32_16x16x32_bf16 v[92:95], a[164:167], a[84:87], v[92:95]
    s_add_u32 m0, s51, 0
    ds_read_b128 a[28:31], v35 offset:37888
    v_max3_f32 v38, v38, v104, v105
    v_mfma_f32_16x16x32_bf16 v[100:103], a[164:167], a[88:91], v[100:103]
    ds_read_b128 a[32:35], v35 offset:38912
    v_max3_f32 v36, v36, v90, v91
    v_mfma_f32_16x16x32_bf16 v[108:111], a[164:167], a[92:95], v[108:111]
    ds_read_b128 a[36:39], v35 offset:43008
    v_max3_f32 v37, v37, v98, v99
    v_mfma_f32_16x16x32_bf16 v[92:95], a[168:171], a[96:99], v[92:95]
    ds_read_b128 a[40:43], v35 offset:44032
    v_max3_f32 v38, v38, v106, v107
    v_mfma_f32_16x16x32_bf16 v[100:103], a[168:171], a[100:103], v[100:103]
    ds_read_b128 a[44:47], v35 offset:45056
    v_mul_u32_u24 v63, 410, v34
    v_mfma_f32_16x16x32_bf16 v[108:111], a[168:171], a[104:107], v[108:111]
    s_waitcnt lgkmcnt(6)
    ds_read_b128 a[48:51], v35 offset:49152
    v_lshrrev_b32 v63, 12, v63
    v_mfma_f32_16x16x32_bf16 v[92:95], a[172:175], a[108:111], v[92:95]
    ds_read_b128 a[52:55], v35 offset:50176
    v_mul_u32_u24 v62, 0, v63
    v_mfma_f32_16x16x32_bf16 v[100:103], a[172:175], a[112:115], v[100:103]
    ds_read_b128 a[56:59], v35 offset:51200
    v_lshl_add_u32 v62, v34, 7, v62
    v_mfma_f32_16x16x32_bf16 v[108:111], a[172:175], a[116:119], v[108:111]
    ds_read_b128 a[60:63], v35 offset:55296
    v_bfrev_b32 v63, 1
    v_mfma_f32_16x16x32_bf16 v[92:95], a[176:179], a[120:123], v[92:95]
    ds_read_b128 a[64:67], v35 offset:56320
    s_sub_u32 s60, s59, 1280
    s_cselect_b32 s59, s59, s60
    v_mfma_f32_16x16x32_bf16 v[100:103], a[176:179], a[124:127], v[100:103]
    s_add_u32 s10, s10, s59
    ds_read_b128 a[68:71], v35 offset:57344
    s_mul_i32 s59, s58, 171
    v_mfma_f32_16x16x32_bf16 v[108:111], a[176:179], a[128:131], v[108:111]
    s_lshr_b32 s59, s59, 9
    s_mul_i32 s59, s59, 9
    s_add_u32 s58, s58, s59
    v_mfma_f32_16x16x32_bf16 v[92:95], a[180:183], a[132:135], v[92:95]
    s_mul_i32 s59, s48, 3
    s_add_u32 s58, s58, s59
    s_mul_i32 s59, s58, 171
    v_mfma_f32_16x16x32_bf16 v[100:103], a[180:183], a[136:139], v[100:103]
    s_lshr_b32 s59, s59, 9
    s_mul_i32 s20, s58, 1024
    s_mul_i32 s60, s59, 3
    v_mfma_f32_16x16x32_bf16 v[108:111], a[180:183], a[140:143], v[108:111]
    s_sub_u32 s58, s58, s60
    s_and_b32 s60, s59, 3
    s_lshl_b32 s21, s60, 6
    v_max3_f32 v36, v36, v92, v93
    v_max3_f32 v36, v36, v94, v95
    s_lshr_b32 s22, s60, 1
    s_and_b32 s60, s60, 1
    v_max3_f32 v37, v37, v100, v101
    s_waitcnt vmcnt(6) lgkmcnt(0)
    s_barrier
    ds_read_b128 a[160:163], v11 offset:24576
    buffer_load_dwordx4 v2, s[12:15], s57 offen nt lds
    ds_read_b128 a[164:167], v12 offset:24576
    v_max3_f32 v38, v38, v108, v109
    v_max3_f32 v37, v37, v102, v103
    ds_read_b128 a[168:171], v11 offset:24704
    v_max3_f32 v38, v38, v110, v111
    ds_read_b128 a[172:175], v12 offset:24704
    buffer_load_dwordx4 v[56:59], off, s[40:43], 0 sc1
    ds_read_b128 a[176:179], v11 offset:24832
    s_mul_i32 s22, s22, 122880
    s_lshl_b32 s60, s60, 6
    ds_read_b128 a[180:183], v12 offset:24832
    s_waitcnt vmcnt(6)
    buffer_load_dwordx4 v3, s[12:15], s57 offen offset:1024 nt lds
    s_add_u32 s22, s22, s60
    ds_read_b64_tr_b16 a[184:185], v23 offset:24576
    s_waitcnt lgkmcnt(6)
    v_mfma_f32_16x16x32_bf16 v[112:115], a[160:163], a[72:75], 0
    s_lshr_b32 s59, s59, 2
    ds_read_b64_tr_b16 a[186:187], v23 offset:26624
    ds_read_b64_tr_b16 a[188:189], v24 offset:24576
    v_mfma_f32_16x16x32_bf16 v[120:123], a[160:163], a[76:79], 0
    s_mul_i32 s60, s58, 40960
    ds_read_b64_tr_b16 a[190:191], v24 offset:26624
    ds_read_b64_tr_b16 a[192:193], v23 offset:28672
    v_mfma_f32_16x16x32_bf16 v[128:131], a[160:163], a[80:83], 0
    s_lshl_b32 s59, s59, 7
    ds_read_b128 a[160:163], v11 offset:30720
    s_add_u32 s22, s22, s60
    s_waitcnt lgkmcnt(8)
    v_mfma_f32_16x16x32_bf16 v[112:115], a[164:167], a[84:87], v[112:115]
    s_add_u32 s59, s59, s44
    s_waitcnt vmcnt(6)
    buffer_load_dwordx4 v4, s[12:15], s57 offen offset:2048 nt lds
    v_mfma_f32_16x16x32_bf16 v[120:123], a[164:167], a[88:91], v[120:123]
    s_mov_b32 s57, 3256320
    s_add_u32 m0, s51, 12288
    ds_read_b64_tr_b16 a[194:195], v23 offset:30720
    v_mfma_f32_16x16x32_bf16 v[128:131], a[164:167], a[92:95], v[128:131]
    s_add_u32 s21, s21, 1966336
    ds_read_b128 a[164:167], v12 offset:30720
    s_lshl_b32 s58, s55, 2
    v_mfma_f32_16x16x32_bf16 v[112:115], a[168:171], a[96:99], v[112:115]
    s_add_u32 s58, s58, s48
    ds_read_b64_tr_b16 a[196:197], v24 offset:28672
    ds_read_b64_tr_b16 a[198:199], v24 offset:30720
    v_mfma_f32_16x16x32_bf16 v[120:123], a[168:171], a[100:103], v[120:123]
    s_mul_i32 s58, s58, 7680
    ds_read_b64_tr_b16 a[200:201], v23 offset:32768
    ds_read_b64_tr_b16 a[202:203], v23 offset:34816
    v_mfma_f32_16x16x32_bf16 v[128:131], a[168:171], a[104:107], v[128:131]
    s_add_u32 s66, s58, 3932160
    s_waitcnt vmcnt(6)
    buffer_load_dwordx4 v2, s[12:15], s57 offen nt lds
    v_mfma_f32_16x16x32_bf16 v[112:115], a[172:175], a[108:111], v[112:115]
    ds_read_b128 a[168:171], v11 offset:30848
    s_sub_u32 s60, s59, 1280
    s_cselect_b32 s59, s59, s60
    v_mfma_f32_16x16x32_bf16 v[120:123], a[172:175], a[112:115], v[120:123]
    s_add_u32 s22, s22, s59
    ds_read_b64_tr_b16 a[204:205], v24 offset:32768
    ds_read_b64_tr_b16 a[206:207], v24 offset:34816
    v_mfma_f32_16x16x32_bf16 v[128:131], a[172:175], a[116:119], v[128:131]
    s_waitcnt lgkmcnt(7)
    ds_read_b128 a[172:175], v12 offset:30848
    s_cmp_ge_u32 s20, 122880
    s_cselect_b32 s21, s9, s21
    s_cselect_b32 s22, 0x40000000, s22
    s_cselect_b32 s20, s8, s20
    s_cselect_b32 s23, 0x40000000, 0
    v_mfma_f32_16x16x32_bf16 v[112:115], a[176:179], a[120:123], v[112:115]
    s_mov_b32 s9, 1966080
    s_waitcnt vmcnt(6)
    buffer_load_dwordx4 v3, s[12:15], s57 offen offset:1024 nt lds
    v_mfma_f32_16x16x32_bf16 v[120:123], a[176:179], a[124:127], v[120:123]
    s_mov_b32 s21, 1966336
    s_cmp_eq_u32 s48, 0
    s_cselect_b32 s58, 0, 0x40000000
    s_cselect_b32 s11, 1, 0
    v_mfma_f32_16x16x32_bf16 v[128:131], a[176:179], a[128:131], v[128:131]
    ds_read_b128 a[176:179], v11 offset:30976
    v_add_u32 v30, s58, v30
    v_mfma_f32_16x16x32_bf16 v[112:115], a[180:183], a[132:135], v[112:115]
    v_mfma_f32_16x16x32_bf16 v[120:123], a[180:183], a[136:139], v[120:123]
    s_waitcnt vmcnt(6)
    buffer_load_dwordx4 v4, s[12:15], s57 offen offset:2048 nt lds
    v_mfma_f32_16x16x32_bf16 v[128:131], a[180:183], a[140:143], v[128:131]
    s_add_u32 m0, s51, 98304
    s_sub_u32 s57, s45, 1280
    s_cselect_b32 s45, s45, s57
    v_mfma_f32_16x16x32_bf16 v[116:119], a[160:163], a[72:75], 0
    s_add_u32 s57, s45, 0
    ds_read_b128 a[180:183], v12 offset:30976
    v_max3_f32 v36, v36, v112, v113
    v_mfma_f32_16x16x32_bf16 v[124:127], a[160:163], a[76:79], 0
    s_add_u32 s45, s44, 896
    v_max3_f32 v37, v37, v120, v121
    v_max3_f32 v36, v36, v114, v115
    v_mfma_f32_16x16x32_bf16 v[132:135], a[160:163], a[80:83], 0
    v_max3_f32 v38, v38, v128, v129
    v_max3_f32 v37, v37, v122, v123
    v_mfma_f32_16x16x32_bf16 v[116:119], a[164:167], a[84:87], v[116:119]
    s_waitcnt vmcnt(6)
    buffer_load_dwordx4 v8, s[24:27], s57 offen lds
    v_mfma_f32_16x16x32_bf16 v[124:127], a[164:167], a[88:91], v[124:127]
    v_max3_f32 v38, v38, v130, v131
    v_mfma_f32_16x16x32_bf16 v[132:135], a[164:167], a[92:95], v[132:135]
    s_waitcnt lgkmcnt(1)
    v_mfma_f32_16x16x32_bf16 v[116:119], a[168:171], a[96:99], v[116:119]
    v_mfma_f32_16x16x32_bf16 v[124:127], a[168:171], a[100:103], v[124:127]
    v_mfma_f32_16x16x32_bf16 v[132:135], a[168:171], a[104:107], v[132:135]
    s_waitcnt vmcnt(6)
    buffer_load_dwordx4 v9, s[24:27], s57 offen offset:1024 lds
    v_mfma_f32_16x16x32_bf16 v[116:119], a[172:175], a[108:111], v[116:119]
    v_mfma_f32_16x16x32_bf16 v[124:127], a[172:175], a[112:115], v[124:127]
    v_mfma_f32_16x16x32_bf16 v[132:135], a[172:175], a[116:119], v[132:135]
    v_mfma_f32_16x16x32_bf16 v[116:119], a[176:179], a[120:123], v[116:119]
    v_mfma_f32_16x16x32_bf16 v[124:127], a[176:179], a[124:127], v[124:127]
    s_waitcnt vmcnt(6)
    buffer_load_dwordx4 v10, s[24:27], s57 offen offset:2048 lds
    v_mfma_f32_16x16x32_bf16 v[132:135], a[176:179], a[128:131], v[132:135]
    s_add_u32 m0, s51, 110592
    s_waitcnt lgkmcnt(0)
    s_barrier
    v_mfma_f32_16x16x32_bf16 v[116:119], a[180:183], a[132:135], v[116:119]
    ds_read_b128 a[160:163], v11 offset:49152
    s_sub_u32 s57, s45, 1280
    s_cselect_b32 s45, s45, s57
    v_mfma_f32_16x16x32_bf16 v[124:127], a[180:183], a[136:139], v[124:127]
    s_add_u32 s57, s45, 122880
    ds_read_b128 a[164:167], v12 offset:49152
    s_add_u32 s45, s44, 640
    v_mfma_f32_16x16x32_bf16 v[132:135], a[180:183], a[140:143], v[132:135]
    ds_read_b128 a[168:171], v11 offset:49280
    v_max3_f32 v36, v36, v116, v117
    v_mfma_f32_16x16x32_bf16 v[208:211], a[184:187], a[0:3], 0
    ds_read_b128 a[172:175], v12 offset:49280
    v_max3_f32 v36, v36, v118, v119
    v_mfma_f32_16x16x32_bf16 v[216:219], a[184:187], a[4:7], 0
    ds_read_b128 a[176:179], v11 offset:49408
    v_max3_f32 v37, v37, v124, v125
    v_mfma_f32_16x16x32_bf16 v[224:227], a[184:187], a[8:11], 0
    ds_read_b128 a[180:183], v12 offset:49408
    v_max3_f32 v38, v38, v132, v133
    v_mfma_f32_16x16x32_bf16 v[212:215], a[188:191], a[0:3], 0
    s_waitcnt vmcnt(6)
    buffer_load_dwordx4 v8, s[24:27], s57 offen lds
    v_mfma_f32_16x16x32_bf16 v[220:223], a[188:191], a[4:7], 0
    v_max3_f32 v37, v37, v126, v127
    v_max3_f32 v38, v38, v134, v135
    v_mfma_f32_16x16x32_bf16 v[228:231], a[188:191], a[8:11], 0
    ds_read_b64_tr_b16 a[184:185], v23 offset:36864
    ds_read_b64_tr_b16 a[186:187], v23 offset:38912
    v_mfma_f32_16x16x32_bf16 v[208:211], a[192:195], a[12:15], v[208:211]
    ds_read_b64_tr_b16 a[188:189], v24 offset:36864
    ds_read_b64_tr_b16 a[190:191], v24 offset:38912
    v_mfma_f32_16x16x32_bf16 v[216:219], a[192:195], a[16:19], v[216:219]
    v_mfma_f32_16x16x32_bf16 v[224:227], a[192:195], a[20:23], v[224:227]
    s_waitcnt vmcnt(6)
    buffer_load_dwordx4 v9, s[24:27], s57 offen offset:1024 lds
    v_mfma_f32_16x16x32_bf16 v[212:215], a[196:199], a[12:15], v[212:215]
    ds_read_b64_tr_b16 a[192:193], v23 offset:40960
    ds_read_b64_tr_b16 a[194:195], v23 offset:43008
    v_mfma_f32_16x16x32_bf16 v[220:223], a[196:199], a[16:19], v[220:223]
    v_mfma_f32_16x16x32_bf16 v[228:231], a[196:199], a[20:23], v[228:231]
    ds_read_b64_tr_b16 a[196:197], v24 offset:40960
    ds_read_b64_tr_b16 a[198:199], v24 offset:43008
    v_mfma_f32_16x16x32_bf16 v[208:211], a[200:203], a[24:27], v[208:211]
    v_mfma_f32_16x16x32_bf16 v[216:219], a[200:203], a[28:31], v[216:219]
    s_waitcnt vmcnt(6)
    buffer_load_dwordx4 v10, s[24:27], s57 offen offset:2048 lds
    v_mfma_f32_16x16x32_bf16 v[224:227], a[200:203], a[32:35], v[224:227]
    s_mov_b32 s57, 3268608
    s_add_u32 m0, s51, 24576
    ds_read_b64_tr_b16 a[200:201], v23 offset:45056
    v_mfma_f32_16x16x32_bf16 v[212:215], a[204:207], a[24:27], v[212:215]
    ds_read_b64_tr_b16 a[202:203], v23 offset:47104
    v_mfma_f32_16x16x32_bf16 v[220:223], a[204:207], a[28:31], v[220:223]
    v_mfma_f32_16x16x32_bf16 v[228:231], a[204:207], a[32:35], v[228:231]
    s_waitcnt lgkmcnt(4)
    ds_read_b64_tr_b16 a[204:205], v24 offset:45056
    ds_read_b64_tr_b16 a[206:207], v24 offset:47104
    v_mfma_f32_16x16x32_bf16 v[136:139], a[160:163], a[72:75], 0
    s_waitcnt vmcnt(6)
    buffer_load_dwordx4 v2, s[12:15], s57 offen nt lds
    v_mfma_f32_16x16x32_bf16 v[144:147], a[160:163], a[76:79], 0
    v_mfma_f32_16x16x32_bf16 v[152:155], a[160:163], a[80:83], 0
    ds_read_b128 a[160:163], v11 offset:55296
    v_mfma_f32_16x16x32_bf16 v[136:139], a[164:167], a[84:87], v[136:139]
    v_mfma_f32_16x16x32_bf16 v[144:147], a[164:167], a[88:91], v[144:147]
    v_mfma_f32_16x16x32_bf16 v[152:155], a[164:167], a[92:95], v[152:155]
    s_waitcnt vmcnt(6)
    buffer_load_dwordx4 v3, s[12:15], s57 offen offset:1024 nt lds
    v_mfma_f32_16x16x32_bf16 v[136:139], a[168:171], a[96:99], v[136:139]
    ds_read_b128 a[164:167], v12 offset:55296
    v_mfma_f32_16x16x32_bf16 v[144:147], a[168:171], a[100:103], v[144:147]
    v_mfma_f32_16x16x32_bf16 v[152:155], a[168:171], a[104:107], v[152:155]
    ds_read_b128 a[168:171], v11 offset:55424
    v_mfma_f32_16x16x32_bf16 v[136:139], a[172:175], a[108:111], v[136:139]
    v_mfma_f32_16x16x32_bf16 v[144:147], a[172:175], a[112:115], v[144:147]
    s_waitcnt vmcnt(6)
    buffer_load_dwordx4 v4, s[12:15], s57 offen offset:2048 nt lds
    v_mfma_f32_16x16x32_bf16 v[152:155], a[172:175], a[116:119], v[152:155]
    s_mov_b32 s57, 3280896
    ds_read_b128 a[172:175], v12 offset:55424
    s_add_u32 m0, s51, 36864
    v_mfma_f32_16x16x32_bf16 v[136:139], a[176:179], a[120:123], v[136:139]
    v_mfma_f32_16x16x32_bf16 v[144:147], a[176:179], a[124:127], v[144:147]
    v_mfma_f32_16x16x32_bf16 v[152:155], a[176:179], a[128:131], v[152:155]
    ds_read_b128 a[176:179], v11 offset:55552
    v_mfma_f32_16x16x32_bf16 v[136:139], a[180:183], a[132:135], v[136:139]
    s_waitcnt vmcnt(6)
    buffer_load_dwordx4 v2, s[12:15], s57 offen nt lds
    v_mfma_f32_16x16x32_bf16 v[144:147], a[180:183], a[136:139], v[144:147]
    v_mfma_f32_16x16x32_bf16 v[152:155], a[180:183], a[140:143], v[152:155]
    s_waitcnt lgkmcnt(2)
    ds_read_b128 a[180:183], v12 offset:55552
    v_mfma_f32_16x16x32_bf16 v[140:143], a[160:163], a[72:75], 0
    s_nop 0
    v_max3_f32 v36, v36, v136, v137
    v_max3_f32 v36, v36, v138, v139
    v_mfma_f32_16x16x32_bf16 v[148:151], a[160:163], a[76:79], 0
    v_max3_f32 v37, v37, v144, v145
    v_max3_f32 v37, v37, v146, v147
    v_mfma_f32_16x16x32_bf16 v[156:159], a[160:163], a[80:83], 0
    s_waitcnt vmcnt(6)
    buffer_load_dwordx4 v3, s[12:15], s57 offen offset:1024 nt lds
    v_mfma_f32_16x16x32_bf16 v[140:143], a[164:167], a[84:87], v[140:143]
    v_max3_f32 v38, v38, v152, v153
    v_max3_f32 v38, v38, v154, v155
    v_mfma_f32_16x16x32_bf16 v[148:151], a[164:167], a[88:91], v[148:151]
    v_mfma_f32_16x16x32_bf16 v[156:159], a[164:167], a[92:95], v[156:159]
    v_mfma_f32_16x16x32_bf16 v[140:143], a[168:171], a[96:99], v[140:143]
    v_mfma_f32_16x16x32_bf16 v[148:151], a[168:171], a[100:103], v[148:151]
    s_waitcnt vmcnt(6)
    buffer_load_dwordx4 v4, s[12:15], s57 offen offset:2048 nt lds
    v_mfma_f32_16x16x32_bf16 v[156:159], a[168:171], a[104:107], v[156:159]
    s_mov_b32 s57, 3293184
    s_waitcnt vmcnt(6) lgkmcnt(0)
    s_barrier
    v_mfma_f32_16x16x32_bf16 v[140:143], a[172:175], a[108:111], v[140:143]
    s_add_u32 m0, s51, 49152
    ds_read_b128 a[160:163], v11 offset:0
    v_mfma_f32_16x16x32_bf16 v[148:151], a[172:175], a[112:115], v[148:151]
    ds_read_b128 a[164:167], v12 offset:0
    v_mfma_f32_16x16x32_bf16 v[156:159], a[172:175], a[116:119], v[156:159]
    ds_read_b128 a[168:171], v11 offset:128
    v_mfma_f32_16x16x32_bf16 v[140:143], a[176:179], a[120:123], v[140:143]
    ds_read_b128 a[172:175], v12 offset:128
    buffer_load_dwordx4 v2, s[12:15], s57 offen nt lds
    v_mfma_f32_16x16x32_bf16 v[148:151], a[176:179], a[124:127], v[148:151]
    v_mfma_f32_16x16x32_bf16 v[156:159], a[176:179], a[128:131], v[156:159]
    ds_read_b128 a[176:179], v11 offset:256
    v_mfma_f32_16x16x32_bf16 v[140:143], a[180:183], a[132:135], v[140:143]
    v_mfma_f32_16x16x32_bf16 v[148:151], a[180:183], a[136:139], v[148:151]
    v_mfma_f32_16x16x32_bf16 v[156:159], a[180:183], a[140:143], v[156:159]
    ds_read_b128 a[180:183], v12 offset:256
    s_waitcnt vmcnt(6)
    buffer_load_dwordx4 v3, s[12:15], s57 offen offset:1024 nt lds
    v_mfma_f32_16x16x32_bf16 v[208:211], a[184:187], a[36:39], v[208:211]
    s_nop 1
    v_max3_f32 v36, v36, v140, v141
    v_max3_f32 v37, v37, v148, v149
    v_mfma_f32_16x16x32_bf16 v[216:219], a[184:187], a[40:43], v[216:219]
    v_max3_f32 v36, v36, v142, v143
    v_max3_f32 v38, v38, v156, v157
    v_mfma_f32_16x16x32_bf16 v[224:227], a[184:187], a[44:47], v[224:227]
    v_max3_f32 v37, v37, v150, v151
    v_max3_f32 v38, v38, v158, v159
    v_mfma_f32_16x16x32_bf16 v[212:215], a[188:191], a[36:39], v[212:215]
    ds_read_b64_tr_b16 a[184:185], v25 offset:0
    ds_read_b64_tr_b16 a[186:187], v25 offset:2048
    v_mfma_f32_16x16x32_bf16 v[220:223], a[188:191], a[40:43], v[220:223]
    s_waitcnt vmcnt(6)
    buffer_load_dwordx4 v4, s[12:15], s57 offen offset:2048 nt lds
    v_mfma_f32_16x16x32_bf16 v[228:231], a[188:191], a[44:47], v[228:231]
    s_mov_b32 s57, 3305472
    s_add_u32 m0, s51, 61440
    ds_read_b64_tr_b16 a[188:189], v26 offset:0
    v_mfma_f32_16x16x32_bf16 v[208:211], a[192:195], a[48:51], v[208:211]
    ds_read_b64_tr_b16 a[190:191], v26 offset:2048
    v_mfma_f32_16x16x32_bf16 v[216:219], a[192:195], a[52:55], v[216:219]
    v_mfma_f32_16x16x32_bf16 v[224:227], a[192:195], a[56:59], v[224:227]
    ds_read_b64_tr_b16 a[192:193], v25 offset:4096
    ds_read_b64_tr_b16 a[194:195], v25 offset:6144
    v_mfma_f32_16x16x32_bf16 v[212:215], a[196:199], a[48:51], v[212:215]
    s_waitcnt vmcnt(6)
    buffer_load_dwordx4 v2, s[12:15], s57 offen nt lds
    v_mfma_f32_16x16x32_bf16 v[220:223], a[196:199], a[52:55], v[220:223]
    v_mfma_f32_16x16x32_bf16 v[228:231], a[196:199], a[56:59], v[228:231]
    ds_read_b64_tr_b16 a[196:197], v26 offset:4096
    ds_read_b64_tr_b16 a[198:199], v26 offset:6144
    v_mfma_f32_16x16x32_bf16 v[208:211], a[200:203], a[60:63], v[208:211]
    v_mfma_f32_16x16x32_bf16 v[216:219], a[200:203], a[64:67], v[216:219]
    v_mfma_f32_16x16x32_bf16 v[224:227], a[200:203], a[68:71], v[224:227]
    s_waitcnt vmcnt(6)
    buffer_load_dwordx4 v3, s[12:15], s57 offen offset:1024 nt lds
    v_mfma_f32_16x16x32_bf16 v[212:215], a[204:207], a[60:63], v[212:215]
    s_nop 2
    v_cvt_pk_bf16_f32 v208, v208, v209
    v_cvt_pk_bf16_f32 v209, v210, v211
    v_mfma_f32_16x16x32_bf16 v[220:223], a[204:207], a[64:67], v[220:223]
    v_cvt_pk_bf16_f32 v216, v216, v217
    v_cvt_pk_bf16_f32 v217, v218, v219
    v_mfma_f32_16x16x32_bf16 v[228:231], a[204:207], a[68:71], v[228:231]
    s_waitcnt lgkmcnt(2)
    v_cvt_pk_bf16_f32 v224, v224, v225
    v_cvt_pk_bf16_f32 v225, v226, v227
    v_mfma_f32_16x16x32_bf16 v[160:163], a[160:163], a[72:75], 0
    v_cvt_pk_bf16_f32 v210, v212, v213
    v_cvt_pk_bf16_f32 v211, v214, v215
    v_mfma_f32_16x16x32_bf16 v[168:171], a[160:163], a[76:79], 0
    s_waitcnt vmcnt(6)
    buffer_load_dwordx4 v4, s[12:15], s57 offen offset:2048 nt lds
    v_mfma_f32_16x16x32_bf16 v[176:179], a[160:163], a[80:83], 0
    s_add_u32 m0, s51, 73728
    ds_read_b128 a[160:163], v11 offset:6144
    v_cvt_pk_bf16_f32 v218, v220, v221
    v_mfma_f32_16x16x32_bf16 v[160:163], a[164:167], a[84:87], v[160:163]
    s_sub_u32 s57, s45, 1280
    s_cselect_b32 s45, s45, s57
    s_add_u32 s57, s45, 0
    v_mfma_f32_16x16x32_bf16 v[168:171], a[164:167], a[88:91], v[168:171]
    s_add_u32 s45, s44, 640
    v_cvt_pk_bf16_f32 v219, v222, v223
    v_cvt_pk_bf16_f32 v226, v228, v229
    v_mfma_f32_16x16x32_bf16 v[176:179], a[164:167], a[92:95], v[176:179]
    ds_read_b128 a[164:167], v12 offset:6144
    v_cvt_pk_bf16_f32 v227, v230, v231
    v_mfma_f32_16x16x32_bf16 v[160:163], a[168:171], a[96:99], v[160:163]
    s_waitcnt vmcnt(6)
    buffer_load_dwordx4 v8, s[24:27], s57 offen lds
    v_mfma_f32_16x16x32_bf16 v[168:171], a[168:171], a[100:103], v[168:171]
    v_accvgpr_write_b32 a208, v208
    v_accvgpr_write_b32 a209, v209
    v_mfma_f32_16x16x32_bf16 v[176:179], a[168:171], a[104:107], v[176:179]
    ds_read_b128 a[168:171], v11 offset:6272
    v_accvgpr_write_b32 a210, v210
    v_mfma_f32_16x16x32_bf16 v[160:163], a[172:175], a[108:111], v[160:163]
    v_accvgpr_write_b32 a211, v211
    v_accvgpr_write_b32 a212, v216
    v_mfma_f32_16x16x32_bf16 v[168:171], a[172:175], a[112:115], v[168:171]
    v_accvgpr_write_b32 a213, v217
    v_accvgpr_write_b32 a214, v218
    v_mfma_f32_16x16x32_bf16 v[176:179], a[172:175], a[116:119], v[176:179]
    s_waitcnt vmcnt(6)
    buffer_load_dwordx4 v9, s[24:27], s57 offen offset:1024 lds
    v_mfma_f32_16x16x32_bf16 v[160:163], a[176:179], a[120:123], v[160:163]
    ds_read_b128 a[172:175], v12 offset:6272
    v_accvgpr_write_b32 a215, v219
    v_mfma_f32_16x16x32_bf16 v[168:171], a[176:179], a[124:127], v[168:171]
    v_accvgpr_write_b32 a216, v224
    v_accvgpr_write_b32 a217, v225
    v_mfma_f32_16x16x32_bf16 v[176:179], a[176:179], a[128:131], v[176:179]
    ds_read_b128 a[176:179], v11 offset:6400
    v_accvgpr_write_b32 a218, v226
    v_mfma_f32_16x16x32_bf16 v[160:163], a[180:183], a[132:135], v[160:163]
    v_accvgpr_write_b32 a219, v227
    v_mfma_f32_16x16x32_bf16 v[168:171], a[180:183], a[136:139], v[168:171]
    s_waitcnt vmcnt(6)
    buffer_load_dwordx4 v10, s[24:27], s57 offen offset:2048 lds
    v_mfma_f32_16x16x32_bf16 v[176:179], a[180:183], a[140:143], v[176:179]
    s_add_u32 m0, s51, 86016
    ds_read_b128 a[180:183], v12 offset:6400
    s_sub_u32 s57, s45, 1280
    s_cselect_b32 s45, s45, s57
    s_waitcnt lgkmcnt(2)
    v_mfma_f32_16x16x32_bf16 v[164:167], a[160:163], a[72:75], 0
    s_add_u32 s57, s45, 122880
    ds_read_b64_tr_b16 a[200:201], v25 offset:8192
    ds_read_b64_tr_b16 a[202:203], v25 offset:10240
    v_mfma_f32_16x16x32_bf16 v[172:175], a[160:163], a[76:79], 0
    s_add_u32 s45, s44, 0
    ds_read_b64_tr_b16 a[204:205], v26 offset:8192
    ds_read_b64_tr_b16 a[206:207], v26 offset:10240
    v_mfma_f32_16x16x32_bf16 v[180:183], a[160:163], a[80:83], 0
    v_max3_f32 v36, v36, v160, v161
    v_max3_f32 v37, v37, v168, v169
    v_mfma_f32_16x16x32_bf16 v[164:167], a[164:167], a[84:87], v[164:167]
    v_max3_f32 v38, v38, v176, v177
    v_max3_f32 v36, v36, v162, v163
    v_mfma_f32_16x16x32_bf16 v[172:175], a[164:167], a[88:91], v[172:175]
    v_max3_f32 v37, v37, v170, v171
    v_max3_f32 v38, v38, v178, v179
    v_mfma_f32_16x16x32_bf16 v[180:183], a[164:167], a[92:95], v[180:183]
    s_waitcnt lgkmcnt(4)
    s_barrier
    ds_read_b128 a[160:163], v11 offset:24576
    v_mfma_f32_16x16x32_bf16 v[164:167], a[168:171], a[96:99], v[164:167]
    ds_read_b128 a[164:167], v12 offset:24576
    s_waitcnt vmcnt(6)
    buffer_load_dwordx4 v8, s[24:27], s57 offen lds
    v_mfma_f32_16x16x32_bf16 v[172:175], a[168:171], a[100:103], v[172:175]
    v_and_b32 v56, v56, v57
    v_and_b32 v58, v58, v59
    v_and_b32 v56, v56, v58
    s_nop 0
    v_readfirstlane_b32 s47, v56
    s_nop 0
    s_cmp_eq_u32 s47, 0x1
    s_cbranch_scc0 LA_slow0
LA_back0:
    v_mfma_f32_16x16x32_bf16 v[180:183], a[168:171], a[104:107], v[180:183]
    ds_read_b128 a[168:171], v11 offset:24704
    v_mov_b32 v56, 0x3f80
    v_mfma_f32_16x16x32_bf16 v[164:167], a[172:175], a[108:111], v[164:167]
    s_waitcnt vmcnt(6)
    buffer_load_dwordx4 v9, s[24:27], s57 offen offset:1024 lds
    v_mfma_f32_16x16x32_bf16 v[172:175], a[172:175], a[112:115], v[172:175]
    v_lshlrev_b32 v50, v50, v56
    v_lshrrev_b32 v56, 1, v48
    v_mfma_f32_16x16x32_bf16 v[180:183], a[172:175], a[116:119], v[180:183]
    ds_read_b128 a[172:175], v12 offset:24704
    v_lshlrev_b32 v57, 1, v49
    v_mfma_f32_16x16x32_bf16 v[164:167], a[176:179], a[120:123], v[164:167]
    v_cmp_eq_u32 vcc, v56, v57
    s_nop 1
    v_cndmask_b32 v58, 0, v50, vcc
    v_mfma_f32_16x16x32_bf16 v[172:175], a[176:179], a[124:127], v[172:175]
    v_add_u32 v57, 1, v57
    v_cmp_eq_u32 vcc, v56, v57
    v_mfma_f32_16x16x32_bf16 v[180:183], a[176:179], a[128:131], v[180:183]
    ds_read_b128 a[176:179], v11 offset:24832
    v_cndmask_b32 v59, 0, v50, vcc
    v_mfma_f32_16x16x32_bf16 v[164:167], a[180:183], a[132:135], v[164:167]
    s_waitcnt vmcnt(6)
    buffer_load_dwordx4 v10, s[24:27], s57 offen offset:2048 lds
    v_mfma_f32_16x16x32_bf16 v[172:175], a[180:183], a[136:139], v[172:175]
    s_mov_b32 s57, 3317760
    s_add_u32 m0, s51, 0
    v_and_b32 v50, 1, v49
    v_mfma_f32_16x16x32_bf16 v[180:183], a[180:183], a[140:143], v[180:183]
    ds_read_b128 a[180:183], v12 offset:24832
    v_lshl_add_u32 v29, v50, 5, v29
    v_mfma_f32_16x16x32_bf16 v[232:235], a[184:187], a[0:3], 0
    v_max3_f32 v36, v36, v164, v165
    v_max3_f32 v36, v36, v166, v167
    v_mfma_f32_16x16x32_bf16 v[240:243], a[184:187], a[4:7], 0
    v_max3_f32 v37, v37, v172, v173
    v_max3_f32 v37, v37, v174, v175
    v_mfma_f32_16x16x32_bf16 v[248:251], a[184:187], a[8:11], 0
    s_waitcnt vmcnt(6)
    buffer_load_dwordx4 v2, s[12:15], s57 offen nt lds
    v_mfma_f32_16x16x32_bf16 v[236:239], a[188:191], a[0:3], 0
    v_max3_f32 v38, v38, v180, v181
    v_max3_f32 v38, v38, v182, v183
    v_mfma_f32_16x16x32_bf16 v[244:247], a[188:191], a[4:7], 0
    ds_read_b64_tr_b16 a[184:185], v25 offset:12288
    ds_read_b64_tr_b16 a[186:187], v25 offset:14336
    v_mfma_f32_16x16x32_bf16 v[252:255], a[188:191], a[8:11], 0
    ds_read_b64_tr_b16 a[188:189], v26 offset:12288
    ds_read_b64_tr_b16 a[190:191], v26 offset:14336
    v_mfma_f32_16x16x32_bf16 v[232:235], a[192:195], a[12:15], v[232:235]
    v_lshrrev_b32 v50, 1, v49
    v_lshl_add_u32 v29, v50, 4, v29
    v_mfma_f32_16x16x32_bf16 v[240:243], a[192:195], a[16:19], v[240:243]
    s_waitcnt vmcnt(6)
    buffer_load_dwordx4 v3, s[12:15], s57 offen offset:1024 nt lds
    v_mfma_f32_16x16x32_bf16 v[248:251], a[192:195], a[20:23], v[248:251]
    ds_read_b64_tr_b16 a[192:193], v25 offset:16384
    ds_read_b64_tr_b16 a[194:195], v25 offset:18432
    v_mfma_f32_16x16x32_bf16 v[236:239], a[196:199], a[12:15], v[236:239]
    v_add_u32 v0, s22, v29
    v_mov_b32 v56, 0
    v_mfma_f32_16x16x32_bf16 v[244:247], a[196:199], a[16:19], v[244:247]
    v_mov_b32 v57, 0
    v_add_u32 v29, s10, v29
    v_mfma_f32_16x16x32_bf16 v[252:255], a[196:199], a[20:23], v[252:255]
    s_waitcnt lgkmcnt(4)
    ds_read_b64_tr_b16 a[196:197], v26 offset:16384
    ds_read_b64_tr_b16 a[198:199], v26 offset:18432
    v_mfma_f32_16x16x32_bf16 v[232:235], a[200:203], a[24:27], v[232:235]
    s_waitcnt vmcnt(6)
    buffer_load_dwordx4 v4, s[12:15], s57 offen offset:2048 nt lds
    v_mfma_f32_16x16x32_bf16 v[240:243], a[200:203], a[28:31], v[240:243]
    s_mov_b32 s57, 3330048
    s_add_u32 m0, s51, 12288
    v_cmp_gt_u32 vcc, 60, v34
    v_mfma_f32_16x16x32_bf16 v[248:251], a[200:203], a[32:35], v[248:251]
    ds_read_b64_tr_b16 a[200:201], v25 offset:20480
    ds_read_b64_tr_b16 a[202:203], v25 offset:22528
    v_mfma_f32_16x16x32_bf16 v[236:239], a[204:207], a[24:27], v[236:239]
    v_cndmask_b32 v62, v63, v62, vcc
    v_mov_b32 v63, 1
    v_mfma_f32_16x16x32_bf16 v[244:247], a[204:207], a[28:31], v[244:247]
    v_mfma_f32_16x16x32_bf16 v[252:255], a[204:207], a[32:35], v[252:255]
    s_waitcnt vmcnt(6)
    buffer_load_dwordx4 v2, s[12:15], s57 offen nt lds
    v_mfma_f32_16x16x32_bf16 v[184:187], a[160:163], a[72:75], 0
    ds_read_b64_tr_b16 a[204:205], v26 offset:20480
    ds_read_b64_tr_b16 a[206:207], v26 offset:22528
    v_mfma_f32_16x16x32_bf16 v[192:195], a[160:163], a[76:79], 0
    v_mfma_f32_16x16x32_bf16 v[200:203], a[160:163], a[80:83], 0
    ds_read_b128 a[160:163], v11 offset:30720
    v_mfma_f32_16x16x32_bf16 v[184:187], a[164:167], a[84:87], v[184:187]
    v_mfma_f32_16x16x32_bf16 v[192:195], a[164:167], a[88:91], v[192:195]
    s_waitcnt vmcnt(6)
    buffer_load_dwordx4 v3, s[12:15], s57 offen offset:1024 nt lds
    v_mfma_f32_16x16x32_bf16 v[200:203], a[164:167], a[92:95], v[200:203]
    ds_read_b128 a[164:167], v12 offset:30720
    v_mfma_f32_16x16x32_bf16 v[184:187], a[168:171], a[96:99], v[184:187]
    v_mfma_f32_16x16x32_bf16 v[192:195], a[168:171], a[100:103], v[192:195]
    v_mfma_f32_16x16x32_bf16 v[200:203], a[168:171], a[104:107], v[200:203]
    ds_read_b128 a[168:171], v11 offset:30848
    v_mfma_f32_16x16x32_bf16 v[184:187], a[172:175], a[108:111], v[184:187]
    s_waitcnt vmcnt(6)
    buffer_load_dwordx4 v4, s[12:15], s57 offen offset:2048 nt lds
    v_mfma_f32_16x16x32_bf16 v[192:195], a[172:175], a[112:115], v[192:195]
    s_mov_b32 s57, 3145728
    s_add_u32 m0, s51, 24576
    v_mfma_f32_16x16x32_bf16 v[200:203], a[172:175], a[116:119], v[200:203]
    ds_read_b128 a[172:175], v12 offset:30848
    v_mfma_f32_16x16x32_bf16 v[184:187], a[176:179], a[120:123], v[184:187]
    v_mfma_f32_16x16x32_bf16 v[192:195], a[176:179], a[124:127], v[192:195]
    v_mfma_f32_16x16x32_bf16 v[200:203], a[176:179], a[128:131], v[200:203]
    ds_read_b128 a[176:179], v11 offset:30976
    v_mfma_f32_16x16x32_bf16 v[184:187], a[180:183], a[132:135], v[184:187]
    v_mfma_f32_16x16x32_bf16 v[192:195], a[180:183], a[136:139], v[192:195]
    v_mfma_f32_16x16x32_bf16 v[200:203], a[180:183], a[140:143], v[200:203]
    s_waitcnt lgkmcnt(2)
    ds_read_b128 a[180:183], v12 offset:30976
    v_mfma_f32_16x16x32_bf16 v[188:191], a[160:163], a[72:75], 0
    s_nop 2
    v_max3_f32 v36, v36, v184, v185
    v_max3_f32 v36, v36, v186, v187
    v_mfma_f32_16x16x32_bf16 v[196:199], a[160:163], a[76:79], 0
    v_max3_f32 v37, v37, v192, v193
    v_max3_f32 v37, v37, v194, v195
    v_mfma_f32_16x16x32_bf16 v[204:207], a[160:163], a[80:83], 0
    v_max3_f32 v38, v38, v200, v201
    v_max3_f32 v38, v38, v202, v203
    v_mfma_f32_16x16x32_bf16 v[188:191], a[164:167], a[84:87], v[188:191]
    v_mfma_f32_16x16x32_bf16 v[196:199], a[164:167], a[88:91], v[196:199]
    v_mfma_f32_16x16x32_bf16 v[204:207], a[164:167], a[92:95], v[204:207]
    s_waitcnt vmcnt(6) lgkmcnt(0)
    s_barrier
    ds_read_b128 a[160:163], v11 offset:49152
    v_mfma_f32_16x16x32_bf16 v[188:191], a[168:171], a[96:99], v[188:191]
    ds_read_b128 a[164:167], v12 offset:49152
    buffer_load_dwordx4 v2, s[16:19], s57 offen nt lds
    v_mfma_f32_16x16x32_bf16 v[196:199], a[168:171], a[100:103], v[196:199]
    v_mfma_f32_16x16x32_bf16 v[204:207], a[168:171], a[104:107], v[204:207]
    ds_read_b128 a[168:171], v11 offset:49280
    v_mfma_f32_16x16x32_bf16 v[188:191], a[172:175], a[108:111], v[188:191]
    v_mfma_f32_16x16x32_bf16 v[196:199], a[172:175], a[112:115], v[196:199]
    v_mfma_f32_16x16x32_bf16 v[204:207], a[172:175], a[116:119], v[204:207]
    ds_read_b128 a[172:175], v12 offset:49280
    v_mfma_f32_16x16x32_bf16 v[188:191], a[176:179], a[120:123], v[188:191]
    v_mfma_f32_16x16x32_bf16 v[196:199], a[176:179], a[124:127], v[196:199]
    s_waitcnt vmcnt(6)
    buffer_load_dwordx4 v3, s[16:19], s57 offen offset:1024 nt lds
    v_mfma_f32_16x16x32_bf16 v[204:207], a[176:179], a[128:131], v[204:207]
    ds_read_b128 a[176:179], v11 offset:49408
    v_mfma_f32_16x16x32_bf16 v[188:191], a[180:183], a[132:135], v[188:191]
    v_mfma_f32_16x16x32_bf16 v[196:199], a[180:183], a[136:139], v[196:199]
    v_mfma_f32_16x16x32_bf16 v[204:207], a[180:183], a[140:143], v[204:207]
    ds_read_b128 a[180:183], v12 offset:49408
    v_mfma_f32_16x16x32_bf16 v[232:235], a[184:187], a[36:39], v[232:235]
    s_nop 3
    v_max3_f32 v36, v36, v188, v189
    v_max3_f32 v36, v36, v190, v191
    v_mfma_f32_16x16x32_bf16 v[240:243], a[184:187], a[40:43], v[240:243]
    v_max3_f32 v37, v37, v196, v197
    v_max3_f32 v37, v37, v198, v199
    v_mfma_f32_16x16x32_bf16 v[248:251], a[184:187], a[44:47], v[248:251]
    s_waitcnt vmcnt(6)
    buffer_load_dwordx4 v4, s[16:19], s57 offen offset:2048 nt lds
    v_mfma_f32_16x16x32_bf16 v[236:239], a[188:191], a[36:39], v[236:239]
    s_mov_b32 s57, 3158016
    v_max3_f32 v38, v38, v204, v205
    v_max3_f32 v38, v38, v206, v207
    v_mfma_f32_16x16x32_bf16 v[244:247], a[188:191], a[40:43], v[244:247]
    s_add_u32 m0, s51, 36864
    ds_read_b64_tr_b16 a[184:185], v23 offset:24576
    ds_read_b64_tr_b16 a[186:187], v23 offset:26624
    v_mfma_f32_16x16x32_bf16 v[252:255], a[188:191], a[44:47], v[252:255]
    ds_read_b64_tr_b16 a[188:189], v24 offset:24576
    ds_read_b64_tr_b16 a[190:191], v24 offset:26624
    v_mfma_f32_16x16x32_bf16 v[232:235], a[192:195], a[48:51], v[232:235]
    v_mfma_f32_16x16x32_bf16 v[240:243], a[192:195], a[52:55], v[240:243]
    v_mfma_f32_16x16x32_bf16 v[248:251], a[192:195], a[56:59], v[248:251]
    ds_read_b64_tr_b16 a[192:193], v23 offset:28672
    ds_read_b64_tr_b16 a[194:195], v23 offset:30720
    v_mfma_f32_16x16x32_bf16 v[236:239], a[196:199], a[48:51], v[236:239]
    s_waitcnt vmcnt(6)
    buffer_load_dwordx4 v2, s[16:19], s57 offen nt lds
    v_mfma_f32_16x16x32_bf16 v[244:247], a[196:199], a[52:55], v[244:247]
    v_mfma_f32_16x16x32_bf16 v[252:255], a[196:199], a[56:59], v[252:255]
    ds_read_b64_tr_b16 a[196:197], v24 offset:28672
    ds_read_b64_tr_b16 a[198:199], v24 offset:30720
    v_mfma_f32_16x16x32_bf16 v[232:235], a[200:203], a[60:63], v[232:235]
    v_mfma_f32_16x16x32_bf16 v[240:243], a[200:203], a[64:67], v[240:243]
    v_mfma_f32_16x16x32_bf16 v[248:251], a[200:203], a[68:71], v[248:251]
    ds_read_b64_tr_b16 a[200:201], v23 offset:32768
    ds_read_b64_tr_b16 a[202:203], v23 offset:34816
    v_mfma_f32_16x16x32_bf16 v[236:239], a[204:207], a[60:63], v[236:239]
    s_nop 2
    v_cvt_pk_bf16_f32 v232, v232, v233
    v_cvt_pk_bf16_f32 v233, v234, v235
    v_mfma_f32_16x16x32_bf16 v[244:247], a[204:207], a[64:67], v[244:247]
    s_waitcnt vmcnt(6)
    buffer_load_dwordx4 v3, s[16:19], s57 offen offset:1024 nt lds
    v_mfma_f32_16x16x32_bf16 v[252:255], a[204:207], a[68:71], v[252:255]
    s_waitcnt lgkmcnt(4)
    v_cvt_pk_bf16_f32 v240, v240, v241
    v_cvt_pk_bf16_f32 v248, v248, v249
    v_mfma_f32_16x16x32_bf16 v[208:211], a[160:163], a[72:75], 0
    v_cvt_pk_bf16_f32 v241, v242, v243
    v_cvt_pk_bf16_f32 v249, v250, v251
    v_mfma_f32_16x16x32_bf16 v[216:219], a[160:163], a[76:79], 0
    v_cvt_pk_bf16_f32 v234, v236, v237
    v_cvt_pk_bf16_f32 v235, v238, v239
    v_mfma_f32_16x16x32_bf16 v[224:227], a[160:163], a[80:83], 0
    ds_read_b128 a[160:163], v11 offset:55296
    v_cvt_pk_bf16_f32 v242, v244, v245
    v_mfma_f32_16x16x32_bf16 v[208:211], a[164:167], a[84:87], v[208:211]
    v_cvt_pk_bf16_f32 v243, v246, v247
    v_cvt_pk_bf16_f32 v250, v252, v253
    v_mfma_f32_16x16x32_bf16 v[216:219], a[164:167], a[88:91], v[216:219]
    v_cvt_pk_bf16_f32 v251, v254, v255
    v_accvgpr_write_b32 a220, v232
    v_mfma_f32_16x16x32_bf16 v[224:227], a[164:167], a[92:95], v[224:227]
    ds_read_b128 a[164:167], v12 offset:55296
    v_accvgpr_write_b32 a221, v233
    v_mfma_f32_16x16x32_bf16 v[208:211], a[168:171], a[96:99], v[208:211]
    s_waitcnt vmcnt(6)
    buffer_load_dwordx4 v4, s[16:19], s57 offen offset:2048 nt lds
    v_mfma_f32_16x16x32_bf16 v[216:219], a[168:171], a[100:103], v[216:219]
    s_mov_b32 s57, 3170304
    v_accvgpr_write_b32 a222, v234
    v_accvgpr_write_b32 a223, v235
    v_mfma_f32_16x16x32_bf16 v[224:227], a[168:171], a[104:107], v[224:227]
    s_add_u32 m0, s51, 49152
    ds_read_b128 a[168:171], v11 offset:55424
    v_accvgpr_write_b32 a224, v240
    v_mfma_f32_16x16x32_bf16 v[208:211], a[172:175], a[108:111], v[208:211]
    v_accvgpr_write_b32 a225, v241
    v_accvgpr_write_b32 a226, v242
    v_mfma_f32_16x16x32_bf16 v[216:219], a[172:175], a[112:115], v[216:219]
    v_accvgpr_write_b32 a227, v243
    v_accvgpr_write_b32 a228, v248
    v_mfma_f32_16x16x32_bf16 v[224:227], a[172:175], a[116:119], v[224:227]
    ds_read_b128 a[172:175], v12 offset:55424
    v_accvgpr_write_b32 a229, v249
    v_mfma_f32_16x16x32_bf16 v[208:211], a[176:179], a[120:123], v[208:211]
    v_accvgpr_write_b32 a230, v250
    v_accvgpr_write_b32 a231, v251
    v_mfma_f32_16x16x32_bf16 v[216:219], a[176:179], a[124:127], v[216:219]
    ds_read_b64_tr_b16 a[204:205], v24 offset:32768
    ds_read_b64_tr_b16 a[206:207], v24 offset:34816
    v_mfma_f32_16x16x32_bf16 v[224:227], a[176:179], a[128:131], v[224:227]
    ds_read_b128 a[176:179], v11 offset:55552
    v_mfma_f32_16x16x32_bf16 v[208:211], a[180:183], a[132:135], v[208:211]
    v_mfma_f32_16x16x32_bf16 v[216:219], a[180:183], a[136:139], v[216:219]
    v_mfma_f32_16x16x32_bf16 v[224:227], a[180:183], a[140:143], v[224:227]
    s_waitcnt lgkmcnt(4)
    ds_read_b128 a[180:183], v12 offset:55552
    v_mfma_f32_16x16x32_bf16 v[212:215], a[160:163], a[72:75], 0
    s_nop 2
    v_max3_f32 v36, v36, v208, v209
    v_max3_f32 v36, v36, v210, v211
    v_mfma_f32_16x16x32_bf16 v[220:223], a[160:163], a[76:79], 0
    v_max3_f32 v37, v37, v216, v217
    v_max3_f32 v37, v37, v218, v219
    v_mfma_f32_16x16x32_bf16 v[228:231], a[160:163], a[80:83], 0
    v_max3_f32 v38, v38, v224, v225
    v_max3_f32 v38, v38, v226, v227
    v_mfma_f32_16x16x32_bf16 v[212:215], a[164:167], a[84:87], v[212:215]
    v_mfma_f32_16x16x32_bf16 v[220:223], a[164:167], a[88:91], v[220:223]
    v_mfma_f32_16x16x32_bf16 v[228:231], a[164:167], a[92:95], v[228:231]
    s_waitcnt vmcnt(6) lgkmcnt(0)
    s_barrier
    ds_read_b128 a[160:163], v11 offset:0
    v_mfma_f32_16x16x32_bf16 v[212:215], a[168:171], a[96:99], v[212:215]
    ds_read_b128 a[164:167], v12 offset:0
    buffer_load_dwordx4 v2, s[16:19], s57 offen nt lds
    v_mfma_f32_16x16x32_bf16 v[220:223], a[168:171], a[100:103], v[220:223]
    v_mfma_f32_16x16x32_bf16 v[228:231], a[168:171], a[104:107], v[228:231]
    ds_read_b128 a[168:171], v11 offset:128
    v_mfma_f32_16x16x32_bf16 v[212:215], a[172:175], a[108:111], v[212:215]
    v_mfma_f32_16x16x32_bf16 v[220:223], a[172:175], a[112:115], v[220:223]
    v_mfma_f32_16x16x32_bf16 v[228:231], a[172:175], a[116:119], v[228:231]
    ds_read_b128 a[172:175], v12 offset:128
    v_mfma_f32_16x16x32_bf16 v[212:215], a[176:179], a[120:123], v[212:215]
    s_waitcnt vmcnt(6)
    buffer_load_dwordx4 v3, s[16:19], s57 offen offset:1024 nt lds
    v_mfma_f32_16x16x32_bf16 v[220:223], a[176:179], a[124:127], v[220:223]
    v_mfma_f32_16x16x32_bf16 v[228:231], a[176:179], a[128:131], v[228:231]
    ds_read_b128 a[176:179], v11 offset:256
    v_mfma_f32_16x16x32_bf16 v[212:215], a[180:183], a[132:135], v[212:215]
    v_mfma_f32_16x16x32_bf16 v[220:223], a[180:183], a[136:139], v[220:223]
    v_mfma_f32_16x16x32_bf16 v[228:231], a[180:183], a[140:143], v[228:231]
    ds_read_b128 a[180:183], v12 offset:256
    v_mfma_f32_16x16x32_bf16 a[232:235], a[184:187], a[0:3], 0
    s_waitcnt vmcnt(6)
    buffer_load_dwordx4 v4, s[16:19], s57 offen offset:2048 nt lds
    v_mfma_f32_16x16x32_bf16 a[240:243], a[184:187], a[4:7], 0
    s_mov_b32 s57, 3182592
    v_max3_f32 v36, v36, v212, v213
    v_max3_f32 v37, v37, v220, v221
    v_mfma_f32_16x16x32_bf16 a[248:251], a[184:187], a[8:11], 0
    s_add_u32 m0, s51, 61440
    v_max3_f32 v38, v38, v228, v229
    v_max3_f32 v36, v36, v214, v215
    v_mfma_f32_16x16x32_bf16 a[236:239], a[188:191], a[0:3], 0
    v_max3_f32 v37, v37, v222, v223
    v_max3_f32 v38, v38, v230, v231
    v_mfma_f32_16x16x32_bf16 a[244:247], a[188:191], a[4:7], 0
    ds_read_b64_tr_b16 a[184:185], v23 offset:36864
    ds_read_b64_tr_b16 a[186:187], v23 offset:38912
    v_mfma_f32_16x16x32_bf16 a[252:255], a[188:191], a[8:11], 0
    ds_read_b64_tr_b16 a[188:189], v24 offset:36864
    ds_read_b64_tr_b16 a[190:191], v24 offset:38912
    v_mfma_f32_16x16x32_bf16 a[232:235], a[192:195], a[12:15], a[232:235]
    s_waitcnt vmcnt(6)
    buffer_load_dwordx4 v2, s[16:19], s57 offen nt lds
    v_mfma_f32_16x16x32_bf16 a[240:243], a[192:195], a[16:19], a[240:243]
    v_mfma_f32_16x16x32_bf16 a[248:251], a[192:195], a[20:23], a[248:251]
    ds_read_b64_tr_b16 a[192:193], v23 offset:40960
    ds_read_b64_tr_b16 a[194:195], v23 offset:43008
    v_mfma_f32_16x16x32_bf16 a[236:239], a[196:199], a[12:15], a[236:239]
    v_mfma_f32_16x16x32_bf16 a[244:247], a[196:199], a[16:19], a[244:247]
    v_mfma_f32_16x16x32_bf16 a[252:255], a[196:199], a[20:23], a[252:255]
    ds_read_b64_tr_b16 a[196:197], v24 offset:40960
    ds_read_b64_tr_b16 a[198:199], v24 offset:43008
    v_mfma_f32_16x16x32_bf16 a[232:235], a[200:203], a[24:27], a[232:235]
    s_waitcnt vmcnt(6)
    buffer_load_dwordx4 v3, s[16:19], s57 offen offset:1024 nt lds
    v_mfma_f32_16x16x32_bf16 a[240:243], a[200:203], a[28:31], a[240:243]
    v_mfma_f32_16x16x32_bf16 a[248:251], a[200:203], a[32:35], a[248:251]
    ds_read_b64_tr_b16 a[200:201], v23 offset:45056
    ds_read_b64_tr_b16 a[202:203], v23 offset:47104
    v_mfma_f32_16x16x32_bf16 a[236:239], a[204:207], a[24:27], a[236:239]
    v_mfma_f32_16x16x32_bf16 a[244:247], a[204:207], a[28:31], a[244:247]
    v_mfma_f32_16x16x32_bf16 a[252:255], a[204:207], a[32:35], a[252:255]
    s_waitcnt lgkmcnt(4)
    ds_read_b64_tr_b16 a[204:205], v24 offset:45056
    ds_read_b64_tr_b16 a[206:207], v24 offset:47104
    v_mfma_f32_16x16x32_bf16 v[232:235], a[160:163], a[72:75], 0
    s_waitcnt vmcnt(6)
    buffer_load_dwordx4 v4, s[16:19], s57 offen offset:2048 nt lds
    v_mfma_f32_16x16x32_bf16 v[240:243], a[160:163], a[76:79], 0
    s_add_u32 m0, s51, 98304
    s_sub_u32 s57, s45, 1280
    s_cselect_b32 s45, s45, s57
    v_mfma_f32_16x16x32_bf16 v[248:251], a[160:163], a[80:83], 0
    s_add_u32 s57, s45, 0
    ds_read_b128 a[160:163], v11 offset:6144
    s_add_u32 s45, s44, 0
    v_mfma_f32_16x16x32_bf16 v[232:235], a[164:167], a[84:87], v[232:235]
    v_mfma_f32_16x16x32_bf16 v[240:243], a[164:167], a[88:91], v[240:243]
    v_mfma_f32_16x16x32_bf16 v[248:251], a[164:167], a[92:95], v[248:251]
    ds_read_b128 a[164:167], v12 offset:6144
    v_mfma_f32_16x16x32_bf16 v[232:235], a[168:171], a[96:99], v[232:235]
    v_mfma_f32_16x16x32_bf16 v[240:243], a[168:171], a[100:103], v[240:243]
    v_mfma_f32_16x16x32_bf16 v[248:251], a[168:171], a[104:107], v[248:251]
    ds_read_b128 a[168:171], v11 offset:6272
    v_mfma_f32_16x16x32_bf16 v[232:235], a[172:175], a[108:111], v[232:235]
    v_mfma_f32_16x16x32_bf16 v[240:243], a[172:175], a[112:115], v[240:243]
    v_mfma_f32_16x16x32_bf16 v[248:251], a[172:175], a[116:119], v[248:251]
    ds_read_b128 a[172:175], v12 offset:6272
    v_mfma_f32_16x16x32_bf16 v[232:235], a[176:179], a[120:123], v[232:235]
    v_mfma_f32_16x16x32_bf16 v[240:243], a[176:179], a[124:127], v[240:243]
    v_mfma_f32_16x16x32_bf16 v[248:251], a[176:179], a[128:131], v[248:251]
    ds_read_b128 a[176:179], v11 offset:6400
    v_mfma_f32_16x16x32_bf16 v[232:235], a[180:183], a[132:135], v[232:235]
    v_mfma_f32_16x16x32_bf16 v[240:243], a[180:183], a[136:139], v[240:243]
    v_mfma_f32_16x16x32_bf16 v[248:251], a[180:183], a[140:143], v[248:251]
    s_waitcnt lgkmcnt(2)
    ds_read_b128 a[180:183], v12 offset:6400
    v_mov_b32 v12, 0
    v_mfma_f32_16x16x32_bf16 v[236:239], a[160:163], a[72:75], 0
    s_nop 1
    v_max3_f32 v36, v36, v232, v233
    v_max3_f32 v36, v36, v234, v235
    v_mfma_f32_16x16x32_bf16 v[244:247], a[160:163], a[76:79], 0
    v_max3_f32 v37, v37, v240, v241
    v_max3_f32 v37, v37, v242, v243
    v_mfma_f32_16x16x32_bf16 v[252:255], a[160:163], a[80:83], 0
    v_max3_f32 v38, v38, v248, v249
    v_max3_f32 v38, v38, v250, v251
    v_mfma_f32_16x16x32_bf16 v[236:239], a[164:167], a[84:87], v[236:239]
    v_mfma_f32_16x16x32_bf16 v[244:247], a[164:167], a[88:91], v[244:247]
    v_mfma_f32_16x16x32_bf16 v[252:255], a[164:167], a[92:95], v[252:255]
    v_mfma_f32_16x16x32_bf16 v[236:239], a[168:171], a[96:99], v[236:239]
    v_mfma_f32_16x16x32_bf16 v[244:247], a[168:171], a[100:103], v[244:247]
    v_mfma_f32_16x16x32_bf16 v[252:255], a[168:171], a[104:107], v[252:255]
    s_waitcnt lgkmcnt(0)
    v_mfma_f32_16x16x32_bf16 v[236:239], a[172:175], a[108:111], v[236:239]
    v_mfma_f32_16x16x32_bf16 v[244:247], a[172:175], a[112:115], v[244:247]
    v_mfma_f32_16x16x32_bf16 v[252:255], a[172:175], a[116:119], v[252:255]
    v_mfma_f32_16x16x32_bf16 v[236:239], a[176:179], a[120:123], v[236:239]
    v_mfma_f32_16x16x32_bf16 v[244:247], a[176:179], a[124:127], v[244:247]
    v_mfma_f32_16x16x32_bf16 v[252:255], a[176:179], a[128:131], v[252:255]
    v_mfma_f32_16x16x32_bf16 v[236:239], a[180:183], a[132:135], v[236:239]
    v_mfma_f32_16x16x32_bf16 v[244:247], a[180:183], a[136:139], v[244:247]
    v_mfma_f32_16x16x32_bf16 v[252:255], a[180:183], a[140:143], v[252:255]
    v_mfma_f32_16x16x32_bf16 a[232:235], a[184:187], a[36:39], a[232:235]
    s_nop 4
    v_max3_f32 v36, v36, v236, v237
    v_max3_f32 v36, v36, v238, v239
    v_mfma_f32_16x16x32_bf16 a[240:243], a[184:187], a[40:43], a[240:243]
    v_max3_f32 v37, v37, v244, v245
    v_max3_f32 v37, v37, v246, v247
    v_mfma_f32_16x16x32_bf16 a[248:251], a[184:187], a[44:47], a[248:251]
    v_max3_f32 v38, v38, v252, v253
    v_max3_f32 v38, v38, v254, v255
    v_mfma_f32_16x16x32_bf16 a[236:239], a[188:191], a[36:39], a[236:239]
    v_mov_b32 v48, v36
    v_mov_b32 v49, v37
    v_mfma_f32_16x16x32_bf16 a[244:247], a[188:191], a[40:43], a[244:247]
    v_mov_b32 v50, v38
    v_permlane32_swap_b32 v48, v36
    v_mfma_f32_16x16x32_bf16 a[252:255], a[188:191], a[44:47], a[252:255]
    v_permlane32_swap_b32 v49, v37
    v_permlane32_swap_b32 v50, v38
    v_mfma_f32_16x16x32_bf16 a[232:235], a[192:195], a[48:51], a[232:235]
    v_max_f32 v36, v48, v36
    v_max_f32 v37, v49, v37
    v_mfma_f32_16x16x32_bf16 a[240:243], a[192:195], a[52:55], a[240:243]
    v_max_f32 v38, v50, v38
    v_mov_b32 v48, v36
    v_mfma_f32_16x16x32_bf16 a[248:251], a[192:195], a[56:59], a[248:251]
    v_mov_b32 v49, v37
    v_mov_b32 v50, v38
    v_mfma_f32_16x16x32_bf16 a[236:239], a[196:199], a[48:51], a[236:239]
    v_permlane16_swap_b32 v48, v36
    v_permlane16_swap_b32 v49, v37
    v_mfma_f32_16x16x32_bf16 a[244:247], a[196:199], a[52:55], a[244:247]
    v_permlane16_swap_b32 v50, v38
    v_max_f32 v36, v48, v36
    v_mfma_f32_16x16x32_bf16 a[252:255], a[196:199], a[56:59], a[252:255]
    v_max_f32 v37, v49, v37
    v_max_f32 v38, v50, v38
    v_mfma_f32_16x16x32_bf16 a[232:235], a[200:203], a[60:63], a[232:235]
    ds_write_b128 v31, v[36:39]
    v_mfma_f32_16x16x32_bf16 a[240:243], a[200:203], a[64:67], a[240:243]
    v_mfma_f32_16x16x32_bf16 a[248:251], a[200:203], a[68:71], a[248:251]
    v_mfma_f32_16x16x32_bf16 a[236:239], a[204:207], a[60:63], a[236:239]
    v_mfma_f32_16x16x32_bf16 a[244:247], a[204:207], a[64:67], a[244:247]
    v_mfma_f32_16x16x32_bf16 a[252:255], a[204:207], a[68:71], a[252:255]
    s_waitcnt lgkmcnt(0)
    s_barrier
    ds_read_b128 v[40:43], v32
    s_waitcnt vmcnt(6)
    buffer_load_dwordx4 v8, s[24:27], s57 offen lds
    s_waitcnt vmcnt(6)
    buffer_load_dwordx4 v9, s[24:27], s57 offen offset:1024 lds
    s_waitcnt vmcnt(6)
    buffer_load_dwordx4 v10, s[24:27], s57 offen offset:2048 lds
    s_mov_b32 s57, 3194880
    s_add_u32 m0, s51, 0
    s_waitcnt vmcnt(6)
    buffer_load_dwordx4 v2, s[16:19], s57 offen nt lds
    s_waitcnt vmcnt(6)
    buffer_load_dwordx4 v3, s[16:19], s57 offen offset:1024 nt lds
    s_waitcnt vmcnt(6)
    buffer_load_dwordx4 v4, s[16:19], s57 offen offset:2048 nt lds
    s_mov_b32 s57, 3207168
    s_add_u32 m0, s51, 12288
    s_waitcnt lgkmcnt(0)
    v_max_f32 v44, v36, v40
    v_max_f32 v45, v37, v41
    v_max_f32 v46, v38, v42
    v_mul_f32 v44, s52, v44
    v_mul_f32 v45, s52, v45
    v_mul_f32 v46, s52, v46
    v_fma_f32 v64, v64, s52, -v44
    v_fma_f32 v65, v65, s52, -v44
    v_fma_f32 v72, v72, s52, -v45
    v_fma_f32 v73, v73, s52, -v45
    v_fma_f32 v80, v80, s52, -v46
    v_fma_f32 v81, v81, s52, -v46
    v_exp_f32 v64, v64
    v_exp_f32 v65, v65
    v_fma_f32 v66, v66, s52, -v44
    v_fma_f32 v67, v67, s52, -v44
    v_exp_f32 v72, v72
    v_exp_f32 v73, v73
    v_fma_f32 v74, v74, s52, -v45
    v_fma_f32 v75, v75, s52, -v45
    v_exp_f32 v80, v80
    v_exp_f32 v81, v81
    v_fma_f32 v82, v82, s52, -v46
    v_fma_f32 v83, v83, s52, -v46
    v_exp_f32 v66, v66
    v_exp_f32 v67, v67
    v_fma_f32 v68, v68, s52, -v44
    v_fma_f32 v69, v69, s52, -v44
    v_fma_f32 v70, v70, s52, -v44
    v_fma_f32 v71, v71, s52, -v44
    v_exp_f32 v74, v74
    v_exp_f32 v75, v75
    v_fma_f32 v76, v76, s52, -v45
    v_fma_f32 v77, v77, s52, -v45
    v_fma_f32 v78, v78, s52, -v45
    v_fma_f32 v79, v79, s52, -v45
    v_exp_f32 v82, v82
    v_exp_f32 v83, v83
    v_fma_f32 v84, v84, s52, -v46
    v_fma_f32 v85, v85, s52, -v46
    v_fma_f32 v86, v86, s52, -v46
    v_fma_f32 v87, v87, s52, -v46
    v_exp_f32 v68, v68
    v_exp_f32 v69, v69
    v_exp_f32 v70, v70
    v_exp_f32 v71, v71
    v_exp_f32 v76, v76
    v_exp_f32 v77, v77
    v_exp_f32 v78, v78
    v_exp_f32 v79, v79
    v_exp_f32 v84, v84
    v_exp_f32 v85, v85
    v_exp_f32 v86, v86
    v_exp_f32 v87, v87
    v_cvt_pk_bf16_f32 v64, v64, v65
    v_cvt_pk_bf16_f32 v72, v72, v73
    v_cvt_pk_bf16_f32 v80, v80, v81
    v_cvt_pk_bf16_f32 v65, v66, v67
    v_cvt_pk_bf16_f32 v73, v74, v75
    v_cvt_pk_bf16_f32 v81, v82, v83
    v_cvt_pk_bf16_f32 v66, v68, v69
    v_cvt_pk_bf16_f32 v67, v70, v71
    v_cvt_pk_bf16_f32 v74, v76, v77
    v_cvt_pk_bf16_f32 v75, v78, v79
    v_mfma_f32_16x16x32_bf16 a[144:147], a[156:159], v[64:67], 0
    s_waitcnt vmcnt(6)
    buffer_load_dwordx4 v2, s[16:19], s57 offen nt lds
    v_mfma_f32_16x16x32_bf16 a[148:151], a[156:159], v[72:75], 0
    s_waitcnt vmcnt(6)
    buffer_load_dwordx4 v3, s[16:19], s57 offen offset:1024 nt lds
    ds_write_b128 v27, v[64:67] offset:0
    s_waitcnt vmcnt(6)
    buffer_load_dwordx4 v4, s[16:19], s57 offen offset:2048 nt lds
    v_cvt_pk_bf16_f32 v82, v84, v85
    v_cvt_pk_bf16_f32 v83, v86, v87
    s_sub_u32 s57, s45, 1280
    s_cselect_b32 s45, s45, s57
    v_mfma_f32_16x16x32_bf16 a[152:155], a[156:159], v[80:83], 0
    s_add_u32 s57, s45, 122880
    ds_write_b128 v27, v[72:75] offset:1024
    s_add_u32 m0, s51, 110592
    v_fma_f32 v88, v88, s52, -v44
    v_fma_f32 v89, v89, s52, -v44
    v_fma_f32 v96, v96, s52, -v45
    v_fma_f32 v97, v97, s52, -v45
    v_fma_f32 v104, v104, s52, -v46
    ds_write_b128 v27, v[80:83] offset:2048
    v_fma_f32 v105, v105, s52, -v46
    v_exp_f32 v88, v88
    v_exp_f32 v89, v89
    v_fma_f32 v90, v90, s52, -v44
    v_fma_f32 v91, v91, s52, -v44
    v_exp_f32 v96, v96
    v_exp_f32 v97, v97
    v_fma_f32 v98, v98, s52, -v45
    v_fma_f32 v99, v99, s52, -v45
    v_exp_f32 v104, v104
    v_exp_f32 v105, v105
    v_fma_f32 v106, v106, s52, -v46
    v_fma_f32 v107, v107, s52, -v46
    v_exp_f32 v90, v90
    v_exp_f32 v91, v91
    v_fma_f32 v92, v92, s52, -v44
    v_fma_f32 v93, v93, s52, -v44
    s_waitcnt lgkmcnt(0)
    s_barrier
    ds_read_b64_tr_b16 a[160:161], v13 offset:24576
    ds_read_b64_tr_b16 a[162:163], v13 offset:30720
    ds_read_b64_tr_b16 a[164:165], v14 offset:24576
    s_waitcnt vmcnt(6)
    buffer_load_dwordx4 v8, s[24:27], s57 offen lds
    ds_read_b64_tr_b16 a[166:167], v14 offset:30720
    ds_read_b64_tr_b16 a[168:169], v15 offset:24576
    v_fma_f32 v94, v94, s52, -v44
    ds_read_b64_tr_b16 a[170:171], v15 offset:30720
    ds_read_b64_tr_b16 a[172:173], v16 offset:24576
    ds_read_b64_tr_b16 a[174:175], v16 offset:30720
    v_fma_f32 v95, v95, s52, -v44
    ds_read_b64_tr_b16 a[176:177], v13 offset:24704
    ds_read_b64_tr_b16 a[178:179], v13 offset:30848
    ds_read_b64_tr_b16 a[180:181], v14 offset:24704
    v_exp_f32 v98, v98
    ds_read_b64_tr_b16 a[182:183], v14 offset:30848
    ds_read_b128 v[68:71], v28 offset:0
    s_waitcnt lgkmcnt(11)
    v_mfma_f32_16x16x32_bf16 a[72:75], a[160:163], v[64:67], 0
    s_add_u32 s45, s44, 1152
    ds_read_b128 v[76:79], v28 offset:1024
    v_fma_f32 v100, v100, s52, -v45
    v_mfma_f32_16x16x32_bf16 a[76:79], a[160:163], v[72:75], 0
    ds_read_b128 v[84:87], v28 offset:2048
    v_fma_f32 v101, v101, s52, -v45
    v_mfma_f32_16x16x32_bf16 a[80:83], a[160:163], v[80:83], 0
    s_waitcnt lgkmcnt(9)
    ds_read_b64_tr_b16 a[160:161], v17 offset:24576
    v_fma_f32 v102, v102, s52, -v45
    v_mfma_f32_16x16x32_bf16 a[84:87], a[164:167], v[64:67], 0
    ds_read_b64_tr_b16 a[162:163], v17 offset:30720
    v_fma_f32 v103, v103, s52, -v45
    v_mfma_f32_16x16x32_bf16 a[88:91], a[164:167], v[72:75], 0
    s_waitcnt vmcnt(6)
    buffer_load_dwordx4 v9, s[24:27], s57 offen offset:1024 lds
    v_mfma_f32_16x16x32_bf16 a[92:95], a[164:167], v[80:83], 0
    ds_read_b64_tr_b16 a[164:165], v18 offset:24576
    ds_read_b64_tr_b16 a[166:167], v18 offset:30720
    v_mfma_f32_16x16x32_bf16 a[96:99], a[168:171], v[64:67], 0
    v_exp_f32 v99, v99
    v_mfma_f32_16x16x32_bf16 a[100:103], a[168:171], v[72:75], 0
    v_exp_f32 v106, v106
    v_mfma_f32_16x16x32_bf16 a[104:107], a[168:171], v[80:83], 0
    s_waitcnt lgkmcnt(4)
    ds_read_b64_tr_b16 a[168:169], v19 offset:24576
    ds_read_b64_tr_b16 a[170:171], v19 offset:30720
    v_mfma_f32_16x16x32_bf16 a[108:111], a[172:175], v[64:67], 0
    v_exp_f32 v107, v107
    v_mfma_f32_16x16x32_bf16 a[112:115], a[172:175], v[72:75], 0
    v_fma_f32 v108, v108, s52, -v46
    v_fma_f32 v109, v109, s52, -v46
    v_mfma_f32_16x16x32_bf16 a[116:119], a[172:175], v[80:83], 0
    ds_read_b64_tr_b16 a[172:173], v20 offset:24576
    ds_read_b64_tr_b16 a[174:175], v20 offset:30720
    v_mfma_f32_16x16x32_bf16 a[120:123], a[176:179], v[64:67], 0
    v_fma_f32 v110, v110, s52, -v46
    v_fma_f32 v111, v111, s52, -v46
    v_mfma_f32_16x16x32_bf16 a[124:127], a[176:179], v[72:75], 0
    v_exp_f32 v92, v92
    v_mfma_f32_16x16x32_bf16 a[128:131], a[176:179], v[80:83], 0
    s_waitcnt vmcnt(6)
    buffer_load_dwordx4 v10, s[24:27], s57 offen offset:2048 lds
    v_mfma_f32_16x16x32_bf16 a[132:135], a[180:183], v[64:67], 0
    s_mov_b32 s57, 3219456
    ds_read_b64_tr_b16 a[176:177], v17 offset:24704
    ds_read_b64_tr_b16 a[178:179], v17 offset:30848
    v_mfma_f32_16x16x32_bf16 a[136:139], a[180:183], v[72:75], 0
    s_add_u32 m0, s51, 24576
    v_exp_f32 v93, v93
    v_mfma_f32_16x16x32_bf16 a[140:143], a[180:183], v[80:83], 0
    s_waitcnt lgkmcnt(4)
    ds_read_b64_tr_b16 a[180:181], v18 offset:24704
    ds_read_b64_tr_b16 a[182:183], v18 offset:30848
    v_mfma_f32_16x16x32_bf16 a[72:75], a[160:163], v[68:71], a[72:75]
    v_exp_f32 v94, v94
    v_mfma_f32_16x16x32_bf16 a[76:79], a[160:163], v[76:79], a[76:79]
    v_exp_f32 v95, v95
    v_mfma_f32_16x16x32_bf16 a[80:83], a[160:163], v[84:87], a[80:83]
    v_exp_f32 v100, v100
    v_mfma_f32_16x16x32_bf16 a[84:87], a[164:167], v[68:71], a[84:87]
    v_exp_f32 v101, v101
    v_mfma_f32_16x16x32_bf16 a[88:91], a[164:167], v[76:79], a[88:91]
    v_exp_f32 v102, v102
    v_mfma_f32_16x16x32_bf16 a[92:95], a[164:167], v[84:87], a[92:95]
    v_exp_f32 v103, v103
    v_mfma_f32_16x16x32_bf16 a[96:99], a[168:171], v[68:71], a[96:99]
    v_exp_f32 v108, v108
    v_mfma_f32_16x16x32_bf16 a[100:103], a[168:171], v[76:79], a[100:103]
    v_exp_f32 v109, v109
    v_mfma_f32_16x16x32_bf16 a[104:107], a[168:171], v[84:87], a[104:107]
    s_waitcnt lgkmcnt(0)
    v_exp_f32 v110, v110
    v_mfma_f32_16x16x32_bf16 a[108:111], a[172:175], v[68:71], a[108:111]
    v_exp_f32 v111, v111
    v_mfma_f32_16x16x32_bf16 a[112:115], a[172:175], v[76:79], a[112:115]
    v_cvt_pk_bf16_f32 v88, v88, v89
    v_cvt_pk_bf16_f32 v96, v96, v97
    v_mfma_f32_16x16x32_bf16 a[116:119], a[172:175], v[84:87], a[116:119]
    v_cvt_pk_bf16_f32 v104, v104, v105
    v_cvt_pk_bf16_f32 v89, v90, v91
    v_mfma_f32_16x16x32_bf16 a[120:123], a[176:179], v[68:71], a[120:123]
    v_cvt_pk_bf16_f32 v97, v98, v99
    v_cvt_pk_bf16_f32 v105, v106, v107
    v_mfma_f32_16x16x32_bf16 a[124:127], a[176:179], v[76:79], a[124:127]
    v_cvt_pk_bf16_f32 v90, v92, v93
    v_cvt_pk_bf16_f32 v91, v94, v95
    v_mfma_f32_16x16x32_bf16 a[128:131], a[176:179], v[84:87], a[128:131]
    ds_write_b128 v27, v[88:91] offset:12288
    v_mfma_f32_16x16x32_bf16 a[132:135], a[180:183], v[68:71], a[132:135]
    v_cvt_pk_bf16_f32 v98, v100, v101
    v_cvt_pk_bf16_f32 v99, v102, v103
    v_mfma_f32_16x16x32_bf16 a[136:139], a[180:183], v[76:79], a[136:139]
    ds_write_b128 v27, v[96:99] offset:13312
    v_mfma_f32_16x16x32_bf16 a[140:143], a[180:183], v[84:87], a[140:143]
    v_cvt_pk_bf16_f32 v106, v108, v109
    v_cvt_pk_bf16_f32 v107, v110, v111
    v_mfma_f32_16x16x32_bf16 a[144:147], a[156:159], v[88:91], a[144:147]
    v_fma_f32 v112, v112, s52, -v44
    v_fma_f32 v113, v113, s52, -v44
    v_mfma_f32_16x16x32_bf16 a[148:151], a[156:159], v[96:99], a[148:151]
    ds_write_b128 v27, v[104:107] offset:14336
    v_mfma_f32_16x16x32_bf16 a[152:155], a[156:159], v[104:107], a[152:155]
    v_fma_f32 v120, v120, s52, -v45
    v_fma_f32 v121, v121, s52, -v45
    v_fma_f32 v128, v128, s52, -v46
    v_fma_f32 v129, v129, s52, -v46
    v_exp_f32 v112, v112
    v_exp_f32 v113, v113
    v_fma_f32 v114, v114, s52, -v44
    v_fma_f32 v115, v115, s52, -v44
    v_exp_f32 v120, v120
    v_exp_f32 v121, v121
    v_fma_f32 v122, v122, s52, -v45
    v_fma_f32 v123, v123, s52, -v45
    v_exp_f32 v128, v128
    v_exp_f32 v129, v129
    v_fma_f32 v130, v130, s52, -v46
    v_fma_f32 v131, v131, s52, -v46
    v_exp_f32 v114, v114
    s_waitcnt vmcnt(0) lgkmcnt(0)
    s_barrier
    ds_read_b64_tr_b16 a[160:161], v13 offset:49152
    ds_read_b64_tr_b16 a[162:163], v13 offset:55296
    ds_read_b64_tr_b16 a[164:165], v14 offset:49152
    buffer_load_dwordx4 v2, s[16:19], s57 offen nt lds
    ds_read_b64_tr_b16 a[166:167], v14 offset:55296
    ds_read_b64_tr_b16 a[168:169], v15 offset:49152
    v_exp_f32 v115, v115
    ds_read_b64_tr_b16 a[170:171], v15 offset:55296
    ds_read_b64_tr_b16 a[172:173], v16 offset:49152
    ds_read_b64_tr_b16 a[174:175], v16 offset:55296
    v_fma_f32 v116, v116, s52, -v44
    ds_read_b64_tr_b16 a[176:177], v13 offset:49280
    ds_read_b64_tr_b16 a[178:179], v13 offset:55424
    ds_read_b64_tr_b16 a[180:181], v14 offset:49280
    v_fma_f32 v117, v117, s52, -v44
    ds_read_b64_tr_b16 a[182:183], v14 offset:55424
    ds_read_b128 v[92:95], v28 offset:12288
    s_waitcnt lgkmcnt(11)
    v_mfma_f32_16x16x32_bf16 a[72:75], a[160:163], v[88:91], a[72:75]
    ds_read_b128 v[100:103], v28 offset:13312
    v_fma_f32 v118, v118, s52, -v44
    v_mfma_f32_16x16x32_bf16 a[76:79], a[160:163], v[96:99], a[76:79]
    buffer_load_dwordx4 v3, s[16:19], s57 offen offset:1024 nt lds
    v_mfma_f32_16x16x32_bf16 a[80:83], a[160:163], v[104:107], a[80:83]
    s_waitcnt lgkmcnt(9)
    ds_read_b64_tr_b16 a[160:161], v17 offset:49152
    ds_read_b64_tr_b16 a[162:163], v17 offset:55296
    v_mfma_f32_16x16x32_bf16 a[84:87], a[164:167], v[88:91], a[84:87]
    ds_read_b128 v[108:111], v28 offset:14336
    v_fma_f32 v119, v119, s52, -v44
    v_mfma_f32_16x16x32_bf16 a[88:91], a[164:167], v[96:99], a[88:91]
    ds_read_b64_tr_b16 a[184:185], v25 offset:0
    ds_read_b64_tr_b16 a[186:187], v25 offset:2048
    v_mfma_f32_16x16x32_bf16 a[92:95], a[164:167], v[104:107], a[92:95]
    s_waitcnt lgkmcnt(8)
    ds_read_b64_tr_b16 a[164:165], v18 offset:49152
    ds_read_b64_tr_b16 a[166:167], v18 offset:55296
    v_mfma_f32_16x16x32_bf16 a[96:99], a[168:171], v[88:91], a[96:99]
    ds_read_b64_tr_b16 a[188:189], v26 offset:0
    ds_read_b64_tr_b16 a[190:191], v26 offset:2048
    v_mfma_f32_16x16x32_bf16 a[100:103], a[168:171], v[96:99], a[100:103]
    ds_read_b64_tr_b16 a[192:193], v25 offset:4096
    ds_read_b64_tr_b16 a[194:195], v25 offset:6144
    v_mfma_f32_16x16x32_bf16 a[104:107], a[168:171], v[104:107], a[104:107]
    buffer_load_dwordx4 v4, s[16:19], s57 offen offset:2048 nt lds
    v_mfma_f32_16x16x32_bf16 a[108:111], a[172:175], v[88:91], a[108:111]
    s_mov_b32 s57, 3231744
    ds_read_b64_tr_b16 a[168:169], v19 offset:49152
    ds_read_b64_tr_b16 a[170:171], v19 offset:55296
    v_mfma_f32_16x16x32_bf16 a[112:115], a[172:175], v[96:99], a[112:115]
    s_add_u32 m0, s51, 36864
    ds_read_b64_tr_b16 a[196:197], v26 offset:4096
    ds_read_b64_tr_b16 a[198:199], v26 offset:6144
    v_mfma_f32_16x16x32_bf16 a[116:119], a[172:175], v[104:107], a[116:119]
    ds_read_b64_tr_b16 a[172:173], v20 offset:49152
    ds_read_b64_tr_b16 a[174:175], v20 offset:55296
    v_mfma_f32_16x16x32_bf16 a[120:123], a[176:179], v[88:91], a[120:123]
    v_exp_f32 v122, v122
    v_mfma_f32_16x16x32_bf16 a[124:127], a[176:179], v[96:99], a[124:127]
    v_exp_f32 v123, v123
    v_mfma_f32_16x16x32_bf16 a[128:131], a[176:179], v[104:107], a[128:131]
    s_waitcnt lgkmcnt(6)
    ds_read_b64_tr_b16 a[176:177], v17 offset:49280
    ds_read_b64_tr_b16 a[178:179], v17 offset:55424
    v_mfma_f32_16x16x32_bf16 a[132:135], a[180:183], v[88:91], a[132:135]
    buffer_load_dwordx4 v2, s[16:19], s57 offen nt lds
    v_mfma_f32_16x16x32_bf16 a[136:139], a[180:183], v[96:99], a[136:139]
    v_fma_f32 v124, v124, s52, -v45
    v_fma_f32 v125, v125, s52, -v45
    v_mfma_f32_16x16x32_bf16 a[140:143], a[180:183], v[104:107], a[140:143]
    ds_read_b64_tr_b16 a[180:181], v18 offset:49280
    ds_read_b64_tr_b16 a[182:183], v18 offset:55424
    v_mfma_f32_16x16x32_bf16 a[72:75], a[160:163], v[92:95], a[72:75]
    v_fma_f32 v126, v126, s52, -v45
    v_fma_f32 v127, v127, s52, -v45
    v_mfma_f32_16x16x32_bf16 a[76:79], a[160:163], v[100:103], a[76:79]
    v_exp_f32 v130, v130
    v_mfma_f32_16x16x32_bf16 a[80:83], a[160:163], v[108:111], a[80:83]
    v_exp_f32 v131, v131
    v_mfma_f32_16x16x32_bf16 a[84:87], a[164:167], v[92:95], a[84:87]
    v_fma_f32 v132, v132, s52, -v46
    v_fma_f32 v133, v133, s52, -v46
    v_mfma_f32_16x16x32_bf16 a[88:91], a[164:167], v[100:103], a[88:91]
    buffer_load_dwordx4 v3, s[16:19], s57 offen offset:1024 nt lds
    v_mfma_f32_16x16x32_bf16 a[92:95], a[164:167], v[108:111], a[92:95]
    s_waitcnt lgkmcnt(2)
    v_fma_f32 v134, v134, s52, -v46
    v_fma_f32 v135, v135, s52, -v46
    v_mfma_f32_16x16x32_bf16 a[96:99], a[168:171], v[92:95], a[96:99]
    v_exp_f32 v116, v116
    v_mfma_f32_16x16x32_bf16 a[100:103], a[168:171], v[100:103], a[100:103]
    v_exp_f32 v117, v117
    v_mfma_f32_16x16x32_bf16 a[104:107], a[168:171], v[108:111], a[104:107]
    v_exp_f32 v118, v118
    v_mfma_f32_16x16x32_bf16 a[108:111], a[172:175], v[92:95], a[108:111]
    v_exp_f32 v119, v119
    v_mfma_f32_16x16x32_bf16 a[112:115], a[172:175], v[100:103], a[112:115]
    v_exp_f32 v124, v124
    v_mfma_f32_16x16x32_bf16 a[116:119], a[172:175], v[108:111], a[116:119]
    buffer_load_dwordx4 v4, s[16:19], s57 offen offset:2048 nt lds
    v_mfma_f32_16x16x32_bf16 a[120:123], a[176:179], v[92:95], a[120:123]
    s_mov_b32 s57, 3244032
    v_exp_f32 v125, v125
    v_mfma_f32_16x16x32_bf16 a[124:127], a[176:179], v[100:103], a[124:127]
    s_add_u32 m0, s51, 49152
    v_exp_f32 v126, v126
    v_mfma_f32_16x16x32_bf16 a[128:131], a[176:179], v[108:111], a[128:131]
    s_waitcnt lgkmcnt(0)
    v_exp_f32 v127, v127
    v_mfma_f32_16x16x32_bf16 a[132:135], a[180:183], v[92:95], a[132:135]
    v_exp_f32 v132, v132
    v_mfma_f32_16x16x32_bf16 a[136:139], a[180:183], v[100:103], a[136:139]
    v_exp_f32 v133, v133
    v_mfma_f32_16x16x32_bf16 a[140:143], a[180:183], v[108:111], a[140:143]
    v_exp_f32 v134, v134
    v_mfma_f32_16x16x32_bf16 v[64:67], a[184:187], a[0:3], 0
    v_exp_f32 v135, v135
    v_mfma_f32_16x16x32_bf16 v[72:75], a[184:187], a[4:7], 0
    v_cvt_pk_bf16_f32 v112, v112, v113
    v_cvt_pk_bf16_f32 v120, v120, v121
    v_mfma_f32_16x16x32_bf16 v[80:83], a[184:187], a[8:11], 0
    v_cvt_pk_bf16_f32 v128, v128, v129
    v_cvt_pk_bf16_f32 v113, v114, v115
    v_mfma_f32_16x16x32_bf16 v[68:71], a[188:191], a[0:3], 0
    v_cvt_pk_bf16_f32 v121, v122, v123
    v_cvt_pk_bf16_f32 v129, v130, v131
    v_mfma_f32_16x16x32_bf16 v[76:79], a[188:191], a[4:7], 0
    v_cvt_pk_bf16_f32 v114, v116, v117
    v_cvt_pk_bf16_f32 v115, v118, v119
    v_mfma_f32_16x16x32_bf16 v[84:87], a[188:191], a[8:11], 0
    ds_write_b128 v27, v[112:115] offset:0
    v_mfma_f32_16x16x32_bf16 v[64:67], a[192:195], a[12:15], v[64:67]
    v_cvt_pk_bf16_f32 v122, v124, v125
    v_cvt_pk_bf16_f32 v123, v126, v127
    v_mfma_f32_16x16x32_bf16 v[72:75], a[192:195], a[16:19], v[72:75]
    ds_write_b128 v27, v[120:123] offset:1024
    v_mfma_f32_16x16x32_bf16 v[80:83], a[192:195], a[20:23], v[80:83]
    v_cvt_pk_bf16_f32 v130, v132, v133
    v_cvt_pk_bf16_f32 v131, v134, v135
    v_mfma_f32_16x16x32_bf16 v[68:71], a[196:199], a[12:15], v[68:71]
    v_fma_f32 v136, v136, s52, -v44
    v_fma_f32 v137, v137, s52, -v44
    v_mfma_f32_16x16x32_bf16 v[76:79], a[196:199], a[16:19], v[76:79]
    ds_write_b128 v27, v[128:131] offset:2048
    v_mfma_f32_16x16x32_bf16 v[84:87], a[196:199], a[20:23], v[84:87]
    v_fma_f32 v144, v144, s52, -v45
    v_fma_f32 v145, v145, s52, -v45
    v_mfma_f32_16x16x32_bf16 a[144:147], a[156:159], v[112:115], a[144:147]
    ds_read_b64_tr_b16 a[200:201], v25 offset:8192
    v_fma_f32 v152, v152, s52, -v46
    v_mfma_f32_16x16x32_bf16 a[148:151], a[156:159], v[120:123], a[148:151]
    ds_read_b64_tr_b16 a[202:203], v25 offset:10240
    ds_read_b64_tr_b16 a[204:205], v26 offset:8192
    v_mfma_f32_16x16x32_bf16 a[152:155], a[156:159], v[128:131], a[152:155]
    ds_read_b64_tr_b16 a[206:207], v26 offset:10240
    ds_read_b64_tr_b16 a[184:185], v25 offset:12288
    ds_read_b64_tr_b16 a[186:187], v25 offset:14336
    v_fma_f32 v153, v153, s52, -v46
    v_exp_f32 v136, v136
    v_exp_f32 v137, v137
    v_fma_f32 v138, v138, s52, -v44
    v_fma_f32 v139, v139, s52, -v44
    v_exp_f32 v144, v144
    s_waitcnt lgkmcnt(6)
    s_barrier
    ds_read_b64_tr_b16 a[160:161], v13 offset:0
    ds_read_b64_tr_b16 a[162:163], v13 offset:6144
    ds_read_b64_tr_b16 a[164:165], v14 offset:0
    buffer_load_dwordx4 v2, s[16:19], s57 offen nt lds
    ds_read_b64_tr_b16 a[166:167], v14 offset:6144
    ds_read_b64_tr_b16 a[168:169], v15 offset:0
    v_exp_f32 v145, v145
    ds_read_b64_tr_b16 a[170:171], v15 offset:6144
    ds_read_b64_tr_b16 a[172:173], v16 offset:0
    ds_read_b64_tr_b16 a[174:175], v16 offset:6144
    v_fma_f32 v146, v146, s52, -v45
    ds_read_b64_tr_b16 a[176:177], v13 offset:128
    ds_read_b64_tr_b16 a[178:179], v13 offset:6272
    ds_read_b64_tr_b16 a[180:181], v14 offset:128
    s_waitcnt vmcnt(6)
    buffer_load_dwordx4 v3, s[16:19], s57 offen offset:1024 nt lds
    ds_read_b64_tr_b16 a[182:183], v14 offset:6272
    ds_read_b128 v[116:119], v28 offset:0
    v_fma_f32 v147, v147, s52, -v45
    s_waitcnt lgkmcnt(11)
    v_mfma_f32_16x16x32_bf16 a[72:75], a[160:163], v[112:115], a[72:75]
    ds_read_b128 v[124:127], v28 offset:1024
    v_fma_f32 v154, v154, s52, -v46
    v_mfma_f32_16x16x32_bf16 a[76:79], a[160:163], v[120:123], a[76:79]
    ds_read_b128 v[132:135], v28 offset:2048
    v_fma_f32 v155, v155, s52, -v46
    v_mfma_f32_16x16x32_bf16 a[80:83], a[160:163], v[128:131], a[80:83]
    s_waitcnt lgkmcnt(10)
    ds_read_b64_tr_b16 a[160:161], v17 offset:0
    v_fma_f32 v140, v140, s52, -v44
    v_mfma_f32_16x16x32_bf16 a[84:87], a[164:167], v[112:115], a[84:87]
    s_waitcnt vmcnt(6)
    buffer_load_dwordx4 v4, s[16:19], s57 offen offset:2048 nt lds
    v_mfma_f32_16x16x32_bf16 a[88:91], a[164:167], v[120:123], a[88:91]
    s_mov_b32 s57, 3256320
    ds_read_b64_tr_b16 a[162:163], v17 offset:6144
    s_add_u32 m0, s51, 61440
    v_mfma_f32_16x16x32_bf16 a[92:95], a[164:167], v[128:131], a[92:95]
    s_waitcnt lgkmcnt(6)
    ds_read_b64_tr_b16 a[164:165], v18 offset:0
    ds_read_b64_tr_b16 a[166:167], v18 offset:6144
    v_mfma_f32_16x16x32_bf16 a[96:99], a[168:171], v[112:115], a[96:99]
    ds_read_b64_tr_b16 a[188:189], v26 offset:12288
    ds_read_b64_tr_b16 a[190:191], v26 offset:14336
    v_mfma_f32_16x16x32_bf16 a[100:103], a[168:171], v[120:123], a[100:103]
    v_exp_f32 v152, v152
    v_mfma_f32_16x16x32_bf16 a[104:107], a[168:171], v[128:131], a[104:107]
    s_waitcnt vmcnt(6)
    buffer_load_dwordx4 v2, s[16:19], s57 offen nt lds
    v_mfma_f32_16x16x32_bf16 a[108:111], a[172:175], v[112:115], a[108:111]
    ds_read_b64_tr_b16 a[168:169], v19 offset:0
    ds_read_b64_tr_b16 a[170:171], v19 offset:6144
    v_mfma_f32_16x16x32_bf16 a[112:115], a[172:175], v[120:123], a[112:115]
    v_exp_f32 v153, v153
    v_mfma_f32_16x16x32_bf16 a[116:119], a[172:175], v[128:131], a[116:119]
    ds_read_b64_tr_b16 a[172:173], v20 offset:0
    ds_read_b64_tr_b16 a[174:175], v20 offset:6144
    v_mfma_f32_16x16x32_bf16 a[120:123], a[176:179], v[112:115], a[120:123]
    v_exp_f32 v138, v138
    v_mfma_f32_16x16x32_bf16 a[124:127], a[176:179], v[120:123], a[124:127]
    s_waitcnt vmcnt(6)
    buffer_load_dwordx4 v3, s[16:19], s57 offen offset:1024 nt lds
    v_mfma_f32_16x16x32_bf16 a[128:131], a[176:179], v[128:131], a[128:131]
    s_waitcnt lgkmcnt(4)
    ds_read_b64_tr_b16 a[176:177], v17 offset:128
    ds_read_b64_tr_b16 a[178:179], v17 offset:6272
    v_mfma_f32_16x16x32_bf16 a[132:135], a[180:183], v[112:115], a[132:135]
    v_exp_f32 v139, v139
    v_mfma_f32_16x16x32_bf16 a[136:139], a[180:183], v[120:123], a[136:139]
    v_fma_f32 v141, v141, s52, -v44
    v_fma_f32 v142, v142, s52, -v44
    v_mfma_f32_16x16x32_bf16 a[140:143], a[180:183], v[128:131], a[140:143]
    ds_read_b64_tr_b16 a[180:181], v18 offset:128
    ds_read_b64_tr_b16 a[182:183], v18 offset:6272
    v_mfma_f32_16x16x32_bf16 a[72:75], a[160:163], v[116:119], a[72:75]
    s_waitcnt vmcnt(6)
    buffer_load_dwordx4 v4, s[16:19], s57 offen offset:2048 nt lds
    v_mfma_f32_16x16x32_bf16 a[76:79], a[160:163], v[124:127], a[76:79]
    s_add_u32 m0, s51, 73728
    s_sub_u32 s57, s45, 1280
    s_cselect_b32 s45, s45, s57
    v_mfma_f32_16x16x32_bf16 a[80:83], a[160:163], v[132:135], a[80:83]
    s_add_u32 s57, s45, 0
    v_fma_f32 v143, v143, s52, -v44
    v_fma_f32 v148, v148, s52, -v45
    v_mfma_f32_16x16x32_bf16 a[84:87], a[164:167], v[116:119], a[84:87]
    s_add_u32 s45, s44, 1152
    v_exp_f32 v146, v146
    v_mfma_f32_16x16x32_bf16 a[88:91], a[164:167], v[124:127], a[88:91]
    v_exp_f32 v147, v147
    v_mfma_f32_16x16x32_bf16 a[92:95], a[164:167], v[132:135], a[92:95]
    s_waitcnt lgkmcnt(2)
    s_waitcnt vmcnt(6)
    buffer_load_dwordx4 v8, s[24:27], s57 offen lds
    v_mfma_f32_16x16x32_bf16 a[96:99], a[168:171], v[116:119], a[96:99]
    v_fma_f32 v149, v149, s52, -v45
    v_fma_f32 v150, v150, s52, -v45
    v_mfma_f32_16x16x32_bf16 a[100:103], a[168:171], v[124:127], a[100:103]
    v_fma_f32 v151, v151, s52, -v45
    v_fma_f32 v156, v156, s52, -v46
    v_mfma_f32_16x16x32_bf16 a[104:107], a[168:171], v[132:135], a[104:107]
    v_exp_f32 v154, v154
    v_mfma_f32_16x16x32_bf16 a[108:111], a[172:175], v[116:119], a[108:111]
    v_exp_f32 v155, v155
    v_mfma_f32_16x16x32_bf16 a[112:115], a[172:175], v[124:127], a[112:115]
    s_waitcnt vmcnt(6)
    buffer_load_dwordx4 v9, s[24:27], s57 offen offset:1024 lds
    v_mfma_f32_16x16x32_bf16 a[116:119], a[172:175], v[132:135], a[116:119]
    v_fma_f32 v157, v157, s52, -v46
    v_fma_f32 v158, v158, s52, -v46
    v_mfma_f32_16x16x32_bf16 a[120:123], a[176:179], v[116:119], a[120:123]
    v_fma_f32 v159, v159, s52, -v46
    v_cvt_pk_bf16_f32 v136, v136, v137
    v_mfma_f32_16x16x32_bf16 a[124:127], a[176:179], v[124:127], a[124:127]
    v_exp_f32 v140, v140
    v_mfma_f32_16x16x32_bf16 a[128:131], a[176:179], v[132:135], a[128:131]
    s_waitcnt lgkmcnt(0)
    v_exp_f32 v141, v141
    v_mfma_f32_16x16x32_bf16 a[132:135], a[180:183], v[116:119], a[132:135]
    s_waitcnt vmcnt(6)
    buffer_load_dwordx4 v10, s[24:27], s57 offen offset:2048 lds
    v_mfma_f32_16x16x32_bf16 a[136:139], a[180:183], v[124:127], a[136:139]
    s_add_u32 m0, s51, 86016
    v_exp_f32 v142, v142
    v_mfma_f32_16x16x32_bf16 a[140:143], a[180:183], v[132:135], a[140:143]
    v_exp_f32 v143, v143
    v_mfma_f32_16x16x32_bf16 v[64:67], a[200:203], a[24:27], v[64:67]
    v_exp_f32 v148, v148
    v_mfma_f32_16x16x32_bf16 v[72:75], a[200:203], a[28:31], v[72:75]
    v_exp_f32 v149, v149
    v_mfma_f32_16x16x32_bf16 v[80:83], a[200:203], a[32:35], v[80:83]
    v_exp_f32 v150, v150
    v_mfma_f32_16x16x32_bf16 v[68:71], a[204:207], a[24:27], v[68:71]
    v_exp_f32 v151, v151
    v_mfma_f32_16x16x32_bf16 v[76:79], a[204:207], a[28:31], v[76:79]
    v_exp_f32 v156, v156
    v_mfma_f32_16x16x32_bf16 v[84:87], a[204:207], a[32:35], v[84:87]
    v_exp_f32 v157, v157
    v_mfma_f32_16x16x32_bf16 v[64:67], a[184:187], a[36:39], v[64:67]
    v_exp_f32 v158, v158
    v_mfma_f32_16x16x32_bf16 v[72:75], a[184:187], a[40:43], v[72:75]
    v_exp_f32 v159, v159
    v_mfma_f32_16x16x32_bf16 v[80:83], a[184:187], a[44:47], v[80:83]
    v_cvt_pk_bf16_f32 v144, v144, v145
    v_cvt_pk_bf16_f32 v152, v152, v153
    v_mfma_f32_16x16x32_bf16 v[68:71], a[188:191], a[36:39], v[68:71]
    v_cvt_pk_bf16_f32 v137, v138, v139
    v_cvt_pk_bf16_f32 v145, v146, v147
    v_mfma_f32_16x16x32_bf16 v[76:79], a[188:191], a[40:43], v[76:79]
    v_cvt_pk_bf16_f32 v153, v154, v155
    v_cvt_pk_bf16_f32 v138, v140, v141
    v_mfma_f32_16x16x32_bf16 v[84:87], a[188:191], a[44:47], v[84:87]
    v_cvt_pk_bf16_f32 v139, v142, v143
    v_cvt_pk_bf16_f32 v146, v148, v149
    v_cvt_pk_bf16_f32 v147, v150, v151
    v_mfma_f32_16x16x32_bf16 a[144:147], a[156:159], v[136:139], a[144:147]
    ds_write_b128 v27, v[136:139] offset:12288
    v_mfma_f32_16x16x32_bf16 a[148:151], a[156:159], v[144:147], a[148:151]
    v_cvt_pk_bf16_f32 v154, v156, v157
    v_cvt_pk_bf16_f32 v155, v158, v159
    s_sub_u32 s57, s45, 1280
    s_cselect_b32 s45, s45, s57
    v_mfma_f32_16x16x32_bf16 a[152:155], a[156:159], v[152:155], a[152:155]
    s_add_u32 s57, s45, 122880
    ds_write_b128 v27, v[144:147] offset:13312
    v_fma_f32 v160, v160, s52, -v44
    v_fma_f32 v161, v161, s52, -v44
    v_fma_f32 v168, v168, s52, -v45
    v_fma_f32 v169, v169, s52, -v45
    v_fma_f32 v176, v176, s52, -v46
    v_fma_f32 v177, v177, s52, -v46
    ds_write_b128 v27, v[152:155] offset:14336
    v_exp_f32 v160, v160
    v_exp_f32 v161, v161
    v_fma_f32 v162, v162, s52, -v44
    v_fma_f32 v163, v163, s52, -v44
    ds_read_b64_tr_b16 a[192:193], v25 offset:16384
    ds_read_b64_tr_b16 a[194:195], v25 offset:18432
    ds_read_b64_tr_b16 a[196:197], v26 offset:16384
    v_exp_f32 v168, v168
    v_exp_f32 v169, v169
    v_fma_f32 v170, v170, s52, -v45
    v_fma_f32 v171, v171, s52, -v45
    v_exp_f32 v176, v176
    v_exp_f32 v177, v177
    v_fma_f32 v178, v178, s52, -v46
    v_fma_f32 v179, v179, s52, -v46
    v_exp_f32 v162, v162
    s_waitcnt lgkmcnt(3)
    s_barrier
    ds_read_b64_tr_b16 a[160:161], v13 offset:24576
    ds_read_b64_tr_b16 a[162:163], v13 offset:30720
    ds_read_b64_tr_b16 a[164:165], v14 offset:24576
    s_waitcnt vmcnt(6)
    buffer_load_dwordx4 v8, s[24:27], s57 offen lds
    ds_read_b64_tr_b16 a[166:167], v14 offset:30720
    ds_read_b64_tr_b16 a[168:169], v15 offset:24576
    v_exp_f32 v163, v163
    ds_read_b64_tr_b16 a[170:171], v15 offset:30720
    ds_read_b64_tr_b16 a[172:173], v16 offset:24576
    ds_read_b64_tr_b16 a[174:175], v16 offset:30720
    v_fma_f32 v164, v164, s52, -v44
    ds_read_b64_tr_b16 a[176:177], v13 offset:24704
    ds_read_b64_tr_b16 a[178:179], v13 offset:30848
    ds_read_b64_tr_b16 a[180:181], v14 offset:24704
    s_waitcnt vmcnt(6)
    buffer_load_dwordx4 v9, s[24:27], s57 offen offset:1024 lds
    ds_read_b64_tr_b16 a[182:183], v14 offset:30848
    ds_read_b128 v[140:143], v28 offset:12288
    v_fma_f32 v165, v165, s52, -v44
    s_waitcnt lgkmcnt(11)
    v_mfma_f32_16x16x32_bf16 a[72:75], a[160:163], v[136:139], a[72:75]
    s_add_u32 s45, s44, 128
    ds_read_b128 v[148:151], v28 offset:13312
    v_fma_f32 v166, v166, s52, -v44
    v_mfma_f32_16x16x32_bf16 a[76:79], a[160:163], v[144:147], a[76:79]
    ds_read_b128 v[156:159], v28 offset:14336
    v_fma_f32 v167, v167, s52, -v44
    v_mfma_f32_16x16x32_bf16 a[80:83], a[160:163], v[152:155], a[80:83]
    s_waitcnt lgkmcnt(10)
    ds_read_b64_tr_b16 a[160:161], v17 offset:24576
    v_fma_f32 v172, v172, s52, -v45
    v_mfma_f32_16x16x32_bf16 a[84:87], a[164:167], v[136:139], a[84:87]
    s_waitcnt vmcnt(6)
    buffer_load_dwordx4 v10, s[24:27], s57 offen offset:2048 lds
    v_mfma_f32_16x16x32_bf16 a[88:91], a[164:167], v[144:147], a[88:91]
    s_mov_b32 s57, 3268608
    ds_read_b64_tr_b16 a[162:163], v17 offset:30720
    s_add_u32 m0, s51, 0
    v_mfma_f32_16x16x32_bf16 a[92:95], a[164:167], v[152:155], a[92:95]
    s_waitcnt lgkmcnt(6)
    ds_read_b64_tr_b16 a[164:165], v18 offset:24576
    ds_read_b64_tr_b16 a[166:167], v18 offset:30720
    v_mfma_f32_16x16x32_bf16 a[96:99], a[168:171], v[136:139], a[96:99]
    ds_read_b64_tr_b16 a[198:199], v26 offset:18432
    ds_read_b64_tr_b16 a[200:201], v25 offset:20480
    v_mfma_f32_16x16x32_bf16 a[100:103], a[168:171], v[144:147], a[100:103]
    ds_read_b64_tr_b16 a[202:203], v25 offset:22528
    v_fma_f32 v173, v173, s52, -v45
    v_mfma_f32_16x16x32_bf16 a[104:107], a[168:171], v[152:155], a[104:107]
    s_waitcnt vmcnt(6)
    buffer_load_dwordx4 v2, s[16:19], s57 offen nt lds
    v_mfma_f32_16x16x32_bf16 a[108:111], a[172:175], v[136:139], a[108:111]
    ds_read_b64_tr_b16 a[168:169], v19 offset:24576
    ds_read_b64_tr_b16 a[170:171], v19 offset:30720
    v_mfma_f32_16x16x32_bf16 a[112:115], a[172:175], v[144:147], a[112:115]
    ds_read_b64_tr_b16 a[204:205], v26 offset:20480
    ds_read_b64_tr_b16 a[206:207], v26 offset:22528
    v_mfma_f32_16x16x32_bf16 a[116:119], a[172:175], v[152:155], a[116:119]
    ds_read_b64_tr_b16 a[172:173], v20 offset:24576
    ds_read_b64_tr_b16 a[174:175], v20 offset:30720
    v_mfma_f32_16x16x32_bf16 a[120:123], a[176:179], v[136:139], a[120:123]
    v_exp_f32 v170, v170
    v_mfma_f32_16x16x32_bf16 a[124:127], a[176:179], v[144:147], a[124:127]
    s_waitcnt vmcnt(6)
    buffer_load_dwordx4 v3, s[16:19], s57 offen offset:1024 nt lds
    v_mfma_f32_16x16x32_bf16 a[128:131], a[176:179], v[152:155], a[128:131]
    s_waitcnt lgkmcnt(6)
    ds_read_b64_tr_b16 a[176:177], v17 offset:24704
    ds_read_b64_tr_b16 a[178:179], v17 offset:30848
    v_mfma_f32_16x16x32_bf16 a[132:135], a[180:183], v[136:139], a[132:135]
    v_exp_f32 v171, v171
    v_mfma_f32_16x16x32_bf16 a[136:139], a[180:183], v[144:147], a[136:139]
    v_fma_f32 v174, v174, s52, -v45
    v_fma_f32 v175, v175, s52, -v45
    v_mfma_f32_16x16x32_bf16 a[140:143], a[180:183], v[152:155], a[140:143]
    ds_read_b64_tr_b16 a[180:181], v18 offset:24704
    ds_read_b64_tr_b16 a[182:183], v18 offset:30848
    v_mfma_f32_16x16x32_bf16 a[72:75], a[160:163], v[140:143], a[72:75]
    s_waitcnt vmcnt(6)
    buffer_load_dwordx4 v4, s[16:19], s57 offen offset:2048 nt lds
    v_mfma_f32_16x16x32_bf16 a[76:79], a[160:163], v[148:151], a[76:79]
    s_mov_b32 s57, 3280896
    s_add_u32 m0, s51, 12288
    v_fma_f32 v180, v180, s52, -v46
    v_mfma_f32_16x16x32_bf16 a[80:83], a[160:163], v[156:159], a[80:83]
    v_exp_f32 v178, v178
    v_mfma_f32_16x16x32_bf16 a[84:87], a[164:167], v[140:143], a[84:87]
    v_exp_f32 v179, v179
    v_mfma_f32_16x16x32_bf16 a[88:91], a[164:167], v[148:151], a[88:91]
    v_fma_f32 v181, v181, s52, -v46
    v_fma_f32 v182, v182, s52, -v46
    v_mfma_f32_16x16x32_bf16 a[92:95], a[164:167], v[156:159], a[92:95]
    s_waitcnt lgkmcnt(2)
    s_waitcnt vmcnt(6)
    buffer_load_dwordx4 v2, s[16:19], s57 offen nt lds
    v_mfma_f32_16x16x32_bf16 a[96:99], a[168:171], v[140:143], a[96:99]
    v_fma_f32 v183, v183, s52, -v46
    v_cvt_pk_bf16_f32 v160, v160, v161
    v_mfma_f32_16x16x32_bf16 a[100:103], a[168:171], v[148:151], a[100:103]
    v_exp_f32 v164, v164
    v_mfma_f32_16x16x32_bf16 a[104:107], a[168:171], v[156:159], a[104:107]
    v_exp_f32 v165, v165
    v_mfma_f32_16x16x32_bf16 a[108:111], a[172:175], v[140:143], a[108:111]
    v_exp_f32 v166, v166
    v_mfma_f32_16x16x32_bf16 a[112:115], a[172:175], v[148:151], a[112:115]
    s_waitcnt vmcnt(6)
    buffer_load_dwordx4 v3, s[16:19], s57 offen offset:1024 nt lds
    v_mfma_f32_16x16x32_bf16 a[116:119], a[172:175], v[156:159], a[116:119]
    v_exp_f32 v167, v167
    v_mfma_f32_16x16x32_bf16 a[120:123], a[176:179], v[140:143], a[120:123]
    v_exp_f32 v172, v172
    v_mfma_f32_16x16x32_bf16 a[124:127], a[176:179], v[148:151], a[124:127]
    v_exp_f32 v173, v173
    v_mfma_f32_16x16x32_bf16 a[128:131], a[176:179], v[156:159], a[128:131]
    s_waitcnt lgkmcnt(0)
    v_exp_f32 v174, v174
    v_mfma_f32_16x16x32_bf16 a[132:135], a[180:183], v[140:143], a[132:135]
    s_waitcnt vmcnt(6)
    buffer_load_dwordx4 v4, s[16:19], s57 offen offset:2048 nt lds
    v_mfma_f32_16x16x32_bf16 a[136:139], a[180:183], v[148:151], a[136:139]
    s_mov_b32 s57, 3293184
    v_exp_f32 v175, v175
    v_mfma_f32_16x16x32_bf16 a[140:143], a[180:183], v[156:159], a[140:143]
    s_add_u32 m0, s51, 24576
    v_exp_f32 v180, v180
    v_mfma_f32_16x16x32_bf16 v[64:67], a[192:195], a[48:51], v[64:67]
    v_exp_f32 v181, v181
    v_mfma_f32_16x16x32_bf16 v[72:75], a[192:195], a[52:55], v[72:75]
    v_exp_f32 v182, v182
    v_mfma_f32_16x16x32_bf16 v[80:83], a[192:195], a[56:59], v[80:83]
    v_exp_f32 v183, v183
    v_mfma_f32_16x16x32_bf16 v[68:71], a[196:199], a[48:51], v[68:71]
    v_cvt_pk_bf16_f32 v168, v168, v169
    v_cvt_pk_bf16_f32 v176, v176, v177
    v_mfma_f32_16x16x32_bf16 v[76:79], a[196:199], a[52:55], v[76:79]
    v_cvt_pk_bf16_f32 v161, v162, v163
    v_cvt_pk_bf16_f32 v169, v170, v171
    v_mfma_f32_16x16x32_bf16 v[84:87], a[196:199], a[56:59], v[84:87]
    v_cvt_pk_bf16_f32 v177, v178, v179
    v_cvt_pk_bf16_f32 v162, v164, v165
    v_mfma_f32_16x16x32_bf16 v[64:67], a[200:203], a[60:63], v[64:67]
    v_cvt_pk_bf16_f32 v163, v166, v167
    v_cvt_pk_bf16_f32 v170, v172, v173
    v_mfma_f32_16x16x32_bf16 v[72:75], a[200:203], a[64:67], v[72:75]
    ds_write_b128 v27, v[160:163] offset:0
    v_mfma_f32_16x16x32_bf16 v[80:83], a[200:203], a[68:71], v[80:83]
    v_cvt_pk_bf16_f32 v171, v174, v175
    v_cvt_pk_bf16_f32 v178, v180, v181
    v_mfma_f32_16x16x32_bf16 v[68:71], a[204:207], a[60:63], v[68:71]
    ds_write_b128 v27, v[168:171] offset:1024
    v_mfma_f32_16x16x32_bf16 v[76:79], a[204:207], a[64:67], v[76:79]
    v_cvt_pk_bf16_f32 v179, v182, v183
    v_fma_f32 v184, v184, s52, -v44
    v_mfma_f32_16x16x32_bf16 v[84:87], a[204:207], a[68:71], v[84:87]
    v_fma_f32 v185, v185, s52, -v44
    v_fma_f32 v192, v192, s52, -v45
    v_mfma_f32_16x16x32_bf16 a[144:147], a[156:159], v[160:163], a[144:147]
    ds_write_b128 v27, v[176:179] offset:2048
    v_mfma_f32_16x16x32_bf16 a[148:151], a[156:159], v[168:171], a[148:151]
    v_fma_f32 v193, v193, s52, -v45
    v_fma_f32 v200, v200, s52, -v46
    v_mfma_f32_16x16x32_bf16 a[152:155], a[156:159], v[176:179], a[152:155]
    v_fma_f32 v201, v201, s52, -v46
    v_exp_f32 v184, v184
    v_exp_f32 v185, v185
    v_fma_f32 v186, v186, s52, -v44
    v_fma_f32 v187, v187, s52, -v44
    v_exp_f32 v192, v192
    v_exp_f32 v193, v193
    v_fma_f32 v194, v194, s52, -v45
    v_fma_f32 v195, v195, s52, -v45
    v_exp_f32 v200, v200
    v_exp_f32 v201, v201
    v_fma_f32 v202, v202, s52, -v46
    v_fma_f32 v203, v203, s52, -v46
    s_waitcnt vmcnt(6) lgkmcnt(0)
    s_barrier
    ds_read_b64_tr_b16 a[160:161], v13 offset:49152
    ds_read_b64_tr_b16 a[162:163], v13 offset:55296
    ds_read_b64_tr_b16 a[164:165], v14 offset:49152
    buffer_load_dwordx4 v2, s[16:19], s57 offen nt lds
    ds_read_b64_tr_b16 a[166:167], v14 offset:55296
    ds_read_b64_tr_b16 a[168:169], v15 offset:49152
    v_exp_f32 v186, v186
    ds_read_b64_tr_b16 a[170:171], v15 offset:55296
    ds_read_b64_tr_b16 a[172:173], v16 offset:49152
    ds_read_b64_tr_b16 a[174:175], v16 offset:55296
    v_exp_f32 v187, v187
    ds_read_b64_tr_b16 a[176:177], v13 offset:49280
    ds_read_b64_tr_b16 a[178:179], v13 offset:55424
    ds_read_b64_tr_b16 a[180:181], v14 offset:49280
    v_fma_f32 v188, v188, s52, -v44
    v_fma_f32 v189, v189, s52, -v44
    v_fma_f32 v190, v190, s52, -v44
    v_fma_f32 v191, v191, s52, -v44
    s_waitcnt lgkmcnt(9)
    v_mfma_f32_16x16x32_bf16 a[72:75], a[160:163], v[160:163], a[72:75]
    ds_read_b64_tr_b16 a[182:183], v14 offset:55424
    ds_read_b128 v[164:167], v28 offset:0
    v_mfma_f32_16x16x32_bf16 a[76:79], a[160:163], v[168:171], a[76:79]
    s_waitcnt vmcnt(6)
    buffer_load_dwordx4 v3, s[16:19], s57 offen offset:1024 nt lds
    v_mfma_f32_16x16x32_bf16 a[80:83], a[160:163], v[176:179], a[80:83]
    s_waitcnt lgkmcnt(8)
    ds_read_b64_tr_b16 a[160:161], v17 offset:49152
    ds_read_b64_tr_b16 a[162:163], v17 offset:55296
    v_mfma_f32_16x16x32_bf16 a[84:87], a[164:167], v[160:163], a[84:87]
    ds_read_b128 v[172:175], v28 offset:1024
    v_fma_f32 v196, v196, s52, -v45
    v_mfma_f32_16x16x32_bf16 a[88:91], a[164:167], v[168:171], a[88:91]
    ds_read_b128 v[180:183], v28 offset:2048
    v_fma_f32 v197, v197, s52, -v45
    v_mfma_f32_16x16x32_bf16 a[92:95], a[164:167], v[176:179], a[92:95]
    s_waitcnt lgkmcnt(6)
    ds_read_b64_tr_b16 a[164:165], v18 offset:49152
    ds_read_b64_tr_b16 a[166:167], v18 offset:55296
    v_mfma_f32_16x16x32_bf16 a[96:99], a[168:171], v[160:163], a[96:99]
    ds_read_b64_tr_b16 a[184:185], v23 offset:24576
    ds_read_b64_tr_b16 a[186:187], v23 offset:26624
    v_mfma_f32_16x16x32_bf16 a[100:103], a[168:171], v[168:171], a[100:103]
    ds_read_b64_tr_b16 a[188:189], v24 offset:24576
    ds_read_b64_tr_b16 a[190:191], v24 offset:26624
    v_mfma_f32_16x16x32_bf16 a[104:107], a[168:171], v[176:179], a[104:107]
    s_waitcnt vmcnt(6)
    buffer_load_dwordx4 v4, s[16:19], s57 offen offset:2048 nt lds
    v_mfma_f32_16x16x32_bf16 a[108:111], a[172:175], v[160:163], a[108:111]
    s_mov_b32 s57, 3305472
    ds_read_b64_tr_b16 a[168:169], v19 offset:49152
    ds_read_b64_tr_b16 a[170:171], v19 offset:55296
    v_mfma_f32_16x16x32_bf16 a[112:115], a[172:175], v[168:171], a[112:115]
    s_add_u32 m0, s51, 36864
    ds_read_b64_tr_b16 a[192:193], v23 offset:28672
    ds_read_b64_tr_b16 a[194:195], v23 offset:30720
    v_mfma_f32_16x16x32_bf16 a[116:119], a[172:175], v[176:179], a[116:119]
    ds_read_b64_tr_b16 a[172:173], v20 offset:49152
    ds_read_b64_tr_b16 a[174:175], v20 offset:55296
    v_mfma_f32_16x16x32_bf16 a[120:123], a[176:179], v[160:163], a[120:123]
    ds_read_b64_tr_b16 a[196:197], v24 offset:28672
    ds_read_b64_tr_b16 a[198:199], v24 offset:30720
    v_mfma_f32_16x16x32_bf16 a[124:127], a[176:179], v[168:171], a[124:127]
    v_exp_f32 v194, v194
    v_mfma_f32_16x16x32_bf16 a[128:131], a[176:179], v[176:179], a[128:131]
    s_waitcnt lgkmcnt(8)
    ds_read_b64_tr_b16 a[176:177], v17 offset:49280
    ds_read_b64_tr_b16 a[178:179], v17 offset:55424
    v_mfma_f32_16x16x32_bf16 a[132:135], a[180:183], v[160:163], a[132:135]
    s_waitcnt vmcnt(6)
    buffer_load_dwordx4 v2, s[16:19], s57 offen nt lds
    v_mfma_f32_16x16x32_bf16 a[136:139], a[180:183], v[168:171], a[136:139]
    v_exp_f32 v195, v195
    v_mfma_f32_16x16x32_bf16 a[140:143], a[180:183], v[176:179], a[140:143]
    ds_read_b64_tr_b16 a[180:181], v18 offset:49280
    ds_read_b64_tr_b16 a[182:183], v18 offset:55424
    v_mfma_f32_16x16x32_bf16 a[72:75], a[160:163], v[164:167], a[72:75]
    v_fma_f32 v198, v198, s52, -v45
    v_fma_f32 v199, v199, s52, -v45
    v_mfma_f32_16x16x32_bf16 a[76:79], a[160:163], v[172:175], a[76:79]
    v_exp_f32 v202, v202
    v_mfma_f32_16x16x32_bf16 a[80:83], a[160:163], v[180:183], a[80:83]
    v_exp_f32 v203, v203
    v_mfma_f32_16x16x32_bf16 a[84:87], a[164:167], v[164:167], a[84:87]
    v_fma_f32 v204, v204, s52, -v46
    v_fma_f32 v205, v205, s52, -v46
    v_mfma_f32_16x16x32_bf16 a[88:91], a[164:167], v[172:175], a[88:91]
    s_waitcnt vmcnt(6)
    buffer_load_dwordx4 v3, s[16:19], s57 offen offset:1024 nt lds
    v_mfma_f32_16x16x32_bf16 a[92:95], a[164:167], v[180:183], a[92:95]
    s_waitcnt lgkmcnt(2)
    v_fma_f32 v206, v206, s52, -v46
    v_fma_f32 v207, v207, s52, -v46
    v_mfma_f32_16x16x32_bf16 a[96:99], a[168:171], v[164:167], a[96:99]
    v_exp_f32 v188, v188
    v_mfma_f32_16x16x32_bf16 a[100:103], a[168:171], v[172:175], a[100:103]
    v_exp_f32 v189, v189
    v_mfma_f32_16x16x32_bf16 a[104:107], a[168:171], v[180:183], a[104:107]
    v_exp_f32 v190, v190
    v_mfma_f32_16x16x32_bf16 a[108:111], a[172:175], v[164:167], a[108:111]
    v_exp_f32 v191, v191
    v_mfma_f32_16x16x32_bf16 a[112:115], a[172:175], v[172:175], a[112:115]
    v_exp_f32 v196, v196
    v_mfma_f32_16x16x32_bf16 a[116:119], a[172:175], v[180:183], a[116:119]
    s_waitcnt vmcnt(6)
    buffer_load_dwordx4 v4, s[16:19], s57 offen offset:2048 nt lds
    v_mfma_f32_16x16x32_bf16 a[120:123], a[176:179], v[164:167], a[120:123]
    s_mov_b32 s57, 3317760
    v_exp_f32 v197, v197
    v_mfma_f32_16x16x32_bf16 a[124:127], a[176:179], v[172:175], a[124:127]
    s_add_u32 m0, s51, 49152
    v_exp_f32 v198, v198
    v_mfma_f32_16x16x32_bf16 a[128:131], a[176:179], v[180:183], a[128:131]
    s_waitcnt lgkmcnt(0)
    v_exp_f32 v199, v199
    v_mfma_f32_16x16x32_bf16 a[132:135], a[180:183], v[164:167], a[132:135]
    v_exp_f32 v204, v204
    v_mfma_f32_16x16x32_bf16 a[136:139], a[180:183], v[172:175], a[136:139]
    v_exp_f32 v205, v205
    v_mfma_f32_16x16x32_bf16 a[140:143], a[180:183], v[180:183], a[140:143]
    v_exp_f32 v206, v206
    v_mfma_f32_16x16x32_bf16 v[88:91], a[184:187], a[0:3], 0
    v_exp_f32 v207, v207
    v_mfma_f32_16x16x32_bf16 v[96:99], a[184:187], a[4:7], 0
    v_cvt_pk_bf16_f32 v184, v184, v185
    v_cvt_pk_bf16_f32 v192, v192, v193
    v_mfma_f32_16x16x32_bf16 v[104:107], a[184:187], a[8:11], 0
    v_cvt_pk_bf16_f32 v200, v200, v201
    v_cvt_pk_bf16_f32 v185, v186, v187
    v_mfma_f32_16x16x32_bf16 v[92:95], a[188:191], a[0:3], 0
    v_cvt_pk_bf16_f32 v193, v194, v195
    v_cvt_pk_bf16_f32 v201, v202, v203
    v_mfma_f32_16x16x32_bf16 v[100:103], a[188:191], a[4:7], 0
    v_cvt_pk_bf16_f32 v186, v188, v189
    v_cvt_pk_bf16_f32 v187, v190, v191
    v_mfma_f32_16x16x32_bf16 v[108:111], a[188:191], a[8:11], 0
    ds_write_b128 v27, v[184:187] offset:12288
    v_mfma_f32_16x16x32_bf16 v[88:91], a[192:195], a[12:15], v[88:91]
    v_cvt_pk_bf16_f32 v194, v196, v197
    v_cvt_pk_bf16_f32 v195, v198, v199
    v_mfma_f32_16x16x32_bf16 v[96:99], a[192:195], a[16:19], v[96:99]
    ds_write_b128 v27, v[192:195] offset:13312
    v_mfma_f32_16x16x32_bf16 v[104:107], a[192:195], a[20:23], v[104:107]
    v_cvt_pk_bf16_f32 v202, v204, v205
    v_cvt_pk_bf16_f32 v203, v206, v207
    v_mfma_f32_16x16x32_bf16 v[92:95], a[196:199], a[12:15], v[92:95]
    v_fma_f32 v208, v208, s52, -v44
    v_fma_f32 v209, v209, s52, -v44
    v_mfma_f32_16x16x32_bf16 v[100:103], a[196:199], a[16:19], v[100:103]
    ds_write_b128 v27, v[200:203] offset:14336
    v_mfma_f32_16x16x32_bf16 v[108:111], a[196:199], a[20:23], v[108:111]
    v_fma_f32 v216, v216, s52, -v45
    v_fma_f32 v217, v217, s52, -v45
    v_mfma_f32_16x16x32_bf16 a[144:147], a[156:159], v[184:187], a[144:147]
    ds_read_b64_tr_b16 a[200:201], v23 offset:32768
    v_fma_f32 v224, v224, s52, -v46
    v_mfma_f32_16x16x32_bf16 a[148:151], a[156:159], v[192:195], a[148:151]
    ds_read_b64_tr_b16 a[202:203], v23 offset:34816
    ds_read_b64_tr_b16 a[204:205], v24 offset:32768
    v_mfma_f32_16x16x32_bf16 a[152:155], a[156:159], v[200:203], a[152:155]
    ds_read_b64_tr_b16 a[206:207], v24 offset:34816
    ds_read_b64_tr_b16 a[184:185], v23 offset:36864
    ds_read_b64_tr_b16 a[186:187], v23 offset:38912
    v_fma_f32 v225, v225, s52, -v46
    v_exp_f32 v208, v208
    v_exp_f32 v209, v209
    v_fma_f32 v210, v210, s52, -v44
    v_fma_f32 v211, v211, s52, -v44
    v_exp_f32 v216, v216
    s_waitcnt vmcnt(6) lgkmcnt(6)
    s_barrier
    ds_read_b64_tr_b16 a[160:161], v13 offset:0
    ds_read_b64_tr_b16 a[162:163], v13 offset:6144
    ds_read_b64_tr_b16 a[164:165], v14 offset:0
    buffer_load_dwordx4 v2, s[16:19], s57 offen nt lds
    ds_read_b64_tr_b16 a[166:167], v14 offset:6144
    ds_read_b64_tr_b16 a[168:169], v15 offset:0
    v_exp_f32 v217, v217
    ds_read_b64_tr_b16 a[170:171], v15 offset:6144
    ds_read_b64_tr_b16 a[172:173], v16 offset:0
    ds_read_b64_tr_b16 a[174:175], v16 offset:6144
    v_fma_f32 v218, v218, s52, -v45
    ds_read_b64_tr_b16 a[176:177], v13 offset:128
    ds_read_b64_tr_b16 a[178:179], v13 offset:6272
    ds_read_b64_tr_b16 a[180:181], v14 offset:128
    v_fma_f32 v219, v219, s52, -v45
    ds_read_b64_tr_b16 a[182:183], v14 offset:6272
    ds_read_b128 v[188:191], v28 offset:12288
    s_waitcnt lgkmcnt(11)
    v_mfma_f32_16x16x32_bf16 a[72:75], a[160:163], v[184:187], a[72:75]
    ds_read_b128 v[196:199], v28 offset:13312
    v_fma_f32 v226, v226, s52, -v46
    v_mfma_f32_16x16x32_bf16 a[76:79], a[160:163], v[192:195], a[76:79]
    s_waitcnt vmcnt(6)
    buffer_load_dwordx4 v3, s[16:19], s57 offen offset:1024 nt lds
    v_mfma_f32_16x16x32_bf16 a[80:83], a[160:163], v[200:203], a[80:83]
    s_waitcnt lgkmcnt(9)
    ds_read_b64_tr_b16 a[160:161], v17 offset:0
    ds_read_b64_tr_b16 a[162:163], v17 offset:6144
    v_mfma_f32_16x16x32_bf16 a[84:87], a[164:167], v[184:187], a[84:87]
    ds_read_b128 v[204:207], v28 offset:14336
    v_fma_f32 v227, v227, s52, -v46
    v_mfma_f32_16x16x32_bf16 a[88:91], a[164:167], v[192:195], a[88:91]
    ds_read_b64_tr_b16 a[188:189], v24 offset:36864
    ds_read_b64_tr_b16 a[190:191], v24 offset:38912
    v_mfma_f32_16x16x32_bf16 a[92:95], a[164:167], v[200:203], a[92:95]
    s_waitcnt lgkmcnt(8)
    ds_read_b64_tr_b16 a[164:165], v18 offset:0
    ds_read_b64_tr_b16 a[166:167], v18 offset:6144
    v_mfma_f32_16x16x32_bf16 a[96:99], a[168:171], v[184:187], a[96:99]
    v_exp_f32 v224, v224
    v_mfma_f32_16x16x32_bf16 a[100:103], a[168:171], v[192:195], a[100:103]
    v_exp_f32 v225, v225
    v_mfma_f32_16x16x32_bf16 a[104:107], a[168:171], v[200:203], a[104:107]
    s_waitcnt vmcnt(6)
    buffer_load_dwordx4 v4, s[16:19], s57 offen offset:2048 nt lds
    v_mfma_f32_16x16x32_bf16 a[108:111], a[172:175], v[184:187], a[108:111]
    s_mov_b32 s57, 3330048
    ds_read_b64_tr_b16 a[168:169], v19 offset:0
    ds_read_b64_tr_b16 a[170:171], v19 offset:6144
    v_mfma_f32_16x16x32_bf16 a[112:115], a[172:175], v[192:195], a[112:115]
    s_add_u32 m0, s51, 61440
    v_exp_f32 v210, v210
    v_mfma_f32_16x16x32_bf16 a[116:119], a[172:175], v[200:203], a[116:119]
    ds_read_b64_tr_b16 a[172:173], v20 offset:0
    ds_read_b64_tr_b16 a[174:175], v20 offset:6144
    v_mfma_f32_16x16x32_bf16 a[120:123], a[176:179], v[184:187], a[120:123]
    v_exp_f32 v211, v211
    v_mfma_f32_16x16x32_bf16 a[124:127], a[176:179], v[192:195], a[124:127]
    v_fma_f32 v212, v212, s52, -v44
    v_fma_f32 v213, v213, s52, -v44
    v_mfma_f32_16x16x32_bf16 a[128:131], a[176:179], v[200:203], a[128:131]
    s_waitcnt lgkmcnt(4)
    ds_read_b64_tr_b16 a[176:177], v17 offset:128
    ds_read_b64_tr_b16 a[178:179], v17 offset:6272
    v_mfma_f32_16x16x32_bf16 a[132:135], a[180:183], v[184:187], a[132:135]
    s_waitcnt vmcnt(6)
    buffer_load_dwordx4 v2, s[16:19], s57 offen nt lds
    v_mfma_f32_16x16x32_bf16 a[136:139], a[180:183], v[192:195], a[136:139]
    v_fma_f32 v214, v214, s52, -v44
    v_fma_f32 v215, v215, s52, -v44
    v_mfma_f32_16x16x32_bf16 a[140:143], a[180:183], v[200:203], a[140:143]
    ds_read_b64_tr_b16 a[180:181], v18 offset:128
    ds_read_b64_tr_b16 a[182:183], v18 offset:6272
    v_mfma_f32_16x16x32_bf16 a[72:75], a[160:163], v[188:191], a[72:75]
    v_exp_f32 v218, v218
    v_mfma_f32_16x16x32_bf16 a[76:79], a[160:163], v[196:199], a[76:79]
    v_exp_f32 v219, v219
    v_mfma_f32_16x16x32_bf16 a[80:83], a[160:163], v[204:207], a[80:83]
    v_fma_f32 v220, v220, s52, -v45
    v_fma_f32 v221, v221, s52, -v45
    v_mfma_f32_16x16x32_bf16 a[84:87], a[164:167], v[188:191], a[84:87]
    v_fma_f32 v222, v222, s52, -v45
    v_fma_f32 v223, v223, s52, -v45
    v_mfma_f32_16x16x32_bf16 a[88:91], a[164:167], v[196:199], a[88:91]
    s_waitcnt vmcnt(6)
    buffer_load_dwordx4 v3, s[16:19], s57 offen offset:1024 nt lds
    v_mfma_f32_16x16x32_bf16 a[92:95], a[164:167], v[204:207], a[92:95]
    s_waitcnt lgkmcnt(2)
    v_exp_f32 v226, v226
    v_mfma_f32_16x16x32_bf16 a[96:99], a[168:171], v[188:191], a[96:99]
    v_exp_f32 v227, v227
    v_mfma_f32_16x16x32_bf16 a[100:103], a[168:171], v[196:199], a[100:103]
    v_fma_f32 v228, v228, s52, -v46
    v_fma_f32 v229, v229, s52, -v46
    v_mfma_f32_16x16x32_bf16 a[104:107], a[168:171], v[204:207], a[104:107]
    v_fma_f32 v230, v230, s52, -v46
    v_fma_f32 v231, v231, s52, -v46
    v_mfma_f32_16x16x32_bf16 a[108:111], a[172:175], v[188:191], a[108:111]
    v_exp_f32 v212, v212
    v_mfma_f32_16x16x32_bf16 a[112:115], a[172:175], v[196:199], a[112:115]
    v_exp_f32 v213, v213
    v_mfma_f32_16x16x32_bf16 a[116:119], a[172:175], v[204:207], a[116:119]
    s_waitcnt vmcnt(6)
    buffer_load_dwordx4 v4, s[16:19], s57 offen offset:2048 nt lds
    v_mfma_f32_16x16x32_bf16 a[120:123], a[176:179], v[188:191], a[120:123]
    s_add_u32 m0, s51, 0
    v_exp_f32 v214, v214
    v_mfma_f32_16x16x32_bf16 a[124:127], a[176:179], v[196:199], a[124:127]
    v_exp_f32 v215, v215
    v_mfma_f32_16x16x32_bf16 a[128:131], a[176:179], v[204:207], a[128:131]
    s_waitcnt lgkmcnt(0)
    v_exp_f32 v220, v220
    v_mfma_f32_16x16x32_bf16 a[132:135], a[180:183], v[188:191], a[132:135]
    v_exp_f32 v221, v221
    v_mfma_f32_16x16x32_bf16 a[136:139], a[180:183], v[196:199], a[136:139]
    v_exp_f32 v222, v222
    v_mfma_f32_16x16x32_bf16 a[140:143], a[180:183], v[204:207], a[140:143]
    v_exp_f32 v223, v223
    v_mfma_f32_16x16x32_bf16 v[88:91], a[200:203], a[24:27], v[88:91]
    v_exp_f32 v228, v228
    v_mfma_f32_16x16x32_bf16 v[96:99], a[200:203], a[28:31], v[96:99]
    v_exp_f32 v229, v229
    v_mfma_f32_16x16x32_bf16 v[104:107], a[200:203], a[32:35], v[104:107]
    v_exp_f32 v230, v230
    v_mfma_f32_16x16x32_bf16 v[92:95], a[204:207], a[24:27], v[92:95]
    v_exp_f32 v231, v231
    v_mfma_f32_16x16x32_bf16 v[100:103], a[204:207], a[28:31], v[100:103]
    v_cvt_pk_bf16_f32 v208, v208, v209
    v_cvt_pk_bf16_f32 v216, v216, v217
    v_mfma_f32_16x16x32_bf16 v[108:111], a[204:207], a[32:35], v[108:111]
    v_cvt_pk_bf16_f32 v224, v224, v225
    v_cvt_pk_bf16_f32 v209, v210, v211
    v_mfma_f32_16x16x32_bf16 v[88:91], a[184:187], a[36:39], v[88:91]
    v_cvt_pk_bf16_f32 v217, v218, v219
    v_cvt_pk_bf16_f32 v225, v226, v227
    v_mfma_f32_16x16x32_bf16 v[96:99], a[184:187], a[40:43], v[96:99]
    v_cvt_pk_bf16_f32 v210, v212, v213
    v_cvt_pk_bf16_f32 v211, v214, v215
    v_mfma_f32_16x16x32_bf16 v[104:107], a[184:187], a[44:47], v[104:107]
    ds_write_b128 v27, v[208:211] offset:0
    v_mfma_f32_16x16x32_bf16 v[92:95], a[188:191], a[36:39], v[92:95]
    v_cvt_pk_bf16_f32 v218, v220, v221
    v_cvt_pk_bf16_f32 v219, v222, v223
    v_mfma_f32_16x16x32_bf16 v[100:103], a[188:191], a[40:43], v[100:103]
    ds_write_b128 v27, v[216:219] offset:1024
    v_mfma_f32_16x16x32_bf16 v[108:111], a[188:191], a[44:47], v[108:111]
    v_cvt_pk_bf16_f32 v226, v228, v229
    v_cvt_pk_bf16_f32 v227, v230, v231
    v_mfma_f32_16x16x32_bf16 a[144:147], a[156:159], v[208:211], a[144:147]
    s_sub_u32 s57, s45, 1280
    s_cselect_b32 s45, s45, s57
    s_add_u32 s57, s45, 0
    v_mfma_f32_16x16x32_bf16 a[148:151], a[156:159], v[216:219], a[148:151]
    ds_write_b128 v27, v[224:227] offset:2048
    v_mfma_f32_16x16x32_bf16 a[152:155], a[156:159], v[224:227], a[152:155]
    buffer_load_dword v55, v62, s[24:27], s66 offen
    v_fma_f32 v232, v232, s52, -v44
    v_fma_f32 v233, v233, s52, -v44
    ds_read_b64_tr_b16 a[192:193], v23 offset:40960
    ds_read_b64_tr_b16 a[194:195], v23 offset:43008
    ds_read_b64_tr_b16 a[196:197], v24 offset:40960
    v_exp_f32 v232, v232
    ds_read_b64_tr_b16 a[198:199], v24 offset:43008
    ds_read_b64_tr_b16 a[200:201], v23 offset:45056
    ds_read_b64_tr_b16 a[202:203], v23 offset:47104
    v_exp_f32 v233, v233
    ds_read_b64_tr_b16 a[204:205], v24 offset:45056
    ds_read_b64_tr_b16 a[206:207], v24 offset:47104
    v_fma_f32 v234, v234, s52, -v44
    s_waitcnt vmcnt(7) lgkmcnt(8)
    s_barrier
    ds_read_b64_tr_b16 a[160:161], v13 offset:24576
    ds_read_b64_tr_b16 a[162:163], v13 offset:30720
    ds_read_b64_tr_b16 a[164:165], v14 offset:24576
    buffer_load_dwordx4 v8, s[24:27], s57 offen lds
    ds_read_b64_tr_b16 a[166:167], v14 offset:30720
    ds_read_b64_tr_b16 a[168:169], v15 offset:24576
    v_fma_f32 v235, v235, s52, -v44
    ds_read_b64_tr_b16 a[170:171], v15 offset:30720
    ds_read_b64_tr_b16 a[172:173], v16 offset:24576
    ds_read_b64_tr_b16 a[174:175], v16 offset:30720
    v_exp_f32 v234, v234
    ds_read_b64_tr_b16 a[176:177], v13 offset:24704
    ds_read_b64_tr_b16 a[178:179], v13 offset:30848
    ds_read_b64_tr_b16 a[180:181], v14 offset:24704
    v_exp_f32 v235, v235
    v_fma_f32 v236, v236, s52, -v44
    v_fma_f32 v237, v237, s52, -v44
    v_fma_f32 v238, v238, s52, -v44
    s_waitcnt lgkmcnt(9)
    v_mfma_f32_16x16x32_bf16 a[72:75], a[160:163], v[208:211], a[72:75]
    s_sub_u32 s66, s64, 0
    ds_read_b64_tr_b16 a[182:183], v14 offset:30848
    ds_read_b128 v[212:215], v28 offset:0
    v_mfma_f32_16x16x32_bf16 a[76:79], a[160:163], v[216:219], a[76:79]
    buffer_load_dwordx4 v9, s[24:27], s57 offen offset:1024 lds
    v_mfma_f32_16x16x32_bf16 a[80:83], a[160:163], v[224:227], a[80:83]
    s_waitcnt lgkmcnt(7)
    ds_read_b64_tr_b16 a[160:161], v17 offset:24576
    ds_read_b64_tr_b16 a[162:163], v17 offset:30720
    v_mfma_f32_16x16x32_bf16 a[84:87], a[164:167], v[208:211], a[84:87]
    ds_read_b128 v[220:223], v28 offset:1024
    v_fma_f32 v239, v239, s52, -v44
    v_mfma_f32_16x16x32_bf16 a[88:91], a[164:167], v[216:219], a[88:91]
    ds_read_b128 v[228:231], v28 offset:2048
    v_cvt_pk_bf16_f32 v232, v232, v233
    v_mfma_f32_16x16x32_bf16 a[92:95], a[164:167], v[224:227], a[92:95]
    ds_read_b64_tr_b16 a[164:165], v18 offset:24576
    ds_read_b64_tr_b16 a[166:167], v18 offset:30720
    v_mfma_f32_16x16x32_bf16 a[96:99], a[168:171], v[208:211], a[96:99]
    v_exp_f32 v236, v236
    v_mfma_f32_16x16x32_bf16 a[100:103], a[168:171], v[216:219], a[100:103]
    v_exp_f32 v237, v237
    v_mfma_f32_16x16x32_bf16 a[104:107], a[168:171], v[224:227], a[104:107]
    s_waitcnt lgkmcnt(6)
    buffer_load_dwordx4 v10, s[24:27], s57 offen offset:2048 lds
    v_mfma_f32_16x16x32_bf16 a[108:111], a[172:175], v[208:211], a[108:111]
    s_add_u32 s57, s45, 122880
    ds_read_b64_tr_b16 a[168:169], v19 offset:24576
    ds_read_b64_tr_b16 a[170:171], v19 offset:30720
    v_mfma_f32_16x16x32_bf16 a[112:115], a[172:175], v[216:219], a[112:115]
    s_add_u32 m0, s51, 12288
    v_exp_f32 v238, v238
    v_mfma_f32_16x16x32_bf16 a[116:119], a[172:175], v[224:227], a[116:119]
    s_add_u32 s45, s44, 0
    ds_read_b64_tr_b16 a[172:173], v20 offset:24576
    ds_read_b64_tr_b16 a[174:175], v20 offset:30720
    v_mfma_f32_16x16x32_bf16 a[120:123], a[176:179], v[208:211], a[120:123]
    v_exp_f32 v239, v239
    v_mfma_f32_16x16x32_bf16 a[124:127], a[176:179], v[216:219], a[124:127]
    v_fma_f32 v240, v240, s52, -v45
    v_fma_f32 v241, v241, s52, -v45
    v_mfma_f32_16x16x32_bf16 a[128:131], a[176:179], v[224:227], a[128:131]
    ds_read_b64_tr_b16 a[176:177], v17 offset:24704
    ds_read_b64_tr_b16 a[178:179], v17 offset:30848
    v_mfma_f32_16x16x32_bf16 a[132:135], a[180:183], v[208:211], a[132:135]
    buffer_load_dwordx4 v8, s[24:27], s57 offen lds
    v_mfma_f32_16x16x32_bf16 a[136:139], a[180:183], v[216:219], a[136:139]
    v_cvt_pk_bf16_f32 v233, v234, v235
    v_fma_f32 v242, v242, s52, -v45
    v_mfma_f32_16x16x32_bf16 a[140:143], a[180:183], v[224:227], a[140:143]
    s_waitcnt lgkmcnt(4)
    ds_read_b64_tr_b16 a[180:181], v18 offset:24704
    ds_read_b64_tr_b16 a[182:183], v18 offset:30848
    v_mfma_f32_16x16x32_bf16 a[72:75], a[160:163], v[212:215], a[72:75]
    v_exp_f32 v240, v240
    v_mfma_f32_16x16x32_bf16 a[76:79], a[160:163], v[220:223], a[76:79]
    v_exp_f32 v241, v241
    v_mfma_f32_16x16x32_bf16 a[80:83], a[160:163], v[228:231], a[80:83]
    v_fma_f32 v243, v243, s52, -v45
    v_cvt_pk_bf16_f32 v234, v236, v237
    v_mfma_f32_16x16x32_bf16 a[84:87], a[164:167], v[212:215], a[84:87]
    v_cvt_pk_bf16_f32 v235, v238, v239
    v_fma_f32 v244, v244, s52, -v45
    v_mfma_f32_16x16x32_bf16 a[88:91], a[164:167], v[220:223], a[88:91]
    buffer_load_dwordx4 v9, s[24:27], s57 offen offset:1024 lds
    v_mfma_f32_16x16x32_bf16 a[92:95], a[164:167], v[228:231], a[92:95]
    ds_write_b128 v27, v[232:235] offset:12288
    v_mfma_f32_16x16x32_bf16 a[96:99], a[168:171], v[212:215], a[96:99]
    v_exp_f32 v242, v242
    v_mfma_f32_16x16x32_bf16 a[100:103], a[168:171], v[220:223], a[100:103]
    v_exp_f32 v243, v243
    v_mfma_f32_16x16x32_bf16 a[104:107], a[168:171], v[228:231], a[104:107]
    s_waitcnt lgkmcnt(1)
    v_fma_f32 v245, v245, s52, -v45
    v_fma_f32 v246, v246, s52, -v45
    v_mfma_f32_16x16x32_bf16 a[108:111], a[172:175], v[212:215], a[108:111]
    v_fma_f32 v247, v247, s52, -v45
    v_cvt_pk_bf16_f32 v240, v240, v241
    v_mfma_f32_16x16x32_bf16 a[112:115], a[172:175], v[220:223], a[112:115]
    buffer_load_dwordx4 v10, s[24:27], s57 offen offset:2048 lds
    v_mfma_f32_16x16x32_bf16 a[116:119], a[172:175], v[228:231], a[116:119]
    s_add_u32 m0, s51, 24576
    v_exp_f32 v244, v244
    v_mfma_f32_16x16x32_bf16 a[120:123], a[176:179], v[212:215], a[120:123]
    v_exp_f32 v245, v245
    v_mfma_f32_16x16x32_bf16 a[124:127], a[176:179], v[220:223], a[124:127]
    v_exp_f32 v246, v246
    v_mfma_f32_16x16x32_bf16 a[128:131], a[176:179], v[228:231], a[128:131]
    v_exp_f32 v247, v247
    v_mfma_f32_16x16x32_bf16 a[132:135], a[180:183], v[212:215], a[132:135]
    v_fma_f32 v248, v248, s52, -v46
    v_fma_f32 v249, v249, s52, -v46
    v_mfma_f32_16x16x32_bf16 a[136:139], a[180:183], v[220:223], a[136:139]
    v_cvt_pk_bf16_f32 v241, v242, v243
    v_fma_f32 v250, v250, s52, -v46
    v_mfma_f32_16x16x32_bf16 a[140:143], a[180:183], v[228:231], a[140:143]
    v_exp_f32 v248, v248
    v_mfma_f32_16x16x32_bf16 v[88:91], a[192:195], a[48:51], v[88:91]
    v_exp_f32 v249, v249
    v_mfma_f32_16x16x32_bf16 v[96:99], a[192:195], a[52:55], v[96:99]
    v_fma_f32 v251, v251, s52, -v46
    v_cvt_pk_bf16_f32 v242, v244, v245
    v_mfma_f32_16x16x32_bf16 v[104:107], a[192:195], a[56:59], v[104:107]
    v_cvt_pk_bf16_f32 v243, v246, v247
    v_fma_f32 v252, v252, s52, -v46
    v_mfma_f32_16x16x32_bf16 v[92:95], a[196:199], a[48:51], v[92:95]
    ds_write_b128 v27, v[240:243] offset:13312
    v_mfma_f32_16x16x32_bf16 v[100:103], a[196:199], a[52:55], v[100:103]
    v_exp_f32 v250, v250
    v_mfma_f32_16x16x32_bf16 v[108:111], a[196:199], a[56:59], v[108:111]
    v_exp_f32 v251, v251
    v_mfma_f32_16x16x32_bf16 v[88:91], a[200:203], a[60:63], v[88:91]
    v_fma_f32 v253, v253, s52, -v46
    v_fma_f32 v254, v254, s52, -v46
    v_mfma_f32_16x16x32_bf16 v[96:99], a[200:203], a[64:67], v[96:99]
    v_fma_f32 v255, v255, s52, -v46
    v_cvt_pk_bf16_f32 v248, v248, v249
    v_mfma_f32_16x16x32_bf16 v[104:107], a[200:203], a[68:71], v[104:107]
    v_exp_f32 v252, v252
    v_mfma_f32_16x16x32_bf16 v[92:95], a[204:207], a[60:63], v[92:95]
    v_exp_f32 v253, v253
    v_mfma_f32_16x16x32_bf16 v[100:103], a[204:207], a[64:67], v[100:103]
    v_exp_f32 v254, v254
    v_mfma_f32_16x16x32_bf16 v[108:111], a[204:207], a[68:71], v[108:111]
    v_exp_f32 v255, v255
    v_mfma_f32_16x16x32_bf16 a[144:147], a[156:159], v[232:235], a[144:147]
    v_cvt_pk_bf16_f32 v249, v250, v251
    v_cvt_pk_bf16_f32 v250, v252, v253
    v_mfma_f32_16x16x32_bf16 a[148:151], a[156:159], v[240:243], a[148:151]
    v_cvt_pk_bf16_f32 v251, v254, v255
    s_sub_u32 s57, s45, 1280
    s_cselect_b32 s45, s45, s57
    v_mfma_f32_16x16x32_bf16 a[152:155], a[156:159], v[248:251], a[152:155]
    s_add_u32 s57, s45, 3932160
    ds_write_b128 v27, v[248:251] offset:14336
    v_accvgpr_read_b32 v36, a144
    s_nop 0
    v_accvgpr_read_b32 v37, a148
    v_add_u32 v62, s23, v1
    v_add_u32 v4, s58, v47
    s_and_b32 s66, s66, 15
    s_cselect_b64 s[6:7], 0, -1
    v_accvgpr_read_b32 v38, a152
    ds_write_b128 v31, v[36:39]
    s_mul_i32 s66, s66, 122880
    s_add_u32 s66, s66, 0
    s_waitcnt vmcnt(7) lgkmcnt(0)
    s_barrier
    ds_read_b64_tr_b16 a[160:161], v13 offset:49152
    ds_read_b64_tr_b16 a[162:163], v13 offset:55296
    ds_read_b128 v[236:239], v28 offset:12288
    buffer_load_dwordx4 v8, s[24:27], s57 offen lds
    ds_read_b64_tr_b16 a[164:165], v17 offset:49152
    ds_read_b64_tr_b16 a[166:167], v17 offset:55296
    ds_read_b128 v[244:247], v28 offset:13312
    buffer_load_dwordx4 v9, s[24:27], s57 offen offset:1024 lds
    ds_read_b128 v[252:255], v28 offset:14336
    ds_read_b64_tr_b16 a[168:169], v14 offset:49152
    ds_read_b64_tr_b16 a[170:171], v14 offset:55296
    buffer_load_dwordx4 v10, s[24:27], s57 offen offset:2048 lds
    ds_read_b64_tr_b16 a[172:173], v18 offset:49152
    ds_read_b64_tr_b16 a[174:175], v18 offset:55296
    s_waitcnt lgkmcnt(9)
    v_mfma_f32_16x16x32_bf16 a[72:75], a[160:163], v[232:235], a[72:75]
    s_add_u32 s57, s45, 4055040
    ds_read_b64_tr_b16 a[176:177], v15 offset:49152
    ds_read_b64_tr_b16 a[178:179], v15 offset:55296
    v_mfma_f32_16x16x32_bf16 a[76:79], a[160:163], v[240:243], a[76:79]
    s_add_u32 m0, s51, 36864
    ds_read_b64_tr_b16 a[180:181], v19 offset:49152
    ds_read_b64_tr_b16 a[182:183], v19 offset:55296
    v_mfma_f32_16x16x32_bf16 a[80:83], a[160:163], v[248:251], a[80:83]
    s_add_u32 s45, s44, 256
    buffer_load_dwordx4 v8, s[24:27], s57 offen lds
    s_waitcnt lgkmcnt(9)
    v_mfma_f32_16x16x32_bf16 a[72:75], a[164:167], v[236:239], a[72:75]
    ds_read_b64_tr_b16 a[160:161], v16 offset:49152
    ds_read_b64_tr_b16 a[162:163], v16 offset:55296
    v_mfma_f32_16x16x32_bf16 a[76:79], a[164:167], v[244:247], a[76:79]
    s_waitcnt lgkmcnt(10)
    ds_read_b128 v[40:43], v32
    v_mov_b32 v15, 0
    v_mfma_f32_16x16x32_bf16 a[80:83], a[164:167], v[252:255], a[80:83]
    s_waitcnt lgkmcnt(9)
    buffer_load_dwordx4 v9, s[24:27], s57 offen offset:1024 lds
    v_mfma_f32_16x16x32_bf16 a[84:87], a[168:171], v[232:235], a[84:87]
    ds_read_b64_tr_b16 a[164:165], v20 offset:49152
    ds_read_b64_tr_b16 a[166:167], v20 offset:55296
    v_mfma_f32_16x16x32_bf16 a[88:91], a[168:171], v[240:243], a[88:91]
    v_accvgpr_read_b32 v208, a72
    v_accvgpr_read_b32 v209, a73
    v_mfma_f32_16x16x32_bf16 a[92:95], a[168:171], v[248:251], a[92:95]
    s_waitcnt lgkmcnt(5)
    buffer_load_dwordx4 v10, s[24:27], s57 offen offset:2048 lds
    v_mfma_f32_16x16x32_bf16 a[84:87], a[172:175], v[236:239], a[84:87]
    s_add_u32 m0, s51, 73728
    ds_read_b64_tr_b16 a[168:169], v13 offset:49280
    ds_read_b64_tr_b16 a[170:171], v13 offset:55424
    v_mfma_f32_16x16x32_bf16 a[88:91], a[172:175], v[244:247], a[88:91]
    s_sub_u32 s57, s45, 1280
    s_cselect_b32 s45, s45, s57
    s_add_u32 s57, s45, 0
    v_mfma_f32_16x16x32_bf16 a[92:95], a[172:175], v[252:255], a[92:95]
    buffer_load_dwordx4 v8, s[24:27], s57 offen lds
    v_mfma_f32_16x16x32_bf16 a[96:99], a[176:179], v[232:235], a[96:99]
    ds_read_b64_tr_b16 a[172:173], v17 offset:49280
    ds_read_b64_tr_b16 a[174:175], v17 offset:55424
    v_mfma_f32_16x16x32_bf16 a[100:103], a[176:179], v[240:243], a[100:103]
    s_waitcnt lgkmcnt(4)
    v_add_f32 v52, v36, v40
    v_add_f32 v53, v37, v41
    v_mfma_f32_16x16x32_bf16 a[104:107], a[176:179], v[248:251], a[104:107]
    buffer_load_dwordx4 v9, s[24:27], s57 offen offset:1024 lds
    v_mfma_f32_16x16x32_bf16 a[96:99], a[180:183], v[236:239], a[96:99]
    ds_read_b64_tr_b16 a[176:177], v14 offset:49280
    ds_read_b64_tr_b16 a[178:179], v14 offset:55424
    v_mfma_f32_16x16x32_bf16 a[100:103], a[180:183], v[244:247], a[100:103]
    v_add_f32 v54, v38, v42
    v_accvgpr_read_b32 v216, a76
    v_mfma_f32_16x16x32_bf16 a[104:107], a[180:183], v[252:255], a[104:107]
    buffer_load_dwordx4 v10, s[24:27], s57 offen offset:2048 lds
    v_mfma_f32_16x16x32_bf16 a[108:111], a[160:163], v[232:235], a[108:111]
    s_add_u32 s57, s45, 122880
    s_add_u32 m0, s51, 86016
    ds_read_b64_tr_b16 a[180:181], v18 offset:49280
    v_mfma_f32_16x16x32_bf16 a[112:115], a[160:163], v[240:243], a[112:115]
    s_add_u32 s45, s44, 128
    ds_read_b64_tr_b16 a[182:183], v18 offset:55424
    v_accvgpr_read_b32 v217, a77
    v_mfma_f32_16x16x32_bf16 a[116:119], a[160:163], v[248:251], a[116:119]
    buffer_load_dwordx4 v8, s[24:27], s57 offen lds
    v_mfma_f32_16x16x32_bf16 a[108:111], a[164:167], v[236:239], a[108:111]
    v_rcp_f32 v52, v52
    v_mfma_f32_16x16x32_bf16 a[112:115], a[164:167], v[244:247], a[112:115]
    v_rcp_f32 v53, v53
    v_mfma_f32_16x16x32_bf16 a[116:119], a[164:167], v[252:255], a[116:119]
    s_waitcnt lgkmcnt(2)
    buffer_load_dwordx4 v9, s[24:27], s57 offen offset:1024 lds
    v_mfma_f32_16x16x32_bf16 a[120:123], a[168:171], v[232:235], a[120:123]
    v_rcp_f32 v54, v54
    v_mfma_f32_16x16x32_bf16 a[124:127], a[168:171], v[240:243], a[124:127]
    v_accvgpr_read_b32 v224, a80
    v_accvgpr_read_b32 v225, a81
    v_mfma_f32_16x16x32_bf16 a[128:131], a[168:171], v[248:251], a[128:131]
    buffer_load_dwordx4 v10, s[24:27], s57 offen offset:2048 lds
    v_mfma_f32_16x16x32_bf16 a[120:123], a[172:175], v[236:239], a[120:123]
    s_add_u32 m0, s51, 49152
    v_mul_f32 v208, v52, v208
    v_mul_f32 v209, v52, v209
    v_mfma_f32_16x16x32_bf16 a[124:127], a[172:175], v[244:247], a[124:127]
    v_accvgpr_read_b32 v210, a74
    v_accvgpr_read_b32 v211, a75
    v_mfma_f32_16x16x32_bf16 a[128:131], a[172:175], v[252:255], a[128:131]
    v_mul_f32 v216, v53, v216
    v_mul_f32 v217, v53, v217
    v_mfma_f32_16x16x32_bf16 a[132:135], a[176:179], v[232:235], a[132:135]
    v_accvgpr_read_b32 v218, a78
    v_accvgpr_read_b32 v219, a79
    v_mfma_f32_16x16x32_bf16 a[136:139], a[176:179], v[240:243], a[136:139]
    v_mul_f32 v224, v54, v224
    v_mul_f32 v225, v54, v225
    v_mfma_f32_16x16x32_bf16 a[140:143], a[176:179], v[248:251], a[140:143]
    s_waitcnt lgkmcnt(0)
    v_accvgpr_read_b32 v226, a82
    v_accvgpr_read_b32 v227, a83
    v_mfma_f32_16x16x32_bf16 a[132:135], a[180:183], v[236:239], a[132:135]
    v_mul_f32 v210, v52, v210
    v_mul_f32 v211, v52, v211
    v_mfma_f32_16x16x32_bf16 a[136:139], a[180:183], v[244:247], a[136:139]
    v_accvgpr_read_b32 v212, a84
    v_accvgpr_read_b32 v213, a85
    v_mfma_f32_16x16x32_bf16 a[140:143], a[180:183], v[252:255], a[140:143]
    v_accvgpr_read_b32 v214, a86
    v_accvgpr_read_b32 v215, a87
    v_cvt_pk_bf16_f32 v208, v208, v209
    v_mul_f32 v218, v53, v218
    v_mul_f32 v219, v53, v219
    v_accvgpr_read_b32 v220, a88
    v_accvgpr_read_b32 v221, a89
    v_accvgpr_read_b32 v222, a90
    v_accvgpr_read_b32 v223, a91
    v_cvt_pk_bf16_f32 v216, v216, v217
    v_mul_f32 v226, v54, v226
    v_mul_f32 v227, v54, v227
    v_accvgpr_read_b32 v228, a92
    v_accvgpr_read_b32 v229, a93
    v_accvgpr_read_b32 v230, a94
    v_accvgpr_read_b32 v231, a95
    v_cvt_pk_bf16_f32 v224, v224, v225
    v_mul_f32 v212, v52, v212
    v_mul_f32 v213, v52, v213
    v_mul_f32 v214, v52, v214
    v_mul_f32 v215, v52, v215
    v_cvt_pk_bf16_f32 v209, v210, v211
    v_mul_f32 v220, v53, v220
    v_mul_f32 v221, v53, v221
    v_mul_f32 v222, v53, v222
    v_mul_f32 v223, v53, v223
    v_cvt_pk_bf16_f32 v217, v218, v219
    v_mul_f32 v228, v54, v228
    v_mul_f32 v229, v54, v229
    v_mul_f32 v230, v54, v230
    v_mul_f32 v231, v54, v231
    v_cvt_pk_bf16_f32 v225, v226, v227
    v_cvt_pk_bf16_f32 v210, v212, v213
    v_cvt_pk_bf16_f32 v211, v214, v215
    v_cvt_pk_bf16_f32 v218, v220, v221
    v_cvt_pk_bf16_f32 v219, v222, v223
    v_cvt_pk_bf16_f32 v226, v228, v229
    v_cvt_pk_bf16_f32 v227, v230, v231
    v_accvgpr_read_b32 v232, a96
    v_accvgpr_read_b32 v233, a97
    v_accvgpr_read_b32 v240, a100
    v_accvgpr_read_b32 v241, a101
    v_accvgpr_read_b32 v248, a104
    v_accvgpr_read_b32 v249, a105
    v_mul_f32 v232, v52, v232
    v_mul_f32 v233, v52, v233
    v_accvgpr_read_b32 v234, a98
    v_accvgpr_read_b32 v235, a99
    v_mul_f32 v240, v53, v240
    v_mul_f32 v241, v53, v241
    v_accvgpr_read_b32 v242, a102
    v_accvgpr_read_b32 v243, a103
    v_mul_f32 v248, v54, v248
    v_mul_f32 v249, v54, v249
    v_accvgpr_read_b32 v250, a106
    v_accvgpr_read_b32 v251, a107
    v_mul_f32 v234, v52, v234
    v_mul_f32 v235, v52, v235
    v_accvgpr_read_b32 v236, a108
    v_accvgpr_read_b32 v237, a109
    v_accvgpr_read_b32 v238, a110
    v_accvgpr_read_b32 v239, a111
    v_cvt_pk_bf16_f32 v232, v232, v233
    v_mul_f32 v242, v53, v242
    v_mul_f32 v243, v53, v243
    v_accvgpr_read_b32 v244, a112
    v_accvgpr_read_b32 v245, a113
    v_accvgpr_read_b32 v246, a114
    v_accvgpr_read_b32 v247, a115
    v_cvt_pk_bf16_f32 v240, v240, v241
    v_mul_f32 v250, v54, v250
    v_mul_f32 v251, v54, v251
    v_accvgpr_read_b32 v252, a116
    v_accvgpr_read_b32 v253, a117
    v_accvgpr_read_b32 v254, a118
    v_accvgpr_read_b32 v255, a119
    v_cvt_pk_bf16_f32 v248, v248, v249
    v_accvgpr_read_b32 v212, a132
    v_accvgpr_read_b32 v213, a133
    v_accvgpr_read_b32 v214, a134
    v_accvgpr_read_b32 v215, a135
    v_accvgpr_read_b32 v220, a136
    v_accvgpr_read_b32 v221, a137
    v_accvgpr_read_b32 v222, a138
    v_accvgpr_read_b32 v223, a139
    v_accvgpr_read_b32 v228, a140
    v_accvgpr_read_b32 v229, a141
    v_accvgpr_read_b32 v230, a142
    v_accvgpr_read_b32 v231, a143
    v_mul_f32 v236, v52, v236
    v_mul_f32 v237, v52, v237
    v_mul_f32 v238, v52, v238
    v_mul_f32 v239, v52, v239
    v_cvt_pk_bf16_f32 v233, v234, v235
    v_mul_f32 v244, v53, v244
    v_mul_f32 v245, v53, v245
    v_mul_f32 v246, v53, v246
    v_mul_f32 v247, v53, v247
    v_cvt_pk_bf16_f32 v241, v242, v243
    v_mul_f32 v252, v54, v252
    v_mul_f32 v253, v54, v253
    v_mul_f32 v254, v54, v254
    v_mul_f32 v255, v54, v255
    v_cvt_pk_bf16_f32 v249, v250, v251
    v_mul_f32 v212, v52, v212
    v_mul_f32 v213, v52, v213
    v_mul_f32 v214, v52, v214
    v_mul_f32 v215, v52, v215
    v_mul_f32 v220, v53, v220
    v_mul_f32 v221, v53, v221
    v_mul_f32 v222, v53, v222
    v_mul_f32 v223, v53, v223
    v_mul_f32 v228, v54, v228
    v_mul_f32 v229, v54, v229
    v_mul_f32 v230, v54, v230
    v_mul_f32 v231, v54, v231
    v_cvt_pk_bf16_f32 v234, v236, v237
    v_cvt_pk_bf16_f32 v235, v238, v239
    v_cvt_pk_bf16_f32 v242, v244, v245
    v_cvt_pk_bf16_f32 v243, v246, v247
    v_cvt_pk_bf16_f32 v250, v252, v253
    v_cvt_pk_bf16_f32 v251, v254, v255
    ds_write_b128 v33, v[208:211] offset:0
    v_accvgpr_read_b32 v208, a120
    v_accvgpr_read_b32 v209, a121
    v_mul_f32 v208, v52, v208
    v_mul_f32 v209, v52, v209
    v_accvgpr_read_b32 v210, a122
    v_accvgpr_read_b32 v211, a123
    v_mul_f32 v210, v52, v210
    v_mul_f32 v211, v52, v211
    v_cvt_pk_bf16_f32 v208, v208, v209
    v_cvt_pk_bf16_f32 v209, v210, v211
    v_cvt_pk_bf16_f32 v210, v212, v213
    v_cvt_pk_bf16_f32 v211, v214, v215
    ds_write_b128 v33, v[216:219] offset:1024
    v_accvgpr_read_b32 v216, a124
    v_accvgpr_read_b32 v217, a125
    v_mul_f32 v216, v53, v216
    v_mul_f32 v217, v53, v217
    v_accvgpr_read_b32 v218, a126
    v_accvgpr_read_b32 v219, a127
    v_mul_f32 v218, v53, v218
    v_mul_f32 v219, v53, v219
    v_cvt_pk_bf16_f32 v216, v216, v217
    v_cvt_pk_bf16_f32 v217, v218, v219
    v_cvt_pk_bf16_f32 v218, v220, v221
    v_cvt_pk_bf16_f32 v219, v222, v223
    ds_write_b128 v33, v[224:227] offset:2048
    v_accvgpr_read_b32 v224, a128
    v_accvgpr_read_b32 v225, a129
    v_mul_f32 v224, v54, v224
    v_mul_f32 v225, v54, v225
    v_accvgpr_read_b32 v226, a130
    v_accvgpr_read_b32 v227, a131
    v_mul_f32 v226, v54, v226
    v_mul_f32 v227, v54, v227
    v_cvt_pk_bf16_f32 v224, v224, v225
    v_cvt_pk_bf16_f32 v225, v226, v227
    v_cvt_pk_bf16_f32 v226, v228, v229
    v_cvt_pk_bf16_f32 v227, v230, v231
    ds_write_b128 v33, v[232:235] offset:6144
    s_sub_u32 s57, s45, 1280
    s_cselect_b32 s45, s45, s57
    s_add_u32 s57, s45, 3932160
    v_mov_b32 v13, 0
    v_mov_b32 v14, 0
    v_mov_b32 v16, 0
    ds_write_b128 v33, v[240:243] offset:7168
    v_mov_b32 v17, 0
    v_mov_b32 v18, 0
    v_mov_b32 v19, 0
    v_mov_b32 v20, 0x40000000
    ds_write_b128 v33, v[248:251] offset:8192
    ds_write_b128 v33, v[208:211] offset:12288
    ds_write_b128 v33, v[216:219] offset:13312
    ds_write_b128 v33, v[224:227] offset:14336
    s_waitcnt vmcnt(12) lgkmcnt(0)
    s_barrier
    ds_read_b64_tr_b16 a[184:185], v21 offset:0
    ds_read_b64_tr_b16 a[186:187], v21 offset:2048
    ds_read_b64_tr_b16 a[188:189], v22 offset:0
    buffer_load_dwordx4 v8, s[24:27], s57 offen lds
    ds_read_b64_tr_b16 a[190:191], v22 offset:2048
    ds_read_b64_tr_b16 a[192:193], v21 offset:4096
    ds_read_b64_tr_b16 a[194:195], v21 offset:6144
    ds_read_b64_tr_b16 a[196:197], v22 offset:4096
    ds_read_b64_tr_b16 a[198:199], v22 offset:6144
    buffer_load_dwordx4 v9, s[24:27], s57 offen offset:1024 lds
    ds_read_b64_tr_b16 a[200:201], v21 offset:8192
    ds_read_b64_tr_b16 a[202:203], v21 offset:10240
    ds_read_b64_tr_b16 a[204:205], v22 offset:8192
    ds_read_b64_tr_b16 a[206:207], v22 offset:10240
    buffer_load_dwordx4 v10, s[24:27], s57 offen offset:2048 lds
    s_add_u32 s57, s45, 4055040
    s_waitcnt lgkmcnt(10)
    v_mfma_f32_16x16x32_bf16 v[112:115], a[184:187], a[0:3], 0
    s_add_u32 m0, s51, 61440
    s_add_u32 s45, s44, 384
    ds_read_b128 a[72:75], v35 offset:0
    v_mfma_f32_16x16x32_bf16 v[120:123], a[184:187], a[4:7], 0
    buffer_load_dwordx4 v8, s[24:27], s57 offen lds
    v_mfma_f32_16x16x32_bf16 v[128:131], a[184:187], a[8:11], 0
    s_waitcnt lgkmcnt(7)
    ds_read_b64_tr_b16 a[184:185], v21 offset:12288
    ds_read_b64_tr_b16 a[186:187], v21 offset:14336
    v_mfma_f32_16x16x32_bf16 v[116:119], a[188:191], a[0:3], 0
    ds_read_b128 a[76:79], v35 offset:1024
    buffer_load_dwordx4 v9, s[24:27], s57 offen offset:1024 lds
    v_mfma_f32_16x16x32_bf16 v[124:127], a[188:191], a[4:7], 0
    ds_read_b128 a[80:83], v35 offset:2048
    v_mfma_f32_16x16x32_bf16 v[132:135], a[188:191], a[8:11], 0
    ds_read_b64_tr_b16 a[188:189], v22 offset:12288
    ds_read_b64_tr_b16 a[190:191], v22 offset:14336
    v_mfma_f32_16x16x32_bf16 v[112:115], a[192:195], a[12:15], v[112:115]
    buffer_load_dwordx4 v10, s[24:27], s57 offen offset:2048 lds
    v_mfma_f32_16x16x32_bf16 v[120:123], a[192:195], a[16:19], v[120:123]
    s_add_u32 m0, s51, 135168
    s_sub_u32 s57, s45, 1280
    s_cselect_b32 s45, s45, s57
    v_mfma_f32_16x16x32_bf16 v[128:131], a[192:195], a[20:23], v[128:131]
    s_add_u32 s57, s45, 0
    ds_read_b64_tr_b16 a[192:193], v21 offset:16384
    ds_read_b64_tr_b16 a[194:195], v21 offset:18432
    s_waitcnt lgkmcnt(5)
    v_mfma_f32_16x16x32_bf16 v[116:119], a[196:199], a[12:15], v[116:119]
    buffer_load_dwordx4 v8, s[24:27], s57 offen lds
    v_mfma_f32_16x16x32_bf16 v[124:127], a[196:199], a[16:19], v[124:127]
    ds_read_b128 a[84:87], v35 offset:6144
    v_mfma_f32_16x16x32_bf16 v[132:135], a[196:199], a[20:23], v[132:135]
    ds_read_b64_tr_b16 a[196:197], v22 offset:16384
    ds_read_b64_tr_b16 a[198:199], v22 offset:18432
    v_mfma_f32_16x16x32_bf16 v[112:115], a[200:203], a[24:27], v[112:115]
    buffer_load_dwordx4 v9, s[24:27], s57 offen offset:1024 lds
    v_mfma_f32_16x16x32_bf16 v[120:123], a[200:203], a[28:31], v[120:123]
    ds_read_b128 a[88:91], v35 offset:7168
    v_mfma_f32_16x16x32_bf16 v[128:131], a[200:203], a[32:35], v[128:131]
    ds_read_b128 a[92:95], v35 offset:8192
    buffer_load_dwordx4 v10, s[24:27], s57 offen offset:2048 lds
    v_mfma_f32_16x16x32_bf16 v[116:119], a[204:207], a[24:27], v[116:119]
    s_add_u32 s57, s45, 122880
    ds_read_b128 a[96:99], v35 offset:12288
    s_add_u32 m0, s51, 147456
    v_mfma_f32_16x16x32_bf16 v[124:127], a[204:207], a[28:31], v[124:127]
    s_add_u32 s45, s44, 256
    ds_read_b128 a[100:103], v35 offset:13312
    buffer_load_dwordx4 v8, s[24:27], s57 offen lds
    v_mfma_f32_16x16x32_bf16 v[132:135], a[204:207], a[32:35], v[132:135]
    ds_read_b128 a[104:107], v35 offset:14336
    v_mfma_f32_16x16x32_bf16 v[112:115], a[184:187], a[36:39], v[112:115]
    ds_read_b128 a[108:111], v35 offset:18432
    buffer_load_dwordx4 v9, s[24:27], s57 offen offset:1024 lds
    v_mfma_f32_16x16x32_bf16 v[120:123], a[184:187], a[40:43], v[120:123]
    ds_read_b128 a[112:115], v35 offset:19456
    v_mfma_f32_16x16x32_bf16 v[128:131], a[184:187], a[44:47], v[128:131]
    s_waitcnt lgkmcnt(5)
    ds_read_b128 a[116:119], v35 offset:20480
    buffer_load_dwordx4 v10, s[24:27], s57 offen offset:2048 lds
    v_mfma_f32_16x16x32_bf16 v[116:119], a[188:191], a[36:39], v[116:119]
    s_add_u32 m0, s51, 0
    ds_read_b128 a[120:123], v35 offset:24576
    s_sub_u32 s57, s45, 1280
    s_cselect_b32 s45, s45, s57
    v_mfma_f32_16x16x32_bf16 v[124:127], a[188:191], a[40:43], v[124:127]
    s_add_u32 s57, s45, 3932160
    ds_read_b128 a[124:127], v35 offset:25600
    v_mfma_f32_16x16x32_bf16 v[132:135], a[188:191], a[44:47], v[132:135]
    ds_read_b128 a[128:131], v35 offset:26624
    v_mfma_f32_16x16x32_bf16 v[112:115], a[192:195], a[48:51], v[112:115]
    ds_read_b128 a[132:135], v35 offset:30720
    v_mfma_f32_16x16x32_bf16 v[120:123], a[192:195], a[52:55], v[120:123]
    ds_read_b128 a[136:139], v35 offset:31744
    v_mfma_f32_16x16x32_bf16 v[128:131], a[192:195], a[56:59], v[128:131]
    ds_read_b128 a[140:143], v35 offset:32768
    v_mfma_f32_16x16x32_bf16 v[116:119], a[196:199], a[48:51], v[116:119]
    ds_read_b64_tr_b16 a[200:201], v21 offset:20480
    ds_read_b64_tr_b16 a[202:203], v21 offset:22528
    v_mfma_f32_16x16x32_bf16 v[124:127], a[196:199], a[52:55], v[124:127]
    ds_read_b64_tr_b16 a[204:205], v22 offset:20480
    ds_read_b64_tr_b16 a[206:207], v22 offset:22528
    v_mfma_f32_16x16x32_bf16 v[132:135], a[196:199], a[56:59], v[132:135]
    s_waitcnt lgkmcnt(2)
    v_mfma_f32_16x16x32_bf16 v[112:115], a[200:203], a[60:63], v[112:115]
    v_mfma_f32_16x16x32_bf16 v[120:123], a[200:203], a[64:67], v[120:123]
    s_waitcnt vmcnt(18) lgkmcnt(0)
    s_barrier
    ds_read_b64_tr_b16 a[184:185], v21 offset:24576
    v_mfma_f32_16x16x32_bf16 v[128:131], a[200:203], a[68:71], v[128:131]
    ds_read_b64_tr_b16 a[186:187], v21 offset:26624
    ds_read_b64_tr_b16 a[188:189], v22 offset:24576
    v_mfma_f32_16x16x32_bf16 v[116:119], a[204:207], a[60:63], v[116:119]
    ds_read_b64_tr_b16 a[190:191], v22 offset:26624
    ds_read_b64_tr_b16 a[192:193], v21 offset:28672
    v_mfma_f32_16x16x32_bf16 v[124:127], a[204:207], a[64:67], v[124:127]
    ds_read_b64_tr_b16 a[194:195], v21 offset:30720
    ds_read_b64_tr_b16 a[196:197], v22 offset:28672
    v_mfma_f32_16x16x32_bf16 v[132:135], a[204:207], a[68:71], v[132:135]
    ds_read_b64_tr_b16 a[198:199], v22 offset:30720
    ds_read_b64_tr_b16 a[200:201], v21 offset:32768
    ds_read_b64_tr_b16 a[202:203], v21 offset:34816
    buffer_load_dwordx4 v8, s[24:27], s57 offen lds
    ds_read_b64_tr_b16 a[204:205], v22 offset:32768
    ds_read_b64_tr_b16 a[206:207], v22 offset:34816
    s_waitcnt lgkmcnt(10)
    v_mfma_f32_16x16x32_bf16 v[64:67], a[184:187], a[72:75], v[64:67]
    buffer_load_dwordx4 v9, s[24:27], s57 offen offset:1024 lds
    v_mfma_f32_16x16x32_bf16 v[72:75], a[184:187], a[76:79], v[72:75]
    v_mfma_f32_16x16x32_bf16 v[80:83], a[184:187], a[80:83], v[80:83]
    s_waitcnt lgkmcnt(6)
    ds_read_b64_tr_b16 a[184:185], v21 offset:36864
    ds_read_b64_tr_b16 a[186:187], v21 offset:38912
    v_mfma_f32_16x16x32_bf16 v[68:71], a[188:191], a[72:75], v[68:71]
    buffer_load_dwordx4 v10, s[24:27], s57 offen offset:2048 lds
    v_mfma_f32_16x16x32_bf16 v[76:79], a[188:191], a[76:79], v[76:79]
    s_add_u32 s57, s45, 4055040
    s_add_u32 m0, s51, 12288
    s_add_u32 s45, s44, 512
    v_mfma_f32_16x16x32_bf16 v[84:87], a[188:191], a[80:83], v[84:87]
    ds_read_b64_tr_b16 a[188:189], v22 offset:36864
    ds_read_b64_tr_b16 a[190:191], v22 offset:38912
    v_mfma_f32_16x16x32_bf16 v[64:67], a[192:195], a[84:87], v[64:67]
    buffer_load_dwordx4 v8, s[24:27], s57 offen lds
    v_mfma_f32_16x16x32_bf16 v[72:75], a[192:195], a[88:91], v[72:75]
    v_mfma_f32_16x16x32_bf16 v[80:83], a[192:195], a[92:95], v[80:83]
    s_waitcnt lgkmcnt(4)
    ds_read_b64_tr_b16 a[192:193], v21 offset:40960
    ds_read_b64_tr_b16 a[194:195], v21 offset:43008
    v_mfma_f32_16x16x32_bf16 v[68:71], a[196:199], a[84:87], v[68:71]
    buffer_load_dwordx4 v9, s[24:27], s57 offen offset:1024 lds
    v_mfma_f32_16x16x32_bf16 v[76:79], a[196:199], a[88:91], v[76:79]
    v_mfma_f32_16x16x32_bf16 v[84:87], a[196:199], a[92:95], v[84:87]
    ds_read_b64_tr_b16 a[196:197], v22 offset:40960
    ds_read_b64_tr_b16 a[198:199], v22 offset:43008
    v_mfma_f32_16x16x32_bf16 v[64:67], a[200:203], a[96:99], v[64:67]
    buffer_load_dwordx4 v10, s[24:27], s57 offen offset:2048 lds
    v_mfma_f32_16x16x32_bf16 v[72:75], a[200:203], a[100:103], v[72:75]
    s_add_u32 m0, s51, 98304
    s_sub_u32 s57, s45, 1280
    s_cselect_b32 s45, s45, s57
    v_mfma_f32_16x16x32_bf16 v[80:83], a[200:203], a[104:107], v[80:83]
    s_add_u32 s57, s45, 0
    ds_read_b64_tr_b16 a[200:201], v21 offset:45056
    ds_read_b64_tr_b16 a[202:203], v21 offset:47104
    v_mfma_f32_16x16x32_bf16 v[68:71], a[204:207], a[96:99], v[68:71]
    buffer_load_dwordx4 v8, s[24:27], s57 offen lds
    v_mfma_f32_16x16x32_bf16 v[76:79], a[204:207], a[100:103], v[76:79]
    v_mfma_f32_16x16x32_bf16 v[84:87], a[204:207], a[104:107], v[84:87]
    s_waitcnt lgkmcnt(4)
    ds_read_b64_tr_b16 a[204:205], v22 offset:45056
    ds_read_b64_tr_b16 a[206:207], v22 offset:47104
    v_mfma_f32_16x16x32_bf16 v[64:67], a[184:187], a[108:111], v[64:67]
    buffer_load_dwordx4 v9, s[24:27], s57 offen offset:1024 lds
    v_mfma_f32_16x16x32_bf16 v[72:75], a[184:187], a[112:115], v[72:75]
    v_mfma_f32_16x16x32_bf16 v[80:83], a[184:187], a[116:119], v[80:83]
    buffer_load_dwordx4 v10, s[24:27], s57 offen offset:2048 lds
    v_mfma_f32_16x16x32_bf16 v[68:71], a[188:191], a[108:111], v[68:71]
    s_add_u32 s57, s45, 122880
    s_add_u32 m0, s51, 110592
    s_add_u32 s45, s44, 384
    v_mfma_f32_16x16x32_bf16 v[76:79], a[188:191], a[112:115], v[76:79]
    buffer_load_dwordx4 v8, s[24:27], s57 offen lds
    v_mfma_f32_16x16x32_bf16 v[84:87], a[188:191], a[116:119], v[84:87]
    v_mfma_f32_16x16x32_bf16 v[64:67], a[192:195], a[120:123], v[64:67]
    buffer_load_dwordx4 v9, s[24:27], s57 offen offset:1024 lds
    v_mfma_f32_16x16x32_bf16 v[72:75], a[192:195], a[124:127], v[72:75]
    v_mfma_f32_16x16x32_bf16 v[80:83], a[192:195], a[128:131], v[80:83]
    s_waitcnt lgkmcnt(0)
    buffer_load_dwordx4 v10, s[24:27], s57 offen offset:2048 lds
    v_mfma_f32_16x16x32_bf16 v[68:71], a[196:199], a[120:123], v[68:71]
    s_add_u32 m0, s51, 24576
    s_waitcnt vmcnt(24)
    s_barrier
    v_mfma_f32_16x16x32_bf16 v[76:79], a[196:199], a[124:127], v[76:79]
    ds_read_b64_tr_b16 a[184:185], v23 offset:24576
    ds_read_b64_tr_b16 a[186:187], v23 offset:26624
    v_mfma_f32_16x16x32_bf16 v[84:87], a[196:199], a[128:131], v[84:87]
    ds_read_b64_tr_b16 a[188:189], v24 offset:24576
    ds_read_b64_tr_b16 a[190:191], v24 offset:26624
    v_mfma_f32_16x16x32_bf16 v[64:67], a[200:203], a[132:135], v[64:67]
    ds_read_b64_tr_b16 a[192:193], v23 offset:28672
    ds_read_b64_tr_b16 a[194:195], v23 offset:30720
    v_mfma_f32_16x16x32_bf16 v[72:75], a[200:203], a[136:139], v[72:75]
    ds_read_b64_tr_b16 a[196:197], v24 offset:28672
    ds_read_b64_tr_b16 a[198:199], v24 offset:30720
    v_mfma_f32_16x16x32_bf16 v[80:83], a[200:203], a[140:143], v[80:83]
    ds_read_b64_tr_b16 a[200:201], v23 offset:32768
    ds_read_b64_tr_b16 a[202:203], v23 offset:34816
    v_mfma_f32_16x16x32_bf16 v[68:71], a[204:207], a[132:135], v[68:71]
    v_cvt_pk_bf16_f32 v64, v64, v65
    v_cvt_pk_bf16_f32 v65, v66, v67
    v_mfma_f32_16x16x32_bf16 v[76:79], a[204:207], a[136:139], v[76:79]
    v_cndmask_b32 v12, v12, v64, s[6:7]
    v_cndmask_b32 v13, v13, v65, s[6:7]
    v_mfma_f32_16x16x32_bf16 v[84:87], a[204:207], a[140:143], v[84:87]
    s_waitcnt lgkmcnt(8)
    ds_read_b64_tr_b16 a[204:205], v24 offset:32768
    ds_read_b64_tr_b16 a[206:207], v24 offset:34816
    v_mfma_f32_16x16x32_bf16 v[136:139], a[184:187], a[0:3], 0
    v_cvt_pk_bf16_f32 v66, v68, v69
    v_cvt_pk_bf16_f32 v67, v70, v71
    v_mfma_f32_16x16x32_bf16 v[144:147], a[184:187], a[4:7], 0
    v_cndmask_b32 v68, v5, v20, s[6:7]
    v_cndmask_b32 v14, v14, v66, s[6:7]
    v_mfma_f32_16x16x32_bf16 v[152:155], a[184:187], a[8:11], 0
    s_waitcnt lgkmcnt(4)
    buffer_store_dwordx4 v[64:67], v68, s[32:35], s66 offen sc1
    v_mfma_f32_16x16x32_bf16 v[140:143], a[188:191], a[0:3], 0
    s_nop 0
    s_sub_u32 s66, s64, 1
    ds_read_b64_tr_b16 a[184:185], v23 offset:36864
    ds_read_b64_tr_b16 a[186:187], v23 offset:38912
    v_mfma_f32_16x16x32_bf16 v[148:151], a[188:191], a[4:7], 0
    v_cndmask_b32 v15, v15, v67, s[6:7]
    v_cvt_pk_bf16_f32 v72, v72, v73
    v_mfma_f32_16x16x32_bf16 v[156:159], a[188:191], a[8:11], 0
    ds_read_b64_tr_b16 a[188:189], v24 offset:36864
    ds_read_b64_tr_b16 a[190:191], v24 offset:38912
    v_mfma_f32_16x16x32_bf16 v[136:139], a[192:195], a[12:15], v[136:139]
    s_and_b32 s66, s66, 15
    s_cselect_b64 s[6:7], 0, -1
    v_cvt_pk_bf16_f32 v73, v74, v75
    v_mfma_f32_16x16x32_bf16 v[144:147], a[192:195], a[16:19], v[144:147]
    s_mul_i32 s66, s66, 122880
    v_cvt_pk_bf16_f32 v74, v76, v77
    v_cvt_pk_bf16_f32 v75, v78, v79
    v_mfma_f32_16x16x32_bf16 v[152:155], a[192:195], a[20:23], v[152:155]
    s_add_u32 s66, s66, 1024
    v_cndmask_b32 v76, v5, v20, s[6:7]
    v_cndmask_b32 v12, v12, v72, s[6:7]
    v_mfma_f32_16x16x32_bf16 v[140:143], a[196:199], a[12:15], v[140:143]
    buffer_store_dwordx4 v[72:75], v76, s[32:35], s66 offen sc1
    v_mfma_f32_16x16x32_bf16 v[148:151], a[196:199], a[16:19], v[148:151]
    s_nop 0
    s_sub_u32 s66, s64, 2
    v_cndmask_b32 v13, v13, v73, s[6:7]
    v_cndmask_b32 v14, v14, v74, s[6:7]
    v_mfma_f32_16x16x32_bf16 v[156:159], a[196:199], a[20:23], v[156:159]
    s_waitcnt lgkmcnt(1)
    v_cndmask_b32 v15, v15, v75, s[6:7]
    v_cvt_pk_bf16_f32 v80, v80, v81
    v_mfma_f32_16x16x32_bf16 v[136:139], a[200:203], a[24:27], v[136:139]
    s_and_b32 s66, s66, 15
    s_cselect_b64 s[6:7], 0, -1
    v_cvt_pk_bf16_f32 v81, v82, v83
    v_mfma_f32_16x16x32_bf16 v[144:147], a[200:203], a[28:31], v[144:147]
    s_mul_i32 s66, s66, 122880
    v_cvt_pk_bf16_f32 v82, v84, v85
    v_cvt_pk_bf16_f32 v83, v86, v87
    v_mfma_f32_16x16x32_bf16 v[152:155], a[200:203], a[32:35], v[152:155]
    s_add_u32 s66, s66, 2048
    ds_read_b64_tr_b16 a[192:193], v23 offset:40960
    ds_read_b64_tr_b16 a[194:195], v23 offset:43008
    v_mfma_f32_16x16x32_bf16 v[140:143], a[204:207], a[24:27], v[140:143]
    v_cndmask_b32 v84, v5, v20, s[6:7]
    v_cndmask_b32 v12, v12, v80, s[6:7]
    v_mfma_f32_16x16x32_bf16 v[148:151], a[204:207], a[28:31], v[148:151]
    buffer_store_dwordx4 v[80:83], v84, s[32:35], s66 offen sc1
    v_mfma_f32_16x16x32_bf16 v[156:159], a[204:207], a[32:35], v[156:159]
    s_nop 0
    s_sub_u32 s66, s64, 3
    v_cndmask_b32 v13, v13, v81, s[6:7]
    v_cndmask_b32 v14, v14, v82, s[6:7]
    v_mfma_f32_16x16x32_bf16 v[136:139], a[184:187], a[36:39], v[136:139]
    v_cndmask_b32 v15, v15, v83, s[6:7]
    s_sub_u32 s57, s45, 1280
    s_cselect_b32 s45, s45, s57
    v_mfma_f32_16x16x32_bf16 v[144:147], a[184:187], a[40:43], v[144:147]
    s_add_u32 s57, s45, 3932160
    ds_read_b64_tr_b16 a[196:197], v24 offset:40960
    ds_read_b64_tr_b16 a[198:199], v24 offset:43008
    v_mfma_f32_16x16x32_bf16 v[152:155], a[184:187], a[44:47], v[152:155]
    s_waitcnt lgkmcnt(3)
    buffer_load_dwordx4 v8, s[24:27], s57 offen lds
    v_mfma_f32_16x16x32_bf16 v[140:143], a[188:191], a[36:39], v[140:143]
    ds_read_b64_tr_b16 a[200:201], v23 offset:45056
    ds_read_b64_tr_b16 a[202:203], v23 offset:47104
    v_mfma_f32_16x16x32_bf16 v[148:151], a[188:191], a[40:43], v[148:151]
    ds_read_b64_tr_b16 a[204:205], v24 offset:45056
    ds_read_b64_tr_b16 a[206:207], v24 offset:47104
    v_mfma_f32_16x16x32_bf16 v[156:159], a[188:191], a[44:47], v[156:159]
    s_and_b32 s66, s66, 15
    s_cselect_b64 s[6:7], 0, -1
    s_mul_i32 s66, s66, 122880
    s_waitcnt lgkmcnt(6)
    v_mfma_f32_16x16x32_bf16 v[136:139], a[192:195], a[48:51], v[136:139]
    s_add_u32 s66, s66, 12288
    v_mfma_f32_16x16x32_bf16 v[144:147], a[192:195], a[52:55], v[144:147]
    buffer_load_dwordx4 v9, s[24:27], s57 offen offset:1024 lds
    v_mfma_f32_16x16x32_bf16 v[152:155], a[192:195], a[56:59], v[152:155]
    s_waitcnt lgkmcnt(4)
    v_mfma_f32_16x16x32_bf16 v[140:143], a[196:199], a[48:51], v[140:143]
    v_mfma_f32_16x16x32_bf16 v[148:151], a[196:199], a[52:55], v[148:151]
    v_mfma_f32_16x16x32_bf16 v[156:159], a[196:199], a[56:59], v[156:159]
    s_waitcnt lgkmcnt(0)
    v_mfma_f32_16x16x32_bf16 v[136:139], a[200:203], a[60:63], v[136:139]
    buffer_load_dwordx4 v10, s[24:27], s57 offen offset:2048 lds
    v_mfma_f32_16x16x32_bf16 v[144:147], a[200:203], a[64:67], v[144:147]
    s_add_u32 s57, s45, 4055040
    s_add_u32 m0, s51, 36864
    s_add_u32 s45, s44, 768
    v_mfma_f32_16x16x32_bf16 v[152:155], a[200:203], a[68:71], v[152:155]
    v_mfma_f32_16x16x32_bf16 v[140:143], a[204:207], a[60:63], v[140:143]
    v_mfma_f32_16x16x32_bf16 v[148:151], a[204:207], a[64:67], v[148:151]
    v_mfma_f32_16x16x32_bf16 v[156:159], a[204:207], a[68:71], v[156:159]
    buffer_load_dwordx4 v8, s[24:27], s57 offen lds
    buffer_load_dwordx4 v9, s[24:27], s57 offen offset:1024 lds
    buffer_load_dwordx4 v10, s[24:27], s57 offen offset:2048 lds
    s_waitcnt vmcnt(27)
    s_barrier
    ds_read_b64_tr_b16 a[184:185], v23 offset:0
    ds_read_b64_tr_b16 a[186:187], v23 offset:2048
    ds_read_b64_tr_b16 a[188:189], v24 offset:0
    s_sub_u32 s57, s45, 1280
    s_cselect_b32 s45, s45, s57
    ds_read_b64_tr_b16 a[190:191], v24 offset:2048
    ds_read_b64_tr_b16 a[192:193], v23 offset:4096
    s_add_u32 s57, s45, 0
    ds_read_b64_tr_b16 a[194:195], v23 offset:6144
    s_add_u32 m0, s51, 73728
    ds_read_b64_tr_b16 a[196:197], v24 offset:4096
    ds_read_b64_tr_b16 a[198:199], v24 offset:6144
    ds_read_b64_tr_b16 a[200:201], v23 offset:8192
    buffer_load_dwordx4 v8, s[24:27], s57 offen lds
    ds_read_b64_tr_b16 a[202:203], v23 offset:10240
    ds_read_b64_tr_b16 a[204:205], v24 offset:8192
    ds_read_b64_tr_b16 a[206:207], v24 offset:10240
    s_waitcnt lgkmcnt(10)
    v_mfma_f32_16x16x32_bf16 v[112:115], a[184:187], a[72:75], v[112:115]
    v_mfma_f32_16x16x32_bf16 v[120:123], a[184:187], a[76:79], v[120:123]
    v_mfma_f32_16x16x32_bf16 v[128:131], a[184:187], a[80:83], v[128:131]
    s_waitcnt lgkmcnt(6)
    ds_read_b64_tr_b16 a[184:185], v23 offset:12288
    ds_read_b64_tr_b16 a[186:187], v23 offset:14336
    v_mfma_f32_16x16x32_bf16 v[116:119], a[188:191], a[72:75], v[116:119]
    buffer_load_dwordx4 v9, s[24:27], s57 offen offset:1024 lds
    v_mfma_f32_16x16x32_bf16 v[124:127], a[188:191], a[76:79], v[124:127]
    v_mfma_f32_16x16x32_bf16 v[132:135], a[188:191], a[80:83], v[132:135]
    ds_read_b64_tr_b16 a[188:189], v24 offset:12288
    ds_read_b64_tr_b16 a[190:191], v24 offset:14336
    v_mfma_f32_16x16x32_bf16 v[112:115], a[192:195], a[84:87], v[112:115]
    v_mfma_f32_16x16x32_bf16 v[120:123], a[192:195], a[88:91], v[120:123]
    v_mfma_f32_16x16x32_bf16 v[128:131], a[192:195], a[92:95], v[128:131]
    s_waitcnt lgkmcnt(4)
    buffer_load_dwordx4 v10, s[24:27], s57 offen offset:2048 lds
    v_mfma_f32_16x16x32_bf16 v[116:119], a[196:199], a[84:87], v[116:119]
    s_add_u32 s57, s45, 122880
    ds_read_b64_tr_b16 a[192:193], v23 offset:16384
    ds_read_b64_tr_b16 a[194:195], v23 offset:18432
    v_mfma_f32_16x16x32_bf16 v[124:127], a[196:199], a[88:91], v[124:127]
    s_add_u32 m0, s51, 86016
    s_add_u32 s45, s44, 512
    v_mfma_f32_16x16x32_bf16 v[132:135], a[196:199], a[92:95], v[132:135]
    ds_read_b64_tr_b16 a[196:197], v24 offset:16384
    ds_read_b64_tr_b16 a[198:199], v24 offset:18432
    v_mfma_f32_16x16x32_bf16 v[112:115], a[200:203], a[96:99], v[112:115]
    v_mfma_f32_16x16x32_bf16 v[120:123], a[200:203], a[100:103], v[120:123]
    buffer_load_dwordx4 v8, s[24:27], s57 offen lds
    v_mfma_f32_16x16x32_bf16 v[128:131], a[200:203], a[104:107], v[128:131]
    ds_read_b64_tr_b16 a[200:201], v23 offset:20480
    ds_read_b64_tr_b16 a[202:203], v23 offset:22528
    v_mfma_f32_16x16x32_bf16 v[116:119], a[204:207], a[96:99], v[116:119]
    v_mfma_f32_16x16x32_bf16 v[124:127], a[204:207], a[100:103], v[124:127]
    v_mfma_f32_16x16x32_bf16 v[132:135], a[204:207], a[104:107], v[132:135]
    s_waitcnt lgkmcnt(4)
    ds_read_b64_tr_b16 a[204:205], v24 offset:20480
    ds_read_b64_tr_b16 a[206:207], v24 offset:22528
    v_mfma_f32_16x16x32_bf16 v[112:115], a[184:187], a[108:111], v[112:115]
    buffer_load_dwordx4 v9, s[24:27], s57 offen offset:1024 lds
    v_mfma_f32_16x16x32_bf16 v[120:123], a[184:187], a[112:115], v[120:123]
    v_mfma_f32_16x16x32_bf16 v[128:131], a[184:187], a[116:119], v[128:131]
    v_mfma_f32_16x16x32_bf16 v[116:119], a[188:191], a[108:111], v[116:119]
    v_mfma_f32_16x16x32_bf16 v[124:127], a[188:191], a[112:115], v[124:127]
    v_mfma_f32_16x16x32_bf16 v[132:135], a[188:191], a[116:119], v[132:135]
    buffer_load_dwordx4 v10, s[24:27], s57 offen offset:2048 lds
    v_mfma_f32_16x16x32_bf16 v[112:115], a[192:195], a[120:123], v[112:115]
    s_add_u32 m0, s51, 49152
    s_waitcnt vmcnt(27) lgkmcnt(0)
    s_barrier
    v_mfma_f32_16x16x32_bf16 v[120:123], a[192:195], a[124:127], v[120:123]
    ds_read_b64_tr_b16 a[184:185], v25 offset:36864
    ds_read_b64_tr_b16 a[186:187], v25 offset:38912
    v_mfma_f32_16x16x32_bf16 v[128:131], a[192:195], a[128:131], v[128:131]
    ds_read_b64_tr_b16 a[188:189], v26 offset:36864
    ds_read_b64_tr_b16 a[190:191], v26 offset:38912
    v_mfma_f32_16x16x32_bf16 v[116:119], a[196:199], a[120:123], v[116:119]
    ds_read_b64_tr_b16 a[192:193], v25 offset:40960
    ds_read_b64_tr_b16 a[194:195], v25 offset:43008
    v_mfma_f32_16x16x32_bf16 v[124:127], a[196:199], a[124:127], v[124:127]
    s_sub_u32 s57, s45, 1280
    s_cselect_b32 s45, s45, s57
    s_add_u32 s57, s45, 3932160
    v_mfma_f32_16x16x32_bf16 v[132:135], a[196:199], a[128:131], v[132:135]
    ds_read_b64_tr_b16 a[196:197], v26 offset:40960
    ds_read_b64_tr_b16 a[198:199], v26 offset:43008
    v_mfma_f32_16x16x32_bf16 v[112:115], a[200:203], a[132:135], v[112:115]
    buffer_load_dwordx4 v8, s[24:27], s57 offen lds
    v_mfma_f32_16x16x32_bf16 v[120:123], a[200:203], a[136:139], v[120:123]
    v_mfma_f32_16x16x32_bf16 v[128:131], a[200:203], a[140:143], v[128:131]
    ds_read_b64_tr_b16 a[200:201], v25 offset:45056
    ds_read_b64_tr_b16 a[202:203], v25 offset:47104
    v_mfma_f32_16x16x32_bf16 v[116:119], a[204:207], a[132:135], v[116:119]
    s_nop 1
    v_cvt_pk_bf16_f32 v112, v112, v113
    v_cvt_pk_bf16_f32 v113, v114, v115
    v_mfma_f32_16x16x32_bf16 v[124:127], a[204:207], a[136:139], v[124:127]
    v_cndmask_b32 v12, v12, v112, s[6:7]
    v_cndmask_b32 v13, v13, v113, s[6:7]
    v_mfma_f32_16x16x32_bf16 v[132:135], a[204:207], a[140:143], v[132:135]
    s_waitcnt lgkmcnt(4)
    ds_read_b64_tr_b16 a[204:205], v26 offset:45056
    ds_read_b64_tr_b16 a[206:207], v26 offset:47104
    v_mfma_f32_16x16x32_bf16 v[160:163], a[184:187], a[0:3], 0
    buffer_load_dwordx4 v9, s[24:27], s57 offen offset:1024 lds
    v_mfma_f32_16x16x32_bf16 v[168:171], a[184:187], a[4:7], 0
    v_cvt_pk_bf16_f32 v114, v116, v117
    v_cvt_pk_bf16_f32 v115, v118, v119
    v_mfma_f32_16x16x32_bf16 v[176:179], a[184:187], a[8:11], 0
    ds_read_b64_tr_b16 a[184:185], v25 offset:49152
    ds_read_b64_tr_b16 a[186:187], v25 offset:51200
    v_mfma_f32_16x16x32_bf16 v[164:167], a[188:191], a[0:3], 0
    v_cndmask_b32 v116, v5, v20, s[6:7]
    v_cndmask_b32 v14, v14, v114, s[6:7]
    v_mfma_f32_16x16x32_bf16 v[172:175], a[188:191], a[4:7], 0
    buffer_store_dwordx4 v[112:115], v116, s[32:35], s66 offen sc1
    v_mfma_f32_16x16x32_bf16 v[180:183], a[188:191], a[8:11], 0
    s_nop 0
    s_sub_u32 s66, s64, 4
    buffer_load_dwordx4 v10, s[24:27], s57 offen offset:2048 lds
    v_mfma_f32_16x16x32_bf16 v[160:163], a[192:195], a[12:15], v[160:163]
    s_add_u32 s57, s45, 4055040
    v_cndmask_b32 v15, v15, v115, s[6:7]
    v_cvt_pk_bf16_f32 v120, v120, v121
    v_mfma_f32_16x16x32_bf16 v[168:171], a[192:195], a[16:19], v[168:171]
    s_add_u32 m0, s51, 61440
    ds_read_b64_tr_b16 a[188:189], v26 offset:49152
    ds_read_b64_tr_b16 a[190:191], v26 offset:51200
    v_mfma_f32_16x16x32_bf16 v[176:179], a[192:195], a[20:23], v[176:179]
    s_add_u32 s45, s44, 640
    s_and_b32 s66, s66, 15
    s_cselect_b64 s[6:7], 0, -1
    s_waitcnt lgkmcnt(2)
    v_mfma_f32_16x16x32_bf16 v[164:167], a[196:199], a[12:15], v[164:167]
    s_mul_i32 s66, s66, 122880
    v_cvt_pk_bf16_f32 v121, v122, v123
    v_cvt_pk_bf16_f32 v122, v124, v125
    v_mfma_f32_16x16x32_bf16 v[172:175], a[196:199], a[16:19], v[172:175]
    s_add_u32 s66, s66, 13312
    buffer_load_dwordx4 v8, s[24:27], s57 offen lds
    v_mfma_f32_16x16x32_bf16 v[180:183], a[196:199], a[20:23], v[180:183]
    v_cvt_pk_bf16_f32 v123, v126, v127
    v_cndmask_b32 v124, v5, v20, s[6:7]
    v_mfma_f32_16x16x32_bf16 v[160:163], a[200:203], a[24:27], v[160:163]
    buffer_store_dwordx4 v[120:123], v124, s[32:35], s66 offen sc1
    v_mfma_f32_16x16x32_bf16 v[168:171], a[200:203], a[28:31], v[168:171]
    s_nop 0
    s_sub_u32 s66, s64, 5
    v_cndmask_b32 v12, v12, v120, s[6:7]
    v_cndmask_b32 v13, v13, v121, s[6:7]
    v_mfma_f32_16x16x32_bf16 v[176:179], a[200:203], a[32:35], v[176:179]
    v_cndmask_b32 v14, v14, v122, s[6:7]
    v_cndmask_b32 v15, v15, v123, s[6:7]
    v_mfma_f32_16x16x32_bf16 v[164:167], a[204:207], a[24:27], v[164:167]
    buffer_load_dwordx4 v9, s[24:27], s57 offen offset:1024 lds
    v_mfma_f32_16x16x32_bf16 v[172:175], a[204:207], a[28:31], v[172:175]
    v_cvt_pk_bf16_f32 v128, v128, v129
    v_cvt_pk_bf16_f32 v129, v130, v131
    v_mfma_f32_16x16x32_bf16 v[180:183], a[204:207], a[32:35], v[180:183]
    s_and_b32 s66, s66, 15
    s_cselect_b64 s[6:7], 0, -1
    v_cvt_pk_bf16_f32 v130, v132, v133
    v_mfma_f32_16x16x32_bf16 v[160:163], a[184:187], a[36:39], v[160:163]
    s_mul_i32 s66, s66, 122880
    ds_read_b64_tr_b16 a[192:193], v25 offset:53248
    ds_read_b64_tr_b16 a[194:195], v25 offset:55296
    v_mfma_f32_16x16x32_bf16 v[168:171], a[184:187], a[40:43], v[168:171]
    s_add_u32 s66, s66, 14336
    v_cvt_pk_bf16_f32 v131, v134, v135
    v_cndmask_b32 v132, v5, v20, s[6:7]
    v_mfma_f32_16x16x32_bf16 v[176:179], a[184:187], a[44:47], v[176:179]
    s_waitcnt lgkmcnt(2)
    buffer_store_dwordx4 v[128:131], v132, s[32:35], s66 offen sc1
    v_mfma_f32_16x16x32_bf16 v[164:167], a[188:191], a[36:39], v[164:167]
    s_nop 0
    s_sub_u32 s66, s64, 6
    buffer_load_dwordx4 v10, s[24:27], s57 offen offset:2048 lds
    v_mfma_f32_16x16x32_bf16 v[172:175], a[188:191], a[40:43], v[172:175]
    s_add_u32 m0, s51, 135168
    v_cndmask_b32 v12, v12, v128, s[6:7]
    v_cndmask_b32 v13, v13, v129, s[6:7]
    v_mfma_f32_16x16x32_bf16 v[180:183], a[188:191], a[44:47], v[180:183]
    s_waitcnt lgkmcnt(1)
    v_cndmask_b32 v14, v14, v130, s[6:7]
    v_cndmask_b32 v15, v15, v131, s[6:7]
    s_sub_u32 s57, s45, 1280
    s_cselect_b32 s45, s45, s57
    s_waitcnt lgkmcnt(0)
    v_mfma_f32_16x16x32_bf16 v[160:163], a[192:195], a[48:51], v[160:163]
    s_add_u32 s57, s45, 3932160
    ds_read_b64_tr_b16 a[196:197], v26 offset:53248
    ds_read_b64_tr_b16 a[198:199], v26 offset:55296
    v_mfma_f32_16x16x32_bf16 v[168:171], a[192:195], a[52:55], v[168:171]
    ds_read_b64_tr_b16 a[200:201], v25 offset:57344
    ds_read_b64_tr_b16 a[202:203], v25 offset:59392
    v_mfma_f32_16x16x32_bf16 v[176:179], a[192:195], a[56:59], v[176:179]
    ds_read_b64_tr_b16 a[204:205], v26 offset:57344
    ds_read_b64_tr_b16 a[206:207], v26 offset:59392
    s_and_b32 s66, s66, 15
    s_cselect_b64 s[6:7], 0, -1
    s_mul_i32 s66, s66, 122880
    s_add_u32 s66, s66, 24576
    s_waitcnt lgkmcnt(4)
    v_mfma_f32_16x16x32_bf16 v[164:167], a[196:199], a[48:51], v[164:167]
    v_mfma_f32_16x16x32_bf16 v[172:175], a[196:199], a[52:55], v[172:175]
    v_mfma_f32_16x16x32_bf16 v[180:183], a[196:199], a[56:59], v[180:183]
    s_waitcnt vmcnt(30) lgkmcnt(0)
    s_barrier
    ds_read_b64_tr_b16 a[184:185], v21 offset:0
    v_mfma_f32_16x16x32_bf16 v[160:163], a[200:203], a[60:63], v[160:163]
    ds_read_b64_tr_b16 a[186:187], v21 offset:2048
    ds_read_b64_tr_b16 a[188:189], v22 offset:0
    v_mfma_f32_16x16x32_bf16 v[168:171], a[200:203], a[64:67], v[168:171]
    ds_read_b64_tr_b16 a[190:191], v22 offset:2048
    ds_read_b64_tr_b16 a[192:193], v21 offset:4096
    v_mfma_f32_16x16x32_bf16 v[176:179], a[200:203], a[68:71], v[176:179]
    ds_read_b64_tr_b16 a[194:195], v21 offset:6144
    ds_read_b64_tr_b16 a[196:197], v22 offset:4096
    v_mfma_f32_16x16x32_bf16 v[164:167], a[204:207], a[60:63], v[164:167]
    ds_read_b64_tr_b16 a[198:199], v22 offset:6144
    ds_read_b64_tr_b16 a[200:201], v21 offset:8192
    v_mfma_f32_16x16x32_bf16 v[172:175], a[204:207], a[64:67], v[172:175]
    ds_read_b64_tr_b16 a[202:203], v21 offset:10240
    buffer_load_dwordx4 v8, s[24:27], s57 offen lds
    v_mfma_f32_16x16x32_bf16 v[180:183], a[204:207], a[68:71], v[180:183]
    s_waitcnt lgkmcnt(8)
    ds_read_b64_tr_b16 a[204:205], v22 offset:8192
    ds_read_b64_tr_b16 a[206:207], v22 offset:10240
    v_mfma_f32_16x16x32_bf16 v[136:139], a[184:187], a[72:75], v[136:139]
    v_mfma_f32_16x16x32_bf16 v[144:147], a[184:187], a[76:79], v[144:147]
    v_mfma_f32_16x16x32_bf16 v[152:155], a[184:187], a[80:83], v[152:155]
    s_waitcnt lgkmcnt(6)
    ds_read_b64_tr_b16 a[184:185], v21 offset:12288
    ds_read_b64_tr_b16 a[186:187], v21 offset:14336
    v_mfma_f32_16x16x32_bf16 v[140:143], a[188:191], a[72:75], v[140:143]
    buffer_load_dwordx4 v9, s[24:27], s57 offen offset:1024 lds
    v_mfma_f32_16x16x32_bf16 v[148:151], a[188:191], a[76:79], v[148:151]
    v_mfma_f32_16x16x32_bf16 v[156:159], a[188:191], a[80:83], v[156:159]
    ds_read_b64_tr_b16 a[188:189], v22 offset:12288
    ds_read_b64_tr_b16 a[190:191], v22 offset:14336
    v_mfma_f32_16x16x32_bf16 v[136:139], a[192:195], a[84:87], v[136:139]
    v_mfma_f32_16x16x32_bf16 v[144:147], a[192:195], a[88:91], v[144:147]
    v_mfma_f32_16x16x32_bf16 v[152:155], a[192:195], a[92:95], v[152:155]
    s_waitcnt lgkmcnt(4)
    buffer_load_dwordx4 v10, s[24:27], s57 offen offset:2048 lds
    v_mfma_f32_16x16x32_bf16 v[140:143], a[196:199], a[84:87], v[140:143]
    s_add_u32 s57, s45, 4055040
    ds_read_b64_tr_b16 a[192:193], v21 offset:16384
    ds_read_b64_tr_b16 a[194:195], v21 offset:18432
    v_mfma_f32_16x16x32_bf16 v[148:151], a[196:199], a[88:91], v[148:151]
    s_add_u32 m0, s51, 147456
    s_add_u32 s45, s44, 768
    v_mfma_f32_16x16x32_bf16 v[156:159], a[196:199], a[92:95], v[156:159]
    ds_read_b64_tr_b16 a[196:197], v22 offset:16384
    ds_read_b64_tr_b16 a[198:199], v22 offset:18432
    v_mfma_f32_16x16x32_bf16 v[136:139], a[200:203], a[96:99], v[136:139]
    v_mfma_f32_16x16x32_bf16 v[144:147], a[200:203], a[100:103], v[144:147]
    buffer_load_dwordx4 v8, s[24:27], s57 offen lds
    v_mfma_f32_16x16x32_bf16 v[152:155], a[200:203], a[104:107], v[152:155]
    ds_read_b64_tr_b16 a[200:201], v21 offset:20480
    ds_read_b64_tr_b16 a[202:203], v21 offset:22528
    v_mfma_f32_16x16x32_bf16 v[140:143], a[204:207], a[96:99], v[140:143]
    v_mfma_f32_16x16x32_bf16 v[148:151], a[204:207], a[100:103], v[148:151]
    v_mfma_f32_16x16x32_bf16 v[156:159], a[204:207], a[104:107], v[156:159]
    s_waitcnt lgkmcnt(4)
    ds_read_b64_tr_b16 a[204:205], v22 offset:20480
    ds_read_b64_tr_b16 a[206:207], v22 offset:22528
    v_mfma_f32_16x16x32_bf16 v[136:139], a[184:187], a[108:111], v[136:139]
    buffer_load_dwordx4 v9, s[24:27], s57 offen offset:1024 lds
    v_mfma_f32_16x16x32_bf16 v[144:147], a[184:187], a[112:115], v[144:147]
    v_mfma_f32_16x16x32_bf16 v[152:155], a[184:187], a[116:119], v[152:155]
    v_mfma_f32_16x16x32_bf16 v[140:143], a[188:191], a[108:111], v[140:143]
    v_mfma_f32_16x16x32_bf16 v[148:151], a[188:191], a[112:115], v[148:151]
    v_mfma_f32_16x16x32_bf16 v[156:159], a[188:191], a[116:119], v[156:159]
    buffer_load_dwordx4 v10, s[24:27], s57 offen offset:2048 lds
    v_mfma_f32_16x16x32_bf16 v[136:139], a[192:195], a[120:123], v[136:139]
    s_add_u32 m0, s51, 0
    s_waitcnt vmcnt(30) lgkmcnt(0)
    s_barrier
    v_mfma_f32_16x16x32_bf16 v[144:147], a[192:195], a[124:127], v[144:147]
    ds_read_b64_tr_b16 a[184:185], v25 offset:0
    ds_read_b64_tr_b16 a[186:187], v25 offset:2048
    v_mfma_f32_16x16x32_bf16 v[152:155], a[192:195], a[128:131], v[152:155]
    ds_read_b64_tr_b16 a[188:189], v26 offset:0
    ds_read_b64_tr_b16 a[190:191], v26 offset:2048
    v_mfma_f32_16x16x32_bf16 v[140:143], a[196:199], a[120:123], v[140:143]
    ds_read_b64_tr_b16 a[192:193], v25 offset:4096
    ds_read_b64_tr_b16 a[194:195], v25 offset:6144
    v_mfma_f32_16x16x32_bf16 v[148:151], a[196:199], a[124:127], v[148:151]
    s_sub_u32 s57, s45, 1280
    s_cselect_b32 s45, s45, s57
    s_add_u32 s57, s45, 3932160
    v_mfma_f32_16x16x32_bf16 v[156:159], a[196:199], a[128:131], v[156:159]
    ds_read_b64_tr_b16 a[196:197], v26 offset:4096
    ds_read_b64_tr_b16 a[198:199], v26 offset:6144
    v_mfma_f32_16x16x32_bf16 v[136:139], a[200:203], a[132:135], v[136:139]
    buffer_load_dwordx4 v8, s[24:27], s57 offen lds
    v_mfma_f32_16x16x32_bf16 v[144:147], a[200:203], a[136:139], v[144:147]
    v_mfma_f32_16x16x32_bf16 v[152:155], a[200:203], a[140:143], v[152:155]
    ds_read_b64_tr_b16 a[200:201], v25 offset:8192
    ds_read_b64_tr_b16 a[202:203], v25 offset:10240
    v_mfma_f32_16x16x32_bf16 v[140:143], a[204:207], a[132:135], v[140:143]
    s_nop 1
    v_cvt_pk_bf16_f32 v136, v136, v137
    v_cvt_pk_bf16_f32 v137, v138, v139
    v_mfma_f32_16x16x32_bf16 v[148:151], a[204:207], a[136:139], v[148:151]
    v_cndmask_b32 v12, v12, v136, s[6:7]
    v_cndmask_b32 v13, v13, v137, s[6:7]
    v_mfma_f32_16x16x32_bf16 v[156:159], a[204:207], a[140:143], v[156:159]
    s_waitcnt lgkmcnt(4)
    ds_read_b64_tr_b16 a[204:205], v26 offset:8192
    ds_read_b64_tr_b16 a[206:207], v26 offset:10240
    v_mfma_f32_16x16x32_bf16 v[184:187], a[184:187], a[0:3], 0
    buffer_load_dwordx4 v9, s[24:27], s57 offen offset:1024 lds
    v_mfma_f32_16x16x32_bf16 v[192:195], a[184:187], a[4:7], 0
    v_cvt_pk_bf16_f32 v138, v140, v141
    v_cvt_pk_bf16_f32 v139, v142, v143
    v_mfma_f32_16x16x32_bf16 v[200:203], a[184:187], a[8:11], 0
    ds_read_b64_tr_b16 a[184:185], v25 offset:12288
    ds_read_b64_tr_b16 a[186:187], v25 offset:14336
    v_mfma_f32_16x16x32_bf16 v[188:191], a[188:191], a[0:3], 0
    v_cndmask_b32 v140, v5, v20, s[6:7]
    v_cndmask_b32 v14, v14, v138, s[6:7]
    v_mfma_f32_16x16x32_bf16 v[196:199], a[188:191], a[4:7], 0
    buffer_store_dwordx4 v[136:139], v140, s[32:35], s66 offen sc1
    v_mfma_f32_16x16x32_bf16 v[204:207], a[188:191], a[8:11], 0
    s_nop 0
    s_sub_u32 s66, s64, 7
    buffer_load_dwordx4 v10, s[24:27], s57 offen offset:2048 lds
    v_mfma_f32_16x16x32_bf16 v[184:187], a[192:195], a[12:15], v[184:187]
    s_add_u32 s57, s45, 4055040
    v_cndmask_b32 v15, v15, v139, s[6:7]
    v_cvt_pk_bf16_f32 v144, v144, v145
    v_mfma_f32_16x16x32_bf16 v[192:195], a[192:195], a[16:19], v[192:195]
    s_add_u32 m0, s51, 12288
    ds_read_b64_tr_b16 a[188:189], v26 offset:12288
    ds_read_b64_tr_b16 a[190:191], v26 offset:14336
    v_mfma_f32_16x16x32_bf16 v[200:203], a[192:195], a[20:23], v[200:203]
    s_add_u32 s45, s44, 896
    s_and_b32 s66, s66, 15
    s_cselect_b64 s[6:7], 0, -1
    s_waitcnt lgkmcnt(2)
    v_mfma_f32_16x16x32_bf16 v[188:191], a[196:199], a[12:15], v[188:191]
    s_mul_i32 s66, s66, 122880
    v_cvt_pk_bf16_f32 v145, v146, v147
    v_cvt_pk_bf16_f32 v146, v148, v149
    v_mfma_f32_16x16x32_bf16 v[196:199], a[196:199], a[16:19], v[196:199]
    s_add_u32 s66, s66, 25600
    buffer_load_dwordx4 v8, s[24:27], s57 offen lds
    v_mfma_f32_16x16x32_bf16 v[204:207], a[196:199], a[20:23], v[204:207]
    v_cvt_pk_bf16_f32 v147, v150, v151
    v_cndmask_b32 v148, v5, v20, s[6:7]
    v_mfma_f32_16x16x32_bf16 v[184:187], a[200:203], a[24:27], v[184:187]
    buffer_store_dwordx4 v[144:147], v148, s[32:35], s66 offen sc1
    v_mfma_f32_16x16x32_bf16 v[192:195], a[200:203], a[28:31], v[192:195]
    s_nop 0
    s_sub_u32 s66, s64, 8
    v_cndmask_b32 v12, v12, v144, s[6:7]
    v_cndmask_b32 v13, v13, v145, s[6:7]
    v_mfma_f32_16x16x32_bf16 v[200:203], a[200:203], a[32:35], v[200:203]
    v_cndmask_b32 v14, v14, v146, s[6:7]
    v_cndmask_b32 v15, v15, v147, s[6:7]
    v_mfma_f32_16x16x32_bf16 v[188:191], a[204:207], a[24:27], v[188:191]
    buffer_load_dwordx4 v9, s[24:27], s57 offen offset:1024 lds
    v_mfma_f32_16x16x32_bf16 v[196:199], a[204:207], a[28:31], v[196:199]
    v_cvt_pk_bf16_f32 v152, v152, v153
    v_cvt_pk_bf16_f32 v153, v154, v155
    v_mfma_f32_16x16x32_bf16 v[204:207], a[204:207], a[32:35], v[204:207]
    s_and_b32 s66, s66, 15
    s_cselect_b64 s[6:7], 0, -1
    v_cvt_pk_bf16_f32 v154, v156, v157
    v_mfma_f32_16x16x32_bf16 v[184:187], a[184:187], a[36:39], v[184:187]
    s_mul_i32 s66, s66, 122880
    ds_read_b64_tr_b16 a[192:193], v25 offset:16384
    ds_read_b64_tr_b16 a[194:195], v25 offset:18432
    v_mfma_f32_16x16x32_bf16 v[192:195], a[184:187], a[40:43], v[192:195]
    s_add_u32 s66, s66, 26624
    v_cvt_pk_bf16_f32 v155, v158, v159
    v_cndmask_b32 v156, v5, v20, s[6:7]
    v_mfma_f32_16x16x32_bf16 v[200:203], a[184:187], a[44:47], v[200:203]
    s_waitcnt lgkmcnt(2)
    buffer_store_dwordx4 v[152:155], v156, s[32:35], s66 offen sc1
    v_mfma_f32_16x16x32_bf16 v[188:191], a[188:191], a[36:39], v[188:191]
    s_nop 0
    s_sub_u32 s66, s64, 9
    buffer_load_dwordx4 v10, s[24:27], s57 offen offset:2048 lds
    v_mfma_f32_16x16x32_bf16 v[196:199], a[188:191], a[40:43], v[196:199]
    s_add_u32 m0, s51, 98304
    v_cndmask_b32 v12, v12, v152, s[6:7]
    v_cndmask_b32 v13, v13, v153, s[6:7]
    v_mfma_f32_16x16x32_bf16 v[204:207], a[188:191], a[44:47], v[204:207]
    s_waitcnt lgkmcnt(1)
    v_cndmask_b32 v14, v14, v154, s[6:7]
    v_cndmask_b32 v15, v15, v155, s[6:7]
    s_sub_u32 s57, s45, 1280
    s_cselect_b32 s45, s45, s57
    s_waitcnt lgkmcnt(0)
    v_mfma_f32_16x16x32_bf16 v[184:187], a[192:195], a[48:51], v[184:187]
    s_add_u32 s57, s45, 3932160
    ds_read_b64_tr_b16 a[196:197], v26 offset:16384
    ds_read_b64_tr_b16 a[198:199], v26 offset:18432
    v_mfma_f32_16x16x32_bf16 v[192:195], a[192:195], a[52:55], v[192:195]
    ds_read_b64_tr_b16 a[200:201], v25 offset:20480
    ds_read_b64_tr_b16 a[202:203], v25 offset:22528
    v_mfma_f32_16x16x32_bf16 v[200:203], a[192:195], a[56:59], v[200:203]
    ds_read_b64_tr_b16 a[204:205], v26 offset:20480
    ds_read_b64_tr_b16 a[206:207], v26 offset:22528
    s_and_b32 s66, s66, 15
    s_cselect_b64 s[6:7], 0, -1
    s_mul_i32 s66, s66, 122880
    s_add_u32 s66, s66, 36864
    s_waitcnt lgkmcnt(4)
    v_mfma_f32_16x16x32_bf16 v[188:191], a[196:199], a[48:51], v[188:191]
    v_mfma_f32_16x16x32_bf16 v[196:199], a[196:199], a[52:55], v[196:199]
    v_mfma_f32_16x16x32_bf16 v[204:207], a[196:199], a[56:59], v[204:207]
    s_waitcnt vmcnt(30) lgkmcnt(0)
    s_barrier
    ds_read_b64_tr_b16 a[184:185], v21 offset:24576
    v_mfma_f32_16x16x32_bf16 v[184:187], a[200:203], a[60:63], v[184:187]
    ds_read_b64_tr_b16 a[186:187], v21 offset:26624
    ds_read_b64_tr_b16 a[188:189], v22 offset:24576
    v_mfma_f32_16x16x32_bf16 v[192:195], a[200:203], a[64:67], v[192:195]
    ds_read_b64_tr_b16 a[190:191], v22 offset:26624
    ds_read_b64_tr_b16 a[192:193], v21 offset:28672
    v_mfma_f32_16x16x32_bf16 v[200:203], a[200:203], a[68:71], v[200:203]
    ds_read_b64_tr_b16 a[194:195], v21 offset:30720
    ds_read_b64_tr_b16 a[196:197], v22 offset:28672
    v_mfma_f32_16x16x32_bf16 v[188:191], a[204:207], a[60:63], v[188:191]
    ds_read_b64_tr_b16 a[198:199], v22 offset:30720
    ds_read_b64_tr_b16 a[200:201], v21 offset:32768
    v_mfma_f32_16x16x32_bf16 v[196:199], a[204:207], a[64:67], v[196:199]
    ds_read_b64_tr_b16 a[202:203], v21 offset:34816
    buffer_load_dwordx4 v8, s[24:27], s57 offen lds
    v_mfma_f32_16x16x32_bf16 v[204:207], a[204:207], a[68:71], v[204:207]
    s_waitcnt lgkmcnt(8)
    ds_read_b64_tr_b16 a[204:205], v22 offset:32768
    ds_read_b64_tr_b16 a[206:207], v22 offset:34816
    v_mfma_f32_16x16x32_bf16 v[160:163], a[184:187], a[72:75], v[160:163]
    v_mfma_f32_16x16x32_bf16 v[168:171], a[184:187], a[76:79], v[168:171]
    v_mfma_f32_16x16x32_bf16 v[176:179], a[184:187], a[80:83], v[176:179]
    s_waitcnt lgkmcnt(6)
    ds_read_b64_tr_b16 a[184:185], v21 offset:36864
    ds_read_b64_tr_b16 a[186:187], v21 offset:38912
    v_mfma_f32_16x16x32_bf16 v[164:167], a[188:191], a[72:75], v[164:167]
    buffer_load_dwordx4 v9, s[24:27], s57 offen offset:1024 lds
    v_mfma_f32_16x16x32_bf16 v[172:175], a[188:191], a[76:79], v[172:175]
    v_mfma_f32_16x16x32_bf16 v[180:183], a[188:191], a[80:83], v[180:183]
    ds_read_b64_tr_b16 a[188:189], v22 offset:36864
    ds_read_b64_tr_b16 a[190:191], v22 offset:38912
    v_mfma_f32_16x16x32_bf16 v[160:163], a[192:195], a[84:87], v[160:163]
    v_mfma_f32_16x16x32_bf16 v[168:171], a[192:195], a[88:91], v[168:171]
    v_mfma_f32_16x16x32_bf16 v[176:179], a[192:195], a[92:95], v[176:179]
    s_waitcnt lgkmcnt(4)
    buffer_load_dwordx4 v10, s[24:27], s57 offen offset:2048 lds
    v_mfma_f32_16x16x32_bf16 v[164:167], a[196:199], a[84:87], v[164:167]
    s_add_u32 s57, s45, 4055040
    ds_read_b64_tr_b16 a[192:193], v21 offset:40960
    ds_read_b64_tr_b16 a[194:195], v21 offset:43008
    v_mfma_f32_16x16x32_bf16 v[172:175], a[196:199], a[88:91], v[172:175]
    s_add_u32 m0, s51, 110592
    s_add_u32 s45, s44, 1024
    v_mfma_f32_16x16x32_bf16 v[180:183], a[196:199], a[92:95], v[180:183]
    ds_read_b64_tr_b16 a[196:197], v22 offset:40960
    ds_read_b64_tr_b16 a[198:199], v22 offset:43008
    v_mfma_f32_16x16x32_bf16 v[160:163], a[200:203], a[96:99], v[160:163]
    v_mfma_f32_16x16x32_bf16 v[168:171], a[200:203], a[100:103], v[168:171]
    buffer_load_dwordx4 v8, s[24:27], s57 offen lds
    v_mfma_f32_16x16x32_bf16 v[176:179], a[200:203], a[104:107], v[176:179]
    ds_read_b64_tr_b16 a[200:201], v21 offset:45056
    ds_read_b64_tr_b16 a[202:203], v21 offset:47104
    v_mfma_f32_16x16x32_bf16 v[164:167], a[204:207], a[96:99], v[164:167]
    v_mfma_f32_16x16x32_bf16 v[172:175], a[204:207], a[100:103], v[172:175]
    v_mfma_f32_16x16x32_bf16 v[180:183], a[204:207], a[104:107], v[180:183]
    s_waitcnt lgkmcnt(4)
    ds_read_b64_tr_b16 a[204:205], v22 offset:45056
    ds_read_b64_tr_b16 a[206:207], v22 offset:47104
    v_mfma_f32_16x16x32_bf16 v[160:163], a[184:187], a[108:111], v[160:163]
    buffer_load_dwordx4 v9, s[24:27], s57 offen offset:1024 lds
    v_mfma_f32_16x16x32_bf16 v[168:171], a[184:187], a[112:115], v[168:171]
    v_mfma_f32_16x16x32_bf16 v[176:179], a[184:187], a[116:119], v[176:179]
    v_mfma_f32_16x16x32_bf16 v[164:167], a[188:191], a[108:111], v[164:167]
    v_mfma_f32_16x16x32_bf16 v[172:175], a[188:191], a[112:115], v[172:175]
    v_mfma_f32_16x16x32_bf16 v[180:183], a[188:191], a[116:119], v[180:183]
    buffer_load_dwordx4 v10, s[24:27], s57 offen offset:2048 lds
    v_mfma_f32_16x16x32_bf16 v[160:163], a[192:195], a[120:123], v[160:163]
    s_add_u32 m0, s51, 24576
    s_waitcnt vmcnt(30) lgkmcnt(0)
    s_barrier
    v_mfma_f32_16x16x32_bf16 v[168:171], a[192:195], a[124:127], v[168:171]
    ds_read_b64_tr_b16 a[184:185], v23 offset:24576
    ds_read_b64_tr_b16 a[186:187], v23 offset:26624
    v_mfma_f32_16x16x32_bf16 v[176:179], a[192:195], a[128:131], v[176:179]
    ds_read_b64_tr_b16 a[188:189], v24 offset:24576
    ds_read_b64_tr_b16 a[190:191], v24 offset:26624
    v_mfma_f32_16x16x32_bf16 v[164:167], a[196:199], a[120:123], v[164:167]
    ds_read_b64_tr_b16 a[192:193], v23 offset:28672
    ds_read_b64_tr_b16 a[194:195], v23 offset:30720
    v_mfma_f32_16x16x32_bf16 v[172:175], a[196:199], a[124:127], v[172:175]
    s_sub_u32 s57, s45, 1280
    s_cselect_b32 s45, s45, s57
    s_add_u32 s57, s45, 3932160
    v_mfma_f32_16x16x32_bf16 v[180:183], a[196:199], a[128:131], v[180:183]
    ds_read_b64_tr_b16 a[196:197], v24 offset:28672
    ds_read_b64_tr_b16 a[198:199], v24 offset:30720
    v_mfma_f32_16x16x32_bf16 v[160:163], a[200:203], a[132:135], v[160:163]
    buffer_load_dwordx4 v8, s[24:27], s57 offen lds
    v_mfma_f32_16x16x32_bf16 v[168:171], a[200:203], a[136:139], v[168:171]
    v_mfma_f32_16x16x32_bf16 v[176:179], a[200:203], a[140:143], v[176:179]
    ds_read_b64_tr_b16 a[200:201], v23 offset:32768
    ds_read_b64_tr_b16 a[202:203], v23 offset:34816
    v_mfma_f32_16x16x32_bf16 v[164:167], a[204:207], a[132:135], v[164:167]
    s_nop 1
    v_cvt_pk_bf16_f32 v160, v160, v161
    v_cvt_pk_bf16_f32 v161, v162, v163
    v_mfma_f32_16x16x32_bf16 v[172:175], a[204:207], a[136:139], v[172:175]
    v_cndmask_b32 v12, v12, v160, s[6:7]
    v_cndmask_b32 v13, v13, v161, s[6:7]
    v_mfma_f32_16x16x32_bf16 v[180:183], a[204:207], a[140:143], v[180:183]
    s_waitcnt lgkmcnt(4)
    ds_read_b64_tr_b16 a[204:205], v24 offset:32768
    ds_read_b64_tr_b16 a[206:207], v24 offset:34816
    v_mfma_f32_16x16x32_bf16 v[208:211], a[184:187], a[0:3], 0
    buffer_load_dwordx4 v9, s[24:27], s57 offen offset:1024 lds
    v_mfma_f32_16x16x32_bf16 v[216:219], a[184:187], a[4:7], 0
    v_cvt_pk_bf16_f32 v162, v164, v165
    v_cvt_pk_bf16_f32 v163, v166, v167
    v_mfma_f32_16x16x32_bf16 v[224:227], a[184:187], a[8:11], 0
    ds_read_b64_tr_b16 a[184:185], v23 offset:36864
    ds_read_b64_tr_b16 a[186:187], v23 offset:38912
    v_mfma_f32_16x16x32_bf16 v[212:215], a[188:191], a[0:3], 0
    v_cndmask_b32 v164, v5, v20, s[6:7]
    v_cndmask_b32 v14, v14, v162, s[6:7]
    v_mfma_f32_16x16x32_bf16 v[220:223], a[188:191], a[4:7], 0
    buffer_store_dwordx4 v[160:163], v164, s[32:35], s66 offen sc1
    v_mfma_f32_16x16x32_bf16 v[228:231], a[188:191], a[8:11], 0
    s_nop 0
    s_sub_u32 s66, s64, 10
    buffer_load_dwordx4 v10, s[24:27], s57 offen offset:2048 lds
    v_mfma_f32_16x16x32_bf16 v[208:211], a[192:195], a[12:15], v[208:211]
    s_add_u32 s57, s45, 4055040
    v_cndmask_b32 v15, v15, v163, s[6:7]
    v_cvt_pk_bf16_f32 v168, v168, v169
    v_mfma_f32_16x16x32_bf16 v[216:219], a[192:195], a[16:19], v[216:219]
    s_add_u32 m0, s51, 36864
    ds_read_b64_tr_b16 a[188:189], v24 offset:36864
    ds_read_b64_tr_b16 a[190:191], v24 offset:38912
    v_mfma_f32_16x16x32_bf16 v[224:227], a[192:195], a[20:23], v[224:227]
    s_add_u32 s45, s44, 1152
    s_and_b32 s66, s66, 15
    s_cselect_b64 s[6:7], 0, -1
    s_waitcnt lgkmcnt(2)
    v_mfma_f32_16x16x32_bf16 v[212:215], a[196:199], a[12:15], v[212:215]
    s_mul_i32 s66, s66, 122880
    v_cvt_pk_bf16_f32 v169, v170, v171
    v_cvt_pk_bf16_f32 v170, v172, v173
    v_mfma_f32_16x16x32_bf16 v[220:223], a[196:199], a[16:19], v[220:223]
    s_add_u32 s66, s66, 37888
    buffer_load_dwordx4 v8, s[24:27], s57 offen lds
    v_mfma_f32_16x16x32_bf16 v[228:231], a[196:199], a[20:23], v[228:231]
    v_cvt_pk_bf16_f32 v171, v174, v175
    v_cndmask_b32 v172, v5, v20, s[6:7]
    v_mfma_f32_16x16x32_bf16 v[208:211], a[200:203], a[24:27], v[208:211]
    buffer_store_dwordx4 v[168:171], v172, s[32:35], s66 offen sc1
    v_mfma_f32_16x16x32_bf16 v[216:219], a[200:203], a[28:31], v[216:219]
    s_nop 0
    s_sub_u32 s66, s64, 11
    v_cndmask_b32 v12, v12, v168, s[6:7]
    v_cndmask_b32 v13, v13, v169, s[6:7]
    v_mfma_f32_16x16x32_bf16 v[224:227], a[200:203], a[32:35], v[224:227]
    v_cndmask_b32 v14, v14, v170, s[6:7]
    v_cndmask_b32 v15, v15, v171, s[6:7]
    v_mfma_f32_16x16x32_bf16 v[212:215], a[204:207], a[24:27], v[212:215]
    buffer_load_dwordx4 v9, s[24:27], s57 offen offset:1024 lds
    v_mfma_f32_16x16x32_bf16 v[220:223], a[204:207], a[28:31], v[220:223]
    v_cvt_pk_bf16_f32 v176, v176, v177
    v_cvt_pk_bf16_f32 v177, v178, v179
    v_mfma_f32_16x16x32_bf16 v[228:231], a[204:207], a[32:35], v[228:231]
    s_and_b32 s66, s66, 15
    s_cselect_b64 s[6:7], 0, -1
    v_cvt_pk_bf16_f32 v178, v180, v181
    v_mfma_f32_16x16x32_bf16 v[208:211], a[184:187], a[36:39], v[208:211]
    s_mul_i32 s66, s66, 122880
    ds_read_b64_tr_b16 a[192:193], v23 offset:40960
    ds_read_b64_tr_b16 a[194:195], v23 offset:43008
    v_mfma_f32_16x16x32_bf16 v[216:219], a[184:187], a[40:43], v[216:219]
    s_add_u32 s66, s66, 38912
    v_cvt_pk_bf16_f32 v179, v182, v183
    v_cndmask_b32 v180, v5, v20, s[6:7]
    v_mfma_f32_16x16x32_bf16 v[224:227], a[184:187], a[44:47], v[224:227]
    s_waitcnt lgkmcnt(2)
    buffer_store_dwordx4 v[176:179], v180, s[32:35], s66 offen sc1
    v_mfma_f32_16x16x32_bf16 v[212:215], a[188:191], a[36:39], v[212:215]
    s_nop 0
    s_sub_u32 s66, s64, 12
    buffer_load_dwordx4 v10, s[24:27], s57 offen offset:2048 lds
    v_mfma_f32_16x16x32_bf16 v[220:223], a[188:191], a[40:43], v[220:223]
    s_add_u32 m0, s51, 73728
    v_cndmask_b32 v12, v12, v176, s[6:7]
    v_cndmask_b32 v13, v13, v177, s[6:7]
    v_mfma_f32_16x16x32_bf16 v[228:231], a[188:191], a[44:47], v[228:231]
    s_waitcnt lgkmcnt(1)
    v_cndmask_b32 v14, v14, v178, s[6:7]
    v_cndmask_b32 v15, v15, v179, s[6:7]
    s_sub_u32 s57, s45, 1280
    s_cselect_b32 s45, s45, s57
    s_waitcnt lgkmcnt(0)
    v_mfma_f32_16x16x32_bf16 v[208:211], a[192:195], a[48:51], v[208:211]
    s_add_u32 s57, s45, 3932160
    ds_read_b64_tr_b16 a[196:197], v24 offset:40960
    ds_read_b64_tr_b16 a[198:199], v24 offset:43008
    v_mfma_f32_16x16x32_bf16 v[216:219], a[192:195], a[52:55], v[216:219]
    ds_read_b64_tr_b16 a[200:201], v23 offset:45056
    ds_read_b64_tr_b16 a[202:203], v23 offset:47104
    v_mfma_f32_16x16x32_bf16 v[224:227], a[192:195], a[56:59], v[224:227]
    ds_read_b64_tr_b16 a[204:205], v24 offset:45056
    ds_read_b64_tr_b16 a[206:207], v24 offset:47104
    s_and_b32 s66, s66, 15
    s_cselect_b64 s[6:7], 0, -1
    s_mul_i32 s66, s66, 122880
    s_add_u32 s66, s66, 49152
    s_waitcnt lgkmcnt(4)
    v_mfma_f32_16x16x32_bf16 v[212:215], a[196:199], a[48:51], v[212:215]
    v_mfma_f32_16x16x32_bf16 v[220:223], a[196:199], a[52:55], v[220:223]
    v_mfma_f32_16x16x32_bf16 v[228:231], a[196:199], a[56:59], v[228:231]
    s_waitcnt vmcnt(30) lgkmcnt(0)
    s_barrier
    ds_read_b64_tr_b16 a[184:185], v23 offset:0
    v_mfma_f32_16x16x32_bf16 v[208:211], a[200:203], a[60:63], v[208:211]
    ds_read_b64_tr_b16 a[186:187], v23 offset:2048
    ds_read_b64_tr_b16 a[188:189], v24 offset:0
    v_mfma_f32_16x16x32_bf16 v[216:219], a[200:203], a[64:67], v[216:219]
    ds_read_b64_tr_b16 a[190:191], v24 offset:2048
    ds_read_b64_tr_b16 a[192:193], v23 offset:4096
    v_mfma_f32_16x16x32_bf16 v[224:227], a[200:203], a[68:71], v[224:227]
    ds_read_b64_tr_b16 a[194:195], v23 offset:6144
    ds_read_b64_tr_b16 a[196:197], v24 offset:4096
    v_mfma_f32_16x16x32_bf16 v[212:215], a[204:207], a[60:63], v[212:215]
    ds_read_b64_tr_b16 a[198:199], v24 offset:6144
    ds_read_b64_tr_b16 a[200:201], v23 offset:8192
    v_mfma_f32_16x16x32_bf16 v[220:223], a[204:207], a[64:67], v[220:223]
    ds_read_b64_tr_b16 a[202:203], v23 offset:10240
    buffer_load_dwordx4 v8, s[24:27], s57 offen lds
    v_mfma_f32_16x16x32_bf16 v[228:231], a[204:207], a[68:71], v[228:231]
    s_waitcnt lgkmcnt(8)
    ds_read_b64_tr_b16 a[204:205], v24 offset:8192
    ds_read_b64_tr_b16 a[206:207], v24 offset:10240
    v_mfma_f32_16x16x32_bf16 v[184:187], a[184:187], a[72:75], v[184:187]
    v_mfma_f32_16x16x32_bf16 v[192:195], a[184:187], a[76:79], v[192:195]
    v_mfma_f32_16x16x32_bf16 v[200:203], a[184:187], a[80:83], v[200:203]
    s_waitcnt lgkmcnt(6)
    ds_read_b64_tr_b16 a[184:185], v23 offset:12288
    ds_read_b64_tr_b16 a[186:187], v23 offset:14336
    v_mfma_f32_16x16x32_bf16 v[188:191], a[188:191], a[72:75], v[188:191]
    buffer_load_dwordx4 v9, s[24:27], s57 offen offset:1024 lds
    v_mfma_f32_16x16x32_bf16 v[196:199], a[188:191], a[76:79], v[196:199]
    v_mfma_f32_16x16x32_bf16 v[204:207], a[188:191], a[80:83], v[204:207]
    ds_read_b64_tr_b16 a[188:189], v24 offset:12288
    ds_read_b64_tr_b16 a[190:191], v24 offset:14336
    v_mfma_f32_16x16x32_bf16 v[184:187], a[192:195], a[84:87], v[184:187]
    v_mfma_f32_16x16x32_bf16 v[192:195], a[192:195], a[88:91], v[192:195]
    v_mfma_f32_16x16x32_bf16 v[200:203], a[192:195], a[92:95], v[200:203]
    s_waitcnt lgkmcnt(4)
    buffer_load_dwordx4 v10, s[24:27], s57 offen offset:2048 lds
    v_mfma_f32_16x16x32_bf16 v[188:191], a[196:199], a[84:87], v[188:191]
    s_add_u32 s57, s45, 4055040
    ds_read_b64_tr_b16 a[192:193], v23 offset:16384
    ds_read_b64_tr_b16 a[194:195], v23 offset:18432
    v_mfma_f32_16x16x32_bf16 v[196:199], a[196:199], a[88:91], v[196:199]
    s_add_u32 m0, s51, 86016
    v_mfma_f32_16x16x32_bf16 v[204:207], a[196:199], a[92:95], v[204:207]
    ds_read_b64_tr_b16 a[196:197], v24 offset:16384
    ds_read_b64_tr_b16 a[198:199], v24 offset:18432
    v_mfma_f32_16x16x32_bf16 v[184:187], a[200:203], a[96:99], v[184:187]
    v_mfma_f32_16x16x32_bf16 v[192:195], a[200:203], a[100:103], v[192:195]
    buffer_load_dwordx4 v8, s[24:27], s57 offen lds
    v_mfma_f32_16x16x32_bf16 v[200:203], a[200:203], a[104:107], v[200:203]
    ds_read_b64_tr_b16 a[200:201], v23 offset:20480
    ds_read_b64_tr_b16 a[202:203], v23 offset:22528
    v_mfma_f32_16x16x32_bf16 v[188:191], a[204:207], a[96:99], v[188:191]
    v_mfma_f32_16x16x32_bf16 v[196:199], a[204:207], a[100:103], v[196:199]
    v_mfma_f32_16x16x32_bf16 v[204:207], a[204:207], a[104:107], v[204:207]
    s_waitcnt lgkmcnt(4)
    ds_read_b64_tr_b16 a[204:205], v24 offset:20480
    ds_read_b64_tr_b16 a[206:207], v24 offset:22528
    v_mfma_f32_16x16x32_bf16 v[184:187], a[184:187], a[108:111], v[184:187]
    buffer_load_dwordx4 v9, s[24:27], s57 offen offset:1024 lds
    v_mfma_f32_16x16x32_bf16 v[192:195], a[184:187], a[112:115], v[192:195]
    v_mfma_f32_16x16x32_bf16 v[200:203], a[184:187], a[116:119], v[200:203]
    v_mfma_f32_16x16x32_bf16 v[188:191], a[188:191], a[108:111], v[188:191]
    v_mfma_f32_16x16x32_bf16 v[196:199], a[188:191], a[112:115], v[196:199]
    v_mfma_f32_16x16x32_bf16 v[204:207], a[188:191], a[116:119], v[204:207]
    buffer_load_dwordx4 v10, s[24:27], s57 offen offset:2048 lds
    v_mfma_f32_16x16x32_bf16 v[184:187], a[192:195], a[120:123], v[184:187]
    s_waitcnt vmcnt(30) lgkmcnt(0)
    s_barrier
    ds_read_b64_tr_b16 a[184:185], v25 offset:36864
    v_mfma_f32_16x16x32_bf16 v[192:195], a[192:195], a[124:127], v[192:195]
    ds_read_b64_tr_b16 a[186:187], v25 offset:38912
    ds_read_b64_tr_b16 a[188:189], v26 offset:36864
    v_mfma_f32_16x16x32_bf16 v[200:203], a[192:195], a[128:131], v[200:203]
    ds_read_b64_tr_b16 a[190:191], v26 offset:38912
    ds_read_b64_tr_b16 a[192:193], v25 offset:40960
    v_mfma_f32_16x16x32_bf16 v[188:191], a[196:199], a[120:123], v[188:191]
    ds_read_b64_tr_b16 a[194:195], v25 offset:43008
    v_mfma_f32_16x16x32_bf16 v[196:199], a[196:199], a[124:127], v[196:199]
    v_mfma_f32_16x16x32_bf16 v[204:207], a[196:199], a[128:131], v[204:207]
    ds_read_b64_tr_b16 a[196:197], v26 offset:40960
    ds_read_b64_tr_b16 a[198:199], v26 offset:43008
    v_mfma_f32_16x16x32_bf16 v[184:187], a[200:203], a[132:135], v[184:187]
    v_mfma_f32_16x16x32_bf16 v[192:195], a[200:203], a[136:139], v[192:195]
    v_mfma_f32_16x16x32_bf16 v[200:203], a[200:203], a[140:143], v[200:203]
    ds_read_b64_tr_b16 a[200:201], v25 offset:45056
    ds_read_b64_tr_b16 a[202:203], v25 offset:47104
    v_mfma_f32_16x16x32_bf16 v[188:191], a[204:207], a[132:135], v[188:191]
    s_nop 2
    v_cvt_pk_bf16_f32 v184, v184, v185
    v_cvt_pk_bf16_f32 v185, v186, v187
    v_mfma_f32_16x16x32_bf16 v[196:199], a[204:207], a[136:139], v[196:199]
    v_cndmask_b32 v12, v12, v184, s[6:7]
    v_cndmask_b32 v13, v13, v185, s[6:7]
    v_mfma_f32_16x16x32_bf16 v[204:207], a[204:207], a[140:143], v[204:207]
    s_waitcnt lgkmcnt(4)
    ds_read_b64_tr_b16 a[204:205], v26 offset:45056
    ds_read_b64_tr_b16 a[206:207], v26 offset:47104
    v_mfma_f32_16x16x32_bf16 a[232:235], a[184:187], a[72:75], a[232:235]
    v_cvt_pk_bf16_f32 v186, v188, v189
    v_cvt_pk_bf16_f32 v187, v190, v191
    v_mfma_f32_16x16x32_bf16 a[240:243], a[184:187], a[76:79], a[240:243]
    v_cndmask_b32 v188, v5, v20, s[6:7]
    v_cndmask_b32 v14, v14, v186, s[6:7]
    v_mfma_f32_16x16x32_bf16 a[248:251], a[184:187], a[80:83], a[248:251]
    buffer_store_dwordx4 v[184:187], v188, s[32:35], s66 offen sc1
    v_mfma_f32_16x16x32_bf16 a[236:239], a[188:191], a[72:75], a[236:239]
    s_nop 0
    s_sub_u32 s66, s64, 13
    ds_read_b64_tr_b16 a[184:185], v25 offset:49152
    ds_read_b64_tr_b16 a[186:187], v25 offset:51200
    v_mfma_f32_16x16x32_bf16 a[244:247], a[188:191], a[76:79], a[244:247]
    v_cndmask_b32 v15, v15, v187, s[6:7]
    v_cvt_pk_bf16_f32 v192, v192, v193
    v_mfma_f32_16x16x32_bf16 a[252:255], a[188:191], a[80:83], a[252:255]
    ds_read_b64_tr_b16 a[188:189], v26 offset:49152
    ds_read_b64_tr_b16 a[190:191], v26 offset:51200
    v_mfma_f32_16x16x32_bf16 a[232:235], a[192:195], a[84:87], a[232:235]
    s_and_b32 s66, s66, 15
    s_cselect_b64 s[6:7], 0, -1
    v_cvt_pk_bf16_f32 v193, v194, v195
    v_mfma_f32_16x16x32_bf16 a[240:243], a[192:195], a[88:91], a[240:243]
    s_mul_i32 s66, s66, 122880
    v_cvt_pk_bf16_f32 v194, v196, v197
    v_cvt_pk_bf16_f32 v195, v198, v199
    v_mfma_f32_16x16x32_bf16 a[248:251], a[192:195], a[92:95], a[248:251]
    s_add_u32 s66, s66, 50176
    v_cndmask_b32 v196, v5, v20, s[6:7]
    v_cndmask_b32 v12, v12, v192, s[6:7]
    s_waitcnt lgkmcnt(4)
    v_mfma_f32_16x16x32_bf16 a[236:239], a[196:199], a[84:87], a[236:239]
    buffer_store_dwordx4 v[192:195], v196, s[32:35], s66 offen sc1
    v_mfma_f32_16x16x32_bf16 a[244:247], a[196:199], a[88:91], a[244:247]
    s_nop 0
    s_sub_u32 s66, s64, 14
    v_cndmask_b32 v13, v13, v193, s[6:7]
    v_cndmask_b32 v14, v14, v194, s[6:7]
    v_mfma_f32_16x16x32_bf16 a[252:255], a[196:199], a[92:95], a[252:255]
    v_cndmask_b32 v15, v15, v195, s[6:7]
    v_cvt_pk_bf16_f32 v200, v200, v201
    v_mfma_f32_16x16x32_bf16 a[232:235], a[200:203], a[96:99], a[232:235]
    s_and_b32 s66, s66, 15
    s_cselect_b64 s[6:7], 0, -1
    v_cvt_pk_bf16_f32 v201, v202, v203
    v_mfma_f32_16x16x32_bf16 a[240:243], a[200:203], a[100:103], a[240:243]
    s_mul_i32 s66, s66, 122880
    v_cvt_pk_bf16_f32 v202, v204, v205
    v_cvt_pk_bf16_f32 v203, v206, v207
    v_mfma_f32_16x16x32_bf16 a[248:251], a[200:203], a[104:107], a[248:251]
    s_add_u32 s66, s66, 51200
    ds_read_b64_tr_b16 a[192:193], v25 offset:53248
    ds_read_b64_tr_b16 a[194:195], v25 offset:55296
    v_mfma_f32_16x16x32_bf16 a[236:239], a[204:207], a[96:99], a[236:239]
    v_cndmask_b32 v204, v5, v20, s[6:7]
    v_cndmask_b32 v12, v12, v200, s[6:7]
    v_mfma_f32_16x16x32_bf16 a[244:247], a[204:207], a[100:103], a[244:247]
    buffer_store_dwordx4 v[200:203], v204, s[32:35], s66 offen sc1
    v_mfma_f32_16x16x32_bf16 a[252:255], a[204:207], a[104:107], a[252:255]
    s_nop 0
    s_sub_u32 s66, s64, 15
    v_cndmask_b32 v13, v13, v201, s[6:7]
    v_cndmask_b32 v14, v14, v202, s[6:7]
    s_waitcnt lgkmcnt(2)
    v_mfma_f32_16x16x32_bf16 a[232:235], a[184:187], a[108:111], a[232:235]
    v_cndmask_b32 v15, v15, v203, s[6:7]
    s_and_b32 s66, s66, 15
    s_cselect_b64 s[6:7], 0, -1
    v_mfma_f32_16x16x32_bf16 a[240:243], a[184:187], a[112:115], a[240:243]
    s_mul_i32 s66, s66, 122880
    ds_read_b64_tr_b16 a[196:197], v26 offset:53248
    ds_read_b64_tr_b16 a[198:199], v26 offset:55296
    v_mfma_f32_16x16x32_bf16 a[248:251], a[184:187], a[116:119], a[248:251]
    s_add_u32 s66, s66, 61440
    ds_read_b64_tr_b16 a[200:201], v25 offset:57344
    ds_read_b64_tr_b16 a[202:203], v25 offset:59392
    v_mfma_f32_16x16x32_bf16 a[236:239], a[188:191], a[108:111], a[236:239]
    ds_read_b64_tr_b16 a[204:205], v26 offset:57344
    ds_read_b64_tr_b16 a[206:207], v26 offset:59392
    v_mfma_f32_16x16x32_bf16 a[244:247], a[188:191], a[112:115], a[244:247]
    v_mfma_f32_16x16x32_bf16 a[252:255], a[188:191], a[116:119], a[252:255]
    s_waitcnt lgkmcnt(6)
    v_mfma_f32_16x16x32_bf16 a[232:235], a[192:195], a[120:123], a[232:235]
    v_mfma_f32_16x16x32_bf16 a[240:243], a[192:195], a[124:127], a[240:243]
    v_mfma_f32_16x16x32_bf16 a[248:251], a[192:195], a[128:131], a[248:251]
    s_waitcnt lgkmcnt(4)
    v_mfma_f32_16x16x32_bf16 a[236:239], a[196:199], a[120:123], a[236:239]
    s_waitcnt vmcnt(24) lgkmcnt(0)
    s_barrier
    v_mfma_f32_16x16x32_bf16 a[244:247], a[196:199], a[124:127], a[244:247]
    ds_read_b64_tr_b16 a[184:185], v21 offset:0
    ds_read_b64_tr_b16 a[186:187], v21 offset:2048
    v_mfma_f32_16x16x32_bf16 a[252:255], a[196:199], a[128:131], a[252:255]
    ds_read_b64_tr_b16 a[188:189], v22 offset:0
    ds_read_b64_tr_b16 a[190:191], v22 offset:2048
    v_mfma_f32_16x16x32_bf16 a[232:235], a[200:203], a[132:135], a[232:235]
    ds_read_b64_tr_b16 a[192:193], v21 offset:4096
    ds_read_b64_tr_b16 a[194:195], v21 offset:6144
    v_mfma_f32_16x16x32_bf16 a[240:243], a[200:203], a[136:139], a[240:243]
    ds_read_b64_tr_b16 a[196:197], v22 offset:4096
    ds_read_b64_tr_b16 a[198:199], v22 offset:6144
    v_mfma_f32_16x16x32_bf16 a[248:251], a[200:203], a[140:143], a[248:251]
    ds_read_b64_tr_b16 a[200:201], v21 offset:8192
    ds_read_b64_tr_b16 a[202:203], v21 offset:10240
    v_mfma_f32_16x16x32_bf16 a[236:239], a[204:207], a[132:135], a[236:239]
    v_accvgpr_read_b32 v232, a232
    v_accvgpr_read_b32 v233, a233
    v_mfma_f32_16x16x32_bf16 a[244:247], a[204:207], a[136:139], a[244:247]
    v_accvgpr_read_b32 v234, a234
    v_accvgpr_read_b32 v235, a235
    v_mfma_f32_16x16x32_bf16 a[252:255], a[204:207], a[140:143], a[252:255]
    s_waitcnt lgkmcnt(8)
    ds_read_b64_tr_b16 a[204:205], v22 offset:8192
    ds_read_b64_tr_b16 a[206:207], v22 offset:10240
    v_mfma_f32_16x16x32_bf16 v[208:211], a[184:187], a[72:75], v[208:211]
    v_cvt_pk_bf16_f32 v232, v232, v233
    v_accvgpr_read_b32 v236, a236
    v_mfma_f32_16x16x32_bf16 v[216:219], a[184:187], a[76:79], v[216:219]
    v_accvgpr_read_b32 v237, a237
    v_cvt_pk_bf16_f32 v233, v234, v235
    v_mfma_f32_16x16x32_bf16 v[224:227], a[184:187], a[80:83], v[224:227]
    s_waitcnt lgkmcnt(4)
    ds_read_b64_tr_b16 a[184:185], v21 offset:12288
    ds_read_b64_tr_b16 a[186:187], v21 offset:14336
    v_mfma_f32_16x16x32_bf16 v[212:215], a[188:191], a[72:75], v[212:215]
    v_accvgpr_read_b32 v238, a238
    v_accvgpr_read_b32 v239, a239
    v_mfma_f32_16x16x32_bf16 v[220:223], a[188:191], a[76:79], v[220:223]
    v_cvt_pk_bf16_f32 v234, v236, v237
    v_cvt_pk_bf16_f32 v235, v238, v239
    v_mfma_f32_16x16x32_bf16 v[228:231], a[188:191], a[80:83], v[228:231]
    v_cndmask_b32 v236, v5, v20, s[6:7]
    v_cndmask_b32 v12, v12, v232, s[6:7]
    v_mfma_f32_16x16x32_bf16 v[208:211], a[192:195], a[84:87], v[208:211]
    buffer_store_dwordx4 v[232:235], v236, s[32:35], s66 offen sc1
    v_mfma_f32_16x16x32_bf16 v[216:219], a[192:195], a[88:91], v[216:219]
    s_nop 0
    s_sub_u32 s66, s64, 0
    v_cndmask_b32 v13, v13, v233, s[6:7]
    v_cndmask_b32 v14, v14, v234, s[6:7]
    v_mfma_f32_16x16x32_bf16 v[224:227], a[192:195], a[92:95], v[224:227]
    v_cndmask_b32 v15, v15, v235, s[6:7]
    v_accvgpr_read_b32 v240, a240
    v_mfma_f32_16x16x32_bf16 v[212:215], a[196:199], a[84:87], v[212:215]
    v_accvgpr_read_b32 v241, a241
    v_accvgpr_read_b32 v242, a242
    v_mfma_f32_16x16x32_bf16 v[220:223], a[196:199], a[88:91], v[220:223]
    ds_read_b64_tr_b16 a[188:189], v22 offset:12288
    ds_read_b64_tr_b16 a[190:191], v22 offset:14336
    v_mfma_f32_16x16x32_bf16 v[228:231], a[196:199], a[92:95], v[228:231]
    s_waitcnt lgkmcnt(2)
    v_accvgpr_read_b32 v243, a243
    v_cvt_pk_bf16_f32 v240, v240, v241
    v_mfma_f32_16x16x32_bf16 v[208:211], a[200:203], a[96:99], v[208:211]
    s_and_b32 s66, s66, 15
    s_cselect_b64 s[6:7], 0, -1
    v_accvgpr_read_b32 v244, a244
    v_mfma_f32_16x16x32_bf16 v[216:219], a[200:203], a[100:103], v[216:219]
    s_mul_i32 s66, s66, 122880
    v_accvgpr_read_b32 v245, a245
    v_cvt_pk_bf16_f32 v241, v242, v243
    v_mfma_f32_16x16x32_bf16 v[224:227], a[200:203], a[104:107], v[224:227]
    s_add_u32 s66, s66, 62464
    v_accvgpr_read_b32 v246, a246
    v_accvgpr_read_b32 v247, a247
    v_mfma_f32_16x16x32_bf16 v[212:215], a[204:207], a[96:99], v[212:215]
    v_cvt_pk_bf16_f32 v242, v244, v245
    v_cvt_pk_bf16_f32 v243, v246, v247
    v_mfma_f32_16x16x32_bf16 v[220:223], a[204:207], a[100:103], v[220:223]
    v_cndmask_b32 v244, v5, v20, s[6:7]
    v_cndmask_b32 v16, v16, v240, s[6:7]
    v_mfma_f32_16x16x32_bf16 v[228:231], a[204:207], a[104:107], v[228:231]
    buffer_store_dwordx4 v[240:243], v244, s[32:35], s66 offen sc1
    v_mfma_f32_16x16x32_bf16 v[208:211], a[184:187], a[108:111], v[208:211]
    s_nop 0
    s_sub_u32 s66, s64, 1
    v_cndmask_b32 v17, v17, v241, s[6:7]
    v_cndmask_b32 v18, v18, v242, s[6:7]
    v_mfma_f32_16x16x32_bf16 v[216:219], a[184:187], a[112:115], v[216:219]
    v_cndmask_b32 v19, v19, v243, s[6:7]
    v_accvgpr_read_b32 v248, a248
    v_mfma_f32_16x16x32_bf16 v[224:227], a[184:187], a[116:119], v[224:227]
    s_waitcnt lgkmcnt(0)
    v_accvgpr_read_b32 v249, a249
    v_accvgpr_read_b32 v250, a250
    v_mfma_f32_16x16x32_bf16 v[212:215], a[188:191], a[108:111], v[212:215]
    v_accvgpr_read_b32 v251, a251
    v_cvt_pk_bf16_f32 v248, v248, v249
    v_mfma_f32_16x16x32_bf16 v[220:223], a[188:191], a[112:115], v[220:223]
    s_and_b32 s66, s66, 15
    s_cselect_b64 s[6:7], 0, -1
    v_accvgpr_read_b32 v252, a252
    v_mfma_f32_16x16x32_bf16 v[228:231], a[188:191], a[116:119], v[228:231]
    s_mul_i32 s66, s66, 122880
    v_accvgpr_read_b32 v253, a253
    v_cvt_pk_bf16_f32 v249, v250, v251
    v_accvgpr_read_b32 v254, a254
    v_accvgpr_read_b32 v255, a255
    v_cvt_pk_bf16_f32 v250, v252, v253
    v_cvt_pk_bf16_f32 v251, v254, v255
    s_add_u32 s66, s66, 63488
    v_cndmask_b32 v252, v5, v20, s[6:7]
    v_cndmask_b32 v16, v16, v248, s[6:7]
    v_cndmask_b32 v17, v17, v249, s[6:7]
    v_cndmask_b32 v18, v18, v250, s[6:7]
    v_cndmask_b32 v19, v19, v251, s[6:7]
    buffer_store_dwordx4 v[248:251], v252, s[32:35], s66 offen sc1
    ds_read_b64_tr_b16 a[192:193], v21 offset:16384
    ds_read_b64_tr_b16 a[194:195], v21 offset:18432
    ds_read_b64_tr_b16 a[196:197], v22 offset:16384
    s_sub_u32 s66, s64, 2
    ds_read_b64_tr_b16 a[198:199], v22 offset:18432
    s_and_b32 s66, s66, 15
    s_cselect_b64 s[6:7], 0, -1
    ds_read_b64_tr_b16 a[200:201], v21 offset:20480
    ds_read_b64_tr_b16 a[202:203], v21 offset:22528
    s_mul_i32 s66, s66, 122880
    ds_read_b64_tr_b16 a[204:205], v22 offset:20480
    s_add_u32 s66, s66, 73728
    ds_read_b64_tr_b16 a[206:207], v22 offset:22528
    s_waitcnt lgkmcnt(6)
    v_mfma_f32_16x16x32_bf16 v[208:211], a[192:195], a[120:123], v[208:211]
    v_mfma_f32_16x16x32_bf16 v[216:219], a[192:195], a[124:127], v[216:219]
    v_mfma_f32_16x16x32_bf16 v[224:227], a[192:195], a[128:131], v[224:227]
    s_waitcnt lgkmcnt(2)
    v_mfma_f32_16x16x32_bf16 v[212:215], a[196:199], a[120:123], v[212:215]
    s_waitcnt vmcnt(21) lgkmcnt(0)
    s_barrier
    ds_read_b64_tr_b16 a[184:185], v25 offset:0
    v_mfma_f32_16x16x32_bf16 v[220:223], a[196:199], a[124:127], v[220:223]
    ds_read_b64_tr_b16 a[186:187], v25 offset:2048
    ds_read_b64_tr_b16 a[188:189], v26 offset:0
    v_mfma_f32_16x16x32_bf16 v[228:231], a[196:199], a[128:131], v[228:231]
    ds_read_b64_tr_b16 a[190:191], v26 offset:2048
    ds_read_b64_tr_b16 a[192:193], v25 offset:4096
    v_mfma_f32_16x16x32_bf16 v[208:211], a[200:203], a[132:135], v[208:211]
    ds_read_b64_tr_b16 a[194:195], v25 offset:6144
    ds_read_b64_tr_b16 a[196:197], v26 offset:4096
    v_mfma_f32_16x16x32_bf16 v[216:219], a[200:203], a[136:139], v[216:219]
    ds_read_b64_tr_b16 a[198:199], v26 offset:6144
    v_mfma_f32_16x16x32_bf16 v[224:227], a[200:203], a[140:143], v[224:227]
    ds_read_b64_tr_b16 a[200:201], v25 offset:8192
    ds_read_b64_tr_b16 a[202:203], v25 offset:10240
    v_mfma_f32_16x16x32_bf16 v[212:215], a[204:207], a[132:135], v[212:215]
    v_cvt_pk_bf16_f32 v208, v208, v209
    v_cvt_pk_bf16_f32 v209, v210, v211
    v_mfma_f32_16x16x32_bf16 v[220:223], a[204:207], a[136:139], v[220:223]
    v_cndmask_b32 v16, v16, v208, s[6:7]
    v_cndmask_b32 v17, v17, v209, s[6:7]
    v_mfma_f32_16x16x32_bf16 v[228:231], a[204:207], a[140:143], v[228:231]
    ds_read_b64_tr_b16 a[204:205], v26 offset:8192
    ds_read_b64_tr_b16 a[206:207], v26 offset:10240
    v_mfma_f32_16x16x32_bf16 v[64:67], v[58:61], a[220:223], 0
    v_cvt_pk_bf16_f32 v210, v212, v213
    v_cvt_pk_bf16_f32 v211, v214, v215
    v_mfma_f32_16x16x32_bf16 v[72:75], v[58:61], a[224:227], 0
    v_cndmask_b32 v212, v5, v20, s[6:7]
    v_cndmask_b32 v18, v18, v210, s[6:7]
    v_mfma_f32_16x16x32_bf16 v[80:83], v[58:61], a[228:231], 0
    buffer_store_dwordx4 v[208:211], v212, s[32:35], s66 offen sc1
    v_mfma_f32_16x16x32_bf16 v[68:71], v[56:59], a[220:223], 0
    s_nop 0
    s_sub_u32 s66, s64, 3
    v_cndmask_b32 v19, v19, v211, s[6:7]
    v_cvt_pk_bf16_f32 v216, v216, v217
    v_mfma_f32_16x16x32_bf16 v[76:79], v[56:59], a[224:227], 0
    s_and_b32 s66, s66, 15
    s_cselect_b64 s[6:7], 0, -1
    v_cvt_pk_bf16_f32 v217, v218, v219
    v_mfma_f32_16x16x32_bf16 v[84:87], v[56:59], a[228:231], 0
    s_mul_i32 s66, s66, 122880
    v_cvt_pk_bf16_f32 v218, v220, v221
    v_cvt_pk_bf16_f32 v219, v222, v223
    s_waitcnt lgkmcnt(0)
    v_mfma_f32_16x16x32_bf16 v[64:67], a[184:187], a[72:75], v[64:67]
    s_add_u32 s66, s66, 74752
    v_cndmask_b32 v220, v5, v20, s[6:7]
    v_cndmask_b32 v16, v16, v216, s[6:7]
    v_mfma_f32_16x16x32_bf16 v[72:75], a[184:187], a[76:79], v[72:75]
    buffer_store_dwordx4 v[216:219], v220, s[32:35], s66 offen sc1
    v_mfma_f32_16x16x32_bf16 v[80:83], a[184:187], a[80:83], v[80:83]
    s_nop 0
    s_sub_u32 s66, s64, 4
    v_cndmask_b32 v17, v17, v217, s[6:7]
    v_cndmask_b32 v18, v18, v218, s[6:7]
    v_mfma_f32_16x16x32_bf16 v[68:71], a[188:191], a[72:75], v[68:71]
    v_cndmask_b32 v19, v19, v219, s[6:7]
    v_cvt_pk_bf16_f32 v224, v224, v225
    v_mfma_f32_16x16x32_bf16 v[76:79], a[188:191], a[76:79], v[76:79]
    s_and_b32 s66, s66, 15
    s_cselect_b64 s[6:7], 0, -1
    v_cvt_pk_bf16_f32 v225, v226, v227
    v_mfma_f32_16x16x32_bf16 v[84:87], a[188:191], a[80:83], v[84:87]
    s_mul_i32 s66, s66, 122880
    v_cvt_pk_bf16_f32 v226, v228, v229
    v_cvt_pk_bf16_f32 v227, v230, v231
    v_mfma_f32_16x16x32_bf16 v[64:67], a[192:195], a[84:87], v[64:67]
    s_add_u32 s66, s66, 75776
    ds_read_b64_tr_b16 a[184:185], v25 offset:12288
    ds_read_b64_tr_b16 a[186:187], v25 offset:14336
    v_mfma_f32_16x16x32_bf16 v[72:75], a[192:195], a[88:91], v[72:75]
    v_cndmask_b32 v228, v5, v20, s[6:7]
    v_cndmask_b32 v16, v16, v224, s[6:7]
    v_mfma_f32_16x16x32_bf16 v[80:83], a[192:195], a[92:95], v[80:83]
    buffer_store_dwordx4 v[224:227], v228, s[32:35], s66 offen sc1
    v_mfma_f32_16x16x32_bf16 v[68:71], a[196:199], a[84:87], v[68:71]
    s_nop 0
    s_sub_u32 s66, s64, 5
    v_cndmask_b32 v17, v17, v225, s[6:7]
    v_cndmask_b32 v18, v18, v226, s[6:7]
    v_mfma_f32_16x16x32_bf16 v[76:79], a[196:199], a[88:91], v[76:79]
    v_cndmask_b32 v19, v19, v227, s[6:7]
    s_and_b32 s66, s66, 15
    s_cselect_b64 s[6:7], 0, -1
    v_mfma_f32_16x16x32_bf16 v[84:87], a[196:199], a[92:95], v[84:87]
    s_mul_i32 s66, s66, 122880
    ds_read_b64_tr_b16 a[188:189], v26 offset:12288
    ds_read_b64_tr_b16 a[190:191], v26 offset:14336
    v_mfma_f32_16x16x32_bf16 v[64:67], a[200:203], a[96:99], v[64:67]
    s_add_u32 s66, s66, 86016
    ds_read_b64_tr_b16 a[192:193], v25 offset:16384
    ds_read_b64_tr_b16 a[194:195], v25 offset:18432
    v_mfma_f32_16x16x32_bf16 v[72:75], a[200:203], a[100:103], v[72:75]
    ds_read_b64_tr_b16 a[196:197], v26 offset:16384
    ds_read_b64_tr_b16 a[198:199], v26 offset:18432
    v_mfma_f32_16x16x32_bf16 v[80:83], a[200:203], a[104:107], v[80:83]
    ds_read_b64_tr_b16 a[200:201], v25 offset:20480
    ds_read_b64_tr_b16 a[202:203], v25 offset:22528
    v_mfma_f32_16x16x32_bf16 v[68:71], a[204:207], a[96:99], v[68:71]
    v_mfma_f32_16x16x32_bf16 v[76:79], a[204:207], a[100:103], v[76:79]
    v_mfma_f32_16x16x32_bf16 v[84:87], a[204:207], a[104:107], v[84:87]
    s_waitcnt lgkmcnt(8)
    ds_read_b64_tr_b16 a[204:205], v26 offset:20480
    ds_read_b64_tr_b16 a[206:207], v26 offset:22528
    v_mfma_f32_16x16x32_bf16 v[64:67], a[184:187], a[108:111], v[64:67]
    v_mfma_f32_16x16x32_bf16 v[72:75], a[184:187], a[112:115], v[72:75]
    v_mfma_f32_16x16x32_bf16 v[80:83], a[184:187], a[116:119], v[80:83]
    s_waitcnt lgkmcnt(4)
    v_mfma_f32_16x16x32_bf16 v[68:71], a[188:191], a[108:111], v[68:71]
    v_mfma_f32_16x16x32_bf16 v[76:79], a[188:191], a[112:115], v[76:79]
    v_mfma_f32_16x16x32_bf16 v[84:87], a[188:191], a[116:119], v[84:87]
    s_waitcnt vmcnt(3) lgkmcnt(0)
    s_barrier
    v_mfma_f32_16x16x32_bf16 v[64:67], a[192:195], a[120:123], v[64:67]
    ds_read_b64_tr_b16 a[184:185], v21 offset:24576
    ds_read_b64_tr_b16 a[186:187], v21 offset:26624
    v_mfma_f32_16x16x32_bf16 v[72:75], a[192:195], a[124:127], v[72:75]
    ds_read_b64_tr_b16 a[188:189], v22 offset:24576
    ds_read_b64_tr_b16 a[190:191], v22 offset:26624
    v_mfma_f32_16x16x32_bf16 v[80:83], a[192:195], a[128:131], v[80:83]
    ds_read_b64_tr_b16 a[192:193], v21 offset:28672
    ds_read_b64_tr_b16 a[194:195], v21 offset:30720
    v_mfma_f32_16x16x32_bf16 v[68:71], a[196:199], a[120:123], v[68:71]
    v_mfma_f32_16x16x32_bf16 v[76:79], a[196:199], a[124:127], v[76:79]
    v_mfma_f32_16x16x32_bf16 v[84:87], a[196:199], a[128:131], v[84:87]
    ds_read_b64_tr_b16 a[196:197], v22 offset:28672
    ds_read_b64_tr_b16 a[198:199], v22 offset:30720
    v_mfma_f32_16x16x32_bf16 v[64:67], a[200:203], a[132:135], v[64:67]
    v_mfma_f32_16x16x32_bf16 v[72:75], a[200:203], a[136:139], v[72:75]
    v_mfma_f32_16x16x32_bf16 v[80:83], a[200:203], a[140:143], v[80:83]
    ds_read_b64_tr_b16 a[200:201], v21 offset:32768
    ds_read_b64_tr_b16 a[202:203], v21 offset:34816
    v_mfma_f32_16x16x32_bf16 v[68:71], a[204:207], a[132:135], v[68:71]
    s_nop 2
    v_cvt_pk_bf16_f32 v64, v64, v65
    v_cvt_pk_bf16_f32 v65, v66, v67
    v_mfma_f32_16x16x32_bf16 v[76:79], a[204:207], a[136:139], v[76:79]
    v_cndmask_b32 v16, v16, v64, s[6:7]
    v_cndmask_b32 v17, v17, v65, s[6:7]
    v_mfma_f32_16x16x32_bf16 v[84:87], a[204:207], a[140:143], v[84:87]
    v_cvt_pk_bf16_f32 v72, v72, v73
    v_cvt_pk_bf16_f32 v73, v74, v75
    v_mfma_f32_16x16x32_bf16 v[112:115], v[58:61], a[208:211], 0
    v_cvt_pk_bf16_f32 v66, v68, v69
    v_cvt_pk_bf16_f32 v67, v70, v71
    v_mfma_f32_16x16x32_bf16 v[120:123], v[58:61], a[212:215], 0
    v_cndmask_b32 v68, v5, v20, s[6:7]
    v_cndmask_b32 v18, v18, v66, s[6:7]
    v_mfma_f32_16x16x32_bf16 v[128:131], v[58:61], a[216:219], 0
    buffer_store_dwordx4 v[64:67], v68, s[32:35], s66 offen sc1
    v_mfma_f32_16x16x32_bf16 v[116:119], v[56:59], a[208:211], 0
    s_nop 0
    s_sub_u32 s66, s64, 6
    v_cndmask_b32 v19, v19, v67, s[6:7]
    v_cvt_pk_bf16_f32 v74, v76, v77
    v_mfma_f32_16x16x32_bf16 v[124:127], v[56:59], a[212:215], 0
    s_and_b32 s66, s66, 15
    s_cselect_b64 s[6:7], 0, -1
    s_mul_i32 s66, s66, 122880
    v_mfma_f32_16x16x32_bf16 v[132:135], v[56:59], a[216:219], 0
    s_add_u32 s66, s66, 87040
    ds_read_b64_tr_b16 a[204:205], v22 offset:32768
    ds_read_b64_tr_b16 a[206:207], v22 offset:34816
    s_waitcnt lgkmcnt(2)
    v_mfma_f32_16x16x32_bf16 v[112:115], a[184:187], a[72:75], v[112:115]
    v_cvt_pk_bf16_f32 v75, v78, v79
    v_cndmask_b32 v76, v5, v20, s[6:7]
    v_mfma_f32_16x16x32_bf16 v[120:123], a[184:187], a[76:79], v[120:123]
    buffer_store_dwordx4 v[72:75], v76, s[32:35], s66 offen sc1
    v_mfma_f32_16x16x32_bf16 v[128:131], a[184:187], a[80:83], v[128:131]
    s_nop 0
    s_sub_u32 s66, s64, 7
    v_cndmask_b32 v16, v16, v72, s[6:7]
    v_cndmask_b32 v17, v17, v73, s[6:7]
    v_mfma_f32_16x16x32_bf16 v[116:119], a[188:191], a[72:75], v[116:119]
    v_cndmask_b32 v18, v18, v74, s[6:7]
    v_cndmask_b32 v19, v19, v75, s[6:7]
    v_mfma_f32_16x16x32_bf16 v[124:127], a[188:191], a[76:79], v[124:127]
    v_cvt_pk_bf16_f32 v80, v80, v81
    v_cvt_pk_bf16_f32 v81, v82, v83
    v_mfma_f32_16x16x32_bf16 v[132:135], a[188:191], a[80:83], v[132:135]
    s_and_b32 s66, s66, 15
    s_cselect_b64 s[6:7], 0, -1
    v_cvt_pk_bf16_f32 v82, v84, v85
    v_mfma_f32_16x16x32_bf16 v[112:115], a[192:195], a[84:87], v[112:115]
    s_mul_i32 s66, s66, 122880
    v_cvt_pk_bf16_f32 v83, v86, v87
    s_add_u32 s66, s66, 88064
    v_mfma_f32_16x16x32_bf16 v[120:123], a[192:195], a[88:91], v[120:123]
    v_cndmask_b32 v84, v5, v20, s[6:7]
    v_cndmask_b32 v16, v16, v80, s[6:7]
    v_mfma_f32_16x16x32_bf16 v[128:131], a[192:195], a[92:95], v[128:131]
    buffer_store_dwordx4 v[80:83], v84, s[32:35], s66 offen sc1
    v_mfma_f32_16x16x32_bf16 v[116:119], a[196:199], a[84:87], v[116:119]
    s_nop 0
    s_sub_u32 s66, s64, 8
    buffer_store_dword v63, v4, s[32:35], s65 offen sc1
    v_mfma_f32_16x16x32_bf16 v[124:127], a[196:199], a[88:91], v[124:127]
    ds_read_b64_tr_b16 a[184:185], v21 offset:36864
    ds_read_b64_tr_b16 a[186:187], v21 offset:38912
    v_mfma_f32_16x16x32_bf16 v[132:135], a[196:199], a[92:95], v[132:135]
    v_cndmask_b32 v17, v17, v81, s[6:7]
    v_cndmask_b32 v18, v18, v82, s[6:7]
    v_mfma_f32_16x16x32_bf16 v[112:115], a[200:203], a[96:99], v[112:115]
    v_cndmask_b32 v19, v19, v83, s[6:7]
    s_and_b32 s66, s66, 15
    s_cselect_b64 s[6:7], 0, -1
    v_mfma_f32_16x16x32_bf16 v[120:123], a[200:203], a[100:103], v[120:123]
    s_mul_i32 s66, s66, 122880
    ds_read_b64_tr_b16 a[188:189], v22 offset:36864
    ds_read_b64_tr_b16 a[190:191], v22 offset:38912
    v_mfma_f32_16x16x32_bf16 v[128:131], a[200:203], a[104:107], v[128:131]
    s_add_u32 s66, s66, 98304
    ds_read_b64_tr_b16 a[192:193], v21 offset:40960
    ds_read_b64_tr_b16 a[194:195], v21 offset:43008
    s_waitcnt lgkmcnt(6)
    v_mfma_f32_16x16x32_bf16 v[116:119], a[204:207], a[96:99], v[116:119]
    ds_read_b64_tr_b16 a[196:197], v22 offset:40960
    ds_read_b64_tr_b16 a[198:199], v22 offset:43008
    v_mfma_f32_16x16x32_bf16 v[124:127], a[204:207], a[100:103], v[124:127]
    ds_read_b64_tr_b16 a[200:201], v21 offset:45056
    ds_read_b64_tr_b16 a[202:203], v21 offset:47104
    v_mfma_f32_16x16x32_bf16 v[132:135], a[204:207], a[104:107], v[132:135]
    s_waitcnt lgkmcnt(8)
    ds_read_b64_tr_b16 a[204:205], v22 offset:45056
    ds_read_b64_tr_b16 a[206:207], v22 offset:47104
    v_mfma_f32_16x16x32_bf16 v[112:115], a[184:187], a[108:111], v[112:115]
    v_mfma_f32_16x16x32_bf16 v[120:123], a[184:187], a[112:115], v[120:123]
    v_mfma_f32_16x16x32_bf16 v[128:131], a[184:187], a[116:119], v[128:131]
    s_waitcnt lgkmcnt(8)
    v_mfma_f32_16x16x32_bf16 v[116:119], a[188:191], a[108:111], v[116:119]
    v_mfma_f32_16x16x32_bf16 v[124:127], a[188:191], a[112:115], v[124:127]
    v_mfma_f32_16x16x32_bf16 v[132:135], a[188:191], a[116:119], v[132:135]
    s_waitcnt lgkmcnt(0)
    s_barrier
    v_mfma_f32_16x16x32_bf16 v[112:115], a[192:195], a[120:123], v[112:115]
    ds_read_b64_tr_b16 a[184:185], v23 offset:24576
    ds_read_b64_tr_b16 a[186:187], v23 offset:26624
    v_mfma_f32_16x16x32_bf16 v[120:123], a[192:195], a[124:127], v[120:123]
    ds_read_b64_tr_b16 a[188:189], v24 offset:24576
    ds_read_b64_tr_b16 a[190:191], v24 offset:26624
    v_mfma_f32_16x16x32_bf16 v[128:131], a[192:195], a[128:131], v[128:131]
    ds_read_b64_tr_b16 a[192:193], v23 offset:28672
    ds_read_b64_tr_b16 a[194:195], v23 offset:30720
    v_mfma_f32_16x16x32_bf16 v[116:119], a[196:199], a[120:123], v[116:119]
    v_mfma_f32_16x16x32_bf16 v[124:127], a[196:199], a[124:127], v[124:127]
    v_mfma_f32_16x16x32_bf16 v[132:135], a[196:199], a[128:131], v[132:135]
    ds_read_b64_tr_b16 a[196:197], v24 offset:28672
    ds_read_b64_tr_b16 a[198:199], v24 offset:30720
    v_mfma_f32_16x16x32_bf16 v[112:115], a[200:203], a[132:135], v[112:115]
    v_mfma_f32_16x16x32_bf16 v[120:123], a[200:203], a[136:139], v[120:123]
    v_mfma_f32_16x16x32_bf16 v[128:131], a[200:203], a[140:143], v[128:131]
    ds_read_b64_tr_b16 a[200:201], v23 offset:32768
    ds_read_b64_tr_b16 a[202:203], v23 offset:34816
    v_mfma_f32_16x16x32_bf16 v[116:119], a[204:207], a[132:135], v[116:119]
    s_nop 2
    v_cvt_pk_bf16_f32 v112, v112, v113
    v_cvt_pk_bf16_f32 v113, v114, v115
    v_mfma_f32_16x16x32_bf16 v[124:127], a[204:207], a[136:139], v[124:127]
    v_cndmask_b32 v16, v16, v112, s[6:7]
    v_cndmask_b32 v17, v17, v113, s[6:7]
    v_mfma_f32_16x16x32_bf16 v[132:135], a[204:207], a[140:143], v[132:135]
    s_waitcnt lgkmcnt(4)
    ds_read_b64_tr_b16 a[204:205], v24 offset:32768
    ds_read_b64_tr_b16 a[206:207], v24 offset:34816
    v_mfma_f32_16x16x32_bf16 v[88:91], a[184:187], a[72:75], v[88:91]
    v_cvt_pk_bf16_f32 v114, v116, v117
    v_cvt_pk_bf16_f32 v115, v118, v119
    v_mfma_f32_16x16x32_bf16 v[96:99], a[184:187], a[76:79], v[96:99]
    v_cndmask_b32 v116, v5, v20, s[6:7]
    v_cndmask_b32 v18, v18, v114, s[6:7]
    v_mfma_f32_16x16x32_bf16 v[104:107], a[184:187], a[80:83], v[104:107]
    buffer_store_dwordx4 v[112:115], v116, s[32:35], s66 offen sc1
    v_mfma_f32_16x16x32_bf16 v[92:95], a[188:191], a[72:75], v[92:95]
    s_nop 0
    s_sub_u32 s66, s64, 9
    ds_read_b64_tr_b16 a[184:185], v23 offset:36864
    ds_read_b64_tr_b16 a[186:187], v23 offset:38912
    v_mfma_f32_16x16x32_bf16 v[100:103], a[188:191], a[76:79], v[100:103]
    v_cndmask_b32 v19, v19, v115, s[6:7]
    v_cvt_pk_bf16_f32 v120, v120, v121
    v_mfma_f32_16x16x32_bf16 v[108:111], a[188:191], a[80:83], v[108:111]
    ds_read_b64_tr_b16 a[188:189], v24 offset:36864
    ds_read_b64_tr_b16 a[190:191], v24 offset:38912
    v_mfma_f32_16x16x32_bf16 v[88:91], a[192:195], a[84:87], v[88:91]
    s_and_b32 s66, s66, 15
    s_cselect_b64 s[6:7], 0, -1
    v_cvt_pk_bf16_f32 v121, v122, v123
    v_mfma_f32_16x16x32_bf16 v[96:99], a[192:195], a[88:91], v[96:99]
    s_mul_i32 s66, s66, 122880
    v_cvt_pk_bf16_f32 v122, v124, v125
    v_cvt_pk_bf16_f32 v123, v126, v127
    v_mfma_f32_16x16x32_bf16 v[104:107], a[192:195], a[92:95], v[104:107]
    s_add_u32 s66, s66, 99328
    v_cndmask_b32 v124, v5, v20, s[6:7]
    v_cndmask_b32 v16, v16, v120, s[6:7]
    s_waitcnt lgkmcnt(4)
    v_mfma_f32_16x16x32_bf16 v[92:95], a[196:199], a[84:87], v[92:95]
    buffer_store_dwordx4 v[120:123], v124, s[32:35], s66 offen sc1
    v_mfma_f32_16x16x32_bf16 v[100:103], a[196:199], a[88:91], v[100:103]
    s_nop 0
    s_sub_u32 s66, s64, 10
    v_cndmask_b32 v17, v17, v121, s[6:7]
    v_cndmask_b32 v18, v18, v122, s[6:7]
    v_mfma_f32_16x16x32_bf16 v[108:111], a[196:199], a[92:95], v[108:111]
    v_cndmask_b32 v19, v19, v123, s[6:7]
    v_cvt_pk_bf16_f32 v128, v128, v129
    v_mfma_f32_16x16x32_bf16 v[88:91], a[200:203], a[96:99], v[88:91]
    s_and_b32 s66, s66, 15
    s_cselect_b64 s[6:7], 0, -1
    v_cvt_pk_bf16_f32 v129, v130, v131
    v_mfma_f32_16x16x32_bf16 v[96:99], a[200:203], a[100:103], v[96:99]
    s_mul_i32 s66, s66, 122880
    v_cvt_pk_bf16_f32 v130, v132, v133
    v_cvt_pk_bf16_f32 v131, v134, v135
    v_mfma_f32_16x16x32_bf16 v[104:107], a[200:203], a[104:107], v[104:107]
    s_add_u32 s66, s66, 100352
    ds_read_b64_tr_b16 a[192:193], v23 offset:40960
    ds_read_b64_tr_b16 a[194:195], v23 offset:43008
    v_mfma_f32_16x16x32_bf16 v[92:95], a[204:207], a[96:99], v[92:95]
    v_cndmask_b32 v132, v5, v20, s[6:7]
    v_cndmask_b32 v16, v16, v128, s[6:7]
    v_mfma_f32_16x16x32_bf16 v[100:103], a[204:207], a[100:103], v[100:103]
    buffer_store_dwordx4 v[128:131], v132, s[32:35], s66 offen sc1
    v_mfma_f32_16x16x32_bf16 v[108:111], a[204:207], a[104:107], v[108:111]
    s_nop 0
    s_sub_u32 s66, s64, 11
    v_cndmask_b32 v17, v17, v129, s[6:7]
    v_cndmask_b32 v18, v18, v130, s[6:7]
    s_waitcnt lgkmcnt(2)
    v_mfma_f32_16x16x32_bf16 v[88:91], a[184:187], a[108:111], v[88:91]
    v_cndmask_b32 v19, v19, v131, s[6:7]
    s_and_b32 s66, s66, 15
    s_cselect_b64 s[6:7], 0, -1
    v_mfma_f32_16x16x32_bf16 v[96:99], a[184:187], a[112:115], v[96:99]
    s_mul_i32 s66, s66, 122880
    ds_read_b64_tr_b16 a[196:197], v24 offset:40960
    ds_read_b64_tr_b16 a[198:199], v24 offset:43008
    v_mfma_f32_16x16x32_bf16 v[104:107], a[184:187], a[116:119], v[104:107]
    s_add_u32 s66, s66, 110592
    ds_read_b64_tr_b16 a[200:201], v23 offset:45056
    ds_read_b64_tr_b16 a[202:203], v23 offset:47104
    v_mfma_f32_16x16x32_bf16 v[92:95], a[188:191], a[108:111], v[92:95]
    ds_read_b64_tr_b16 a[204:205], v24 offset:45056
    ds_read_b64_tr_b16 a[206:207], v24 offset:47104
    v_mfma_f32_16x16x32_bf16 v[100:103], a[188:191], a[112:115], v[100:103]
    v_mfma_f32_16x16x32_bf16 v[108:111], a[188:191], a[116:119], v[108:111]
    s_waitcnt lgkmcnt(6)
    v_mfma_f32_16x16x32_bf16 v[88:91], a[192:195], a[120:123], v[88:91]
    v_mfma_f32_16x16x32_bf16 v[96:99], a[192:195], a[124:127], v[96:99]
    v_mfma_f32_16x16x32_bf16 v[104:107], a[192:195], a[128:131], v[104:107]
    s_waitcnt lgkmcnt(4)
    v_mfma_f32_16x16x32_bf16 v[92:95], a[196:199], a[120:123], v[92:95]
    v_mfma_f32_16x16x32_bf16 v[100:103], a[196:199], a[124:127], v[100:103]
    v_mfma_f32_16x16x32_bf16 v[108:111], a[196:199], a[128:131], v[108:111]
    s_waitcnt lgkmcnt(0)
    v_mfma_f32_16x16x32_bf16 v[88:91], a[200:203], a[132:135], v[88:91]
    v_mfma_f32_16x16x32_bf16 v[96:99], a[200:203], a[136:139], v[96:99]
    v_mfma_f32_16x16x32_bf16 v[104:107], a[200:203], a[140:143], v[104:107]
    v_mfma_f32_16x16x32_bf16 v[92:95], a[204:207], a[132:135], v[92:95]
    s_nop 4
    v_cvt_pk_bf16_f32 v88, v88, v89
    v_cvt_pk_bf16_f32 v89, v90, v91
    v_mfma_f32_16x16x32_bf16 v[100:103], a[204:207], a[136:139], v[100:103]
    v_cndmask_b32 v16, v16, v88, s[6:7]
    v_cndmask_b32 v17, v17, v89, s[6:7]
    v_mfma_f32_16x16x32_bf16 v[108:111], a[204:207], a[140:143], v[108:111]
    v_cvt_pk_bf16_f32 v96, v96, v97
    v_cvt_pk_bf16_f32 v97, v98, v99
    v_cvt_pk_bf16_f32 v90, v92, v93
    v_cvt_pk_bf16_f32 v91, v94, v95
    v_cndmask_b32 v92, v5, v20, s[6:7]
    v_cndmask_b32 v18, v18, v90, s[6:7]
    v_cndmask_b32 v19, v19, v91, s[6:7]
    v_cvt_pk_bf16_f32 v98, v100, v101
    v_cvt_pk_bf16_f32 v99, v102, v103
    v_cvt_pk_bf16_f32 v104, v104, v105
    v_cvt_pk_bf16_f32 v105, v106, v107
    v_cvt_pk_bf16_f32 v106, v108, v109
    buffer_store_dwordx4 v[88:91], v92, s[32:35], s66 offen sc1
    v_cvt_pk_bf16_f32 v107, v110, v111
    s_nop 0
    s_sub_u32 s66, s64, 12
    s_and_b32 s66, s66, 15
    s_cselect_b64 s[6:7], 0, -1
    s_mul_i32 s66, s66, 122880
    s_add_u32 s66, s66, 111616
    v_cndmask_b32 v100, v5, v20, s[6:7]
    v_cndmask_b32 v16, v16, v96, s[6:7]
    v_cndmask_b32 v17, v17, v97, s[6:7]
    v_cndmask_b32 v18, v18, v98, s[6:7]
    v_cndmask_b32 v19, v19, v99, s[6:7]
    buffer_store_dwordx4 v[96:99], v100, s[32:35], s66 offen sc1
    s_nop 1
    s_sub_u32 s66, s64, 13
    s_and_b32 s66, s66, 15
    s_cselect_b64 s[6:7], 0, -1
    s_mul_i32 s66, s66, 122880
    s_add_u32 s66, s66, 112640
    v_cndmask_b32 v108, v5, v20, s[6:7]
    buffer_store_dwordx4 v[104:107], v108, s[32:35], s66 offen sc1
    buffer_load_dword v6, v30, s[32:35], s9 offen sc1
    v_cndmask_b32 v16, v16, v104, s[6:7]
    v_cndmask_b32 v17, v17, v105, s[6:7]
    v_cndmask_b32 v18, v18, v106, s[6:7]
    v_cndmask_b32 v19, v19, v107, s[6:7]
    s_waitcnt vmcnt(1)
    s_barrier
    buffer_store_dword v63, v4, s[32:35], s65 offen offset:256 sc1
    s_waitcnt vmcnt(1)
    v_cmp_ne_u32 vcc, s11, v6
    s_nop 3
    s_cbranch_vccnz LA_ps0
LA_backp0:
    s_barrier
    s_add_u32 s58, s8, 122880
    buffer_load_dwordx4 a[4:7], v1, s[32:35], s58 offen sc1
    s_add_u32 s58, s8, 245760
    buffer_load_dwordx4 a[8:11], v1, s[32:35], s58 offen sc1
    s_add_u32 s58, s8, 368640
    buffer_load_dwordx4 a[12:15], v1, s[32:35], s58 offen sc1
    s_add_u32 s58, s8, 491520
    buffer_load_dwordx4 a[16:19], v1, s[32:35], s58 offen sc1
    buffer_load_dword v7, v30, s[32:35], s21 offen sc1
    s_add_u32 s58, s8, 614400
    buffer_load_dwordx4 a[20:23], v1, s[32:35], s58 offen sc1
    s_add_u32 s58, s8, 737280
    buffer_load_dwordx4 a[24:27], v1, s[32:35], s58 offen sc1
    s_add_u32 s58, s8, 860160
    buffer_load_dwordx4 a[28:31], v1, s[32:35], s58 offen sc1
    s_add_u32 s58, s8, 983040
    buffer_load_dwordx4 a[32:35], v1, s[32:35], s58 offen sc1
    s_add_u32 s58, s8, 1105920
    buffer_load_dwordx4 a[36:39], v1, s[32:35], s58 offen sc1
    s_add_u32 s58, s8, 1228800
    buffer_load_dwordx4 a[40:43], v1, s[32:35], s58 offen sc1
    s_add_u32 s58, s8, 1351680
    buffer_load_dwordx4 a[44:47], v1, s[32:35], s58 offen sc1
    s_add_u32 s58, s8, 1474560
    buffer_load_dwordx4 a[48:51], v1, s[32:35], s58 offen sc1
    s_add_u32 s58, s8, 1597440
    buffer_load_dwordx4 a[52:55], v1, s[32:35], s58 offen sc1
    s_add_u32 s58, s8, 1720320
    buffer_load_dwordx4 a[56:59], v1, s[32:35], s58 offen sc1
    s_add_u32 s58, s8, 1843200
    buffer_load_dwordx4 a[60:63], v1, s[32:35], s58 offen sc1
    s_waitcnt vmcnt(11)
    v_cmp_ne_u32 vcc, s11, v7
    s_nop 3
    s_cbranch_vccnz LA_ps1
LA_backp1:
    s_barrier
    s_add_u32 s58, s20, 122880
    buffer_load_dwordx4 a[76:79], v62, s[32:35], s58 offen sc1
    s_add_u32 s58, s20, 245760
    buffer_load_dwordx4 a[80:83], v62, s[32:35], s58 offen sc1
    s_add_u32 s58, s20, 368640
    buffer_load_dwordx4 a[84:87], v62, s[32:35], s58 offen sc1
    s_add_u32 s58, s20, 491520
    buffer_load_dwordx4 a[88:91], v62, s[32:35], s58 offen sc1
    s_add_u32 s58, s20, 614400
    buffer_load_dwordx4 a[92:95], v62, s[32:35], s58 offen sc1
    s_add_u32 s58, s20, 737280
    buffer_load_dwordx4 a[96:99], v62, s[32:35], s58 offen sc1
    s_add_u32 s58, s20, 860160
    buffer_load_dwordx4 a[100:103], v62, s[32:35], s58 offen sc1
    s_add_u32 s58, s20, 983040
    buffer_load_dwordx4 a[104:107], v62, s[32:35], s58 offen sc1
    s_add_u32 s58, s20, 1105920
    buffer_load_dwordx4 a[108:111], v62, s[32:35], s58 offen sc1
    s_add_u32 s58, s20, 1228800
    buffer_load_dwordx4 a[112:115], v62, s[32:35], s58 offen sc1
    s_add_u32 s58, s20, 1351680
    buffer_load_dwordx4 a[116:119], v62, s[32:35], s58 offen sc1
    s_add_u32 s58, s20, 1474560
    buffer_load_dwordx4 a[120:123], v62, s[32:35], s58 offen sc1
    s_add_u32 s58, s20, 1597440
    buffer_load_dwordx4 a[124:127], v62, s[32:35], s58 offen sc1
    s_add_u32 s58, s20, 1720320
    buffer_load_dwordx4 a[128:131], v62, s[32:35], s58 offen sc1
    s_add_u32 s58, s20, 1843200
    buffer_load_dwordx4 a[132:135], v62, s[32:35], s58 offen sc1
    v_mfma_f32_16x16x32_bf16 v[136:139], v[58:61], v[12:15], 0
    v_mfma_f32_16x16x32_bf16 v[140:143], v[56:59], v[12:15], 0
    v_mfma_f32_16x16x32_bf16 v[136:139], v[58:61], a[4:7], v[136:139]
    v_mfma_f32_16x16x32_bf16 v[140:143], v[56:59], a[4:7], v[140:143]
    v_mfma_f32_16x16x32_bf16 v[136:139], v[58:61], a[8:11], v[136:139]
    v_mfma_f32_16x16x32_bf16 v[140:143], v[56:59], a[8:11], v[140:143]
    v_mfma_f32_16x16x32_bf16 v[136:139], v[58:61], a[12:15], v[136:139]
    v_mfma_f32_16x16x32_bf16 v[140:143], v[56:59], a[12:15], v[140:143]
    v_mfma_f32_16x16x32_bf16 v[136:139], v[58:61], a[16:19], v[136:139]
    v_mfma_f32_16x16x32_bf16 v[140:143], v[56:59], a[16:19], v[140:143]
    s_waitcnt vmcnt(25)
    v_mfma_f32_16x16x32_bf16 v[136:139], v[58:61], a[20:23], v[136:139]
    v_mfma_f32_16x16x32_bf16 v[140:143], v[56:59], a[20:23], v[140:143]
    s_waitcnt vmcnt(24)
    v_mfma_f32_16x16x32_bf16 v[136:139], v[58:61], a[24:27], v[136:139]
    v_mfma_f32_16x16x32_bf16 v[140:143], v[56:59], a[24:27], v[140:143]
    s_waitcnt vmcnt(23)
    v_mfma_f32_16x16x32_bf16 v[136:139], v[58:61], a[28:31], v[136:139]
    v_mfma_f32_16x16x32_bf16 v[140:143], v[56:59], a[28:31], v[140:143]
    s_waitcnt vmcnt(22)
    v_mfma_f32_16x16x32_bf16 v[136:139], v[58:61], a[32:35], v[136:139]
    v_mfma_f32_16x16x32_bf16 v[140:143], v[56:59], a[32:35], v[140:143]
    s_waitcnt vmcnt(21)
    v_mfma_f32_16x16x32_bf16 v[136:139], v[58:61], a[36:39], v[136:139]
    v_mfma_f32_16x16x32_bf16 v[140:143], v[56:59], a[36:39], v[140:143]
    s_waitcnt vmcnt(20)
    v_mfma_f32_16x16x32_bf16 v[136:139], v[58:61], a[40:43], v[136:139]
    v_mfma_f32_16x16x32_bf16 v[140:143], v[56:59], a[40:43], v[140:143]
    s_waitcnt vmcnt(19)
    v_mfma_f32_16x16x32_bf16 v[136:139], v[58:61], a[44:47], v[136:139]
    v_mfma_f32_16x16x32_bf16 v[140:143], v[56:59], a[44:47], v[140:143]
    s_waitcnt vmcnt(18)
    v_mfma_f32_16x16x32_bf16 v[136:139], v[58:61], a[48:51], v[136:139]
    v_mfma_f32_16x16x32_bf16 v[140:143], v[56:59], a[48:51], v[140:143]
    s_waitcnt vmcnt(17)
    v_mfma_f32_16x16x32_bf16 v[136:139], v[58:61], a[52:55], v[136:139]
    v_mfma_f32_16x16x32_bf16 v[140:143], v[56:59], a[52:55], v[140:143]
    s_waitcnt vmcnt(16)
    v_mfma_f32_16x16x32_bf16 v[136:139], v[58:61], a[56:59], v[136:139]
    v_mfma_f32_16x16x32_bf16 v[140:143], v[56:59], a[56:59], v[140:143]
    s_waitcnt vmcnt(15)
    v_mfma_f32_16x16x32_bf16 v[136:139], v[58:61], a[60:63], v[136:139]
    v_mfma_f32_16x16x32_bf16 v[140:143], v[56:59], a[60:63], v[140:143]
    v_mfma_f32_16x16x32_bf16 v[144:147], v[58:61], v[16:19], 0
    v_mfma_f32_16x16x32_bf16 v[148:151], v[56:59], v[16:19], 0
    s_nop 4
    v_cvt_pk_bf16_f32 v136, v136, v137
    v_cvt_pk_bf16_f32 v137, v138, v139
    s_waitcnt vmcnt(14)
    v_mfma_f32_16x16x32_bf16 v[144:147], v[58:61], a[76:79], v[144:147]
    v_cvt_pk_bf16_f32 v138, v140, v141
    v_cvt_pk_bf16_f32 v139, v142, v143
    v_mfma_f32_16x16x32_bf16 v[148:151], v[56:59], a[76:79], v[148:151]
    v_permlane16_swap_b32 v136, v138
    v_permlane16_swap_b32 v137, v139
    s_waitcnt vmcnt(13)
    v_mfma_f32_16x16x32_bf16 v[144:147], v[58:61], a[80:83], v[144:147]
    buffer_store_dwordx4 v[136:139], v29, s[36:39], 0 offen sc1
    v_mfma_f32_16x16x32_bf16 v[148:151], v[56:59], a[80:83], v[148:151]
    s_waitcnt vmcnt(13)
    v_mfma_f32_16x16x32_bf16 v[144:147], v[58:61], a[84:87], v[144:147]
    v_mfma_f32_16x16x32_bf16 v[148:151], v[56:59], a[84:87], v[148:151]
    s_waitcnt vmcnt(12)
    v_mfma_f32_16x16x32_bf16 v[144:147], v[58:61], a[88:91], v[144:147]
    v_mfma_f32_16x16x32_bf16 v[148:151], v[56:59], a[88:91], v[148:151]
    s_waitcnt vmcnt(11)
    v_mfma_f32_16x16x32_bf16 v[144:147], v[58:61], a[92:95], v[144:147]
    v_mfma_f32_16x16x32_bf16 v[148:151], v[56:59], a[92:95], v[148:151]
    s_waitcnt vmcnt(10)
    v_mfma_f32_16x16x32_bf16 v[144:147], v[58:61], a[96:99], v[144:147]
    v_mfma_f32_16x16x32_bf16 v[148:151], v[56:59], a[96:99], v[148:151]
    s_waitcnt vmcnt(9)
    v_mfma_f32_16x16x32_bf16 v[144:147], v[58:61], a[100:103], v[144:147]
    v_mfma_f32_16x16x32_bf16 v[148:151], v[56:59], a[100:103], v[148:151]
    s_waitcnt vmcnt(8)
    v_mfma_f32_16x16x32_bf16 v[144:147], v[58:61], a[104:107], v[144:147]
    v_mfma_f32_16x16x32_bf16 v[148:151], v[56:59], a[104:107], v[148:151]
    s_waitcnt vmcnt(7)
    v_mfma_f32_16x16x32_bf16 v[144:147], v[58:61], a[108:111], v[144:147]
    v_mfma_f32_16x16x32_bf16 v[148:151], v[56:59], a[108:111], v[148:151]
    s_waitcnt vmcnt(6)
    v_mfma_f32_16x16x32_bf16 v[144:147], v[58:61], a[112:115], v[144:147]
    v_mfma_f32_16x16x32_bf16 v[148:151], v[56:59], a[112:115], v[148:151]
    s_waitcnt vmcnt(5)
    v_mfma_f32_16x16x32_bf16 v[144:147], v[58:61], a[116:119], v[144:147]
    v_mfma_f32_16x16x32_bf16 v[148:151], v[56:59], a[116:119], v[148:151]
    s_waitcnt vmcnt(4)
    v_mfma_f32_16x16x32_bf16 v[144:147], v[58:61], a[120:123], v[144:147]
    v_mfma_f32_16x16x32_bf16 v[148:151], v[56:59], a[120:123], v[148:151]
    s_waitcnt vmcnt(3)
    v_mfma_f32_16x16x32_bf16 v[144:147], v[58:61], a[124:127], v[144:147]
    v_mfma_f32_16x16x32_bf16 v[148:151], v[56:59], a[124:127], v[148:151]
    s_waitcnt vmcnt(2)
    v_mfma_f32_16x16x32_bf16 v[144:147], v[58:61], a[128:131], v[144:147]
    v_mfma_f32_16x16x32_bf16 v[148:151], v[56:59], a[128:131], v[148:151]
    s_waitcnt vmcnt(1)
    v_mfma_f32_16x16x32_bf16 v[144:147], v[58:61], a[132:135], v[144:147]
    v_mfma_f32_16x16x32_bf16 v[148:151], v[56:59], a[132:135], v[148:151]
    s_nop 6
    v_cvt_pk_bf16_f32 v144, v144, v145
    v_cvt_pk_bf16_f32 v145, v146, v147
    v_cvt_pk_bf16_f32 v146, v148, v149
    v_cvt_pk_bf16_f32 v147, v150, v151
    s_nop 0
    v_permlane16_swap_b32 v144, v146
    v_permlane16_swap_b32 v145, v147
    buffer_store_dwordx4 v[144:147], v0, s[36:39], 0 offen sc1
    s_endpgm
LA_slow0:
    s_mov_b32 s3, 524288
LA_spin0:
    buffer_load_dwordx4 v[56:59], off, s[40:43], 0 sc1
    s_waitcnt vmcnt(0)
    v_and_b32 v56, v56, v57
    v_and_b32 v58, v58, v59
    v_and_b32 v56, v56, v58
    s_nop 0
    v_readfirstlane_b32 s47, v56
    s_nop 0
    s_cmp_eq_u32 s47, 0x1
    s_cbranch_scc1 LA_back0
    s_sub_u32 s3, s3, 1
    s_cmp_lg_u32 s3, 0
    s_cbranch_scc1 LA_spin0
    s_branch LA_back0
LA_ps0:
    s_mov_b32 s3, 524288
LA_poll0:
    buffer_load_dword v6, v30, s[32:35], s9 offen sc1
    s_waitcnt vmcnt(0)
    v_cmp_ne_u32 vcc, s11, v6
    s_sub_u32 s3, s3, 1
    s_cbranch_scc1 LA_backp0
    s_nop 1
    s_cbranch_vccnz LA_poll0
    s_branch LA_backp0
LA_ps1:
    s_mov_b32 s3, 524288
LA_poll1:
    buffer_load_dword v7, v30, s[32:35], s21 offen sc1
    s_waitcnt vmcnt(0)
    v_cmp_ne_u32 vcc, s11, v7
    s_sub_u32 s3, s3, 1
    s_cbranch_scc1 LA_backp1
    s_nop 1
    s_cbranch_vccnz LA_poll1
    s_branch LA_backp1
LA_code_end:
.section .rodata,"a"
.p2align 6
.amdhsa_kernel concat_heads__gqa_block_cached__mha_block_cached__near_ridge_kernel
  .amdhsa_next_free_vgpr 512
  .amdhsa_next_free_sgpr 102
  .amdhsa_accum_offset 256
  .amdhsa_group_segment_fixed_size 0
  .amdhsa_kernarg_size 104
  .amdhsa_user_sgpr_count 2
  .amdhsa_user_sgpr_kernarg_segment_ptr 1
  .amdhsa_system_sgpr_workgroup_id_x 1
  .amdhsa_float_denorm_mode_32 3
.end_amdhsa_kernel
```
